```python
import torch

def _softmax(x, axis=-1):
    return torch.softmax(x, dim=axis)
def _gelu(x):
    return torch.nn.functional.gelu(x, approximate="tanh")
def _silu(x):
    return torch.nn.functional.silu(x)
def _sigmoid(x):
    return torch.sigmoid(x)
def _layernorm(x, axis=-1, eps=1e-5):
    m = x.mean(dim=axis, keepdim=True)
    v = x.var(dim=axis, keepdim=True, unbiased=False)
    return (x - m) / torch.sqrt(v + eps)
def _scatter_add(tgt, idx, src, axis=0):
    return tgt.clone().index_add_(axis, idx, src)
def _segment_sum(src, seg, n):
    out = torch.zeros((n,) + src.shape[1:], dtype=src.dtype)
    return out.index_add_(0, seg, src)
def _pad(x, pw):
    flat = tuple(v for pair in reversed(pw) for v in pair)
    return torch.nn.functional.pad(x, flat)

kernel_name = 'sequential_preLN__sliding_local_dilated__moe_arch_mod__prompt'

def setup_inputs():

    _w = (lambda a: (lambda t: t.to(torch.bfloat16) if t.is_floating_point() else t)(torch.as_tensor(a)))
    def _A_setup():
        B, S, D = 1, 2048, 640
        return {
            "x": _w((lambda *s: torch.randn(*s, dtype=torch.bfloat16) * 0.05)(B, S, D)),
            "wqkv": _w((lambda *s: torch.randn(*s, dtype=torch.bfloat16) * 0.05)(D, 3 * D)),
            "wo": _w((lambda *s: torch.randn(*s, dtype=torch.bfloat16) * 0.05)(D, D)),
        }
    _A_in = _A_setup()

    def _B_setup():
        B, S, D, F, C = 1, 2048, 640, 1536, 1
        return {
            "x": _w((lambda *s: torch.randn(*s, dtype=torch.bfloat16) * 0.05)(B, S, D)),
            "w_r": _w((lambda *s: torch.randn(*s, dtype=torch.bfloat16) * 0.05)(D)),
            "w_gate": _w((lambda *s: torch.randn(*s, dtype=torch.bfloat16) * 0.05)(D, F)),
            "w_up": _w((lambda *s: torch.randn(*s, dtype=torch.bfloat16) * 0.05)(D, F)),
            "w_down": _w((lambda *s: torch.randn(*s, dtype=torch.bfloat16) * 0.05)(F, D)),
        }
    _B_in = _B_setup()

    return {
        "A_x": _A_in["x"],
        "A_wqkv": _A_in["wqkv"],
        "A_wo": _A_in["wo"],
        "B_x": _B_in["x"],
        "B_w_r": _B_in["w_r"],
        "B_w_gate": _B_in["w_gate"],
        "B_w_up": _B_in["w_up"],
        "B_w_down": _B_in["w_down"],
    }

def reference(A_x, A_wqkv, A_wo, B_x, B_w_r, B_w_gate, B_w_up, B_w_down):
    def _A_ref(x, wqkv, wo):
        B, S, D = x.shape
        H = 32; Dh = D // H
        W, dil = 8, 2
        qkv = (lambda x, *d: x.permute(*d))((x @ wqkv).reshape(B, S, 3, H, Dh), 2, 0, 3, 1, 4)
        q, k, v = qkv[0], qkv[1], qkv[2]
        scale = Dh ** -0.5
        pos = torch.arange(S)
        off = torch.arange(W) * dil
        idx = pos[:, None] - off[None, :]
        mask = idx >= 0
        idx_c = torch.where(mask, idx, 0).reshape(-1)
        kg = k[:, :, idx_c, :].reshape(B, H, S, W, Dh)
        vg = v[:, :, idx_c, :].reshape(B, H, S, W, Dh)
        logits = torch.einsum("bhsd,bhswd->bhsw", q, kg) * scale
        logits = torch.where(mask[None, None, :, :], logits, -1e9)
        attn = _softmax(logits, axis=-1)
        o = torch.einsum("bhsw,bhswd->bhsd", attn, vg)
        return (lambda x, *d: x.permute(*d))(o, 0, 2, 1, 3).reshape(B, S, D) @ wo

    def _B_ref(x, w_r, w_gate, w_up, w_down):
        B, S, D = x.shape
        C = 1
        r = x @ w_r
        idx = torch.argsort(-r, axis=-1)[:, :C]
        idx_e = (lambda x, n, axis: torch.repeat_interleave(x, n, dim=axis))(idx.reshape(B, C, 1), D, axis=2)
        x_sel = (lambda x, i, axis: torch.take_along_dim(x, i, dim=axis))(x, idx_e, axis=1)
        g = _silu(x_sel @ w_gate)
        u = x_sel @ w_up
        y = (g * u) @ w_down
        r_sel = _sigmoid((lambda x, i, axis: torch.take_along_dim(x, i, dim=axis))(r, idx, axis=1))
        y = y * r_sel.reshape(B, C, 1)
        b_off = (torch.arange(B) * S).reshape(B, 1)
        flat_idx = (idx + b_off).reshape(B * C)
        zero = (x * 0.0).reshape(B * S, D)
        upd = _scatter_add(zero, flat_idx, y.reshape(B * C, D), axis=0)
        return x + upd.reshape(B, S, D)

    x = A_x
    h = x + _A_ref(_layernorm(x, axis=-1), A_wqkv, A_wo)
    h2 = h + _B_ref(_layernorm(h, axis=-1), B_w_r, B_w_gate, B_w_up, B_w_down)
    return h2
```

```asm
; @launch grid=(256,1,1) block=(512,1,1) lds=163840
.amdgcn_target "amdgcn-amd-amdhsa--gfx950"
.text
.globl sequential_preLN__sliding_local_dilated__moe_arch_mod__prompt_kernel
.p2align 8
.type sequential_preLN__sliding_local_dilated__moe_arch_mod__prompt_kernel,@function
sequential_preLN__sliding_local_dilated__moe_arch_mod__prompt_kernel:
    s_cmp_ge_u32 s2, 256
    s_cbranch_scc1 L_end
    s_load_dwordx16 s[4:19], s[0:1], 0
    s_load_dwordx2 s[20:21], s[0:1], 64
    s_load_dwordx2 s[22:23], s[0:1], 80
    v_lshrrev_b32 v1, 6, v0
    v_and_b32 v0, 63, v0
    s_lshr_b32 s56, s2, 3
    s_mov_b32 s3, 0x40000
    v_readfirstlane_b32 s48, v1
    s_mov_b32 s47, 0xffff0000
    s_cmp_ge_u32 s2, 240
    s_cbranch_scc0 P_main
    s_getpc_b64 s[58:59]
    v_lshlrev_b32 v2, 7, v0
    v_lshl_add_u32 v2, v1, 13, v2
    v_cmp_gt_u32 vcc, L_last-P_main, v2
    s_nop 1
    v_cndmask_b32 v2, 0, v2, vcc
    global_load_dword v219, v2, s[58:59]
    s_branch F_start
P_main:
    s_mul_i32 s51, s56, 86
    s_lshr_b32 s51, s51, 8
    s_mul_i32 s57, s51, 3
    s_sub_u32 s57, s56, s57
    s_sub_u32 s52, s51, 5
    s_cselect_b32 s52, s51, s52
    s_and_b32 s66, s2, 7
    s_mul_i32 s53, s66, 3
    s_add_u32 s53, s53, s57
    s_lshr_b32 s55, s53, 1
    s_and_b32 s50, s53, 1
    s_mul_i32 s55, s55, 86
    s_sub_u32 s55, s55, 10
    s_mov_b32 s30, 2621440
    s_mov_b32 s31, 0x00020000
    s_mov_b32 s26, 7340032
    s_mov_b32 s27, 0x00020000
    s_cmp_ge_u32 s48, 4
    s_cbranch_scc1 LD_start
    v_and_b32 v1, 15, v0
    v_lshrrev_b32 v2, 4, v0
    s_mul_i32 s60, s51, 12
    s_lshl_b32 s61, s48, 2
    s_add_u32 s60, s60, s61
    v_add_u32 v10, s60, v2
    v_add_u32 v11, s55, v10
    v_cmp_gt_i32 vcc, 0, v11
    v_lshl_add_u32 v11, v11, 1, s50
    v_mul_u32_u24 v11, 1280, v11
    v_lshl_add_u32 v11, v1, 4, v11
    v_cndmask_b32 v11, v11, 2.0, vcc
    s_mov_b32 s34, 1280
    s_mov_b32 s35, 0x00020000
    s_mov_b32 s38, 819200
    s_mov_b32 s39, 0x00020000
    s_lshl_b32 s62, s53, 1
    s_add_u32 s62, s62, s51
    s_mul_i32 s62, s62, 8
    s_add_u32 s62, s62, s61
    s_sub_u32 s62, s62, 64
    s_cmp_lt_u32 s48, 2
    s_cselect_b32 s62, s62, 640
    s_lshl3_add_u32 s63, s53, s51
    s_add_u32 s63, s63, 384
    s_cmp_lt_u32 s51, 8
    s_cselect_b32 s65, 3, 0
    s_cselect_b32 s62, s63, s62
    s_cselect_b32 s63, 192, 1
    v_lshlrev_b32 v58, 4, v0
    v_lshlrev_b32 v59, 2, v0
    s_waitcnt lgkmcnt(0)
    s_mov_b32 s28, s4
    s_and_b32 s29, s5, 0xffff
    s_mov_b32 s24, s22
    s_and_b32 s25, s23, 0xffff
    s_buffer_load_dword s54, s[24:27], 0
    s_mov_b32 s32, s12
    s_and_b32 s33, s13, 0xffff
    s_mov_b32 s36, s8
    s_and_b32 s37, s9, 0xffff
    s_cmp_lt_u32 s48, s65
    s_cbranch_scc0 A_nors
    buffer_load_dwordx4 v[20:23], v11, s[28:31], 0 offen offset:0
    buffer_load_dwordx4 v[24:27], v11, s[28:31], 0 offen offset:256
    buffer_load_dwordx4 v[28:31], v11, s[28:31], 0 offen offset:512
    buffer_load_dwordx4 v[32:35], v11, s[28:31], 0 offen offset:768
    buffer_load_dwordx4 v[36:39], v11, s[28:31], 0 offen offset:1024
    s_branch A_cons
A_nors:
    s_cmp_lg_u32 s48, 3
    s_cbranch_scc1 A_nowr
    buffer_load_dwordx4 v[48:51], v58, s[32:35], 0 offen
    buffer_load_dword v52, v59, s[32:35], 0 offen offset:1024
A_nowr:
    s_cmp_ge_u32 s62, 640
    s_cbranch_scc1 A_cons
    v_mul_u32_u24 v10, s63, v2
    v_add_u32 v10, s62, v10
    v_lshlrev_b32 v12, 4, v1
    v_mul_u32_u24 v11, 1280, v10
    v_add_u32 v11, v11, v12
    buffer_load_dwordx4 v[76:79], v12, s[32:35], 0 offen offset:0
    buffer_load_dwordx4 v[80:83], v12, s[32:35], 0 offen offset:256
    buffer_load_dwordx4 v[84:87], v12, s[32:35], 0 offen offset:512
    buffer_load_dwordx4 v[88:91], v12, s[32:35], 0 offen offset:768
    buffer_load_dwordx4 v[92:95], v12, s[32:35], 0 offen offset:1024
    buffer_load_dwordx4 v[20:23], v11, s[36:39], 0 offen offset:0
    buffer_load_dwordx4 v[24:27], v11, s[36:39], 0 offen offset:256
    buffer_load_dwordx4 v[28:31], v11, s[36:39], 0 offen offset:512
    buffer_load_dwordx4 v[32:35], v11, s[36:39], 0 offen offset:768
    buffer_load_dwordx4 v[36:39], v11, s[36:39], 0 offen offset:1024
    s_branch A_cons
LD_start:
    s_sub_u32 s60, s48, 4
    v_lshrrev_b32 v1, 3, v0
    v_lshrrev_b32 v2, 4, v0
    v_and_b32 v3, 7, v0
    s_mul_i32 s62, s60, 24
    s_add_u32 s63, s62, 0
    v_add_u32 v4, s63, v1
    v_lshrrev_b32 v5, 1, v4
    v_and_b32 v5, 7, v5
    v_xor_b32 v5, v5, v3
    v_add_u32 v4, s55, v4
    v_cmp_gt_i32 vcc, 0, v4
    v_lshl_add_u32 v4, v4, 1, s50
    v_mul_u32_u24 v4, 1280, v4
    v_lshl_add_u32 v4, v5, 4, v4
    v_cndmask_b32 v10, v4, 2.0, vcc
    s_add_u32 s63, s62, 8
    v_add_u32 v4, s63, v1
    v_lshrrev_b32 v5, 1, v4
    v_and_b32 v5, 7, v5
    v_xor_b32 v5, v5, v3
    v_add_u32 v4, s55, v4
    v_cmp_gt_i32 vcc, 0, v4
    v_lshl_add_u32 v4, v4, 1, s50
    v_mul_u32_u24 v4, 1280, v4
    v_lshl_add_u32 v4, v5, 4, v4
    v_cndmask_b32 v11, v4, 2.0, vcc
    s_add_u32 s63, s62, 16
    v_add_u32 v4, s63, v1
    v_lshrrev_b32 v5, 1, v4
    v_and_b32 v5, 7, v5
    v_xor_b32 v5, v5, v3
    v_add_u32 v4, s55, v4
    v_cmp_gt_i32 vcc, 0, v4
    v_lshl_add_u32 v4, v4, 1, s50
    v_mul_u32_u24 v4, 1280, v4
    v_lshl_add_u32 v4, v5, 4, v4
    v_cndmask_b32 v12, v4, 2.0, vcc
    s_lshl_b32 s62, s60, 3
    v_add_u32 v4, s62, v1
    v_mul_u32_u24 v5, 3840, v4
    v_and_b32 v6, 1, v2
    s_and_b32 s62, s60, 1
    s_lshl_b32 s62, s62, 2
    v_lshl_or_b32 v6, v6, 1, s62
    v_xor_b32 v6, v6, v3
    s_lshl_b32 s62, s51, 7
    v_lshl_add_u32 v6, v6, 4, s62
    v_add_u32 v13, v5, v6
    v_add_u32 v14, 256, v13
    v_add_u32 v15, 512, v13
    s_add_u32 s61, s57, s51
    s_movk_i32 s58, 0x3210
    s_bitcmp1_b32 s61, 0
    s_cselect_b32 s58, 0x2301, s58
    s_mul_i32 s62, s61, 86
    s_lshr_b32 s62, s62, 8
    s_mul_i32 s62, s62, 3
    s_sub_u32 s61, s61, s62
    s_mov_b32 s59, 0x987654
    s_cmp_eq_u32 s61, 1
    s_cselect_b32 s59, 0x798465, s59
    s_cmp_eq_u32 s61, 2
    s_cselect_b32 s59, 0x879546, s59
    s_lshl_b32 s62, s59, 16
    s_or_b32 s58, s58, s62
    s_lshr_b32 s59, s59, 16
    s_mov_b32 s58, 0x76543210
    s_movk_i32 s59, 0x98
    s_mul_i32 s66, s66, 5
    s_lshr_b32 s66, s66, 2
    s_mul_i32 s64, s60, 3072
    s_mov_b32 s65, s64
    s_add_u32 s70, s64, 110592
    s_mov_b32 s34, 2457600
    s_mov_b32 s35, 0x00020000
    s_getpc_b64 s[98:99]
LD_pc:
    s_add_u32 s98, s98, LD_cont-LD_pc
    s_addc_u32 s99, s99, 0
    s_waitcnt lgkmcnt(0)
    s_mov_b32 s28, s4
    s_and_b32 s29, s5, 0xffff
    s_mov_b32 s32, s6
    s_and_b32 s33, s7, 0xffff
LD_issue:
    s_and_b32 s61, s58, 15
    s_add_u32 s61, s61, s66
    s_sub_u32 s67, s61, 10
    s_cselect_b32 s61, s61, s67
    s_mov_b32 m0, s65
    s_lshl_b32 s67, s61, 7
    buffer_load_dwordx4 v10, s[28:31], s67 offen lds
    s_add_u32 m0, s65, 1024
    s_mul_i32 s68, s61, 245760
    buffer_load_dwordx4 v11, s[28:31], s67 offen lds
    s_add_u32 m0, s65, 2048
    s_add_u32 s69, s68, 122880
    buffer_load_dwordx4 v12, s[28:31], s67 offen lds
    s_add_u32 m0, s65, 12288
    s_lshr_b64 s[58:59], s[58:59], 4
    buffer_load_dwordx4 v13, s[32:35], s68 offen offset:0 lds
    buffer_load_dwordx4 v14, s[32:35], s68 offen offset:1024 lds
    buffer_load_dwordx4 v15, s[32:35], s68 offen offset:2048 lds
    s_add_u32 m0, s65, 24576
    s_nop 0
    buffer_load_dwordx4 v13, s[32:35], s69 offen offset:0 lds
    buffer_load_dwordx4 v14, s[32:35], s69 offen offset:1024 lds
    buffer_load_dwordx4 v15, s[32:35], s69 offen offset:2048 lds
    s_add_u32 s65, s65, 36864
    s_cmp_eq_u32 s65, s70
    s_cselect_b32 s65, s64, s65
    s_setpc_b64 s[98:99]
LD_cont:
    s_mov_b32 s24, s22
    s_and_b32 s25, s23, 0xffff
    s_mov_b32 s36, s8
    s_and_b32 s37, s9, 0xffff
    s_mov_b32 s38, 819200
    s_mov_b32 s39, 0x00020000
    s_buffer_load_dword s54, s[24:27], 0
    v_mul_u32_u24 v5, 1280, v4
    v_add_u32 v16, v5, v6
    s_lshl_b32 s71, s53, 11
    s_add_u32 s71, s71, 81920
    s_mul_i32 s62, s60, 24
    v_add_u32 v17, s62, v0
    v_lshlrev_b32 v18, 4, v17
    v_cmp_gt_u32 vcc, 24, v0
    v_add_u32 v19, 72, v0
    v_lshlrev_b32 v19, 4, v19
    v_cndmask_b32 v18, v19, v18, vcc
    s_lshl_b32 s62, s51, 2
    s_add_u32 s62, s62, s60
    s_lshl_b32 s62, s62, 8
    s_sub_u32 s62, s62, s71
    s_add_u32 s62, s62, 1243488
    v_add_u32 v19, s62, v19
    v_cmp_lt_u32 vcc, 33, v0
    s_nop 1
    v_cndmask_b32 v18, v18, v19, vcc
    v_cmp_lt_u32 vcc, 49, v0
    s_nop 1
    v_cndmask_b32 v18, v18, 2.0, vcc
    v_mov_b32 v28, 0
    v_mov_b32 v29, 0
    v_mov_b32 v30, 0
    v_mov_b32 v31, 0
    s_lshl_b32 s62, s60, 6
    v_add_u32 v4, s62, v0
    v_lshlrev_b32 v35, 4, v4
    v_add_u32 v35, 135168, v35
    ds_write_b128 v35, v[28:31] offset:0
    ds_write_b128 v35, v[28:31] offset:4096
    ds_write_b128 v35, v[28:31] offset:8192
    ds_write_b128 v35, v[28:31] offset:12288
    ds_write_b128 v35, v[28:31] offset:16384
    ds_write_b128 v35, v[28:31] offset:20480
    v_mov_b32 v6, 159776
    ds_write_b64 v6, v[28:29]
    v_and_b32 v4, 31, v0
    v_lshlrev_b32 v5, 7, v4
    s_lshl_b32 s62, s51, 11
    v_add_u32 v6, s62, v5
    s_lshl_b32 s62, s51, 10
    s_add_u32 s62, s62, 18432
    v_add_u32 v7, s62, v5
    v_cmp_lt_u32 vcc, 15, v4
    s_nop 1
    v_cndmask_b32 v6, v6, v7, vcc
    s_lshl_b32 s62, s51, 8
    s_add_u32 s62, s62, 27648
    v_add_u32 v7, s62, v5
    v_cmp_lt_u32 vcc, 23, v4
    s_nop 1
    v_cndmask_b32 v6, v6, v7, vcc
    v_and_b32 v7, 128, v5
    v_add_u32 v7, 33280, v7
    v_cmp_lt_u32 vcc, 25, v4
    s_nop 1
    v_cndmask_b32 v6, v6, v7, vcc
    v_lshrrev_b32 v7, 5, v0
    v_mul_u32_u24 v7, 34560, v7
    v_add_u32 v36, v6, v7
    s_mov_b32 vcc_hi, 0xfc000000
    s_cmp_eq_u32 s60, 0
    s_cselect_b32 vcc_lo, 0xf0005555, vcc_hi
    v_cndmask_b32 v36, v36, 2.0, vcc
    s_call_b64 s[98:99], S_late
    s_call_b64 s[98:99], LD_issue
    s_waitcnt vmcnt(9) lgkmcnt(0)
    s_add_u32 s54, s54, 2654435761
    s_lshl_b32 s62, s60, 10
    s_add_u32 s62, s62, 36864
    s_mov_b32 s63, 245760
    s_barrier
    s_call_b64 s[98:99], LD_issue
    s_call_b64 s[98:99], S_late2
    s_waitcnt vmcnt(9)
    s_barrier
    s_call_b64 s[98:99], LD_issue
    s_call_b64 s[98:99], S_late3
    s_waitcnt vmcnt(9)
    s_barrier
    s_call_b64 s[98:99], LD_issue
    s_call_b64 s[98:99], S_late4
    s_waitcnt vmcnt(9)
    s_barrier
    s_call_b64 s[98:99], LD_issue
    s_waitcnt vmcnt(9)
    s_barrier
    s_call_b64 s[98:99], LD_issue
    s_waitcnt vmcnt(9)
    s_barrier
    s_call_b64 s[98:99], LD_issue
    s_waitcnt vmcnt(9)
    s_barrier
    s_call_b64 s[98:99], LD_issue
    s_waitcnt vmcnt(9)
    s_barrier
    buffer_load_dwordx4 v[20:23], v18, s[24:27], s71 offen sc1
    s_call_b64 s[98:99], LD_issue
    s_waitcnt vmcnt(9)
    s_barrier
    ds_read_b32 v24, v251 offset:2288
    s_mov_b32 m0, s62
    s_add_u32 s62, s62, 4096
    buffer_load_dwordx4 v16, s[36:39], s63 offen lds
    s_add_u32 s63, s63, 40960
    s_mov_b32 m0, s62
    s_add_u32 s62, s62, 4096
    buffer_load_dwordx4 v16, s[36:39], s63 offen lds
    s_add_u32 s63, s63, 40960
    s_mov_b32 m0, s62
    s_add_u32 s62, s62, 4096
    buffer_load_dwordx4 v16, s[36:39], s63 offen lds
    s_add_u32 s63, s63, 40960
    s_mov_b32 m0, s62
    s_add_u32 s62, s62, 4096
    buffer_load_dwordx4 v16, s[36:39], s63 offen lds
    s_add_u32 s63, s63, 40960
    s_mov_b32 m0, s62
    s_add_u32 s62, s62, 4096
    buffer_load_dwordx4 v16, s[36:39], s63 offen lds
    s_add_u32 s63, s63, 40960
    s_mov_b32 m0, s62
    s_add_u32 s62, s62, 4096
    buffer_load_dwordx4 v16, s[36:39], s63 offen lds
    s_add_u32 s63, s63, 40960
    s_mov_b32 m0, s62
    s_add_u32 s62, s62, 4096
    buffer_load_dwordx4 v16, s[36:39], s63 offen lds
    s_add_u32 s63, s63, 40960
    s_mov_b32 m0, s62
    s_add_u32 s62, s62, 4096
    buffer_load_dwordx4 v16, s[36:39], s63 offen lds
    s_add_u32 s63, s63, 40960
    s_mov_b32 m0, s62
    s_add_u32 s62, s62, 4096
    buffer_load_dwordx4 v16, s[36:39], s63 offen lds
    s_add_u32 s63, s63, 40960
    s_mov_b32 exec_hi, 3
    v_cmp_ne_u32 vcc, s54, v22
    s_cbranch_vccz LD_rs
LD_rsp:
    buffer_load_dwordx4 v[20:23], v18, s[24:27], s71 offen sc1
    s_waitcnt vmcnt(0)
    v_cmp_ne_u32 vcc, s54, v22
    s_cbranch_vccz LD_rs
    s_sleep 1
    s_sub_u32 s3, s3, 1
    s_cbranch_scc0 LD_rsp
    s_mov_b32 s3, 0
LD_rs:
    s_getreg_b32 s61, hwreg(HW_REG_XCC_ID)
    v_cmp_ne_u32 vcc, s61, v20
    s_lshr_b64 vcc, vcc, 24
    s_cselect_b32 s49, 0, 1
    s_lshl_b32 s61, s60, 5
    s_add_u32 s61, s61, 160828
    s_mov_b32 exec_hi, 0x3fffc
    s_mov_b32 exec_lo, 0
    v_cmp_eq_u32 vcc, s54, v22
    v_lshl_add_u32 v4, v0, 1, s61
    s_waitcnt lgkmcnt(0)
    v_mul_f32 v24, 0xbacccccd, v24
    v_fmac_f32 v21, v20, v24
    v_cndmask_b32 v21, 0, v21, vcc
    ds_write_b16_d16_hi v4, v21
    s_mov_b32 exec_hi, 0
    s_mov_b32 exec_lo, 0xffffff
    v_lshlrev_b32 v4, 3, v17
    v_add_u32 v4, 159808, v4
    ds_write_b64 v4, v[20:21]
    v_mov_b32 v4, 160768
    v_mov_b32 v5, s49
    ds_write_b32 v4, v5
    ds_write_b64 v4, v[28:29] offset:8
    ds_write_b64 v4, v[28:29] offset:16
    ds_write_b64 v4, v[28:29] offset:24
    s_mov_b64 exec, -1
    s_waitcnt vmcnt(9) lgkmcnt(0)
    s_barrier
    s_mov_b32 m0, s62
    s_add_u32 s62, s62, 4096
    buffer_load_dwordx4 v16, s[36:39], s63 offen lds
    s_add_u32 s63, s63, 40960
    s_mov_b32 m0, s62
    s_add_u32 s62, s62, 4096
    buffer_load_dwordx4 v16, s[36:39], s63 offen lds
    s_add_u32 s63, s63, 40960
    s_mov_b32 m0, s62
    s_add_u32 s62, s62, 4096
    buffer_load_dwordx4 v16, s[36:39], s63 offen lds
    s_add_u32 s63, s63, 40960
    s_mov_b32 m0, s62
    s_add_u32 s62, s62, 4096
    buffer_load_dwordx4 v16, s[36:39], s63 offen lds
    s_add_u32 s63, s63, 40960
    s_mov_b32 m0, s62
    s_add_u32 s62, s62, 4096
    buffer_load_dwordx4 v16, s[36:39], s63 offen lds
    s_add_u32 s63, s63, 40960
    s_cmp_eq_u32 s60, 3
    s_cbranch_scc1 pf_1
    s_mul_i32 s67, s53, 6
    s_lshl_b32 s68, s60, 1
    s_add_u32 s67, s67, s68
    s_mul_i32 s67, s67, 34560
    s_add_u32 s67, s67, 1310720
    buffer_load_dword v182, v36, s[24:27], s67 offen sc1
    s_mov_b64 exec, -1
    s_branch pf_2
pf_1:
    v_lshlrev_b32 v4, 7, v0
    s_sub_u32 s67, s100, s57
    s_add_u32 s67, s67, 173312
    v_writelane_b32 v4, s67, 3
    s_mov_b64 exec, 15
    buffer_load_dword v182, v4, s[24:27], s57 offen sc1
    s_mov_b64 exec, -1
pf_2:
    v_mov_b32 v99, v16
    s_mov_b64 exec, 0
    s_cmp_eq_u32 s60, 0
    s_cbranch_scc1 HA0_0
    s_cmp_eq_u32 s60, 1
    s_cbranch_scc1 HA1_0
    s_cmp_eq_u32 s60, 2
    s_cbranch_scc1 HA2_0
    s_branch HA3_0
HA_ret:
    s_mov_b64 exec, -1
    s_branch AT_start
S_late:
    v_and_b32 v200, 15, v0
    v_lshrrev_b32 v201, 4, v0
    v_lshlrev_b32 v202, 4, v0
    v_lshlrev_b32 v203, 2, v0
    v_lshrrev_b32 v64, 5, v0
    v_and_b32 v65, 12, v200
    s_mov_b32 s40, s20
    s_and_b32 s41, s21, 0xffff
    s_mov_b32 s42, 2621440
    s_mov_b32 s43, 0x00020000
    s_lshl_b32 s4, s52, 3
    s_sub_u32 s4, 96768, s4
    s_min_u32 s5, s48, 5
    s_lshl_b32 s6, s5, 4
    v_add_u32 v67, s6, v200
    v_mul_u32_u24 v68, 400, v67
    v_mad_u32_u24 v66, v201, 40, s4
    v_add_u32 v71, v68, v66
    v_subrev_u32 v205, 3072, v71
    v_mul_u32_u24 v72, 5, v201
    v_subrev_u32 v72, s52, v72
    v_mov_b32 v73, 159776
    v_add_u32 v74, 0, v72
    v_cmp_gt_u32 vcc, 16, v74
    v_add_u32 v74, 0, v71
    s_nop 0
    v_cndmask_b32 v204, v73, v74, vcc
    v_add_u32 v74, 1, v72
    v_cmp_gt_u32 vcc, 16, v74
    v_add_u32 v74, 8, v71
    s_nop 0
    v_cndmask_b32 v229, v73, v74, vcc
    v_add_u32 v74, 2, v72
    v_cmp_gt_u32 vcc, 16, v74
    v_add_u32 v74, 16, v71
    s_nop 0
    v_cndmask_b32 v230, v73, v74, vcc
    v_add_u32 v74, 3, v72
    v_cmp_gt_u32 vcc, 16, v74
    v_add_u32 v74, 24, v71
    s_nop 0
    v_cndmask_b32 v231, v73, v74, vcc
    v_add_u32 v74, 4, v72
    v_cmp_gt_u32 vcc, 16, v74
    v_add_u32 v74, 32, v71
    s_nop 0
    v_cndmask_b32 v255, v73, v74, vcc
    v_lshlrev_b32 v208, 3, v67
    v_add_u32 v208, 159808, v208
    v_add_u32 v69, s6, v65
    v_lshlrev_b32 v209, 3, v69
    v_add_u32 v209, 159748, v209
    v_and_b32 v70, 3, v0
    v_cmp_gt_u32 vcc, 1, v70
    v_mov_b32 v73, s47
    s_nop 0
    v_cndmask_b32 v207, 0, v73, vcc
    v_cmp_gt_u32 vcc, 3, v70
    s_nop 1
    v_cndmask_b32 v211, 0, v73, vcc
    v_cmp_gt_u32 vcc, 2, v70
    s_nop 1
    v_cndmask_b32 v211, v211, -1, vcc
    s_setpc_b64 s[98:99]
S_late2:
    s_lshl_b32 s7, s5, 12
    s_add_u32 s7, s7, 135184
    v_lshl_add_u32 v66, v0, 6, s7
    v_lshl_add_u32 v210, v65, 1, v66
    s_add_u32 s13, s6, s55
    v_add_u32 v212, s13, v65
    s_mul_i32 s8, s53, 6
    s_mul_i32 s9, s8, 34560
    s_add_u32 s9, s9, 1310720
    s_mul_i32 s0, s48, 34560
    s_add_u32 s0, s0, s9
    s_lshl_b32 s7, s51, 10
    s_add_u32 s12, s0, s7
    s_add_u32 s12, s12, 19456
    v_lshlrev_b32 v206, 4, v200
    v_lshl_add_u32 v206, v64, 8, v206
    v_xor_b32 v213, 256, v206
    v_lshl_add_u32 v213, v64, 11, v213
    s_cmp_lg_u32 s52, 0
    s_cselect_b32 s20, 0x0000ffff, 0
    s_cmp_lg_u32 s52, 4
    s_cselect_b32 s21, s47, 0
    s_lshl_b32 s7, s51, 11
    s_add_u32 s22, s0, s7
    s_add_u32 s100, s9, 33280
    s_lshr_b32 s7, s51, 1
    s_mul_i32 s7, s7, 33792
    s_mul_i32 s57, s51, 384
    s_add_u32 s7, s7, s57
    s_add_u32 s7, s7, 33792
    s_add_u32 s57, s7, s9
    s_mul_i32 s7, s48, 10
    s_add_u32 s7, s7, s51
    s_lshl_b32 s7, s7, 2
    s_add_u32 s23, s100, s7
    s_and_b32 s101, s48, 1
    s_lshr_b32 s56, s48, 1
    s_add_u32 s56, s56, 2
    s_cmp_lt_u32 s48, 4
    s_cselect_b32 s101, 0, s101
    s_cselect_b32 s56, s48, s56
    s_mul_i32 s1, s56, 34560
    s_add_u32 s1, s1, s9
    s_add_u32 s8, s8, s56
    s_mul_i32 s44, s53, 2560
    s_lshl_b32 s7, s51, 8
    s_add_u32 s44, s44, s7
    s_add_u32 s44, s44, 262144
    s_lshl_b32 s45, s53, 6
    s_add_u32 s45, s45, 196608
    s_setpc_b64 s[98:99]
S_late3:
    v_bfe_u32 v68, v0, 2, 2
    v_and_b32 v69, 3, v0
    v_lshl_add_u32 v70, v201, 3, v68
    s_lshl_b32 s7, s48, 4
    s_sub_u32 s7, s7, 16
    v_add_u32 v71, s7, v70
    v_and_b32 v72, 15, v71
    v_max_i32 v71, v71, v72
    v_mul_u32_u24 v71, 400, v71
    v_lshl_add_u32 v71, v69, 3, v71
    v_add_u32 v214, 97024, v71
    v_and_b32 v72, 1, v201
    v_lshl_add_u32 v71, v72, 1, v64
    v_lshlrev_b32 v71, 8, v71
    v_lshl_add_u32 v215, v200, 4, v71
    s_cmp_eq_u32 s48, 0
    s_cselect_b32 s7, 8, 0
    v_cmp_gt_u32 vcc, s7, v200
    s_nop 1
    v_cndmask_b32 v215, v215, 2.0, vcc
    v_cndmask_b32 v249, v202, 2.0, vcc
    v_lshrrev_b32 v71, 1, v68
    v_lshl_or_b32 v71, v72, 1, v71
    v_lshlrev_b32 v70, 7, v70
    v_lshl_add_u32 v70, v69, 3, v70
    s_mul_i32 s7, s101, 40960
    s_add_u32 s7, s7, 12288
    v_add_u32 v70, s7, v70
    v_xor_b32 v73, 0, v71
    v_lshl_add_u32 v216, v73, 5, v70
    v_add_u32 v220, 40960, v216
    v_xor_b32 v73, 1, v71
    v_lshl_add_u32 v217, v73, 5, v70
    v_add_u32 v221, 40960, v217
    v_xor_b32 v73, 2, v71
    v_lshl_add_u32 v218, v73, 5, v70
    v_add_u32 v222, 40960, v218
    v_xor_b32 v73, 3, v71
    v_lshl_add_u32 v219, v73, 5, v70
    v_add_u32 v223, 40960, v219
    s_setpc_b64 s[98:99]
S_late4:
    s_lshl_b32 s7, s56, 4
    v_add_u32 v73, s7, v200
    v_cmp_gt_u32 vcc, 10, v73
    v_add_u32 v73, s55, v73
    v_lshl_add_u32 v73, v73, 1, s50
    v_mul_u32_u24 v74, 1280, v73
    s_lshl_b32 s7, s51, 7
    v_lshl_add_u32 v75, v201, 3, s7
    v_add_u32 v74, v74, v75
    v_cndmask_b32 v253, v74, 2.0, vcc
    v_cndmask_b32 v254, v73, -1, vcc
    v_add_u32 v227, 161792, v75
    v_mul_u32_u24 v224, 61440, v201
    v_lshl_add_u32 v224, v200, 4, v224
    s_mov_b32 s7, 161024
    v_lshl_add_u32 v228, v201, 5, s7
    v_lshl_add_u32 v252, v69, 5, s7
    v_lshl_add_u32 v252, v68, 3, v252
    v_mul_u32_u24 v225, 24, v72
    v_add_u32 v225, v225, v253
    v_lshl_add_u32 v226, s8, 4, v200
    s_cmp_eq_u32 s101, 1
    s_cselect_b64 vcc, -1, 0
    v_cndmask_b32 v250, v225, 2.0, vcc
    v_mov_b32 v251, 160784
    s_lshl_b32 s7, s48, 12
    s_add_u32 s7, s7, 135168
    v_lshl_add_u32 v73, v200, 6, s7
    v_lshl_add_u32 v73, v201, 4, v73
    v_add_u32 v74, s52, v201
    s_add_u32 s46, s52, 0
    s_mul_i32 s46, s46, 52
    s_lshr_b32 s46, s46, 8
    v_lshl_add_u32 v172, s46, 10, v73
    s_add_u32 s46, s52, 3
    s_mul_i32 s46, s46, 52
    s_lshr_b32 s46, s46, 8
    v_lshl_add_u32 v173, s46, 10, v73
    s_mul_i32 s46, s46, 5
    s_sub_u32 s46, s46, 0
    v_cmp_le_i32 s[4:5], s46, v74
    s_add_u32 s46, s52, 4
    s_mul_i32 s46, s46, 52
    s_lshr_b32 s46, s46, 8
    v_lshl_add_u32 v174, s46, 10, v73
    s_add_u32 s46, s52, 7
    s_mul_i32 s46, s46, 52
    s_lshr_b32 s46, s46, 8
    v_lshl_add_u32 v175, s46, 10, v73
    s_mul_i32 s46, s46, 5
    s_sub_u32 s46, s46, 4
    v_cmp_le_i32 s[6:7], s46, v74
    s_add_u32 s46, s52, 8
    s_mul_i32 s46, s46, 52
    s_lshr_b32 s46, s46, 8
    v_lshl_add_u32 v176, s46, 10, v73
    s_add_u32 s46, s52, 11
    s_mul_i32 s46, s46, 52
    s_lshr_b32 s46, s46, 8
    v_lshl_add_u32 v177, s46, 10, v73
    s_mul_i32 s46, s46, 5
    s_sub_u32 s46, s46, 8
    v_cmp_le_i32 s[8:9], s46, v74
    s_add_u32 s46, s52, 12
    s_mul_i32 s46, s46, 52
    s_lshr_b32 s46, s46, 8
    v_lshl_add_u32 v178, s46, 10, v73
    s_add_u32 s46, s52, 15
    s_mul_i32 s46, s46, 52
    s_lshr_b32 s46, s46, 8
    v_lshl_add_u32 v179, s46, 10, v73
    s_mul_i32 s46, s46, 5
    s_sub_u32 s46, s46, 12
    v_cmp_le_i32 s[10:11], s46, v74
    s_setpc_b64 s[98:99]
A_cons:
    v_mov_b32 v99, 2.0
    v_lshrrev_b32 v3, 1, v1
    v_xor_b32 v3, v3, v2
    v_lshlrev_b32 v3, 4, v3
    v_lshl_add_u32 v4, v1, 7, v3
    v_xor_b32 v5, 64, v4
    v_cmp_eq_u32 vcc, 0, v1
    v_mov_b32 v3, 159744
    s_nop 0
    v_cndmask_b32 v6, v4, v3, vcc
    v_cndmask_b32 v7, v5, v3, vcc
    v_cndmask_b32 v8, 1, 0, vcc
    v_bfe_u32 v14, v0, 2, 2
    v_and_b32 v15, 3, v0
    v_lshrrev_b32 v16, 1, v14
    v_and_b32 v17, 1, v2
    v_lshl_or_b32 v16, v17, 1, v16
    v_xor_b32 v16, s48, v16
    v_lshlrev_b32 v16, 5, v16
    v_lshl_add_u32 v16, v15, 3, v16
    v_lshl_add_u32 v16, v14, 7, v16
    v_mul_u32_u24 v17, 3072, v2
    v_add_u32 v9, v16, v17
    v_mov_b32 v16, 0x3f803f80
    v_mov_b32 v17, v16
    v_mov_b32 v18, v16
    v_mov_b32 v19, v16
    ds_write_b128 v3, v[16:19]
    v_mov_b64 v[100:101], 0
    v_mov_b64 v[102:103], 0
    v_mov_b64 v[104:105], 0
    v_mov_b64 v[106:107], 0
    v_mov_b64 v[108:109], 0
    v_mov_b64 v[110:111], 0
    v_mov_b64 v[112:113], 0
    v_mov_b64 v[114:115], 0
    v_mov_b64 v[116:117], 0
    v_mov_b64 v[118:119], 0
    v_mov_b64 v[120:121], 0
    v_mov_b64 v[122:123], 0
    v_mov_b64 v[124:125], 0
    v_mov_b64 v[126:127], 0
    v_mov_b64 v[128:129], 0
    v_mov_b64 v[130:131], 0
    v_mov_b64 v[132:133], 0
    v_mov_b64 v[134:135], 0
    v_mov_b64 v[136:137], 0
    v_mov_b64 v[138:139], 0
    v_mov_b64 v[140:141], 0
    v_mov_b64 v[142:143], 0
    v_mov_b64 v[144:145], 0
    v_mov_b64 v[146:147], 0
    v_mov_b64 v[148:149], 0
    v_mov_b64 v[150:151], 0
    v_mov_b64 v[152:153], 0
    v_mov_b64 v[154:155], 0
    v_mov_b64 v[156:157], 0
    v_mov_b64 v[158:159], 0
    v_mov_b64 v[160:161], 0
    v_mov_b64 v[162:163], 0
    v_mov_b64 v[164:165], 0
    v_mov_b64 v[166:167], 0
    v_mov_b64 v[168:169], 0
    v_mov_b64 v[170:171], 0
    s_call_b64 s[98:99], S_late
    s_call_b64 s[98:99], S_late2
    s_call_b64 s[98:99], S_late3
    s_call_b64 s[98:99], S_late4
    s_waitcnt lgkmcnt(0)
    s_add_u32 s54, s54, 2654435761
    s_lshl_b32 s63, s53, 11
    s_add_u32 s63, s63, 81920
    v_mov_b32 v42, s54
    v_lshlrev_b32 v10, 4, v10
    s_cmp_lt_u32 s48, s65
    s_cbranch_scc0 A_nos
    s_waitcnt vmcnt(4)
    v_dot2_f32_bf16 v40, v20, v16, 0
    v_dot2_f32_bf16 v41, v20, v20, 0
    v_dot2_f32_bf16 v44, v21, v16, 0
    v_dot2_f32_bf16 v45, v21, v21, 0
    v_dot2_f32_bf16 v40, v22, v16, v40
    v_dot2_f32_bf16 v41, v22, v22, v41
    v_dot2_f32_bf16 v44, v23, v16, v44
    v_dot2_f32_bf16 v45, v23, v23, v45
    s_waitcnt vmcnt(3)
    v_dot2_f32_bf16 v40, v24, v16, v40
    v_dot2_f32_bf16 v41, v24, v24, v41
    v_dot2_f32_bf16 v44, v25, v16, v44
    v_dot2_f32_bf16 v45, v25, v25, v45
    v_dot2_f32_bf16 v40, v26, v16, v40
    v_dot2_f32_bf16 v41, v26, v26, v41
    v_dot2_f32_bf16 v44, v27, v16, v44
    v_dot2_f32_bf16 v45, v27, v27, v45
    s_waitcnt vmcnt(2)
    v_dot2_f32_bf16 v40, v28, v16, v40
    v_dot2_f32_bf16 v41, v28, v28, v41
    v_dot2_f32_bf16 v44, v29, v16, v44
    v_dot2_f32_bf16 v45, v29, v29, v45
    v_dot2_f32_bf16 v40, v30, v16, v40
    v_dot2_f32_bf16 v41, v30, v30, v41
    v_dot2_f32_bf16 v44, v31, v16, v44
    v_dot2_f32_bf16 v45, v31, v31, v45
    s_waitcnt vmcnt(1)
    v_dot2_f32_bf16 v40, v32, v16, v40
    v_dot2_f32_bf16 v41, v32, v32, v41
    v_dot2_f32_bf16 v44, v33, v16, v44
    v_dot2_f32_bf16 v45, v33, v33, v45
    v_dot2_f32_bf16 v40, v34, v16, v40
    v_dot2_f32_bf16 v41, v34, v34, v41
    v_dot2_f32_bf16 v44, v35, v16, v44
    v_dot2_f32_bf16 v45, v35, v35, v45
    s_waitcnt vmcnt(0)
    v_dot2_f32_bf16 v40, v36, v16, v40
    v_dot2_f32_bf16 v41, v36, v36, v41
    v_dot2_f32_bf16 v44, v37, v16, v44
    v_dot2_f32_bf16 v45, v37, v37, v45
    v_dot2_f32_bf16 v40, v38, v16, v40
    v_dot2_f32_bf16 v41, v38, v38, v41
    v_dot2_f32_bf16 v44, v39, v16, v44
    v_dot2_f32_bf16 v45, v39, v39, v45
A_red:
    s_nop 1
    v_add_f32 v40, v40, v44
    v_add_f32 v41, v41, v45
    s_nop 0
    v_add_f32_dpp v40, v40, v40 row_ror:1 row_mask:0xf bank_mask:0xf
    v_add_f32_dpp v41, v41, v41 row_ror:1 row_mask:0xf bank_mask:0xf
    s_nop 0
    v_add_f32_dpp v40, v40, v40 row_ror:2 row_mask:0xf bank_mask:0xf
    v_add_f32_dpp v41, v41, v41 row_ror:2 row_mask:0xf bank_mask:0xf
    s_nop 0
    v_add_f32_dpp v40, v40, v40 row_ror:4 row_mask:0xf bank_mask:0xf
    v_add_f32_dpp v41, v41, v41 row_ror:4 row_mask:0xf bank_mask:0xf
    s_nop 0
    v_add_f32_dpp v40, v40, v40 row_ror:8 row_mask:0xf bank_mask:0xf
    v_add_f32_dpp v41, v41, v41 row_ror:8 row_mask:0xf bank_mask:0xf
    s_cselect_b32 s64, s63, 1245184
    s_cbranch_scc0 A_nln
    v_mul_f32 v40, 0x3acccccd, v40
    v_mul_f32 v41, 0x3acccccd, v41
    v_fma_f32 v41, -v40, v40, v41
    v_max_f32 v41, 0, v41
    v_cvt_pk_bf16_f32 v41, v41, v41
    v_and_b32 v41, 0xffff0000, v41
    v_add_f32 v41, 0x3727c5ac, v41
    v_cvt_pk_bf16_f32 v41, v41, v41
    v_and_b32 v41, 0xffff0000, v41
    v_sqrt_f32 v41, v41
    v_cvt_pk_bf16_f32 v40, v40, v40
    v_and_b32 v40, 0xffff0000, v40
    v_cvt_pk_bf16_f32 v41, v41, v41
    v_and_b32 v41, 0xffff0000, v41
    v_rcp_f32 v41, v41
A_nln:
    s_mov_b32 exec_lo, 0x00010001
    s_mov_b32 exec_hi, 0x00010001
    buffer_store_dwordx3 v[40:42], v10, s[24:27], s64 offen sc1
    s_mov_b64 exec, -1
A_w3:
    s_cmp_lg_u32 s48, 3
    s_cbranch_scc1 A_go
    s_getreg_b32 s61, hwreg(HW_REG_XCC_ID)
    s_lshl_b32 s64, s51, 4
    s_add_u32 s64, s64, 1536
    v_mov_b32 v44, s61
    v_mov_b32 v43, s64
    v_mov_b32 v46, s54
    s_mov_b64 exec, 1
    buffer_store_dwordx3 v[44:46], v43, s[24:27], s63 offen sc1
    s_mov_b64 exec, -1
    v_add_u32 v58, 161792, v58
    v_add_u32 v59, 161792, v59
    s_cmp_lt_u32 s62, 640
    s_cbranch_scc1 A_w3l
    s_waitcnt vmcnt(1)
A_w3l:
    ds_write_b128 v58, v[48:51]
    ds_write_b32 v59, v52 offset:1024
    v_dot2_f32_bf16 v25, v48, v16, 0
    v_dot2_f32_bf16 v25, v49, v16, v25
    v_dot2_f32_bf16 v25, v50, v16, v25
    v_dot2_f32_bf16 v25, v51, v16, v25
    v_dot2_f32_bf16 v25, v52, v16, v25
    s_nop 2
    v_add_f32_dpp v25, v25, v25 row_ror:1 row_mask:0xf bank_mask:0xf
    s_nop 1
    v_add_f32_dpp v25, v25, v25 row_ror:2 row_mask:0xf bank_mask:0xf
    s_nop 1
    v_add_f32_dpp v25, v25, v25 row_ror:4 row_mask:0xf bank_mask:0xf
    s_nop 1
    v_add_f32_dpp v25, v25, v25 row_ror:8 row_mask:0xf bank_mask:0xf
    v_mov_b32 v26, v25
    s_nop 1
    v_permlane32_swap_b32 v25, v26
    v_add_f32 v25, v25, v26
    v_mov_b32 v26, v25
    s_nop 1
    v_permlane16_swap_b32 v25, v26
    v_add_f32 v25, v25, v26
    v_mov_b32 v58, 161792
    ds_write_b32 v58, v25 offset:1280
    s_waitcnt lgkmcnt(0)
    s_branch A_go
A_nos:
    s_cmp_ge_u32 s62, 640
    s_cbranch_scc1 A_w3
    s_waitcnt vmcnt(4)
    v_dot2_f32_bf16 v40, v20, v16, 0
    v_dot2_f32_bf16 v41, v20, v76, 0
    v_dot2_f32_bf16 v44, v21, v16, 0
    v_dot2_f32_bf16 v45, v21, v77, 0
    v_dot2_f32_bf16 v40, v22, v16, v40
    v_dot2_f32_bf16 v41, v22, v78, v41
    v_dot2_f32_bf16 v44, v23, v16, v44
    v_dot2_f32_bf16 v45, v23, v79, v45
    s_waitcnt vmcnt(3)
    v_dot2_f32_bf16 v40, v24, v16, v40
    v_dot2_f32_bf16 v41, v24, v80, v41
    v_dot2_f32_bf16 v44, v25, v16, v44
    v_dot2_f32_bf16 v45, v25, v81, v45
    v_dot2_f32_bf16 v40, v26, v16, v40
    v_dot2_f32_bf16 v41, v26, v82, v41
    v_dot2_f32_bf16 v44, v27, v16, v44
    v_dot2_f32_bf16 v45, v27, v83, v45
    s_waitcnt vmcnt(2)
    v_dot2_f32_bf16 v40, v28, v16, v40
    v_dot2_f32_bf16 v41, v28, v84, v41
    v_dot2_f32_bf16 v44, v29, v16, v44
    v_dot2_f32_bf16 v45, v29, v85, v45
    v_dot2_f32_bf16 v40, v30, v16, v40
    v_dot2_f32_bf16 v41, v30, v86, v41
    v_dot2_f32_bf16 v44, v31, v16, v44
    v_dot2_f32_bf16 v45, v31, v87, v45
    s_waitcnt vmcnt(1)
    v_dot2_f32_bf16 v40, v32, v16, v40
    v_dot2_f32_bf16 v41, v32, v88, v41
    v_dot2_f32_bf16 v44, v33, v16, v44
    v_dot2_f32_bf16 v45, v33, v89, v45
    v_dot2_f32_bf16 v40, v34, v16, v40
    v_dot2_f32_bf16 v41, v34, v90, v41
    v_dot2_f32_bf16 v44, v35, v16, v44
    v_dot2_f32_bf16 v45, v35, v91, v45
    s_waitcnt vmcnt(0)
    v_dot2_f32_bf16 v40, v36, v16, v40
    v_dot2_f32_bf16 v41, v36, v92, v41
    v_dot2_f32_bf16 v44, v37, v16, v44
    v_dot2_f32_bf16 v45, v37, v93, v45
    v_dot2_f32_bf16 v40, v38, v16, v40
    v_dot2_f32_bf16 v41, v38, v94, v41
    v_dot2_f32_bf16 v44, v39, v16, v44
    v_dot2_f32_bf16 v45, v39, v95, v45
    s_branch A_red
A_go:
    v_lshlrev_b32 v15, 3, v1
    v_add_u32 v15, 159808, v15
    v_mul_u32_u24 v16, 400, v1
    v_lshl_add_u32 v16, v2, 3, v16
    s_lshl_b32 s60, s48, 5
    s_add_u32 s60, s60, 96768
    v_add_u32 v16, s60, v16
    v_mov_b32 v17, 160768
    s_mov_b32 s60, 0
    v_add_u32 v14, s60, v9
    v_mad_u32_u24 v10, v8, s60, v6
    v_add_u32 v12, s60, v4
    v_mad_u32_u24 v11, v8, s60, v7
    v_add_u32 v13, s60, v5
    s_mov_b32 s61, 0
    s_barrier
    ds_read_b64_tr_b16 v[44:45], v14 offset:12288
    ds_read_b64_tr_b16 v[46:47], v14 offset:12800
    ds_read_b64_tr_b16 v[48:49], v14 offset:13312
    ds_read_b64_tr_b16 v[50:51], v14 offset:13824
    ds_read_b64_tr_b16 v[52:53], v14 offset:14336
    ds_read_b64_tr_b16 v[54:55], v14 offset:14848
    ds_read_b128 v[20:23], v10
    ds_read_b128 v[24:27], v12 offset:2048
    ds_read_b128 v[28:31], v12 offset:4096
    ds_read_b128 v[32:35], v12 offset:6144
    ds_read_b128 v[36:39], v12 offset:8192
    ds_read_b128 v[40:43], v12 offset:10240
A_loop:
    s_waitcnt lgkmcnt(0)
    v_mfma_f32_16x16x32_bf16 v[100:103], v[44:47], v[20:23], v[100:103]
    ds_read_b64_tr_b16 v[80:81], v14 offset:24576
    v_mfma_f32_16x16x32_bf16 v[104:107], v[48:51], v[20:23], v[104:107]
    ds_read_b64_tr_b16 v[82:83], v14 offset:25088
    v_mfma_f32_16x16x32_bf16 v[108:111], v[52:55], v[20:23], v[108:111]
    ds_read_b64_tr_b16 v[84:85], v14 offset:25600
    v_mfma_f32_16x16x32_bf16 v[112:115], v[44:47], v[24:27], v[112:115]
    ds_read_b64_tr_b16 v[86:87], v14 offset:26112
    v_mfma_f32_16x16x32_bf16 v[116:119], v[48:51], v[24:27], v[116:119]
    ds_read_b64_tr_b16 v[88:89], v14 offset:26624
    v_mfma_f32_16x16x32_bf16 v[120:123], v[52:55], v[24:27], v[120:123]
    ds_read_b64_tr_b16 v[90:91], v14 offset:27136
    v_mfma_f32_16x16x32_bf16 v[124:127], v[44:47], v[28:31], v[124:127]
    ds_read_b128 v[56:59], v11
    v_mfma_f32_16x16x32_bf16 v[128:131], v[48:51], v[28:31], v[128:131]
    ds_read_b128 v[60:63], v13 offset:2048
    v_mfma_f32_16x16x32_bf16 v[132:135], v[52:55], v[28:31], v[132:135]
    ds_read_b128 v[64:67], v13 offset:4096
    v_mfma_f32_16x16x32_bf16 v[136:139], v[44:47], v[32:35], v[136:139]
    ds_read_b128 v[68:71], v13 offset:6144
    v_mfma_f32_16x16x32_bf16 v[140:143], v[48:51], v[32:35], v[140:143]
    ds_read_b128 v[72:75], v13 offset:8192
    v_mfma_f32_16x16x32_bf16 v[144:147], v[52:55], v[32:35], v[144:147]
    ds_read_b128 v[76:79], v13 offset:10240
    v_mfma_f32_16x16x32_bf16 v[148:151], v[44:47], v[36:39], v[148:151]
    s_add_u32 s60, s60, 36864
    v_mfma_f32_16x16x32_bf16 v[152:155], v[48:51], v[36:39], v[152:155]
    s_add_u32 s61, s61, 1
    v_mfma_f32_16x16x32_bf16 v[156:159], v[52:55], v[36:39], v[156:159]
    s_cmp_eq_u32 s60, 110592
    v_mfma_f32_16x16x32_bf16 v[160:163], v[44:47], v[40:43], v[160:163]
    s_cselect_b32 s60, 0, s60
    v_mfma_f32_16x16x32_bf16 v[164:167], v[48:51], v[40:43], v[164:167]
    s_cmp_eq_u32 s61, 10
    v_mfma_f32_16x16x32_bf16 v[168:171], v[52:55], v[40:43], v[168:171]
    s_waitcnt lgkmcnt(0)
    s_cbranch_scc1 A_tail
    v_mfma_f32_16x16x32_bf16 v[100:103], v[80:83], v[56:59], v[100:103]
    v_add_u32 v14, s60, v9
    v_mfma_f32_16x16x32_bf16 v[104:107], v[84:87], v[56:59], v[104:107]
    v_mad_u32_u24 v10, v8, s60, v6
    v_mfma_f32_16x16x32_bf16 v[108:111], v[88:91], v[56:59], v[108:111]
    v_add_u32 v12, s60, v4
    v_mfma_f32_16x16x32_bf16 v[112:115], v[80:83], v[60:63], v[112:115]
    v_mad_u32_u24 v11, v8, s60, v7
    v_mfma_f32_16x16x32_bf16 v[116:119], v[84:87], v[60:63], v[116:119]
    v_add_u32 v13, s60, v5
    v_mfma_f32_16x16x32_bf16 v[120:123], v[88:91], v[60:63], v[120:123]
    s_barrier
    v_mfma_f32_16x16x32_bf16 v[124:127], v[80:83], v[64:67], v[124:127]
    ds_read_b64_tr_b16 v[44:45], v14 offset:12288
    ds_read_b64_tr_b16 v[46:47], v14 offset:12800
    v_mfma_f32_16x16x32_bf16 v[128:131], v[84:87], v[64:67], v[128:131]
    ds_read_b64_tr_b16 v[48:49], v14 offset:13312
    ds_read_b64_tr_b16 v[50:51], v14 offset:13824
    v_mfma_f32_16x16x32_bf16 v[132:135], v[88:91], v[64:67], v[132:135]
    ds_read_b64_tr_b16 v[52:53], v14 offset:14336
    ds_read_b64_tr_b16 v[54:55], v14 offset:14848
    v_mfma_f32_16x16x32_bf16 v[136:139], v[80:83], v[68:71], v[136:139]
    ds_read_b128 v[20:23], v10
    ds_read_b128 v[24:27], v12 offset:2048
    v_mfma_f32_16x16x32_bf16 v[140:143], v[84:87], v[68:71], v[140:143]
    ds_read_b128 v[28:31], v12 offset:4096
    ds_read_b128 v[32:35], v12 offset:6144
    v_mfma_f32_16x16x32_bf16 v[144:147], v[88:91], v[68:71], v[144:147]
    ds_read_b128 v[36:39], v12 offset:8192
    ds_read_b128 v[40:43], v12 offset:10240
    v_mfma_f32_16x16x32_bf16 v[148:151], v[80:83], v[72:75], v[148:151]
    v_mfma_f32_16x16x32_bf16 v[152:155], v[84:87], v[72:75], v[152:155]
    v_mfma_f32_16x16x32_bf16 v[156:159], v[88:91], v[72:75], v[156:159]
    v_mfma_f32_16x16x32_bf16 v[160:163], v[80:83], v[76:79], v[160:163]
    v_mfma_f32_16x16x32_bf16 v[164:167], v[84:87], v[76:79], v[164:167]
    v_mfma_f32_16x16x32_bf16 v[168:171], v[88:91], v[76:79], v[168:171]
    s_branch A_loop
A_tail:
    v_mfma_f32_16x16x32_bf16 v[100:103], v[80:83], v[56:59], v[100:103]
    v_mfma_f32_16x16x32_bf16 v[104:107], v[84:87], v[56:59], v[104:107]
    v_mfma_f32_16x16x32_bf16 v[108:111], v[88:91], v[56:59], v[108:111]
    ds_read_b64 v[32:33], v15 offset:0
    v_mfma_f32_16x16x32_bf16 v[112:115], v[80:83], v[60:63], v[112:115]
    ds_read_b64 v[34:35], v15 offset:128
    v_mfma_f32_16x16x32_bf16 v[116:119], v[84:87], v[60:63], v[116:119]
    ds_read_b64 v[36:37], v15 offset:256
    v_mfma_f32_16x16x32_bf16 v[120:123], v[88:91], v[60:63], v[120:123]
    ds_read_b64 v[38:39], v15 offset:384
    v_mfma_f32_16x16x32_bf16 v[124:127], v[80:83], v[64:67], v[124:127]
    ds_read_b64 v[40:41], v15 offset:512
    v_mfma_f32_16x16x32_bf16 v[128:131], v[84:87], v[64:67], v[128:131]
    ds_read_b64 v[42:43], v15 offset:640
    v_mfma_f32_16x16x32_bf16 v[132:135], v[88:91], v[64:67], v[132:135]
    ds_read_b32 v17, v17
    v_mfma_f32_16x16x32_bf16 v[136:139], v[80:83], v[68:71], v[136:139]
    v_mov_b32_dpp v20, v100 row_newbcast:0 row_mask:0xf bank_mask:0xf
    v_mov_b32_dpp v21, v101 row_newbcast:0 row_mask:0xf bank_mask:0xf
    v_mfma_f32_16x16x32_bf16 v[140:143], v[84:87], v[68:71], v[140:143]
    v_mov_b32_dpp v22, v102 row_newbcast:0 row_mask:0xf bank_mask:0xf
    v_mov_b32_dpp v23, v103 row_newbcast:0 row_mask:0xf bank_mask:0xf
    v_mfma_f32_16x16x32_bf16 v[144:147], v[88:91], v[68:71], v[144:147]
    v_mov_b32_dpp v24, v104 row_newbcast:0 row_mask:0xf bank_mask:0xf
    v_mov_b32_dpp v25, v105 row_newbcast:0 row_mask:0xf bank_mask:0xf
    v_mfma_f32_16x16x32_bf16 v[148:151], v[80:83], v[72:75], v[148:151]
    v_mov_b32_dpp v26, v106 row_newbcast:0 row_mask:0xf bank_mask:0xf
    v_mov_b32_dpp v27, v107 row_newbcast:0 row_mask:0xf bank_mask:0xf
    v_mfma_f32_16x16x32_bf16 v[152:155], v[84:87], v[72:75], v[152:155]
    v_mov_b32_dpp v28, v108 row_newbcast:0 row_mask:0xf bank_mask:0xf
    v_mov_b32_dpp v29, v109 row_newbcast:0 row_mask:0xf bank_mask:0xf
    v_mfma_f32_16x16x32_bf16 v[156:159], v[88:91], v[72:75], v[156:159]
    v_mov_b32_dpp v30, v110 row_newbcast:0 row_mask:0xf bank_mask:0xf
    v_mov_b32_dpp v31, v111 row_newbcast:0 row_mask:0xf bank_mask:0xf
    s_waitcnt lgkmcnt(0)
    v_mfma_f32_16x16x32_bf16 v[160:163], v[80:83], v[76:79], v[160:163]
    v_pk_fma_f32 v[100:101], v[32:33], v[20:21], v[100:101] op_sel_hi:[0,1,1] neg_lo:[1,0,0] neg_hi:[1,0,0]
    v_pk_fma_f32 v[102:103], v[32:33], v[22:23], v[102:103] op_sel_hi:[0,1,1] neg_lo:[1,0,0] neg_hi:[1,0,0]
    v_mfma_f32_16x16x32_bf16 v[164:167], v[84:87], v[76:79], v[164:167]
    v_pk_fma_f32 v[104:105], v[32:33], v[24:25], v[104:105] op_sel_hi:[0,1,1] neg_lo:[1,0,0] neg_hi:[1,0,0]
    v_pk_fma_f32 v[106:107], v[32:33], v[26:27], v[106:107] op_sel_hi:[0,1,1] neg_lo:[1,0,0] neg_hi:[1,0,0]
    v_mfma_f32_16x16x32_bf16 v[168:171], v[88:91], v[76:79], v[168:171]
    v_pk_fma_f32 v[108:109], v[32:33], v[28:29], v[108:109] op_sel_hi:[0,1,1] neg_lo:[1,0,0] neg_hi:[1,0,0]
    v_pk_fma_f32 v[110:111], v[32:33], v[30:31], v[110:111] op_sel_hi:[0,1,1] neg_lo:[1,0,0] neg_hi:[1,0,0]
    v_cvt_pk_bf16_f32 v100, v100, v101
    v_cvt_pk_bf16_f32 v101, v102, v103
    ds_write_b64 v16, v[100:101] offset:0
    v_cvt_pk_bf16_f32 v104, v104, v105
    v_cvt_pk_bf16_f32 v105, v106, v107
    ds_write_b64 v16, v[104:105] offset:128
    v_cvt_pk_bf16_f32 v108, v108, v109
    v_cvt_pk_bf16_f32 v109, v110, v111
    ds_write_b64 v16, v[108:109] offset:256
    v_readfirstlane_b32 s49, v17
    v_pk_fma_f32 v[112:113], v[34:35], v[20:21], v[112:113] op_sel_hi:[0,1,1] neg_lo:[1,0,0] neg_hi:[1,0,0]
    v_pk_fma_f32 v[114:115], v[34:35], v[22:23], v[114:115] op_sel_hi:[0,1,1] neg_lo:[1,0,0] neg_hi:[1,0,0]
    v_pk_fma_f32 v[116:117], v[34:35], v[24:25], v[116:117] op_sel_hi:[0,1,1] neg_lo:[1,0,0] neg_hi:[1,0,0]
    v_pk_fma_f32 v[118:119], v[34:35], v[26:27], v[118:119] op_sel_hi:[0,1,1] neg_lo:[1,0,0] neg_hi:[1,0,0]
    v_pk_fma_f32 v[120:121], v[34:35], v[28:29], v[120:121] op_sel_hi:[0,1,1] neg_lo:[1,0,0] neg_hi:[1,0,0]
    v_pk_fma_f32 v[122:123], v[34:35], v[30:31], v[122:123] op_sel_hi:[0,1,1] neg_lo:[1,0,0] neg_hi:[1,0,0]
    v_cvt_pk_bf16_f32 v112, v112, v113
    v_cvt_pk_bf16_f32 v113, v114, v115
    ds_write_b64 v16, v[112:113] offset:6400
    v_cvt_pk_bf16_f32 v116, v116, v117
    v_cvt_pk_bf16_f32 v117, v118, v119
    ds_write_b64 v16, v[116:117] offset:6528
    v_cvt_pk_bf16_f32 v120, v120, v121
    v_cvt_pk_bf16_f32 v121, v122, v123
    ds_write_b64 v16, v[120:121] offset:6656
    v_pk_fma_f32 v[124:125], v[36:37], v[20:21], v[124:125] op_sel_hi:[0,1,1] neg_lo:[1,0,0] neg_hi:[1,0,0]
    v_pk_fma_f32 v[126:127], v[36:37], v[22:23], v[126:127] op_sel_hi:[0,1,1] neg_lo:[1,0,0] neg_hi:[1,0,0]
    v_pk_fma_f32 v[128:129], v[36:37], v[24:25], v[128:129] op_sel_hi:[0,1,1] neg_lo:[1,0,0] neg_hi:[1,0,0]
    v_pk_fma_f32 v[130:131], v[36:37], v[26:27], v[130:131] op_sel_hi:[0,1,1] neg_lo:[1,0,0] neg_hi:[1,0,0]
    v_pk_fma_f32 v[132:133], v[36:37], v[28:29], v[132:133] op_sel_hi:[0,1,1] neg_lo:[1,0,0] neg_hi:[1,0,0]
    v_pk_fma_f32 v[134:135], v[36:37], v[30:31], v[134:135] op_sel_hi:[0,1,1] neg_lo:[1,0,0] neg_hi:[1,0,0]
    v_cvt_pk_bf16_f32 v124, v124, v125
    v_cvt_pk_bf16_f32 v125, v126, v127
    ds_write_b64 v16, v[124:125] offset:12800
    v_cvt_pk_bf16_f32 v128, v128, v129
    v_cvt_pk_bf16_f32 v129, v130, v131
    ds_write_b64 v16, v[128:129] offset:12928
    v_cvt_pk_bf16_f32 v132, v132, v133
    v_cvt_pk_bf16_f32 v133, v134, v135
    ds_write_b64 v16, v[132:133] offset:13056
    v_pk_fma_f32 v[136:137], v[38:39], v[20:21], v[136:137] op_sel_hi:[0,1,1] neg_lo:[1,0,0] neg_hi:[1,0,0]
    v_pk_fma_f32 v[138:139], v[38:39], v[22:23], v[138:139] op_sel_hi:[0,1,1] neg_lo:[1,0,0] neg_hi:[1,0,0]
    v_pk_fma_f32 v[140:141], v[38:39], v[24:25], v[140:141] op_sel_hi:[0,1,1] neg_lo:[1,0,0] neg_hi:[1,0,0]
    v_pk_fma_f32 v[142:143], v[38:39], v[26:27], v[142:143] op_sel_hi:[0,1,1] neg_lo:[1,0,0] neg_hi:[1,0,0]
    v_pk_fma_f32 v[144:145], v[38:39], v[28:29], v[144:145] op_sel_hi:[0,1,1] neg_lo:[1,0,0] neg_hi:[1,0,0]
    v_pk_fma_f32 v[146:147], v[38:39], v[30:31], v[146:147] op_sel_hi:[0,1,1] neg_lo:[1,0,0] neg_hi:[1,0,0]
    v_cvt_pk_bf16_f32 v136, v136, v137
    v_cvt_pk_bf16_f32 v137, v138, v139
    ds_write_b64 v16, v[136:137] offset:19200
    v_cvt_pk_bf16_f32 v140, v140, v141
    v_cvt_pk_bf16_f32 v141, v142, v143
    ds_write_b64 v16, v[140:141] offset:19328
    v_cvt_pk_bf16_f32 v144, v144, v145
    v_cvt_pk_bf16_f32 v145, v146, v147
    ds_write_b64 v16, v[144:145] offset:19456
    v_pk_fma_f32 v[148:149], v[40:41], v[20:21], v[148:149] op_sel_hi:[0,1,1] neg_lo:[1,0,0] neg_hi:[1,0,0]
    v_pk_fma_f32 v[150:151], v[40:41], v[22:23], v[150:151] op_sel_hi:[0,1,1] neg_lo:[1,0,0] neg_hi:[1,0,0]
    v_pk_fma_f32 v[152:153], v[40:41], v[24:25], v[152:153] op_sel_hi:[0,1,1] neg_lo:[1,0,0] neg_hi:[1,0,0]
    v_pk_fma_f32 v[154:155], v[40:41], v[26:27], v[154:155] op_sel_hi:[0,1,1] neg_lo:[1,0,0] neg_hi:[1,0,0]
    v_pk_fma_f32 v[156:157], v[40:41], v[28:29], v[156:157] op_sel_hi:[0,1,1] neg_lo:[1,0,0] neg_hi:[1,0,0]
    v_pk_fma_f32 v[158:159], v[40:41], v[30:31], v[158:159] op_sel_hi:[0,1,1] neg_lo:[1,0,0] neg_hi:[1,0,0]
    v_cvt_pk_bf16_f32 v148, v148, v149
    v_cvt_pk_bf16_f32 v149, v150, v151
    ds_write_b64 v16, v[148:149] offset:25600
    v_cvt_pk_bf16_f32 v152, v152, v153
    v_cvt_pk_bf16_f32 v153, v154, v155
    ds_write_b64 v16, v[152:153] offset:25728
    v_cvt_pk_bf16_f32 v156, v156, v157
    v_cvt_pk_bf16_f32 v157, v158, v159
    ds_write_b64 v16, v[156:157] offset:25856
    v_pk_fma_f32 v[160:161], v[42:43], v[20:21], v[160:161] op_sel_hi:[0,1,1] neg_lo:[1,0,0] neg_hi:[1,0,0]
    v_pk_fma_f32 v[162:163], v[42:43], v[22:23], v[162:163] op_sel_hi:[0,1,1] neg_lo:[1,0,0] neg_hi:[1,0,0]
    v_pk_fma_f32 v[164:165], v[42:43], v[24:25], v[164:165] op_sel_hi:[0,1,1] neg_lo:[1,0,0] neg_hi:[1,0,0]
    v_pk_fma_f32 v[166:167], v[42:43], v[26:27], v[166:167] op_sel_hi:[0,1,1] neg_lo:[1,0,0] neg_hi:[1,0,0]
    v_pk_fma_f32 v[168:169], v[42:43], v[28:29], v[168:169] op_sel_hi:[0,1,1] neg_lo:[1,0,0] neg_hi:[1,0,0]
    v_pk_fma_f32 v[170:171], v[42:43], v[30:31], v[170:171] op_sel_hi:[0,1,1] neg_lo:[1,0,0] neg_hi:[1,0,0]
    v_cvt_pk_bf16_f32 v160, v160, v161
    v_cvt_pk_bf16_f32 v161, v162, v163
    ds_write_b64 v16, v[160:161] offset:32000
    v_cvt_pk_bf16_f32 v164, v164, v165
    v_cvt_pk_bf16_f32 v165, v166, v167
    ds_write_b64 v16, v[164:165] offset:32128
    v_cvt_pk_bf16_f32 v168, v168, v169
    v_cvt_pk_bf16_f32 v169, v170, v171
    ds_write_b64 v16, v[168:169] offset:32256
AT_start:
HA0_0:
    s_cbranch_execz HA0_1
    s_cmp_lt_u32 s48, 4
    s_cbranch_scc1 AT_np
    s_setprio 2
AT_np:
    ds_read_b32 v16, v208 offset:4
    ds_read2_b32 v[4:5], v209 offset0:0 offset1:2
HA0_1:
    s_cbranch_execz HA0_2
    ds_read2_b32 v[6:7], v209 offset0:4 offset1:6
    ds_read2_b32 v[8:9], v209 offset0:8 offset1:10
    ds_read2_b32 v[10:11], v209 offset0:12 offset1:14
    ds_read2_b32 v[12:13], v209 offset0:16 offset1:18
    ds_read2_b32 v[14:15], v209 offset0:20 offset1:22
    s_mov_b32 s60, 0x07060503
    s_mov_b32 s61, 0x07060502
    s_mov_b32 s62, 0x07060501
    s_mov_b32 s63, 0x04000c0c
    s_mov_b32 s64, 0x0706000c
    s_mov_b32 s66, 0x11111111
    s_mov_b32 s67, s66
    s_mov_b32 s68, 0x33333333
    s_mov_b32 s69, s68
    s_mov_b32 s70, 0x77777777
    s_mov_b32 s71, s70
    v_mov_b32 v79, s54
    v_mov_b32 v83, s54
    v_mov_b32 v87, s54
    v_mov_b32 v88, 0
    v_mov_b32 v89, 0
    v_mov_b32 v90, 0
    v_mov_b32 v92, 0
    v_mov_b32 v93, 0
    v_mov_b32 v94, 0
    s_waitcnt lgkmcnt(0)
    s_barrier
    s_cmp_lt_u32 s48, 6
    s_cbranch_scc1 AT_qk
    s_lshl_b32 s65, s48, 10
    s_add_u32 s65, s65, 8192
    v_subrev_u32 v98, 20480, v99
    s_add_u32 m0, s65, 0
    s_mov_b32 s66, 0
    buffer_load_dwordx4 v99, s[36:39], s66 offen lds
    s_add_u32 m0, s65, -2048
    s_nop 0
    buffer_load_dwordx4 v98, s[36:39], s66 offen lds
    s_add_u32 m0, s65, 4096
    s_mov_b32 s66, 40960
    buffer_load_dwordx4 v99, s[36:39], s66 offen lds
HA0_2:
    s_cbranch_execz HA0_3
    s_add_u32 m0, s65, 2048
    s_nop 0
    buffer_load_dwordx4 v98, s[36:39], s66 offen lds
    s_add_u32 m0, s65, 8192
    s_mov_b32 s66, 81920
    buffer_load_dwordx4 v99, s[36:39], s66 offen lds
    s_add_u32 m0, s65, 6144
    s_nop 0
    buffer_load_dwordx4 v98, s[36:39], s66 offen lds
    s_add_u32 m0, s65, 12288
    s_mov_b32 s66, 122880
    buffer_load_dwordx4 v99, s[36:39], s66 offen lds
    s_add_u32 m0, s65, 10240
    s_nop 0
    buffer_load_dwordx4 v98, s[36:39], s66 offen lds
    s_add_u32 m0, s65, 16384
    s_mov_b32 s66, 163840
    buffer_load_dwordx4 v99, s[36:39], s66 offen lds
    s_add_u32 m0, s65, 14336
    s_nop 0
    buffer_load_dwordx4 v98, s[36:39], s66 offen lds
    s_add_u32 m0, s65, 20480
    s_mov_b32 s66, 204800
    buffer_load_dwordx4 v99, s[36:39], s66 offen lds
    s_add_u32 m0, s65, 18432
    s_nop 0
    buffer_load_dwordx4 v98, s[36:39], s66 offen lds
    buffer_load_dwordx4 v[232:235], v250, s[28:31], 0 offen offset:0
    buffer_load_dwordx4 v[236:239], v250, s[28:31], 0 offen offset:64
    ds_read_b64 v[240:241], v227 offset:0
    ds_read_b64 v[242:243], v227 offset:32
    ds_read_b64 v[244:245], v227 offset:64
    ds_read_b64 v[246:247], v227 offset:96
    ds_read_b32 v248, v251 offset:2288
HA0_3:
    s_cbranch_execz HA0_4
    s_waitcnt vmcnt(0)
    v_mov_b32 v19, 1
    s_mov_b64 exec, 1
    ds_add_u32 v251, v19
    s_mov_b64 exec, -1
    s_branch B_start
AT_qk:
    ds_read_b64 v[20:21], v204
    ds_read_b64 v[30:31], v205 offset:0
    ds_read_b64 v[40:41], v205 offset:1600
    ds_read_b64 v[50:51], v205 offset:3200
    ds_read_b64 v[22:23], v229
    ds_read_b64 v[32:33], v205 offset:8
    ds_read_b64 v[42:43], v205 offset:1608
    ds_read_b64 v[52:53], v205 offset:3208
    ds_read_b64 v[24:25], v230
    ds_read_b64 v[34:35], v205 offset:16
    ds_read_b64 v[44:45], v205 offset:1616
    ds_read_b64 v[54:55], v205 offset:3216
    ds_read_b64 v[26:27], v231
    ds_read_b64 v[36:37], v205 offset:24
    ds_read_b64 v[46:47], v205 offset:1624
    ds_read_b64 v[56:57], v205 offset:3224
    ds_read_b64 v[28:29], v255
    ds_read_b64 v[38:39], v205 offset:32
    ds_read_b64 v[48:49], v205 offset:1632
    ds_read_b64 v[58:59], v205 offset:3232
    v_cndmask_b32 v13, v13, v5, s[66:67]
    v_cndmask_b32 v14, v14, v6, s[68:69]
    v_cndmask_b32 v15, v15, v7, s[70:71]
    v_mul_f32 v16, 0x3ea52b5c, v16
    v_mul_f32 v148, v16, v8
    v_mul_f32 v149, v16, v9
    v_mul_f32 v150, v16, v10
    v_mul_f32 v151, v16, v11
    v_mul_f32 v152, v16, v12
    v_mul_f32 v153, v16, v13
    v_mul_f32 v154, v16, v14
    v_mul_f32 v155, v16, v15
HA0_4:
    s_cbranch_execz HA0_5
    s_waitcnt lgkmcnt(15)
    v_mfma_f32_4x4x4_16b_bf16 v[60:63], v[30:31], v[20:21], 0
    v_mfma_f32_4x4x4_16b_bf16 v[64:67], v[40:41], v[20:21], 0
    v_mfma_f32_4x4x4_16b_bf16 v[68:71], v[50:51], v[20:21], 0
    s_waitcnt lgkmcnt(12)
    v_mfma_f32_4x4x4_16b_bf16 v[60:63], v[32:33], v[22:23], v[60:63]
    v_mfma_f32_4x4x4_16b_bf16 v[64:67], v[42:43], v[22:23], v[64:67]
    v_mfma_f32_4x4x4_16b_bf16 v[68:71], v[52:53], v[22:23], v[68:71]
    s_waitcnt lgkmcnt(8)
    v_mfma_f32_4x4x4_16b_bf16 v[60:63], v[34:35], v[24:25], v[60:63]
    v_mfma_f32_4x4x4_16b_bf16 v[64:67], v[44:45], v[24:25], v[64:67]
    v_mfma_f32_4x4x4_16b_bf16 v[68:71], v[54:55], v[24:25], v[68:71]
    s_waitcnt lgkmcnt(4)
    v_mfma_f32_4x4x4_16b_bf16 v[60:63], v[36:37], v[26:27], v[60:63]
    v_mfma_f32_4x4x4_16b_bf16 v[64:67], v[46:47], v[26:27], v[64:67]
    v_mfma_f32_4x4x4_16b_bf16 v[68:71], v[56:57], v[26:27], v[68:71]
    s_waitcnt lgkmcnt(0)
    v_mfma_f32_4x4x4_16b_bf16 v[60:63], v[38:39], v[28:29], v[60:63]
    v_mfma_f32_4x4x4_16b_bf16 v[64:67], v[48:49], v[28:29], v[64:67]
    v_mfma_f32_4x4x4_16b_bf16 v[68:71], v[58:59], v[28:29], v[68:71]
    ds_read_b64_tr_b16 v[100:101], v214 offset:0
    ds_read_b64_tr_b16 v[102:103], v214 offset:1600
    ds_read_b64_tr_b16 v[104:105], v214 offset:32
    ds_read_b64_tr_b16 v[106:107], v214 offset:1632
    ds_read_b64_tr_b16 v[108:109], v214 offset:64
    ds_read_b64_tr_b16 v[110:111], v214 offset:1664
    ds_read_b64_tr_b16 v[112:113], v214 offset:96
    ds_read_b64_tr_b16 v[114:115], v214 offset:1696
    s_cmp_lt_i32 s13, 8
    s_cbranch_scc1 AT_mask
AT_nomask:
    v_cndmask_b32 v69, v69, v61, s[66:67]
    v_cndmask_b32 v70, v70, v62, s[68:69]
    v_cndmask_b32 v71, v71, v63, s[70:71]
    v_mul_f32 v64, v64, v148
    v_mul_f32 v65, v65, v149
    v_mul_f32 v66, v66, v150
    v_mul_f32 v67, v67, v151
HA0_5:
    s_cbranch_execz HA0_6
    v_mul_f32 v68, v68, v152
    v_mul_f32 v69, v69, v153
    v_mul_f32 v70, v70, v154
    v_mul_f32 v71, v71, v155
    v_perm_b32 v80, v64, v67, s60
    v_perm_b32 v81, v65, v67, s61
    v_perm_b32 v82, v66, v67, s62
    v_perm_b32 v84, v68, v71, s60
    v_perm_b32 v85, v69, v71, s61
    v_perm_b32 v86, v70, v71, s62
    s_mov_b64 exec, s[20:21]
    s_cmp_eq_u32 s49, 0
    s_cbranch_scc1 sts_3
    buffer_store_dwordx4 v[80:83], v206, s[24:27], s12 offen offset:1024
    buffer_store_dwordx4 v[84:87], v206, s[24:27], s12 offen offset:1536
std_4:
    buffer_load_dwordx4 v[88:91], v213, s[24:27], s12 offen offset:0 sc1
    buffer_load_dwordx4 v[92:95], v213, s[24:27], s12 offen offset:512 sc1
    s_mov_b64 exec, -1
    v_bfe_u32 v17, v215, 8, 2
    v_lshl_add_u32 v17, v17, 4, v251
    ds_read_b128 v[156:159], v17 offset:112
    ds_read_b128 v[160:163], v17 offset:176
    v_and_b32 v164, 2, v201
    v_lshl_add_u32 v164, v200, 2, v164
    s_lshl_b32 s65, s48, 6
    s_add_u32 s65, s65, s57
    s_sub_u32 s58, s23, s100
    s_lshr_b32 s58, s58, 1
    s_add_u32 s58, s58, s100
    s_sub_u32 s58, s58, s65
    s_add_u32 s58, s58, 173312
    v_writelane_b32 v164, s58, 16
    s_mov_b64 exec, s[20:21]
    s_branch AT_pw
AT_poll:
    buffer_load_dwordx4 v[88:91], v213, s[24:27], s12 offen offset:0 sc1
    buffer_load_dwordx4 v[92:95], v213, s[24:27], s12 offen offset:512 sc1
AT_pw:
    s_waitcnt vmcnt(0)
    v_cmp_ne_u32 vcc, s54, v91
    v_cmp_ne_u32 s[58:59], s54, v95
    s_or_b64 vcc, vcc, s[58:59]
    s_cbranch_vccz AT_got
    s_sub_u32 s3, s3, 1
    s_cbranch_scc0 AT_poll
HA0_6:
    s_cbranch_execz HA0_7
    s_mov_b32 s3, 0
AT_got:
    s_mov_b64 exec, -1
    buffer_load_dwordx4 v[232:235], v250, s[28:31], 0 offen offset:0
    buffer_load_dwordx4 v[236:239], v250, s[28:31], 0 offen offset:64
    ds_read_b64 v[240:241], v227 offset:0
    ds_read_b64 v[242:243], v227 offset:32
    ds_read_b64 v[244:245], v227 offset:64
    ds_read_b64 v[246:247], v227 offset:96
    ds_read_b32 v248, v251 offset:2288
    v_perm_b32 v91, v88, v89, s63
    v_perm_b32 v95, v92, v93, s63
    v_perm_b32 v91, v91, v90, s64
    v_perm_b32 v95, v95, v94, s64
    v_add_f32 v64, v64, v88
    v_add_f32 v65, v65, v89
    v_add_f32 v66, v66, v90
    v_add_f32 v67, v67, v91
    v_add_f32 v68, v68, v92
    v_add_f32 v69, v69, v93
    v_add_f32 v70, v70, v94
    v_add_f32 v71, v71, v95
    v_max3_f32 v18, v64, v65, v66
    v_max3_f32 v19, v67, v68, v69
    v_max3_f32 v18, v18, v70, v71
    v_max_f32 v18, v18, v19
    v_sub_f32 v64, v64, v18
    v_sub_f32 v65, v65, v18
    v_sub_f32 v66, v66, v18
    v_sub_f32 v67, v67, v18
    v_sub_f32 v68, v68, v18
    v_sub_f32 v69, v69, v18
    v_sub_f32 v70, v70, v18
    v_sub_f32 v71, v71, v18
    v_exp_f32 v64, v64
    v_exp_f32 v65, v65
    v_exp_f32 v66, v66
    v_exp_f32 v67, v67
    v_exp_f32 v68, v68
    v_exp_f32 v69, v69
    v_exp_f32 v70, v70
    v_exp_f32 v71, v71
    v_add_f32 v20, v64, v65
    v_add_f32 v21, v66, v67
    v_add_f32 v22, v68, v69
    v_add_f32 v23, v70, v71
    v_add_f32 v20, v20, v21
    v_add_f32 v22, v22, v23
    v_add_f32 v20, v20, v22
    v_rcp_f32 v20, v20
HA0_7:
    s_cbranch_execz HA_ret
    v_mul_f32 v64, v64, v8
    v_mul_f32 v65, v65, v9
    v_mul_f32 v66, v66, v10
    v_mul_f32 v67, v67, v11
    v_mul_f32 v68, v68, v12
    v_mul_f32 v69, v69, v13
    v_mul_f32 v70, v70, v14
    v_mul_f32 v71, v71, v15
    v_mul_f32 v64, v64, v20
    v_mul_f32 v65, v65, v20
    v_mul_f32 v66, v66, v20
    v_mul_f32 v67, v67, v20
    v_mul_f32 v68, v68, v20
    v_mul_f32 v69, v69, v20
    v_mul_f32 v70, v70, v20
    v_mul_f32 v71, v71, v20
    v_cvt_pk_bf16_f32 v24, v64, v65
    v_cvt_pk_bf16_f32 v25, v66, v67
    v_cvt_pk_bf16_f32 v26, v68, v69
    v_cvt_pk_bf16_f32 v27, v70, v71
    ds_write_b64 v210, v[24:25] offset:8
    v_and_b32 v28, v26, v207
    v_and_b32 v29, v27, v211
    ds_write_b64 v210, v[28:29]
    v_xor_b32 v26, v26, v28
    v_xor_b32 v27, v27, v29
    ds_write_b64 v210, v[26:27] offset:16
    s_cmp_lt_u32 s48, 4
    s_cbranch_scc1 AT_pv
    v_mov_b32 v19, 1
    s_mov_b64 exec, 1
    ds_add_u32 v251, v19
    s_mov_b64 exec, -1
AT_pv:
    ds_read_b128 v[116:119], v172
    ds_read_b128 v[120:123], v173
    ds_read_b128 v[124:127], v174
    ds_read_b128 v[128:131], v175
    ds_read_b128 v[132:135], v176
    ds_read_b128 v[136:139], v177
    ds_read_b128 v[140:143], v178
    ds_read_b128 v[144:147], v179
    s_waitcnt lgkmcnt(6)
    v_mfma_f32_16x16x32_bf16 v[20:23], v[100:103], v[116:119], 0
    v_mfma_f32_16x16x32_bf16 v[24:27], v[100:103], v[120:123], 0
    s_waitcnt lgkmcnt(4)
HA1_0:
    s_cbranch_execz HA1_1
    v_mfma_f32_16x16x32_bf16 v[28:31], v[104:107], v[124:127], 0
    v_mfma_f32_16x16x32_bf16 v[32:35], v[104:107], v[128:131], 0
    s_waitcnt lgkmcnt(2)
    v_mfma_f32_16x16x32_bf16 v[36:39], v[108:111], v[132:135], 0
    v_mfma_f32_16x16x32_bf16 v[40:43], v[108:111], v[136:139], 0
    s_waitcnt lgkmcnt(0)
    v_mfma_f32_16x16x32_bf16 v[44:47], v[112:115], v[140:143], 0
    v_mfma_f32_16x16x32_bf16 v[48:51], v[112:115], v[144:147], 0
    v_cndmask_b32 v20, v20, v24, s[4:5]
    v_cndmask_b32 v21, v21, v25, s[4:5]
    v_cndmask_b32 v22, v22, v26, s[4:5]
    v_cndmask_b32 v23, v23, v27, s[4:5]
    v_cvt_pk_bf16_f32 v60, v20, v21
    v_cvt_pk_bf16_f32 v61, v22, v23
    v_cndmask_b32 v28, v28, v32, s[6:7]
    v_cndmask_b32 v29, v29, v33, s[6:7]
    v_cndmask_b32 v30, v30, v34, s[6:7]
    v_cndmask_b32 v31, v31, v35, s[6:7]
    v_cvt_pk_bf16_f32 v62, v28, v29
    v_cvt_pk_bf16_f32 v63, v30, v31
    v_cndmask_b32 v36, v36, v40, s[8:9]
    v_cndmask_b32 v37, v37, v41, s[8:9]
    v_cndmask_b32 v38, v38, v42, s[8:9]
    v_cndmask_b32 v39, v39, v43, s[8:9]
    v_cvt_pk_bf16_f32 v64, v36, v37
    v_cvt_pk_bf16_f32 v65, v38, v39
    v_cndmask_b32 v44, v44, v48, s[10:11]
    v_cndmask_b32 v45, v45, v49, s[10:11]
    v_cndmask_b32 v46, v46, v50, s[10:11]
    v_cndmask_b32 v47, v47, v51, s[10:11]
    v_cvt_pk_bf16_f32 v66, v44, v45
    v_cvt_pk_bf16_f32 v67, v46, v47
    v_permlane16_swap_b32 v60, v62
HA1_1:
    s_cbranch_execz HA1_2
    v_permlane16_swap_b32 v61, v63
    v_permlane16_swap_b32 v64, v66
    v_permlane16_swap_b32 v65, v67
    s_cmp_eq_u32 s49, 0
    s_cbranch_scc1 sts_5
    buffer_store_dwordx4 v[60:63], v215, s[24:27], s22 offen offset:0
    buffer_store_dwordx4 v[64:67], v215, s[24:27], s22 offen offset:1024
std_6:
    v_dot2_f32_bf16 v20, v60, v156, 0
    v_dot2_f32_bf16 v21, v60, v60, 0
    v_dot2_f32_bf16 v20, v61, v157, v20
    v_dot2_f32_bf16 v21, v61, v61, v21
    v_dot2_f32_bf16 v20, v62, v158, v20
    v_dot2_f32_bf16 v21, v62, v62, v21
    v_dot2_f32_bf16 v20, v63, v159, v20
    v_dot2_f32_bf16 v21, v63, v63, v21
    v_dot2_f32_bf16 v20, v64, v160, v20
    v_dot2_f32_bf16 v21, v64, v64, v21
    v_dot2_f32_bf16 v20, v65, v161, v20
    v_dot2_f32_bf16 v21, v65, v65, v21
    v_dot2_f32_bf16 v20, v66, v162, v20
    v_dot2_f32_bf16 v21, v66, v66, v21
    v_dot2_f32_bf16 v20, v67, v163, v20
    v_dot2_f32_bf16 v21, v67, v67, v21
    s_nop 2
    v_permlane32_swap_b32 v20, v21
    v_add_f32 v20, v20, v21
    v_mov_b32 v21, v20
    s_nop 1
    v_permlane16_swap_b32 v20, v21
    s_mov_b32 exec_lo, 0x1ffff
    s_mov_b32 exec_hi, 0xffff
    v_add_f32 v20, v20, v21
    v_writelane_b32 v20, s54, 16
    s_cmp_eq_u32 s49, 0
    s_cbranch_scc1 sts_7
    buffer_store_short_d16_hi v20, v164, s[24:27], s65 offen
std_8:
    s_mov_b64 exec, -1
    s_waitcnt vmcnt(3)
B_start:
    ds_read_b32 v19, v251
    v_permlane16_swap_b32 v232, v234
HA1_2:
    s_cbranch_execz HA1_3
    v_permlane16_swap_b32 v233, v235
    v_permlane16_swap_b32 v236, v238
    v_permlane16_swap_b32 v237, v239
    v_lshlrev_b32 v184, 16, v232
    v_and_b32 v185, s47, v232
    v_lshlrev_b32 v186, 16, v233
    v_and_b32 v187, s47, v233
    v_lshlrev_b32 v188, 16, v234
    v_and_b32 v189, s47, v234
    v_lshlrev_b32 v190, 16, v235
    v_and_b32 v191, s47, v235
    v_lshlrev_b32 v192, 16, v236
    v_and_b32 v193, s47, v236
    v_lshlrev_b32 v194, 16, v237
    v_and_b32 v195, s47, v237
    v_lshlrev_b32 v196, 16, v238
    v_and_b32 v197, s47, v238
    v_lshlrev_b32 v198, 16, v239
    v_and_b32 v199, s47, v239
    s_cmp_ge_u32 s48, 6
    s_cbranch_scc1 B_nf
    s_waitcnt vmcnt(1)
    s_mov_b64 exec, 1
    s_cmp_eq_u32 s49, 0
    s_cbranch_scc1 sts_9
    buffer_store_dword v79, v203, s[24:27], s23 offen
std_10:
    s_mov_b64 exec, -1
B_nf:
    s_mul_i32 s65, s101, 10240
    s_add_u32 s58, s1, s65
    s_add_u32 s59, s58, 4096
    s_add_u32 s60, s58, 8192
    s_add_u32 s61, s58, 12288
    s_add_u32 s62, s58, 16384
    v_cmp_gt_u32 vcc, 2048, v254
    s_mov_b64 s[4:5], vcc
    s_mov_b32 s70, 2.0
    v_lshlrev_b32 v11, 11, v200
    s_branch B_wc
B_ww:
    ds_read_b32 v19, v251
B_wc:
    s_waitcnt lgkmcnt(0)
    v_cmp_ne_u32 vcc, 4, v19
    s_cbranch_vccz B_wd
    s_sub_u32 s3, s3, 1
    s_cbranch_scc0 B_ww
    s_mov_b32 s3, 0
B_wd:
    ds_read_b64_tr_b16 v[100:101], v216 offset:0
    ds_read_b64_tr_b16 v[102:103], v216 offset:512
    ds_read_b64_tr_b16 v[104:105], v217 offset:0
    ds_read_b64_tr_b16 v[106:107], v217 offset:512
    ds_read_b64_tr_b16 v[108:109], v218 offset:0
HA1_3:
    s_cbranch_execz HA1_4
    ds_read_b64_tr_b16 v[110:111], v218 offset:512
    ds_read_b64_tr_b16 v[112:113], v219 offset:0
    ds_read_b64_tr_b16 v[114:115], v219 offset:512
    ds_read_b64_tr_b16 v[116:117], v216 offset:4096
    ds_read_b64_tr_b16 v[118:119], v216 offset:4608
    ds_read_b64_tr_b16 v[120:121], v217 offset:4096
    ds_read_b64_tr_b16 v[122:123], v217 offset:4608
    ds_read_b64_tr_b16 v[124:125], v218 offset:4096
    ds_read_b64_tr_b16 v[126:127], v218 offset:4608
    ds_read_b64_tr_b16 v[128:129], v219 offset:4096
    ds_read_b64_tr_b16 v[130:131], v219 offset:4608
    ds_read_b64_tr_b16 v[132:133], v216 offset:8192
    ds_read_b64_tr_b16 v[134:135], v216 offset:8704
    ds_read_b64_tr_b16 v[136:137], v217 offset:8192
    ds_read_b64_tr_b16 v[138:139], v217 offset:8704
    ds_read_b64_tr_b16 v[140:141], v218 offset:8192
    ds_read_b64_tr_b16 v[142:143], v218 offset:8704
    ds_read_b64_tr_b16 v[144:145], v219 offset:8192
    ds_read_b64_tr_b16 v[146:147], v219 offset:8704
    ds_read_b64_tr_b16 v[148:149], v216 offset:12288
    ds_read_b64_tr_b16 v[150:151], v216 offset:12800
    ds_read_b64_tr_b16 v[152:153], v217 offset:12288
    ds_read_b64_tr_b16 v[154:155], v217 offset:12800
    ds_read_b64_tr_b16 v[156:157], v218 offset:12288
    ds_read_b64_tr_b16 v[158:159], v218 offset:12800
    ds_read_b64_tr_b16 v[160:161], v219 offset:12288
    ds_read_b64_tr_b16 v[162:163], v219 offset:12800
    ds_read_b64_tr_b16 v[164:165], v216 offset:16384
    ds_read_b64_tr_b16 v[166:167], v216 offset:16896
    ds_read_b64_tr_b16 v[168:169], v217 offset:16384
    ds_read_b64_tr_b16 v[170:171], v217 offset:16896
    ds_read_b64_tr_b16 v[172:173], v218 offset:16384
HA1_4:
    s_cbranch_execz HA1_5
    ds_read_b64_tr_b16 v[174:175], v218 offset:16896
    ds_read_b64_tr_b16 v[176:177], v219 offset:16384
    ds_read_b64_tr_b16 v[178:179], v219 offset:16896
    s_cmp_lt_u32 s48, 6
    s_cbranch_scc1 B_e3
    s_cmp_eq_u32 s48, 6
    s_cbranch_scc1 B_est
    s_mov_b32 s66, 0x40100401
    s_mov_b32 s67, 0x00040100
    s_lshl_b64 s[66:67], s[66:67], s51
    s_mov_b32 exec_hi, 0x0fffffff
    s_andn2_b64 exec, exec, s[66:67]
B_poll:
    buffer_load_dword v18, v203, s[24:27], s100 offen sc1
    s_waitcnt vmcnt(0)
    v_cmp_ne_u32 vcc, s54, v18
    s_cbranch_vccz B_go
    s_sub_u32 s3, s3, 1
    s_cbranch_scc0 B_poll
    s_mov_b32 s3, 0
B_go:
    s_mov_b64 exec, -1
    s_branch B_e3
B_est:
    v_mul_u32_u24 v4, 12, v0
    v_and_b32 v5, 31, v0
    v_mul_u32_u24 v5, 3, v5
    s_mul_i32 s64, s53, 96
    s_sub_u32 s65, 1014, s55
    v_add_u32 v8, -10, v5
    v_cmp_gt_u32 s[6:7], s65, v8
    v_add3_u32 v8, v5, s64, 0
    v_add_u32 v9, -9, v5
    v_cmp_gt_u32 s[8:9], s65, v9
    v_add3_u32 v9, v5, s64, 1
    v_add_u32 v10, -8, v5
    v_cmp_gt_u32 s[10:11], s65, v10
    v_add3_u32 v10, v5, s64, 2
    s_add_u32 s14, s100, 512
    s_add_u32 s15, s100, 35072
    s_add_u32 s16, s100, 69632
    s_add_u32 s17, s100, 104192
    s_add_u32 s18, s100, 138752
    s_add_u32 s19, s100, 173312
HA1_5:
    s_cbranch_execz HA1_6
    s_mov_b32 s63, 0x00003f80
    s_mov_b32 s64, 0x3f800000
    s_pack_hh_b32_b16 s65, s54, s54
    s_mov_b64 exec, 0x3fffffff
E_poll:
    buffer_load_dword v18, v203, s[24:27], s19 offen sc1
    s_waitcnt vmcnt(0)
    v_cmp_ne_u32 vcc, s65, v18
    s_cbranch_vccz E_go
    s_sleep 1
    s_sub_u32 s3, s3, 1
    s_cbranch_scc0 E_poll
    s_mov_b32 s3, 0
E_go:
    s_mov_b64 exec, -1
    buffer_load_dwordx3 v[60:62], v4, s[24:27], s14 offen sc1
    buffer_load_dwordx3 v[64:66], v4, s[24:27], s15 offen sc1
    buffer_load_dwordx3 v[68:70], v4, s[24:27], s16 offen sc1
    buffer_load_dwordx3 v[72:74], v4, s[24:27], s17 offen sc1
    buffer_load_dwordx3 v[76:78], v4, s[24:27], s18 offen sc1
    s_barrier
    s_waitcnt vmcnt(0)
    v_dot2_f32_bf16 v84, v60, s63, 0
    v_dot2_f32_bf16 v88, v60, s64, 0
    v_dot2_f32_bf16 v85, v61, s63, 0
    v_dot2_f32_bf16 v89, v61, s64, 0
    v_dot2_f32_bf16 v86, v62, s63, 0
    v_dot2_f32_bf16 v90, v62, s64, 0
    v_dot2_f32_bf16 v84, v64, s63, v84
    v_dot2_f32_bf16 v88, v64, s64, v88
    v_dot2_f32_bf16 v85, v65, s63, v85
    v_dot2_f32_bf16 v89, v65, s64, v89
    v_dot2_f32_bf16 v86, v66, s63, v86
    v_dot2_f32_bf16 v90, v66, s64, v90
    v_dot2_f32_bf16 v84, v68, s63, v84
    v_dot2_f32_bf16 v88, v68, s64, v88
    v_dot2_f32_bf16 v85, v69, s63, v85
    v_dot2_f32_bf16 v89, v69, s64, v89
    v_dot2_f32_bf16 v86, v70, s63, v86
    v_dot2_f32_bf16 v90, v70, s64, v90
HA1_6:
    s_cbranch_execz HA1_7
    v_dot2_f32_bf16 v84, v72, s63, v84
    v_dot2_f32_bf16 v88, v72, s64, v88
    v_dot2_f32_bf16 v85, v73, s63, v85
    v_dot2_f32_bf16 v89, v73, s64, v89
    v_dot2_f32_bf16 v86, v74, s63, v86
    v_dot2_f32_bf16 v90, v74, s64, v90
    v_dot2_f32_bf16 v84, v76, s63, v84
    v_dot2_f32_bf16 v88, v76, s64, v88
    v_dot2_f32_bf16 v85, v77, s63, v85
    v_dot2_f32_bf16 v89, v77, s64, v89
    v_dot2_f32_bf16 v86, v78, s63, v86
    v_dot2_f32_bf16 v90, v78, s64, v90
    v_permlane32_swap_b32 v84, v88
    v_permlane32_swap_b32 v85, v89
    s_nop 0
    v_permlane32_swap_b32 v86, v90
    v_add_f32 v84, v84, v88
    v_add_f32 v85, v85, v89
    v_add_f32 v86, v86, v90
    v_rsq_f32 v88, v84
    v_rsq_f32 v89, v85
    v_rsq_f32 v90, v86
    v_permlane32_swap_b32 v88, v92
    v_permlane32_swap_b32 v89, v93
    v_permlane32_swap_b32 v90, v94
    v_mul_f32 v84, v84, v92
    v_mul_f32 v85, v85, v93
    v_mul_f32 v86, v86, v94
    v_ashrrev_i32 v88, 31, v84
    v_ashrrev_i32 v89, 31, v85
    v_ashrrev_i32 v90, 31, v86
    v_or_b32 v88, 0x80000000, v88
    v_or_b32 v89, 0x80000000, v89
    v_or_b32 v90, 0x80000000, v90
    v_xor_b32 v88, v88, v84
    v_xor_b32 v89, v89, v85
    v_xor_b32 v90, v90, v86
    v_and_b32 v88, 0xfffff000, v88
    v_and_b32 v89, 0xfffff000, v89
    v_and_b32 v90, 0xfffff000, v90
    v_or_b32 v88, v88, v8
    v_or_b32 v89, v89, v9
    v_or_b32 v90, v90, v10
    v_cndmask_b32 v88, 0, v88, s[6:7]
HA1_7:
    s_cbranch_execz HA_ret
    v_cndmask_b32 v89, 0, v89, s[8:9]
    v_cndmask_b32 v90, 0, v90, s[10:11]
    v_max3_u32 v6, v88, v89, v90
    v_mov_b32 v7, s54
    s_nop 0
    v_max_u32_dpp v6, v6, v6 row_ror:1 row_mask:0xf bank_mask:0xf
    s_nop 1
    v_max_u32_dpp v6, v6, v6 row_ror:2 row_mask:0xf bank_mask:0xf
    s_nop 1
    v_max_u32_dpp v6, v6, v6 row_ror:4 row_mask:0xf bank_mask:0xf
    s_nop 1
    v_max_u32_dpp v6, v6, v6 row_ror:8 row_mask:0xf bank_mask:0xf
    v_mov_b32 v5, v6
    s_nop 1
    v_permlane16_swap_b32 v6, v5
    s_mov_b64 exec, 0xffff
    s_cmp_eq_u32 s51, 0
    v_max_u32 v6, v6, v5
    s_cselect_b32 s70, s45, s70
    ds_write_b32 v251, v6 offset:4
    s_mov_b64 exec, -1
    s_branch B_e4
B_e3:
    s_barrier
B_e4:
    s_cmp_lt_u32 s48, 4
    s_cbranch_scc1 B_np
    s_setprio 2
B_np:
    buffer_load_dwordx4 v[20:23], v249, s[24:27], s58 offen offset:0 sc1
    buffer_load_dwordx4 v[24:27], v249, s[24:27], s58 offen offset:1024 sc1
    buffer_load_dwordx4 v[28:31], v249, s[24:27], s58 offen offset:2048 sc1
    buffer_load_dwordx4 v[32:35], v249, s[24:27], s58 offen offset:3072 sc1
    buffer_load_dwordx4 v[36:39], v249, s[24:27], s59 offen offset:0 sc1
    buffer_load_dwordx4 v[40:43], v249, s[24:27], s59 offen offset:1024 sc1
    buffer_load_dwordx4 v[44:47], v249, s[24:27], s59 offen offset:2048 sc1
    buffer_load_dwordx4 v[48:51], v249, s[24:27], s59 offen offset:3072 sc1
    buffer_load_dwordx4 v[52:55], v249, s[24:27], s60 offen offset:0 sc1
    buffer_load_dwordx4 v[56:59], v249, s[24:27], s60 offen offset:1024 sc1
    s_cmp_ge_u32 s48, 4
    s_cbranch_scc1 B_half
    s_waitcnt vmcnt(9) lgkmcnt(8)
    v_mfma_f32_16x16x32_bf16 v[184:187], v[100:103], v[20:23], v[184:187]
    ds_read_b64_tr_b16 v[100:101], v216 offset:20480
HA2_0:
    s_cbranch_execz HA2_1
    ds_read_b64_tr_b16 v[102:103], v216 offset:20992
    v_mfma_f32_16x16x32_bf16 v[188:191], v[104:107], v[20:23], v[188:191]
    ds_read_b64_tr_b16 v[104:105], v217 offset:20480
    ds_read_b64_tr_b16 v[106:107], v217 offset:20992
    v_mfma_f32_16x16x32_bf16 v[192:195], v[108:111], v[20:23], v[192:195]
    ds_read_b64_tr_b16 v[108:109], v218 offset:20480
    ds_read_b64_tr_b16 v[110:111], v218 offset:20992
    v_mfma_f32_16x16x32_bf16 v[196:199], v[112:115], v[20:23], v[196:199]
    ds_read_b64_tr_b16 v[112:113], v219 offset:20480
    ds_read_b64_tr_b16 v[114:115], v219 offset:20992
    buffer_load_dwordx4 v[60:63], v249, s[24:27], s60 offen offset:2048 sc1
    s_waitcnt vmcnt(9) lgkmcnt(8)
    v_mfma_f32_16x16x32_bf16 v[184:187], v[116:119], v[24:27], v[184:187]
    ds_read_b64_tr_b16 v[116:117], v216 offset:24576
    ds_read_b64_tr_b16 v[118:119], v216 offset:25088
    v_mfma_f32_16x16x32_bf16 v[188:191], v[120:123], v[24:27], v[188:191]
    ds_read_b64_tr_b16 v[120:121], v217 offset:24576
    ds_read_b64_tr_b16 v[122:123], v217 offset:25088
    v_mfma_f32_16x16x32_bf16 v[192:195], v[124:127], v[24:27], v[192:195]
    ds_read_b64_tr_b16 v[124:125], v218 offset:24576
    ds_read_b64_tr_b16 v[126:127], v218 offset:25088
    v_mfma_f32_16x16x32_bf16 v[196:199], v[128:131], v[24:27], v[196:199]
    ds_read_b64_tr_b16 v[128:129], v219 offset:24576
    ds_read_b64_tr_b16 v[130:131], v219 offset:25088
    buffer_load_dwordx4 v[64:67], v249, s[24:27], s60 offen offset:3072 sc1
    s_waitcnt vmcnt(9) lgkmcnt(8)
    v_mfma_f32_16x16x32_bf16 v[184:187], v[132:135], v[28:31], v[184:187]
    ds_read_b64_tr_b16 v[132:133], v216 offset:28672
    ds_read_b64_tr_b16 v[134:135], v216 offset:29184
    v_mfma_f32_16x16x32_bf16 v[188:191], v[136:139], v[28:31], v[188:191]
    ds_read_b64_tr_b16 v[136:137], v217 offset:28672
    ds_read_b64_tr_b16 v[138:139], v217 offset:29184
    v_mfma_f32_16x16x32_bf16 v[192:195], v[140:143], v[28:31], v[192:195]
HA2_1:
    s_cbranch_execz HA2_2
    ds_read_b64_tr_b16 v[140:141], v218 offset:28672
    ds_read_b64_tr_b16 v[142:143], v218 offset:29184
    v_mfma_f32_16x16x32_bf16 v[196:199], v[144:147], v[28:31], v[196:199]
    ds_read_b64_tr_b16 v[144:145], v219 offset:28672
    ds_read_b64_tr_b16 v[146:147], v219 offset:29184
    buffer_load_dwordx4 v[68:71], v249, s[24:27], s61 offen offset:0 sc1
    s_waitcnt vmcnt(9) lgkmcnt(8)
    v_mfma_f32_16x16x32_bf16 v[184:187], v[148:151], v[32:35], v[184:187]
    ds_read_b64_tr_b16 v[148:149], v216 offset:32768
    ds_read_b64_tr_b16 v[150:151], v216 offset:33280
    v_mfma_f32_16x16x32_bf16 v[188:191], v[152:155], v[32:35], v[188:191]
    ds_read_b64_tr_b16 v[152:153], v217 offset:32768
    ds_read_b64_tr_b16 v[154:155], v217 offset:33280
    v_mfma_f32_16x16x32_bf16 v[192:195], v[156:159], v[32:35], v[192:195]
    ds_read_b64_tr_b16 v[156:157], v218 offset:32768
    ds_read_b64_tr_b16 v[158:159], v218 offset:33280
    v_mfma_f32_16x16x32_bf16 v[196:199], v[160:163], v[32:35], v[196:199]
    ds_read_b64_tr_b16 v[160:161], v219 offset:32768
    ds_read_b64_tr_b16 v[162:163], v219 offset:33280
    buffer_load_dwordx4 v[72:75], v249, s[24:27], s61 offen offset:1024 sc1
    s_waitcnt vmcnt(9) lgkmcnt(8)
    v_mfma_f32_16x16x32_bf16 v[184:187], v[164:167], v[36:39], v[184:187]
    ds_read_b64_tr_b16 v[164:165], v216 offset:36864
    ds_read_b64_tr_b16 v[166:167], v216 offset:37376
    v_mfma_f32_16x16x32_bf16 v[188:191], v[168:171], v[36:39], v[188:191]
    ds_read_b64_tr_b16 v[168:169], v217 offset:36864
    ds_read_b64_tr_b16 v[170:171], v217 offset:37376
    v_mfma_f32_16x16x32_bf16 v[192:195], v[172:175], v[36:39], v[192:195]
    ds_read_b64_tr_b16 v[172:173], v218 offset:36864
    ds_read_b64_tr_b16 v[174:175], v218 offset:37376
    v_mfma_f32_16x16x32_bf16 v[196:199], v[176:179], v[36:39], v[196:199]
    ds_read_b64_tr_b16 v[176:177], v219 offset:36864
HA2_2:
    s_cbranch_execz HA2_3
    ds_read_b64_tr_b16 v[178:179], v219 offset:37376
    buffer_load_dwordx4 v[76:79], v249, s[24:27], s61 offen offset:2048 sc1
    s_waitcnt vmcnt(9) lgkmcnt(8)
    v_mfma_f32_16x16x32_bf16 v[184:187], v[100:103], v[40:43], v[184:187]
    ds_read_b64_tr_b16 v[100:101], v220 offset:0
    ds_read_b64_tr_b16 v[102:103], v220 offset:512
    v_mfma_f32_16x16x32_bf16 v[188:191], v[104:107], v[40:43], v[188:191]
    ds_read_b64_tr_b16 v[104:105], v221 offset:0
    ds_read_b64_tr_b16 v[106:107], v221 offset:512
    v_mfma_f32_16x16x32_bf16 v[192:195], v[108:111], v[40:43], v[192:195]
    ds_read_b64_tr_b16 v[108:109], v222 offset:0
    ds_read_b64_tr_b16 v[110:111], v222 offset:512
    v_mfma_f32_16x16x32_bf16 v[196:199], v[112:115], v[40:43], v[196:199]
    ds_read_b64_tr_b16 v[112:113], v223 offset:0
    ds_read_b64_tr_b16 v[114:115], v223 offset:512
    buffer_load_dwordx4 v[80:83], v249, s[24:27], s61 offen offset:3072 sc1
    s_waitcnt vmcnt(9) lgkmcnt(8)
    v_mfma_f32_16x16x32_bf16 v[184:187], v[116:119], v[44:47], v[184:187]
    ds_read_b64_tr_b16 v[116:117], v220 offset:4096
    ds_read_b64_tr_b16 v[118:119], v220 offset:4608
    v_mfma_f32_16x16x32_bf16 v[188:191], v[120:123], v[44:47], v[188:191]
    ds_read_b64_tr_b16 v[120:121], v221 offset:4096
    ds_read_b64_tr_b16 v[122:123], v221 offset:4608
    v_mfma_f32_16x16x32_bf16 v[192:195], v[124:127], v[44:47], v[192:195]
    ds_read_b64_tr_b16 v[124:125], v222 offset:4096
    ds_read_b64_tr_b16 v[126:127], v222 offset:4608
    v_mfma_f32_16x16x32_bf16 v[196:199], v[128:131], v[44:47], v[196:199]
    ds_read_b64_tr_b16 v[128:129], v223 offset:4096
    ds_read_b64_tr_b16 v[130:131], v223 offset:4608
    buffer_load_dwordx4 v[84:87], v249, s[24:27], s62 offen offset:0 sc1
    s_waitcnt vmcnt(9) lgkmcnt(8)
    v_mfma_f32_16x16x32_bf16 v[184:187], v[132:135], v[48:51], v[184:187]
    ds_read_b64_tr_b16 v[132:133], v220 offset:8192
HA2_3:
    s_cbranch_execz HA2_4
    ds_read_b64_tr_b16 v[134:135], v220 offset:8704
    v_mfma_f32_16x16x32_bf16 v[188:191], v[136:139], v[48:51], v[188:191]
    ds_read_b64_tr_b16 v[136:137], v221 offset:8192
    ds_read_b64_tr_b16 v[138:139], v221 offset:8704
    v_mfma_f32_16x16x32_bf16 v[192:195], v[140:143], v[48:51], v[192:195]
    ds_read_b64_tr_b16 v[140:141], v222 offset:8192
    ds_read_b64_tr_b16 v[142:143], v222 offset:8704
    v_mfma_f32_16x16x32_bf16 v[196:199], v[144:147], v[48:51], v[196:199]
    ds_read_b64_tr_b16 v[144:145], v223 offset:8192
    ds_read_b64_tr_b16 v[146:147], v223 offset:8704
    buffer_load_dwordx4 v[88:91], v249, s[24:27], s62 offen offset:1024 sc1
    s_waitcnt vmcnt(9) lgkmcnt(8)
    v_mfma_f32_16x16x32_bf16 v[184:187], v[148:151], v[52:55], v[184:187]
    ds_read_b64_tr_b16 v[148:149], v220 offset:12288
    ds_read_b64_tr_b16 v[150:151], v220 offset:12800
    v_mfma_f32_16x16x32_bf16 v[188:191], v[152:155], v[52:55], v[188:191]
    ds_read_b64_tr_b16 v[152:153], v221 offset:12288
    ds_read_b64_tr_b16 v[154:155], v221 offset:12800
    v_mfma_f32_16x16x32_bf16 v[192:195], v[156:159], v[52:55], v[192:195]
    ds_read_b64_tr_b16 v[156:157], v222 offset:12288
    ds_read_b64_tr_b16 v[158:159], v222 offset:12800
    v_mfma_f32_16x16x32_bf16 v[196:199], v[160:163], v[52:55], v[196:199]
    ds_read_b64_tr_b16 v[160:161], v223 offset:12288
    ds_read_b64_tr_b16 v[162:163], v223 offset:12800
    buffer_load_dwordx4 v[92:95], v249, s[24:27], s62 offen offset:2048 sc1
    s_waitcnt vmcnt(9) lgkmcnt(8)
    v_mfma_f32_16x16x32_bf16 v[184:187], v[164:167], v[56:59], v[184:187]
    ds_read_b64_tr_b16 v[164:165], v220 offset:16384
    ds_read_b64_tr_b16 v[166:167], v220 offset:16896
    v_mfma_f32_16x16x32_bf16 v[188:191], v[168:171], v[56:59], v[188:191]
    ds_read_b64_tr_b16 v[168:169], v221 offset:16384
    ds_read_b64_tr_b16 v[170:171], v221 offset:16896
    v_mfma_f32_16x16x32_bf16 v[192:195], v[172:175], v[56:59], v[192:195]
HA2_4:
    s_cbranch_execz HA2_5
    ds_read_b64_tr_b16 v[172:173], v222 offset:16384
    ds_read_b64_tr_b16 v[174:175], v222 offset:16896
    v_mfma_f32_16x16x32_bf16 v[196:199], v[176:179], v[56:59], v[196:199]
    ds_read_b64_tr_b16 v[176:177], v223 offset:16384
    ds_read_b64_tr_b16 v[178:179], v223 offset:16896
    buffer_load_dwordx4 v[96:99], v249, s[24:27], s62 offen offset:3072 sc1
    s_waitcnt vmcnt(9) lgkmcnt(8)
    v_mfma_f32_16x16x32_bf16 v[184:187], v[100:103], v[60:63], v[184:187]
    ds_read_b64_tr_b16 v[100:101], v220 offset:20480
    ds_read_b64_tr_b16 v[102:103], v220 offset:20992
    v_mfma_f32_16x16x32_bf16 v[188:191], v[104:107], v[60:63], v[188:191]
    ds_read_b64_tr_b16 v[104:105], v221 offset:20480
    ds_read_b64_tr_b16 v[106:107], v221 offset:20992
    v_mfma_f32_16x16x32_bf16 v[192:195], v[108:111], v[60:63], v[192:195]
    ds_read_b64_tr_b16 v[108:109], v222 offset:20480
    ds_read_b64_tr_b16 v[110:111], v222 offset:20992
    v_mfma_f32_16x16x32_bf16 v[196:199], v[112:115], v[60:63], v[196:199]
    ds_read_b64_tr_b16 v[112:113], v223 offset:20480
    ds_read_b64_tr_b16 v[114:115], v223 offset:20992
    s_waitcnt vmcnt(8) lgkmcnt(8)
    v_mfma_f32_16x16x32_bf16 v[184:187], v[116:119], v[64:67], v[184:187]
    ds_read_b64_tr_b16 v[116:117], v220 offset:24576
    ds_read_b64_tr_b16 v[118:119], v220 offset:25088
    v_mfma_f32_16x16x32_bf16 v[188:191], v[120:123], v[64:67], v[188:191]
    ds_read_b64_tr_b16 v[120:121], v221 offset:24576
    ds_read_b64_tr_b16 v[122:123], v221 offset:25088
    v_mfma_f32_16x16x32_bf16 v[192:195], v[124:127], v[64:67], v[192:195]
    ds_read_b64_tr_b16 v[124:125], v222 offset:24576
    ds_read_b64_tr_b16 v[126:127], v222 offset:25088
    v_mfma_f32_16x16x32_bf16 v[196:199], v[128:131], v[64:67], v[196:199]
    ds_read_b64_tr_b16 v[128:129], v223 offset:24576
    ds_read_b64_tr_b16 v[130:131], v223 offset:25088
HA2_5:
    s_cbranch_execz HA2_6
    s_waitcnt vmcnt(7) lgkmcnt(8)
    v_mfma_f32_16x16x32_bf16 v[184:187], v[132:135], v[68:71], v[184:187]
    ds_read_b64_tr_b16 v[132:133], v220 offset:28672
    ds_read_b64_tr_b16 v[134:135], v220 offset:29184
    v_mfma_f32_16x16x32_bf16 v[188:191], v[136:139], v[68:71], v[188:191]
    ds_read_b64_tr_b16 v[136:137], v221 offset:28672
    ds_read_b64_tr_b16 v[138:139], v221 offset:29184
    v_mfma_f32_16x16x32_bf16 v[192:195], v[140:143], v[68:71], v[192:195]
    ds_read_b64_tr_b16 v[140:141], v222 offset:28672
    ds_read_b64_tr_b16 v[142:143], v222 offset:29184
    v_mfma_f32_16x16x32_bf16 v[196:199], v[144:147], v[68:71], v[196:199]
    ds_read_b64_tr_b16 v[144:145], v223 offset:28672
    ds_read_b64_tr_b16 v[146:147], v223 offset:29184
    s_waitcnt vmcnt(6) lgkmcnt(8)
    v_mfma_f32_16x16x32_bf16 v[184:187], v[148:151], v[72:75], v[184:187]
    ds_read_b64_tr_b16 v[148:149], v220 offset:32768
    ds_read_b64_tr_b16 v[150:151], v220 offset:33280
    v_mfma_f32_16x16x32_bf16 v[188:191], v[152:155], v[72:75], v[188:191]
    ds_read_b64_tr_b16 v[152:153], v221 offset:32768
    ds_read_b64_tr_b16 v[154:155], v221 offset:33280
    v_mfma_f32_16x16x32_bf16 v[192:195], v[156:159], v[72:75], v[192:195]
    ds_read_b64_tr_b16 v[156:157], v222 offset:32768
    ds_read_b64_tr_b16 v[158:159], v222 offset:33280
    v_mfma_f32_16x16x32_bf16 v[196:199], v[160:163], v[72:75], v[196:199]
    ds_read_b64_tr_b16 v[160:161], v223 offset:32768
    ds_read_b64_tr_b16 v[162:163], v223 offset:33280
    s_waitcnt vmcnt(5) lgkmcnt(8)
    v_mfma_f32_16x16x32_bf16 v[184:187], v[164:167], v[76:79], v[184:187]
    ds_read_b64_tr_b16 v[164:165], v220 offset:36864
    ds_read_b64_tr_b16 v[166:167], v220 offset:37376
    v_mfma_f32_16x16x32_bf16 v[188:191], v[168:171], v[76:79], v[188:191]
    ds_read_b64_tr_b16 v[168:169], v221 offset:36864
    ds_read_b64_tr_b16 v[170:171], v221 offset:37376
HA2_6:
    s_cbranch_execz HA2_7
    v_mfma_f32_16x16x32_bf16 v[192:195], v[172:175], v[76:79], v[192:195]
    ds_read_b64_tr_b16 v[172:173], v222 offset:36864
    ds_read_b64_tr_b16 v[174:175], v222 offset:37376
    v_mfma_f32_16x16x32_bf16 v[196:199], v[176:179], v[76:79], v[196:199]
    ds_read_b64_tr_b16 v[176:177], v223 offset:36864
    ds_read_b64_tr_b16 v[178:179], v223 offset:37376
    s_waitcnt vmcnt(4) lgkmcnt(8)
    v_mfma_f32_16x16x32_bf16 v[184:187], v[100:103], v[80:83], v[184:187]
    v_mfma_f32_16x16x32_bf16 v[188:191], v[104:107], v[80:83], v[188:191]
    v_mfma_f32_16x16x32_bf16 v[192:195], v[108:111], v[80:83], v[192:195]
    v_mfma_f32_16x16x32_bf16 v[196:199], v[112:115], v[80:83], v[196:199]
    s_waitcnt vmcnt(3) lgkmcnt(0)
    v_mfma_f32_16x16x32_bf16 v[184:187], v[116:119], v[84:87], v[184:187]
    v_mfma_f32_16x16x32_bf16 v[188:191], v[120:123], v[84:87], v[188:191]
    v_mfma_f32_16x16x32_bf16 v[192:195], v[124:127], v[84:87], v[192:195]
    v_mfma_f32_16x16x32_bf16 v[196:199], v[128:131], v[84:87], v[196:199]
    s_waitcnt vmcnt(2) lgkmcnt(0)
    v_mfma_f32_16x16x32_bf16 v[184:187], v[132:135], v[88:91], v[184:187]
    ds_read_b32 v10, v251 offset:4
    v_mfma_f32_16x16x32_bf16 v[188:191], v[136:139], v[88:91], v[188:191]
    v_mfma_f32_16x16x32_bf16 v[192:195], v[140:143], v[88:91], v[192:195]
    v_mfma_f32_16x16x32_bf16 v[196:199], v[144:147], v[88:91], v[196:199]
    s_waitcnt vmcnt(1) lgkmcnt(0)
    v_mfma_f32_16x16x32_bf16 v[184:187], v[148:151], v[92:95], v[184:187]
    v_and_b32 v10, 0xfff, v10
    v_cmp_eq_u32 s[68:69], v10, v226
    v_mfma_f32_16x16x32_bf16 v[188:191], v[152:155], v[92:95], v[188:191]
    v_add_u32 v10, s54, v10
    v_mfma_f32_16x16x32_bf16 v[192:195], v[156:159], v[92:95], v[192:195]
    v_mfma_f32_16x16x32_bf16 v[196:199], v[160:163], v[92:95], v[196:199]
    s_waitcnt vmcnt(0) lgkmcnt(0)
    v_mfma_f32_16x16x32_bf16 v[184:187], v[164:167], v[96:99], v[184:187]
    v_mfma_f32_16x16x32_bf16 v[188:191], v[168:171], v[96:99], v[188:191]
    v_mfma_f32_16x16x32_bf16 v[192:195], v[172:175], v[96:99], v[192:195]
    v_mfma_f32_16x16x32_bf16 v[196:199], v[176:179], v[96:99], v[196:199]
HA2_7:
    s_cbranch_execz HA_ret
    s_branch B_epi
B_half:
    s_mov_b64 exec, 0xffff
    buffer_store_dwordx2 v[6:7], v11, s[24:27], s70 offen sc1
    s_mov_b64 exec, -1
    s_waitcnt vmcnt(10) lgkmcnt(8)
    v_mfma_f32_16x16x32_bf16 v[184:187], v[100:103], v[20:23], v[184:187]
    ds_read_b64_tr_b16 v[100:101], v216 offset:20480
    ds_read_b64_tr_b16 v[102:103], v216 offset:20992
    v_mfma_f32_16x16x32_bf16 v[188:191], v[104:107], v[20:23], v[188:191]
    ds_read_b64_tr_b16 v[104:105], v217 offset:20480
    ds_read_b64_tr_b16 v[106:107], v217 offset:20992
    v_mfma_f32_16x16x32_bf16 v[192:195], v[108:111], v[20:23], v[192:195]
    ds_read_b64_tr_b16 v[108:109], v218 offset:20480
    ds_read_b64_tr_b16 v[110:111], v218 offset:20992
    v_mfma_f32_16x16x32_bf16 v[196:199], v[112:115], v[20:23], v[196:199]
    ds_read_b64_tr_b16 v[112:113], v219 offset:20480
    ds_read_b64_tr_b16 v[114:115], v219 offset:20992
    s_waitcnt vmcnt(9) lgkmcnt(8)
    v_mfma_f32_16x16x32_bf16 v[184:187], v[116:119], v[24:27], v[184:187]
    ds_read_b64_tr_b16 v[116:117], v216 offset:24576
    ds_read_b64_tr_b16 v[118:119], v216 offset:25088
    v_mfma_f32_16x16x32_bf16 v[188:191], v[120:123], v[24:27], v[188:191]
    ds_read_b64_tr_b16 v[120:121], v217 offset:24576
    ds_read_b64_tr_b16 v[122:123], v217 offset:25088
    v_mfma_f32_16x16x32_bf16 v[192:195], v[124:127], v[24:27], v[192:195]
    ds_read_b64_tr_b16 v[124:125], v218 offset:24576
    ds_read_b64_tr_b16 v[126:127], v218 offset:25088
    v_mfma_f32_16x16x32_bf16 v[196:199], v[128:131], v[24:27], v[196:199]
    ds_read_b64_tr_b16 v[128:129], v219 offset:24576
    ds_read_b64_tr_b16 v[130:131], v219 offset:25088
    s_waitcnt vmcnt(8) lgkmcnt(8)
    v_mfma_f32_16x16x32_bf16 v[184:187], v[132:135], v[28:31], v[184:187]
    ds_read_b64_tr_b16 v[132:133], v216 offset:28672
    ds_read_b64_tr_b16 v[134:135], v216 offset:29184
HA3_0:
    s_cbranch_execz HA3_1
    v_mfma_f32_16x16x32_bf16 v[188:191], v[136:139], v[28:31], v[188:191]
    ds_read_b64_tr_b16 v[136:137], v217 offset:28672
    ds_read_b64_tr_b16 v[138:139], v217 offset:29184
    v_mfma_f32_16x16x32_bf16 v[192:195], v[140:143], v[28:31], v[192:195]
    ds_read_b64_tr_b16 v[140:141], v218 offset:28672
    ds_read_b64_tr_b16 v[142:143], v218 offset:29184
    v_mfma_f32_16x16x32_bf16 v[196:199], v[144:147], v[28:31], v[196:199]
    ds_read_b64_tr_b16 v[144:145], v219 offset:28672
    ds_read_b64_tr_b16 v[146:147], v219 offset:29184
    s_waitcnt vmcnt(7) lgkmcnt(8)
    v_mfma_f32_16x16x32_bf16 v[184:187], v[148:151], v[32:35], v[184:187]
    ds_read_b64_tr_b16 v[148:149], v216 offset:32768
    ds_read_b64_tr_b16 v[150:151], v216 offset:33280
    v_mfma_f32_16x16x32_bf16 v[188:191], v[152:155], v[32:35], v[188:191]
    ds_read_b64_tr_b16 v[152:153], v217 offset:32768
    ds_read_b64_tr_b16 v[154:155], v217 offset:33280
    v_mfma_f32_16x16x32_bf16 v[192:195], v[156:159], v[32:35], v[192:195]
    ds_read_b64_tr_b16 v[156:157], v218 offset:32768
    ds_read_b64_tr_b16 v[158:159], v218 offset:33280
    v_mfma_f32_16x16x32_bf16 v[196:199], v[160:163], v[32:35], v[196:199]
    ds_read_b64_tr_b16 v[160:161], v219 offset:32768
    ds_read_b64_tr_b16 v[162:163], v219 offset:33280
    s_waitcnt vmcnt(6) lgkmcnt(8)
    v_mfma_f32_16x16x32_bf16 v[184:187], v[164:167], v[36:39], v[184:187]
    ds_read_b64_tr_b16 v[164:165], v216 offset:36864
    ds_read_b64_tr_b16 v[166:167], v216 offset:37376
    v_mfma_f32_16x16x32_bf16 v[188:191], v[168:171], v[36:39], v[188:191]
    ds_read_b64_tr_b16 v[168:169], v217 offset:36864
    ds_read_b64_tr_b16 v[170:171], v217 offset:37376
    v_mfma_f32_16x16x32_bf16 v[192:195], v[172:175], v[36:39], v[192:195]
    ds_read_b64_tr_b16 v[172:173], v218 offset:36864
    ds_read_b64_tr_b16 v[174:175], v218 offset:37376
HA3_1:
    s_cbranch_execz HA3_2
    v_mfma_f32_16x16x32_bf16 v[196:199], v[176:179], v[36:39], v[196:199]
    ds_read_b64_tr_b16 v[176:177], v219 offset:36864
    ds_read_b64_tr_b16 v[178:179], v219 offset:37376
    s_waitcnt vmcnt(5) lgkmcnt(8)
    v_mfma_f32_16x16x32_bf16 v[184:187], v[100:103], v[40:43], v[184:187]
    v_mfma_f32_16x16x32_bf16 v[188:191], v[104:107], v[40:43], v[188:191]
    v_mfma_f32_16x16x32_bf16 v[192:195], v[108:111], v[40:43], v[192:195]
    v_mfma_f32_16x16x32_bf16 v[196:199], v[112:115], v[40:43], v[196:199]
    s_waitcnt vmcnt(4) lgkmcnt(0)
    v_mfma_f32_16x16x32_bf16 v[184:187], v[116:119], v[44:47], v[184:187]
    v_mfma_f32_16x16x32_bf16 v[188:191], v[120:123], v[44:47], v[188:191]
    v_mfma_f32_16x16x32_bf16 v[192:195], v[124:127], v[44:47], v[192:195]
    v_mfma_f32_16x16x32_bf16 v[196:199], v[128:131], v[44:47], v[196:199]
    s_waitcnt vmcnt(3) lgkmcnt(0)
    v_mfma_f32_16x16x32_bf16 v[184:187], v[132:135], v[48:51], v[184:187]
    v_mfma_f32_16x16x32_bf16 v[188:191], v[136:139], v[48:51], v[188:191]
    v_mfma_f32_16x16x32_bf16 v[192:195], v[140:143], v[48:51], v[192:195]
    v_mfma_f32_16x16x32_bf16 v[196:199], v[144:147], v[48:51], v[196:199]
    s_waitcnt vmcnt(2) lgkmcnt(0)
    v_mfma_f32_16x16x32_bf16 v[184:187], v[148:151], v[52:55], v[184:187]
    ds_read_b32 v10, v251 offset:4
    v_mfma_f32_16x16x32_bf16 v[188:191], v[152:155], v[52:55], v[188:191]
    v_mfma_f32_16x16x32_bf16 v[192:195], v[156:159], v[52:55], v[192:195]
    v_mfma_f32_16x16x32_bf16 v[196:199], v[160:163], v[52:55], v[196:199]
    s_waitcnt vmcnt(1) lgkmcnt(0)
    v_mfma_f32_16x16x32_bf16 v[184:187], v[164:167], v[56:59], v[184:187]
    v_and_b32 v10, 0xfff, v10
    v_cmp_eq_u32 s[68:69], v10, v226
    v_mfma_f32_16x16x32_bf16 v[188:191], v[168:171], v[56:59], v[188:191]
    v_add_u32 v10, s54, v10
    v_mfma_f32_16x16x32_bf16 v[192:195], v[172:175], v[56:59], v[192:195]
    v_mfma_f32_16x16x32_bf16 v[196:199], v[176:179], v[56:59], v[196:199]
    s_lshl_b32 s61, s56, 12
    s_add_u32 s61, s61, 135168
    v_add_u32 v16, s61, v202
    s_lshl_b32 s61, s56, 2
HA3_2:
    s_cbranch_execz HA3_3
    s_add_u32 s61, s61, 160760
    v_mov_b32 v18, s61
    s_cmp_eq_u32 s101, 0
    s_cbranch_scc1 B_rx
    ds_write_b128 v16, v[184:187] offset:0
    ds_write_b128 v16, v[188:191] offset:1024
    ds_write_b128 v16, v[192:195] offset:2048
    ds_write_b128 v16, v[196:199] offset:3072
    v_mov_b32 v19, 1
    s_waitcnt lgkmcnt(0)
    ds_write_b32 v18, v19
    s_branch L_fin
B_rx:
    ds_read_b32 v19, v18
    s_waitcnt lgkmcnt(0)
    v_cmp_eq_u32 vcc, 0, v19
    s_cbranch_vccz B_rd
    s_sub_u32 s3, s3, 1
    s_cbranch_scc0 B_rx
    s_mov_b32 s3, 0
B_rd:
    ds_read_b128 v[100:103], v16 offset:0
    ds_read_b128 v[104:107], v16 offset:1024
    ds_read_b128 v[108:111], v16 offset:2048
    ds_read_b128 v[112:115], v16 offset:3072
    s_waitcnt lgkmcnt(0)
    v_add_f32 v184, v184, v100
    v_add_f32 v185, v185, v101
    v_add_f32 v186, v186, v102
    v_add_f32 v187, v187, v103
    v_add_f32 v188, v188, v104
    v_add_f32 v189, v189, v105
    v_add_f32 v190, v190, v106
    v_add_f32 v191, v191, v107
    v_add_f32 v192, v192, v108
    v_add_f32 v193, v193, v109
    v_add_f32 v194, v194, v110
    v_add_f32 v195, v195, v111
    v_add_f32 v196, v196, v112
    v_add_f32 v197, v197, v113
    v_add_f32 v198, v198, v114
    v_add_f32 v199, v199, v115
B_epi:
    v_mov_b32 v16, 0x3f803f80
    v_mov_b32 v15, s54
    s_add_u32 s63, s1, 30720
    s_lshl_b32 s64, s51, 8
    s_add_u32 s64, s64, s63
    v_cvt_pk_bf16_f32 v52, v184, v185
    v_cvt_pk_bf16_f32 v53, v186, v187
    v_cvt_pk_bf16_f32 v54, v188, v189
HA3_3:
    s_cbranch_execz HA3_4
    v_cvt_pk_bf16_f32 v55, v190, v191
    v_cvt_pk_bf16_f32 v56, v192, v193
    v_cvt_pk_bf16_f32 v57, v194, v195
    v_cvt_pk_bf16_f32 v58, v196, v197
    v_cvt_pk_bf16_f32 v59, v198, v199
    s_cmp_eq_u64 s[68:69], 0
    s_cbranch_scc1 B_np2
    s_mov_b64 exec, s[68:69]
    ds_write_b128 v228, v[52:55] offset:0
    ds_write_b128 v228, v[56:59] offset:16
    s_mov_b64 exec, -1
    ds_read_b64 v[8:9], v252
    s_waitcnt lgkmcnt(0)
    buffer_store_dwordx3 v[8:10], v224, s[24:27], s44 offen sc1
B_np2:
    v_dot2_f32_bf16 v12, v52, v16, 0
    v_dot2_f32_bf16 v13, v52, v52, 0
    v_dot2_f32_bf16 v14, v52, v240, 0
    v_dot2_f32_bf16 v12, v53, v16, v12
    v_dot2_f32_bf16 v13, v53, v53, v13
    v_dot2_f32_bf16 v14, v53, v241, v14
    v_dot2_f32_bf16 v12, v54, v16, v12
    v_dot2_f32_bf16 v13, v54, v54, v13
    v_dot2_f32_bf16 v14, v54, v242, v14
    v_dot2_f32_bf16 v12, v55, v16, v12
    v_dot2_f32_bf16 v13, v55, v55, v13
    v_dot2_f32_bf16 v14, v55, v243, v14
    v_dot2_f32_bf16 v12, v56, v16, v12
    v_dot2_f32_bf16 v13, v56, v56, v13
    v_dot2_f32_bf16 v14, v56, v244, v14
    v_dot2_f32_bf16 v12, v57, v16, v12
    v_dot2_f32_bf16 v13, v57, v57, v13
    v_dot2_f32_bf16 v14, v57, v245, v14
    v_dot2_f32_bf16 v12, v58, v16, v12
    v_dot2_f32_bf16 v13, v58, v58, v13
HA3_4:
    s_cbranch_execz HA3_5
    v_dot2_f32_bf16 v14, v58, v246, v14
    v_dot2_f32_bf16 v12, v59, v16, v12
    v_dot2_f32_bf16 v13, v59, v59, v13
    v_dot2_f32_bf16 v14, v59, v247, v14
    s_nop 0
    v_mov_b32 v17, v12
    v_mov_b32 v18, v13
    v_mov_b32 v19, v14
    v_permlane32_swap_b32 v17, v12
    v_permlane32_swap_b32 v18, v13
    v_permlane32_swap_b32 v19, v14
    v_add_f32 v12, v12, v17
    v_add_f32 v13, v13, v18
    v_add_f32 v14, v14, v19
    v_mov_b32 v17, v12
    v_mov_b32 v18, v13
    v_mov_b32 v19, v14
    v_permlane16_swap_b32 v17, v12
    v_permlane16_swap_b32 v18, v13
    v_permlane16_swap_b32 v19, v14
    v_add_f32 v12, v12, v17
    v_add_f32 v13, v13, v18
    v_add_f32 v14, v14, v19
    s_mov_b64 exec, 0xffff
    s_cmp_eq_u32 s49, 0
    s_cbranch_scc1 sts_11
    buffer_store_dwordx4 v[12:15], v202, s[24:27], s64 offen
std_12:
    s_mov_b64 exec, -1
    v_lshlrev_b32 v36, 16, v52
    v_and_b32 v37, s47, v52
    v_lshlrev_b32 v38, 16, v53
    v_and_b32 v39, s47, v53
    v_lshlrev_b32 v40, 16, v54
    v_and_b32 v41, s47, v54
    v_lshlrev_b32 v42, 16, v55
    v_and_b32 v43, s47, v55
    v_lshlrev_b32 v44, 16, v56
    v_and_b32 v45, s47, v56
    v_lshlrev_b32 v46, 16, v57
    v_and_b32 v47, s47, v57
    v_lshlrev_b32 v48, 16, v58
    v_and_b32 v49, s47, v58
    v_lshlrev_b32 v50, 16, v59
    v_and_b32 v51, s47, v59
    v_mov_b32 v108, 0
    v_mov_b32 v109, 0
    v_mov_b32 v110, 0
    v_mov_b32 v111, s54
    v_mov_b32 v11, s54
    v_lshlrev_b32 v7, 11, v200
    s_add_u32 s45, s45, 32768
    s_sub_u32 s44, s44, 131072
S_poll:
    buffer_load_dwordx4 v[100:103], v202, s[24:27], s63 offen sc1
HA3_5:
    s_cbranch_execz HA3_6
    buffer_load_dwordx4 v[104:107], v202, s[24:27], s63 offen offset:1024 sc1
    s_mov_b32 exec_hi, 0
    buffer_load_dwordx4 v[108:111], v202, s[24:27], s63 offen offset:2048 sc1
    s_mov_b32 exec_hi, -1
    s_waitcnt vmcnt(0)
    v_cmp_ne_u32 vcc, s54, v103
    v_cmp_ne_u32 s[64:65], s54, v107
    v_cmp_ne_u32 s[66:67], s54, v111
    s_or_b64 vcc, vcc, s[64:65]
    s_or_b64 vcc, vcc, s[66:67]
    s_cbranch_vccz S_got
    s_sub_u32 s3, s3, 1
    s_cbranch_scc0 S_poll
    s_mov_b32 s3, 0
S_got:
    v_add_f32 v12, v100, v104
    v_add_f32 v13, v101, v105
    v_add_f32 v14, v102, v106
    v_add_f32 v12, v12, v108
    v_add_f32 v13, v13, v109
    v_add_f32 v14, v14, v110
    v_mov_b32 v17, v12
    v_mov_b32 v18, v13
    v_mov_b32 v19, v14
    v_permlane32_swap_b32 v17, v12
    v_permlane32_swap_b32 v18, v13
    v_permlane32_swap_b32 v19, v14
    v_add_f32 v12, v12, v17
    v_add_f32 v13, v13, v18
    v_add_f32 v14, v14, v19
    v_mov_b32 v17, v12
    v_mov_b32 v18, v13
    v_mov_b32 v19, v14
    v_permlane16_swap_b32 v17, v12
    v_permlane16_swap_b32 v18, v13
    v_permlane16_swap_b32 v19, v14
    v_add_f32 v12, v12, v17
    v_add_f32 v13, v13, v18
    v_add_f32 v14, v14, v19
    v_mul_f32 v12, 0x3acccccd, v12
    v_mul_f32 v13, 0x3acccccd, v13
    v_fma_f32 v13, -v12, v12, v13
    v_max_f32 v13, 0, v13
    v_cvt_pk_bf16_f32 v13, v13, v13
    v_and_b32 v13, 0xffff0000, v13
    v_add_f32 v13, 0x3727c5ac, v13
    v_cvt_pk_bf16_f32 v13, v13, v13
    v_and_b32 v13, 0xffff0000, v13
    v_sqrt_f32 v13, v13
    v_cvt_pk_bf16_f32 v12, v12, v12
    v_and_b32 v12, 0xffff0000, v12
HA3_6:
    s_cbranch_execz HA3_7
    v_cvt_pk_bf16_f32 v13, v13, v13
    v_and_b32 v13, 0xffff0000, v13
    v_rcp_f32 v13, v13
    v_fma_f32 v14, -v12, v248, v14
    v_mul_f32 v14, v14, v13
    v_ashrrev_i32 v6, 31, v14
    v_or_b32 v6, 0x80000000, v6
    v_xor_b32 v6, v6, v14
    v_and_b32 v6, 0xfffff000, v6
    v_or_b32 v6, v6, v226
    s_and_b64 exec, s[4:5], 0xffff
    ds_max_u32 v251, v6 offset:12
    s_mov_b64 exec, -1
    v_sub_f32 v20, v36, v12
    v_sub_f32 v21, v37, v12
    v_sub_f32 v22, v38, v12
    v_sub_f32 v23, v39, v12
    v_sub_f32 v24, v40, v12
    v_sub_f32 v25, v41, v12
    v_sub_f32 v26, v42, v12
    v_sub_f32 v27, v43, v12
    s_waitcnt lgkmcnt(0)
    s_barrier
    ds_read_b32 v10, v251 offset:12
    v_sub_f32 v28, v44, v12
    v_sub_f32 v29, v45, v12
    v_sub_f32 v30, v46, v12
    v_sub_f32 v31, v47, v12
    v_sub_f32 v32, v48, v12
    v_sub_f32 v33, v49, v12
    v_sub_f32 v34, v50, v12
    v_sub_f32 v35, v51, v12
    s_or_b32 s64, s51, s48
    s_waitcnt lgkmcnt(0)
    s_cbranch_scc1 S_nc
    s_mov_b64 exec, 0xffff
    buffer_store_dwordx2 v[10:11], v7, s[24:27], s45 offen sc1
    s_mov_b64 exec, -1
S_nc:
    v_cmp_eq_u32 s[68:69], v10, v6
    v_cvt_pk_bf16_f32 v60, v20, v21
    v_cvt_pk_bf16_f32 v61, v22, v23
    v_cvt_pk_bf16_f32 v62, v24, v25
    v_cvt_pk_bf16_f32 v63, v26, v27
    v_cvt_pk_bf16_f32 v64, v28, v29
    v_cvt_pk_bf16_f32 v65, v30, v31
HA3_7:
    s_cbranch_execz HA3_8
    v_cvt_pk_bf16_f32 v66, v32, v33
    v_cvt_pk_bf16_f32 v67, v34, v35
    v_lshlrev_b32 v20, 16, v60
    v_and_b32 v21, s47, v60
    v_lshlrev_b32 v22, 16, v61
    v_and_b32 v23, s47, v61
    v_lshlrev_b32 v24, 16, v62
    v_and_b32 v25, s47, v62
    v_lshlrev_b32 v26, 16, v63
    v_and_b32 v27, s47, v63
    v_lshlrev_b32 v28, 16, v64
    v_and_b32 v29, s47, v64
    v_lshlrev_b32 v30, 16, v65
    v_and_b32 v31, s47, v65
    v_lshlrev_b32 v32, 16, v66
    v_and_b32 v33, s47, v66
    v_lshlrev_b32 v34, 16, v67
    v_and_b32 v35, s47, v67
    v_mul_f32 v20, v20, v13
    v_mul_f32 v21, v21, v13
    v_mul_f32 v22, v22, v13
    v_mul_f32 v23, v23, v13
    v_mul_f32 v24, v24, v13
    v_mul_f32 v25, v25, v13
    v_mul_f32 v26, v26, v13
    v_mul_f32 v27, v27, v13
    v_mul_f32 v28, v28, v13
    v_mul_f32 v29, v29, v13
    v_mul_f32 v30, v30, v13
    v_mul_f32 v31, v31, v13
    v_mul_f32 v32, v32, v13
    v_mul_f32 v33, v33, v13
    v_mul_f32 v34, v34, v13
    v_mul_f32 v35, v35, v13
    v_cvt_pk_bf16_f32 v60, v20, v21
    v_cvt_pk_bf16_f32 v61, v22, v23
    v_cvt_pk_bf16_f32 v62, v24, v25
    v_cvt_pk_bf16_f32 v63, v26, v27
    v_cvt_pk_bf16_f32 v64, v28, v29
    v_cvt_pk_bf16_f32 v65, v30, v31
    v_cvt_pk_bf16_f32 v66, v32, v33
    v_cvt_pk_bf16_f32 v67, v34, v35
    v_lshlrev_b32 v20, 16, v60
    v_and_b32 v21, s47, v60
    v_lshlrev_b32 v22, 16, v61
    v_and_b32 v23, s47, v61
    v_lshlrev_b32 v24, 16, v62
    v_and_b32 v25, s47, v62
    v_lshlrev_b32 v26, 16, v63
    v_and_b32 v27, s47, v63
    v_lshlrev_b32 v28, 16, v64
    v_and_b32 v29, s47, v64
    v_lshlrev_b32 v30, 16, v65
HA3_8:
    s_cbranch_execz HA_ret
    v_and_b32 v31, s47, v65
    v_lshlrev_b32 v32, 16, v66
    v_and_b32 v33, s47, v66
    v_lshlrev_b32 v34, 16, v67
    v_and_b32 v35, s47, v67
    v_add_f32 v20, v20, v36
    v_add_f32 v21, v21, v37
    v_add_f32 v22, v22, v38
    v_add_f32 v23, v23, v39
    v_add_f32 v24, v24, v40
    v_add_f32 v25, v25, v41
    v_add_f32 v26, v26, v42
    v_add_f32 v27, v27, v43
    v_add_f32 v28, v28, v44
    v_add_f32 v29, v29, v45
    v_add_f32 v30, v30, v46
    v_add_f32 v31, v31, v47
    v_add_f32 v32, v32, v48
    v_add_f32 v33, v33, v49
    v_add_f32 v34, v34, v50
    v_add_f32 v35, v35, v51
    v_cvt_pk_bf16_f32 v60, v20, v21
    v_cvt_pk_bf16_f32 v61, v22, v23
    v_cvt_pk_bf16_f32 v62, v24, v25
    v_cvt_pk_bf16_f32 v63, v26, v27
    v_cvt_pk_bf16_f32 v64, v28, v29
    v_cvt_pk_bf16_f32 v65, v30, v31
    v_cvt_pk_bf16_f32 v66, v32, v33
    v_cvt_pk_bf16_f32 v67, v34, v35
    v_permlane16_swap_b32 v60, v62
    v_permlane16_swap_b32 v61, v63
    v_permlane16_swap_b32 v64, v66
    v_permlane16_swap_b32 v65, v67
    buffer_store_dwordx4 v[60:63], v225, s[40:43], 0 offen offset:0 sc1
    buffer_store_dwordx4 v[64:67], v225, s[40:43], 0 offen offset:64 sc1
    s_and_b64 s[68:69], s[68:69], s[4:5]
    s_cbranch_scc0 L_fin
    s_mov_b64 exec, s[68:69]
    ds_write_b128 v228, v[52:55] offset:0
    ds_write_b128 v228, v[56:59] offset:16
    s_mov_b64 exec, -1
    ds_read_b64 v[8:9], v252
    v_and_b32 v10, 0xfff, v10
    v_add_u32 v10, s54, v10
    s_mov_b64 exec, 0xffff
    s_waitcnt vmcnt(0) lgkmcnt(0)
    buffer_store_dwordx3 v[8:10], v224, s[24:27], s44 offen sc1
L_fin:
L_end:
    s_endpgm
AT_mask:
    v_mov_b32 v17, 0xf149f2ca
    v_cmp_le_i32 vcc, 8, v212
    s_nop 1
    v_cndmask_b32 v60, v17, v60, vcc
    v_cmp_le_i32 vcc, 7, v212
    s_nop 1
    v_cndmask_b32 v61, v17, v61, vcc
    v_cmp_le_i32 vcc, 6, v212
    s_nop 1
    v_cndmask_b32 v62, v17, v62, vcc
    v_cmp_le_i32 vcc, 5, v212
    s_nop 1
    v_cndmask_b32 v63, v17, v63, vcc
    v_cmp_le_i32 vcc, 4, v212
    s_nop 1
    v_cndmask_b32 v64, v17, v64, vcc
    v_cmp_le_i32 vcc, 3, v212
    s_nop 1
    v_cndmask_b32 v65, v17, v65, vcc
    v_cmp_le_i32 vcc, 2, v212
    s_nop 1
    v_cndmask_b32 v66, v17, v66, vcc
    v_cmp_le_i32 vcc, 1, v212
    s_nop 1
    v_cndmask_b32 v67, v17, v67, vcc
    v_cmp_le_i32 vcc, 0, v212
    s_nop 1
    v_cndmask_b32 v68, v17, v68, vcc
    v_cmp_le_i32 vcc, -1, v212
    s_nop 1
    v_cndmask_b32 v69, v17, v69, vcc
    v_cmp_le_i32 vcc, -2, v212
    s_nop 1
    v_cndmask_b32 v70, v17, v70, vcc
    v_cmp_le_i32 vcc, -3, v212
    s_nop 1
    v_cndmask_b32 v71, v17, v71, vcc
    s_branch AT_nomask
sts_3:
    buffer_store_dwordx4 v[80:83], v206, s[24:27], s12 offen offset:1024 sc1
    buffer_store_dwordx4 v[84:87], v206, s[24:27], s12 offen offset:1536 sc1
    s_branch std_4
sts_5:
    buffer_store_dwordx4 v[60:63], v215, s[24:27], s22 offen offset:0 sc1
    buffer_store_dwordx4 v[64:67], v215, s[24:27], s22 offen offset:1024 sc1
    s_branch std_6
sts_7:
    buffer_store_short_d16_hi v20, v164, s[24:27], s65 offen sc1
    s_branch std_8
sts_9:
    buffer_store_dword v79, v203, s[24:27], s23 offen sc1
    s_branch std_10
sts_11:
    buffer_store_dwordx4 v[12:15], v202, s[24:27], s64 offen sc1
    s_branch std_12
F_start:
    s_and_b32 s49, s2, 7
    s_lshl_b32 s49, s49, 1
    s_add_u32 s49, s49, s56
    s_sub_u32 s49, s49, 30
    s_and_b32 s50, s48, 1
    s_lshr_b32 s51, s48, 1
    s_mul_i32 s52, s48, 6144
    s_mul_i32 s61, s49, 192
    v_mov_b32 v5, 128
    v_add_u32 v1, 0, v0
    v_mul_u32_u24 v2, 171, v1
    v_lshrrev_b32 v2, 11, v2
    v_mul_u32_u24 v3, 12, v2
    v_sub_u32 v3, v1, v3
    v_mul_u32_u24 v2, 3072, v2
    v_lshl_add_u32 v3, v3, 4, s61
    v_lshrrev_b32 v4, 8, v3
    v_cmp_eq_u32 vcc, 9, v4
    s_nop 1
    v_cndmask_b32 v4, 0, v5, vcc
    v_xad_u32 v210, v3, v4, v2
    v_add_u32 v1, 64, v0
    v_mul_u32_u24 v2, 171, v1
    v_lshrrev_b32 v2, 11, v2
    v_mul_u32_u24 v3, 12, v2
    v_sub_u32 v3, v1, v3
    v_mul_u32_u24 v2, 3072, v2
    v_lshl_add_u32 v3, v3, 4, s61
    v_lshrrev_b32 v4, 8, v3
    v_cmp_eq_u32 vcc, 9, v4
    s_nop 1
    v_cndmask_b32 v4, 0, v5, vcc
    v_xad_u32 v211, v3, v4, v2
    v_add_u32 v1, 128, v0
    v_mul_u32_u24 v2, 171, v1
    v_lshrrev_b32 v2, 11, v2
    v_mul_u32_u24 v3, 12, v2
    v_sub_u32 v3, v1, v3
    v_mul_u32_u24 v2, 3072, v2
    v_lshl_add_u32 v3, v3, 4, s61
    v_lshrrev_b32 v4, 8, v3
    v_cmp_eq_u32 vcc, 9, v4
    s_nop 1
    v_cndmask_b32 v4, 0, v5, vcc
    v_xad_u32 v212, v3, v4, v2
    s_mul_i32 s60, s51, 491520
    s_mov_b32 s30, 1966080
    s_mov_b32 s31, 0x00020000
    s_waitcnt lgkmcnt(0)
    s_cmp_eq_u32 s50, 0
    s_cselect_b32 s28, s14, s16
    s_cselect_b32 s29, s15, s17
    s_and_b32 s29, s29, 0xffff
    s_add_u32 m0, s52, 0
    s_add_u32 s62, s60, 0
    buffer_load_dwordx4 v210, s[28:31], s62 offen lds
    s_add_u32 m0, s52, 1024
    s_add_u32 s62, s60, 0
    buffer_load_dwordx4 v211, s[28:31], s62 offen lds
    s_add_u32 m0, s52, 2048
    s_add_u32 s62, s60, 0
    buffer_load_dwordx4 v212, s[28:31], s62 offen lds
    s_add_u32 m0, s52, 3072
    s_add_u32 s62, s60, 49152
    buffer_load_dwordx4 v210, s[28:31], s62 offen lds
    s_add_u32 m0, s52, 4096
    s_add_u32 s62, s60, 49152
    buffer_load_dwordx4 v211, s[28:31], s62 offen lds
    s_add_u32 m0, s52, 5120
    s_add_u32 s62, s60, 49152
    buffer_load_dwordx4 v212, s[28:31], s62 offen lds
    s_load_dword s54, s[22:23], 0
    s_mov_b32 s36, s8
    s_and_b32 s37, s9, 0xffff
    s_mov_b32 s38, 819200
    s_mov_b32 s39, 0x00020000
    s_mov_b32 s4, s12
    s_and_b32 s5, s13, 0xffff
    s_mov_b32 s6, 1280
    s_mov_b32 s7, 0x00020000
    s_mov_b32 s24, s22
    s_and_b32 s25, s23, 0xffff
    s_mov_b32 s26, 7340032
    s_mov_b32 s27, 0x00020000
    s_mov_b32 s32, s18
    s_and_b32 s33, s19, 0xffff
    s_mov_b32 s34, 1966080
    s_mov_b32 s35, 0x00020000
    s_mov_b32 s40, s20
    s_and_b32 s41, s21, 0xffff
    s_mov_b32 s42, 2621440
    s_mov_b32 s43, 0x00020000
    s_cmp_lg_u32 s48, 7
    s_cbranch_scc1 F_ntlb
    s_lshr_b32 s63, 25945, s49
    s_bitcmp0_b32 s63, 0
    s_cbranch_scc1 F_ntlb
    v_lshlrev_b32 v7, 16, v0
    buffer_load_dword v219, v7, s[40:43], 0 offen sc1
    buffer_load_dword v219, v7, s[36:39], 0 offen
    v_lshlrev_b32 v7, 17, v0
    buffer_load_dword v219, v7, s[24:27], 64 offen sc1
F_ntlb:
    s_add_u32 m0, s52, 49152
    s_add_u32 s62, s60, 98304
    buffer_load_dwordx4 v210, s[28:31], s62 offen lds
    s_add_u32 m0, s52, 50176
    s_add_u32 s62, s60, 98304
    buffer_load_dwordx4 v211, s[28:31], s62 offen lds
    s_add_u32 m0, s52, 51200
    s_add_u32 s62, s60, 98304
    buffer_load_dwordx4 v212, s[28:31], s62 offen lds
    s_add_u32 m0, s52, 52224
    s_add_u32 s62, s60, 147456
    buffer_load_dwordx4 v210, s[28:31], s62 offen lds
    s_add_u32 m0, s52, 53248
    s_add_u32 s62, s60, 147456
    buffer_load_dwordx4 v211, s[28:31], s62 offen lds
    s_add_u32 m0, s52, 54272
    s_add_u32 s62, s60, 147456
    buffer_load_dwordx4 v212, s[28:31], s62 offen lds
    s_mul_i32 s53, s48, 5120
    s_mul_i32 s61, s49, 122880
    s_add_u32 s61, s61, s53
    s_and_b32 s63, s48, 2
    s_lshl_b32 s63, s63, 2
    v_add_u32 v1, 0, v0
    v_mul_u32_u24 v2, 205, v1
    v_lshrrev_b32 v2, 14, v2
    v_lshl_or_b32 v2, v2, 1, s63
    v_xor_b32 v1, v1, v2
    v_lshlrev_b32 v213, 4, v1
    v_add_u32 v1, 64, v0
    v_mul_u32_u24 v2, 205, v1
    v_lshrrev_b32 v2, 14, v2
    v_lshl_or_b32 v2, v2, 1, s63
    v_xor_b32 v1, v1, v2
    v_lshlrev_b32 v214, 4, v1
    v_add_u32 v1, 128, v0
    v_mul_u32_u24 v2, 205, v1
    v_lshrrev_b32 v2, 14, v2
    v_lshl_or_b32 v2, v2, 1, s63
    v_xor_b32 v1, v1, v2
    v_lshlrev_b32 v215, 4, v1
    v_add_u32 v1, 192, v0
    v_mul_u32_u24 v2, 205, v1
    v_lshrrev_b32 v2, 14, v2
    v_lshl_or_b32 v2, v2, 1, s63
    v_xor_b32 v1, v1, v2
    v_lshlrev_b32 v216, 4, v1
    v_add_u32 v1, 256, v0
    v_mul_u32_u24 v2, 205, v1
    v_lshrrev_b32 v2, 14, v2
    v_lshl_or_b32 v2, v2, 1, s63
    v_xor_b32 v1, v1, v2
    v_lshlrev_b32 v217, 4, v1
    v_lshrrev_b32 v2, 4, v0
    v_bfe_u32 v1, v0, 2, 2
    v_lshl_add_u32 v3, v2, 3, v1
    v_and_b32 v4, 3, v0
    v_lshlrev_b32 v4, 3, v4
    v_mul_u32_u24 v5, 192, v3
    v_add3_u32 v218, v5, v4, s52
    v_and_b32 v6, 1, v2
    v_lshl_or_b32 v6, v6, 2, v1
    v_lshlrev_b32 v6, 5, v6
    v_mul_u32_u24 v3, 1280, v3
    s_mul_i32 s63, s48, 160
    s_add_u32 s64, s63, 0
    v_add_u32 v7, s64, v4
    v_xor_b32 v7, v7, v6
    v_add_u32 v200, v7, v3
    v_add_u32 v205, 98304, v200
    s_add_u32 s64, s63, 32
    v_add_u32 v7, s64, v4
    v_xor_b32 v7, v7, v6
    v_add_u32 v201, v7, v3
    v_add_u32 v206, 98304, v201
    s_add_u32 s64, s63, 64
    v_add_u32 v7, s64, v4
    v_xor_b32 v7, v7, v6
    v_add_u32 v202, v7, v3
    v_add_u32 v207, 98304, v202
    s_add_u32 s64, s63, 96
    v_add_u32 v7, s64, v4
    v_xor_b32 v7, v7, v6
    v_add_u32 v203, v7, v3
    v_add_u32 v208, 98304, v203
    s_add_u32 s64, s63, 128
    v_add_u32 v7, s64, v4
    v_xor_b32 v7, v7, v6
    v_add_u32 v204, v7, v3
    v_add_u32 v209, 98304, v204
    s_waitcnt lgkmcnt(0)
    s_add_u32 s54, s54, 2654435761
    s_mov_b32 s67, 0x3f803f80
    v_mov_b32 v220, s67
    v_mov_b32 v221, s67
    v_mov_b32 v222, s67
    v_mov_b32 v223, s67
    s_mul_i32 s65, s48, 384
    v_lshl_add_u32 v3, v2, 4, s65
    v_add_u32 v230, 140544, v3
    v_lshlrev_b32 v16, 3, v0
    buffer_load_dwordx2 v[10:11], v16, s[4:7], 0 offen offset:0
    buffer_load_dwordx2 v[12:13], v16, s[4:7], 0 offen offset:512
    buffer_load_dwordx2 v[14:15], v16, s[4:7], 0 offen offset:1024
    v_lshlrev_b32 v1, 4, v0
    v_lshlrev_b32 v7, 6, v0
    s_lshl_b32 s15, s49, 11
    s_add_u32 s15, s15, 196608
    s_add_u32 s70, s15, 32768
    s_cmp_eq_u32 s48, 7
    s_cselect_b32 s65, s70, 2.0
    s_mov_b64 exec, 0xffffff
    buffer_load_dword v219, v7, s[24:27], s65 offen sc1
    s_mov_b64 exec, -1
    v_mov_b32 v8, 140288
    v_mov_b32 v224, 0
    v_mov_b32 v225, 0
    v_mov_b32 v226, 0
    v_mov_b32 v227, 0
    ds_write_b128 v8, v[224:227] offset:0
    ds_write_b128 v8, v[224:227] offset:16
    ds_write_b128 v8, v[224:227] offset:32
    s_mul_i32 s65, s48, 1344
    v_add_u32 v16, s65, v16
    v_and_b32 v5, 7, v0
    v_mul_u32_u24 v6, 3088, v5
    v_add_u32 v3, v3, v6
    v_lshlrev_b32 v6, 4, v2
    v_mul_u32_u24 v9, 1344, v5
    s_mul_i32 s65, s51, 320
    v_add3_u32 v9, v9, v6, s65
    s_mul_i32 s65, s48, 48
    v_add_u32 v4, s65, v0
    v_lshlrev_b32 v5, 1, v4
    v_lshlrev_b32 v4, 2, v4
    v_and_b32 v18, 1, v2
    v_and_b32 v19, 15, v0
    v_lshlrev_b32 v17, 4, v19
    v_lshl_add_u32 v17, v18, 10, v17
    v_lshlrev_b32 v18, 4, v18
    v_add_u32 v18, 2048, v18
    v_cmp_gt_u32 vcc, 4, v19
    s_nop 1
    v_cndmask_b32 v17, v18, v17, vcc
    v_lshrrev_b32 v18, 1, v2
    v_mul_u32_u24 v18, 3072, v18
    v_add_u32 v17, v17, v18
    s_mul_i32 s8, s48, 6144
    s_lshl_b32 s65, s49, 6
    s_add_u32 s8, s8, s65
    s_add_u32 s8, s8, 32768
    s_sub_u32 s65, s54, 1
    v_mov_b32 v227, s65
    s_mov_b32 exec_lo, 0x001f001f
    s_mov_b32 exec_hi, 0x001f001f
    buffer_store_dwordx4 v[224:227], v17, s[24:27], s8 offen sc1
    s_mov_b64 exec, -1
    s_sub_u32 s44, s48, 2
    s_mul_i32 s14, s49, 3072
    s_lshl_b32 s65, s44, 10
    s_add_u32 s14, s14, s65
    s_add_u32 s14, s14, 32768
    s_lshr_b32 s65, s49, 1
    s_mul_i32 s65, s65, 16
    s_lshl_b32 s66, s49, 1
    s_add_u32 s65, s65, s66
    s_and_b32 s66, s44, 1
    s_cmp_eq_u32 s44, 2
    s_cselect_b32 s66, 16, s66
    s_cselect_b32 s63, 0, 2
    s_cselect_b32 s18, 0x33333333, -1
    s_mov_b32 s19, s18
    s_add_u32 s65, s65, s66
    v_and_b32 v18, 3, v0
    v_lshlrev_b32 v18, s63, v18
    v_add_lshl_u32 v18, v18, s65, 3
    v_lshl_add_u32 v19, v2, 1, v18
    s_mov_b32 s9, 0x07060503
    s_mov_b32 s10, 0x07060502
    s_mov_b32 s11, 0x07060501
    s_mov_b32 s12, 0x04000c0c
    s_mov_b32 s13, 0x0706000c
    s_lshr_b32 s16, s49, 2
    s_mul_i32 s16, s16, 61440
    s_add_u32 s16, s16, 262144
    s_mov_b32 s17, 0
    s_mov_b32 s20, 12
    s_movk_i32 s68, 3088
    s_movk_i32 s69, 1344
    v_add_u32 v228, 140544, v4
    s_lshl_b32 s65, s48, 2
    v_add_u32 v231, s65, v8
    s_cmp_lg_u32 s48, 6
    s_cbranch_scc1 HF_ret
    s_mov_b64 exec, 0
    s_branch HF0_0
HF_ret:
    s_mov_b64 exec, -1
    s_waitcnt vmcnt(11)
    ds_read_b64_tr_b16 v[20:21], v218 offset:0
    ds_read_b64_tr_b16 v[22:23], v218 offset:768
    ds_read_b64_tr_b16 v[24:25], v218 offset:32
    ds_read_b64_tr_b16 v[26:27], v218 offset:800
    ds_read_b64_tr_b16 v[28:29], v218 offset:64
    ds_read_b64_tr_b16 v[30:31], v218 offset:832
    ds_read_b64_tr_b16 v[32:33], v218 offset:96
    ds_read_b64_tr_b16 v[34:35], v218 offset:864
    ds_read_b64_tr_b16 v[36:37], v218 offset:128
    ds_read_b64_tr_b16 v[38:39], v218 offset:896
    ds_read_b64_tr_b16 v[40:41], v218 offset:160
    ds_read_b64_tr_b16 v[42:43], v218 offset:928
    s_waitcnt lgkmcnt(0)
    s_add_u32 m0, s52, 0
    s_add_u32 s62, s60, 196608
    buffer_load_dwordx4 v210, s[28:31], s62 offen lds
    s_add_u32 m0, s52, 1024
    s_add_u32 s62, s60, 196608
    buffer_load_dwordx4 v211, s[28:31], s62 offen lds
    s_add_u32 m0, s52, 2048
    s_add_u32 s62, s60, 196608
    buffer_load_dwordx4 v212, s[28:31], s62 offen lds
    s_add_u32 m0, s52, 3072
    s_add_u32 s62, s60, 245760
    buffer_load_dwordx4 v210, s[28:31], s62 offen lds
    s_add_u32 m0, s52, 4096
    s_add_u32 s62, s60, 245760
    buffer_load_dwordx4 v211, s[28:31], s62 offen lds
    s_add_u32 m0, s52, 5120
    s_add_u32 s62, s60, 245760
    buffer_load_dwordx4 v212, s[28:31], s62 offen lds
    s_lshl_b32 s63, 1, s49
    s_sub_u32 s64, s63, 1
    s_andn2_b32 s64, s64, 0x3084
    s_bcnt1_i32_b32 s64, s64
    s_mul_i32 s65, s64, 86
    s_lshr_b32 s65, s65, 8
    s_mul_i32 s66, s65, 3
    s_sub_u32 s64, s64, s66
    s_lshl_b32 s65, s65, 2
    s_lshr_b32 s65, 0xdc72, s65
    s_and_b32 s65, s65, 15
    s_mul_i32 s65, s65, 3
    s_add_u32 s64, s64, s65
    s_mul_i32 s64, s64, 40960
    s_add_u32 s64, s64, s53
    s_and_b32 s63, s63, 0x3084
    s_cselect_b32 s64, 2.0, s64
    v_lshlrev_b32 v229, 3, v1
    s_mov_b32 exec_hi, 0xff
    buffer_load_dword v219, v229, s[32:35], s64 offen
    s_mov_b32 exec_hi, -1
    v_mfma_f32_16x16x32_bf16 v[232:235], v[20:23], v[220:223], 0
    v_mfma_f32_16x16x32_bf16 v[236:239], v[24:27], v[220:223], 0
    v_mfma_f32_16x16x32_bf16 v[240:243], v[28:31], v[220:223], 0
    v_mfma_f32_16x16x32_bf16 v[244:247], v[32:35], v[220:223], 0
    v_mfma_f32_16x16x32_bf16 v[248:251], v[36:39], v[220:223], 0
    v_mfma_f32_16x16x32_bf16 v[252:255], v[40:43], v[220:223], 0
    s_waitcnt vmcnt(12)
    ds_read_b64_tr_b16 v[44:45], v218 offset:49152
    ds_read_b64_tr_b16 v[46:47], v218 offset:49920
    ds_read_b64_tr_b16 v[48:49], v218 offset:49184
    ds_read_b64_tr_b16 v[50:51], v218 offset:49952
    ds_read_b64_tr_b16 v[52:53], v218 offset:49216
    ds_read_b64_tr_b16 v[54:55], v218 offset:49984
    ds_read_b64_tr_b16 v[56:57], v218 offset:49248
    ds_read_b64_tr_b16 v[58:59], v218 offset:50016
    ds_read_b64_tr_b16 v[60:61], v218 offset:49280
    ds_read_b64_tr_b16 v[62:63], v218 offset:50048
    ds_read_b64_tr_b16 v[64:65], v218 offset:49312
    ds_read_b64_tr_b16 v[66:67], v218 offset:50080
    s_waitcnt lgkmcnt(0)
    s_add_u32 m0, s52, 49152
    s_add_u32 s62, s60, 294912
    buffer_load_dwordx4 v210, s[28:31], s62 offen lds
    s_add_u32 m0, s52, 50176
    s_add_u32 s62, s60, 294912
    buffer_load_dwordx4 v211, s[28:31], s62 offen lds
    s_add_u32 m0, s52, 51200
    s_add_u32 s62, s60, 294912
    buffer_load_dwordx4 v212, s[28:31], s62 offen lds
    s_add_u32 m0, s52, 52224
    s_add_u32 s62, s60, 344064
    buffer_load_dwordx4 v210, s[28:31], s62 offen lds
    s_add_u32 m0, s52, 53248
    s_add_u32 s62, s60, 344064
    buffer_load_dwordx4 v211, s[28:31], s62 offen lds
    s_add_u32 m0, s52, 54272
    s_add_u32 s62, s60, 344064
    buffer_load_dwordx4 v212, s[28:31], s62 offen lds
    v_mfma_f32_16x16x32_bf16 v[232:235], v[44:47], v[220:223], v[232:235]
    v_mfma_f32_16x16x32_bf16 v[236:239], v[48:51], v[220:223], v[236:239]
    v_mfma_f32_16x16x32_bf16 v[240:243], v[52:55], v[220:223], v[240:243]
    v_mfma_f32_16x16x32_bf16 v[244:247], v[56:59], v[220:223], v[244:247]
    v_mfma_f32_16x16x32_bf16 v[248:251], v[60:63], v[220:223], v[248:251]
    v_mfma_f32_16x16x32_bf16 v[252:255], v[64:67], v[220:223], v[252:255]
    s_waitcnt vmcnt(7)
    ds_read_b64_tr_b16 v[68:69], v218 offset:0
    ds_read_b64_tr_b16 v[70:71], v218 offset:768
    ds_read_b64_tr_b16 v[72:73], v218 offset:32
    ds_read_b64_tr_b16 v[74:75], v218 offset:800
    ds_read_b64_tr_b16 v[76:77], v218 offset:64
    ds_read_b64_tr_b16 v[78:79], v218 offset:832
    ds_read_b64_tr_b16 v[80:81], v218 offset:96
    ds_read_b64_tr_b16 v[82:83], v218 offset:864
    ds_read_b64_tr_b16 v[84:85], v218 offset:128
    ds_read_b64_tr_b16 v[86:87], v218 offset:896
    ds_read_b64_tr_b16 v[88:89], v218 offset:160
    ds_read_b64_tr_b16 v[90:91], v218 offset:928
    s_waitcnt lgkmcnt(0)
    s_add_u32 m0, s52, 0
    s_add_u32 s62, s60, 393216
    buffer_load_dwordx4 v210, s[28:31], s62 offen lds
    s_add_u32 m0, s52, 1024
    s_add_u32 s62, s60, 393216
    buffer_load_dwordx4 v211, s[28:31], s62 offen lds
    s_add_u32 m0, s52, 2048
    s_add_u32 s62, s60, 393216
    buffer_load_dwordx4 v212, s[28:31], s62 offen lds
    s_add_u32 m0, s52, 3072
    s_add_u32 s62, s60, 442368
    buffer_load_dwordx4 v210, s[28:31], s62 offen lds
    s_add_u32 m0, s52, 4096
    s_add_u32 s62, s60, 442368
    buffer_load_dwordx4 v211, s[28:31], s62 offen lds
    s_add_u32 m0, s52, 5120
    s_add_u32 s62, s60, 442368
    buffer_load_dwordx4 v212, s[28:31], s62 offen lds
    s_mul_i32 s62, s49, 3
    s_add_u32 s62, s62, 0
    s_lshr_b32 s63, s62, 2
    s_cmp_eq_u32 s63, 9
    s_cselect_b32 s63, 2, 0
    s_xor_b32 s62, s62, s63
    s_mul_i32 s62, s62, 40960
    s_add_u32 s62, s62, s53
    s_add_u32 m0, s53, 98304
    s_nop 0
    buffer_load_dwordx4 v213, s[32:35], s62 offen lds
    s_add_u32 m0, s53, 99328
    s_nop 0
    buffer_load_dwordx4 v214, s[32:35], s62 offen lds
    s_add_u32 m0, s53, 100352
    s_nop 0
    buffer_load_dwordx4 v215, s[32:35], s62 offen lds
    s_add_u32 m0, s53, 101376
    s_nop 0
    buffer_load_dwordx4 v216, s[32:35], s62 offen lds
    s_add_u32 m0, s53, 102400
    s_nop 0
    buffer_load_dwordx4 v217, s[32:35], s62 offen lds
    v_mfma_f32_16x16x32_bf16 v[232:235], v[68:71], v[220:223], v[232:235]
    v_mfma_f32_16x16x32_bf16 v[236:239], v[72:75], v[220:223], v[236:239]
    v_mfma_f32_16x16x32_bf16 v[240:243], v[76:79], v[220:223], v[240:243]
    v_mfma_f32_16x16x32_bf16 v[244:247], v[80:83], v[220:223], v[244:247]
    v_mfma_f32_16x16x32_bf16 v[248:251], v[84:87], v[220:223], v[248:251]
    v_mfma_f32_16x16x32_bf16 v[252:255], v[88:91], v[220:223], v[252:255]
    v_dot2_f32_bf16 v226, v10, s67, 0
    v_dot2_f32_bf16 v226, v11, s67, v226
    v_dot2_f32_bf16 v226, v12, s67, v226
    v_dot2_f32_bf16 v226, v13, s67, v226
    v_dot2_f32_bf16 v226, v14, s67, v226
    v_dot2_f32_bf16 v226, v15, s67, v226
    s_nop 2
    v_add_f32_dpp v226, v226, v226 row_ror:1 row_mask:0xf bank_mask:0xf
    s_nop 1
    v_add_f32_dpp v226, v226, v226 row_ror:2 row_mask:0xf bank_mask:0xf
    s_nop 1
    v_add_f32_dpp v226, v226, v226 row_ror:4 row_mask:0xf bank_mask:0xf
    s_nop 1
    v_add_f32_dpp v226, v226, v226 row_ror:8 row_mask:0xf bank_mask:0xf
    v_mov_b32 v229, v226
    s_nop 1
    v_permlane32_swap_b32 v226, v229
    v_add_f32 v226, v226, v229
    v_mov_b32 v229, v226
    s_nop 1
    v_permlane16_swap_b32 v226, v229
    v_add_f32 v226, v226, v229
    s_nop 0
    v_readfirstlane_b32 s55, v226
    s_waitcnt vmcnt(11)
    ds_read_b64_tr_b16 v[92:93], v218 offset:49152
    ds_read_b64_tr_b16 v[94:95], v218 offset:49920
    ds_read_b64_tr_b16 v[96:97], v218 offset:49184
    ds_read_b64_tr_b16 v[98:99], v218 offset:49952
    ds_read_b64_tr_b16 v[100:101], v218 offset:49216
    ds_read_b64_tr_b16 v[102:103], v218 offset:49984
    ds_read_b64_tr_b16 v[104:105], v218 offset:49248
    ds_read_b64_tr_b16 v[106:107], v218 offset:50016
    ds_read_b64_tr_b16 v[108:109], v218 offset:49280
    ds_read_b64_tr_b16 v[110:111], v218 offset:50048
    ds_read_b64_tr_b16 v[112:113], v218 offset:49312
    ds_read_b64_tr_b16 v[114:115], v218 offset:50080
    s_waitcnt lgkmcnt(0)
    s_barrier
    s_mul_i32 s62, s49, 3
    s_add_u32 s62, s62, 1
    s_lshr_b32 s63, s62, 2
    s_cmp_eq_u32 s63, 9
    s_cselect_b32 s63, 2, 0
    s_xor_b32 s62, s62, s63
    s_mul_i32 s62, s62, 40960
    s_add_u32 s62, s62, s53
    s_add_u32 m0, s53, 49152
    s_nop 0
    buffer_load_dwordx4 v213, s[32:35], s62 offen lds
    s_add_u32 m0, s53, 50176
    s_nop 0
    buffer_load_dwordx4 v214, s[32:35], s62 offen lds
    s_add_u32 m0, s53, 51200
    s_nop 0
    buffer_load_dwordx4 v215, s[32:35], s62 offen lds
    s_add_u32 m0, s53, 52224
    s_nop 0
    buffer_load_dwordx4 v216, s[32:35], s62 offen lds
    s_add_u32 m0, s53, 53248
    s_nop 0
    buffer_load_dwordx4 v217, s[32:35], s62 offen lds
    v_mfma_f32_16x16x32_bf16 v[232:235], v[92:95], v[220:223], v[232:235]
    v_mfma_f32_16x16x32_bf16 v[236:239], v[96:99], v[220:223], v[236:239]
    v_mfma_f32_16x16x32_bf16 v[240:243], v[100:103], v[220:223], v[240:243]
    v_mfma_f32_16x16x32_bf16 v[244:247], v[104:107], v[220:223], v[244:247]
    v_mfma_f32_16x16x32_bf16 v[248:251], v[108:111], v[220:223], v[248:251]
    v_mfma_f32_16x16x32_bf16 v[252:255], v[112:115], v[220:223], v[252:255]
    s_waitcnt vmcnt(10)
    ds_read_b64_tr_b16 v[116:117], v218 offset:0
    ds_read_b64_tr_b16 v[118:119], v218 offset:768
    ds_read_b64_tr_b16 v[120:121], v218 offset:32
    ds_read_b64_tr_b16 v[122:123], v218 offset:800
    ds_read_b64_tr_b16 v[124:125], v218 offset:64
    ds_read_b64_tr_b16 v[126:127], v218 offset:832
    ds_read_b64_tr_b16 v[128:129], v218 offset:96
    ds_read_b64_tr_b16 v[130:131], v218 offset:864
    ds_read_b64_tr_b16 v[132:133], v218 offset:128
    ds_read_b64_tr_b16 v[134:135], v218 offset:896
    ds_read_b64_tr_b16 v[136:137], v218 offset:160
    ds_read_b64_tr_b16 v[138:139], v218 offset:928
    s_waitcnt lgkmcnt(0)
    s_barrier
    s_mul_i32 s62, s49, 3
    s_add_u32 s62, s62, 2
    s_lshr_b32 s63, s62, 2
    s_cmp_eq_u32 s63, 9
    s_cselect_b32 s63, 2, 0
    s_xor_b32 s62, s62, s63
    s_mul_i32 s62, s62, 40960
    s_add_u32 s62, s62, s53
    s_add_u32 m0, s53, 0
    s_nop 0
    buffer_load_dwordx4 v213, s[32:35], s62 offen lds
    s_add_u32 m0, s53, 1024
    s_nop 0
    buffer_load_dwordx4 v214, s[32:35], s62 offen lds
    s_add_u32 m0, s53, 2048
    s_nop 0
    buffer_load_dwordx4 v215, s[32:35], s62 offen lds
    s_add_u32 m0, s53, 3072
    s_nop 0
    buffer_load_dwordx4 v216, s[32:35], s62 offen lds
    s_add_u32 m0, s53, 4096
    s_nop 0
    buffer_load_dwordx4 v217, s[32:35], s62 offen lds
    v_mfma_f32_16x16x32_bf16 v[232:235], v[116:119], v[220:223], v[232:235]
    v_mfma_f32_16x16x32_bf16 v[236:239], v[120:123], v[220:223], v[236:239]
    v_mfma_f32_16x16x32_bf16 v[240:243], v[124:127], v[220:223], v[240:243]
    v_mfma_f32_16x16x32_bf16 v[244:247], v[128:131], v[220:223], v[244:247]
    v_mfma_f32_16x16x32_bf16 v[248:251], v[132:135], v[220:223], v[248:251]
    v_mfma_f32_16x16x32_bf16 v[252:255], v[136:139], v[220:223], v[252:255]
    s_mov_b32 exec_lo, 0x00010001
    s_mov_b32 exec_hi, 0x00010001
    s_nop 0
    ds_write_b128 v230, v[232:235] offset:0
    ds_write_b128 v230, v[236:239] offset:64
    ds_write_b128 v230, v[240:243] offset:128
    ds_write_b128 v230, v[244:247] offset:192
    ds_write_b128 v230, v[248:251] offset:256
    ds_write_b128 v230, v[252:255] offset:320
    s_mov_b64 exec, -1
    s_waitcnt lgkmcnt(0)
    s_waitcnt vmcnt(5)
    s_barrier
    ds_read_b32 v232, v228 offset:0
    ds_read_b32 v233, v228 offset:384
    ds_read_b32 v234, v228 offset:768
    ds_read_b32 v235, v228 offset:1152
    ds_read_b32 v236, v228 offset:1536
    ds_read_b32 v237, v228 offset:1920
    ds_read_b32 v238, v228 offset:2304
    ds_read_b32 v239, v228 offset:2688
    ds_read_b64_tr_b16 v[140:141], v205 offset:0
    ds_read_b64_tr_b16 v[142:143], v205 offset:5120
    ds_read_b64_tr_b16 v[144:145], v206 offset:0
    ds_read_b64_tr_b16 v[146:147], v206 offset:5120
    ds_read_b64_tr_b16 v[148:149], v207 offset:0
    ds_read_b64_tr_b16 v[150:151], v207 offset:5120
    ds_read_b64_tr_b16 v[152:153], v208 offset:0
    ds_read_b64_tr_b16 v[154:155], v208 offset:5120
    ds_read_b64_tr_b16 v[156:157], v209 offset:0
    ds_read_b64_tr_b16 v[158:159], v209 offset:5120
    ds_read_b64_tr_b16 v[160:161], v200 offset:49152
    ds_read_b64_tr_b16 v[162:163], v200 offset:54272
    ds_read_b64_tr_b16 v[164:165], v201 offset:49152
    ds_read_b64_tr_b16 v[166:167], v201 offset:54272
    ds_read_b64_tr_b16 v[168:169], v202 offset:49152
    ds_read_b64_tr_b16 v[170:171], v202 offset:54272
    ds_read_b64_tr_b16 v[172:173], v203 offset:49152
    ds_read_b64_tr_b16 v[174:175], v203 offset:54272
    ds_read_b64_tr_b16 v[176:177], v204 offset:49152
    ds_read_b64_tr_b16 v[178:179], v204 offset:54272
    s_waitcnt lgkmcnt(0)
    v_add_f32 v232, v232, v236
    v_add_f32 v233, v233, v237
    v_add_f32 v234, v234, v238
    v_add_f32 v235, v235, v239
    v_add_f32 v0, v232, v234
    v_add_f32 v2, v233, v235
    s_waitcnt vmcnt(0)
    s_barrier
    ds_read_b64_tr_b16 v[180:181], v200 offset:0
    ds_read_b64_tr_b16 v[182:183], v200 offset:5120
    ds_read_b64_tr_b16 v[184:185], v201 offset:0
    ds_read_b64_tr_b16 v[186:187], v201 offset:5120
    ds_read_b64_tr_b16 v[188:189], v202 offset:0
    ds_read_b64_tr_b16 v[190:191], v202 offset:5120
    ds_read_b64_tr_b16 v[192:193], v203 offset:0
    ds_read_b64_tr_b16 v[194:195], v203 offset:5120
    ds_read_b64_tr_b16 v[196:197], v204 offset:0
    ds_read_b64_tr_b16 v[198:199], v204 offset:5120
    s_waitcnt lgkmcnt(0)
F_rdy:
HF0_0:
    s_cbranch_execz HF0_1
    s_cmp_lg_u32 s48, 0
    s_cbranch_scc1 F_wait
    s_mov_b64 exec, 0xffffff
F_poll:
    buffer_load_dwordx2 v[224:225], v7, s[24:27], s15 offen sc1
    s_waitcnt vmcnt(0)
    v_cmp_ne_u32 vcc, s54, v225
    s_cbranch_vccz F_got
    s_sleep 1
    s_sub_u32 s3, s3, 1
    s_cbranch_scc0 F_poll
    s_mov_b32 s3, 0
F_got:
    s_mov_b64 exec, -1
    v_max_u32_dpp v226, v224, v224 row_ror:1 row_mask:0xf bank_mask:0xf
    s_nop 1
    v_max_u32_dpp v226, v226, v226 row_ror:2 row_mask:0xf bank_mask:0xf
HF0_1:
    s_cbranch_execz HF0_2
    s_nop 1
    v_max_u32_dpp v226, v226, v226 row_ror:4 row_mask:0xf bank_mask:0xf
    s_nop 1
    v_max_u32_dpp v226, v226, v226 row_ror:8 row_mask:0xf bank_mask:0xf
    s_nop 0
    v_readlane_b32 s60, v226, 0
    v_readlane_b32 s62, v226, 16
    s_max_u32 s60, s60, s62
    s_max_u32 s60, s60, 1376257
    s_sub_u32 s60, s60, 1376256
    v_cmp_le_u32 vcc, s60, v224
    s_nop 1
    v_mbcnt_lo_u32_b32 v226, vcc_lo, 0
    v_cmp_gt_u32 s[62:63], 8, v226
    v_lshl_add_u32 v226, v226, 2, v8
    s_and_b64 exec, vcc, s[62:63]
    ds_write_b32 v226, v224 offset:0
    s_mov_b64 exec, -1
    s_waitcnt lgkmcnt(0)
F_wait:
    s_barrier
    ds_read_b32 v224, v231 offset:0
    s_waitcnt lgkmcnt(0)
    v_readfirstlane_b32 s60, v224
F_redo:
    s_mov_b32 s21, 0
    s_and_b32 s61, s60, 0xfff
    s_cbranch_scc0 F_b1
    s_lshr_b32 s62, s61, 4
    s_mul_i32 s62, s62, 171
    s_lshr_b32 s62, s62, 10
    s_mul_i32 s62, s62, 2560
    s_add_u32 s62, s62, s16
    s_add_u32 s63, s54, s61
    v_mov_b64 v[228:229], 0
    v_mov_b32 v230, s63
F_row:
    buffer_load_dwordx3 v[220:222], v1, s[24:27], s62 offen sc1
    buffer_load_dwordx3 v[224:226], v1, s[24:27], s62 offen offset:1024 sc1
    s_mov_b32 exec_hi, 0
    buffer_load_dwordx3 v[228:230], v1, s[24:27], s62 offen offset:2048 sc1
    s_mov_b32 exec_hi, -1
    s_waitcnt vmcnt(0)
    ds_write_b64 v16, v[220:221] offset:24832
    ds_write_b64 v16, v[224:225] offset:25344
    s_mov_b32 exec_hi, 0
    ds_write_b64 v16, v[228:229] offset:25856
    s_mov_b32 exec_hi, -1
HF0_2:
    s_cbranch_execz HF0_3
    v_cmp_ne_u32 vcc, s63, v222
    v_cmp_ne_u32 s[64:65], s63, v226
    s_or_b64 vcc, vcc, s[64:65]
    v_cmp_ne_u32 s[64:65], s63, v230
    s_or_b64 vcc, vcc, s[64:65]
    s_cselect_b32 s21, 0, 1
    s_cbranch_scc0 F_b1
    s_sub_u32 s20, s20, 1
    s_cbranch_scc0 F_row
F_b1:
    s_waitcnt lgkmcnt(0)
    s_barrier
    ds_read_b128 v[200:203], v9 offset:24832
    ds_read_b128 v[204:207], v9 offset:24896
    ds_read_b128 v[208:211], v9 offset:24960
    ds_read_b128 v[212:215], v9 offset:25024
    ds_read_b128 v[216:219], v9 offset:25088
    s_cmp_eq_u32 s21, 0
    s_cbranch_scc1 F_d1
    v_dot2_f32_bf16 v222, v220, s67, 0
    v_dot2_f32_bf16 v223, v220, v220, 0
    v_dot2_f32_bf16 v226, v220, v10, 0
    v_dot2_f32_bf16 v222, v221, s67, v222
    v_dot2_f32_bf16 v223, v221, v221, v223
    v_dot2_f32_bf16 v226, v221, v11, v226
    v_dot2_f32_bf16 v222, v224, s67, v222
    v_dot2_f32_bf16 v223, v224, v224, v223
    v_dot2_f32_bf16 v226, v224, v12, v226
    v_dot2_f32_bf16 v222, v225, s67, v222
    v_dot2_f32_bf16 v223, v225, v225, v223
    v_dot2_f32_bf16 v226, v225, v13, v226
    v_dot2_f32_bf16 v222, v228, s67, v222
    v_dot2_f32_bf16 v223, v228, v228, v223
    v_dot2_f32_bf16 v226, v228, v14, v226
    v_dot2_f32_bf16 v222, v229, s67, v222
    v_dot2_f32_bf16 v223, v229, v229, v223
    v_dot2_f32_bf16 v226, v229, v15, v226
HF0_3:
    s_cbranch_execz HF0_4
    s_nop 2
    v_mov_b32 v227, v226
    v_permlane32_swap_b32 v222, v223
    s_nop 0
    v_permlane32_swap_b32 v226, v227
    v_add_f32 v222, v222, v223
    v_add_f32 v226, v226, v227
    s_nop 1
    v_permlane16_swap_b32 v222, v226
    v_add_f32 v222, v222, v226
    s_nop 1
    v_add_f32_dpp v222, v222, v222 row_ror:1 row_mask:0xf bank_mask:0xf
    s_nop 1
    v_add_f32_dpp v222, v222, v222 row_ror:2 row_mask:0xf bank_mask:0xf
    s_nop 1
    v_add_f32_dpp v222, v222, v222 row_ror:4 row_mask:0xf bank_mask:0xf
    s_nop 1
    v_add_f32_dpp v222, v222, v222 row_ror:8 row_mask:0xf bank_mask:0xf
    s_nop 0
    v_readlane_b32 s64, v222, 32
    v_readlane_b32 s65, v222, 16
    v_mov_b32 v220, v222
    v_mov_b32 v221, s64
    v_mul_f32 v220, 0x3acccccd, v220
    v_mul_f32 v221, 0x3acccccd, v221
    v_fma_f32 v221, -v220, v220, v221
    v_max_f32 v221, 0, v221
    v_cvt_pk_bf16_f32 v221, v221, v221
    v_and_b32 v221, 0xffff0000, v221
    v_add_f32 v221, 0x3727c5ac, v221
    v_cvt_pk_bf16_f32 v221, v221, v221
    v_and_b32 v221, 0xffff0000, v221
    v_sqrt_f32 v221, v221
    v_cvt_pk_bf16_f32 v220, v220, v220
    v_and_b32 v220, 0xffff0000, v220
    v_cvt_pk_bf16_f32 v221, v221, v221
    v_and_b32 v221, 0xffff0000, v221
    v_rcp_f32 v221, v221
    v_mul_f32 v222, s55, v220
    v_sub_f32 v222, s65, v222
    v_mov_b32 v224, s48
    v_mul_f32 v222, v222, v221
    v_lshl_add_u32 v226, v224, 4, v8
HF0_4:
    s_cbranch_execz HF0_5
    v_ashrrev_i32 v225, 31, v222
    v_or_b32 v225, 0x80000000, v225
    v_xor_b32 v225, v225, v222
    v_and_b32 v225, 0xfffff000, v225
    v_or_b32 v225, s61, v225
    s_mov_b64 exec, 1
    ds_write_b96 v226, v[220:222] offset:64
    ds_max_u64 v8, v[224:225] offset:32
    s_mov_b64 exec, -1
F_d1:
    s_waitcnt lgkmcnt(4)
    v_mfma_f32_16x16x32_bf16 v[232:235], v[20:23], v[200:203], 0
    v_mfma_f32_16x16x32_bf16 v[236:239], v[24:27], v[200:203], 0
    v_mfma_f32_16x16x32_bf16 v[240:243], v[28:31], v[200:203], 0
    v_mfma_f32_16x16x32_bf16 v[244:247], v[32:35], v[200:203], 0
    v_mfma_f32_16x16x32_bf16 v[248:251], v[36:39], v[200:203], 0
    v_mfma_f32_16x16x32_bf16 v[252:255], v[40:43], v[200:203], 0
    s_waitcnt lgkmcnt(3)
    v_mfma_f32_16x16x32_bf16 v[232:235], v[44:47], v[204:207], v[232:235]
    v_mfma_f32_16x16x32_bf16 v[236:239], v[48:51], v[204:207], v[236:239]
    v_mfma_f32_16x16x32_bf16 v[240:243], v[52:55], v[204:207], v[240:243]
    v_mfma_f32_16x16x32_bf16 v[244:247], v[56:59], v[204:207], v[244:247]
    v_mfma_f32_16x16x32_bf16 v[248:251], v[60:63], v[204:207], v[248:251]
    v_mfma_f32_16x16x32_bf16 v[252:255], v[64:67], v[204:207], v[252:255]
    s_waitcnt lgkmcnt(2)
    v_mfma_f32_16x16x32_bf16 v[232:235], v[68:71], v[208:211], v[232:235]
    v_mfma_f32_16x16x32_bf16 v[236:239], v[72:75], v[208:211], v[236:239]
    v_mfma_f32_16x16x32_bf16 v[240:243], v[76:79], v[208:211], v[240:243]
    v_mfma_f32_16x16x32_bf16 v[244:247], v[80:83], v[208:211], v[244:247]
    v_mfma_f32_16x16x32_bf16 v[248:251], v[84:87], v[208:211], v[248:251]
    v_mfma_f32_16x16x32_bf16 v[252:255], v[88:91], v[208:211], v[252:255]
    s_waitcnt lgkmcnt(1)
    v_mfma_f32_16x16x32_bf16 v[232:235], v[92:95], v[212:215], v[232:235]
    v_mfma_f32_16x16x32_bf16 v[236:239], v[96:99], v[212:215], v[236:239]
    v_mfma_f32_16x16x32_bf16 v[240:243], v[100:103], v[212:215], v[240:243]
    v_mfma_f32_16x16x32_bf16 v[244:247], v[104:107], v[212:215], v[244:247]
    v_mfma_f32_16x16x32_bf16 v[248:251], v[108:111], v[212:215], v[248:251]
HF0_5:
    s_cbranch_execz HF0_6
    v_mfma_f32_16x16x32_bf16 v[252:255], v[112:115], v[212:215], v[252:255]
    s_waitcnt lgkmcnt(0)
    v_mfma_f32_16x16x32_bf16 v[232:235], v[116:119], v[216:219], v[232:235]
    v_mfma_f32_16x16x32_bf16 v[236:239], v[120:123], v[216:219], v[236:239]
    v_mfma_f32_16x16x32_bf16 v[240:243], v[124:127], v[216:219], v[240:243]
    v_mfma_f32_16x16x32_bf16 v[244:247], v[128:131], v[216:219], v[244:247]
    v_mfma_f32_16x16x32_bf16 v[248:251], v[132:135], v[216:219], v[248:251]
    v_mfma_f32_16x16x32_bf16 v[252:255], v[136:139], v[216:219], v[252:255]
    s_mov_b32 exec_lo, 0x00ff00ff
    s_mov_b32 exec_hi, 0x00ff00ff
    s_nop 0
    ds_write_b128 v3, v[232:235] offset:0
    ds_write_b128 v3, v[236:239] offset:64
    ds_write_b128 v3, v[240:243] offset:128
    ds_write_b128 v3, v[244:247] offset:192
    ds_write_b128 v3, v[248:251] offset:256
    ds_write_b128 v3, v[252:255] offset:320
    s_mov_b64 exec, -1
    s_waitcnt lgkmcnt(0)
    s_barrier
    ds_read_b64 v[224:225], v8 offset:32
    s_cmp_ge_u32 s48, 2
    s_waitcnt lgkmcnt(0)
    v_lshl_add_u32 v226, v224, 4, v8
    s_cbranch_scc1 F_sig
    v_mad_u32_u24 v227, v224, s68, v4
    ds_read_b64 v[228:229], v226 offset:64
    ds_read_b32 v232, v227 offset:0
    ds_read_b32 v233, v227 offset:384
    ds_read_b32 v234, v227 offset:768
    ds_read_b32 v235, v227 offset:1152
    ds_read_b32 v236, v227 offset:1536
    ds_read_b32 v237, v227 offset:1920
    ds_read_b32 v238, v227 offset:2304
    ds_read_b32 v239, v227 offset:2688
    v_readfirstlane_b32 s61, v225
HF0_6:
    s_cbranch_execz HF0_7
    s_waitcnt lgkmcnt(4)
    v_fma_f32 v232, -v228, v0, v232
    v_fma_f32 v233, -v228, v2, v233
    v_add_f32 v232, v232, v234
    v_add_f32 v233, v233, v235
    s_waitcnt lgkmcnt(0)
    v_add_f32 v236, v236, v238
    v_add_f32 v237, v237, v239
    v_add_f32 v232, v232, v236
    v_add_f32 v233, v233, v237
    v_mul_f32 v232, v232, v229
    v_mul_f32 v233, v233, v229
    v_cvt_pk_bf16_f32 v233, v232, v233
    v_lshlrev_b32 v232, 16, v233
    v_mul_f32 v234, 0xbfb8aa3b, v232
    v_exp_f32 v234, v234
    v_and_b32 v233, s47, v233
    v_add_f32 v234, 1.0, v234
    v_rcp_f32 v234, v234
    s_and_b32 s61, s61, 0xfff
    v_mul_f32 v232, v232, v234
    v_cvt_pk_bf16_f32 v232, v232, v232
    v_and_b32 v232, 0xffff0000, v232
    v_mul_f32 v232, v232, v233
    v_cvt_pk_bf16_f32 v232, v232, v232
    s_mov_b32 exec_hi, 0xffff
    ds_write_b16 v5, v232 offset:36864
    s_mov_b64 exec, -1
    s_waitcnt lgkmcnt(0)
    s_branch F_gu
F_sig:
    v_mad_u32_u24 v227, v224, s69, v19
    ds_read_b96 v[228:230], v226 offset:64
    ds_read_u16 v226, v227 offset:24832
    v_readfirstlane_b32 s61, v225
    v_mov_b32 v220, 0
    s_cmp_lg_u32 s48, 7
    s_cbranch_scc1 F_n7
    s_mov_b64 exec, 0xffffff
    buffer_load_dwordx2 v[220:221], v7, s[24:27], s70 offen sc1
    s_mov_b64 exec, -1
F_n7:
    s_and_b32 s61, s61, 0xfff
    s_lshr_b32 s65, s61, 4
    s_mul_i32 s65, s65, 171
    s_lshr_b32 s65, s65, 10
    s_mul_i32 s64, s65, 2560
HF0_7:
    s_cbranch_execz HF0_8
    s_add_u32 s64, s64, 131072
    s_mul_i32 s71, s65, 96
    s_sub_u32 s66, s61, s71
    s_lshr_b32 s71, s65, 1
    s_mul_i32 s71, s71, 86
    s_add_u32 s66, s66, s71
    s_sub_u32 s66, s66, 10
    s_lshl_b32 s66, s66, 1
    s_and_b32 s65, s65, 1
    s_add_u32 s66, s66, s65
    s_mul_i32 s66, s66, 1280
    s_waitcnt lgkmcnt(0)
    v_cvt_pk_bf16_f32 v231, v230, v230
    v_and_b32 v231, 0xffff0000, v231
    v_lshlrev_b32 v226, 16, v226
    v_mul_f32 v231, 0xbfb8aa3b, v231
    v_sub_f32 v227, v226, v228
    v_exp_f32 v231, v231
    v_cvt_pk_bf16_f32 v227, v227, v227
    v_and_b32 v227, 0xffff0000, v227
    v_add_f32 v231, 1.0, v231
    v_mul_f32 v227, v227, v229
    v_rcp_f32 v231, v231
    v_cvt_pk_bf16_f32 v227, v227, v227
    v_and_b32 v227, 0xffff0000, v227
    v_cvt_pk_bf16_f32 v231, v231, v231
    v_and_b32 v231, 0xffff0000, v231
F_gu:
    s_barrier
    ds_read_b128 v[200:203], v6 offset:36864
    ds_read_b128 v[204:207], v6 offset:36928
    ds_read_b128 v[208:211], v6 offset:36992
    s_add_u32 s63, s54, s61
    v_mov_b32 v215, s63
    s_waitcnt lgkmcnt(2)
    v_mfma_f32_16x16x32_bf16 v[232:235], v[140:143], v[200:203], 0
    v_mfma_f32_16x16x32_bf16 v[236:239], v[144:147], v[200:203], 0
    v_mfma_f32_16x16x32_bf16 v[240:243], v[148:151], v[200:203], 0
    v_mfma_f32_16x16x32_bf16 v[244:247], v[152:155], v[200:203], 0
    v_mfma_f32_16x16x32_bf16 v[248:251], v[156:159], v[200:203], 0
    s_waitcnt lgkmcnt(1)
    v_mfma_f32_16x16x32_bf16 v[232:235], v[160:163], v[204:207], v[232:235]
HF0_8:
    s_cbranch_execz HF0_9
    v_mfma_f32_16x16x32_bf16 v[236:239], v[164:167], v[204:207], v[236:239]
    v_mfma_f32_16x16x32_bf16 v[240:243], v[168:171], v[204:207], v[240:243]
    v_mfma_f32_16x16x32_bf16 v[244:247], v[172:175], v[204:207], v[244:247]
    v_mfma_f32_16x16x32_bf16 v[248:251], v[176:179], v[204:207], v[248:251]
    s_waitcnt lgkmcnt(0)
    v_mfma_f32_16x16x32_bf16 v[232:235], v[180:183], v[208:211], v[232:235]
    v_mfma_f32_16x16x32_bf16 v[236:239], v[184:187], v[208:211], v[236:239]
    v_mfma_f32_16x16x32_bf16 v[240:243], v[188:191], v[208:211], v[240:243]
    v_mfma_f32_16x16x32_bf16 v[244:247], v[192:195], v[208:211], v[244:247]
    v_mfma_f32_16x16x32_bf16 v[248:251], v[196:199], v[208:211], v[248:251]
    s_mov_b32 exec_lo, 0x00010001
    s_mov_b32 exec_hi, 0x00010001
    s_nop 1
    v_perm_b32 v212, v232, v235, s9
    v_perm_b32 v213, v233, v235, s10
    v_perm_b32 v214, v234, v235, s11
    s_lshl_b64 exec, exec, 1
    v_perm_b32 v212, v236, v239, s9
    v_perm_b32 v213, v237, v239, s10
    v_perm_b32 v214, v238, v239, s11
    s_lshl_b64 exec, exec, 1
    v_perm_b32 v212, v240, v243, s9
    v_perm_b32 v213, v241, v243, s10
    v_perm_b32 v214, v242, v243, s11
    s_lshl_b64 exec, exec, 1
    v_perm_b32 v212, v244, v247, s9
    v_perm_b32 v213, v245, v247, s10
    v_perm_b32 v214, v246, v247, s11
    s_lshl_b64 exec, exec, 1
    v_perm_b32 v212, v248, v251, s9
    v_perm_b32 v213, v249, v251, s10
    v_perm_b32 v214, v250, v251, s11
    s_mov_b32 exec_lo, 0x001f001f
    s_mov_b32 exec_hi, 0x001f001f
    buffer_store_dwordx4 v[212:215], v17, s[24:27], s8 offen sc1
HF0_9:
    s_cbranch_execz HF0_10
    s_mov_b64 exec, -1
    s_cmp_lt_u32 s44, 3
    s_cbranch_scc0 F_rest
    v_mov_b32 v222, s63
    v_lshlrev_b32 v223, 1, v18
F_yp:
    s_and_b64 exec, s[18:19], 15
    buffer_load_dwordx3 v[220:222], v223, s[24:27], s64 offen sc1
    s_mov_b64 exec, s[18:19]
    s_waitcnt vmcnt(1)
    buffer_load_dwordx4 v[200:203], v1, s[24:27], s14 offen sc1
    s_waitcnt vmcnt(1)
    ds_read_b32 v224, v8 offset:40
    v_cmp_ne_u32 s[58:59], s63, v222
    s_waitcnt lgkmcnt(0)
    v_readfirstlane_b32 s60, v224
    s_and_b32 s62, s60, 0xfff
    s_cmp_lg_u32 s62, s61
    s_cbranch_scc1 F_chk
F_yc:
    s_waitcnt vmcnt(0)
    v_cmp_ne_u32 vcc, s63, v203
    s_or_b64 vcc, vcc, s[58:59]
    s_cbranch_vccz F_yg
F_ys:
    s_sleep 1
    s_sub_u32 s3, s3, 1
    s_cbranch_scc0 F_yp
    s_mov_b32 s3, 0
F_yg:
    s_mov_b64 exec, -1
    v_perm_b32 v203, v200, v201, s12
    v_perm_b32 v203, v203, v202, s13
    v_permlane32_swap_b32 v200, v202
    s_nop 0
    v_permlane32_swap_b32 v201, v203
    v_add_f32 v200, v200, v202
    v_add_f32 v201, v201, v203
    s_nop 1
    v_permlane16_swap_b32 v200, v201
    v_add_f32 v200, v200, v201
    s_nop 1
    v_add_f32_dpp v200, v200, v200 row_ror:4 row_mask:0xf bank_mask:0xf
    s_nop 1
    v_add_f32_dpp v200, v200, v200 row_ror:8 row_mask:0xf bank_mask:0xf
    v_cvt_pk_bf16_f32 v200, v200, v200
    v_and_b32 v200, 0xffff0000, v200
    v_mul_f32 v200, v200, v231
    v_cvt_pk_bf16_f32 v200, v200, v200
    v_and_b32 v200, 0xffff0000, v200
    v_add_f32 v200, v200, v227
    v_cvt_pk_bf16_f32 v200, v200, v200
HF0_10:
    s_cbranch_execz HF0_11
    v_and_b32 v200, 0xffff0000, v200
    v_add_f32 v200, v200, v226
    v_mov_b32 v201, v200
    s_nop 1
    v_permlane16_swap_b32 v200, v201
    v_cvt_pk_bf16_f32 v202, v200, v201
    v_cvt_pk_bf16_f32 v203, v200, v201
    s_nop 1
    v_permlane32_swap_b32 v202, v203
    s_and_b64 exec, s[18:19], 15
    buffer_store_dwordx2 v[202:203], v18, s[40:43], s66 offen sc1
    s_or_b32 s65, s49, s44
    s_cbranch_scc1 L_fin
    s_mov_b64 exec, 1
    v_mov_b32 v9, 0
    v_mov_b32 v10, s54
    buffer_store_dword v10, v9, s[24:27], 0 offen sc1
    s_branch L_fin
F_chk:
    s_cmp_lg_u32 s17, 0
    s_cbranch_scc1 F_yc
    s_waitcnt vmcnt(0)
    s_cmp_eq_u32 s60, 0
    s_cbranch_scc0 F_again
    ds_read_b32 v224, v8 offset:40
    s_waitcnt lgkmcnt(0)
    v_readfirstlane_b32 s60, v224
    s_and_b32 s62, s60, 0xfff
    s_cmp_lg_u32 s62, s61
    s_cbranch_scc0 F_yc
    s_branch F_ys
F_rest:
    s_cmp_lg_u32 s17, 0
    s_cbranch_scc1 L_fin
    s_cmp_lg_u32 s48, 7
    s_cbranch_scc1 F_tw
    s_mov_b64 exec, 0xffffff
    s_waitcnt vmcnt(1)
    s_branch F_tc
F_tp:
    buffer_load_dwordx2 v[220:221], v7, s[24:27], s70 offen sc1
    s_waitcnt vmcnt(0)
F_tc:
    v_cmp_ne_u32 vcc, s54, v221
    s_cbranch_vccz F_tg
    s_sub_u32 s3, s3, 1
    s_cbranch_scc0 F_tp
    s_mov_b32 s3, 0
F_tg:
    s_mov_b64 exec, -1
    v_max_u32_dpp v222, v220, v220 row_ror:1 row_mask:0xf bank_mask:0xf
    s_nop 1
    v_max_u32_dpp v222, v222, v222 row_ror:2 row_mask:0xf bank_mask:0xf
    s_nop 1
    v_max_u32_dpp v222, v222, v222 row_ror:4 row_mask:0xf bank_mask:0xf
    s_nop 1
HF0_11:
    s_cbranch_execz HF_ret
    v_max_u32_dpp v222, v222, v222 row_ror:8 row_mask:0xf bank_mask:0xf
    s_nop 0
    v_readlane_b32 s60, v222, 0
    v_readlane_b32 s62, v222, 16
    s_max_u32 s60, s60, s62
    s_max_u32 s60, s60, 1
    v_mov_b32 v220, s60
    ds_write_b32 v8, v220 offset:40
F_tw:
    ds_read_b32 v224, v8 offset:40
    s_waitcnt lgkmcnt(0)
    v_readfirstlane_b32 s60, v224
    s_cmp_lg_u32 s60, 0
    s_cbranch_scc1 F_tk
    s_sleep 2
    s_sub_u32 s3, s3, 1
    s_cbranch_scc0 F_tw
    s_mov_b32 s3, 0
    s_branch L_fin
F_tk:
    s_and_b32 s62, s60, 0xfff
    s_cmp_eq_u32 s62, s61
    s_cbranch_scc1 L_fin
F_again:
    s_mov_b64 exec, -1
    s_waitcnt vmcnt(0)
    s_mov_b32 s17, 1
    s_mov_b32 s16, 131072
    s_mov_b32 s20, 0x40000
    v_mov_b64 v[224:225], 0
    s_cmp_eq_u32 s48, 0
    s_cselect_b32 s60, s60, 0
    s_cbranch_scc0 F_redo
    ds_write_b64 v8, v[224:225] offset:32
    s_branch F_redo
L_last:
.section .rodata,"a"
.p2align 6
.amdhsa_kernel sequential_preLN__sliding_local_dilated__moe_arch_mod__prompt_kernel
  .amdhsa_next_free_vgpr 256
  .amdhsa_next_free_sgpr 102
  .amdhsa_accum_offset 256
  .amdhsa_group_segment_fixed_size 0
  .amdhsa_kernarg_size 88
  .amdhsa_user_sgpr_count 2
  .amdhsa_user_sgpr_kernarg_segment_ptr 1
  .amdhsa_system_sgpr_workgroup_id_x 1
  .amdhsa_float_denorm_mode_32 3
  .amdhsa_float_denorm_mode_16_64 3
.end_amdhsa_kernel
```

```asm
; @launch grid=(256,1,1) block=(512,1,1) lds=163840
.amdgcn_target "amdgcn-amd-amdhsa--gfx950"
.text
.globl sequential_preLN__sliding_local_dilated__moe_arch_mod__prompt_kernel
.p2align 8
.type sequential_preLN__sliding_local_dilated__moe_arch_mod__prompt_kernel,@function
sequential_preLN__sliding_local_dilated__moe_arch_mod__prompt_kernel:
    s_cmp_ge_u32 s2, 256
    s_cbranch_scc1 L_end
    s_load_dwordx16 s[4:19], s[0:1], 0
    s_load_dwordx2 s[20:21], s[0:1], 64
    s_load_dwordx2 s[22:23], s[0:1], 80
    v_lshrrev_b32 v1, 6, v0
    v_and_b32 v0, 63, v0
    s_lshr_b32 s56, s2, 3
    s_mov_b32 s3, 0x40000
    v_readfirstlane_b32 s48, v1
    s_mov_b32 s47, 0xffff0000
    s_cmp_ge_u32 s2, 240
    s_cbranch_scc0 P_main
    s_getpc_b64 s[58:59]
    v_lshlrev_b32 v2, 7, v0
    v_lshl_add_u32 v2, v1, 13, v2
    v_cmp_gt_u32 vcc, L_last-P_main, v2
    s_nop 1
    v_cndmask_b32 v2, 0, v2, vcc
    global_load_dword v219, v2, s[58:59]
    s_branch F_start
P_main:
    s_mul_i32 s51, s56, 86
    s_lshr_b32 s51, s51, 8
    s_mul_i32 s57, s51, 3
    s_sub_u32 s57, s56, s57
    s_sub_u32 s52, s51, 5
    s_cselect_b32 s52, s51, s52
    s_and_b32 s66, s2, 7
    s_mul_i32 s53, s66, 3
    s_add_u32 s53, s53, s57
    s_lshr_b32 s55, s53, 1
    s_and_b32 s50, s53, 1
    s_mul_i32 s55, s55, 86
    s_sub_u32 s55, s55, 10
    s_mov_b32 s30, 2621440
    s_mov_b32 s31, 0x00020000
    s_mov_b32 s26, 7340032
    s_mov_b32 s27, 0x00020000
    s_cmp_ge_u32 s48, 4
    s_cbranch_scc1 LD_start
    v_and_b32 v1, 15, v0
    v_lshrrev_b32 v2, 4, v0
    s_mul_i32 s60, s51, 12
    s_lshl_b32 s61, s48, 2
    s_add_u32 s60, s60, s61
    v_add_u32 v10, s60, v2
    v_add_u32 v11, s55, v10
    v_cmp_gt_i32 vcc, 0, v11
    v_lshl_add_u32 v11, v11, 1, s50
    v_mul_u32_u24 v11, 1280, v11
    v_lshl_add_u32 v11, v1, 4, v11
    v_cndmask_b32 v11, v11, 2.0, vcc
    s_mov_b32 s34, 1280
    s_mov_b32 s35, 0x00020000
    s_mov_b32 s38, 819200
    s_mov_b32 s39, 0x00020000
    s_lshl_b32 s62, s53, 1
    s_add_u32 s62, s62, s51
    s_mul_i32 s62, s62, 8
    s_add_u32 s62, s62, s61
    s_sub_u32 s62, s62, 64
    s_cmp_lt_u32 s48, 2
    s_cselect_b32 s62, s62, 640
    s_lshl3_add_u32 s63, s53, s51
    s_add_u32 s63, s63, 384
    s_cmp_lt_u32 s51, 8
    s_cselect_b32 s65, 3, 0
    s_cselect_b32 s62, s63, s62
    s_cselect_b32 s63, 192, 1
    v_lshlrev_b32 v58, 4, v0
    v_lshlrev_b32 v59, 2, v0
    s_waitcnt lgkmcnt(0)
    s_mov_b32 s28, s4
    s_and_b32 s29, s5, 0xffff
    s_mov_b32 s24, s22
    s_and_b32 s25, s23, 0xffff
    s_buffer_load_dword s54, s[24:27], 0
    s_mov_b32 s32, s12
    s_and_b32 s33, s13, 0xffff
    s_mov_b32 s36, s8
    s_and_b32 s37, s9, 0xffff
    s_cmp_lt_u32 s48, s65
    s_cbranch_scc0 A_nors
    buffer_load_dwordx4 v[20:23], v11, s[28:31], 0 offen offset:0
    buffer_load_dwordx4 v[24:27], v11, s[28:31], 0 offen offset:256
    buffer_load_dwordx4 v[28:31], v11, s[28:31], 0 offen offset:512
    buffer_load_dwordx4 v[32:35], v11, s[28:31], 0 offen offset:768
    buffer_load_dwordx4 v[36:39], v11, s[28:31], 0 offen offset:1024
    s_branch A_cons
A_nors:
    s_cmp_lg_u32 s48, 3
    s_cbranch_scc1 A_nowr
    buffer_load_dwordx4 v[48:51], v58, s[32:35], 0 offen
    buffer_load_dword v52, v59, s[32:35], 0 offen offset:1024
A_nowr:
    s_cmp_ge_u32 s62, 640
    s_cbranch_scc1 A_cons
    v_mul_u32_u24 v10, s63, v2
    v_add_u32 v10, s62, v10
    v_lshlrev_b32 v12, 4, v1
    v_mul_u32_u24 v11, 1280, v10
    v_add_u32 v11, v11, v12
    buffer_load_dwordx4 v[76:79], v12, s[32:35], 0 offen offset:0
    buffer_load_dwordx4 v[80:83], v12, s[32:35], 0 offen offset:256
    buffer_load_dwordx4 v[84:87], v12, s[32:35], 0 offen offset:512
    buffer_load_dwordx4 v[88:91], v12, s[32:35], 0 offen offset:768
    buffer_load_dwordx4 v[92:95], v12, s[32:35], 0 offen offset:1024
    buffer_load_dwordx4 v[20:23], v11, s[36:39], 0 offen offset:0
    buffer_load_dwordx4 v[24:27], v11, s[36:39], 0 offen offset:256
    buffer_load_dwordx4 v[28:31], v11, s[36:39], 0 offen offset:512
    buffer_load_dwordx4 v[32:35], v11, s[36:39], 0 offen offset:768
    buffer_load_dwordx4 v[36:39], v11, s[36:39], 0 offen offset:1024
    s_branch A_cons
LD_start:
    s_sub_u32 s60, s48, 4
    v_lshrrev_b32 v1, 3, v0
    v_lshrrev_b32 v2, 4, v0
    v_and_b32 v3, 7, v0
    s_mul_i32 s62, s60, 24
    s_add_u32 s63, s62, 0
    v_add_u32 v4, s63, v1
    v_lshrrev_b32 v5, 1, v4
    v_and_b32 v5, 7, v5
    v_xor_b32 v5, v5, v3
    v_add_u32 v4, s55, v4
    v_cmp_gt_i32 vcc, 0, v4
    v_lshl_add_u32 v4, v4, 1, s50
    v_mul_u32_u24 v4, 1280, v4
    v_lshl_add_u32 v4, v5, 4, v4
    v_cndmask_b32 v10, v4, 2.0, vcc
    s_add_u32 s63, s62, 8
    v_add_u32 v4, s63, v1
    v_lshrrev_b32 v5, 1, v4
    v_and_b32 v5, 7, v5
    v_xor_b32 v5, v5, v3
    v_add_u32 v4, s55, v4
    v_cmp_gt_i32 vcc, 0, v4
    v_lshl_add_u32 v4, v4, 1, s50
    v_mul_u32_u24 v4, 1280, v4
    v_lshl_add_u32 v4, v5, 4, v4
    v_cndmask_b32 v11, v4, 2.0, vcc
    s_add_u32 s63, s62, 16
    v_add_u32 v4, s63, v1
    v_lshrrev_b32 v5, 1, v4
    v_and_b32 v5, 7, v5
    v_xor_b32 v5, v5, v3
    v_add_u32 v4, s55, v4
    v_cmp_gt_i32 vcc, 0, v4
    v_lshl_add_u32 v4, v4, 1, s50
    v_mul_u32_u24 v4, 1280, v4
    v_lshl_add_u32 v4, v5, 4, v4
    v_cndmask_b32 v12, v4, 2.0, vcc
    s_lshl_b32 s62, s60, 3
    v_add_u32 v4, s62, v1
    v_mul_u32_u24 v5, 3840, v4
    v_and_b32 v6, 1, v2
    s_and_b32 s62, s60, 1
    s_lshl_b32 s62, s62, 2
    v_lshl_or_b32 v6, v6, 1, s62
    v_xor_b32 v6, v6, v3
    s_lshl_b32 s62, s51, 7
    v_lshl_add_u32 v6, v6, 4, s62
    v_add_u32 v13, v5, v6
    v_add_u32 v14, 256, v13
    v_add_u32 v15, 512, v13
    s_mul_i32 s66, s66, 5
    s_lshr_b32 s66, s66, 2
    s_mul_i32 s64, s60, 3072
    s_mov_b32 s65, s64
    s_add_u32 s70, s64, 110592
    s_mov_b32 s34, 2457600
    s_mov_b32 s35, 0x00020000
    s_getpc_b64 s[98:99]
LD_pc:
    s_add_u32 s98, s98, LD_cont-LD_pc
    s_addc_u32 s99, s99, 0
    s_waitcnt lgkmcnt(0)
    s_mov_b32 s28, s4
    s_and_b32 s29, s5, 0xffff
    s_mov_b32 s32, s6
    s_and_b32 s33, s7, 0xffff
LD_issue:
    s_mov_b32 m0, s65
    s_lshl_b32 s67, s66, 7
    buffer_load_dwordx4 v10, s[28:31], s67 offen lds
    s_add_u32 m0, s65, 1024
    s_mul_i32 s68, s66, 245760
    buffer_load_dwordx4 v11, s[28:31], s67 offen lds
    s_add_u32 m0, s65, 2048
    s_add_u32 s69, s68, 122880
    buffer_load_dwordx4 v12, s[28:31], s67 offen lds
    s_add_u32 m0, s65, 12288
    s_add_u32 s66, s66, 1
    buffer_load_dwordx4 v13, s[32:35], s68 offen offset:0 lds
    buffer_load_dwordx4 v14, s[32:35], s68 offen offset:1024 lds
    buffer_load_dwordx4 v15, s[32:35], s68 offen offset:2048 lds
    s_add_u32 m0, s65, 24576
    s_cmp_eq_u32 s66, 10
    s_cselect_b32 s66, 0, s66
    buffer_load_dwordx4 v13, s[32:35], s69 offen offset:0 lds
    buffer_load_dwordx4 v14, s[32:35], s69 offen offset:1024 lds
    buffer_load_dwordx4 v15, s[32:35], s69 offen offset:2048 lds
    s_add_u32 s65, s65, 36864
    s_cmp_eq_u32 s65, s70
    s_cselect_b32 s65, s64, s65
    s_setpc_b64 s[98:99]
LD_cont:
    s_mov_b32 s24, s22
    s_and_b32 s25, s23, 0xffff
    s_mov_b32 s36, s8
    s_and_b32 s37, s9, 0xffff
    s_mov_b32 s38, 819200
    s_mov_b32 s39, 0x00020000
    s_buffer_load_dword s54, s[24:27], 0
    v_mul_u32_u24 v5, 1280, v4
    v_lshlrev_b32 v7, 1, v2
    v_xor_b32 v7, v7, v3
    v_lshl_add_u32 v5, v7, 4, v5
    v_lshl_add_u32 v16, s51, 7, v5
    s_lshl_b32 s71, s53, 11
    s_add_u32 s71, s71, 81920
    s_mul_i32 s62, s60, 24
    v_add_u32 v17, s62, v0
    v_lshlrev_b32 v18, 4, v17
    v_cmp_gt_u32 vcc, 24, v0
    v_add_u32 v19, 72, v0
    v_lshlrev_b32 v19, 4, v19
    v_cndmask_b32 v18, v19, v18, vcc
    s_lshl_b32 s62, s51, 2
    s_add_u32 s62, s62, s60
    s_lshl_b32 s62, s62, 8
    s_sub_u32 s62, s62, s71
    s_add_u32 s62, s62, 1243488
    v_add_u32 v19, s62, v19
    v_cmp_lt_u32 vcc, 33, v0
    s_nop 1
    v_cndmask_b32 v18, v18, v19, vcc
    v_cmp_lt_u32 vcc, 49, v0
    s_nop 1
    v_cndmask_b32 v18, v18, 2.0, vcc
    v_mov_b32 v28, 0
    v_mov_b32 v29, 0
    v_mov_b32 v30, 0
    v_mov_b32 v31, 0
    s_lshl_b32 s62, s60, 6
    v_add_u32 v4, s62, v0
    v_lshlrev_b32 v35, 4, v4
    v_add_u32 v35, 135168, v35
    ds_write_b128 v35, v[28:31] offset:0
    ds_write_b128 v35, v[28:31] offset:4096
    ds_write_b128 v35, v[28:31] offset:8192
    ds_write_b128 v35, v[28:31] offset:12288
    ds_write_b128 v35, v[28:31] offset:16384
    ds_write_b128 v35, v[28:31] offset:20480
    v_mov_b32 v6, 159776
    ds_write_b64 v6, v[28:29]
    v_and_b32 v4, 31, v0
    v_lshlrev_b32 v5, 7, v4
    s_lshl_b32 s62, s51, 11
    v_add_u32 v6, s62, v5
    s_lshl_b32 s62, s51, 10
    s_add_u32 s62, s62, 18432
    v_add_u32 v7, s62, v5
    v_cmp_lt_u32 vcc, 15, v4
    s_nop 1
    v_cndmask_b32 v6, v6, v7, vcc
    s_lshl_b32 s62, s51, 8
    s_add_u32 s62, s62, 27648
    v_add_u32 v7, s62, v5
    v_cmp_lt_u32 vcc, 23, v4
    s_nop 1
    v_cndmask_b32 v6, v6, v7, vcc
    v_and_b32 v7, 128, v5
    v_add_u32 v7, 33280, v7
    v_cmp_lt_u32 vcc, 25, v4
    s_nop 1
    v_cndmask_b32 v6, v6, v7, vcc
    v_lshrrev_b32 v7, 5, v0
    v_mul_u32_u24 v7, 34560, v7
    v_add_u32 v36, v6, v7
    s_mov_b32 vcc_hi, 0xfc000000
    s_cmp_eq_u32 s60, 0
    s_cselect_b32 vcc_lo, 0xf0005555, vcc_hi
    v_cndmask_b32 v36, v36, 2.0, vcc
    s_call_b64 s[98:99], S_late
    s_call_b64 s[98:99], LD_issue
    s_waitcnt vmcnt(9) lgkmcnt(0)
    s_add_u32 s54, s54, 2654435761
    s_lshl_b32 s62, s60, 10
    s_add_u32 s62, s62, 36864
    s_add_u32 s63, s51, 3
    s_sub_u32 s61, s63, 10
    s_cselect_b32 s63, s63, s61
    s_mul_i32 s63, s63, 81920
    s_barrier
    s_bitcmp0_b32 s60, 0
    s_cselect_b32 s16, s14, s16
    s_cselect_b32 s17, s15, s17
    s_mov_b64 s[14:15], s[18:19]
    s_and_b32 s17, s17, 0xffff
    s_mov_b32 s18, 1966080
    s_mov_b32 s19, 0x00020000
    s_lshr_b32 s58, s60, 1
    s_lshl1_add_u32 s58, s2, s58
    s_mul_i32 s61, s58, 21846
    s_lshr_b32 s61, s61, 16
    s_mul_i32 s67, s61, 3
    s_sub_u32 s58, s58, s67
    s_mul_i32 s61, s61, 3072
    s_lshl_b32 s58, s58, 10
    s_add_u32 s58, s58, s61
    s_cmp_lt_u32 s61, 73728
    s_cselect_b32 s58, 2.0, s58
    s_buffer_load_dword s59, s[16:19], s58 offset:384
    s_buffer_load_dword s59, s[16:19], s58 offset:448
    s_buffer_load_dword s59, s[16:19], s58 offset:491904
    s_buffer_load_dword s59, s[16:19], s58 offset:491968
    s_add_u32 s58, s58, 983040
    s_call_b64 s[98:99], LD_issue
    s_call_b64 s[98:99], S_late2
    s_waitcnt vmcnt(9)
    s_barrier
    s_buffer_load_dword s59, s[16:19], s58 offset:384
    s_buffer_load_dword s59, s[16:19], s58 offset:448
    s_buffer_load_dword s59, s[16:19], s58 offset:491904
    s_buffer_load_dword s59, s[16:19], s58 offset:491968
    s_call_b64 s[98:99], LD_issue
    s_call_b64 s[98:99], S_late3
    s_waitcnt vmcnt(9)
    s_barrier
    s_call_b64 s[98:99], LD_issue
    s_call_b64 s[98:99], S_late4
    s_waitcnt vmcnt(9)
    s_barrier
    s_call_b64 s[98:99], LD_issue
    s_waitcnt vmcnt(9)
    s_barrier
    s_call_b64 s[98:99], LD_issue
    s_waitcnt vmcnt(9)
    s_barrier
    s_call_b64 s[98:99], LD_issue
    s_waitcnt vmcnt(9)
    s_barrier
    s_call_b64 s[98:99], LD_issue
    s_waitcnt vmcnt(9)
    s_barrier
    buffer_load_dwordx4 v[20:23], v18, s[24:27], s71 offen sc1
    s_call_b64 s[98:99], LD_issue
    s_waitcnt vmcnt(9)
    s_barrier
    ds_read_b32 v24, v251 offset:2288
    s_mov_b32 m0, s62
    s_add_u32 s62, s62, 4096
    buffer_load_dwordx4 v16, s[36:39], s63 offen lds
    s_add_u32 s63, s63, 40960
    s_mov_b32 m0, s62
    s_add_u32 s62, s62, 4096
    buffer_load_dwordx4 v16, s[36:39], s63 offen lds
    s_add_u32 s63, s63, 40960
    s_cmp_eq_u32 s63, 819200
    s_cselect_b32 s63, 0, s63
    s_mov_b32 m0, s62
    s_add_u32 s62, s62, 4096
    buffer_load_dwordx4 v16, s[36:39], s63 offen lds
    s_add_u32 s63, s63, 40960
    s_mov_b32 m0, s62
    s_add_u32 s62, s62, 4096
    buffer_load_dwordx4 v16, s[36:39], s63 offen lds
    s_add_u32 s63, s63, 40960
    s_cmp_eq_u32 s63, 819200
    s_cselect_b32 s63, 0, s63
    s_mov_b32 m0, s62
    s_add_u32 s62, s62, 4096
    buffer_load_dwordx4 v16, s[36:39], s63 offen lds
    s_add_u32 s63, s63, 40960
    s_mov_b32 m0, s62
    s_add_u32 s62, s62, 4096
    buffer_load_dwordx4 v16, s[36:39], s63 offen lds
    s_add_u32 s63, s63, 40960
    s_cmp_eq_u32 s63, 819200
    s_cselect_b32 s63, 0, s63
    s_mov_b32 m0, s62
    s_add_u32 s62, s62, 4096
    buffer_load_dwordx4 v16, s[36:39], s63 offen lds
    s_add_u32 s63, s63, 40960
    s_mov_b32 m0, s62
    s_add_u32 s62, s62, 4096
    buffer_load_dwordx4 v16, s[36:39], s63 offen lds
    s_add_u32 s63, s63, 40960
    s_cmp_eq_u32 s63, 819200
    s_cselect_b32 s63, 0, s63
    s_mov_b32 m0, s62
    s_add_u32 s62, s62, 4096
    buffer_load_dwordx4 v16, s[36:39], s63 offen lds
    s_add_u32 s63, s63, 40960
    s_mov_b32 exec_hi, 3
    v_cmp_ne_u32 vcc, s54, v22
    s_cbranch_vccz LD_rs
LD_rsp:
    buffer_load_dwordx4 v[20:23], v18, s[24:27], s71 offen sc1
    s_waitcnt vmcnt(0)
    v_cmp_ne_u32 vcc, s54, v22
    s_cbranch_vccz LD_rs
    s_sleep 1
    s_sub_u32 s3, s3, 1
    s_cbranch_scc0 LD_rsp
    s_mov_b32 s3, 0
LD_rs:
    s_getreg_b32 s61, hwreg(HW_REG_XCC_ID)
    v_cmp_ne_u32 vcc, s61, v20
    s_lshr_b64 vcc, vcc, 24
    s_cselect_b32 s49, 0, 1
    s_lshl_b32 s61, s60, 5
    s_add_u32 s61, s61, 160828
    s_mov_b32 exec_hi, 0x3fffc
    s_mov_b32 exec_lo, 0
    v_cmp_eq_u32 vcc, s54, v22
    v_lshl_add_u32 v4, v0, 1, s61
    s_waitcnt lgkmcnt(0)
    v_mul_f32 v24, 0xbacccccd, v24
    v_fmac_f32 v21, v20, v24
    v_cndmask_b32 v21, 0, v21, vcc
    ds_write_b16_d16_hi v4, v21
    s_mov_b32 exec_hi, 0
    s_mov_b32 exec_lo, 0xffffff
    v_lshlrev_b32 v4, 3, v17
    v_add_u32 v4, 159808, v4
    ds_write_b64 v4, v[20:21]
    v_mov_b32 v4, 160768
    v_mov_b32 v5, s49
    ds_write_b32 v4, v5
    ds_write_b64 v4, v[28:29] offset:8
    ds_write_b64 v4, v[28:29] offset:16
    ds_write_b64 v4, v[28:29] offset:24
    s_mov_b64 exec, -1
    s_waitcnt vmcnt(9) lgkmcnt(0)
    s_barrier
    s_mov_b32 m0, s62
    s_add_u32 s62, s62, 4096
    buffer_load_dwordx4 v16, s[36:39], s63 offen lds
    s_add_u32 s63, s63, 40960
    s_cmp_eq_u32 s63, 819200
    s_cselect_b32 s63, 0, s63
    s_mov_b32 m0, s62
    s_add_u32 s62, s62, 4096
    buffer_load_dwordx4 v16, s[36:39], s63 offen lds
    s_add_u32 s63, s63, 40960
    s_mov_b32 m0, s62
    s_add_u32 s62, s62, 4096
    buffer_load_dwordx4 v16, s[36:39], s63 offen lds
    s_add_u32 s63, s63, 40960
    s_cmp_eq_u32 s63, 819200
    s_cselect_b32 s63, 0, s63
    s_mov_b32 m0, s62
    s_add_u32 s62, s62, 4096
    buffer_load_dwordx4 v16, s[36:39], s63 offen lds
    s_add_u32 s63, s63, 40960
    s_mov_b32 m0, s62
    s_add_u32 s62, s62, 4096
    buffer_load_dwordx4 v16, s[36:39], s63 offen lds
    s_add_u32 s63, s63, 40960
    s_cmp_eq_u32 s63, 819200
    s_cselect_b32 s63, 0, s63
    s_cmp_eq_u32 s60, 3
    s_cbranch_scc1 pf_1
    s_mul_i32 s67, s53, 6
    s_lshl_b32 s68, s60, 1
    s_add_u32 s67, s67, s68
    s_mul_i32 s67, s67, 34560
    s_add_u32 s67, s67, 1310720
    buffer_load_dword v182, v36, s[24:27], s67 offen sc1
    s_mov_b64 exec, -1
    s_branch pf_2
pf_1:
    v_lshlrev_b32 v4, 7, v0
    s_mov_b64 exec, 7
    buffer_load_dword v182, v4, s[24:27], s57 offen sc1
    s_mov_b64 exec, -1
pf_2:
    v_mov_b32 v99, v16
    s_mov_b64 exec, 0
    s_cmp_eq_u32 s60, 0
    s_cbranch_scc1 HA0_0
    s_cmp_eq_u32 s60, 1
    s_cbranch_scc1 HA1_0
    s_cmp_eq_u32 s60, 2
    s_cbranch_scc1 HA2_0
    s_branch HA3_0
HA_ret:
    s_mov_b64 exec, -1
    s_branch AT_start
S_late:
    v_and_b32 v200, 15, v0
    v_lshrrev_b32 v201, 4, v0
    v_lshlrev_b32 v202, 4, v0
    v_lshlrev_b32 v203, 2, v0
    v_lshrrev_b32 v64, 5, v0
    v_and_b32 v65, 12, v200
    s_mov_b32 s40, s20
    s_and_b32 s41, s21, 0xffff
    s_mov_b32 s42, 2621440
    s_mov_b32 s43, 0x00020000
    s_lshl_b32 s4, s52, 3
    s_sub_u32 s4, 96768, s4
    s_min_u32 s5, s48, 5
    s_lshl_b32 s6, s5, 4
    v_add_u32 v67, s6, v200
    v_mul_u32_u24 v68, 400, v67
    v_mad_u32_u24 v66, v201, 40, s4
    v_add_u32 v71, v68, v66
    v_subrev_u32 v205, 3072, v71
    v_mul_u32_u24 v72, 5, v201
    v_subrev_u32 v72, s52, v72
    v_mov_b32 v73, 159776
    v_add_u32 v74, 0, v72
    v_cmp_gt_u32 vcc, 16, v74
    v_add_u32 v74, 0, v71
    s_nop 0
    v_cndmask_b32 v204, v73, v74, vcc
    v_add_u32 v74, 1, v72
    v_cmp_gt_u32 vcc, 16, v74
    v_add_u32 v74, 8, v71
    s_nop 0
    v_cndmask_b32 v229, v73, v74, vcc
    v_add_u32 v74, 2, v72
    v_cmp_gt_u32 vcc, 16, v74
    v_add_u32 v74, 16, v71
    s_nop 0
    v_cndmask_b32 v230, v73, v74, vcc
    v_add_u32 v74, 3, v72
    v_cmp_gt_u32 vcc, 16, v74
    v_add_u32 v74, 24, v71
    s_nop 0
    v_cndmask_b32 v231, v73, v74, vcc
    v_add_u32 v74, 4, v72
    v_cmp_gt_u32 vcc, 16, v74
    v_add_u32 v74, 32, v71
    s_nop 0
    v_cndmask_b32 v255, v73, v74, vcc
    v_lshlrev_b32 v208, 3, v67
    v_add_u32 v208, 159808, v208
    v_add_u32 v69, s6, v65
    v_lshlrev_b32 v209, 3, v69
    v_add_u32 v209, 159748, v209
    v_and_b32 v70, 3, v0
    v_cmp_gt_u32 vcc, 1, v70
    v_mov_b32 v73, s47
    s_nop 0
    v_cndmask_b32 v207, 0, v73, vcc
    v_cmp_gt_u32 vcc, 3, v70
    s_nop 1
    v_cndmask_b32 v211, 0, v73, vcc
    v_cmp_gt_u32 vcc, 2, v70
    s_nop 1
    v_cndmask_b32 v211, v211, -1, vcc
    s_setpc_b64 s[98:99]
S_late2:
    s_lshl_b32 s7, s5, 12
    s_add_u32 s7, s7, 135184
    v_lshl_add_u32 v66, v0, 6, s7
    v_lshl_add_u32 v210, v65, 1, v66
    s_add_u32 s13, s6, s55
    v_add_u32 v212, s13, v65
    s_mul_i32 s8, s53, 6
    s_mul_i32 s9, s8, 34560
    s_add_u32 s9, s9, 1310720
    s_mul_i32 s0, s48, 34560
    s_add_u32 s0, s0, s9
    s_lshl_b32 s7, s51, 10
    s_add_u32 s12, s0, s7
    s_add_u32 s12, s12, 19456
    v_lshlrev_b32 v206, 4, v200
    v_lshl_add_u32 v206, v64, 8, v206
    v_xor_b32 v213, 256, v206
    v_lshl_add_u32 v213, v64, 11, v213
    s_cmp_lg_u32 s52, 0
    s_cselect_b32 s20, 0x0000ffff, 0
    s_cmp_lg_u32 s52, 4
    s_cselect_b32 s21, s47, 0
    s_lshl_b32 s7, s51, 11
    s_add_u32 s22, s0, s7
    s_add_u32 s100, s9, 33280
    s_lshr_b32 s7, s51, 1
    s_mul_i32 s7, s7, 33792
    s_mul_i32 s57, s51, 384
    s_add_u32 s7, s7, s57
    s_add_u32 s7, s7, 33792
    s_add_u32 s57, s7, s9
    s_mul_i32 s7, s48, 10
    s_add_u32 s7, s7, s51
    s_lshl_b32 s7, s7, 2
    s_add_u32 s23, s100, s7
    s_sub_u32 s56, s48, 2
    s_cmp_lt_u32 s48, 6
    s_cselect_b32 s101, 0, 1
    s_cselect_b32 s56, s48, s56
    s_mul_i32 s1, s56, 34560
    s_add_u32 s1, s1, s9
    s_add_u32 s8, s8, s56
    s_mul_i32 s44, s53, 2560
    s_lshl_b32 s7, s51, 8
    s_add_u32 s44, s44, s7
    s_add_u32 s44, s44, 262144
    s_lshl_b32 s45, s53, 6
    s_add_u32 s45, s45, 196608
    s_setpc_b64 s[98:99]
S_late3:
    v_bfe_u32 v68, v0, 2, 2
    v_and_b32 v69, 3, v0
    v_lshl_add_u32 v70, v201, 3, v68
    s_lshl_b32 s7, s48, 4
    s_sub_u32 s7, s7, 16
    v_add_u32 v71, s7, v70
    v_and_b32 v72, 15, v71
    v_max_i32 v71, v71, v72
    v_mul_u32_u24 v71, 400, v71
    v_lshl_add_u32 v71, v69, 3, v71
    v_add_u32 v214, 97024, v71
    v_and_b32 v72, 1, v201
    s_cmp_eq_u32 s48, 0
    s_cselect_b32 s7, 8, 0
    v_cmp_gt_u32 vcc, s7, v200
    s_nop 1
    v_cndmask_b32 v249, v202, 2.0, vcc
    v_lshrrev_b32 v71, 1, v68
    v_lshl_or_b32 v71, v72, 1, v71
    v_lshl_add_u32 v70, v201, 2, v68
    v_lshlrev_b32 v70, 7, v70
    v_lshl_add_u32 v70, v69, 3, v70
    s_mul_i32 s7, s101, 40960
    s_add_u32 s7, s7, 12288
    v_add_u32 v70, s7, v70
    s_mul_i32 s7, s101, 36864
    s_sub_u32 s7, 40960, s7
    v_xor_b32 v73, 0, v71
    v_lshl_add_u32 v216, v73, 5, v70
    v_add_u32 v220, s7, v216
    v_xor_b32 v73, 1, v71
    v_lshl_add_u32 v217, v73, 5, v70
    v_add_u32 v221, s7, v217
    v_xor_b32 v73, 2, v71
    v_lshl_add_u32 v218, v73, 5, v70
    v_add_u32 v222, s7, v218
    v_xor_b32 v73, 3, v71
    v_lshl_add_u32 v219, v73, 5, v70
    v_add_u32 v223, s7, v219
    s_setpc_b64 s[98:99]
S_late4:
    s_lshl_b32 s7, s56, 4
    v_add_u32 v73, s7, v200
    v_cmp_gt_u32 vcc, 10, v73
    v_add_u32 v73, s55, v73
    v_lshl_add_u32 v73, v73, 1, s50
    v_mul_u32_u24 v74, 1280, v73
    s_lshl_b32 s7, s51, 7
    v_lshl_add_u32 v75, v201, 3, s7
    v_add_u32 v74, v74, v75
    v_cndmask_b32 v253, v74, 2.0, vcc
    v_cndmask_b32 v254, v73, -1, vcc
    v_add_u32 v227, 161792, v75
    v_mul_u32_u24 v224, 61440, v201
    v_lshl_add_u32 v224, v200, 4, v224
    s_mov_b32 s7, 161024
    v_lshl_add_u32 v228, v201, 5, s7
    v_lshl_add_u32 v252, v69, 5, s7
    v_lshl_add_u32 v252, v68, 3, v252
    v_mul_u32_u24 v225, 24, v72
    v_add_u32 v225, v225, v253
    v_lshl_add_u32 v226, s8, 4, v200
    s_cmp_eq_u32 s101, 1
    s_cselect_b64 vcc, -1, 0
    v_cndmask_b32 v250, v225, 2.0, vcc
    v_mov_b32 v251, 160784
    s_lshl_b32 s7, s48, 12
    s_add_u32 s7, s7, 135168
    v_lshl_add_u32 v73, v200, 6, s7
    v_lshl_add_u32 v73, v201, 4, v73
    v_add_u32 v74, s52, v201
    s_add_u32 s46, s52, 0
    s_mul_i32 s46, s46, 52
    s_lshr_b32 s46, s46, 8
    v_lshl_add_u32 v172, s46, 10, v73
    s_add_u32 s46, s52, 3
    s_mul_i32 s46, s46, 52
    s_lshr_b32 s46, s46, 8
    v_lshl_add_u32 v173, s46, 10, v73
    s_mul_i32 s46, s46, 5
    s_sub_u32 s46, s46, 0
    v_cmp_le_i32 s[4:5], s46, v74
    s_add_u32 s46, s52, 4
    s_mul_i32 s46, s46, 52
    s_lshr_b32 s46, s46, 8
    v_lshl_add_u32 v174, s46, 10, v73
    s_add_u32 s46, s52, 7
    s_mul_i32 s46, s46, 52
    s_lshr_b32 s46, s46, 8
    v_lshl_add_u32 v175, s46, 10, v73
    s_mul_i32 s46, s46, 5
    s_sub_u32 s46, s46, 4
    v_cmp_le_i32 s[6:7], s46, v74
    s_add_u32 s46, s52, 8
    s_mul_i32 s46, s46, 52
    s_lshr_b32 s46, s46, 8
    v_lshl_add_u32 v176, s46, 10, v73
    s_add_u32 s46, s52, 11
    s_mul_i32 s46, s46, 52
    s_lshr_b32 s46, s46, 8
    v_lshl_add_u32 v177, s46, 10, v73
    s_mul_i32 s46, s46, 5
    s_sub_u32 s46, s46, 8
    v_cmp_le_i32 s[8:9], s46, v74
    s_add_u32 s46, s52, 12
    s_mul_i32 s46, s46, 52
    s_lshr_b32 s46, s46, 8
    v_lshl_add_u32 v178, s46, 10, v73
    s_add_u32 s46, s52, 15
    s_mul_i32 s46, s46, 52
    s_lshr_b32 s46, s46, 8
    v_lshl_add_u32 v179, s46, 10, v73
    s_mul_i32 s46, s46, 5
    s_sub_u32 s46, s46, 12
    v_cmp_le_i32 s[10:11], s46, v74
    s_setpc_b64 s[98:99]
A_cons:
    v_mov_b32 v99, 2.0
    v_lshrrev_b32 v3, 1, v1
    v_xor_b32 v3, v3, v2
    v_lshlrev_b32 v3, 4, v3
    v_lshl_add_u32 v4, v1, 7, v3
    v_xor_b32 v5, 64, v4
    v_cmp_eq_u32 vcc, 0, v1
    v_mov_b32 v3, 159744
    s_nop 0
    v_cndmask_b32 v6, v4, v3, vcc
    v_cndmask_b32 v7, v5, v3, vcc
    v_cndmask_b32 v8, 1, 0, vcc
    v_bfe_u32 v14, v0, 2, 2
    v_and_b32 v15, 3, v0
    v_lshrrev_b32 v16, 1, v14
    v_and_b32 v17, 1, v2
    v_lshl_or_b32 v16, v17, 1, v16
    v_xor_b32 v16, s48, v16
    v_lshlrev_b32 v16, 5, v16
    v_lshl_add_u32 v16, v15, 3, v16
    v_lshl_add_u32 v16, v14, 7, v16
    v_mul_u32_u24 v17, 3072, v2
    v_add_u32 v9, v16, v17
    v_mov_b32 v16, 0x3f803f80
    v_mov_b32 v17, v16
    v_mov_b32 v18, v16
    v_mov_b32 v19, v16
    ds_write_b128 v3, v[16:19]
    v_mov_b64 v[100:101], 0
    v_mov_b64 v[102:103], 0
    v_mov_b64 v[104:105], 0
    v_mov_b64 v[106:107], 0
    v_mov_b64 v[108:109], 0
    v_mov_b64 v[110:111], 0
    v_mov_b64 v[112:113], 0
    v_mov_b64 v[114:115], 0
    v_mov_b64 v[116:117], 0
    v_mov_b64 v[118:119], 0
    v_mov_b64 v[120:121], 0
    v_mov_b64 v[122:123], 0
    v_mov_b64 v[124:125], 0
    v_mov_b64 v[126:127], 0
    v_mov_b64 v[128:129], 0
    v_mov_b64 v[130:131], 0
    v_mov_b64 v[132:133], 0
    v_mov_b64 v[134:135], 0
    v_mov_b64 v[136:137], 0
    v_mov_b64 v[138:139], 0
    v_mov_b64 v[140:141], 0
    v_mov_b64 v[142:143], 0
    v_mov_b64 v[144:145], 0
    v_mov_b64 v[146:147], 0
    v_mov_b64 v[148:149], 0
    v_mov_b64 v[150:151], 0
    v_mov_b64 v[152:153], 0
    v_mov_b64 v[154:155], 0
    v_mov_b64 v[156:157], 0
    v_mov_b64 v[158:159], 0
    v_mov_b64 v[160:161], 0
    v_mov_b64 v[162:163], 0
    v_mov_b64 v[164:165], 0
    v_mov_b64 v[166:167], 0
    v_mov_b64 v[168:169], 0
    v_mov_b64 v[170:171], 0
    s_call_b64 s[98:99], S_late
    s_call_b64 s[98:99], S_late2
    s_call_b64 s[98:99], S_late3
    s_call_b64 s[98:99], S_late4
    s_waitcnt lgkmcnt(0)
    s_add_u32 s54, s54, 2654435761
    s_lshl_b32 s63, s53, 11
    s_add_u32 s63, s63, 81920
    v_mov_b32 v42, s54
    v_lshlrev_b32 v10, 4, v10
    s_cmp_lt_u32 s48, s65
    s_cbranch_scc0 A_nos
    s_waitcnt vmcnt(4)
    v_dot2_f32_bf16 v40, v20, v16, 0
    v_dot2_f32_bf16 v41, v20, v20, 0
    v_dot2_f32_bf16 v44, v21, v16, 0
    v_dot2_f32_bf16 v45, v21, v21, 0
    v_dot2_f32_bf16 v40, v22, v16, v40
    v_dot2_f32_bf16 v41, v22, v22, v41
    v_dot2_f32_bf16 v44, v23, v16, v44
    v_dot2_f32_bf16 v45, v23, v23, v45
    s_waitcnt vmcnt(3)
    v_dot2_f32_bf16 v40, v24, v16, v40
    v_dot2_f32_bf16 v41, v24, v24, v41
    v_dot2_f32_bf16 v44, v25, v16, v44
    v_dot2_f32_bf16 v45, v25, v25, v45
    v_dot2_f32_bf16 v40, v26, v16, v40
    v_dot2_f32_bf16 v41, v26, v26, v41
    v_dot2_f32_bf16 v44, v27, v16, v44
    v_dot2_f32_bf16 v45, v27, v27, v45
    s_waitcnt vmcnt(2)
    v_dot2_f32_bf16 v40, v28, v16, v40
    v_dot2_f32_bf16 v41, v28, v28, v41
    v_dot2_f32_bf16 v44, v29, v16, v44
    v_dot2_f32_bf16 v45, v29, v29, v45
    v_dot2_f32_bf16 v40, v30, v16, v40
    v_dot2_f32_bf16 v41, v30, v30, v41
    v_dot2_f32_bf16 v44, v31, v16, v44
    v_dot2_f32_bf16 v45, v31, v31, v45
    s_waitcnt vmcnt(1)
    v_dot2_f32_bf16 v40, v32, v16, v40
    v_dot2_f32_bf16 v41, v32, v32, v41
    v_dot2_f32_bf16 v44, v33, v16, v44
    v_dot2_f32_bf16 v45, v33, v33, v45
    v_dot2_f32_bf16 v40, v34, v16, v40
    v_dot2_f32_bf16 v41, v34, v34, v41
    v_dot2_f32_bf16 v44, v35, v16, v44
    v_dot2_f32_bf16 v45, v35, v35, v45
    s_waitcnt vmcnt(0)
    v_dot2_f32_bf16 v40, v36, v16, v40
    v_dot2_f32_bf16 v41, v36, v36, v41
    v_dot2_f32_bf16 v44, v37, v16, v44
    v_dot2_f32_bf16 v45, v37, v37, v45
    v_dot2_f32_bf16 v40, v38, v16, v40
    v_dot2_f32_bf16 v41, v38, v38, v41
    v_dot2_f32_bf16 v44, v39, v16, v44
    v_dot2_f32_bf16 v45, v39, v39, v45
A_red:
    s_nop 1
    v_add_f32 v40, v40, v44
    v_add_f32 v41, v41, v45
    s_nop 0
    v_add_f32_dpp v40, v40, v40 row_ror:1 row_mask:0xf bank_mask:0xf
    v_add_f32_dpp v41, v41, v41 row_ror:1 row_mask:0xf bank_mask:0xf
    s_nop 0
    v_add_f32_dpp v40, v40, v40 row_ror:2 row_mask:0xf bank_mask:0xf
    v_add_f32_dpp v41, v41, v41 row_ror:2 row_mask:0xf bank_mask:0xf
    s_nop 0
    v_add_f32_dpp v40, v40, v40 row_ror:4 row_mask:0xf bank_mask:0xf
    v_add_f32_dpp v41, v41, v41 row_ror:4 row_mask:0xf bank_mask:0xf
    s_nop 0
    v_add_f32_dpp v40, v40, v40 row_ror:8 row_mask:0xf bank_mask:0xf
    v_add_f32_dpp v41, v41, v41 row_ror:8 row_mask:0xf bank_mask:0xf
    s_cselect_b32 s64, s63, 1245184
    s_cbranch_scc0 A_nln
    v_mul_f32 v40, 0x3acccccd, v40
    v_mul_f32 v41, 0x3acccccd, v41
    v_fma_f32 v41, -v40, v40, v41
    v_max_f32 v41, 0, v41
    v_cvt_pk_bf16_f32 v41, v41, v41
    v_and_b32 v41, 0xffff0000, v41
    v_add_f32 v41, 0x3727c5ac, v41
    v_cvt_pk_bf16_f32 v41, v41, v41
    v_and_b32 v41, 0xffff0000, v41
    v_sqrt_f32 v41, v41
    v_cvt_pk_bf16_f32 v40, v40, v40
    v_and_b32 v40, 0xffff0000, v40
    v_cvt_pk_bf16_f32 v41, v41, v41
    v_and_b32 v41, 0xffff0000, v41
    v_rcp_f32 v41, v41
A_nln:
    s_mov_b32 exec_lo, 0x00010001
    s_mov_b32 exec_hi, 0x00010001
    buffer_store_dwordx3 v[40:42], v10, s[24:27], s64 offen sc1
    s_mov_b64 exec, -1
A_w3:
    s_cmp_lg_u32 s48, 3
    s_cbranch_scc1 A_go
    s_getreg_b32 s61, hwreg(HW_REG_XCC_ID)
    s_lshl_b32 s64, s51, 4
    s_add_u32 s64, s64, 1536
    v_mov_b32 v44, s61
    v_mov_b32 v43, s64
    v_mov_b32 v46, s54
    s_mov_b64 exec, 1
    buffer_store_dwordx3 v[44:46], v43, s[24:27], s63 offen sc1
    s_mov_b64 exec, -1
    v_add_u32 v58, 161792, v58
    v_add_u32 v59, 161792, v59
    s_cmp_lt_u32 s62, 640
    s_cbranch_scc1 A_w3l
    s_waitcnt vmcnt(1)
A_w3l:
    ds_write_b128 v58, v[48:51]
    ds_write_b32 v59, v52 offset:1024
    v_dot2_f32_bf16 v25, v48, v16, 0
    v_dot2_f32_bf16 v25, v49, v16, v25
    v_dot2_f32_bf16 v25, v50, v16, v25
    v_dot2_f32_bf16 v25, v51, v16, v25
    v_dot2_f32_bf16 v25, v52, v16, v25
    s_nop 2
    v_add_f32_dpp v25, v25, v25 row_ror:1 row_mask:0xf bank_mask:0xf
    s_nop 1
    v_add_f32_dpp v25, v25, v25 row_ror:2 row_mask:0xf bank_mask:0xf
    s_nop 1
    v_add_f32_dpp v25, v25, v25 row_ror:4 row_mask:0xf bank_mask:0xf
    s_nop 1
    v_add_f32_dpp v25, v25, v25 row_ror:8 row_mask:0xf bank_mask:0xf
    v_mov_b32 v26, v25
    s_nop 1
    v_permlane32_swap_b32 v25, v26
    v_add_f32 v25, v25, v26
    v_mov_b32 v26, v25
    s_nop 1
    v_permlane16_swap_b32 v25, v26
    v_add_f32 v25, v25, v26
    v_mov_b32 v58, 161792
    ds_write_b32 v58, v25 offset:1280
    s_waitcnt lgkmcnt(0)
    s_branch A_go
A_nos:
    s_cmp_ge_u32 s62, 640
    s_cbranch_scc1 A_w3
    s_waitcnt vmcnt(4)
    v_dot2_f32_bf16 v40, v20, v16, 0
    v_dot2_f32_bf16 v41, v20, v76, 0
    v_dot2_f32_bf16 v44, v21, v16, 0
    v_dot2_f32_bf16 v45, v21, v77, 0
    v_dot2_f32_bf16 v40, v22, v16, v40
    v_dot2_f32_bf16 v41, v22, v78, v41
    v_dot2_f32_bf16 v44, v23, v16, v44
    v_dot2_f32_bf16 v45, v23, v79, v45
    s_waitcnt vmcnt(3)
    v_dot2_f32_bf16 v40, v24, v16, v40
    v_dot2_f32_bf16 v41, v24, v80, v41
    v_dot2_f32_bf16 v44, v25, v16, v44
    v_dot2_f32_bf16 v45, v25, v81, v45
    v_dot2_f32_bf16 v40, v26, v16, v40
    v_dot2_f32_bf16 v41, v26, v82, v41
    v_dot2_f32_bf16 v44, v27, v16, v44
    v_dot2_f32_bf16 v45, v27, v83, v45
    s_waitcnt vmcnt(2)
    v_dot2_f32_bf16 v40, v28, v16, v40
    v_dot2_f32_bf16 v41, v28, v84, v41
    v_dot2_f32_bf16 v44, v29, v16, v44
    v_dot2_f32_bf16 v45, v29, v85, v45
    v_dot2_f32_bf16 v40, v30, v16, v40
    v_dot2_f32_bf16 v41, v30, v86, v41
    v_dot2_f32_bf16 v44, v31, v16, v44
    v_dot2_f32_bf16 v45, v31, v87, v45
    s_waitcnt vmcnt(1)
    v_dot2_f32_bf16 v40, v32, v16, v40
    v_dot2_f32_bf16 v41, v32, v88, v41
    v_dot2_f32_bf16 v44, v33, v16, v44
    v_dot2_f32_bf16 v45, v33, v89, v45
    v_dot2_f32_bf16 v40, v34, v16, v40
    v_dot2_f32_bf16 v41, v34, v90, v41
    v_dot2_f32_bf16 v44, v35, v16, v44
    v_dot2_f32_bf16 v45, v35, v91, v45
    s_waitcnt vmcnt(0)
    v_dot2_f32_bf16 v40, v36, v16, v40
    v_dot2_f32_bf16 v41, v36, v92, v41
    v_dot2_f32_bf16 v44, v37, v16, v44
    v_dot2_f32_bf16 v45, v37, v93, v45
    v_dot2_f32_bf16 v40, v38, v16, v40
    v_dot2_f32_bf16 v41, v38, v94, v41
    v_dot2_f32_bf16 v44, v39, v16, v44
    v_dot2_f32_bf16 v45, v39, v95, v45
    s_branch A_red
A_go:
    v_lshlrev_b32 v15, 3, v1
    v_add_u32 v15, 159808, v15
    v_mul_u32_u24 v16, 400, v1
    v_lshl_add_u32 v16, v2, 3, v16
    s_lshl_b32 s60, s48, 5
    s_add_u32 s60, s60, 96768
    v_add_u32 v16, s60, v16
    v_mov_b32 v17, 160768
    s_mov_b32 s60, 0
    v_add_u32 v14, s60, v9
    v_mad_u32_u24 v10, v8, s60, v6
    v_add_u32 v12, s60, v4
    v_mad_u32_u24 v11, v8, s60, v7
    v_add_u32 v13, s60, v5
    s_mov_b32 s61, 0
    s_barrier
    ds_read_b64_tr_b16 v[44:45], v14 offset:12288
    ds_read_b64_tr_b16 v[46:47], v14 offset:12800
    ds_read_b64_tr_b16 v[48:49], v14 offset:13312
    ds_read_b64_tr_b16 v[50:51], v14 offset:13824
    ds_read_b64_tr_b16 v[52:53], v14 offset:14336
    ds_read_b64_tr_b16 v[54:55], v14 offset:14848
    ds_read_b128 v[20:23], v10
    ds_read_b128 v[24:27], v12 offset:2048
    ds_read_b128 v[28:31], v12 offset:4096
    ds_read_b128 v[32:35], v12 offset:6144
    ds_read_b128 v[36:39], v12 offset:8192
    ds_read_b128 v[40:43], v12 offset:10240
A_loop:
    s_waitcnt lgkmcnt(0)
    v_mfma_f32_16x16x32_bf16 v[100:103], v[44:47], v[20:23], v[100:103]
    ds_read_b64_tr_b16 v[80:81], v14 offset:24576
    v_mfma_f32_16x16x32_bf16 v[104:107], v[48:51], v[20:23], v[104:107]
    ds_read_b64_tr_b16 v[82:83], v14 offset:25088
    v_mfma_f32_16x16x32_bf16 v[108:111], v[52:55], v[20:23], v[108:111]
    ds_read_b64_tr_b16 v[84:85], v14 offset:25600
    v_mfma_f32_16x16x32_bf16 v[112:115], v[44:47], v[24:27], v[112:115]
    ds_read_b64_tr_b16 v[86:87], v14 offset:26112
    v_mfma_f32_16x16x32_bf16 v[116:119], v[48:51], v[24:27], v[116:119]
    ds_read_b64_tr_b16 v[88:89], v14 offset:26624
    v_mfma_f32_16x16x32_bf16 v[120:123], v[52:55], v[24:27], v[120:123]
    ds_read_b64_tr_b16 v[90:91], v14 offset:27136
    v_mfma_f32_16x16x32_bf16 v[124:127], v[44:47], v[28:31], v[124:127]
    ds_read_b128 v[56:59], v11
    v_mfma_f32_16x16x32_bf16 v[128:131], v[48:51], v[28:31], v[128:131]
    ds_read_b128 v[60:63], v13 offset:2048
    v_mfma_f32_16x16x32_bf16 v[132:135], v[52:55], v[28:31], v[132:135]
    ds_read_b128 v[64:67], v13 offset:4096
    v_mfma_f32_16x16x32_bf16 v[136:139], v[44:47], v[32:35], v[136:139]
    ds_read_b128 v[68:71], v13 offset:6144
    v_mfma_f32_16x16x32_bf16 v[140:143], v[48:51], v[32:35], v[140:143]
    ds_read_b128 v[72:75], v13 offset:8192
    v_mfma_f32_16x16x32_bf16 v[144:147], v[52:55], v[32:35], v[144:147]
    ds_read_b128 v[76:79], v13 offset:10240
    v_mfma_f32_16x16x32_bf16 v[148:151], v[44:47], v[36:39], v[148:151]
    s_add_u32 s60, s60, 36864
    v_mfma_f32_16x16x32_bf16 v[152:155], v[48:51], v[36:39], v[152:155]
    s_add_u32 s61, s61, 1
    v_mfma_f32_16x16x32_bf16 v[156:159], v[52:55], v[36:39], v[156:159]
    s_cmp_eq_u32 s60, 110592
    v_mfma_f32_16x16x32_bf16 v[160:163], v[44:47], v[40:43], v[160:163]
    s_cselect_b32 s60, 0, s60
    v_mfma_f32_16x16x32_bf16 v[164:167], v[48:51], v[40:43], v[164:167]
    s_cmp_eq_u32 s61, 10
    v_mfma_f32_16x16x32_bf16 v[168:171], v[52:55], v[40:43], v[168:171]
    s_waitcnt lgkmcnt(0)
    s_cbranch_scc1 A_tail
    v_mfma_f32_16x16x32_bf16 v[100:103], v[80:83], v[56:59], v[100:103]
    v_add_u32 v14, s60, v9
    v_mfma_f32_16x16x32_bf16 v[104:107], v[84:87], v[56:59], v[104:107]
    v_mad_u32_u24 v10, v8, s60, v6
    v_mfma_f32_16x16x32_bf16 v[108:111], v[88:91], v[56:59], v[108:111]
    v_add_u32 v12, s60, v4
    v_mfma_f32_16x16x32_bf16 v[112:115], v[80:83], v[60:63], v[112:115]
    v_mad_u32_u24 v11, v8, s60, v7
    v_mfma_f32_16x16x32_bf16 v[116:119], v[84:87], v[60:63], v[116:119]
    v_add_u32 v13, s60, v5
    v_mfma_f32_16x16x32_bf16 v[120:123], v[88:91], v[60:63], v[120:123]
    s_barrier
    v_mfma_f32_16x16x32_bf16 v[124:127], v[80:83], v[64:67], v[124:127]
    ds_read_b64_tr_b16 v[44:45], v14 offset:12288
    ds_read_b64_tr_b16 v[46:47], v14 offset:12800
    v_mfma_f32_16x16x32_bf16 v[128:131], v[84:87], v[64:67], v[128:131]
    ds_read_b64_tr_b16 v[48:49], v14 offset:13312
    ds_read_b64_tr_b16 v[50:51], v14 offset:13824
    v_mfma_f32_16x16x32_bf16 v[132:135], v[88:91], v[64:67], v[132:135]
    ds_read_b64_tr_b16 v[52:53], v14 offset:14336
    ds_read_b64_tr_b16 v[54:55], v14 offset:14848
    v_mfma_f32_16x16x32_bf16 v[136:139], v[80:83], v[68:71], v[136:139]
    ds_read_b128 v[20:23], v10
    ds_read_b128 v[24:27], v12 offset:2048
    v_mfma_f32_16x16x32_bf16 v[140:143], v[84:87], v[68:71], v[140:143]
    ds_read_b128 v[28:31], v12 offset:4096
    ds_read_b128 v[32:35], v12 offset:6144
    v_mfma_f32_16x16x32_bf16 v[144:147], v[88:91], v[68:71], v[144:147]
    ds_read_b128 v[36:39], v12 offset:8192
    ds_read_b128 v[40:43], v12 offset:10240
    v_mfma_f32_16x16x32_bf16 v[148:151], v[80:83], v[72:75], v[148:151]
    v_mfma_f32_16x16x32_bf16 v[152:155], v[84:87], v[72:75], v[152:155]
    v_mfma_f32_16x16x32_bf16 v[156:159], v[88:91], v[72:75], v[156:159]
    v_mfma_f32_16x16x32_bf16 v[160:163], v[80:83], v[76:79], v[160:163]
    v_mfma_f32_16x16x32_bf16 v[164:167], v[84:87], v[76:79], v[164:167]
    v_mfma_f32_16x16x32_bf16 v[168:171], v[88:91], v[76:79], v[168:171]
    s_branch A_loop
A_tail:
    v_mfma_f32_16x16x32_bf16 v[100:103], v[80:83], v[56:59], v[100:103]
    v_mfma_f32_16x16x32_bf16 v[104:107], v[84:87], v[56:59], v[104:107]
    v_mfma_f32_16x16x32_bf16 v[108:111], v[88:91], v[56:59], v[108:111]
    ds_read_b64 v[32:33], v15 offset:0
    v_mfma_f32_16x16x32_bf16 v[112:115], v[80:83], v[60:63], v[112:115]
    ds_read_b64 v[34:35], v15 offset:128
    v_mfma_f32_16x16x32_bf16 v[116:119], v[84:87], v[60:63], v[116:119]
    ds_read_b64 v[36:37], v15 offset:256
    v_mfma_f32_16x16x32_bf16 v[120:123], v[88:91], v[60:63], v[120:123]
    ds_read_b64 v[38:39], v15 offset:384
    v_mfma_f32_16x16x32_bf16 v[124:127], v[80:83], v[64:67], v[124:127]
    ds_read_b64 v[40:41], v15 offset:512
    v_mfma_f32_16x16x32_bf16 v[128:131], v[84:87], v[64:67], v[128:131]
    ds_read_b64 v[42:43], v15 offset:640
    v_mfma_f32_16x16x32_bf16 v[132:135], v[88:91], v[64:67], v[132:135]
    ds_read_b32 v17, v17
    v_mfma_f32_16x16x32_bf16 v[136:139], v[80:83], v[68:71], v[136:139]
    v_mov_b32_dpp v20, v100 row_newbcast:0 row_mask:0xf bank_mask:0xf
    v_mov_b32_dpp v21, v101 row_newbcast:0 row_mask:0xf bank_mask:0xf
    v_mfma_f32_16x16x32_bf16 v[140:143], v[84:87], v[68:71], v[140:143]
    v_mov_b32_dpp v22, v102 row_newbcast:0 row_mask:0xf bank_mask:0xf
    v_mov_b32_dpp v23, v103 row_newbcast:0 row_mask:0xf bank_mask:0xf
    v_mfma_f32_16x16x32_bf16 v[144:147], v[88:91], v[68:71], v[144:147]
    v_mov_b32_dpp v24, v104 row_newbcast:0 row_mask:0xf bank_mask:0xf
    v_mov_b32_dpp v25, v105 row_newbcast:0 row_mask:0xf bank_mask:0xf
    v_mfma_f32_16x16x32_bf16 v[148:151], v[80:83], v[72:75], v[148:151]
    v_mov_b32_dpp v26, v106 row_newbcast:0 row_mask:0xf bank_mask:0xf
    v_mov_b32_dpp v27, v107 row_newbcast:0 row_mask:0xf bank_mask:0xf
    v_mfma_f32_16x16x32_bf16 v[152:155], v[84:87], v[72:75], v[152:155]
    v_mov_b32_dpp v28, v108 row_newbcast:0 row_mask:0xf bank_mask:0xf
    v_mov_b32_dpp v29, v109 row_newbcast:0 row_mask:0xf bank_mask:0xf
    v_mfma_f32_16x16x32_bf16 v[156:159], v[88:91], v[72:75], v[156:159]
    v_mov_b32_dpp v30, v110 row_newbcast:0 row_mask:0xf bank_mask:0xf
    v_mov_b32_dpp v31, v111 row_newbcast:0 row_mask:0xf bank_mask:0xf
    s_waitcnt lgkmcnt(0)
    v_mfma_f32_16x16x32_bf16 v[160:163], v[80:83], v[76:79], v[160:163]
    v_pk_fma_f32 v[100:101], v[32:33], v[20:21], v[100:101] op_sel_hi:[0,1,1] neg_lo:[1,0,0] neg_hi:[1,0,0]
    v_pk_fma_f32 v[102:103], v[32:33], v[22:23], v[102:103] op_sel_hi:[0,1,1] neg_lo:[1,0,0] neg_hi:[1,0,0]
    v_mfma_f32_16x16x32_bf16 v[164:167], v[84:87], v[76:79], v[164:167]
    v_pk_fma_f32 v[104:105], v[32:33], v[24:25], v[104:105] op_sel_hi:[0,1,1] neg_lo:[1,0,0] neg_hi:[1,0,0]
    v_pk_fma_f32 v[106:107], v[32:33], v[26:27], v[106:107] op_sel_hi:[0,1,1] neg_lo:[1,0,0] neg_hi:[1,0,0]
    v_mfma_f32_16x16x32_bf16 v[168:171], v[88:91], v[76:79], v[168:171]
    v_pk_fma_f32 v[108:109], v[32:33], v[28:29], v[108:109] op_sel_hi:[0,1,1] neg_lo:[1,0,0] neg_hi:[1,0,0]
    v_pk_fma_f32 v[110:111], v[32:33], v[30:31], v[110:111] op_sel_hi:[0,1,1] neg_lo:[1,0,0] neg_hi:[1,0,0]
    v_cvt_pk_bf16_f32 v100, v100, v101
    v_cvt_pk_bf16_f32 v101, v102, v103
    ds_write_b64 v16, v[100:101] offset:0
    v_cvt_pk_bf16_f32 v104, v104, v105
    v_cvt_pk_bf16_f32 v105, v106, v107
    ds_write_b64 v16, v[104:105] offset:128
    v_cvt_pk_bf16_f32 v108, v108, v109
    v_cvt_pk_bf16_f32 v109, v110, v111
    ds_write_b64 v16, v[108:109] offset:256
    v_readfirstlane_b32 s49, v17
    v_pk_fma_f32 v[112:113], v[34:35], v[20:21], v[112:113] op_sel_hi:[0,1,1] neg_lo:[1,0,0] neg_hi:[1,0,0]
    v_pk_fma_f32 v[114:115], v[34:35], v[22:23], v[114:115] op_sel_hi:[0,1,1] neg_lo:[1,0,0] neg_hi:[1,0,0]
    v_pk_fma_f32 v[116:117], v[34:35], v[24:25], v[116:117] op_sel_hi:[0,1,1] neg_lo:[1,0,0] neg_hi:[1,0,0]
    v_pk_fma_f32 v[118:119], v[34:35], v[26:27], v[118:119] op_sel_hi:[0,1,1] neg_lo:[1,0,0] neg_hi:[1,0,0]
    v_pk_fma_f32 v[120:121], v[34:35], v[28:29], v[120:121] op_sel_hi:[0,1,1] neg_lo:[1,0,0] neg_hi:[1,0,0]
    v_pk_fma_f32 v[122:123], v[34:35], v[30:31], v[122:123] op_sel_hi:[0,1,1] neg_lo:[1,0,0] neg_hi:[1,0,0]
    v_cvt_pk_bf16_f32 v112, v112, v113
    v_cvt_pk_bf16_f32 v113, v114, v115
    ds_write_b64 v16, v[112:113] offset:6400
    v_cvt_pk_bf16_f32 v116, v116, v117
    v_cvt_pk_bf16_f32 v117, v118, v119
    ds_write_b64 v16, v[116:117] offset:6528
    v_cvt_pk_bf16_f32 v120, v120, v121
    v_cvt_pk_bf16_f32 v121, v122, v123
    ds_write_b64 v16, v[120:121] offset:6656
    v_pk_fma_f32 v[124:125], v[36:37], v[20:21], v[124:125] op_sel_hi:[0,1,1] neg_lo:[1,0,0] neg_hi:[1,0,0]
    v_pk_fma_f32 v[126:127], v[36:37], v[22:23], v[126:127] op_sel_hi:[0,1,1] neg_lo:[1,0,0] neg_hi:[1,0,0]
    v_pk_fma_f32 v[128:129], v[36:37], v[24:25], v[128:129] op_sel_hi:[0,1,1] neg_lo:[1,0,0] neg_hi:[1,0,0]
    v_pk_fma_f32 v[130:131], v[36:37], v[26:27], v[130:131] op_sel_hi:[0,1,1] neg_lo:[1,0,0] neg_hi:[1,0,0]
    v_pk_fma_f32 v[132:133], v[36:37], v[28:29], v[132:133] op_sel_hi:[0,1,1] neg_lo:[1,0,0] neg_hi:[1,0,0]
    v_pk_fma_f32 v[134:135], v[36:37], v[30:31], v[134:135] op_sel_hi:[0,1,1] neg_lo:[1,0,0] neg_hi:[1,0,0]
    v_cvt_pk_bf16_f32 v124, v124, v125
    v_cvt_pk_bf16_f32 v125, v126, v127
    ds_write_b64 v16, v[124:125] offset:12800
    v_cvt_pk_bf16_f32 v128, v128, v129
    v_cvt_pk_bf16_f32 v129, v130, v131
    ds_write_b64 v16, v[128:129] offset:12928
    v_cvt_pk_bf16_f32 v132, v132, v133
    v_cvt_pk_bf16_f32 v133, v134, v135
    ds_write_b64 v16, v[132:133] offset:13056
    v_pk_fma_f32 v[136:137], v[38:39], v[20:21], v[136:137] op_sel_hi:[0,1,1] neg_lo:[1,0,0] neg_hi:[1,0,0]
    v_pk_fma_f32 v[138:139], v[38:39], v[22:23], v[138:139] op_sel_hi:[0,1,1] neg_lo:[1,0,0] neg_hi:[1,0,0]
    v_pk_fma_f32 v[140:141], v[38:39], v[24:25], v[140:141] op_sel_hi:[0,1,1] neg_lo:[1,0,0] neg_hi:[1,0,0]
    v_pk_fma_f32 v[142:143], v[38:39], v[26:27], v[142:143] op_sel_hi:[0,1,1] neg_lo:[1,0,0] neg_hi:[1,0,0]
    v_pk_fma_f32 v[144:145], v[38:39], v[28:29], v[144:145] op_sel_hi:[0,1,1] neg_lo:[1,0,0] neg_hi:[1,0,0]
    v_pk_fma_f32 v[146:147], v[38:39], v[30:31], v[146:147] op_sel_hi:[0,1,1] neg_lo:[1,0,0] neg_hi:[1,0,0]
    v_cvt_pk_bf16_f32 v136, v136, v137
    v_cvt_pk_bf16_f32 v137, v138, v139
    ds_write_b64 v16, v[136:137] offset:19200
    v_cvt_pk_bf16_f32 v140, v140, v141
    v_cvt_pk_bf16_f32 v141, v142, v143
    ds_write_b64 v16, v[140:141] offset:19328
    v_cvt_pk_bf16_f32 v144, v144, v145
    v_cvt_pk_bf16_f32 v145, v146, v147
    ds_write_b64 v16, v[144:145] offset:19456
    v_pk_fma_f32 v[148:149], v[40:41], v[20:21], v[148:149] op_sel_hi:[0,1,1] neg_lo:[1,0,0] neg_hi:[1,0,0]
    v_pk_fma_f32 v[150:151], v[40:41], v[22:23], v[150:151] op_sel_hi:[0,1,1] neg_lo:[1,0,0] neg_hi:[1,0,0]
    v_pk_fma_f32 v[152:153], v[40:41], v[24:25], v[152:153] op_sel_hi:[0,1,1] neg_lo:[1,0,0] neg_hi:[1,0,0]
    v_pk_fma_f32 v[154:155], v[40:41], v[26:27], v[154:155] op_sel_hi:[0,1,1] neg_lo:[1,0,0] neg_hi:[1,0,0]
    v_pk_fma_f32 v[156:157], v[40:41], v[28:29], v[156:157] op_sel_hi:[0,1,1] neg_lo:[1,0,0] neg_hi:[1,0,0]
    v_pk_fma_f32 v[158:159], v[40:41], v[30:31], v[158:159] op_sel_hi:[0,1,1] neg_lo:[1,0,0] neg_hi:[1,0,0]
    v_cvt_pk_bf16_f32 v148, v148, v149
    v_cvt_pk_bf16_f32 v149, v150, v151
    ds_write_b64 v16, v[148:149] offset:25600
    v_cvt_pk_bf16_f32 v152, v152, v153
    v_cvt_pk_bf16_f32 v153, v154, v155
    ds_write_b64 v16, v[152:153] offset:25728
    v_cvt_pk_bf16_f32 v156, v156, v157
    v_cvt_pk_bf16_f32 v157, v158, v159
    ds_write_b64 v16, v[156:157] offset:25856
    v_pk_fma_f32 v[160:161], v[42:43], v[20:21], v[160:161] op_sel_hi:[0,1,1] neg_lo:[1,0,0] neg_hi:[1,0,0]
    v_pk_fma_f32 v[162:163], v[42:43], v[22:23], v[162:163] op_sel_hi:[0,1,1] neg_lo:[1,0,0] neg_hi:[1,0,0]
    v_pk_fma_f32 v[164:165], v[42:43], v[24:25], v[164:165] op_sel_hi:[0,1,1] neg_lo:[1,0,0] neg_hi:[1,0,0]
    v_pk_fma_f32 v[166:167], v[42:43], v[26:27], v[166:167] op_sel_hi:[0,1,1] neg_lo:[1,0,0] neg_hi:[1,0,0]
    v_pk_fma_f32 v[168:169], v[42:43], v[28:29], v[168:169] op_sel_hi:[0,1,1] neg_lo:[1,0,0] neg_hi:[1,0,0]
    v_pk_fma_f32 v[170:171], v[42:43], v[30:31], v[170:171] op_sel_hi:[0,1,1] neg_lo:[1,0,0] neg_hi:[1,0,0]
    v_cvt_pk_bf16_f32 v160, v160, v161
    v_cvt_pk_bf16_f32 v161, v162, v163
    ds_write_b64 v16, v[160:161] offset:32000
    v_cvt_pk_bf16_f32 v164, v164, v165
    v_cvt_pk_bf16_f32 v165, v166, v167
    ds_write_b64 v16, v[164:165] offset:32128
    v_cvt_pk_bf16_f32 v168, v168, v169
    v_cvt_pk_bf16_f32 v169, v170, v171
    ds_write_b64 v16, v[168:169] offset:32256
AT_start:
HA0_0:
    s_cbranch_execz HA0_1
    s_setprio 2
    s_cmp_lt_u32 s48, 4
    s_cbranch_scc1 AT_np
    s_setprio 3
AT_np:
    ds_read_b32 v16, v208 offset:4
    ds_read2_b32 v[4:5], v209 offset0:0 offset1:2
    ds_read2_b32 v[6:7], v209 offset0:4 offset1:6
    ds_read2_b32 v[8:9], v209 offset0:8 offset1:10
    ds_read2_b32 v[10:11], v209 offset0:12 offset1:14
    ds_read2_b32 v[12:13], v209 offset0:16 offset1:18
    ds_read2_b32 v[14:15], v209 offset0:20 offset1:22
    s_mov_b32 s60, 0x07060503
    s_mov_b32 s61, 0x07060502
    s_mov_b32 s62, 0x07060501
    s_mov_b32 s63, 0x04000c0c
    s_mov_b32 s64, 0x0706000c
    s_mov_b32 s66, 0x11111111
    s_mov_b32 s67, s66
    s_mov_b32 s68, 0x33333333
    s_mov_b32 s69, s68
    s_mov_b32 s70, 0x77777777
    s_mov_b32 s71, s70
    v_mov_b32 v79, s54
HA0_1:
    s_cbranch_execz HA0_2
    v_mov_b32 v83, s54
    v_mov_b32 v87, s54
    v_mov_b32 v88, 0
    v_mov_b32 v89, 0
    v_mov_b32 v90, 0
    v_mov_b32 v92, 0
    v_mov_b32 v93, 0
    v_mov_b32 v94, 0
    s_waitcnt lgkmcnt(0)
    s_barrier
    s_cmp_lt_u32 s48, 6
    s_cbranch_scc1 AT_qk
    s_lshl_b32 s65, s48, 10
    s_add_u32 s65, s65, 8192
    v_subrev_u32 v98, 20480, v99
    s_mul_i32 s66, s51, 81920
    s_add_u32 m0, s65, 0
    s_nop 0
    buffer_load_dwordx4 v99, s[36:39], s66 offen lds
    s_add_u32 m0, s65, -2048
    s_nop 0
    buffer_load_dwordx4 v98, s[36:39], s66 offen lds
    s_add_u32 s66, s66, 40960
    s_add_u32 m0, s65, 4096
    s_nop 0
    buffer_load_dwordx4 v99, s[36:39], s66 offen lds
    s_add_u32 m0, s65, 2048
    s_nop 0
    buffer_load_dwordx4 v98, s[36:39], s66 offen lds
    s_add_u32 s66, s66, 40960
    s_cmp_eq_u32 s66, 819200
    s_cselect_b32 s66, 0, s66
    s_add_u32 m0, s65, 8192
    s_nop 0
    buffer_load_dwordx4 v99, s[36:39], s66 offen lds
    s_add_u32 m0, s65, 6144
    s_nop 0
    buffer_load_dwordx4 v98, s[36:39], s66 offen lds
    s_add_u32 s66, s66, 40960
    s_add_u32 m0, s65, 12288
    s_nop 0
    buffer_load_dwordx4 v99, s[36:39], s66 offen lds
    s_add_u32 m0, s65, 10240
HA0_2:
    s_cbranch_execz HA0_3
    s_nop 0
    buffer_load_dwordx4 v98, s[36:39], s66 offen lds
    s_add_u32 s66, s66, 40960
    s_cmp_eq_u32 s66, 819200
    s_cselect_b32 s66, 0, s66
    s_add_u32 m0, s65, 16384
    s_nop 0
    buffer_load_dwordx4 v99, s[36:39], s66 offen lds
    s_add_u32 m0, s65, 14336
    s_nop 0
    buffer_load_dwordx4 v98, s[36:39], s66 offen lds
    s_add_u32 s66, s66, 40960
    s_add_u32 m0, s65, 20480
    s_nop 0
    buffer_load_dwordx4 v99, s[36:39], s66 offen lds
    s_add_u32 m0, s65, 18432
    s_nop 0
    buffer_load_dwordx4 v98, s[36:39], s66 offen lds
    buffer_load_dwordx4 v[232:235], v250, s[28:31], 0 offen offset:0
    buffer_load_dwordx4 v[236:239], v250, s[28:31], 0 offen offset:64
    ds_read_b64 v[240:241], v227 offset:0
    ds_read_b64 v[242:243], v227 offset:32
    ds_read_b64 v[244:245], v227 offset:64
    ds_read_b64 v[246:247], v227 offset:96
    ds_read_b32 v248, v251 offset:2288
    s_mul_i32 s58, s101, 5
    s_add_u32 s58, s58, s51
    s_sub_u32 s59, s58, 10
    s_cselect_b32 s58, s58, s59
    s_lshl_b32 s58, s58, 11
    s_add_u32 s58, s58, s1
    s_add_u32 s59, s1, 20480
    s_add_u32 s14, s58, 2048
    s_cmp_eq_u32 s14, s59
    s_cselect_b32 s14, s1, s14
    s_add_u32 s15, s14, 2048
    s_cmp_eq_u32 s15, s59
    s_cselect_b32 s15, s1, s15
    s_add_u32 s16, s15, 2048
HA0_3:
    s_cbranch_execz HA0_4
    s_cmp_eq_u32 s16, s59
    s_cselect_b32 s16, s1, s16
    s_add_u32 s17, s16, 2048
    s_cmp_eq_u32 s17, s59
    s_cselect_b32 s17, s1, s17
    s_add_u32 s18, s17, 2048
    s_cmp_eq_u32 s18, s59
    s_cselect_b32 s18, s1, s18
    s_add_u32 s19, s18, 2048
    s_cmp_eq_u32 s19, s59
    s_cselect_b32 s19, s1, s19
    s_add_u32 s66, s19, 2048
    s_cmp_eq_u32 s66, s59
    s_cselect_b32 s66, s1, s66
    s_add_u32 s67, s66, 2048
    s_cmp_eq_u32 s67, s59
    s_cselect_b32 s67, s1, s67
    s_add_u32 s68, s67, 2048
    s_cmp_eq_u32 s68, s59
    s_cselect_b32 s68, s1, s68
    s_add_u32 s58, s58, 1024
    s_cmp_eq_u32 s101, 1
    s_cselect_b32 s18, s58, s18
    s_cselect_b32 s70, 0x3e0, 62
    s_cmp_lt_u32 s48, 4
    s_cselect_b32 s70, 0x3fe, s70
    s_lshl_b32 s70, s70, s51
    s_lshr_b32 s58, s70, 10
    s_or_b32 s70, s70, s58
    s_and_b32 s70, s70, 0x3ff
    s_mov_b32 s71, 0
    s_mul_i32 s69, s56, 40
    s_add_u32 s69, s69, s100
    s_mov_b32 s62, 1
    s_waitcnt vmcnt(0)
    v_mov_b32 v19, 1
    s_mov_b64 exec, 1
    ds_add_u32 v251, v19
    s_mov_b64 exec, -1
    s_branch B_start
AT_qk:
    ds_read_b64 v[20:21], v204
    ds_read_b64 v[30:31], v205 offset:0
    ds_read_b64 v[40:41], v205 offset:1600
    ds_read_b64 v[50:51], v205 offset:3200
    ds_read_b64 v[22:23], v229
    ds_read_b64 v[32:33], v205 offset:8
HA0_4:
    s_cbranch_execz HA0_5
    ds_read_b64 v[42:43], v205 offset:1608
    ds_read_b64 v[52:53], v205 offset:3208
    ds_read_b64 v[24:25], v230
    ds_read_b64 v[34:35], v205 offset:16
    ds_read_b64 v[44:45], v205 offset:1616
    ds_read_b64 v[54:55], v205 offset:3216
    ds_read_b64 v[26:27], v231
    ds_read_b64 v[36:37], v205 offset:24
    ds_read_b64 v[46:47], v205 offset:1624
    ds_read_b64 v[56:57], v205 offset:3224
    ds_read_b64 v[28:29], v255
    ds_read_b64 v[38:39], v205 offset:32
    ds_read_b64 v[48:49], v205 offset:1632
    ds_read_b64 v[58:59], v205 offset:3232
    v_cndmask_b32 v13, v13, v5, s[66:67]
    v_cndmask_b32 v14, v14, v6, s[68:69]
    v_cndmask_b32 v15, v15, v7, s[70:71]
    v_mul_f32 v16, 0x3ea52b5c, v16
    v_mul_f32 v148, v16, v8
    v_mul_f32 v149, v16, v9
    v_mul_f32 v150, v16, v10
    v_mul_f32 v151, v16, v11
    v_mul_f32 v152, v16, v12
    v_mul_f32 v153, v16, v13
    v_mul_f32 v154, v16, v14
    v_mul_f32 v155, v16, v15
    s_waitcnt lgkmcnt(15)
    v_mfma_f32_4x4x4_16b_bf16 v[60:63], v[30:31], v[20:21], 0
    v_mfma_f32_4x4x4_16b_bf16 v[64:67], v[40:41], v[20:21], 0
    v_mfma_f32_4x4x4_16b_bf16 v[68:71], v[50:51], v[20:21], 0
    s_waitcnt lgkmcnt(12)
    v_mfma_f32_4x4x4_16b_bf16 v[60:63], v[32:33], v[22:23], v[60:63]
    v_mfma_f32_4x4x4_16b_bf16 v[64:67], v[42:43], v[22:23], v[64:67]
    v_mfma_f32_4x4x4_16b_bf16 v[68:71], v[52:53], v[22:23], v[68:71]
    s_waitcnt lgkmcnt(8)
    v_mfma_f32_4x4x4_16b_bf16 v[60:63], v[34:35], v[24:25], v[60:63]
    v_mfma_f32_4x4x4_16b_bf16 v[64:67], v[44:45], v[24:25], v[64:67]
HA0_5:
    s_cbranch_execz HA0_6
    v_mfma_f32_4x4x4_16b_bf16 v[68:71], v[54:55], v[24:25], v[68:71]
    s_waitcnt lgkmcnt(4)
    v_mfma_f32_4x4x4_16b_bf16 v[60:63], v[36:37], v[26:27], v[60:63]
    v_mfma_f32_4x4x4_16b_bf16 v[64:67], v[46:47], v[26:27], v[64:67]
    v_mfma_f32_4x4x4_16b_bf16 v[68:71], v[56:57], v[26:27], v[68:71]
    s_waitcnt lgkmcnt(0)
    v_mfma_f32_4x4x4_16b_bf16 v[60:63], v[38:39], v[28:29], v[60:63]
    v_mfma_f32_4x4x4_16b_bf16 v[64:67], v[48:49], v[28:29], v[64:67]
    v_mfma_f32_4x4x4_16b_bf16 v[68:71], v[58:59], v[28:29], v[68:71]
    ds_read_b64_tr_b16 v[100:101], v214 offset:0
    ds_read_b64_tr_b16 v[102:103], v214 offset:1600
    ds_read_b64_tr_b16 v[104:105], v214 offset:32
    ds_read_b64_tr_b16 v[106:107], v214 offset:1632
    ds_read_b64_tr_b16 v[108:109], v214 offset:64
    ds_read_b64_tr_b16 v[110:111], v214 offset:1664
    ds_read_b64_tr_b16 v[112:113], v214 offset:96
    ds_read_b64_tr_b16 v[114:115], v214 offset:1696
    s_cmp_lt_i32 s13, 8
    s_cbranch_scc1 AT_mask
AT_nomask:
    v_cndmask_b32 v69, v69, v61, s[66:67]
    v_cndmask_b32 v70, v70, v62, s[68:69]
    v_cndmask_b32 v71, v71, v63, s[70:71]
    v_mul_f32 v64, v64, v148
    v_mul_f32 v65, v65, v149
    v_mul_f32 v66, v66, v150
    v_mul_f32 v67, v67, v151
    v_mul_f32 v68, v68, v152
    v_mul_f32 v69, v69, v153
    v_mul_f32 v70, v70, v154
    v_mul_f32 v71, v71, v155
    v_perm_b32 v80, v64, v67, s60
    v_perm_b32 v81, v65, v67, s61
    v_perm_b32 v82, v66, v67, s62
    v_perm_b32 v84, v68, v71, s60
    v_perm_b32 v85, v69, v71, s61
    v_perm_b32 v86, v70, v71, s62
    s_mov_b64 exec, s[20:21]
    s_cmp_eq_u32 s49, 0
    s_cbranch_scc1 sts_3
HA0_6:
    s_cbranch_execz HA0_7
    buffer_store_dwordx4 v[80:83], v206, s[24:27], s12 offen offset:1024
    buffer_store_dwordx4 v[84:87], v206, s[24:27], s12 offen offset:1536
std_4:
    buffer_load_dwordx4 v[88:91], v213, s[24:27], s12 offen offset:0 sc1
    buffer_load_dwordx4 v[92:95], v213, s[24:27], s12 offen offset:512 sc1
    s_mov_b64 exec, -1
    v_lshl_add_u32 v17, v201, 3, v251
    ds_read2_b64 v[156:159], v17 offset0:14 offset1:18
    ds_read2_b64 v[160:163], v17 offset0:22 offset1:26
    v_and_b32 v164, 2, v201
    v_lshl_add_u32 v164, v200, 2, v164
    s_lshl_b32 s65, s48, 6
    s_add_u32 s65, s65, s57
    s_mul_i32 s58, s101, 5
    s_add_u32 s58, s58, s51
    s_sub_u32 s59, s58, 10
    s_cselect_b32 s58, s58, s59
    s_lshl_b32 s58, s58, 11
    s_add_u32 s58, s58, s1
    s_add_u32 s59, s1, 20480
    s_add_u32 s14, s58, 2048
    s_cmp_eq_u32 s14, s59
    s_cselect_b32 s14, s1, s14
    s_add_u32 s15, s14, 2048
    s_cmp_eq_u32 s15, s59
    s_cselect_b32 s15, s1, s15
    s_add_u32 s16, s15, 2048
    s_cmp_eq_u32 s16, s59
    s_cselect_b32 s16, s1, s16
    s_add_u32 s17, s16, 2048
    s_cmp_eq_u32 s17, s59
    s_cselect_b32 s17, s1, s17
    s_add_u32 s18, s17, 2048
    s_cmp_eq_u32 s18, s59
    s_cselect_b32 s18, s1, s18
    s_add_u32 s19, s18, 2048
    s_cmp_eq_u32 s19, s59
    s_cselect_b32 s19, s1, s19
    s_add_u32 s66, s19, 2048
    s_cmp_eq_u32 s66, s59
    s_cselect_b32 s66, s1, s66
    s_add_u32 s67, s66, 2048
    s_cmp_eq_u32 s67, s59
    s_cselect_b32 s67, s1, s67
    s_add_u32 s68, s67, 2048
    s_cmp_eq_u32 s68, s59
HA0_7:
    s_cbranch_execz HA_ret
    s_cselect_b32 s68, s1, s68
    s_add_u32 s58, s58, 1024
    s_cmp_eq_u32 s101, 1
    s_cselect_b32 s18, s58, s18
    s_cselect_b32 s70, 0x3e0, 62
    s_cmp_lt_u32 s48, 4
    s_cselect_b32 s70, 0x3fe, s70
    s_lshl_b32 s70, s70, s51
    s_lshr_b32 s58, s70, 10
    s_or_b32 s70, s70, s58
    s_and_b32 s70, s70, 0x3ff
    s_mov_b32 s71, 0
    s_mul_i32 s69, s56, 40
    s_add_u32 s69, s69, s100
    s_mov_b64 exec, s[20:21]
    s_branch AT_pw
AT_poll:
    buffer_load_dwordx4 v[88:91], v213, s[24:27], s12 offen offset:0 sc1
    buffer_load_dwordx4 v[92:95], v213, s[24:27], s12 offen offset:512 sc1
AT_pw:
    s_waitcnt vmcnt(0)
    v_cmp_ne_u32 vcc, s54, v91
    v_cmp_ne_u32 s[58:59], s54, v95
    s_or_b64 vcc, vcc, s[58:59]
    s_cbranch_vccz AT_got
    s_sub_u32 s3, s3, 1
    s_cbranch_scc0 AT_poll
    s_mov_b32 s3, 0
AT_got:
    s_mov_b64 exec, -1
    buffer_load_dwordx4 v[232:235], v250, s[28:31], 0 offen offset:0
    buffer_load_dwordx4 v[236:239], v250, s[28:31], 0 offen offset:64
    ds_read_b64 v[240:241], v227 offset:0
    ds_read_b64 v[242:243], v227 offset:32
    ds_read_b64 v[244:245], v227 offset:64
    ds_read_b64 v[246:247], v227 offset:96
    ds_read_b32 v248, v251 offset:2288
    v_perm_b32 v91, v88, v89, s63
    v_perm_b32 v95, v92, v93, s63
    v_perm_b32 v91, v91, v90, s64
    v_perm_b32 v95, v95, v94, s64
    v_add_f32 v64, v64, v88
    v_add_f32 v65, v65, v89
    v_add_f32 v66, v66, v90
    v_add_f32 v67, v67, v91
    v_add_f32 v68, v68, v92
    v_add_f32 v69, v69, v93
    v_add_f32 v70, v70, v94
HA1_0:
    s_cbranch_execz HA1_1
    v_add_f32 v71, v71, v95
    v_max3_f32 v18, v64, v65, v66
    v_max3_f32 v19, v67, v68, v69
    v_max3_f32 v18, v18, v70, v71
    v_max_f32 v18, v18, v19
    v_sub_f32 v64, v64, v18
    v_sub_f32 v65, v65, v18
    v_sub_f32 v66, v66, v18
    v_sub_f32 v67, v67, v18
    v_sub_f32 v68, v68, v18
    v_sub_f32 v69, v69, v18
    v_sub_f32 v70, v70, v18
    v_sub_f32 v71, v71, v18
    v_exp_f32 v64, v64
    v_exp_f32 v65, v65
    v_exp_f32 v66, v66
    v_exp_f32 v67, v67
    v_exp_f32 v68, v68
    v_exp_f32 v69, v69
    v_exp_f32 v70, v70
    v_exp_f32 v71, v71
    v_add_f32 v20, v64, v65
    v_add_f32 v21, v66, v67
    v_add_f32 v22, v68, v69
    v_add_f32 v23, v70, v71
    v_add_f32 v20, v20, v21
    v_add_f32 v22, v22, v23
    v_add_f32 v20, v20, v22
    v_rcp_f32 v20, v20
    v_mul_f32 v64, v64, v8
    v_mul_f32 v65, v65, v9
    v_mul_f32 v66, v66, v10
    v_mul_f32 v67, v67, v11
    v_mul_f32 v68, v68, v12
    v_mul_f32 v69, v69, v13
    v_mul_f32 v70, v70, v14
    v_mul_f32 v71, v71, v15
    v_mul_f32 v64, v64, v20
    v_mul_f32 v65, v65, v20
    v_mul_f32 v66, v66, v20
    v_mul_f32 v67, v67, v20
    v_mul_f32 v68, v68, v20
    v_mul_f32 v69, v69, v20
    v_mul_f32 v70, v70, v20
    v_mul_f32 v71, v71, v20
    v_cvt_pk_bf16_f32 v24, v64, v65
    v_cvt_pk_bf16_f32 v25, v66, v67
    v_cvt_pk_bf16_f32 v26, v68, v69
    v_cvt_pk_bf16_f32 v27, v70, v71
    ds_write_b64 v210, v[24:25] offset:8
    v_and_b32 v28, v26, v207
    v_and_b32 v29, v27, v211
    ds_write_b64 v210, v[28:29]
    v_xor_b32 v26, v26, v28
HA1_1:
    s_cbranch_execz HA1_2
    v_xor_b32 v27, v27, v29
    ds_write_b64 v210, v[26:27] offset:16
    ds_read_b128 v[116:119], v172
    ds_read_b128 v[120:123], v173
    ds_read_b128 v[124:127], v174
    ds_read_b128 v[128:131], v175
    ds_read_b128 v[132:135], v176
    ds_read_b128 v[136:139], v177
    ds_read_b128 v[140:143], v178
    ds_read_b128 v[144:147], v179
    s_cmp_lt_u32 s48, 4
    s_cbranch_scc1 AT_pv
    v_mov_b32 v19, 1
    s_mov_b64 exec, 1
    ds_add_u32 v251, v19
    s_mov_b64 exec, -1
AT_pv:
    s_waitcnt lgkmcnt(6)
    v_mfma_f32_16x16x32_bf16 v[20:23], v[100:103], v[116:119], 0
    v_mfma_f32_16x16x32_bf16 v[24:27], v[100:103], v[120:123], 0
    s_waitcnt lgkmcnt(4)
    v_mfma_f32_16x16x32_bf16 v[28:31], v[104:107], v[124:127], 0
    v_mfma_f32_16x16x32_bf16 v[32:35], v[104:107], v[128:131], 0
    s_waitcnt lgkmcnt(2)
    v_mfma_f32_16x16x32_bf16 v[36:39], v[108:111], v[132:135], 0
    v_mfma_f32_16x16x32_bf16 v[40:43], v[108:111], v[136:139], 0
    s_waitcnt lgkmcnt(0)
    v_mfma_f32_16x16x32_bf16 v[44:47], v[112:115], v[140:143], 0
    v_mfma_f32_16x16x32_bf16 v[48:51], v[112:115], v[144:147], 0
    v_cndmask_b32 v20, v20, v24, s[4:5]
    v_cndmask_b32 v21, v21, v25, s[4:5]
    v_cndmask_b32 v22, v22, v26, s[4:5]
    v_cndmask_b32 v23, v23, v27, s[4:5]
    v_cvt_pk_bf16_f32 v204, v20, v21
    v_cvt_pk_bf16_f32 v205, v22, v23
    v_cndmask_b32 v28, v28, v32, s[6:7]
    v_cndmask_b32 v29, v29, v33, s[6:7]
    v_cndmask_b32 v30, v30, v34, s[6:7]
HA1_2:
    s_cbranch_execz HA1_3
    v_cndmask_b32 v31, v31, v35, s[6:7]
    v_cvt_pk_bf16_f32 v206, v28, v29
    v_cvt_pk_bf16_f32 v207, v30, v31
    v_cndmask_b32 v36, v36, v40, s[8:9]
    v_cndmask_b32 v37, v37, v41, s[8:9]
    v_cndmask_b32 v38, v38, v42, s[8:9]
    v_cndmask_b32 v39, v39, v43, s[8:9]
    v_cvt_pk_bf16_f32 v208, v36, v37
    v_cvt_pk_bf16_f32 v209, v38, v39
    v_cndmask_b32 v44, v44, v48, s[10:11]
    v_cndmask_b32 v45, v45, v49, s[10:11]
    v_cndmask_b32 v46, v46, v50, s[10:11]
    v_cndmask_b32 v47, v47, v51, s[10:11]
    v_cvt_pk_bf16_f32 v210, v44, v45
    v_cvt_pk_bf16_f32 v211, v46, v47
    s_cmp_eq_u32 s49, 0
    s_cbranch_scc1 sts_5
    buffer_store_dwordx4 v[204:207], v249, s[24:27], s22 offen offset:0
    buffer_store_dwordx4 v[208:211], v249, s[24:27], s22 offen offset:1024
std_6:
    s_mov_b64 exec, s[70:71]
    buffer_load_dword v18, v203, s[24:27], s69 offen sc1
    s_mov_b64 exec, -1
    v_dot2_f32_bf16 v20, v204, v156, 0
    v_dot2_f32_bf16 v21, v204, v204, 0
    v_dot2_f32_bf16 v20, v205, v157, v20
    v_dot2_f32_bf16 v21, v205, v205, v21
    v_dot2_f32_bf16 v20, v206, v158, v20
    v_dot2_f32_bf16 v21, v206, v206, v21
    v_dot2_f32_bf16 v20, v207, v159, v20
    v_dot2_f32_bf16 v21, v207, v207, v21
    v_dot2_f32_bf16 v20, v208, v160, v20
    v_dot2_f32_bf16 v21, v208, v208, v21
    v_dot2_f32_bf16 v20, v209, v161, v20
HA1_3:
    s_cbranch_execz HA1_4
    v_dot2_f32_bf16 v21, v209, v209, v21
    v_dot2_f32_bf16 v20, v210, v162, v20
    v_dot2_f32_bf16 v21, v210, v210, v21
    v_dot2_f32_bf16 v20, v211, v163, v20
    v_dot2_f32_bf16 v21, v211, v211, v21
    s_nop 2
    v_permlane32_swap_b32 v20, v21
    v_add_f32 v20, v20, v21
    v_mov_b32 v21, v20
    s_nop 1
    v_permlane16_swap_b32 v20, v21
    s_mov_b32 exec_lo, 0xffff
    s_mov_b32 exec_hi, 0xffff
    v_add_f32 v20, v20, v21
    s_cmp_eq_u32 s49, 0
    s_cbranch_scc1 sts_7
    buffer_store_short_d16_hi v20, v164, s[24:27], s65 offen
std_8:
    s_mov_b64 exec, -1
    s_waitcnt vmcnt(1)
    s_mov_b64 exec, 1
    s_cmp_eq_u32 s49, 0
    s_cbranch_scc1 sts_9
    buffer_store_dword v79, v203, s[24:27], s23 offen
std_10:
    s_mov_b64 exec, -1
    v_cmp_ne_u32 vcc, s54, v18
    s_and_b32 s62, vcc_lo, s70
    s_cbranch_scc1 B_start
    buffer_load_dwordx4 v[168:171], v249, s[24:27], s14 offen offset:0 sc1
    buffer_load_dwordx4 v[172:175], v249, s[24:27], s14 offen offset:1024 sc1
    buffer_load_dwordx4 v[176:179], v249, s[24:27], s15 offen offset:0 sc1
    buffer_load_dwordx4 v[180:183], v249, s[24:27], s15 offen offset:1024 sc1
    buffer_load_dwordx4 v[212:215], v249, s[24:27], s16 offen offset:0 sc1
    buffer_load_dwordx4 v[12:15], v249, s[24:27], s16 offen offset:1024 sc1
B_start:
    ds_read_b32 v19, v251
    v_permlane16_swap_b32 v232, v234
    v_permlane16_swap_b32 v233, v235
    v_permlane16_swap_b32 v236, v238
    v_permlane16_swap_b32 v237, v239
    v_lshlrev_b32 v184, 16, v232
    v_and_b32 v185, s47, v232
    v_lshlrev_b32 v186, 16, v233
    v_and_b32 v187, s47, v233
    v_lshlrev_b32 v188, 16, v234
    v_and_b32 v189, s47, v234
    v_lshlrev_b32 v190, 16, v235
    v_and_b32 v191, s47, v235
    v_lshlrev_b32 v192, 16, v236
HA1_4:
    s_cbranch_execz HA1_5
    v_and_b32 v193, s47, v236
    v_lshlrev_b32 v194, 16, v237
    v_and_b32 v195, s47, v237
    v_lshlrev_b32 v196, 16, v238
    v_and_b32 v197, s47, v238
    v_lshlrev_b32 v198, 16, v239
    v_and_b32 v199, s47, v239
    v_cmp_gt_u32 vcc, 2048, v254
    s_mov_b64 s[4:5], vcc
    s_branch B_wc
B_ww:
    ds_read_b32 v19, v251
B_wc:
    s_waitcnt lgkmcnt(0)
    v_cmp_ne_u32 vcc, 4, v19
    s_cbranch_vccz B_wd
    s_sub_u32 s3, s3, 1
    s_cbranch_scc0 B_ww
    s_mov_b32 s3, 0
B_wd:
    s_setprio 0
    ds_read_b64_tr_b16 v[20:21], v216 offset:0
    ds_read_b64_tr_b16 v[22:23], v216 offset:2048
    ds_read_b64_tr_b16 v[24:25], v217 offset:0
    ds_read_b64_tr_b16 v[26:27], v217 offset:2048
    ds_read_b64_tr_b16 v[28:29], v218 offset:0
    ds_read_b64_tr_b16 v[30:31], v218 offset:2048
    ds_read_b64_tr_b16 v[32:33], v219 offset:0
    ds_read_b64_tr_b16 v[34:35], v219 offset:2048
    ds_read_b64_tr_b16 v[36:37], v216 offset:4096
    ds_read_b64_tr_b16 v[38:39], v216 offset:6144
    ds_read_b64_tr_b16 v[40:41], v217 offset:4096
    ds_read_b64_tr_b16 v[42:43], v217 offset:6144
    ds_read_b64_tr_b16 v[44:45], v218 offset:4096
    ds_read_b64_tr_b16 v[46:47], v218 offset:6144
    ds_read_b64_tr_b16 v[48:49], v219 offset:4096
    ds_read_b64_tr_b16 v[50:51], v219 offset:6144
    ds_read_b64_tr_b16 v[52:53], v216 offset:8192
    ds_read_b64_tr_b16 v[54:55], v216 offset:10240
    ds_read_b64_tr_b16 v[56:57], v217 offset:8192
    ds_read_b64_tr_b16 v[58:59], v217 offset:10240
    ds_read_b64_tr_b16 v[60:61], v218 offset:8192
    ds_read_b64_tr_b16 v[62:63], v218 offset:10240
HA1_5:
    s_cbranch_execz HA1_6
    ds_read_b64_tr_b16 v[64:65], v219 offset:8192
    ds_read_b64_tr_b16 v[66:67], v219 offset:10240
    ds_read_b64_tr_b16 v[68:69], v216 offset:12288
    ds_read_b64_tr_b16 v[70:71], v216 offset:14336
    ds_read_b64_tr_b16 v[72:73], v217 offset:12288
    ds_read_b64_tr_b16 v[74:75], v217 offset:14336
    ds_read_b64_tr_b16 v[76:77], v218 offset:12288
    ds_read_b64_tr_b16 v[78:79], v218 offset:14336
    ds_read_b64_tr_b16 v[80:81], v219 offset:12288
    ds_read_b64_tr_b16 v[82:83], v219 offset:14336
    s_cmp_eq_u32 s62, 0
    s_cbranch_scc1 B_nap
    s_mov_b64 exec, s[70:71]
    buffer_load_dword v18, v203, s[24:27], s69 offen sc1
    s_mov_b64 exec, -1
B_nap:
    ds_read_b64_tr_b16 v[84:85], v216 offset:16384
    ds_read_b64_tr_b16 v[86:87], v216 offset:18432
    ds_read_b64_tr_b16 v[88:89], v217 offset:16384
    ds_read_b64_tr_b16 v[90:91], v217 offset:18432
    ds_read_b64_tr_b16 v[92:93], v218 offset:16384
    ds_read_b64_tr_b16 v[94:95], v218 offset:18432
    ds_read_b64_tr_b16 v[96:97], v219 offset:16384
    ds_read_b64_tr_b16 v[98:99], v219 offset:18432
    ds_read_b64_tr_b16 v[100:101], v216 offset:20480
    ds_read_b64_tr_b16 v[102:103], v216 offset:22528
    ds_read_b64_tr_b16 v[104:105], v217 offset:20480
    ds_read_b64_tr_b16 v[106:107], v217 offset:22528
    ds_read_b64_tr_b16 v[108:109], v218 offset:20480
    ds_read_b64_tr_b16 v[110:111], v218 offset:22528
    ds_read_b64_tr_b16 v[112:113], v219 offset:20480
    ds_read_b64_tr_b16 v[114:115], v219 offset:22528
    ds_read_b64_tr_b16 v[116:117], v216 offset:24576
    ds_read_b64_tr_b16 v[118:119], v216 offset:26624
HA1_6:
    s_cbranch_execz HA1_7
    ds_read_b64_tr_b16 v[120:121], v217 offset:24576
    ds_read_b64_tr_b16 v[122:123], v217 offset:26624
    ds_read_b64_tr_b16 v[124:125], v218 offset:24576
    ds_read_b64_tr_b16 v[126:127], v218 offset:26624
    ds_read_b64_tr_b16 v[128:129], v219 offset:24576
    ds_read_b64_tr_b16 v[130:131], v219 offset:26624
    s_cmp_ge_u32 s48, 6
    s_cbranch_scc1 B_no
    s_waitcnt lgkmcnt(0)
    v_mfma_f32_16x16x32_bf16 v[184:187], v[20:23], v[204:207], v[184:187]
    v_mfma_f32_16x16x32_bf16 v[188:191], v[24:27], v[204:207], v[188:191]
    v_mfma_f32_16x16x32_bf16 v[192:195], v[28:31], v[204:207], v[192:195]
    v_mfma_f32_16x16x32_bf16 v[196:199], v[32:35], v[204:207], v[196:199]
    s_waitcnt lgkmcnt(0)
    v_mfma_f32_16x16x32_bf16 v[184:187], v[36:39], v[208:211], v[184:187]
    v_mfma_f32_16x16x32_bf16 v[188:191], v[40:43], v[208:211], v[188:191]
    v_mfma_f32_16x16x32_bf16 v[192:195], v[44:47], v[208:211], v[192:195]
    v_mfma_f32_16x16x32_bf16 v[196:199], v[48:51], v[208:211], v[196:199]
    s_branch B_n2
B_rds:
    ds_read_b64_tr_b16 v[132:133], v216 offset:28672
    ds_read_b64_tr_b16 v[134:135], v216 offset:30720
    ds_read_b64_tr_b16 v[136:137], v217 offset:28672
    ds_read_b64_tr_b16 v[138:139], v217 offset:30720
    ds_read_b64_tr_b16 v[140:141], v218 offset:28672
    ds_read_b64_tr_b16 v[142:143], v218 offset:30720
    ds_read_b64_tr_b16 v[144:145], v219 offset:28672
    ds_read_b64_tr_b16 v[146:147], v219 offset:30720
    ds_read_b64_tr_b16 v[148:149], v216 offset:32768
    ds_read_b64_tr_b16 v[150:151], v216 offset:34816
    ds_read_b64_tr_b16 v[152:153], v217 offset:32768
    ds_read_b64_tr_b16 v[154:155], v217 offset:34816
    ds_read_b64_tr_b16 v[156:157], v218 offset:32768
    ds_read_b64_tr_b16 v[158:159], v218 offset:34816
    ds_read_b64_tr_b16 v[160:161], v219 offset:32768
HA1_7:
    s_cbranch_execz HA_ret
    ds_read_b64_tr_b16 v[162:163], v219 offset:34816
    ds_read_b64_tr_b16 v[20:21], v216 offset:36864
    ds_read_b64_tr_b16 v[22:23], v216 offset:38912
    ds_read_b64_tr_b16 v[24:25], v217 offset:36864
    ds_read_b64_tr_b16 v[26:27], v217 offset:38912
    ds_read_b64_tr_b16 v[28:29], v218 offset:36864
    ds_read_b64_tr_b16 v[30:31], v218 offset:38912
    ds_read_b64_tr_b16 v[32:33], v219 offset:36864
    ds_read_b64_tr_b16 v[34:35], v219 offset:38912
    ds_read_b64_tr_b16 v[36:37], v220 offset:0
    ds_read_b64_tr_b16 v[38:39], v220 offset:2048
    ds_read_b64_tr_b16 v[40:41], v221 offset:0
    ds_read_b64_tr_b16 v[42:43], v221 offset:2048
    ds_read_b64_tr_b16 v[44:45], v222 offset:0
    ds_read_b64_tr_b16 v[46:47], v222 offset:2048
    ds_read_b64_tr_b16 v[48:49], v223 offset:0
    ds_read_b64_tr_b16 v[50:51], v223 offset:2048
    s_setpc_b64 s[98:99]
B_no:
    s_call_b64 s[98:99], B_rds
    v_mul_u32_u24 v4, 12, v0
    s_add_u32 s58, s100, 512
    s_add_u32 s59, s100, 35072
    s_add_u32 s60, s100, 69632
    s_add_u32 s12, s100, 104192
    s_add_u32 s13, s100, 138752
    v_and_b32 v5, 31, v0
    v_mul_u32_u24 v5, 3, v5
    s_mul_i32 s64, s53, 96
    s_sub_u32 s65, 1014, s55
    v_mov_b32 v6, 0xfffff000
    v_add_u32 v7, -10, v5
    v_cmp_gt_u32 vcc, s65, v7
    v_add3_u32 v7, v5, s64, 0
    s_nop 0
    v_cndmask_b32 v8, 0, v7, vcc
    v_cndmask_b32 v204, 0, v6, vcc
    v_add_u32 v7, -9, v5
HA2_0:
    s_cbranch_execz HA2_1
    v_cmp_gt_u32 vcc, s65, v7
    v_add3_u32 v7, v5, s64, 1
    s_nop 0
    v_cndmask_b32 v9, 0, v7, vcc
    v_cndmask_b32 v205, 0, v6, vcc
    v_add_u32 v7, -8, v5
    v_cmp_gt_u32 vcc, s65, v7
    v_add3_u32 v7, v5, s64, 2
    s_nop 0
    v_cndmask_b32 v10, 0, v7, vcc
    v_cndmask_b32 v206, 0, v6, vcc
    v_mov_b32 v7, s54
    v_lshlrev_b32 v11, 11, v200
    s_setprio 2
B_n2:
    s_cmp_eq_u32 s62, 0
    s_cbranch_scc1 B_run
    s_mov_b64 exec, s[70:71]
    s_branch B_pw
B_poll:
    buffer_load_dword v18, v203, s[24:27], s69 offen sc1
B_pw:
    s_waitcnt vmcnt(0)
    v_cmp_ne_u32 vcc, s54, v18
    s_cbranch_vccz B_go
    s_sub_u32 s3, s3, 1
    s_cbranch_scc0 B_poll
    s_mov_b32 s3, 0
B_go:
    s_mov_b64 exec, -1
    buffer_load_dwordx4 v[168:171], v249, s[24:27], s14 offen offset:0 sc1
    buffer_load_dwordx4 v[172:175], v249, s[24:27], s14 offen offset:1024 sc1
    buffer_load_dwordx4 v[176:179], v249, s[24:27], s15 offen offset:0 sc1
    buffer_load_dwordx4 v[180:183], v249, s[24:27], s15 offen offset:1024 sc1
    buffer_load_dwordx4 v[212:215], v249, s[24:27], s16 offen offset:0 sc1
    buffer_load_dwordx4 v[12:15], v249, s[24:27], s16 offen offset:1024 sc1
B_run:
    s_cmp_ge_u32 s48, 6
    s_cbranch_scc1 B_half
    s_call_b64 s[98:99], B_rds
    s_cmp_ge_u32 s48, 4
    s_cbranch_scc1 B_half
    s_setprio 1
    s_waitcnt vmcnt(5) lgkmcnt(15)
    v_mfma_f32_16x16x32_bf16 v[184:187], v[52:55], v[168:171], v[184:187]
    v_mfma_f32_16x16x32_bf16 v[188:191], v[56:59], v[168:171], v[188:191]
    ds_read_b64_tr_b16 v[52:53], v220 offset:4096
    v_mfma_f32_16x16x32_bf16 v[192:195], v[60:63], v[168:171], v[192:195]
    ds_read_b64_tr_b16 v[54:55], v220 offset:6144
    v_mfma_f32_16x16x32_bf16 v[196:199], v[64:67], v[168:171], v[196:199]
    buffer_load_dwordx4 v[164:167], v249, s[24:27], s17 offen offset:0 sc1
    ds_read_b64_tr_b16 v[56:57], v221 offset:4096
HA2_1:
    s_cbranch_execz HA2_2
    s_waitcnt vmcnt(5) lgkmcnt(15)
    v_mfma_f32_16x16x32_bf16 v[184:187], v[68:71], v[172:175], v[184:187]
    ds_read_b64_tr_b16 v[58:59], v221 offset:6144
    ds_read_b64_tr_b16 v[60:61], v222 offset:4096
    v_mfma_f32_16x16x32_bf16 v[188:191], v[72:75], v[172:175], v[188:191]
    ds_read_b64_tr_b16 v[62:63], v222 offset:6144
    v_mfma_f32_16x16x32_bf16 v[192:195], v[76:79], v[172:175], v[192:195]
    ds_read_b64_tr_b16 v[64:65], v223 offset:4096
    v_mfma_f32_16x16x32_bf16 v[196:199], v[80:83], v[172:175], v[196:199]
    buffer_load_dwordx4 v[232:235], v249, s[24:27], s17 offen offset:1024 sc1
    ds_read_b64_tr_b16 v[66:67], v223 offset:6144
    s_waitcnt vmcnt(5) lgkmcnt(15)
    v_mfma_f32_16x16x32_bf16 v[184:187], v[84:87], v[176:179], v[184:187]
    ds_read_b64_tr_b16 v[68:69], v220 offset:8192
    ds_read_b64_tr_b16 v[70:71], v220 offset:10240
    v_mfma_f32_16x16x32_bf16 v[188:191], v[88:91], v[176:179], v[188:191]
    ds_read_b64_tr_b16 v[72:73], v221 offset:8192
    v_mfma_f32_16x16x32_bf16 v[192:195], v[92:95], v[176:179], v[192:195]
    ds_read_b64_tr_b16 v[74:75], v221 offset:10240
    v_mfma_f32_16x16x32_bf16 v[196:199], v[96:99], v[176:179], v[196:199]
    buffer_load_dwordx4 v[236:239], v249, s[24:27], s18 offen offset:0 sc1
    ds_read_b64_tr_b16 v[76:77], v222 offset:8192
    s_waitcnt vmcnt(5) lgkmcnt(15)
    v_mfma_f32_16x16x32_bf16 v[184:187], v[100:103], v[180:183], v[184:187]
    ds_read_b64_tr_b16 v[78:79], v222 offset:10240
    ds_read_b64_tr_b16 v[80:81], v223 offset:8192
    v_mfma_f32_16x16x32_bf16 v[188:191], v[104:107], v[180:183], v[188:191]
    ds_read_b64_tr_b16 v[82:83], v223 offset:10240
    v_mfma_f32_16x16x32_bf16 v[192:195], v[108:111], v[180:183], v[192:195]
    ds_read_b64_tr_b16 v[84:85], v220 offset:12288
    v_mfma_f32_16x16x32_bf16 v[196:199], v[112:115], v[180:183], v[196:199]
    buffer_load_dwordx4 v[168:171], v249, s[24:27], s18 offen offset:1024 sc1
    ds_read_b64_tr_b16 v[86:87], v220 offset:14336
HA2_2:
    s_cbranch_execz HA2_3
    s_waitcnt vmcnt(5) lgkmcnt(15)
    v_mfma_f32_16x16x32_bf16 v[184:187], v[116:119], v[212:215], v[184:187]
    ds_read_b64_tr_b16 v[88:89], v221 offset:12288
    ds_read_b64_tr_b16 v[90:91], v221 offset:14336
    v_mfma_f32_16x16x32_bf16 v[188:191], v[120:123], v[212:215], v[188:191]
    ds_read_b64_tr_b16 v[92:93], v222 offset:12288
    v_mfma_f32_16x16x32_bf16 v[192:195], v[124:127], v[212:215], v[192:195]
    ds_read_b64_tr_b16 v[94:95], v222 offset:14336
    v_mfma_f32_16x16x32_bf16 v[196:199], v[128:131], v[212:215], v[196:199]
    buffer_load_dwordx4 v[172:175], v249, s[24:27], s19 offen offset:0 sc1
    ds_read_b64_tr_b16 v[96:97], v223 offset:12288
    s_waitcnt vmcnt(5) lgkmcnt(15)
    v_mfma_f32_16x16x32_bf16 v[184:187], v[132:135], v[12:15], v[184:187]
    ds_read_b64_tr_b16 v[98:99], v223 offset:14336
    ds_read_b64_tr_b16 v[100:101], v220 offset:16384
    v_mfma_f32_16x16x32_bf16 v[188:191], v[136:139], v[12:15], v[188:191]
    ds_read_b64_tr_b16 v[102:103], v220 offset:18432
    v_mfma_f32_16x16x32_bf16 v[192:195], v[140:143], v[12:15], v[192:195]
    ds_read_b64_tr_b16 v[104:105], v221 offset:16384
    v_mfma_f32_16x16x32_bf16 v[196:199], v[144:147], v[12:15], v[196:199]
    buffer_load_dwordx4 v[176:179], v249, s[24:27], s19 offen offset:1024 sc1
    ds_read_b64_tr_b16 v[106:107], v221 offset:18432
    s_waitcnt vmcnt(5) lgkmcnt(15)
    v_mfma_f32_16x16x32_bf16 v[184:187], v[148:151], v[164:167], v[184:187]
    ds_read_b64_tr_b16 v[108:109], v222 offset:16384
    ds_read_b64_tr_b16 v[110:111], v222 offset:18432
    v_mfma_f32_16x16x32_bf16 v[188:191], v[152:155], v[164:167], v[188:191]
    ds_read_b64_tr_b16 v[112:113], v223 offset:16384
    v_mfma_f32_16x16x32_bf16 v[192:195], v[156:159], v[164:167], v[192:195]
    ds_read_b64_tr_b16 v[114:115], v223 offset:18432
    v_mfma_f32_16x16x32_bf16 v[196:199], v[160:163], v[164:167], v[196:199]
    buffer_load_dwordx4 v[180:183], v249, s[24:27], s66 offen offset:0 sc1
    ds_read_b64_tr_b16 v[116:117], v220 offset:20480
HA2_3:
    s_cbranch_execz HA2_4
    s_waitcnt vmcnt(5) lgkmcnt(15)
    v_mfma_f32_16x16x32_bf16 v[184:187], v[20:23], v[232:235], v[184:187]
    ds_read_b64_tr_b16 v[118:119], v220 offset:22528
    ds_read_b64_tr_b16 v[120:121], v221 offset:20480
    v_mfma_f32_16x16x32_bf16 v[188:191], v[24:27], v[232:235], v[188:191]
    ds_read_b64_tr_b16 v[122:123], v221 offset:22528
    v_mfma_f32_16x16x32_bf16 v[192:195], v[28:31], v[232:235], v[192:195]
    ds_read_b64_tr_b16 v[124:125], v222 offset:20480
    v_mfma_f32_16x16x32_bf16 v[196:199], v[32:35], v[232:235], v[196:199]
    buffer_load_dwordx4 v[212:215], v249, s[24:27], s66 offen offset:1024 sc1
    ds_read_b64_tr_b16 v[126:127], v222 offset:22528
    s_waitcnt vmcnt(5) lgkmcnt(15)
    v_mfma_f32_16x16x32_bf16 v[184:187], v[36:39], v[236:239], v[184:187]
    ds_read_b64_tr_b16 v[128:129], v223 offset:20480
    ds_read_b64_tr_b16 v[130:131], v223 offset:22528
    v_mfma_f32_16x16x32_bf16 v[188:191], v[40:43], v[236:239], v[188:191]
    ds_read_b64_tr_b16 v[132:133], v220 offset:24576
    v_mfma_f32_16x16x32_bf16 v[192:195], v[44:47], v[236:239], v[192:195]
    ds_read_b64_tr_b16 v[134:135], v220 offset:26624
    v_mfma_f32_16x16x32_bf16 v[196:199], v[48:51], v[236:239], v[196:199]
    buffer_load_dwordx4 v[12:15], v249, s[24:27], s67 offen offset:0 sc1
    ds_read_b64_tr_b16 v[136:137], v221 offset:24576
    s_waitcnt vmcnt(5) lgkmcnt(15)
    v_mfma_f32_16x16x32_bf16 v[184:187], v[52:55], v[168:171], v[184:187]
    ds_read_b64_tr_b16 v[138:139], v221 offset:26624
    ds_read_b64_tr_b16 v[140:141], v222 offset:24576
    v_mfma_f32_16x16x32_bf16 v[188:191], v[56:59], v[168:171], v[188:191]
    ds_read_b64_tr_b16 v[142:143], v222 offset:26624
    v_mfma_f32_16x16x32_bf16 v[192:195], v[60:63], v[168:171], v[192:195]
    ds_read_b64_tr_b16 v[144:145], v223 offset:24576
    v_mfma_f32_16x16x32_bf16 v[196:199], v[64:67], v[168:171], v[196:199]
    buffer_load_dwordx4 v[164:167], v249, s[24:27], s67 offen offset:1024 sc1
    ds_read_b64_tr_b16 v[146:147], v223 offset:26624
HA2_4:
    s_cbranch_execz HA2_5
    s_waitcnt vmcnt(5) lgkmcnt(15)
    v_mfma_f32_16x16x32_bf16 v[184:187], v[68:71], v[172:175], v[184:187]
    ds_read_b64_tr_b16 v[148:149], v220 offset:28672
    ds_read_b64_tr_b16 v[150:151], v220 offset:30720
    v_mfma_f32_16x16x32_bf16 v[188:191], v[72:75], v[172:175], v[188:191]
    ds_read_b64_tr_b16 v[152:153], v221 offset:28672
    v_mfma_f32_16x16x32_bf16 v[192:195], v[76:79], v[172:175], v[192:195]
    ds_read_b64_tr_b16 v[154:155], v221 offset:30720
    v_mfma_f32_16x16x32_bf16 v[196:199], v[80:83], v[172:175], v[196:199]
    buffer_load_dwordx4 v[232:235], v249, s[24:27], s68 offen offset:0 sc1
    ds_read_b64_tr_b16 v[156:157], v222 offset:28672
    s_waitcnt vmcnt(5) lgkmcnt(15)
    v_mfma_f32_16x16x32_bf16 v[184:187], v[84:87], v[176:179], v[184:187]
    ds_read_b64_tr_b16 v[158:159], v222 offset:30720
    ds_read_b64_tr_b16 v[160:161], v223 offset:28672
    v_mfma_f32_16x16x32_bf16 v[188:191], v[88:91], v[176:179], v[188:191]
    ds_read_b64_tr_b16 v[162:163], v223 offset:30720
    v_mfma_f32_16x16x32_bf16 v[192:195], v[92:95], v[176:179], v[192:195]
    ds_read_b64_tr_b16 v[20:21], v220 offset:32768
    v_mfma_f32_16x16x32_bf16 v[196:199], v[96:99], v[176:179], v[196:199]
    buffer_load_dwordx4 v[236:239], v249, s[24:27], s68 offen offset:1024 sc1
    ds_read_b64_tr_b16 v[22:23], v220 offset:34816
    s_waitcnt vmcnt(5) lgkmcnt(15)
    v_mfma_f32_16x16x32_bf16 v[184:187], v[100:103], v[180:183], v[184:187]
    ds_read_b64_tr_b16 v[24:25], v221 offset:32768
    ds_read_b64_tr_b16 v[26:27], v221 offset:34816
    v_mfma_f32_16x16x32_bf16 v[188:191], v[104:107], v[180:183], v[188:191]
    ds_read_b64_tr_b16 v[28:29], v222 offset:32768
    v_mfma_f32_16x16x32_bf16 v[192:195], v[108:111], v[180:183], v[192:195]
    ds_read_b64_tr_b16 v[30:31], v222 offset:34816
    v_mfma_f32_16x16x32_bf16 v[196:199], v[112:115], v[180:183], v[196:199]
    ds_read_b64_tr_b16 v[32:33], v223 offset:32768
    s_waitcnt vmcnt(4) lgkmcnt(15)
HA2_5:
    s_cbranch_execz HA2_6
    v_mfma_f32_16x16x32_bf16 v[184:187], v[116:119], v[212:215], v[184:187]
    ds_read_b64_tr_b16 v[34:35], v223 offset:34816
    ds_read_b64_tr_b16 v[36:37], v220 offset:36864
    v_mfma_f32_16x16x32_bf16 v[188:191], v[120:123], v[212:215], v[188:191]
    ds_read_b64_tr_b16 v[38:39], v220 offset:38912
    v_mfma_f32_16x16x32_bf16 v[192:195], v[124:127], v[212:215], v[192:195]
    ds_read_b64_tr_b16 v[40:41], v221 offset:36864
    v_mfma_f32_16x16x32_bf16 v[196:199], v[128:131], v[212:215], v[196:199]
    ds_read_b64_tr_b16 v[42:43], v221 offset:38912
    s_waitcnt vmcnt(3) lgkmcnt(15)
    v_mfma_f32_16x16x32_bf16 v[184:187], v[132:135], v[12:15], v[184:187]
    ds_read_b64_tr_b16 v[44:45], v222 offset:36864
    ds_read_b64_tr_b16 v[46:47], v222 offset:38912
    v_mfma_f32_16x16x32_bf16 v[188:191], v[136:139], v[12:15], v[188:191]
    ds_read_b64_tr_b16 v[48:49], v223 offset:36864
    v_mfma_f32_16x16x32_bf16 v[192:195], v[140:143], v[12:15], v[192:195]
    ds_read_b64_tr_b16 v[50:51], v223 offset:38912
    v_mfma_f32_16x16x32_bf16 v[196:199], v[144:147], v[12:15], v[196:199]
    s_waitcnt vmcnt(2) lgkmcnt(15)
    v_mfma_f32_16x16x32_bf16 v[184:187], v[148:151], v[164:167], v[184:187]
    v_mfma_f32_16x16x32_bf16 v[188:191], v[152:155], v[164:167], v[188:191]
    v_mfma_f32_16x16x32_bf16 v[192:195], v[156:159], v[164:167], v[192:195]
    v_mfma_f32_16x16x32_bf16 v[196:199], v[160:163], v[164:167], v[196:199]
    ds_read_b32 v10, v251 offset:4
    s_waitcnt vmcnt(1) lgkmcnt(9)
    v_mfma_f32_16x16x32_bf16 v[184:187], v[20:23], v[232:235], v[184:187]
    v_mfma_f32_16x16x32_bf16 v[188:191], v[24:27], v[232:235], v[188:191]
    v_mfma_f32_16x16x32_bf16 v[192:195], v[28:31], v[232:235], v[192:195]
    v_mfma_f32_16x16x32_bf16 v[196:199], v[32:35], v[232:235], v[196:199]
    s_waitcnt vmcnt(0) lgkmcnt(1)
    v_mfma_f32_16x16x32_bf16 v[184:187], v[36:39], v[236:239], v[184:187]
    v_mfma_f32_16x16x32_bf16 v[188:191], v[40:43], v[236:239], v[188:191]
    v_mfma_f32_16x16x32_bf16 v[192:195], v[44:47], v[236:239], v[192:195]
    v_mfma_f32_16x16x32_bf16 v[196:199], v[48:51], v[236:239], v[196:199]
HA2_6:
    s_cbranch_execz HA2_7
    s_branch B_epi
B_half:
    buffer_load_dwordx4 v[164:167], v249, s[24:27], s17 offen offset:0 sc1
    buffer_load_dwordx4 v[232:235], v249, s[24:27], s17 offen offset:1024 sc1
    buffer_load_dwordx4 v[236:239], v249, s[24:27], s18 offen offset:0 sc1
    s_waitcnt vmcnt(8) lgkmcnt(15)
    v_mfma_f32_16x16x32_bf16 v[184:187], v[52:55], v[168:171], v[184:187]
    v_mfma_f32_16x16x32_bf16 v[188:191], v[56:59], v[168:171], v[188:191]
    v_mfma_f32_16x16x32_bf16 v[192:195], v[60:63], v[168:171], v[192:195]
    v_mfma_f32_16x16x32_bf16 v[196:199], v[64:67], v[168:171], v[196:199]
    s_waitcnt vmcnt(7) lgkmcnt(15)
    v_mfma_f32_16x16x32_bf16 v[184:187], v[68:71], v[172:175], v[184:187]
    v_mfma_f32_16x16x32_bf16 v[188:191], v[72:75], v[172:175], v[188:191]
    v_mfma_f32_16x16x32_bf16 v[192:195], v[76:79], v[172:175], v[192:195]
    v_mfma_f32_16x16x32_bf16 v[196:199], v[80:83], v[172:175], v[196:199]
    s_waitcnt vmcnt(6) lgkmcnt(15)
    v_mfma_f32_16x16x32_bf16 v[184:187], v[84:87], v[176:179], v[184:187]
    v_mfma_f32_16x16x32_bf16 v[188:191], v[88:91], v[176:179], v[188:191]
    v_mfma_f32_16x16x32_bf16 v[192:195], v[92:95], v[176:179], v[192:195]
    v_mfma_f32_16x16x32_bf16 v[196:199], v[96:99], v[176:179], v[196:199]
    s_waitcnt vmcnt(5) lgkmcnt(15)
    v_mfma_f32_16x16x32_bf16 v[184:187], v[100:103], v[180:183], v[184:187]
    v_mfma_f32_16x16x32_bf16 v[188:191], v[104:107], v[180:183], v[188:191]
    v_mfma_f32_16x16x32_bf16 v[192:195], v[108:111], v[180:183], v[192:195]
    v_mfma_f32_16x16x32_bf16 v[196:199], v[112:115], v[180:183], v[196:199]
    s_waitcnt vmcnt(4) lgkmcnt(15)
    v_mfma_f32_16x16x32_bf16 v[184:187], v[116:119], v[212:215], v[184:187]
    v_mfma_f32_16x16x32_bf16 v[188:191], v[120:123], v[212:215], v[188:191]
    v_mfma_f32_16x16x32_bf16 v[192:195], v[124:127], v[212:215], v[192:195]
    v_mfma_f32_16x16x32_bf16 v[196:199], v[128:131], v[212:215], v[196:199]
    s_waitcnt vmcnt(3) lgkmcnt(15)
    v_mfma_f32_16x16x32_bf16 v[184:187], v[132:135], v[12:15], v[184:187]
    v_mfma_f32_16x16x32_bf16 v[188:191], v[136:139], v[12:15], v[188:191]
    v_mfma_f32_16x16x32_bf16 v[192:195], v[140:143], v[12:15], v[192:195]
    v_mfma_f32_16x16x32_bf16 v[196:199], v[144:147], v[12:15], v[196:199]
    s_waitcnt vmcnt(2) lgkmcnt(15)
HA2_7:
    s_cbranch_execz HA_ret
    v_mfma_f32_16x16x32_bf16 v[184:187], v[148:151], v[164:167], v[184:187]
    v_mfma_f32_16x16x32_bf16 v[188:191], v[152:155], v[164:167], v[188:191]
    v_mfma_f32_16x16x32_bf16 v[192:195], v[156:159], v[164:167], v[192:195]
    v_mfma_f32_16x16x32_bf16 v[196:199], v[160:163], v[164:167], v[196:199]
    s_waitcnt vmcnt(1) lgkmcnt(8)
    v_mfma_f32_16x16x32_bf16 v[184:187], v[20:23], v[232:235], v[184:187]
    v_mfma_f32_16x16x32_bf16 v[188:191], v[24:27], v[232:235], v[188:191]
    v_mfma_f32_16x16x32_bf16 v[192:195], v[28:31], v[232:235], v[192:195]
    v_mfma_f32_16x16x32_bf16 v[196:199], v[32:35], v[232:235], v[196:199]
    s_waitcnt vmcnt(0) lgkmcnt(0)
    v_mfma_f32_16x16x32_bf16 v[184:187], v[36:39], v[236:239], v[184:187]
    v_mfma_f32_16x16x32_bf16 v[188:191], v[40:43], v[236:239], v[188:191]
    v_mfma_f32_16x16x32_bf16 v[192:195], v[44:47], v[236:239], v[192:195]
    v_mfma_f32_16x16x32_bf16 v[196:199], v[48:51], v[236:239], v[196:199]
    s_cmp_lg_u32 s48, 6
    s_cbranch_scc1 B_ne
    s_mov_b32 exec_hi, 0x0fffffff
    buffer_load_dword v17, v203, s[24:27], s100 offen sc1
    s_mov_b32 exec_hi, -1
    buffer_load_dwordx3 v[52:54], v4, s[24:27], s58 offen sc1
    buffer_load_dwordx3 v[56:58], v4, s[24:27], s59 offen sc1
    buffer_load_dwordx3 v[60:62], v4, s[24:27], s60 offen sc1
    buffer_load_dwordx3 v[64:66], v4, s[24:27], s12 offen sc1
    buffer_load_dwordx3 v[68:70], v4, s[24:27], s13 offen sc1
B_ne:
    s_lshl_b32 s61, s56, 12
    s_add_u32 s61, s61, 135168
    v_add_u32 v16, s61, v202
    s_lshl_b32 s61, s56, 2
    s_add_u32 s61, s61, 160760
    v_mov_b32 v18, s61
    s_cmp_eq_u32 s101, 0
    s_cbranch_scc1 B_rx0
    ds_write_b128 v16, v[184:187] offset:0
    ds_write_b128 v16, v[188:191] offset:1024
    ds_write_b128 v16, v[192:195] offset:2048
    ds_write_b128 v16, v[196:199] offset:3072
    v_mov_b32 v19, 1
    s_waitcnt lgkmcnt(0)
HA3_0:
    s_cbranch_execz HA3_1
    ds_write_b32 v18, v19
    s_cmp_lg_u32 s48, 6
    s_cbranch_scc1 L_fin
    s_setprio 3
    s_branch E_chk
E_poll:
    s_mov_b32 exec_hi, 0x0fffffff
    buffer_load_dword v17, v203, s[24:27], s100 offen sc1
    s_mov_b32 exec_hi, -1
    buffer_load_dwordx3 v[52:54], v4, s[24:27], s58 offen sc1
    buffer_load_dwordx3 v[56:58], v4, s[24:27], s59 offen sc1
    buffer_load_dwordx3 v[60:62], v4, s[24:27], s60 offen sc1
    buffer_load_dwordx3 v[64:66], v4, s[24:27], s12 offen sc1
    buffer_load_dwordx3 v[68:70], v4, s[24:27], s13 offen sc1
E_chk:
    s_waitcnt vmcnt(0)
    v_cmp_ne_u32 vcc, s54, v17
    s_lshl_b64 vcc, vcc, 4
    s_cbranch_scc0 E_go
    s_sleep 1
    s_sub_u32 s3, s3, 1
    s_cbranch_scc0 E_poll
    s_mov_b32 s3, 0
E_go:
    v_add_f32 v76, v52, v56
    v_add_f32 v77, v53, v57
    v_add_f32 v78, v54, v58
    v_add_f32 v76, v76, v60
    v_add_f32 v77, v77, v61
    v_add_f32 v78, v78, v62
    v_add_f32 v76, v76, v64
    v_add_f32 v77, v77, v65
    v_add_f32 v78, v78, v66
    v_add_f32 v76, v76, v68
    v_add_f32 v77, v77, v69
    v_add_f32 v78, v78, v70
    v_lshlrev_b32 v52, 16, v52
    v_lshlrev_b32 v53, 16, v53
    v_lshlrev_b32 v54, 16, v54
    v_lshlrev_b32 v56, 16, v56
    v_lshlrev_b32 v57, 16, v57
    v_lshlrev_b32 v58, 16, v58
    v_lshlrev_b32 v60, 16, v60
    v_lshlrev_b32 v61, 16, v61
    v_lshlrev_b32 v62, 16, v62
    v_lshlrev_b32 v64, 16, v64
    v_lshlrev_b32 v65, 16, v65
    v_lshlrev_b32 v66, 16, v66
    v_lshlrev_b32 v68, 16, v68
    v_lshlrev_b32 v69, 16, v69
    v_lshlrev_b32 v70, 16, v70
    v_add_f32 v72, v52, v56
    v_add_f32 v73, v53, v57
    v_add_f32 v74, v54, v58
    v_add_f32 v72, v72, v60
    v_add_f32 v73, v73, v61
    v_add_f32 v74, v74, v62
    v_add_f32 v72, v72, v64
HA3_1:
    s_cbranch_execz HA3_2
    v_add_f32 v73, v73, v65
    v_add_f32 v74, v74, v66
    v_add_f32 v72, v72, v68
    v_add_f32 v73, v73, v69
    v_add_f32 v74, v74, v70
    v_permlane32_swap_b32 v72, v76
    v_permlane32_swap_b32 v73, v77
    v_permlane32_swap_b32 v74, v78
    v_add_f32 v72, v72, v76
    v_add_f32 v73, v73, v77
    v_add_f32 v74, v74, v78
    v_rsq_f32 v76, v72
    v_rsq_f32 v77, v73
    v_rsq_f32 v78, v74
    v_permlane32_swap_b32 v76, v80
    v_permlane32_swap_b32 v77, v81
    v_permlane32_swap_b32 v78, v82
    v_mul_f32 v72, v72, v80
    v_mul_f32 v73, v73, v81
    v_mul_f32 v74, v74, v82
    v_and_or_b32 v76, v72, v204, v8
    v_and_or_b32 v77, v73, v205, v9
    v_and_or_b32 v78, v74, v206, v10
    v_max3_i32 v6, v76, v77, v78
    s_nop 1
    v_max_i32_dpp v6, v6, v6 row_ror:1 row_mask:0xf bank_mask:0xf
    s_nop 1
    v_max_i32_dpp v6, v6, v6 row_ror:2 row_mask:0xf bank_mask:0xf
    s_nop 1
    v_max_i32_dpp v6, v6, v6 row_ror:4 row_mask:0xf bank_mask:0xf
    s_nop 1
    v_max_i32_dpp v6, v6, v6 row_ror:8 row_mask:0xf bank_mask:0xf
    v_mov_b32 v5, v6
    s_nop 1
    v_permlane16_swap_b32 v6, v5
    s_mov_b64 exec, 0xffff
    v_max3_i32 v6, v6, v5, 1
    ds_write_b32 v251, v6 offset:4
    s_cmp_lg_u32 s51, 0
    s_cbranch_scc1 L_fin
    buffer_store_dwordx2 v[6:7], v11, s[24:27], s45 offen sc1
    s_branch L_fin
B_rx0:
B_rx:
    ds_read_b32 v19, v18
    s_waitcnt lgkmcnt(0)
    v_cmp_eq_u32 vcc, 0, v19
    s_cbranch_vccz B_rd
    s_sub_u32 s3, s3, 1
    s_cbranch_scc0 B_rx
    s_mov_b32 s3, 0
B_rd:
    ds_read_b32 v10, v251 offset:4
HA3_2:
    s_cbranch_execz HA3_3
    ds_read_b128 v[100:103], v16 offset:0
    ds_read_b128 v[104:107], v16 offset:1024
    ds_read_b128 v[108:111], v16 offset:2048
    ds_read_b128 v[112:115], v16 offset:3072
    s_waitcnt lgkmcnt(0)
    v_add_f32 v184, v184, v100
    v_add_f32 v185, v185, v101
    v_add_f32 v186, v186, v102
    v_add_f32 v187, v187, v103
    v_add_f32 v188, v188, v104
    v_add_f32 v189, v189, v105
    v_add_f32 v190, v190, v106
    v_add_f32 v191, v191, v107
    v_add_f32 v192, v192, v108
    v_add_f32 v193, v193, v109
    v_add_f32 v194, v194, v110
    v_add_f32 v195, v195, v111
    v_add_f32 v196, v196, v112
    v_add_f32 v197, v197, v113
    v_add_f32 v198, v198, v114
    v_add_f32 v199, v199, v115
B_epi:
    s_waitcnt lgkmcnt(0)
    v_cmp_eq_u32 vcc, 0, v10
    v_and_b32 v10, 0xfff, v10
    s_cbranch_vccnz B_ew
B_eg:
    v_cmp_eq_u32 s[68:69], v10, v226
    v_add_u32 v10, s54, v10
    v_mov_b32 v16, 0x3f803f80
    v_mov_b32 v15, s54
    s_add_u32 s63, s1, 30720
    s_lshl_b32 s64, s51, 8
    s_add_u32 s64, s64, s63
    v_cvt_pk_bf16_f32 v52, v184, v185
    v_cvt_pk_bf16_f32 v53, v186, v187
    v_cvt_pk_bf16_f32 v54, v188, v189
    v_cvt_pk_bf16_f32 v55, v190, v191
    v_cvt_pk_bf16_f32 v56, v192, v193
    v_cvt_pk_bf16_f32 v57, v194, v195
    v_cvt_pk_bf16_f32 v58, v196, v197
    v_cvt_pk_bf16_f32 v59, v198, v199
    s_cmp_eq_u64 s[68:69], 0
    s_cbranch_scc1 B_np2
    s_mov_b64 exec, s[68:69]
    ds_write_b128 v228, v[52:55] offset:0
    ds_write_b128 v228, v[56:59] offset:16
    s_mov_b64 exec, -1
HA3_3:
    s_cbranch_execz HA3_4
    ds_read_b64 v[8:9], v252
    s_waitcnt lgkmcnt(0)
    buffer_store_dwordx3 v[8:10], v224, s[24:27], s44 offen sc1
B_np2:
    v_dot2_f32_bf16 v12, v52, v16, 0
    v_dot2_f32_bf16 v13, v52, v52, 0
    v_dot2_f32_bf16 v14, v52, v240, 0
    v_dot2_f32_bf16 v12, v53, v16, v12
    v_dot2_f32_bf16 v13, v53, v53, v13
    v_dot2_f32_bf16 v14, v53, v241, v14
    v_dot2_f32_bf16 v12, v54, v16, v12
    v_dot2_f32_bf16 v13, v54, v54, v13
    v_dot2_f32_bf16 v14, v54, v242, v14
    v_dot2_f32_bf16 v12, v55, v16, v12
    v_dot2_f32_bf16 v13, v55, v55, v13
    v_dot2_f32_bf16 v14, v55, v243, v14
    v_dot2_f32_bf16 v12, v56, v16, v12
    v_dot2_f32_bf16 v13, v56, v56, v13
    v_dot2_f32_bf16 v14, v56, v244, v14
    v_dot2_f32_bf16 v12, v57, v16, v12
    v_dot2_f32_bf16 v13, v57, v57, v13
    v_dot2_f32_bf16 v14, v57, v245, v14
    v_dot2_f32_bf16 v12, v58, v16, v12
    v_dot2_f32_bf16 v13, v58, v58, v13
    v_dot2_f32_bf16 v14, v58, v246, v14
    v_dot2_f32_bf16 v12, v59, v16, v12
    v_dot2_f32_bf16 v13, v59, v59, v13
    v_dot2_f32_bf16 v14, v59, v247, v14
    s_nop 0
    v_mov_b32 v17, v12
    v_mov_b32 v18, v13
    v_mov_b32 v19, v14
    v_permlane32_swap_b32 v17, v12
    v_permlane32_swap_b32 v18, v13
    v_permlane32_swap_b32 v19, v14
    v_add_f32 v12, v12, v17
HA3_4:
    s_cbranch_execz HA3_5
    v_add_f32 v13, v13, v18
    v_add_f32 v14, v14, v19
    v_mov_b32 v17, v12
    v_mov_b32 v18, v13
    v_mov_b32 v19, v14
    v_permlane16_swap_b32 v17, v12
    v_permlane16_swap_b32 v18, v13
    v_permlane16_swap_b32 v19, v14
    v_add_f32 v12, v12, v17
    v_add_f32 v13, v13, v18
    v_add_f32 v14, v14, v19
    s_mov_b64 exec, 0xffff
    s_cmp_eq_u32 s49, 0
    s_cbranch_scc1 sts_11
    buffer_store_dwordx4 v[12:15], v202, s[24:27], s64 offen
std_12:
    s_mov_b64 exec, -1
    v_lshlrev_b32 v36, 16, v52
    v_and_b32 v37, s47, v52
    v_lshlrev_b32 v38, 16, v53
    v_and_b32 v39, s47, v53
    v_lshlrev_b32 v40, 16, v54
    v_and_b32 v41, s47, v54
    v_lshlrev_b32 v42, 16, v55
    v_and_b32 v43, s47, v55
    v_lshlrev_b32 v44, 16, v56
    v_and_b32 v45, s47, v56
    v_lshlrev_b32 v46, 16, v57
    v_and_b32 v47, s47, v57
    v_lshlrev_b32 v48, 16, v58
    v_and_b32 v49, s47, v58
    v_lshlrev_b32 v50, 16, v59
    v_and_b32 v51, s47, v59
    v_mov_b32 v108, 0
    v_mov_b32 v109, 0
    v_mov_b32 v110, 0
    v_mov_b32 v111, s54
    v_mov_b32 v11, s54
    v_lshlrev_b32 v7, 11, v200
    s_add_u32 s45, s45, 32768
    s_sub_u32 s44, s44, 131072
S_poll:
    buffer_load_dwordx4 v[100:103], v202, s[24:27], s63 offen sc1
    buffer_load_dwordx4 v[104:107], v202, s[24:27], s63 offen offset:1024 sc1
    s_mov_b32 exec_hi, 0
    buffer_load_dwordx4 v[108:111], v202, s[24:27], s63 offen offset:2048 sc1
    s_mov_b32 exec_hi, -1
    s_waitcnt vmcnt(0)
    v_cmp_ne_u32 vcc, s54, v103
    v_cmp_ne_u32 s[64:65], s54, v107
    v_cmp_ne_u32 s[66:67], s54, v111
    s_or_b64 vcc, vcc, s[64:65]
    s_or_b64 vcc, vcc, s[66:67]
    s_cbranch_vccz S_got
    s_sub_u32 s3, s3, 1
    s_cbranch_scc0 S_poll
HA3_5:
    s_cbranch_execz HA3_6
    s_mov_b32 s3, 0
S_got:
    v_add_f32 v12, v100, v104
    v_add_f32 v13, v101, v105
    v_add_f32 v14, v102, v106
    v_add_f32 v12, v12, v108
    v_add_f32 v13, v13, v109
    v_add_f32 v14, v14, v110
    v_mov_b32 v17, v12
    v_mov_b32 v18, v13
    v_mov_b32 v19, v14
    v_permlane32_swap_b32 v17, v12
    v_permlane32_swap_b32 v18, v13
    v_permlane32_swap_b32 v19, v14
    v_add_f32 v12, v12, v17
    v_add_f32 v13, v13, v18
    v_add_f32 v14, v14, v19
    v_mov_b32 v17, v12
    v_mov_b32 v18, v13
    v_mov_b32 v19, v14
    v_permlane16_swap_b32 v17, v12
    v_permlane16_swap_b32 v18, v13
    v_permlane16_swap_b32 v19, v14
    v_add_f32 v12, v12, v17
    v_add_f32 v13, v13, v18
    v_add_f32 v14, v14, v19
    v_mul_f32 v12, 0x3acccccd, v12
    v_mul_f32 v13, 0x3acccccd, v13
    v_fma_f32 v13, -v12, v12, v13
    v_max_f32 v13, 0, v13
    v_cvt_pk_bf16_f32 v13, v13, v13
    v_and_b32 v13, 0xffff0000, v13
    v_add_f32 v13, 0x3727c5ac, v13
    v_cvt_pk_bf16_f32 v13, v13, v13
    v_and_b32 v13, 0xffff0000, v13
    v_sqrt_f32 v13, v13
    v_cvt_pk_bf16_f32 v12, v12, v12
    v_and_b32 v12, 0xffff0000, v12
    v_cvt_pk_bf16_f32 v13, v13, v13
    v_and_b32 v13, 0xffff0000, v13
    v_rcp_f32 v13, v13
    v_fma_f32 v14, -v12, v248, v14
    v_mul_f32 v14, v14, v13
    v_ashrrev_i32 v6, 31, v14
    v_or_b32 v6, 0x80000000, v6
    v_xor_b32 v6, v6, v14
    v_and_b32 v6, 0xfffff000, v6
    v_or_b32 v6, v6, v226
    s_and_b64 exec, s[4:5], 0xffff
    ds_max_u32 v251, v6 offset:12
    s_mov_b64 exec, -1
HA3_6:
    s_cbranch_execz HA3_7
    v_sub_f32 v20, v36, v12
    v_sub_f32 v21, v37, v12
    v_sub_f32 v22, v38, v12
    v_sub_f32 v23, v39, v12
    v_sub_f32 v24, v40, v12
    v_sub_f32 v25, v41, v12
    v_sub_f32 v26, v42, v12
    v_sub_f32 v27, v43, v12
    s_waitcnt lgkmcnt(0)
    s_barrier
    ds_read_b32 v10, v251 offset:12
    v_sub_f32 v28, v44, v12
    v_sub_f32 v29, v45, v12
    v_sub_f32 v30, v46, v12
    v_sub_f32 v31, v47, v12
    v_sub_f32 v32, v48, v12
    v_sub_f32 v33, v49, v12
    v_sub_f32 v34, v50, v12
    v_sub_f32 v35, v51, v12
    s_or_b32 s64, s51, s48
    s_waitcnt lgkmcnt(0)
    s_cbranch_scc1 S_nc
    s_mov_b64 exec, 0xffff
    buffer_store_dwordx2 v[10:11], v7, s[24:27], s45 offen sc1
    s_mov_b64 exec, -1
S_nc:
    v_cmp_eq_u32 s[68:69], v10, v6
    v_cvt_pk_bf16_f32 v60, v20, v21
    v_cvt_pk_bf16_f32 v61, v22, v23
    v_cvt_pk_bf16_f32 v62, v24, v25
    v_cvt_pk_bf16_f32 v63, v26, v27
    v_cvt_pk_bf16_f32 v64, v28, v29
    v_cvt_pk_bf16_f32 v65, v30, v31
    v_cvt_pk_bf16_f32 v66, v32, v33
    v_cvt_pk_bf16_f32 v67, v34, v35
    v_lshlrev_b32 v20, 16, v60
    v_and_b32 v21, s47, v60
    v_lshlrev_b32 v22, 16, v61
    v_and_b32 v23, s47, v61
    v_lshlrev_b32 v24, 16, v62
    v_and_b32 v25, s47, v62
    v_lshlrev_b32 v26, 16, v63
    v_and_b32 v27, s47, v63
    v_lshlrev_b32 v28, 16, v64
    v_and_b32 v29, s47, v64
    v_lshlrev_b32 v30, 16, v65
    v_and_b32 v31, s47, v65
    v_lshlrev_b32 v32, 16, v66
HA3_7:
    s_cbranch_execz HA3_8
    v_and_b32 v33, s47, v66
    v_lshlrev_b32 v34, 16, v67
    v_and_b32 v35, s47, v67
    v_mul_f32 v20, v20, v13
    v_mul_f32 v21, v21, v13
    v_mul_f32 v22, v22, v13
    v_mul_f32 v23, v23, v13
    v_mul_f32 v24, v24, v13
    v_mul_f32 v25, v25, v13
    v_mul_f32 v26, v26, v13
    v_mul_f32 v27, v27, v13
    v_mul_f32 v28, v28, v13
    v_mul_f32 v29, v29, v13
    v_mul_f32 v30, v30, v13
    v_mul_f32 v31, v31, v13
    v_mul_f32 v32, v32, v13
    v_mul_f32 v33, v33, v13
    v_mul_f32 v34, v34, v13
    v_mul_f32 v35, v35, v13
    v_cvt_pk_bf16_f32 v60, v20, v21
    v_cvt_pk_bf16_f32 v61, v22, v23
    v_cvt_pk_bf16_f32 v62, v24, v25
    v_cvt_pk_bf16_f32 v63, v26, v27
    v_cvt_pk_bf16_f32 v64, v28, v29
    v_cvt_pk_bf16_f32 v65, v30, v31
    v_cvt_pk_bf16_f32 v66, v32, v33
    v_cvt_pk_bf16_f32 v67, v34, v35
    v_lshlrev_b32 v20, 16, v60
    v_and_b32 v21, s47, v60
    v_lshlrev_b32 v22, 16, v61
    v_and_b32 v23, s47, v61
    v_lshlrev_b32 v24, 16, v62
    v_and_b32 v25, s47, v62
    v_lshlrev_b32 v26, 16, v63
    v_and_b32 v27, s47, v63
    v_lshlrev_b32 v28, 16, v64
    v_and_b32 v29, s47, v64
    v_lshlrev_b32 v30, 16, v65
    v_and_b32 v31, s47, v65
    v_lshlrev_b32 v32, 16, v66
    v_and_b32 v33, s47, v66
    v_lshlrev_b32 v34, 16, v67
    v_and_b32 v35, s47, v67
    v_add_f32 v20, v20, v36
    v_add_f32 v21, v21, v37
    v_add_f32 v22, v22, v38
    v_add_f32 v23, v23, v39
    v_add_f32 v24, v24, v40
    v_add_f32 v25, v25, v41
    v_add_f32 v26, v26, v42
    v_add_f32 v27, v27, v43
    v_add_f32 v28, v28, v44
    v_add_f32 v29, v29, v45
    v_add_f32 v30, v30, v46
    v_add_f32 v31, v31, v47
HA3_8:
    s_cbranch_execz HA_ret
    v_add_f32 v32, v32, v48
    v_add_f32 v33, v33, v49
    v_add_f32 v34, v34, v50
    v_add_f32 v35, v35, v51
    v_cvt_pk_bf16_f32 v60, v20, v21
    v_cvt_pk_bf16_f32 v61, v22, v23
    v_cvt_pk_bf16_f32 v62, v24, v25
    v_cvt_pk_bf16_f32 v63, v26, v27
    v_cvt_pk_bf16_f32 v64, v28, v29
    v_cvt_pk_bf16_f32 v65, v30, v31
    v_cvt_pk_bf16_f32 v66, v32, v33
    v_cvt_pk_bf16_f32 v67, v34, v35
    v_permlane16_swap_b32 v60, v62
    v_permlane16_swap_b32 v61, v63
    v_permlane16_swap_b32 v64, v66
    v_permlane16_swap_b32 v65, v67
    buffer_store_dwordx4 v[60:63], v225, s[40:43], 0 offen offset:0 sc1
    buffer_store_dwordx4 v[64:67], v225, s[40:43], 0 offen offset:64 sc1
    s_and_b64 s[68:69], s[68:69], s[4:5]
    s_cbranch_scc0 L_fin
    s_mov_b64 exec, s[68:69]
    ds_write_b128 v228, v[52:55] offset:0
    ds_write_b128 v228, v[56:59] offset:16
    s_mov_b64 exec, -1
    ds_read_b64 v[8:9], v252
    v_and_b32 v10, 0xfff, v10
    v_add_u32 v10, s54, v10
    s_mov_b64 exec, 0xffff
    s_waitcnt vmcnt(0) lgkmcnt(0)
    buffer_store_dwordx3 v[8:10], v224, s[24:27], s44 offen sc1
L_fin:
L_end:
    s_endpgm
AT_mask:
    v_mov_b32 v17, 0xf149f2ca
    v_cmp_le_i32 vcc, 8, v212
    s_nop 1
    v_cndmask_b32 v60, v17, v60, vcc
    v_cmp_le_i32 vcc, 7, v212
    s_nop 1
    v_cndmask_b32 v61, v17, v61, vcc
    v_cmp_le_i32 vcc, 6, v212
    s_nop 1
    v_cndmask_b32 v62, v17, v62, vcc
    v_cmp_le_i32 vcc, 5, v212
    s_nop 1
    v_cndmask_b32 v63, v17, v63, vcc
    v_cmp_le_i32 vcc, 4, v212
    s_nop 1
    v_cndmask_b32 v64, v17, v64, vcc
    v_cmp_le_i32 vcc, 3, v212
    s_nop 1
    v_cndmask_b32 v65, v17, v65, vcc
    v_cmp_le_i32 vcc, 2, v212
    s_nop 1
    v_cndmask_b32 v66, v17, v66, vcc
    v_cmp_le_i32 vcc, 1, v212
    s_nop 1
    v_cndmask_b32 v67, v17, v67, vcc
    v_cmp_le_i32 vcc, 0, v212
    s_nop 1
    v_cndmask_b32 v68, v17, v68, vcc
    v_cmp_le_i32 vcc, -1, v212
    s_nop 1
    v_cndmask_b32 v69, v17, v69, vcc
    v_cmp_le_i32 vcc, -2, v212
    s_nop 1
    v_cndmask_b32 v70, v17, v70, vcc
    v_cmp_le_i32 vcc, -3, v212
    s_nop 1
    v_cndmask_b32 v71, v17, v71, vcc
    s_branch AT_nomask
sts_3:
    buffer_store_dwordx4 v[80:83], v206, s[24:27], s12 offen offset:1024 sc1
    buffer_store_dwordx4 v[84:87], v206, s[24:27], s12 offen offset:1536 sc1
    s_branch std_4
sts_5:
    buffer_store_dwordx4 v[204:207], v249, s[24:27], s22 offen offset:0 sc1
    buffer_store_dwordx4 v[208:211], v249, s[24:27], s22 offen offset:1024 sc1
    s_branch std_6
sts_7:
    buffer_store_short_d16_hi v20, v164, s[24:27], s65 offen sc1
    s_branch std_8
sts_9:
    buffer_store_dword v79, v203, s[24:27], s23 offen sc1
    s_branch std_10
B_ew:
    s_sleep 1
    ds_read_b32 v10, v251 offset:4
    s_sub_u32 s3, s3, 1
    s_cbranch_scc0 B_epi
    s_mov_b32 s3, 0
    s_waitcnt lgkmcnt(0)
    s_branch B_eg
sts_11:
    buffer_store_dwordx4 v[12:15], v202, s[24:27], s64 offen sc1
    s_branch std_12
F_start:
    s_and_b32 s49, s2, 7
    s_lshl_b32 s49, s49, 1
    s_add_u32 s49, s49, s56
    s_sub_u32 s49, s49, 30
    s_and_b32 s50, s48, 1
    s_lshr_b32 s51, s48, 1
    s_mul_i32 s52, s48, 6144
    s_mul_i32 s61, s49, 192
    v_mov_b32 v5, 128
    v_add_u32 v1, 0, v0
    v_mul_u32_u24 v2, 171, v1
    v_lshrrev_b32 v2, 11, v2
    v_mul_u32_u24 v3, 12, v2
    v_sub_u32 v3, v1, v3
    v_mul_u32_u24 v2, 3072, v2
    v_lshl_add_u32 v3, v3, 4, s61
    v_lshrrev_b32 v4, 8, v3
    v_cmp_eq_u32 vcc, 9, v4
    s_nop 1
    v_cndmask_b32 v4, 0, v5, vcc
    v_xad_u32 v210, v3, v4, v2
    v_add_u32 v1, 64, v0
    v_mul_u32_u24 v2, 171, v1
    v_lshrrev_b32 v2, 11, v2
    v_mul_u32_u24 v3, 12, v2
    v_sub_u32 v3, v1, v3
    v_mul_u32_u24 v2, 3072, v2
    v_lshl_add_u32 v3, v3, 4, s61
    v_lshrrev_b32 v4, 8, v3
    v_cmp_eq_u32 vcc, 9, v4
    s_nop 1
    v_cndmask_b32 v4, 0, v5, vcc
    v_xad_u32 v211, v3, v4, v2
    v_add_u32 v1, 128, v0
    v_mul_u32_u24 v2, 171, v1
    v_lshrrev_b32 v2, 11, v2
    v_mul_u32_u24 v3, 12, v2
    v_sub_u32 v3, v1, v3
    v_mul_u32_u24 v2, 3072, v2
    v_lshl_add_u32 v3, v3, 4, s61
    v_lshrrev_b32 v4, 8, v3
    v_cmp_eq_u32 vcc, 9, v4
    s_nop 1
    v_cndmask_b32 v4, 0, v5, vcc
    v_xad_u32 v212, v3, v4, v2
    s_mul_i32 s60, s51, 491520
    s_mov_b32 s30, 1966080
    s_mov_b32 s31, 0x00020000
    s_waitcnt lgkmcnt(0)
    s_cmp_eq_u32 s50, 0
    s_cselect_b32 s28, s14, s16
    s_cselect_b32 s29, s15, s17
    s_and_b32 s29, s29, 0xffff
    s_add_u32 m0, s52, 0
    s_add_u32 s62, s60, 0
    buffer_load_dwordx4 v210, s[28:31], s62 offen lds
    s_add_u32 m0, s52, 1024
    s_add_u32 s62, s60, 0
    buffer_load_dwordx4 v211, s[28:31], s62 offen lds
    s_add_u32 m0, s52, 2048
    s_add_u32 s62, s60, 0
    buffer_load_dwordx4 v212, s[28:31], s62 offen lds
    s_add_u32 m0, s52, 3072
    s_add_u32 s62, s60, 49152
    buffer_load_dwordx4 v210, s[28:31], s62 offen lds
    s_add_u32 m0, s52, 4096
    s_add_u32 s62, s60, 49152
    buffer_load_dwordx4 v211, s[28:31], s62 offen lds
    s_add_u32 m0, s52, 5120
    s_add_u32 s62, s60, 49152
    buffer_load_dwordx4 v212, s[28:31], s62 offen lds
    s_load_dword s54, s[22:23], 0
    s_mov_b32 s36, s8
    s_and_b32 s37, s9, 0xffff
    s_mov_b32 s38, 819200
    s_mov_b32 s39, 0x00020000
    s_mov_b32 s4, s12
    s_and_b32 s5, s13, 0xffff
    s_mov_b32 s6, 1280
    s_mov_b32 s7, 0x00020000
    s_mov_b32 s24, s22
    s_and_b32 s25, s23, 0xffff
    s_mov_b32 s26, 7340032
    s_mov_b32 s27, 0x00020000
    s_mov_b32 s32, s18
    s_and_b32 s33, s19, 0xffff
    s_mov_b32 s34, 1966080
    s_mov_b32 s35, 0x00020000
    s_mov_b32 s40, s20
    s_and_b32 s41, s21, 0xffff
    s_mov_b32 s42, 2621440
    s_mov_b32 s43, 0x00020000
    s_cmp_lg_u32 s48, 7
    s_cbranch_scc1 F_ntlb
    s_lshr_b32 s63, 25945, s49
    s_bitcmp0_b32 s63, 0
    s_cbranch_scc1 F_ntlb
    v_lshlrev_b32 v7, 16, v0
    buffer_load_dword v219, v7, s[40:43], 0 offen sc1
    buffer_load_dword v219, v7, s[36:39], 0 offen
    v_lshlrev_b32 v7, 17, v0
    buffer_load_dword v219, v7, s[24:27], 64 offen sc1
F_ntlb:
    s_add_u32 m0, s52, 49152
    s_add_u32 s62, s60, 98304
    buffer_load_dwordx4 v210, s[28:31], s62 offen lds
    s_add_u32 m0, s52, 50176
    s_add_u32 s62, s60, 98304
    buffer_load_dwordx4 v211, s[28:31], s62 offen lds
    s_add_u32 m0, s52, 51200
    s_add_u32 s62, s60, 98304
    buffer_load_dwordx4 v212, s[28:31], s62 offen lds
    s_add_u32 m0, s52, 52224
    s_add_u32 s62, s60, 147456
    buffer_load_dwordx4 v210, s[28:31], s62 offen lds
    s_add_u32 m0, s52, 53248
    s_add_u32 s62, s60, 147456
    buffer_load_dwordx4 v211, s[28:31], s62 offen lds
    s_add_u32 m0, s52, 54272
    s_add_u32 s62, s60, 147456
    buffer_load_dwordx4 v212, s[28:31], s62 offen lds
    s_mul_i32 s53, s48, 5120
    s_mul_i32 s61, s49, 122880
    s_add_u32 s61, s61, s53
    s_and_b32 s63, s48, 2
    s_lshl_b32 s63, s63, 2
    v_add_u32 v1, 0, v0
    v_mul_u32_u24 v2, 205, v1
    v_lshrrev_b32 v2, 14, v2
    v_lshl_or_b32 v2, v2, 1, s63
    v_xor_b32 v1, v1, v2
    v_lshlrev_b32 v213, 4, v1
    v_add_u32 v1, 64, v0
    v_mul_u32_u24 v2, 205, v1
    v_lshrrev_b32 v2, 14, v2
    v_lshl_or_b32 v2, v2, 1, s63
    v_xor_b32 v1, v1, v2
    v_lshlrev_b32 v214, 4, v1
    v_add_u32 v1, 128, v0
    v_mul_u32_u24 v2, 205, v1
    v_lshrrev_b32 v2, 14, v2
    v_lshl_or_b32 v2, v2, 1, s63
    v_xor_b32 v1, v1, v2
    v_lshlrev_b32 v215, 4, v1
    v_add_u32 v1, 192, v0
    v_mul_u32_u24 v2, 205, v1
    v_lshrrev_b32 v2, 14, v2
    v_lshl_or_b32 v2, v2, 1, s63
    v_xor_b32 v1, v1, v2
    v_lshlrev_b32 v216, 4, v1
    v_add_u32 v1, 256, v0
    v_mul_u32_u24 v2, 205, v1
    v_lshrrev_b32 v2, 14, v2
    v_lshl_or_b32 v2, v2, 1, s63
    v_xor_b32 v1, v1, v2
    v_lshlrev_b32 v217, 4, v1
    v_lshrrev_b32 v2, 4, v0
    v_bfe_u32 v1, v0, 2, 2
    v_lshl_add_u32 v3, v2, 3, v1
    v_and_b32 v4, 3, v0
    v_lshlrev_b32 v4, 3, v4
    v_mul_u32_u24 v5, 192, v3
    v_add3_u32 v218, v5, v4, s52
    v_and_b32 v6, 1, v2
    v_lshl_or_b32 v6, v6, 2, v1
    v_lshlrev_b32 v6, 5, v6
    v_mul_u32_u24 v3, 1280, v3
    s_mul_i32 s63, s48, 160
    s_add_u32 s64, s63, 0
    v_add_u32 v7, s64, v4
    v_xor_b32 v7, v7, v6
    v_add_u32 v200, v7, v3
    v_add_u32 v205, 98304, v200
    s_add_u32 s64, s63, 32
    v_add_u32 v7, s64, v4
    v_xor_b32 v7, v7, v6
    v_add_u32 v201, v7, v3
    v_add_u32 v206, 98304, v201
    s_add_u32 s64, s63, 64
    v_add_u32 v7, s64, v4
    v_xor_b32 v7, v7, v6
    v_add_u32 v202, v7, v3
    v_add_u32 v207, 98304, v202
    s_add_u32 s64, s63, 96
    v_add_u32 v7, s64, v4
    v_xor_b32 v7, v7, v6
    v_add_u32 v203, v7, v3
    v_add_u32 v208, 98304, v203
    s_add_u32 s64, s63, 128
    v_add_u32 v7, s64, v4
    v_xor_b32 v7, v7, v6
    v_add_u32 v204, v7, v3
    v_add_u32 v209, 98304, v204
    s_waitcnt lgkmcnt(0)
    s_add_u32 s54, s54, 2654435761
    s_mov_b32 s67, 0x3f803f80
    v_mov_b32 v220, s67
    v_mov_b32 v221, s67
    v_mov_b32 v222, s67
    v_mov_b32 v223, s67
    s_mul_i32 s65, s48, 384
    v_lshl_add_u32 v3, v2, 4, s65
    v_add_u32 v230, 140544, v3
    v_lshlrev_b32 v16, 3, v0
    buffer_load_dwordx2 v[10:11], v16, s[4:7], 0 offen offset:0
    buffer_load_dwordx2 v[12:13], v16, s[4:7], 0 offen offset:512
    buffer_load_dwordx2 v[14:15], v16, s[4:7], 0 offen offset:1024
    v_lshlrev_b32 v1, 4, v0
    v_lshlrev_b32 v7, 6, v0
    s_lshl_b32 s15, s49, 11
    s_add_u32 s15, s15, 196608
    s_add_u32 s70, s15, 32768
    s_cmp_eq_u32 s48, 7
    s_cselect_b32 s65, s70, 2.0
    s_mov_b64 exec, 0xffffff
    buffer_load_dword v219, v7, s[24:27], s65 offen sc1
    s_mov_b64 exec, -1
    v_mov_b32 v8, 140288
    v_mov_b32 v224, 0
    v_mov_b32 v225, 0
    v_mov_b32 v226, 0
    v_mov_b32 v227, 0
    ds_write_b128 v8, v[224:227] offset:0
    ds_write_b128 v8, v[224:227] offset:16
    ds_write_b128 v8, v[224:227] offset:32
    s_mul_i32 s65, s48, 1344
    v_add_u32 v16, s65, v16
    v_and_b32 v5, 7, v0
    v_mul_u32_u24 v6, 3088, v5
    v_add_u32 v3, v3, v6
    v_lshlrev_b32 v6, 4, v2
    v_mul_u32_u24 v9, 1344, v5
    s_mul_i32 s65, s51, 320
    v_add3_u32 v9, v9, v6, s65
    s_mul_i32 s65, s48, 48
    v_add_u32 v4, s65, v0
    v_lshlrev_b32 v5, 1, v4
    v_lshlrev_b32 v4, 2, v4
    v_and_b32 v18, 1, v2
    v_and_b32 v19, 15, v0
    v_lshlrev_b32 v17, 4, v19
    v_lshl_add_u32 v17, v18, 10, v17
    v_lshlrev_b32 v18, 4, v18
    v_add_u32 v18, 2048, v18
    v_cmp_gt_u32 vcc, 4, v19
    s_nop 1
    v_cndmask_b32 v17, v18, v17, vcc
    v_lshrrev_b32 v18, 1, v2
    v_mul_u32_u24 v18, 3072, v18
    v_add_u32 v17, v17, v18
    s_mul_i32 s8, s48, 6144
    s_lshl_b32 s65, s49, 6
    s_add_u32 s8, s8, s65
    s_add_u32 s8, s8, 32768
    s_sub_u32 s65, s54, 1
    v_mov_b32 v227, s65
    s_mov_b32 exec_lo, 0x001f001f
    s_mov_b32 exec_hi, 0x001f001f
    buffer_store_dwordx4 v[224:227], v17, s[24:27], s8 offen sc1
    s_mov_b64 exec, -1
    s_sub_u32 s44, s48, 2
    s_mul_i32 s14, s49, 3072
    s_lshl_b32 s65, s44, 10
    s_add_u32 s14, s14, s65
    s_add_u32 s14, s14, 32768
    s_lshr_b32 s65, s49, 1
    s_mul_i32 s65, s65, 16
    s_lshl_b32 s66, s49, 1
    s_add_u32 s65, s65, s66
    s_and_b32 s66, s44, 1
    s_cmp_eq_u32 s44, 2
    s_cselect_b32 s66, 16, s66
    s_cselect_b32 s63, 0, 2
    s_cselect_b32 s18, 0x33333333, -1
    s_mov_b32 s19, s18
    s_add_u32 s65, s65, s66
    v_and_b32 v18, 3, v0
    v_lshlrev_b32 v18, s63, v18
    v_add_lshl_u32 v18, v18, s65, 3
    v_lshl_add_u32 v19, v2, 1, v18
    s_mov_b32 s9, 0x07060503
    s_mov_b32 s10, 0x07060502
    s_mov_b32 s11, 0x07060501
    s_mov_b32 s12, 0x04000c0c
    s_mov_b32 s13, 0x0706000c
    s_lshr_b32 s16, s49, 2
    s_mul_i32 s16, s16, 61440
    s_add_u32 s16, s16, 262144
    s_mov_b32 s17, 0
    s_mov_b32 s20, 16
    s_movk_i32 s68, 3088
    s_movk_i32 s69, 1344
    v_add_u32 v228, 140544, v4
    s_lshl_b32 s65, s48, 2
    v_add_u32 v231, s65, v8
    s_cmp_lg_u32 s48, 6
    s_cbranch_scc1 HF_ret
    s_mov_b64 exec, 0
    s_branch HF0_0
HF_ret:
    s_mov_b64 exec, -1
    s_waitcnt vmcnt(11)
    ds_read_b64_tr_b16 v[20:21], v218 offset:0
    ds_read_b64_tr_b16 v[22:23], v218 offset:768
    ds_read_b64_tr_b16 v[24:25], v218 offset:32
    ds_read_b64_tr_b16 v[26:27], v218 offset:800
    ds_read_b64_tr_b16 v[28:29], v218 offset:64
    ds_read_b64_tr_b16 v[30:31], v218 offset:832
    ds_read_b64_tr_b16 v[32:33], v218 offset:96
    ds_read_b64_tr_b16 v[34:35], v218 offset:864
    ds_read_b64_tr_b16 v[36:37], v218 offset:128
    ds_read_b64_tr_b16 v[38:39], v218 offset:896
    ds_read_b64_tr_b16 v[40:41], v218 offset:160
    ds_read_b64_tr_b16 v[42:43], v218 offset:928
    s_waitcnt lgkmcnt(0)
    s_add_u32 m0, s52, 0
    s_add_u32 s62, s60, 196608
    buffer_load_dwordx4 v210, s[28:31], s62 offen lds
    s_add_u32 m0, s52, 1024
    s_add_u32 s62, s60, 196608
    buffer_load_dwordx4 v211, s[28:31], s62 offen lds
    s_add_u32 m0, s52, 2048
    s_add_u32 s62, s60, 196608
    buffer_load_dwordx4 v212, s[28:31], s62 offen lds
    s_add_u32 m0, s52, 3072
    s_add_u32 s62, s60, 245760
    buffer_load_dwordx4 v210, s[28:31], s62 offen lds
    s_add_u32 m0, s52, 4096
    s_add_u32 s62, s60, 245760
    buffer_load_dwordx4 v211, s[28:31], s62 offen lds
    s_add_u32 m0, s52, 5120
    s_add_u32 s62, s60, 245760
    buffer_load_dwordx4 v212, s[28:31], s62 offen lds
    v_mfma_f32_16x16x32_bf16 v[232:235], v[20:23], v[220:223], 0
    v_mfma_f32_16x16x32_bf16 v[236:239], v[24:27], v[220:223], 0
    v_mfma_f32_16x16x32_bf16 v[240:243], v[28:31], v[220:223], 0
    v_mfma_f32_16x16x32_bf16 v[244:247], v[32:35], v[220:223], 0
    v_mfma_f32_16x16x32_bf16 v[248:251], v[36:39], v[220:223], 0
    v_mfma_f32_16x16x32_bf16 v[252:255], v[40:43], v[220:223], 0
    s_waitcnt vmcnt(11)
    ds_read_b64_tr_b16 v[44:45], v218 offset:49152
    ds_read_b64_tr_b16 v[46:47], v218 offset:49920
    ds_read_b64_tr_b16 v[48:49], v218 offset:49184
    ds_read_b64_tr_b16 v[50:51], v218 offset:49952
    ds_read_b64_tr_b16 v[52:53], v218 offset:49216
    ds_read_b64_tr_b16 v[54:55], v218 offset:49984
    ds_read_b64_tr_b16 v[56:57], v218 offset:49248
    ds_read_b64_tr_b16 v[58:59], v218 offset:50016
    ds_read_b64_tr_b16 v[60:61], v218 offset:49280
    ds_read_b64_tr_b16 v[62:63], v218 offset:50048
    ds_read_b64_tr_b16 v[64:65], v218 offset:49312
    ds_read_b64_tr_b16 v[66:67], v218 offset:50080
    s_waitcnt lgkmcnt(0)
    s_add_u32 m0, s52, 49152
    s_add_u32 s62, s60, 294912
    buffer_load_dwordx4 v210, s[28:31], s62 offen lds
    s_add_u32 m0, s52, 50176
    s_add_u32 s62, s60, 294912
    buffer_load_dwordx4 v211, s[28:31], s62 offen lds
    s_add_u32 m0, s52, 51200
    s_add_u32 s62, s60, 294912
    buffer_load_dwordx4 v212, s[28:31], s62 offen lds
    s_add_u32 m0, s52, 52224
    s_add_u32 s62, s60, 344064
    buffer_load_dwordx4 v210, s[28:31], s62 offen lds
    s_add_u32 m0, s52, 53248
    s_add_u32 s62, s60, 344064
    buffer_load_dwordx4 v211, s[28:31], s62 offen lds
    s_add_u32 m0, s52, 54272
    s_add_u32 s62, s60, 344064
    buffer_load_dwordx4 v212, s[28:31], s62 offen lds
    v_mfma_f32_16x16x32_bf16 v[232:235], v[44:47], v[220:223], v[232:235]
    v_mfma_f32_16x16x32_bf16 v[236:239], v[48:51], v[220:223], v[236:239]
    v_mfma_f32_16x16x32_bf16 v[240:243], v[52:55], v[220:223], v[240:243]
    v_mfma_f32_16x16x32_bf16 v[244:247], v[56:59], v[220:223], v[244:247]
    v_mfma_f32_16x16x32_bf16 v[248:251], v[60:63], v[220:223], v[248:251]
    v_mfma_f32_16x16x32_bf16 v[252:255], v[64:67], v[220:223], v[252:255]
    s_waitcnt vmcnt(6)
    ds_read_b64_tr_b16 v[68:69], v218 offset:0
    ds_read_b64_tr_b16 v[70:71], v218 offset:768
    ds_read_b64_tr_b16 v[72:73], v218 offset:32
    ds_read_b64_tr_b16 v[74:75], v218 offset:800
    ds_read_b64_tr_b16 v[76:77], v218 offset:64
    ds_read_b64_tr_b16 v[78:79], v218 offset:832
    ds_read_b64_tr_b16 v[80:81], v218 offset:96
    ds_read_b64_tr_b16 v[82:83], v218 offset:864
    ds_read_b64_tr_b16 v[84:85], v218 offset:128
    ds_read_b64_tr_b16 v[86:87], v218 offset:896
    ds_read_b64_tr_b16 v[88:89], v218 offset:160
    ds_read_b64_tr_b16 v[90:91], v218 offset:928
    s_waitcnt lgkmcnt(0)
    s_add_u32 m0, s52, 0
    s_add_u32 s62, s60, 393216
    buffer_load_dwordx4 v210, s[28:31], s62 offen lds
    s_add_u32 m0, s52, 1024
    s_add_u32 s62, s60, 393216
    buffer_load_dwordx4 v211, s[28:31], s62 offen lds
    s_add_u32 m0, s52, 2048
    s_add_u32 s62, s60, 393216
    buffer_load_dwordx4 v212, s[28:31], s62 offen lds
    s_add_u32 m0, s52, 3072
    s_add_u32 s62, s60, 442368
    buffer_load_dwordx4 v210, s[28:31], s62 offen lds
    s_add_u32 m0, s52, 4096
    s_add_u32 s62, s60, 442368
    buffer_load_dwordx4 v211, s[28:31], s62 offen lds
    s_add_u32 m0, s52, 5120
    s_add_u32 s62, s60, 442368
    buffer_load_dwordx4 v212, s[28:31], s62 offen lds
    v_mfma_f32_16x16x32_bf16 v[232:235], v[68:71], v[220:223], v[232:235]
    v_mfma_f32_16x16x32_bf16 v[236:239], v[72:75], v[220:223], v[236:239]
    v_mfma_f32_16x16x32_bf16 v[240:243], v[76:79], v[220:223], v[240:243]
    v_mfma_f32_16x16x32_bf16 v[244:247], v[80:83], v[220:223], v[244:247]
    v_mfma_f32_16x16x32_bf16 v[248:251], v[84:87], v[220:223], v[248:251]
    v_mfma_f32_16x16x32_bf16 v[252:255], v[88:91], v[220:223], v[252:255]
    v_dot2_f32_bf16 v226, v10, s67, 0
    v_dot2_f32_bf16 v226, v11, s67, v226
    v_dot2_f32_bf16 v226, v12, s67, v226
    v_dot2_f32_bf16 v226, v13, s67, v226
    v_dot2_f32_bf16 v226, v14, s67, v226
    v_dot2_f32_bf16 v226, v15, s67, v226
    s_nop 2
    v_add_f32_dpp v226, v226, v226 row_ror:1 row_mask:0xf bank_mask:0xf
    s_nop 1
    v_add_f32_dpp v226, v226, v226 row_ror:2 row_mask:0xf bank_mask:0xf
    s_nop 1
    v_add_f32_dpp v226, v226, v226 row_ror:4 row_mask:0xf bank_mask:0xf
    s_nop 1
    v_add_f32_dpp v226, v226, v226 row_ror:8 row_mask:0xf bank_mask:0xf
    v_mov_b32 v229, v226
    s_nop 1
    v_permlane32_swap_b32 v226, v229
    v_add_f32 v226, v226, v229
    v_mov_b32 v229, v226
    s_nop 1
    v_permlane16_swap_b32 v226, v229
    v_add_f32 v226, v226, v229
    s_nop 0
    v_readfirstlane_b32 s55, v226
    s_waitcnt vmcnt(6)
    ds_read_b64_tr_b16 v[92:93], v218 offset:49152
    ds_read_b64_tr_b16 v[94:95], v218 offset:49920
    ds_read_b64_tr_b16 v[96:97], v218 offset:49184
    ds_read_b64_tr_b16 v[98:99], v218 offset:49952
    ds_read_b64_tr_b16 v[100:101], v218 offset:49216
    ds_read_b64_tr_b16 v[102:103], v218 offset:49984
    ds_read_b64_tr_b16 v[104:105], v218 offset:49248
    ds_read_b64_tr_b16 v[106:107], v218 offset:50016
    ds_read_b64_tr_b16 v[108:109], v218 offset:49280
    ds_read_b64_tr_b16 v[110:111], v218 offset:50048
    ds_read_b64_tr_b16 v[112:113], v218 offset:49312
    ds_read_b64_tr_b16 v[114:115], v218 offset:50080
    s_waitcnt lgkmcnt(0)
    s_mul_i32 s62, s49, 3
    s_add_u32 s62, s62, 0
    s_lshr_b32 s63, s62, 2
    s_cmp_eq_u32 s63, 9
    s_cselect_b32 s63, 2, 0
    s_xor_b32 s62, s62, s63
    s_mul_i32 s62, s62, 40960
    s_add_u32 s62, s62, s53
    s_add_u32 m0, s53, 98304
    s_nop 0
    buffer_load_dwordx4 v213, s[32:35], s62 offen lds
    s_add_u32 m0, s53, 99328
    s_nop 0
    buffer_load_dwordx4 v214, s[32:35], s62 offen lds
    s_add_u32 m0, s53, 100352
    s_nop 0
    buffer_load_dwordx4 v215, s[32:35], s62 offen lds
    s_add_u32 m0, s53, 101376
    s_nop 0
    buffer_load_dwordx4 v216, s[32:35], s62 offen lds
    s_add_u32 m0, s53, 102400
    s_nop 0
    buffer_load_dwordx4 v217, s[32:35], s62 offen lds
    s_barrier
    s_mul_i32 s62, s49, 3
    s_add_u32 s62, s62, 1
    s_lshr_b32 s63, s62, 2
    s_cmp_eq_u32 s63, 9
    s_cselect_b32 s63, 2, 0
    s_xor_b32 s62, s62, s63
    s_mul_i32 s62, s62, 40960
    s_add_u32 s62, s62, s53
    s_add_u32 m0, s53, 49152
    s_nop 0
    buffer_load_dwordx4 v213, s[32:35], s62 offen lds
    s_add_u32 m0, s53, 50176
    s_nop 0
    buffer_load_dwordx4 v214, s[32:35], s62 offen lds
    s_add_u32 m0, s53, 51200
    s_nop 0
    buffer_load_dwordx4 v215, s[32:35], s62 offen lds
    s_add_u32 m0, s53, 52224
    s_nop 0
    buffer_load_dwordx4 v216, s[32:35], s62 offen lds
    s_add_u32 m0, s53, 53248
    s_nop 0
    buffer_load_dwordx4 v217, s[32:35], s62 offen lds
    v_mfma_f32_16x16x32_bf16 v[232:235], v[92:95], v[220:223], v[232:235]
    v_mfma_f32_16x16x32_bf16 v[236:239], v[96:99], v[220:223], v[236:239]
    v_mfma_f32_16x16x32_bf16 v[240:243], v[100:103], v[220:223], v[240:243]
    v_mfma_f32_16x16x32_bf16 v[244:247], v[104:107], v[220:223], v[244:247]
    v_mfma_f32_16x16x32_bf16 v[248:251], v[108:111], v[220:223], v[248:251]
    v_mfma_f32_16x16x32_bf16 v[252:255], v[112:115], v[220:223], v[252:255]
    s_waitcnt vmcnt(10)
    ds_read_b64_tr_b16 v[116:117], v218 offset:0
    ds_read_b64_tr_b16 v[118:119], v218 offset:768
    ds_read_b64_tr_b16 v[120:121], v218 offset:32
    ds_read_b64_tr_b16 v[122:123], v218 offset:800
    ds_read_b64_tr_b16 v[124:125], v218 offset:64
    ds_read_b64_tr_b16 v[126:127], v218 offset:832
    ds_read_b64_tr_b16 v[128:129], v218 offset:96
    ds_read_b64_tr_b16 v[130:131], v218 offset:864
    ds_read_b64_tr_b16 v[132:133], v218 offset:128
    ds_read_b64_tr_b16 v[134:135], v218 offset:896
    ds_read_b64_tr_b16 v[136:137], v218 offset:160
    ds_read_b64_tr_b16 v[138:139], v218 offset:928
    s_waitcnt lgkmcnt(0)
    s_barrier
    s_mul_i32 s62, s49, 3
    s_add_u32 s62, s62, 2
    s_lshr_b32 s63, s62, 2
    s_cmp_eq_u32 s63, 9
    s_cselect_b32 s63, 2, 0
    s_xor_b32 s62, s62, s63
    s_mul_i32 s62, s62, 40960
    s_add_u32 s62, s62, s53
    s_add_u32 m0, s53, 0
    s_nop 0
    buffer_load_dwordx4 v213, s[32:35], s62 offen lds
    s_add_u32 m0, s53, 1024
    s_nop 0
    buffer_load_dwordx4 v214, s[32:35], s62 offen lds
    s_add_u32 m0, s53, 2048
    s_nop 0
    buffer_load_dwordx4 v215, s[32:35], s62 offen lds
    s_add_u32 m0, s53, 3072
    s_nop 0
    buffer_load_dwordx4 v216, s[32:35], s62 offen lds
    s_add_u32 m0, s53, 4096
    s_nop 0
    buffer_load_dwordx4 v217, s[32:35], s62 offen lds
    v_mfma_f32_16x16x32_bf16 v[232:235], v[116:119], v[220:223], v[232:235]
    v_mfma_f32_16x16x32_bf16 v[236:239], v[120:123], v[220:223], v[236:239]
    v_mfma_f32_16x16x32_bf16 v[240:243], v[124:127], v[220:223], v[240:243]
    v_mfma_f32_16x16x32_bf16 v[244:247], v[128:131], v[220:223], v[244:247]
    v_mfma_f32_16x16x32_bf16 v[248:251], v[132:135], v[220:223], v[248:251]
    v_mfma_f32_16x16x32_bf16 v[252:255], v[136:139], v[220:223], v[252:255]
    s_mov_b32 exec_lo, 0x00010001
    s_mov_b32 exec_hi, 0x00010001
    s_nop 0
    ds_write_b128 v230, v[232:235] offset:0
    ds_write_b128 v230, v[236:239] offset:64
    ds_write_b128 v230, v[240:243] offset:128
    ds_write_b128 v230, v[244:247] offset:192
    ds_write_b128 v230, v[248:251] offset:256
    ds_write_b128 v230, v[252:255] offset:320
    s_mov_b64 exec, -1
    s_waitcnt lgkmcnt(0)
    s_waitcnt vmcnt(5)
    s_barrier
    ds_read_b32 v232, v228 offset:0
    ds_read_b32 v233, v228 offset:384
    ds_read_b32 v234, v228 offset:768
    ds_read_b32 v235, v228 offset:1152
    ds_read_b32 v236, v228 offset:1536
    ds_read_b32 v237, v228 offset:1920
    ds_read_b32 v238, v228 offset:2304
    ds_read_b32 v239, v228 offset:2688
    ds_read_b64_tr_b16 v[140:141], v205 offset:0
    ds_read_b64_tr_b16 v[142:143], v205 offset:5120
    ds_read_b64_tr_b16 v[144:145], v206 offset:0
    ds_read_b64_tr_b16 v[146:147], v206 offset:5120
    ds_read_b64_tr_b16 v[148:149], v207 offset:0
    ds_read_b64_tr_b16 v[150:151], v207 offset:5120
    ds_read_b64_tr_b16 v[152:153], v208 offset:0
    ds_read_b64_tr_b16 v[154:155], v208 offset:5120
    ds_read_b64_tr_b16 v[156:157], v209 offset:0
    ds_read_b64_tr_b16 v[158:159], v209 offset:5120
    ds_read_b64_tr_b16 v[160:161], v200 offset:49152
    ds_read_b64_tr_b16 v[162:163], v200 offset:54272
    ds_read_b64_tr_b16 v[164:165], v201 offset:49152
    ds_read_b64_tr_b16 v[166:167], v201 offset:54272
    ds_read_b64_tr_b16 v[168:169], v202 offset:49152
    ds_read_b64_tr_b16 v[170:171], v202 offset:54272
    ds_read_b64_tr_b16 v[172:173], v203 offset:49152
    ds_read_b64_tr_b16 v[174:175], v203 offset:54272
    ds_read_b64_tr_b16 v[176:177], v204 offset:49152
    ds_read_b64_tr_b16 v[178:179], v204 offset:54272
    s_waitcnt lgkmcnt(0)
    v_add_f32 v232, v232, v236
    v_add_f32 v233, v233, v237
    v_add_f32 v234, v234, v238
    v_add_f32 v235, v235, v239
    v_add_f32 v0, v232, v234
    v_add_f32 v2, v233, v235
    s_waitcnt vmcnt(0)
    s_barrier
    ds_read_b64_tr_b16 v[180:181], v200 offset:0
    ds_read_b64_tr_b16 v[182:183], v200 offset:5120
    ds_read_b64_tr_b16 v[184:185], v201 offset:0
    ds_read_b64_tr_b16 v[186:187], v201 offset:5120
    ds_read_b64_tr_b16 v[188:189], v202 offset:0
    ds_read_b64_tr_b16 v[190:191], v202 offset:5120
    ds_read_b64_tr_b16 v[192:193], v203 offset:0
    ds_read_b64_tr_b16 v[194:195], v203 offset:5120
    ds_read_b64_tr_b16 v[196:197], v204 offset:0
    ds_read_b64_tr_b16 v[198:199], v204 offset:5120
    s_waitcnt lgkmcnt(0)
F_rdy:
HF0_0:
    s_cbranch_execz HF0_1
    s_cmp_lg_u32 s48, 0
    s_cbranch_scc1 F_wait
    s_mov_b64 exec, 0xffffff
F_poll:
    buffer_load_dwordx2 v[224:225], v7, s[24:27], s15 offen sc1
    s_waitcnt vmcnt(0)
    v_cmp_ne_u32 vcc, s54, v225
    s_cbranch_vccz F_got
    s_sleep 1
    s_sub_u32 s3, s3, 1
    s_cbranch_scc0 F_poll
    s_mov_b32 s3, 0
F_got:
    s_mov_b64 exec, -1
    v_max_u32_dpp v226, v224, v224 row_ror:1 row_mask:0xf bank_mask:0xf
    s_nop 1
    v_max_u32_dpp v226, v226, v226 row_ror:2 row_mask:0xf bank_mask:0xf
    s_nop 1
    v_max_u32_dpp v226, v226, v226 row_ror:4 row_mask:0xf bank_mask:0xf
    s_nop 1
    v_max_u32_dpp v226, v226, v226 row_ror:8 row_mask:0xf bank_mask:0xf
    s_nop 0
    v_readlane_b32 s60, v226, 0
    v_readlane_b32 s62, v226, 16
    s_max_u32 s60, s60, s62
    s_max_u32 s60, s60, 1376257
    s_sub_u32 s60, s60, 1376256
    v_cmp_le_u32 vcc, s60, v224
    s_nop 1
    v_mbcnt_lo_u32_b32 v226, vcc_lo, 0
    v_cmp_gt_u32 s[62:63], 8, v226
    v_lshl_add_u32 v226, v226, 2, v8
    s_and_b64 exec, vcc, s[62:63]
    ds_write_b32 v226, v224 offset:0
    s_mov_b64 exec, -1
    s_waitcnt lgkmcnt(0)
F_wait:
    s_barrier
    ds_read_b32 v224, v231 offset:0
    s_waitcnt lgkmcnt(0)
    v_readfirstlane_b32 s60, v224
F_redo:
    s_mov_b32 s21, 0
    s_and_b32 s61, s60, 0xfff
HF0_1:
    s_cbranch_execz HF0_2
    s_cbranch_scc0 F_b1
    s_lshr_b32 s62, s61, 4
    s_mul_i32 s62, s62, 171
    s_lshr_b32 s62, s62, 10
    s_mul_i32 s62, s62, 2560
    s_add_u32 s62, s62, s16
    s_add_u32 s63, s54, s61
    v_mov_b64 v[228:229], 0
    v_mov_b32 v230, s63
F_row:
    buffer_load_dwordx3 v[220:222], v1, s[24:27], s62 offen sc1
    buffer_load_dwordx3 v[224:226], v1, s[24:27], s62 offen offset:1024 sc1
    s_mov_b32 exec_hi, 0
    buffer_load_dwordx3 v[228:230], v1, s[24:27], s62 offen offset:2048 sc1
    s_mov_b32 exec_hi, -1
    s_waitcnt vmcnt(0)
    ds_write_b64 v16, v[220:221] offset:24832
    ds_write_b64 v16, v[224:225] offset:25344
    s_mov_b32 exec_hi, 0
    ds_write_b64 v16, v[228:229] offset:25856
    s_mov_b32 exec_hi, -1
    v_cmp_ne_u32 vcc, s63, v222
    v_cmp_ne_u32 s[64:65], s63, v226
    s_or_b64 vcc, vcc, s[64:65]
    v_cmp_ne_u32 s[64:65], s63, v230
    s_or_b64 vcc, vcc, s[64:65]
    s_cselect_b32 s21, 0, 1
    s_cbranch_scc0 F_b1
    s_sub_u32 s20, s20, 1
    s_cbranch_scc0 F_row
F_b1:
    s_waitcnt lgkmcnt(0)
    s_barrier
    ds_read_b128 v[200:203], v9 offset:24832
    ds_read_b128 v[204:207], v9 offset:24896
    ds_read_b128 v[208:211], v9 offset:24960
    ds_read_b128 v[212:215], v9 offset:25024
    ds_read_b128 v[216:219], v9 offset:25088
    s_cmp_eq_u32 s21, 0
    s_cbranch_scc1 F_d1
    v_dot2_f32_bf16 v222, v220, s67, 0
    v_dot2_f32_bf16 v223, v220, v220, 0
    v_dot2_f32_bf16 v226, v220, v10, 0
    v_dot2_f32_bf16 v222, v221, s67, v222
    v_dot2_f32_bf16 v223, v221, v221, v223
HF0_2:
    s_cbranch_execz HF0_3
    v_dot2_f32_bf16 v226, v221, v11, v226
    v_dot2_f32_bf16 v222, v224, s67, v222
    v_dot2_f32_bf16 v223, v224, v224, v223
    v_dot2_f32_bf16 v226, v224, v12, v226
    v_dot2_f32_bf16 v222, v225, s67, v222
    v_dot2_f32_bf16 v223, v225, v225, v223
    v_dot2_f32_bf16 v226, v225, v13, v226
    v_dot2_f32_bf16 v222, v228, s67, v222
    v_dot2_f32_bf16 v223, v228, v228, v223
    v_dot2_f32_bf16 v226, v228, v14, v226
    v_dot2_f32_bf16 v222, v229, s67, v222
    v_dot2_f32_bf16 v223, v229, v229, v223
    v_dot2_f32_bf16 v226, v229, v15, v226
    s_nop 2
    v_mov_b32 v227, v226
    v_permlane32_swap_b32 v222, v223
    s_nop 0
    v_permlane32_swap_b32 v226, v227
    v_add_f32 v222, v222, v223
    v_add_f32 v226, v226, v227
    s_nop 1
    v_permlane16_swap_b32 v222, v226
    v_add_f32 v222, v222, v226
    s_nop 1
    v_add_f32_dpp v222, v222, v222 row_ror:1 row_mask:0xf bank_mask:0xf
    s_nop 1
    v_add_f32_dpp v222, v222, v222 row_ror:2 row_mask:0xf bank_mask:0xf
    s_nop 1
    v_add_f32_dpp v222, v222, v222 row_ror:4 row_mask:0xf bank_mask:0xf
    s_nop 1
    v_add_f32_dpp v222, v222, v222 row_ror:8 row_mask:0xf bank_mask:0xf
    s_nop 0
    v_readlane_b32 s64, v222, 32
    v_readlane_b32 s65, v222, 16
    v_mov_b32 v220, v222
    v_mov_b32 v221, s64
    v_mul_f32 v220, 0x3acccccd, v220
    v_mul_f32 v221, 0x3acccccd, v221
    v_fma_f32 v221, -v220, v220, v221
    v_max_f32 v221, 0, v221
HF0_3:
    s_cbranch_execz HF0_4
    v_cvt_pk_bf16_f32 v221, v221, v221
    v_and_b32 v221, 0xffff0000, v221
    v_add_f32 v221, 0x3727c5ac, v221
    v_cvt_pk_bf16_f32 v221, v221, v221
    v_and_b32 v221, 0xffff0000, v221
    v_sqrt_f32 v221, v221
    v_cvt_pk_bf16_f32 v220, v220, v220
    v_and_b32 v220, 0xffff0000, v220
    v_cvt_pk_bf16_f32 v221, v221, v221
    v_and_b32 v221, 0xffff0000, v221
    v_rcp_f32 v221, v221
    v_mul_f32 v222, s55, v220
    v_sub_f32 v222, s65, v222
    v_mov_b32 v224, s48
    v_mul_f32 v222, v222, v221
    v_lshl_add_u32 v226, v224, 4, v8
    v_ashrrev_i32 v225, 31, v222
    v_or_b32 v225, 0x80000000, v225
    v_xor_b32 v225, v225, v222
    v_and_b32 v225, 0xfffff000, v225
    v_or_b32 v225, s61, v225
    s_mov_b64 exec, 1
    ds_write_b96 v226, v[220:222] offset:64
    ds_max_u64 v8, v[224:225] offset:32
    s_mov_b64 exec, -1
F_d1:
    s_waitcnt lgkmcnt(4)
    v_mfma_f32_16x16x32_bf16 v[232:235], v[20:23], v[200:203], 0
    v_mfma_f32_16x16x32_bf16 v[236:239], v[24:27], v[200:203], 0
    v_mfma_f32_16x16x32_bf16 v[240:243], v[28:31], v[200:203], 0
    v_mfma_f32_16x16x32_bf16 v[244:247], v[32:35], v[200:203], 0
    v_mfma_f32_16x16x32_bf16 v[248:251], v[36:39], v[200:203], 0
    v_mfma_f32_16x16x32_bf16 v[252:255], v[40:43], v[200:203], 0
    s_waitcnt lgkmcnt(3)
    v_mfma_f32_16x16x32_bf16 v[232:235], v[44:47], v[204:207], v[232:235]
    v_mfma_f32_16x16x32_bf16 v[236:239], v[48:51], v[204:207], v[236:239]
    v_mfma_f32_16x16x32_bf16 v[240:243], v[52:55], v[204:207], v[240:243]
    v_mfma_f32_16x16x32_bf16 v[244:247], v[56:59], v[204:207], v[244:247]
    v_mfma_f32_16x16x32_bf16 v[248:251], v[60:63], v[204:207], v[248:251]
HF0_4:
    s_cbranch_execz HF0_5
    v_mfma_f32_16x16x32_bf16 v[252:255], v[64:67], v[204:207], v[252:255]
    s_waitcnt lgkmcnt(2)
    v_mfma_f32_16x16x32_bf16 v[232:235], v[68:71], v[208:211], v[232:235]
    v_mfma_f32_16x16x32_bf16 v[236:239], v[72:75], v[208:211], v[236:239]
    v_mfma_f32_16x16x32_bf16 v[240:243], v[76:79], v[208:211], v[240:243]
    v_mfma_f32_16x16x32_bf16 v[244:247], v[80:83], v[208:211], v[244:247]
    v_mfma_f32_16x16x32_bf16 v[248:251], v[84:87], v[208:211], v[248:251]
    v_mfma_f32_16x16x32_bf16 v[252:255], v[88:91], v[208:211], v[252:255]
    s_waitcnt lgkmcnt(1)
    v_mfma_f32_16x16x32_bf16 v[232:235], v[92:95], v[212:215], v[232:235]
    v_mfma_f32_16x16x32_bf16 v[236:239], v[96:99], v[212:215], v[236:239]
    v_mfma_f32_16x16x32_bf16 v[240:243], v[100:103], v[212:215], v[240:243]
    v_mfma_f32_16x16x32_bf16 v[244:247], v[104:107], v[212:215], v[244:247]
    v_mfma_f32_16x16x32_bf16 v[248:251], v[108:111], v[212:215], v[248:251]
    v_mfma_f32_16x16x32_bf16 v[252:255], v[112:115], v[212:215], v[252:255]
    s_waitcnt lgkmcnt(0)
    v_mfma_f32_16x16x32_bf16 v[232:235], v[116:119], v[216:219], v[232:235]
    v_mfma_f32_16x16x32_bf16 v[236:239], v[120:123], v[216:219], v[236:239]
    v_mfma_f32_16x16x32_bf16 v[240:243], v[124:127], v[216:219], v[240:243]
    v_mfma_f32_16x16x32_bf16 v[244:247], v[128:131], v[216:219], v[244:247]
    v_mfma_f32_16x16x32_bf16 v[248:251], v[132:135], v[216:219], v[248:251]
    v_mfma_f32_16x16x32_bf16 v[252:255], v[136:139], v[216:219], v[252:255]
    s_mov_b32 exec_lo, 0x00ff00ff
    s_mov_b32 exec_hi, 0x00ff00ff
    s_nop 0
    ds_write_b128 v3, v[232:235] offset:0
    ds_write_b128 v3, v[236:239] offset:64
    ds_write_b128 v3, v[240:243] offset:128
    ds_write_b128 v3, v[244:247] offset:192
    ds_write_b128 v3, v[248:251] offset:256
    ds_write_b128 v3, v[252:255] offset:320
    s_mov_b64 exec, -1
    s_waitcnt lgkmcnt(0)
    s_barrier
    ds_read_b64 v[224:225], v8 offset:32
HF0_5:
    s_cbranch_execz HF0_6
    s_cmp_ge_u32 s48, 2
    s_waitcnt lgkmcnt(0)
    v_lshl_add_u32 v226, v224, 4, v8
    s_cbranch_scc1 F_sig
    v_mad_u32_u24 v227, v224, s68, v4
    ds_read_b64 v[228:229], v226 offset:64
    ds_read_b32 v232, v227 offset:0
    ds_read_b32 v233, v227 offset:384
    ds_read_b32 v234, v227 offset:768
    ds_read_b32 v235, v227 offset:1152
    ds_read_b32 v236, v227 offset:1536
    ds_read_b32 v237, v227 offset:1920
    ds_read_b32 v238, v227 offset:2304
    ds_read_b32 v239, v227 offset:2688
    v_readfirstlane_b32 s61, v225
    s_waitcnt lgkmcnt(4)
    v_fma_f32 v232, -v228, v0, v232
    v_fma_f32 v233, -v228, v2, v233
    v_add_f32 v232, v232, v234
    v_add_f32 v233, v233, v235
    s_waitcnt lgkmcnt(0)
    v_add_f32 v236, v236, v238
    v_add_f32 v237, v237, v239
    v_add_f32 v232, v232, v236
    v_add_f32 v233, v233, v237
    v_mul_f32 v232, v232, v229
    v_mul_f32 v233, v233, v229
    v_cvt_pk_bf16_f32 v233, v232, v233
    v_lshlrev_b32 v232, 16, v233
    v_mul_f32 v234, 0xbfb8aa3b, v232
    v_exp_f32 v234, v234
    v_and_b32 v233, s47, v233
    v_add_f32 v234, 1.0, v234
    v_rcp_f32 v234, v234
    s_and_b32 s61, s61, 0xfff
    v_mul_f32 v232, v232, v234
    v_cvt_pk_bf16_f32 v232, v232, v232
    v_and_b32 v232, 0xffff0000, v232
    v_mul_f32 v232, v232, v233
    v_cvt_pk_bf16_f32 v232, v232, v232
    s_mov_b32 exec_hi, 0xffff
    ds_write_b16 v5, v232 offset:36864
HF0_6:
    s_cbranch_execz HF0_7
    s_mov_b64 exec, -1
    s_waitcnt lgkmcnt(0)
    s_branch F_gu
F_sig:
    v_mad_u32_u24 v227, v224, s69, v19
    ds_read_b96 v[228:230], v226 offset:64
    ds_read_u16 v226, v227 offset:24832
    v_readfirstlane_b32 s61, v225
    v_mov_b32 v220, 0
    s_cmp_lg_u32 s48, 7
    s_cbranch_scc1 F_n7
    s_mov_b64 exec, 0xffffff
    buffer_load_dwordx2 v[220:221], v7, s[24:27], s70 offen sc1
    s_mov_b64 exec, -1
F_n7:
    s_and_b32 s61, s61, 0xfff
    s_lshr_b32 s65, s61, 4
    s_mul_i32 s65, s65, 171
    s_lshr_b32 s65, s65, 10
    s_mul_i32 s64, s65, 2560
    s_add_u32 s64, s64, 131072
    s_mul_i32 s71, s65, 96
    s_sub_u32 s66, s61, s71
    s_lshr_b32 s71, s65, 1
    s_mul_i32 s71, s71, 86
    s_add_u32 s66, s66, s71
    s_sub_u32 s66, s66, 10
    s_lshl_b32 s66, s66, 1
    s_and_b32 s65, s65, 1
    s_add_u32 s66, s66, s65
    s_mul_i32 s66, s66, 1280
    s_waitcnt lgkmcnt(0)
    v_cvt_pk_bf16_f32 v231, v230, v230
    v_and_b32 v231, 0xffff0000, v231
    v_lshlrev_b32 v226, 16, v226
    v_mul_f32 v231, 0xbfb8aa3b, v231
    v_sub_f32 v227, v226, v228
    v_exp_f32 v231, v231
    v_cvt_pk_bf16_f32 v227, v227, v227
    v_and_b32 v227, 0xffff0000, v227
    v_add_f32 v231, 1.0, v231
    v_mul_f32 v227, v227, v229
    v_rcp_f32 v231, v231
    v_cvt_pk_bf16_f32 v227, v227, v227
    v_and_b32 v227, 0xffff0000, v227
    v_cvt_pk_bf16_f32 v231, v231, v231
HF0_7:
    s_cbranch_execz HF0_8
    v_and_b32 v231, 0xffff0000, v231
F_gu:
    s_barrier
    ds_read_b128 v[200:203], v6 offset:36864
    ds_read_b128 v[204:207], v6 offset:36928
    ds_read_b128 v[208:211], v6 offset:36992
    s_add_u32 s63, s54, s61
    v_mov_b32 v215, s63
    s_waitcnt lgkmcnt(2)
    v_mfma_f32_16x16x32_bf16 v[232:235], v[140:143], v[200:203], 0
    v_mfma_f32_16x16x32_bf16 v[236:239], v[144:147], v[200:203], 0
    v_mfma_f32_16x16x32_bf16 v[240:243], v[148:151], v[200:203], 0
    v_mfma_f32_16x16x32_bf16 v[244:247], v[152:155], v[200:203], 0
    v_mfma_f32_16x16x32_bf16 v[248:251], v[156:159], v[200:203], 0
    s_waitcnt lgkmcnt(1)
    v_mfma_f32_16x16x32_bf16 v[232:235], v[160:163], v[204:207], v[232:235]
    v_mfma_f32_16x16x32_bf16 v[236:239], v[164:167], v[204:207], v[236:239]
    v_mfma_f32_16x16x32_bf16 v[240:243], v[168:171], v[204:207], v[240:243]
    v_mfma_f32_16x16x32_bf16 v[244:247], v[172:175], v[204:207], v[244:247]
    v_mfma_f32_16x16x32_bf16 v[248:251], v[176:179], v[204:207], v[248:251]
    s_waitcnt lgkmcnt(0)
    v_mfma_f32_16x16x32_bf16 v[232:235], v[180:183], v[208:211], v[232:235]
    v_mfma_f32_16x16x32_bf16 v[236:239], v[184:187], v[208:211], v[236:239]
    v_mfma_f32_16x16x32_bf16 v[240:243], v[188:191], v[208:211], v[240:243]
    v_mfma_f32_16x16x32_bf16 v[244:247], v[192:195], v[208:211], v[244:247]
    v_mfma_f32_16x16x32_bf16 v[248:251], v[196:199], v[208:211], v[248:251]
    s_mov_b32 exec_lo, 0x00010001
    s_mov_b32 exec_hi, 0x00010001
    s_nop 1
    v_perm_b32 v212, v232, v235, s9
    v_perm_b32 v213, v233, v235, s10
    v_perm_b32 v214, v234, v235, s11
    s_lshl_b64 exec, exec, 1
    v_perm_b32 v212, v236, v239, s9
    v_perm_b32 v213, v237, v239, s10
    v_perm_b32 v214, v238, v239, s11
HF0_8:
    s_cbranch_execz HF0_9
    s_lshl_b64 exec, exec, 1
    v_perm_b32 v212, v240, v243, s9
    v_perm_b32 v213, v241, v243, s10
    v_perm_b32 v214, v242, v243, s11
    s_lshl_b64 exec, exec, 1
    v_perm_b32 v212, v244, v247, s9
    v_perm_b32 v213, v245, v247, s10
    v_perm_b32 v214, v246, v247, s11
    s_lshl_b64 exec, exec, 1
    v_perm_b32 v212, v248, v251, s9
    v_perm_b32 v213, v249, v251, s10
    v_perm_b32 v214, v250, v251, s11
    s_mov_b32 exec_lo, 0x001f001f
    s_mov_b32 exec_hi, 0x001f001f
    buffer_store_dwordx4 v[212:215], v17, s[24:27], s8 offen sc1
    s_mov_b64 exec, -1
    s_cmp_lt_u32 s44, 3
    s_cbranch_scc0 F_rest
    v_mov_b32 v222, s63
    v_lshlrev_b32 v223, 1, v18
F_yp:
    s_and_b64 exec, s[18:19], 15
    buffer_load_dwordx3 v[220:222], v223, s[24:27], s64 offen sc1
    s_mov_b64 exec, s[18:19]
    s_waitcnt vmcnt(1)
    buffer_load_dwordx4 v[200:203], v1, s[24:27], s14 offen sc1
    s_waitcnt vmcnt(1)
    ds_read_b32 v224, v8 offset:40
    v_cmp_ne_u32 s[58:59], s63, v222
    s_waitcnt lgkmcnt(0)
    v_readfirstlane_b32 s60, v224
    s_and_b32 s62, s60, 0xfff
    s_cmp_lg_u32 s62, s61
    s_cbranch_scc1 F_chk
F_yc:
    s_waitcnt vmcnt(0)
    v_cmp_ne_u32 vcc, s63, v203
    s_or_b64 vcc, vcc, s[58:59]
    s_cbranch_vccz F_yg
F_ys:
    s_sleep 1
    s_sub_u32 s3, s3, 1
    s_cbranch_scc0 F_yp
    s_mov_b32 s3, 0
F_yg:
    s_mov_b64 exec, -1
    v_perm_b32 v203, v200, v201, s12
    v_perm_b32 v203, v203, v202, s13
HF0_9:
    s_cbranch_execz HF0_10
    v_permlane32_swap_b32 v200, v202
    s_nop 0
    v_permlane32_swap_b32 v201, v203
    v_add_f32 v200, v200, v202
    v_add_f32 v201, v201, v203
    s_nop 1
    v_permlane16_swap_b32 v200, v201
    v_add_f32 v200, v200, v201
    s_nop 1
    v_add_f32_dpp v200, v200, v200 row_ror:4 row_mask:0xf bank_mask:0xf
    s_nop 1
    v_add_f32_dpp v200, v200, v200 row_ror:8 row_mask:0xf bank_mask:0xf
    v_cvt_pk_bf16_f32 v200, v200, v200
    v_and_b32 v200, 0xffff0000, v200
    v_mul_f32 v200, v200, v231
    v_cvt_pk_bf16_f32 v200, v200, v200
    v_and_b32 v200, 0xffff0000, v200
    v_add_f32 v200, v200, v227
    v_cvt_pk_bf16_f32 v200, v200, v200
    v_and_b32 v200, 0xffff0000, v200
    v_add_f32 v200, v200, v226
    v_mov_b32 v201, v200
    s_nop 1
    v_permlane16_swap_b32 v200, v201
    v_cvt_pk_bf16_f32 v202, v200, v201
    v_cvt_pk_bf16_f32 v203, v200, v201
    s_nop 1
    v_permlane32_swap_b32 v202, v203
    s_and_b64 exec, s[18:19], 15
    buffer_store_dwordx2 v[202:203], v18, s[40:43], s66 offen
    s_or_b32 s65, s49, s44
    s_cbranch_scc1 L_fin
    s_mov_b64 exec, 1
    v_mov_b32 v9, 0
    v_mov_b32 v10, s54
    buffer_store_dword v10, v9, s[24:27], 0 offen
    s_branch L_fin
F_chk:
    s_cmp_lg_u32 s17, 0
    s_cbranch_scc1 F_yc
    s_waitcnt vmcnt(0)
    s_cmp_eq_u32 s60, 0
    s_cbranch_scc0 F_again
    ds_read_b32 v224, v8 offset:40
    s_waitcnt lgkmcnt(0)
    v_readfirstlane_b32 s60, v224
    s_and_b32 s62, s60, 0xfff
    s_cmp_lg_u32 s62, s61
    s_cbranch_scc0 F_yc
    s_branch F_ys
F_rest:
HF0_10:
    s_cbranch_execz HF0_11
    s_cmp_lg_u32 s17, 0
    s_cbranch_scc1 L_fin
    s_cmp_lg_u32 s48, 7
    s_cbranch_scc1 F_tw
    s_mov_b64 exec, 0xffffff
    s_waitcnt vmcnt(1)
    s_branch F_tc
F_tp:
    buffer_load_dwordx2 v[220:221], v7, s[24:27], s70 offen sc1
    s_waitcnt vmcnt(0)
F_tc:
    v_cmp_ne_u32 vcc, s54, v221
    s_cbranch_vccz F_tg
    s_sub_u32 s3, s3, 1
    s_cbranch_scc0 F_tp
    s_mov_b32 s3, 0
F_tg:
    s_mov_b64 exec, -1
    v_max_u32_dpp v222, v220, v220 row_ror:1 row_mask:0xf bank_mask:0xf
    s_nop 1
    v_max_u32_dpp v222, v222, v222 row_ror:2 row_mask:0xf bank_mask:0xf
    s_nop 1
    v_max_u32_dpp v222, v222, v222 row_ror:4 row_mask:0xf bank_mask:0xf
    s_nop 1
    v_max_u32_dpp v222, v222, v222 row_ror:8 row_mask:0xf bank_mask:0xf
    s_nop 0
    v_readlane_b32 s60, v222, 0
    v_readlane_b32 s62, v222, 16
    s_max_u32 s60, s60, s62
    s_max_u32 s60, s60, 1
    v_mov_b32 v220, s60
    ds_write_b32 v8, v220 offset:40
F_tw:
    ds_read_b32 v224, v8 offset:40
    s_waitcnt lgkmcnt(0)
    v_readfirstlane_b32 s60, v224
    s_cmp_lg_u32 s60, 0
    s_cbranch_scc1 F_tk
    s_sleep 2
    s_sub_u32 s3, s3, 1
    s_cbranch_scc0 F_tw
    s_mov_b32 s3, 0
    s_branch L_fin
F_tk:
    s_and_b32 s62, s60, 0xfff
    s_cmp_eq_u32 s62, s61
    s_cbranch_scc1 L_fin
F_again:
    s_mov_b64 exec, -1
    s_waitcnt vmcnt(0)
    s_mov_b32 s17, 1
    s_mov_b32 s16, 131072
    s_mov_b32 s20, 0x40000
    v_mov_b64 v[224:225], 0
    s_cmp_eq_u32 s48, 0
    s_cselect_b32 s60, s60, 0
HF0_11:
    s_cbranch_execz HF_ret
    s_cbranch_scc0 F_redo
    ds_write_b64 v8, v[224:225] offset:32
    s_branch F_redo
L_last:
.section .rodata,"a"
.p2align 6
.amdhsa_kernel sequential_preLN__sliding_local_dilated__moe_arch_mod__prompt_kernel
  .amdhsa_next_free_vgpr 256
  .amdhsa_next_free_sgpr 102
  .amdhsa_accum_offset 256
  .amdhsa_group_segment_fixed_size 0
  .amdhsa_kernarg_size 88
  .amdhsa_user_sgpr_count 2
  .amdhsa_user_sgpr_kernarg_segment_ptr 1
  .amdhsa_system_sgpr_workgroup_id_x 1
  .amdhsa_float_denorm_mode_32 3
  .amdhsa_float_denorm_mode_16_64 3
.end_amdhsa_kernel
```

```asm
; @launch grid=(256,1,1) block=(512,1,1) lds=163840
.amdgcn_target "amdgcn-amd-amdhsa--gfx950"
.text
.globl sequential_preLN__sliding_local_dilated__moe_arch_mod__prompt_kernel
.p2align 8
.type sequential_preLN__sliding_local_dilated__moe_arch_mod__prompt_kernel,@function
sequential_preLN__sliding_local_dilated__moe_arch_mod__prompt_kernel:
    s_load_dwordx2 s[28:29], s[0:1], 0
    s_load_dwordx2 s[32:33], s[0:1], 8
    v_readfirstlane_b32 s48, v0
    s_load_dwordx2 s[24:25], s[0:1], 80
    s_load_dwordx2 s[36:37], s[0:1], 16
    s_load_dwordx2 s[40:41], s[0:1], 64
    s_load_dwordx8 s[12:19], s[0:1], 32
    s_lshr_b32 s56, s2, 3
    s_lshr_b32 s48, s48, 6
    s_cmp_ge_u32 s2, 240
    s_cbranch_scc1 F_pre
    s_mul_i32 s51, s56, 86
    s_lshr_b32 s51, s51, 8
    s_and_b32 s66, s2, 7
    s_sub_u32 s53, s66, s51
    s_mul_i32 s53, s53, 3
    s_add_u32 s53, s53, s56
    s_lshr_b32 s55, s53, 1
    s_and_b32 s50, s53, 1
    s_mul_i32 s55, s55, 86
    s_sub_u32 s55, s55, 10
    s_mov_b32 s30, 2621440
    s_mov_b32 s31, 0x00020000
    s_sub_u32 s60, s48, 4
    s_cbranch_scc1 C_pre
    s_lshl_b32 s62, s60, 2
    s_and_b32 s62, s62, 4
    v_bfe_u32 v1, v0, 3, 3
    v_bfe_u32 v2, v0, 4, 2
    v_bitop3_b32 v3, v0, 7, s62 bitop3:0x6a
    s_mul_i32 s62, s60, 24
    s_add_u32 s62, s62, s55
    s_lshl1_add_u32 s62, s62, s50
    s_mul_i32 s62, s62, 1280
    v_xor_b32 v4, v3, v2
    v_mul_u32_u24 v5, 2560, v1
    v_lshl_add_u32 v4, v4, 4, s62
    s_movk_i32 s63, 20480
    v_add_u32 v10, v4, v5
    v_bitop3_b32 v6, v1, 2, v3 bitop3:0x6a
    v_xad_u32 v11, v10, 64, s63
    v_add_u32 v12, 40960, v10
    s_mul_i32 s62, s60, 30720
    s_lshl_b32 s63, s51, 7
    s_add_u32 s62, s62, s63
    v_mul_u32_u24 v5, 3840, v1
    v_lshl_add_u32 v6, v6, 4, s62
    s_mul_i32 s66, s66, 5
    s_lshr_b32 s66, s66, 2
    v_add_u32 v13, v5, v6
    s_mul_i32 s65, s60, 3072
    v_add_u32 v14, 256, v13
    v_add_u32 v15, 512, v13
    s_mov_b32 s34, 2457600
    s_mov_b32 s35, 0x00020000
    s_mov_b32 s64, s65
    s_add_u32 s70, s65, 110592
    s_waitcnt lgkmcnt(0)
    s_call_b64 s[98:99], LD_issue
    s_branch LD_cont
LD_issue:
    s_mov_b32 m0, s65
    s_lshl_b32 s67, s66, 7
    buffer_load_dwordx4 v10, s[28:31], s67 offen lds
    s_add_u32 m0, s65, 1024
    s_mul_i32 s68, s66, 245760
    buffer_load_dwordx4 v11, s[28:31], s67 offen lds
    s_add_u32 m0, s65, 2048
    s_add_u32 s69, s68, 122880
    buffer_load_dwordx4 v12, s[28:31], s67 offen lds
    s_add_u32 m0, s65, 12288
    s_add_u32 s66, s66, 1
    buffer_load_dwordx4 v13, s[32:35], s68 offen offset:0 lds
    buffer_load_dwordx4 v14, s[32:35], s68 offen offset:1024 lds
    buffer_load_dwordx4 v15, s[32:35], s68 offen offset:2048 lds
    s_add_u32 m0, s65, 24576
    s_cmp_eq_u32 s66, 10
    s_cselect_b32 s66, 0, s66
    buffer_load_dwordx4 v13, s[32:35], s69 offen offset:0 lds
    buffer_load_dwordx4 v14, s[32:35], s69 offen offset:1024 lds
    buffer_load_dwordx4 v15, s[32:35], s69 offen offset:2048 lds
    s_add_u32 s65, s65, 36864
    s_cmp_eq_u32 s65, s70
    s_cselect_b32 s65, s64, s65
    s_setpc_b64 s[98:99]
F_pre:
    s_cmp_ge_u32 s2, 256
    s_cbranch_scc1 L_end
    s_getpc_b64 s[58:59]
P_main:
    v_lshlrev_b32 v2, 7, v0
    v_cmp_gt_u32 vcc, L_last-P_main, v2
    s_nop 1
    v_cndmask_b32 v2, 0, v2, vcc
    global_load_dword v219, v2, s[58:59]
    s_branch F_start
C_pre:
    v_and_b32 v0, 63, v0
    s_mov_b32 s3, 0x40000
    s_mov_b32 s47, 0xffff0000
    s_mov_b32 s26, 7340032
    s_mov_b32 s27, 0x00020000
    s_mov_b32 s38, 819200
    s_mov_b32 s39, 0x00020000
    s_mov_b32 s42, 2621440
    s_mov_b32 s43, 0x00020000
    s_sub_u32 s52, s51, 5
    s_cselect_b32 s52, s51, s52
    v_and_b32 v1, 15, v0
    v_lshrrev_b32 v2, 4, v0
    s_mul_i32 s60, s51, 12
    s_lshl_b32 s61, s48, 2
    s_add_u32 s60, s60, s61
    v_add_u32 v10, s60, v2
    v_add_u32 v11, s55, v10
    v_cmp_gt_i32 vcc, 0, v11
    v_lshl_add_u32 v11, v11, 1, s50
    v_mul_u32_u24 v11, 1280, v11
    v_lshl_add_u32 v11, v1, 4, v11
    v_cndmask_b32 v11, v11, 2.0, vcc
    s_mov_b32 s34, 1280
    s_mov_b32 s35, 0x00020000
    s_lshl_b32 s62, s53, 1
    s_add_u32 s62, s62, s51
    s_mul_i32 s62, s62, 8
    s_add_u32 s62, s62, s61
    s_sub_u32 s62, s62, 64
    s_cmp_lt_u32 s48, 2
    s_cselect_b32 s62, s62, 640
    s_lshl3_add_u32 s63, s53, s51
    s_add_u32 s63, s63, 384
    s_cmp_lt_u32 s51, 8
    s_cselect_b32 s65, 3, 0
    s_cselect_b32 s62, s63, s62
    s_cselect_b32 s63, 192, 1
    v_lshlrev_b32 v58, 4, v0
    v_lshlrev_b32 v59, 2, v0
    s_waitcnt lgkmcnt(0)
    s_buffer_load_dword s54, s[24:27], 0
    s_mov_b64 s[32:33], s[12:13]
    s_cmp_lt_u32 s48, s65
    s_cbranch_scc0 A_nors
    buffer_load_dwordx4 v[20:23], v11, s[28:31], 0 offen offset:0
    buffer_load_dwordx4 v[24:27], v11, s[28:31], 0 offen offset:256
    buffer_load_dwordx4 v[28:31], v11, s[28:31], 0 offen offset:512
    buffer_load_dwordx4 v[32:35], v11, s[28:31], 0 offen offset:768
    buffer_load_dwordx4 v[36:39], v11, s[28:31], 0 offen offset:1024
    s_branch A_cons
A_nors:
    s_cmp_lg_u32 s48, 3
    s_cbranch_scc1 A_nowr
    buffer_load_dwordx4 v[48:51], v58, s[32:35], 0 offen
    buffer_load_dword v52, v59, s[32:35], 0 offen offset:1024
A_nowr:
    s_cmp_ge_u32 s62, 640
    s_cbranch_scc1 A_cons
    v_mul_u32_u24 v10, s63, v2
    v_add_u32 v10, s62, v10
    v_lshlrev_b32 v12, 4, v1
    v_mul_u32_u24 v11, 1280, v10
    v_add_u32 v11, v11, v12
    buffer_load_dwordx4 v[76:79], v12, s[32:35], 0 offen offset:0
    buffer_load_dwordx4 v[80:83], v12, s[32:35], 0 offen offset:256
    buffer_load_dwordx4 v[84:87], v12, s[32:35], 0 offen offset:512
    buffer_load_dwordx4 v[88:91], v12, s[32:35], 0 offen offset:768
    buffer_load_dwordx4 v[92:95], v12, s[32:35], 0 offen offset:1024
    buffer_load_dwordx4 v[20:23], v11, s[36:39], 0 offen offset:0
    buffer_load_dwordx4 v[24:27], v11, s[36:39], 0 offen offset:256
    buffer_load_dwordx4 v[28:31], v11, s[36:39], 0 offen offset:512
    buffer_load_dwordx4 v[32:35], v11, s[36:39], 0 offen offset:768
    buffer_load_dwordx4 v[36:39], v11, s[36:39], 0 offen offset:1024
A_cons:
    v_mov_b32 v99, 2.0
    v_lshrrev_b32 v3, 1, v1
    v_xor_b32 v3, v3, v2
    v_lshlrev_b32 v3, 4, v3
    v_lshl_add_u32 v4, v1, 7, v3
    v_xor_b32 v5, 64, v4
    v_cmp_eq_u32 vcc, 0, v1
    v_mov_b32 v3, 159744
    s_nop 0
    v_cndmask_b32 v6, v4, v3, vcc
    v_cndmask_b32 v7, v5, v3, vcc
    v_cndmask_b32 v8, 1, 0, vcc
    v_bfe_u32 v14, v0, 2, 2
    v_and_b32 v15, 3, v0
    v_lshrrev_b32 v16, 1, v14
    v_and_b32 v17, 1, v2
    v_lshl_or_b32 v16, v17, 1, v16
    v_xor_b32 v16, s48, v16
    v_lshlrev_b32 v16, 5, v16
    v_lshl_add_u32 v16, v15, 3, v16
    v_lshl_add_u32 v16, v14, 7, v16
    v_mul_u32_u24 v17, 3072, v2
    v_add_u32 v9, v16, v17
    v_mov_b32 v16, 0x3f803f80
    v_mov_b32 v17, v16
    v_mov_b32 v18, v16
    v_mov_b32 v19, v16
    ds_write_b128 v3, v[16:19]
    v_mov_b64 v[100:101], 0
    v_mov_b64 v[102:103], 0
    v_mov_b64 v[104:105], 0
    v_mov_b64 v[106:107], 0
    v_mov_b64 v[108:109], 0
    v_mov_b64 v[110:111], 0
    v_mov_b64 v[112:113], 0
    v_mov_b64 v[114:115], 0
    v_mov_b64 v[116:117], 0
    v_mov_b64 v[118:119], 0
    v_mov_b64 v[120:121], 0
    v_mov_b64 v[122:123], 0
    v_mov_b64 v[124:125], 0
    v_mov_b64 v[126:127], 0
    v_mov_b64 v[128:129], 0
    v_mov_b64 v[130:131], 0
    v_mov_b64 v[132:133], 0
    v_mov_b64 v[134:135], 0
    v_mov_b64 v[136:137], 0
    v_mov_b64 v[138:139], 0
    v_mov_b64 v[140:141], 0
    v_mov_b64 v[142:143], 0
    v_mov_b64 v[144:145], 0
    v_mov_b64 v[146:147], 0
    v_mov_b64 v[148:149], 0
    v_mov_b64 v[150:151], 0
    v_mov_b64 v[152:153], 0
    v_mov_b64 v[154:155], 0
    v_mov_b64 v[156:157], 0
    v_mov_b64 v[158:159], 0
    v_mov_b64 v[160:161], 0
    v_mov_b64 v[162:163], 0
    v_mov_b64 v[164:165], 0
    v_mov_b64 v[166:167], 0
    v_mov_b64 v[168:169], 0
    v_mov_b64 v[170:171], 0
    s_call_b64 s[98:99], S_late
    s_call_b64 s[98:99], S_late2
    s_call_b64 s[98:99], S_late3
    s_call_b64 s[98:99], S_late4
    s_branch A_c2
S_late:
    v_and_b32 v200, 15, v0
    v_lshrrev_b32 v201, 4, v0
    v_lshlrev_b32 v202, 4, v0
    v_lshlrev_b32 v203, 2, v0
    v_lshrrev_b32 v64, 5, v0
    v_and_b32 v65, 12, v200
    s_lshl_b32 s4, s52, 3
    s_sub_u32 s4, 96768, s4
    s_min_u32 s5, s48, 5
    s_lshl_b32 s6, s5, 4
    v_add_u32 v67, s6, v200
    v_mul_u32_u24 v68, 400, v67
    v_mad_u32_u24 v66, v201, 40, s4
    v_add_u32 v71, v68, v66
    v_subrev_u32 v205, 3072, v71
    v_mul_u32_u24 v72, 5, v201
    v_subrev_u32 v72, s52, v72
    v_mov_b32 v73, 159776
    v_add_u32 v74, 0, v72
    v_cmp_gt_u32 vcc, 16, v74
    v_add_u32 v74, 0, v71
    s_nop 0
    v_cndmask_b32 v204, v73, v74, vcc
    v_add_u32 v74, 1, v72
    v_cmp_gt_u32 vcc, 16, v74
    v_add_u32 v74, 8, v71
    s_nop 0
    v_cndmask_b32 v229, v73, v74, vcc
    v_add_u32 v74, 2, v72
    v_cmp_gt_u32 vcc, 16, v74
    v_add_u32 v74, 16, v71
    s_nop 0
    v_cndmask_b32 v230, v73, v74, vcc
    v_add_u32 v74, 3, v72
    v_cmp_gt_u32 vcc, 16, v74
    v_add_u32 v74, 24, v71
    s_nop 0
    v_cndmask_b32 v231, v73, v74, vcc
    v_add_u32 v74, 4, v72
    v_cmp_gt_u32 vcc, 16, v74
    v_add_u32 v74, 32, v71
    s_nop 0
    v_cndmask_b32 v255, v73, v74, vcc
    v_lshlrev_b32 v208, 3, v67
    v_add_u32 v208, 159808, v208
    v_add_u32 v69, s6, v65
    v_lshlrev_b32 v209, 3, v69
    v_add_u32 v209, 159748, v209
    v_and_b32 v70, 3, v0
    v_cmp_gt_u32 vcc, 1, v70
    v_mov_b32 v73, s47
    s_nop 0
    v_cndmask_b32 v207, 0, v73, vcc
    v_cmp_gt_u32 vcc, 3, v70
    s_nop 1
    v_cndmask_b32 v211, 0, v73, vcc
    v_cmp_gt_u32 vcc, 2, v70
    s_nop 1
    v_cndmask_b32 v211, v211, -1, vcc
    s_setpc_b64 s[98:99]
S_late2:
    s_lshl_b32 s7, s5, 12
    s_add_u32 s7, s7, 135184
    v_lshl_add_u32 v66, v0, 6, s7
    v_lshl_add_u32 v210, v65, 1, v66
    s_add_u32 s13, s6, s55
    v_add_u32 v212, s13, v65
    s_mul_i32 s8, s53, 6
    s_mul_i32 s9, s8, 24320
    s_add_u32 s9, s9, 1310720
    s_mul_i32 s0, s48, 24320
    s_add_u32 s0, s0, s9
    v_lshlrev_b32 v206, 4, v200
    v_lshl_add_u32 v206, v64, 8, v206
    v_xor_b32 v213, 256, v206
    v_lshl_add_u32 v213, v64, 12, v213
    s_cmp_lg_u32 s52, 0
    s_cselect_b32 s20, 0x0000ffff, 0
    s_cmp_lg_u32 s52, 4
    s_cselect_b32 s21, s47, 0
    s_cmp_eq_u32 s48, 0
    s_cselect_b32 s7, 0xff00ff00, -1
    s_and_b32 s20, s20, s7
    s_and_b32 s21, s21, s7
    s_lshl_b32 s7, s51, 11
    s_add_u32 s22, s0, s7
    s_sub_u32 s12, s22, 2048
    s_add_u32 s100, s9, 23040
    s_lshr_b32 s7, s51, 1
    s_mul_i32 s7, s7, 23552
    s_mul_i32 s57, s51, 384
    s_add_u32 s7, s7, s57
    s_add_u32 s7, s7, 23552
    s_add_u32 s57, s7, s9
    s_mul_i32 s7, s48, 10
    s_add_u32 s7, s7, s51
    s_lshl_b32 s7, s7, 2
    s_add_u32 s23, s100, s7
    s_sub_u32 s56, s48, 2
    s_cmp_lt_u32 s48, 6
    s_cselect_b32 s101, 0, 1
    s_cselect_b32 s56, s48, s56
    s_mul_i32 s1, s56, 24320
    s_add_u32 s1, s1, s9
    s_add_u32 s8, s8, s56
    s_mul_i32 s44, s53, 2560
    s_lshl_b32 s7, s51, 8
    s_add_u32 s44, s44, s7
    s_add_u32 s44, s44, 262144
    s_lshl_b32 s45, s53, 6
    s_add_u32 s45, s45, 196608
    s_setpc_b64 s[98:99]
S_late3:
    v_bfe_u32 v68, v0, 2, 2
    v_and_b32 v69, 3, v0
    v_lshl_add_u32 v70, v201, 3, v68
    s_lshl_b32 s7, s48, 4
    s_sub_u32 s7, s7, 16
    v_add_u32 v71, s7, v70
    v_and_b32 v72, 15, v71
    v_max_i32 v71, v71, v72
    v_mul_u32_u24 v71, 400, v71
    v_lshl_add_u32 v71, v69, 3, v71
    v_add_u32 v214, 97024, v71
    v_and_b32 v72, 1, v201
    s_cmp_eq_u32 s48, 0
    s_cselect_b32 s7, 8, 0
    v_cmp_gt_u32 vcc, s7, v200
    s_nop 1
    v_cndmask_b32 v249, v202, 2.0, vcc
    v_lshrrev_b32 v71, 1, v68
    v_lshl_or_b32 v71, v72, 1, v71
    v_lshl_add_u32 v70, v201, 2, v68
    v_lshlrev_b32 v70, 7, v70
    v_lshl_add_u32 v70, v69, 3, v70
    s_mul_i32 s7, s101, 40960
    s_add_u32 s7, s7, 12288
    v_add_u32 v70, s7, v70
    s_mul_i32 s7, s101, 36864
    s_sub_u32 s7, 40960, s7
    v_xor_b32 v73, 0, v71
    v_lshl_add_u32 v216, v73, 5, v70
    v_add_u32 v220, s7, v216
    v_xor_b32 v73, 1, v71
    v_lshl_add_u32 v217, v73, 5, v70
    v_add_u32 v221, s7, v217
    v_xor_b32 v73, 2, v71
    v_lshl_add_u32 v218, v73, 5, v70
    v_add_u32 v222, s7, v218
    v_xor_b32 v73, 3, v71
    v_lshl_add_u32 v219, v73, 5, v70
    v_add_u32 v223, s7, v219
    s_setpc_b64 s[98:99]
S_late4:
    s_lshl_b32 s7, s56, 4
    v_add_u32 v73, s7, v200
    v_cmp_gt_u32 vcc, 10, v73
    v_add_u32 v73, s55, v73
    v_lshl_add_u32 v73, v73, 1, s50
    v_mul_u32_u24 v74, 1280, v73
    s_lshl_b32 s7, s51, 7
    v_lshl_add_u32 v75, v201, 3, s7
    v_add_u32 v74, v74, v75
    v_cndmask_b32 v253, v74, 2.0, vcc
    v_cndmask_b32 v254, v73, -1, vcc
    v_add_u32 v227, 161792, v75
    v_mul_u32_u24 v224, 61440, v201
    v_lshl_add_u32 v224, v200, 4, v224
    s_mov_b32 s7, 161024
    v_lshl_add_u32 v228, v201, 5, s7
    v_lshl_add_u32 v252, v69, 5, s7
    v_lshl_add_u32 v252, v68, 3, v252
    v_mul_u32_u24 v225, 24, v72
    v_add_u32 v225, v225, v253
    v_lshl_add_u32 v226, s8, 4, v200
    s_cmp_eq_u32 s101, 1
    s_cselect_b64 vcc, -1, 0
    v_cndmask_b32 v250, v225, 2.0, vcc
    v_mov_b32 v251, 160784
    s_add_u32 s7, s52, 5
    s_cmp_lt_u32 s51, 5
    s_cselect_b32 s7, s7, s52
    s_lshl_b32 s7, s7, 11
    s_add_u32 s16, s7, s1
    s_lshl_b32 s7, s51, 11
    s_add_u32 s14, s7, s1
    s_add_u32 s15, s1, 20480
    s_cmp_eq_u32 s101, 1
    s_cselect_b32 s14, s16, s14
    s_cselect_b32 s18, 0x3e0, 62
    s_lshl_b32 s7, s101, 10
    s_add_u32 s16, s16, s7
    s_cmp_lt_u32 s48, 4
    s_cselect_b32 s18, 0x3fe, s18
    s_lshl_b32 s18, s18, s51
    s_lshr_b32 s7, s18, 10
    s_or_b32 s18, s18, s7
    s_and_b32 s18, s18, 0x3ff
    s_mov_b32 s19, 0
    s_mul_i32 s17, s56, 40
    s_add_u32 s17, s17, s100
    s_lshl_b32 s7, s48, 12
    s_add_u32 s7, s7, 135168
    v_lshl_add_u32 v73, v200, 6, s7
    v_lshl_add_u32 v73, v201, 4, v73
    v_add_u32 v74, s52, v201
    s_add_u32 s46, s52, 0
    s_mul_i32 s46, s46, 52
    s_lshr_b32 s46, s46, 8
    v_lshl_add_u32 v172, s46, 10, v73
    s_add_u32 s46, s52, 3
    s_mul_i32 s46, s46, 52
    s_lshr_b32 s46, s46, 8
    v_lshl_add_u32 v173, s46, 10, v73
    s_mul_i32 s46, s46, 5
    s_sub_u32 s46, s46, 0
    v_cmp_le_i32 s[4:5], s46, v74
    s_add_u32 s46, s52, 4
    s_mul_i32 s46, s46, 52
    s_lshr_b32 s46, s46, 8
    v_lshl_add_u32 v174, s46, 10, v73
    s_add_u32 s46, s52, 7
    s_mul_i32 s46, s46, 52
    s_lshr_b32 s46, s46, 8
    v_lshl_add_u32 v175, s46, 10, v73
    s_mul_i32 s46, s46, 5
    s_sub_u32 s46, s46, 4
    v_cmp_le_i32 s[6:7], s46, v74
    s_add_u32 s46, s52, 8
    s_mul_i32 s46, s46, 52
    s_lshr_b32 s46, s46, 8
    v_lshl_add_u32 v176, s46, 10, v73
    s_add_u32 s46, s52, 11
    s_mul_i32 s46, s46, 52
    s_lshr_b32 s46, s46, 8
    v_lshl_add_u32 v177, s46, 10, v73
    s_mul_i32 s46, s46, 5
    s_sub_u32 s46, s46, 8
    v_cmp_le_i32 s[8:9], s46, v74
    s_add_u32 s46, s52, 12
    s_mul_i32 s46, s46, 52
    s_lshr_b32 s46, s46, 8
    v_lshl_add_u32 v178, s46, 10, v73
    s_add_u32 s46, s52, 15
    s_mul_i32 s46, s46, 52
    s_lshr_b32 s46, s46, 8
    v_lshl_add_u32 v179, s46, 10, v73
    s_mul_i32 s46, s46, 5
    s_sub_u32 s46, s46, 12
    v_cmp_le_i32 s[10:11], s46, v74
    s_setpc_b64 s[98:99]
A_c2:
    s_waitcnt lgkmcnt(0)
    s_add_u32 s54, s54, 2654435761
    s_lshl_b32 s63, s53, 11
    s_add_u32 s63, s63, 81920
    v_mov_b32 v42, s54
    v_lshlrev_b32 v10, 4, v10
    s_cmp_lt_u32 s48, s65
    s_cbranch_scc0 A_nos
    s_waitcnt vmcnt(4)
    v_dot2_f32_bf16 v40, v20, v16, 0
    v_dot2_f32_bf16 v41, v20, v20, 0
    v_dot2_f32_bf16 v44, v21, v16, 0
    v_dot2_f32_bf16 v45, v21, v21, 0
    v_dot2_f32_bf16 v40, v22, v16, v40
    v_dot2_f32_bf16 v41, v22, v22, v41
    v_dot2_f32_bf16 v44, v23, v16, v44
    v_dot2_f32_bf16 v45, v23, v23, v45
    s_waitcnt vmcnt(3)
    v_dot2_f32_bf16 v40, v24, v16, v40
    v_dot2_f32_bf16 v41, v24, v24, v41
    v_dot2_f32_bf16 v44, v25, v16, v44
    v_dot2_f32_bf16 v45, v25, v25, v45
    v_dot2_f32_bf16 v40, v26, v16, v40
    v_dot2_f32_bf16 v41, v26, v26, v41
    v_dot2_f32_bf16 v44, v27, v16, v44
    v_dot2_f32_bf16 v45, v27, v27, v45
    s_waitcnt vmcnt(2)
    v_dot2_f32_bf16 v40, v28, v16, v40
    v_dot2_f32_bf16 v41, v28, v28, v41
    v_dot2_f32_bf16 v44, v29, v16, v44
    v_dot2_f32_bf16 v45, v29, v29, v45
    v_dot2_f32_bf16 v40, v30, v16, v40
    v_dot2_f32_bf16 v41, v30, v30, v41
    v_dot2_f32_bf16 v44, v31, v16, v44
    v_dot2_f32_bf16 v45, v31, v31, v45
    s_waitcnt vmcnt(1)
    v_dot2_f32_bf16 v40, v32, v16, v40
    v_dot2_f32_bf16 v41, v32, v32, v41
    v_dot2_f32_bf16 v44, v33, v16, v44
    v_dot2_f32_bf16 v45, v33, v33, v45
    v_dot2_f32_bf16 v40, v34, v16, v40
    v_dot2_f32_bf16 v41, v34, v34, v41
    v_dot2_f32_bf16 v44, v35, v16, v44
    v_dot2_f32_bf16 v45, v35, v35, v45
    s_waitcnt vmcnt(0)
    v_dot2_f32_bf16 v40, v36, v16, v40
    v_dot2_f32_bf16 v41, v36, v36, v41
    v_dot2_f32_bf16 v44, v37, v16, v44
    v_dot2_f32_bf16 v45, v37, v37, v45
    v_dot2_f32_bf16 v40, v38, v16, v40
    v_dot2_f32_bf16 v41, v38, v38, v41
    v_dot2_f32_bf16 v44, v39, v16, v44
    v_dot2_f32_bf16 v45, v39, v39, v45
A_red:
    s_nop 1
    v_add_f32 v40, v40, v44
    v_add_f32 v41, v41, v45
    s_nop 0
    v_add_f32_dpp v40, v40, v40 row_ror:1 row_mask:0xf bank_mask:0xf
    v_add_f32_dpp v41, v41, v41 row_ror:1 row_mask:0xf bank_mask:0xf
    s_nop 0
    v_add_f32_dpp v40, v40, v40 row_ror:2 row_mask:0xf bank_mask:0xf
    v_add_f32_dpp v41, v41, v41 row_ror:2 row_mask:0xf bank_mask:0xf
    s_nop 0
    v_add_f32_dpp v40, v40, v40 row_ror:4 row_mask:0xf bank_mask:0xf
    v_add_f32_dpp v41, v41, v41 row_ror:4 row_mask:0xf bank_mask:0xf
    s_nop 0
    v_add_f32_dpp v40, v40, v40 row_ror:8 row_mask:0xf bank_mask:0xf
    v_add_f32_dpp v41, v41, v41 row_ror:8 row_mask:0xf bank_mask:0xf
    s_cselect_b32 s64, s63, 1245184
    s_cbranch_scc0 A_nln
    v_mul_f32 v40, 0x3acccccd, v40
    v_mul_f32 v41, 0x3acccccd, v41
    v_fma_f32 v41, -v40, v40, v41
    v_max_f32 v41, 0, v41
    v_cvt_pk_bf16_f32 v41, v41, v41
    v_and_b32 v41, 0xffff0000, v41
    v_add_f32 v41, 0x3727c5ac, v41
    v_cvt_pk_bf16_f32 v41, v41, v41
    v_and_b32 v41, 0xffff0000, v41
    v_sqrt_f32 v41, v41
    v_cvt_pk_bf16_f32 v40, v40, v40
    v_and_b32 v40, 0xffff0000, v40
    v_cvt_pk_bf16_f32 v41, v41, v41
    v_and_b32 v41, 0xffff0000, v41
    v_rcp_f32 v41, v41
A_nln:
    s_mov_b32 exec_lo, 0x00010001
    s_mov_b32 exec_hi, 0x00010001
    buffer_store_dwordx3 v[40:42], v10, s[24:27], s64 offen sc1
    s_mov_b64 exec, -1
A_w3:
    s_cmp_lg_u32 s48, 3
    s_cbranch_scc1 A_go
    s_getreg_b32 s61, hwreg(HW_REG_XCC_ID)
    s_lshl_b32 s64, s51, 4
    s_add_u32 s64, s64, 1536
    v_mov_b32 v44, s61
    v_mov_b32 v43, s64
    v_mov_b32 v46, s54
    s_mov_b64 exec, 1
    buffer_store_dwordx3 v[44:46], v43, s[24:27], s63 offen sc1
    s_mov_b64 exec, -1
    v_add_u32 v58, 161792, v58
    v_add_u32 v59, 161792, v59
    s_cmp_lt_u32 s62, 640
    s_cbranch_scc1 A_w3l
    s_waitcnt vmcnt(1)
A_w3l:
    ds_write_b128 v58, v[48:51]
    ds_write_b32 v59, v52 offset:1024
    v_dot2_f32_bf16 v25, v48, v16, 0
    v_dot2_f32_bf16 v25, v49, v16, v25
    v_dot2_f32_bf16 v25, v50, v16, v25
    v_dot2_f32_bf16 v25, v51, v16, v25
    v_dot2_f32_bf16 v25, v52, v16, v25
    s_nop 2
    v_add_f32_dpp v25, v25, v25 row_ror:1 row_mask:0xf bank_mask:0xf
    s_nop 1
    v_add_f32_dpp v25, v25, v25 row_ror:2 row_mask:0xf bank_mask:0xf
    s_nop 1
    v_add_f32_dpp v25, v25, v25 row_ror:4 row_mask:0xf bank_mask:0xf
    s_nop 1
    v_add_f32_dpp v25, v25, v25 row_ror:8 row_mask:0xf bank_mask:0xf
    v_mov_b32 v26, v25
    s_nop 1
    v_permlane32_swap_b32 v25, v26
    v_add_f32 v25, v25, v26
    v_mov_b32 v26, v25
    s_nop 1
    v_permlane16_swap_b32 v25, v26
    v_add_f32 v25, v25, v26
    v_mov_b32 v58, 161792
    ds_write_b32 v58, v25 offset:1280
    s_waitcnt lgkmcnt(0)
    s_branch A_go
A_nos:
    s_cmp_ge_u32 s62, 640
    s_cbranch_scc1 A_w3
    s_waitcnt vmcnt(4)
    v_dot2_f32_bf16 v40, v20, v16, 0
    v_dot2_f32_bf16 v41, v20, v76, 0
    v_dot2_f32_bf16 v44, v21, v16, 0
    v_dot2_f32_bf16 v45, v21, v77, 0
    v_dot2_f32_bf16 v40, v22, v16, v40
    v_dot2_f32_bf16 v41, v22, v78, v41
    v_dot2_f32_bf16 v44, v23, v16, v44
    v_dot2_f32_bf16 v45, v23, v79, v45
    s_waitcnt vmcnt(3)
    v_dot2_f32_bf16 v40, v24, v16, v40
    v_dot2_f32_bf16 v41, v24, v80, v41
    v_dot2_f32_bf16 v44, v25, v16, v44
    v_dot2_f32_bf16 v45, v25, v81, v45
    v_dot2_f32_bf16 v40, v26, v16, v40
    v_dot2_f32_bf16 v41, v26, v82, v41
    v_dot2_f32_bf16 v44, v27, v16, v44
    v_dot2_f32_bf16 v45, v27, v83, v45
    s_waitcnt vmcnt(2)
    v_dot2_f32_bf16 v40, v28, v16, v40
    v_dot2_f32_bf16 v41, v28, v84, v41
    v_dot2_f32_bf16 v44, v29, v16, v44
    v_dot2_f32_bf16 v45, v29, v85, v45
    v_dot2_f32_bf16 v40, v30, v16, v40
    v_dot2_f32_bf16 v41, v30, v86, v41
    v_dot2_f32_bf16 v44, v31, v16, v44
    v_dot2_f32_bf16 v45, v31, v87, v45
    s_waitcnt vmcnt(1)
    v_dot2_f32_bf16 v40, v32, v16, v40
    v_dot2_f32_bf16 v41, v32, v88, v41
    v_dot2_f32_bf16 v44, v33, v16, v44
    v_dot2_f32_bf16 v45, v33, v89, v45
    v_dot2_f32_bf16 v40, v34, v16, v40
    v_dot2_f32_bf16 v41, v34, v90, v41
    v_dot2_f32_bf16 v44, v35, v16, v44
    v_dot2_f32_bf16 v45, v35, v91, v45
    s_waitcnt vmcnt(0)
    v_dot2_f32_bf16 v40, v36, v16, v40
    v_dot2_f32_bf16 v41, v36, v92, v41
    v_dot2_f32_bf16 v44, v37, v16, v44
    v_dot2_f32_bf16 v45, v37, v93, v45
    v_dot2_f32_bf16 v40, v38, v16, v40
    v_dot2_f32_bf16 v41, v38, v94, v41
    v_dot2_f32_bf16 v44, v39, v16, v44
    v_dot2_f32_bf16 v45, v39, v95, v45
    s_branch A_red
A_go:
    v_lshlrev_b32 v18, 3, v1
    v_add_u32 v18, 159808, v18
    v_mul_u32_u24 v3, 400, v1
    v_lshl_add_u32 v3, v2, 3, v3
    s_lshl_b32 s60, s48, 5
    s_add_u32 s60, s60, 96768
    v_add_u32 v3, s60, v3
    v_mov_b32 v17, 160768
    s_mov_b32 s60, 0
    v_add_u32 v14, s60, v9
    v_mad_u32_u24 v10, v8, s60, v6
    v_add_u32 v12, s60, v4
    v_mad_u32_u24 v11, v8, s60, v7
    v_add_u32 v13, s60, v5
    s_mov_b32 s61, 0
    s_barrier
    ds_read_b64_tr_b16 v[44:45], v14 offset:12288
    ds_read_b64_tr_b16 v[46:47], v14 offset:12800
    ds_read_b64_tr_b16 v[48:49], v14 offset:13312
    ds_read_b64_tr_b16 v[50:51], v14 offset:13824
    ds_read_b64_tr_b16 v[52:53], v14 offset:14336
    ds_read_b64_tr_b16 v[54:55], v14 offset:14848
    ds_read_b128 v[20:23], v10
    ds_read_b128 v[24:27], v12 offset:2048
    ds_read_b128 v[28:31], v12 offset:4096
    ds_read_b128 v[32:35], v12 offset:6144
    ds_read_b128 v[36:39], v12 offset:8192
    ds_read_b128 v[40:43], v12 offset:10240
A_loop:
    s_waitcnt lgkmcnt(0)
    v_mfma_f32_16x16x32_bf16 v[100:103], v[44:47], v[20:23], v[100:103]
    ds_read_b64_tr_b16 v[80:81], v14 offset:24576
    v_mfma_f32_16x16x32_bf16 v[104:107], v[48:51], v[20:23], v[104:107]
    ds_read_b64_tr_b16 v[82:83], v14 offset:25088
    v_mfma_f32_16x16x32_bf16 v[108:111], v[52:55], v[20:23], v[108:111]
    ds_read_b64_tr_b16 v[84:85], v14 offset:25600
    v_mfma_f32_16x16x32_bf16 v[112:115], v[44:47], v[24:27], v[112:115]
    ds_read_b64_tr_b16 v[86:87], v14 offset:26112
    v_mfma_f32_16x16x32_bf16 v[116:119], v[48:51], v[24:27], v[116:119]
    ds_read_b64_tr_b16 v[88:89], v14 offset:26624
    v_mfma_f32_16x16x32_bf16 v[120:123], v[52:55], v[24:27], v[120:123]
    ds_read_b64_tr_b16 v[90:91], v14 offset:27136
    v_mfma_f32_16x16x32_bf16 v[124:127], v[44:47], v[28:31], v[124:127]
    ds_read_b128 v[56:59], v11
    v_mfma_f32_16x16x32_bf16 v[128:131], v[48:51], v[28:31], v[128:131]
    ds_read_b128 v[60:63], v13 offset:2048
    v_mfma_f32_16x16x32_bf16 v[132:135], v[52:55], v[28:31], v[132:135]
    ds_read_b128 v[64:67], v13 offset:4096
    v_mfma_f32_16x16x32_bf16 v[136:139], v[44:47], v[32:35], v[136:139]
    ds_read_b128 v[68:71], v13 offset:6144
    v_mfma_f32_16x16x32_bf16 v[140:143], v[48:51], v[32:35], v[140:143]
    ds_read_b128 v[72:75], v13 offset:8192
    v_mfma_f32_16x16x32_bf16 v[144:147], v[52:55], v[32:35], v[144:147]
    ds_read_b128 v[76:79], v13 offset:10240
    v_mfma_f32_16x16x32_bf16 v[148:151], v[44:47], v[36:39], v[148:151]
    s_add_u32 s60, s60, 36864
    v_mfma_f32_16x16x32_bf16 v[152:155], v[48:51], v[36:39], v[152:155]
    s_add_u32 s61, s61, 1
    v_mfma_f32_16x16x32_bf16 v[156:159], v[52:55], v[36:39], v[156:159]
    s_cmp_eq_u32 s60, 110592
    v_mfma_f32_16x16x32_bf16 v[160:163], v[44:47], v[40:43], v[160:163]
    s_cselect_b32 s60, 0, s60
    v_mfma_f32_16x16x32_bf16 v[164:167], v[48:51], v[40:43], v[164:167]
    s_cmp_lt_u32 s61, 9
    v_mfma_f32_16x16x32_bf16 v[168:171], v[52:55], v[40:43], v[168:171]
    s_waitcnt lgkmcnt(0)
    v_mfma_f32_16x16x32_bf16 v[100:103], v[80:83], v[56:59], v[100:103]
    v_add_u32 v14, s60, v9
    v_mfma_f32_16x16x32_bf16 v[104:107], v[84:87], v[56:59], v[104:107]
    v_mad_u32_u24 v10, v8, s60, v6
    v_mfma_f32_16x16x32_bf16 v[108:111], v[88:91], v[56:59], v[108:111]
    v_add_u32 v12, s60, v4
    v_mfma_f32_16x16x32_bf16 v[112:115], v[80:83], v[60:63], v[112:115]
    v_mad_u32_u24 v11, v8, s60, v7
    v_mfma_f32_16x16x32_bf16 v[116:119], v[84:87], v[60:63], v[116:119]
    v_add_u32 v13, s60, v5
    v_mfma_f32_16x16x32_bf16 v[120:123], v[88:91], v[60:63], v[120:123]
    s_barrier
    v_mfma_f32_16x16x32_bf16 v[124:127], v[80:83], v[64:67], v[124:127]
    ds_read_b64_tr_b16 v[44:45], v14 offset:12288
    ds_read_b64_tr_b16 v[46:47], v14 offset:12800
    v_mfma_f32_16x16x32_bf16 v[128:131], v[84:87], v[64:67], v[128:131]
    ds_read_b64_tr_b16 v[48:49], v14 offset:13312
    ds_read_b64_tr_b16 v[50:51], v14 offset:13824
    v_mfma_f32_16x16x32_bf16 v[132:135], v[88:91], v[64:67], v[132:135]
    ds_read_b64_tr_b16 v[52:53], v14 offset:14336
    ds_read_b64_tr_b16 v[54:55], v14 offset:14848
    v_mfma_f32_16x16x32_bf16 v[136:139], v[80:83], v[68:71], v[136:139]
    ds_read_b128 v[20:23], v10
    ds_read_b128 v[24:27], v12 offset:2048
    v_mfma_f32_16x16x32_bf16 v[140:143], v[84:87], v[68:71], v[140:143]
    ds_read_b128 v[28:31], v12 offset:4096
    ds_read_b128 v[32:35], v12 offset:6144
    v_mfma_f32_16x16x32_bf16 v[144:147], v[88:91], v[68:71], v[144:147]
    ds_read_b128 v[36:39], v12 offset:8192
    ds_read_b128 v[40:43], v12 offset:10240
    v_mfma_f32_16x16x32_bf16 v[148:151], v[80:83], v[72:75], v[148:151]
    v_mfma_f32_16x16x32_bf16 v[152:155], v[84:87], v[72:75], v[152:155]
    v_mfma_f32_16x16x32_bf16 v[156:159], v[88:91], v[72:75], v[156:159]
    v_mfma_f32_16x16x32_bf16 v[160:163], v[80:83], v[76:79], v[160:163]
    v_mfma_f32_16x16x32_bf16 v[164:167], v[84:87], v[76:79], v[164:167]
    v_mfma_f32_16x16x32_bf16 v[168:171], v[88:91], v[76:79], v[168:171]
    s_cbranch_scc1 A_loop
A_tail:
    s_waitcnt lgkmcnt(0)
    v_mfma_f32_16x16x32_bf16 v[108:111], v[52:55], v[20:23], v[108:111]
    ds_read_b64_tr_b16 v[80:81], v14 offset:24576
    ds_read_b64_tr_b16 v[82:83], v14 offset:25088
    v_mfma_f32_16x16x32_bf16 v[120:123], v[52:55], v[24:27], v[120:123]
    ds_read_b64_tr_b16 v[84:85], v14 offset:25600
    ds_read_b64_tr_b16 v[86:87], v14 offset:26112
    v_mfma_f32_16x16x32_bf16 v[132:135], v[52:55], v[28:31], v[132:135]
    ds_read_b128 v[56:59], v11
    ds_read_b128 v[60:63], v13 offset:2048
    v_mfma_f32_16x16x32_bf16 v[144:147], v[52:55], v[32:35], v[144:147]
    ds_read_b64 v[184:185], v18 offset:0
    ds_read_b64 v[186:187], v18 offset:128
    v_mfma_f32_16x16x32_bf16 v[156:159], v[52:55], v[36:39], v[156:159]
    ds_read_b128 v[64:67], v13 offset:4096
    ds_read_b128 v[68:71], v13 offset:6144
    v_mfma_f32_16x16x32_bf16 v[168:171], v[52:55], v[40:43], v[168:171]
    ds_read_b128 v[72:75], v13 offset:8192
    ds_read_b128 v[76:79], v13 offset:10240
    v_mfma_f32_16x16x32_bf16 v[100:103], v[44:47], v[20:23], v[100:103]
    ds_read_b64_tr_b16 v[88:89], v14 offset:26624
    ds_read_b64_tr_b16 v[90:91], v14 offset:27136
    v_mfma_f32_16x16x32_bf16 v[104:107], v[48:51], v[20:23], v[104:107]
    ds_read_b64 v[188:189], v18 offset:256
    ds_read_b64 v[190:191], v18 offset:384
    v_mfma_f32_16x16x32_bf16 v[112:115], v[44:47], v[24:27], v[112:115]
    ds_read_b64 v[192:193], v18 offset:512
    ds_read_b64 v[194:195], v18 offset:640
    v_mfma_f32_16x16x32_bf16 v[116:119], v[48:51], v[24:27], v[116:119]
    ds_read_b32 v17, v17
    s_waitcnt lgkmcnt(11)
    v_mfma_f32_16x16x32_bf16 v[100:103], v[80:83], v[56:59], v[100:103]
    ds_read_b32 v16, v208 offset:4
    ds_read2_b32 v[4:5], v209 offset0:0 offset1:2
    v_mfma_f32_16x16x32_bf16 v[104:107], v[84:87], v[56:59], v[104:107]
    ds_read2_b32 v[6:7], v209 offset0:4 offset1:6
    ds_read2_b32 v[8:9], v209 offset0:8 offset1:10
    v_mfma_f32_16x16x32_bf16 v[112:115], v[80:83], v[60:63], v[112:115]
    ds_read2_b32 v[10:11], v209 offset0:12 offset1:14
    ds_read2_b32 v[12:13], v209 offset0:16 offset1:18
    v_mfma_f32_16x16x32_bf16 v[116:119], v[84:87], v[60:63], v[116:119]
    ds_read2_b32 v[14:15], v209 offset0:20 offset1:22
    s_waitcnt lgkmcnt(7)
    v_mfma_f32_16x16x32_bf16 v[124:127], v[44:47], v[28:31], v[124:127]
    v_mov_b32_dpp v20, v100 row_newbcast:0 row_mask:0xf bank_mask:0xf
    v_mov_b32_dpp v21, v101 row_newbcast:0 row_mask:0xf bank_mask:0xf
    v_mov_b32_dpp v22, v102 row_newbcast:0 row_mask:0xf bank_mask:0xf
    v_mfma_f32_16x16x32_bf16 v[128:131], v[48:51], v[28:31], v[128:131]
    v_mov_b32_dpp v23, v103 row_newbcast:0 row_mask:0xf bank_mask:0xf
    v_mov_b32_dpp v24, v104 row_newbcast:0 row_mask:0xf bank_mask:0xf
    v_mov_b32_dpp v25, v105 row_newbcast:0 row_mask:0xf bank_mask:0xf
    v_mfma_f32_16x16x32_bf16 v[124:127], v[80:83], v[64:67], v[124:127]
    v_mov_b32_dpp v26, v106 row_newbcast:0 row_mask:0xf bank_mask:0xf
    v_mov_b32_dpp v27, v107 row_newbcast:0 row_mask:0xf bank_mask:0xf
    v_pk_fma_f32 v[100:101], v[184:185], v[20:21], v[100:101] op_sel_hi:[0,1,1] neg_lo:[1,0,0] neg_hi:[1,0,0]
    v_mfma_f32_16x16x32_bf16 v[128:131], v[84:87], v[64:67], v[128:131]
    v_pk_fma_f32 v[102:103], v[184:185], v[22:23], v[102:103] op_sel_hi:[0,1,1] neg_lo:[1,0,0] neg_hi:[1,0,0]
    v_pk_fma_f32 v[104:105], v[184:185], v[24:25], v[104:105] op_sel_hi:[0,1,1] neg_lo:[1,0,0] neg_hi:[1,0,0]
    v_pk_fma_f32 v[106:107], v[184:185], v[26:27], v[106:107] op_sel_hi:[0,1,1] neg_lo:[1,0,0] neg_hi:[1,0,0]
    v_mfma_f32_16x16x32_bf16 v[136:139], v[44:47], v[32:35], v[136:139]
    v_cvt_pk_bf16_f32 v100, v100, v101
    v_cvt_pk_bf16_f32 v101, v102, v103
    ds_write_b64 v3, v[100:101] offset:0
    v_mfma_f32_16x16x32_bf16 v[140:143], v[48:51], v[32:35], v[140:143]
    v_cvt_pk_bf16_f32 v104, v104, v105
    v_cvt_pk_bf16_f32 v105, v106, v107
    ds_write_b64 v3, v[104:105] offset:128
    v_mfma_f32_16x16x32_bf16 v[136:139], v[80:83], v[68:71], v[136:139]
    v_pk_fma_f32 v[112:113], v[186:187], v[20:21], v[112:113] op_sel_hi:[0,1,1] neg_lo:[1,0,0] neg_hi:[1,0,0]
    v_pk_fma_f32 v[114:115], v[186:187], v[22:23], v[114:115] op_sel_hi:[0,1,1] neg_lo:[1,0,0] neg_hi:[1,0,0]
    v_pk_fma_f32 v[116:117], v[186:187], v[24:25], v[116:117] op_sel_hi:[0,1,1] neg_lo:[1,0,0] neg_hi:[1,0,0]
    v_mfma_f32_16x16x32_bf16 v[140:143], v[84:87], v[68:71], v[140:143]
    v_pk_fma_f32 v[118:119], v[186:187], v[26:27], v[118:119] op_sel_hi:[0,1,1] neg_lo:[1,0,0] neg_hi:[1,0,0]
    v_cvt_pk_bf16_f32 v112, v112, v113
    v_cvt_pk_bf16_f32 v113, v114, v115
    v_mfma_f32_16x16x32_bf16 v[148:151], v[44:47], v[36:39], v[148:151]
    ds_write_b64 v3, v[112:113] offset:6400
    v_cvt_pk_bf16_f32 v116, v116, v117
    v_cvt_pk_bf16_f32 v117, v118, v119
    v_mfma_f32_16x16x32_bf16 v[152:155], v[48:51], v[36:39], v[152:155]
    ds_write_b64 v3, v[116:117] offset:6528
    v_readfirstlane_b32 s49, v17
    s_mov_b32 s60, 0x07060503
    v_mfma_f32_16x16x32_bf16 v[148:151], v[80:83], v[72:75], v[148:151]
    s_mov_b32 s61, 0x07060502
    s_mov_b32 s62, 0x07060501
    s_mov_b32 s63, 0x04000c0c
    v_mfma_f32_16x16x32_bf16 v[152:155], v[84:87], v[72:75], v[152:155]
    v_pk_fma_f32 v[124:125], v[188:189], v[20:21], v[124:125] op_sel_hi:[0,1,1] neg_lo:[1,0,0] neg_hi:[1,0,0]
    v_pk_fma_f32 v[126:127], v[188:189], v[22:23], v[126:127] op_sel_hi:[0,1,1] neg_lo:[1,0,0] neg_hi:[1,0,0]
    v_pk_fma_f32 v[128:129], v[188:189], v[24:25], v[128:129] op_sel_hi:[0,1,1] neg_lo:[1,0,0] neg_hi:[1,0,0]
    v_mfma_f32_16x16x32_bf16 v[160:163], v[44:47], v[40:43], v[160:163]
    v_pk_fma_f32 v[130:131], v[188:189], v[26:27], v[130:131] op_sel_hi:[0,1,1] neg_lo:[1,0,0] neg_hi:[1,0,0]
    v_cvt_pk_bf16_f32 v124, v124, v125
    v_cvt_pk_bf16_f32 v125, v126, v127
    v_mfma_f32_16x16x32_bf16 v[164:167], v[48:51], v[40:43], v[164:167]
    ds_write_b64 v3, v[124:125] offset:12800
    v_cvt_pk_bf16_f32 v128, v128, v129
    v_cvt_pk_bf16_f32 v129, v130, v131
    v_mfma_f32_16x16x32_bf16 v[160:163], v[80:83], v[76:79], v[160:163]
    ds_write_b64 v3, v[128:129] offset:12928
    s_mov_b32 s64, 0x0706000c
    s_mov_b32 s66, 0x11111111
    v_mfma_f32_16x16x32_bf16 v[164:167], v[84:87], v[76:79], v[164:167]
    s_mov_b32 s67, s66
    s_mov_b32 s68, 0x33333333
    v_pk_fma_f32 v[136:137], v[190:191], v[20:21], v[136:137] op_sel_hi:[0,1,1] neg_lo:[1,0,0] neg_hi:[1,0,0]
    v_mfma_f32_16x16x32_bf16 v[108:111], v[88:91], v[56:59], v[108:111]
    v_pk_fma_f32 v[138:139], v[190:191], v[22:23], v[138:139] op_sel_hi:[0,1,1] neg_lo:[1,0,0] neg_hi:[1,0,0]
    v_pk_fma_f32 v[140:141], v[190:191], v[24:25], v[140:141] op_sel_hi:[0,1,1] neg_lo:[1,0,0] neg_hi:[1,0,0]
    v_pk_fma_f32 v[142:143], v[190:191], v[26:27], v[142:143] op_sel_hi:[0,1,1] neg_lo:[1,0,0] neg_hi:[1,0,0]
    v_mfma_f32_16x16x32_bf16 v[120:123], v[88:91], v[60:63], v[120:123]
    v_cvt_pk_bf16_f32 v136, v136, v137
    v_cvt_pk_bf16_f32 v137, v138, v139
    ds_write_b64 v3, v[136:137] offset:19200
    v_mfma_f32_16x16x32_bf16 v[132:135], v[88:91], v[64:67], v[132:135]
    v_cvt_pk_bf16_f32 v140, v140, v141
    v_cvt_pk_bf16_f32 v141, v142, v143
    ds_write_b64 v3, v[140:141] offset:19328
    v_mfma_f32_16x16x32_bf16 v[144:147], v[88:91], v[68:71], v[144:147]
    s_mov_b32 s69, s68
    s_mov_b32 s70, 0x77777777
    s_mov_b32 s71, s70
    v_mfma_f32_16x16x32_bf16 v[156:159], v[88:91], v[72:75], v[156:159]
    v_pk_fma_f32 v[148:149], v[192:193], v[20:21], v[148:149] op_sel_hi:[0,1,1] neg_lo:[1,0,0] neg_hi:[1,0,0]
    v_pk_fma_f32 v[150:151], v[192:193], v[22:23], v[150:151] op_sel_hi:[0,1,1] neg_lo:[1,0,0] neg_hi:[1,0,0]
    v_pk_fma_f32 v[152:153], v[192:193], v[24:25], v[152:153] op_sel_hi:[0,1,1] neg_lo:[1,0,0] neg_hi:[1,0,0]
    v_mfma_f32_16x16x32_bf16 v[168:171], v[88:91], v[76:79], v[168:171]
    v_pk_fma_f32 v[154:155], v[192:193], v[26:27], v[154:155] op_sel_hi:[0,1,1] neg_lo:[1,0,0] neg_hi:[1,0,0]
    v_cvt_pk_bf16_f32 v148, v148, v149
    v_cvt_pk_bf16_f32 v149, v150, v151
    ds_write_b64 v3, v[148:149] offset:25600
    v_cvt_pk_bf16_f32 v152, v152, v153
    v_cvt_pk_bf16_f32 v153, v154, v155
    ds_write_b64 v3, v[152:153] offset:25728
    v_pk_fma_f32 v[160:161], v[194:195], v[20:21], v[160:161] op_sel_hi:[0,1,1] neg_lo:[1,0,0] neg_hi:[1,0,0]
    v_pk_fma_f32 v[162:163], v[194:195], v[22:23], v[162:163] op_sel_hi:[0,1,1] neg_lo:[1,0,0] neg_hi:[1,0,0]
    v_pk_fma_f32 v[164:165], v[194:195], v[24:25], v[164:165] op_sel_hi:[0,1,1] neg_lo:[1,0,0] neg_hi:[1,0,0]
    v_pk_fma_f32 v[166:167], v[194:195], v[26:27], v[166:167] op_sel_hi:[0,1,1] neg_lo:[1,0,0] neg_hi:[1,0,0]
    v_cvt_pk_bf16_f32 v160, v160, v161
    v_cvt_pk_bf16_f32 v161, v162, v163
    ds_write_b64 v3, v[160:161] offset:32000
    v_cvt_pk_bf16_f32 v164, v164, v165
    v_cvt_pk_bf16_f32 v165, v166, v167
    ds_write_b64 v3, v[164:165] offset:32128
    s_setprio 2
    s_branch AT_e2
AT_start:
    s_setprio 3
    ds_read_b32 v16, v208 offset:4
    ds_read2_b32 v[4:5], v209 offset0:0 offset1:2
    ds_read2_b32 v[6:7], v209 offset0:4 offset1:6
    ds_read2_b32 v[8:9], v209 offset0:8 offset1:10
    ds_read2_b32 v[10:11], v209 offset0:12 offset1:14
    ds_read2_b32 v[12:13], v209 offset0:16 offset1:18
    ds_read2_b32 v[14:15], v209 offset0:20 offset1:22
    s_mov_b32 s60, 0x07060503
    s_mov_b32 s61, 0x07060502
    s_mov_b32 s62, 0x07060501
    s_mov_b32 s63, 0x04000c0c
    s_mov_b32 s64, 0x0706000c
    s_mov_b32 s66, 0x11111111
    s_mov_b32 s67, s66
    s_mov_b32 s68, 0x33333333
    s_mov_b32 s69, s68
    s_mov_b32 s70, 0x77777777
    s_mov_b32 s71, s70
    v_mov_b32 v3, 0
AT_e2:
    s_waitcnt lgkmcnt(0)
    s_barrier
    s_cmp_lt_u32 s48, 6
    s_cbranch_scc1 AT_qk
    s_lshl_b32 s65, s48, 10
    s_add_u32 s65, s65, 8192
    v_subrev_u32 v98, 20480, v99
    s_mul_i32 s66, s51, 81920
    s_add_u32 m0, s65, 0
    s_nop 0
    buffer_load_dwordx4 v99, s[36:39], s66 offen lds
    s_add_u32 m0, s65, -2048
    s_nop 0
    buffer_load_dwordx4 v98, s[36:39], s66 offen lds
    s_add_u32 s66, s66, 40960
    s_add_u32 m0, s65, 4096
    s_nop 0
    buffer_load_dwordx4 v99, s[36:39], s66 offen lds
    s_add_u32 m0, s65, 2048
    s_nop 0
    buffer_load_dwordx4 v98, s[36:39], s66 offen lds
    s_add_u32 s66, s66, 40960
    s_cmp_eq_u32 s66, 819200
    s_cselect_b32 s66, 0, s66
    s_add_u32 m0, s65, 8192
    s_nop 0
    buffer_load_dwordx4 v99, s[36:39], s66 offen lds
    s_add_u32 m0, s65, 6144
    s_nop 0
    buffer_load_dwordx4 v98, s[36:39], s66 offen lds
    s_add_u32 s66, s66, 40960
    s_add_u32 m0, s65, 12288
    s_nop 0
    buffer_load_dwordx4 v99, s[36:39], s66 offen lds
    s_add_u32 m0, s65, 10240
    s_nop 0
    buffer_load_dwordx4 v98, s[36:39], s66 offen lds
    s_add_u32 s66, s66, 40960
    s_cmp_eq_u32 s66, 819200
    s_cselect_b32 s66, 0, s66
    s_add_u32 m0, s65, 16384
    s_nop 0
    buffer_load_dwordx4 v99, s[36:39], s66 offen lds
    s_add_u32 m0, s65, 14336
    s_nop 0
    buffer_load_dwordx4 v98, s[36:39], s66 offen lds
    s_add_u32 s66, s66, 40960
    s_add_u32 m0, s65, 20480
    s_nop 0
    buffer_load_dwordx4 v99, s[36:39], s66 offen lds
    s_add_u32 m0, s65, 18432
    s_nop 0
    buffer_load_dwordx4 v98, s[36:39], s66 offen lds
    buffer_load_dwordx4 v[232:235], v250, s[28:31], 0 offen offset:0
    buffer_load_dwordx4 v[236:239], v250, s[28:31], 0 offen offset:64
    ds_read_b64 v[240:241], v227 offset:0
    ds_read_b64 v[242:243], v227 offset:32
    ds_read_b64 v[244:245], v227 offset:64
    ds_read_b64 v[246:247], v227 offset:96
    ds_read_b32 v248, v251 offset:2288
    s_mov_b64 exec, 0
    s_cmp_eq_u32 s48, 6
    s_cbranch_scc1 HB0_0
    s_branch HB1_0
HB_ret:
    s_mov_b64 exec, -1
    s_mov_b32 s62, 1
    s_waitcnt vmcnt(0)
    v_mov_b32 v19, 1
    s_mov_b64 exec, 1
    ds_add_u32 v251, v19
    s_mov_b64 exec, -1
    s_branch B_start
AT_qk:
    ds_read_b64 v[20:21], v204
    ds_read_b64 v[30:31], v205 offset:0
    ds_read_b64 v[40:41], v205 offset:1600
    ds_read_b64 v[50:51], v205 offset:3200
    ds_read_b64 v[22:23], v229
    ds_read_b64 v[32:33], v205 offset:8
    ds_read_b64 v[42:43], v205 offset:1608
    ds_read_b64 v[52:53], v205 offset:3208
    ds_read_b64 v[24:25], v230
    ds_read_b64 v[34:35], v205 offset:16
    ds_read_b64 v[44:45], v205 offset:1616
    ds_read_b64 v[54:55], v205 offset:3216
    ds_read_b64 v[26:27], v231
    ds_read_b64 v[36:37], v205 offset:24
    ds_read_b64 v[46:47], v205 offset:1624
    ds_read_b64 v[56:57], v205 offset:3224
    ds_read_b64 v[28:29], v255
    ds_read_b64 v[38:39], v205 offset:32
    ds_read_b64 v[48:49], v205 offset:1632
    ds_read_b64 v[58:59], v205 offset:3232
    v_cndmask_b32 v13, v13, v5, s[66:67]
    v_cndmask_b32 v14, v14, v6, s[68:69]
    v_cndmask_b32 v15, v15, v7, s[70:71]
    v_mov_b32 v79, s54
    v_mov_b32 v83, s54
    v_mov_b32 v87, s54
    v_mov_b64 v[88:89], 0
    v_mov_b64 v[90:91], 0
    v_mov_b64 v[92:93], 0
    v_mov_b64 v[94:95], 0
    v_mul_f32 v16, 0x3ea52b5c, v16
    v_mul_f32 v148, v16, v8
    v_mul_f32 v149, v16, v9
    v_mul_f32 v150, v16, v10
    v_mul_f32 v151, v16, v11
    v_mul_f32 v152, v16, v12
    v_mul_f32 v153, v16, v13
    v_mul_f32 v154, v16, v14
    v_mul_f32 v155, v16, v15
    s_waitcnt lgkmcnt(15)
    v_mfma_f32_4x4x4_16b_bf16 v[60:63], v[30:31], v[20:21], 0
    v_mfma_f32_4x4x4_16b_bf16 v[64:67], v[40:41], v[20:21], 0
    v_mfma_f32_4x4x4_16b_bf16 v[68:71], v[50:51], v[20:21], 0
    s_waitcnt lgkmcnt(12)
    v_mfma_f32_4x4x4_16b_bf16 v[60:63], v[32:33], v[22:23], v[60:63]
    v_mfma_f32_4x4x4_16b_bf16 v[64:67], v[42:43], v[22:23], v[64:67]
    v_mfma_f32_4x4x4_16b_bf16 v[68:71], v[52:53], v[22:23], v[68:71]
    s_waitcnt lgkmcnt(8)
    v_mfma_f32_4x4x4_16b_bf16 v[60:63], v[34:35], v[24:25], v[60:63]
    v_mfma_f32_4x4x4_16b_bf16 v[64:67], v[44:45], v[24:25], v[64:67]
    v_mfma_f32_4x4x4_16b_bf16 v[68:71], v[54:55], v[24:25], v[68:71]
    s_waitcnt lgkmcnt(4)
    v_mfma_f32_4x4x4_16b_bf16 v[60:63], v[36:37], v[26:27], v[60:63]
    v_mfma_f32_4x4x4_16b_bf16 v[64:67], v[46:47], v[26:27], v[64:67]
    v_mfma_f32_4x4x4_16b_bf16 v[68:71], v[56:57], v[26:27], v[68:71]
    s_waitcnt lgkmcnt(0)
    v_mfma_f32_4x4x4_16b_bf16 v[60:63], v[38:39], v[28:29], v[60:63]
    v_mfma_f32_4x4x4_16b_bf16 v[64:67], v[48:49], v[28:29], v[64:67]
    v_mfma_f32_4x4x4_16b_bf16 v[68:71], v[58:59], v[28:29], v[68:71]
    s_cmp_lt_i32 s13, 8
    s_cbranch_scc1 AT_mask
AT_nomask:
    s_nop 2
    v_cndmask_b32 v69, v69, v61, s[66:67]
    v_cndmask_b32 v70, v70, v62, s[68:69]
    v_cndmask_b32 v71, v71, v63, s[70:71]
    v_mul_f32 v64, v64, v148
    v_mul_f32 v65, v65, v149
    v_mul_f32 v66, v66, v150
    v_mul_f32 v67, v67, v151
    v_mul_f32 v68, v68, v152
    v_mul_f32 v69, v69, v153
    v_mul_f32 v70, v70, v154
    v_mul_f32 v71, v71, v155
    v_perm_b32 v80, v64, v67, s60
    v_perm_b32 v81, v65, v67, s61
    v_perm_b32 v82, v66, v67, s62
    v_perm_b32 v84, v68, v71, s60
    v_perm_b32 v85, v69, v71, s61
    v_perm_b32 v86, v70, v71, s62
    s_mov_b64 exec, s[20:21]
    s_cmp_eq_u32 s49, 0
    s_cbranch_scc1 sts_1
    buffer_store_dwordx4 v[80:83], v213, s[24:27], s12 offen offset:0
    buffer_store_dwordx4 v[84:87], v213, s[24:27], s12 offen offset:512
std_2:
    s_mov_b64 exec, -1
    s_cmp_ge_u32 s48, 4
    s_cbranch_scc1 AT_vw
    v_mov_b32_dpp v196, v108 row_newbcast:0 row_mask:0xf bank_mask:0xf
    v_mov_b32_dpp v197, v109 row_newbcast:0 row_mask:0xf bank_mask:0xf
    v_mov_b32_dpp v198, v110 row_newbcast:0 row_mask:0xf bank_mask:0xf
    v_mov_b32_dpp v199, v111 row_newbcast:0 row_mask:0xf bank_mask:0xf
    v_pk_fma_f32 v[108:109], v[184:185], v[196:197], v[108:109] op_sel_hi:[0,1,1] neg_lo:[1,0,0] neg_hi:[1,0,0]
    v_pk_fma_f32 v[120:121], v[186:187], v[196:197], v[120:121] op_sel_hi:[0,1,1] neg_lo:[1,0,0] neg_hi:[1,0,0]
    v_pk_fma_f32 v[132:133], v[188:189], v[196:197], v[132:133] op_sel_hi:[0,1,1] neg_lo:[1,0,0] neg_hi:[1,0,0]
    v_pk_fma_f32 v[110:111], v[184:185], v[198:199], v[110:111] op_sel_hi:[0,1,1] neg_lo:[1,0,0] neg_hi:[1,0,0]
    v_pk_fma_f32 v[122:123], v[186:187], v[198:199], v[122:123] op_sel_hi:[0,1,1] neg_lo:[1,0,0] neg_hi:[1,0,0]
    v_pk_fma_f32 v[134:135], v[188:189], v[198:199], v[134:135] op_sel_hi:[0,1,1] neg_lo:[1,0,0] neg_hi:[1,0,0]
    v_cvt_pk_bf16_f32 v108, v108, v109
    v_cvt_pk_bf16_f32 v120, v120, v121
    v_cvt_pk_bf16_f32 v132, v132, v133
    v_cvt_pk_bf16_f32 v109, v110, v111
    v_cvt_pk_bf16_f32 v121, v122, v123
    v_cvt_pk_bf16_f32 v133, v134, v135
    ds_write_b64 v3, v[108:109] offset:256
    ds_write_b64 v3, v[120:121] offset:6656
    ds_write_b64 v3, v[132:133] offset:13056
    v_pk_fma_f32 v[144:145], v[190:191], v[196:197], v[144:145] op_sel_hi:[0,1,1] neg_lo:[1,0,0] neg_hi:[1,0,0]
    v_pk_fma_f32 v[156:157], v[192:193], v[196:197], v[156:157] op_sel_hi:[0,1,1] neg_lo:[1,0,0] neg_hi:[1,0,0]
    v_pk_fma_f32 v[168:169], v[194:195], v[196:197], v[168:169] op_sel_hi:[0,1,1] neg_lo:[1,0,0] neg_hi:[1,0,0]
    v_pk_fma_f32 v[146:147], v[190:191], v[198:199], v[146:147] op_sel_hi:[0,1,1] neg_lo:[1,0,0] neg_hi:[1,0,0]
    v_pk_fma_f32 v[158:159], v[192:193], v[198:199], v[158:159] op_sel_hi:[0,1,1] neg_lo:[1,0,0] neg_hi:[1,0,0]
    v_pk_fma_f32 v[170:171], v[194:195], v[198:199], v[170:171] op_sel_hi:[0,1,1] neg_lo:[1,0,0] neg_hi:[1,0,0]
    v_cvt_pk_bf16_f32 v144, v144, v145
    v_cvt_pk_bf16_f32 v156, v156, v157
    v_cvt_pk_bf16_f32 v168, v168, v169
    v_cvt_pk_bf16_f32 v145, v146, v147
    v_cvt_pk_bf16_f32 v157, v158, v159
    v_cvt_pk_bf16_f32 v169, v170, v171
    ds_write_b64 v3, v[144:145] offset:19456
    ds_write_b64 v3, v[156:157] offset:25856
    ds_write_b64 v3, v[168:169] offset:32256
    v_mov_b32 v19, 1
    s_mov_b64 exec, 1
    ds_add_u32 v251, v19 offset:8
    s_mov_b64 exec, -1
AT_vw:
    v_lshl_add_u32 v17, v201, 3, v251
    ds_read2_b64 v[156:159], v17 offset0:14 offset1:18
    ds_read2_b64 v[160:163], v17 offset0:22 offset1:26
    v_and_b32 v164, 2, v201
    v_lshl_add_u32 v164, v200, 2, v164
    s_lshl_b32 s65, s48, 6
    s_add_u32 s65, s65, s57
    s_mov_b64 exec, s[20:21]
AT_poll:
    buffer_load_dwordx4 v[88:91], v206, s[24:27], s22 offen offset:0 sc1
    buffer_load_dwordx4 v[92:95], v206, s[24:27], s22 offen offset:512 sc1
AT_pw:
    s_waitcnt vmcnt(0)
    v_cmp_ne_u32 vcc, s54, v91
    v_cmp_ne_u32 s[58:59], s54, v95
    s_or_b64 vcc, vcc, s[58:59]
    s_cbranch_vccz AT_got
    s_sub_u32 s3, s3, 1
    s_cbranch_scc0 AT_poll
    s_mov_b32 s3, 0
AT_got:
    s_mov_b64 exec, -1
    ds_read_b32 v17, v251 offset:8
    buffer_load_dwordx4 v[232:235], v250, s[28:31], 0 offen offset:0
    buffer_load_dwordx4 v[236:239], v250, s[28:31], 0 offen offset:64
    ds_read_b64 v[240:241], v227 offset:0
    ds_read_b64 v[242:243], v227 offset:32
    ds_read_b64 v[244:245], v227 offset:64
    ds_read_b64 v[246:247], v227 offset:96
    ds_read_b32 v248, v251 offset:2288
    v_perm_b32 v91, v88, v89, s63
    v_perm_b32 v95, v92, v93, s63
    v_perm_b32 v91, v91, v90, s64
    v_perm_b32 v95, v95, v94, s64
    v_add_f32 v64, v64, v88
    v_add_f32 v65, v65, v89
    v_add_f32 v66, v66, v90
    v_add_f32 v67, v67, v91
    v_add_f32 v68, v68, v92
    v_add_f32 v69, v69, v93
    v_add_f32 v70, v70, v94
    v_add_f32 v71, v71, v95
    v_max3_f32 v18, v64, v65, v66
    v_max3_f32 v19, v67, v68, v69
    v_max3_f32 v18, v18, v70, v71
    v_max_f32 v18, v18, v19
    v_sub_f32 v64, v64, v18
    v_sub_f32 v65, v65, v18
    v_sub_f32 v66, v66, v18
    v_sub_f32 v67, v67, v18
    v_sub_f32 v68, v68, v18
    v_sub_f32 v69, v69, v18
    v_sub_f32 v70, v70, v18
    v_sub_f32 v71, v71, v18
AT_vc:
    s_waitcnt lgkmcnt(0)
    v_cmp_ne_u32 vcc, 4, v17
    s_cbranch_vccnz AT_vs
AT_vg:
    ds_read_b64_tr_b16 v[100:101], v214 offset:0
    ds_read_b64_tr_b16 v[102:103], v214 offset:1600
    ds_read_b64_tr_b16 v[104:105], v214 offset:32
    ds_read_b64_tr_b16 v[106:107], v214 offset:1632
    ds_read_b64_tr_b16 v[108:109], v214 offset:64
    ds_read_b64_tr_b16 v[110:111], v214 offset:1664
    ds_read_b64_tr_b16 v[112:113], v214 offset:96
    ds_read_b64_tr_b16 v[114:115], v214 offset:1696
    v_exp_f32 v64, v64
    v_exp_f32 v65, v65
    v_exp_f32 v66, v66
    v_exp_f32 v67, v67
    v_exp_f32 v68, v68
    v_exp_f32 v69, v69
    v_exp_f32 v70, v70
    v_exp_f32 v71, v71
    v_add_f32 v20, v64, v65
    v_add_f32 v21, v66, v67
    v_add_f32 v22, v68, v69
    v_add_f32 v23, v70, v71
    v_add_f32 v20, v20, v21
    v_add_f32 v22, v22, v23
    v_add_f32 v20, v20, v22
    v_rcp_f32 v20, v20
    v_mul_f32 v64, v64, v8
    v_mul_f32 v65, v65, v9
    v_mul_f32 v66, v66, v10
    v_mul_f32 v67, v67, v11
    v_mul_f32 v68, v68, v12
    v_mul_f32 v69, v69, v13
    v_mul_f32 v70, v70, v14
    v_mul_f32 v71, v71, v15
    v_mul_f32 v64, v64, v20
    v_mul_f32 v65, v65, v20
    v_mul_f32 v66, v66, v20
    v_mul_f32 v67, v67, v20
    v_mul_f32 v68, v68, v20
    v_mul_f32 v69, v69, v20
    v_mul_f32 v70, v70, v20
    v_mul_f32 v71, v71, v20
    v_cvt_pk_bf16_f32 v24, v64, v65
    v_cvt_pk_bf16_f32 v25, v66, v67
    v_cvt_pk_bf16_f32 v26, v68, v69
    v_cvt_pk_bf16_f32 v27, v70, v71
    ds_write_b64 v210, v[24:25] offset:8
    v_and_b32 v28, v26, v207
    v_and_b32 v29, v27, v211
    ds_write_b64 v210, v[28:29]
    v_xor_b32 v26, v26, v28
    v_xor_b32 v27, v27, v29
    ds_write_b64 v210, v[26:27] offset:16
    ds_read_b128 v[116:119], v172
    ds_read_b128 v[120:123], v173
    ds_read_b128 v[124:127], v174
    ds_read_b128 v[128:131], v175
    ds_read_b128 v[132:135], v176
    ds_read_b128 v[136:139], v177
    ds_read_b128 v[140:143], v178
    ds_read_b128 v[144:147], v179
    s_cmp_lt_u32 s48, 4
    s_cbranch_scc1 AT_pv
    v_mov_b32 v19, 1
    s_mov_b64 exec, 1
    ds_add_u32 v251, v19
    s_mov_b64 exec, -1
AT_pv:
    s_waitcnt lgkmcnt(6)
    v_mfma_f32_16x16x32_bf16 v[20:23], v[100:103], v[116:119], 0
    v_mfma_f32_16x16x32_bf16 v[24:27], v[100:103], v[120:123], 0
    s_waitcnt lgkmcnt(4)
    v_mfma_f32_16x16x32_bf16 v[28:31], v[104:107], v[124:127], 0
    v_mfma_f32_16x16x32_bf16 v[32:35], v[104:107], v[128:131], 0
    s_waitcnt lgkmcnt(2)
    v_mfma_f32_16x16x32_bf16 v[36:39], v[108:111], v[132:135], 0
    v_mfma_f32_16x16x32_bf16 v[40:43], v[108:111], v[136:139], 0
    s_waitcnt lgkmcnt(0)
    v_mfma_f32_16x16x32_bf16 v[44:47], v[112:115], v[140:143], 0
    v_mfma_f32_16x16x32_bf16 v[48:51], v[112:115], v[144:147], 0
    v_cndmask_b32 v20, v20, v24, s[4:5]
    v_cndmask_b32 v21, v21, v25, s[4:5]
    v_cndmask_b32 v22, v22, v26, s[4:5]
    v_cndmask_b32 v23, v23, v27, s[4:5]
    v_cvt_pk_bf16_f32 v204, v20, v21
    v_cvt_pk_bf16_f32 v205, v22, v23
    v_cndmask_b32 v28, v28, v32, s[6:7]
    v_cndmask_b32 v29, v29, v33, s[6:7]
    v_cndmask_b32 v30, v30, v34, s[6:7]
    v_cndmask_b32 v31, v31, v35, s[6:7]
    v_cvt_pk_bf16_f32 v206, v28, v29
    v_cvt_pk_bf16_f32 v207, v30, v31
    v_cndmask_b32 v36, v36, v40, s[8:9]
    v_cndmask_b32 v37, v37, v41, s[8:9]
    v_cndmask_b32 v38, v38, v42, s[8:9]
    v_cndmask_b32 v39, v39, v43, s[8:9]
    v_cvt_pk_bf16_f32 v208, v36, v37
    v_cvt_pk_bf16_f32 v209, v38, v39
    v_cndmask_b32 v44, v44, v48, s[10:11]
    v_cndmask_b32 v45, v45, v49, s[10:11]
    v_cndmask_b32 v46, v46, v50, s[10:11]
    v_cndmask_b32 v47, v47, v51, s[10:11]
    v_cvt_pk_bf16_f32 v210, v44, v45
    v_cvt_pk_bf16_f32 v211, v46, v47
    s_cmp_eq_u32 s49, 0
    s_cbranch_scc1 sts_3
    buffer_store_dwordx4 v[204:207], v249, s[24:27], s22 offen offset:0
    buffer_store_dwordx4 v[208:211], v249, s[24:27], s22 offen offset:1024
std_4:
    s_mov_b64 exec, s[18:19]
    buffer_load_dword v18, v203, s[24:27], s17 offen sc1
    s_mov_b64 exec, -1
    v_dot2_f32_bf16 v20, v204, v156, 0
    v_dot2_f32_bf16 v21, v204, v204, 0
    v_dot2_f32_bf16 v20, v205, v157, v20
    v_dot2_f32_bf16 v21, v205, v205, v21
    v_dot2_f32_bf16 v20, v206, v158, v20
    v_dot2_f32_bf16 v21, v206, v206, v21
    v_dot2_f32_bf16 v20, v207, v159, v20
    v_dot2_f32_bf16 v21, v207, v207, v21
    v_dot2_f32_bf16 v20, v208, v160, v20
    v_dot2_f32_bf16 v21, v208, v208, v21
    v_dot2_f32_bf16 v20, v209, v161, v20
    v_dot2_f32_bf16 v21, v209, v209, v21
    v_dot2_f32_bf16 v20, v210, v162, v20
    v_dot2_f32_bf16 v21, v210, v210, v21
    v_dot2_f32_bf16 v20, v211, v163, v20
    v_dot2_f32_bf16 v21, v211, v211, v21
    s_nop 2
    v_permlane32_swap_b32 v20, v21
    v_add_f32 v20, v20, v21
    v_mov_b32 v21, v20
    s_nop 1
    v_permlane16_swap_b32 v20, v21
    s_mov_b32 exec_lo, 0xffff
    s_mov_b32 exec_hi, 0xffff
    v_add_f32 v20, v20, v21
    s_cmp_eq_u32 s49, 0
    s_cbranch_scc1 sts_5
    buffer_store_short_d16_hi v20, v164, s[24:27], s65 offen
std_6:
    s_mov_b64 exec, -1
    s_waitcnt vmcnt(1)
    s_mov_b64 exec, 1
    s_cmp_eq_u32 s49, 0
    s_cbranch_scc1 sts_7
    buffer_store_dword v79, v203, s[24:27], s23 offen
std_8:
    s_mov_b64 exec, -1
    v_cmp_ne_u32 vcc, s54, v18
    s_and_b32 s62, vcc_lo, s18
    s_cbranch_scc1 B_start
    s_add_u32 s14, s14, 2048
    s_cmp_eq_u32 s14, s15
    s_cselect_b32 s14, s1, s14
    buffer_load_dwordx4 v[168:171], v249, s[24:27], s14 offen offset:0 sc1
    buffer_load_dwordx4 v[172:175], v249, s[24:27], s14 offen offset:1024 sc1
    s_add_u32 s14, s14, 2048
    s_cmp_eq_u32 s14, s15
    s_cselect_b32 s14, s1, s14
    buffer_load_dwordx4 v[176:179], v249, s[24:27], s14 offen offset:0 sc1
    buffer_load_dwordx4 v[180:183], v249, s[24:27], s14 offen offset:1024 sc1
    s_add_u32 s14, s14, 2048
    s_cmp_eq_u32 s14, s15
    s_cselect_b32 s14, s1, s14
    buffer_load_dwordx4 v[212:215], v249, s[24:27], s14 offen offset:0 sc1
    buffer_load_dwordx4 v[12:15], v249, s[24:27], s14 offen offset:1024 sc1
B_start:
HB0_0:
    s_cbranch_execz HB0_1
    ds_read_b32 v19, v251
    v_permlane16_swap_b32 v232, v234
    v_permlane16_swap_b32 v233, v235
    v_permlane16_swap_b32 v236, v238
    v_permlane16_swap_b32 v237, v239
    v_lshlrev_b32 v184, 16, v232
    v_and_b32 v185, s47, v232
    v_lshlrev_b32 v186, 16, v233
    v_and_b32 v187, s47, v233
    v_lshlrev_b32 v188, 16, v234
    v_and_b32 v189, s47, v234
    v_lshlrev_b32 v190, 16, v235
    v_and_b32 v191, s47, v235
    v_lshlrev_b32 v192, 16, v236
    v_and_b32 v193, s47, v236
    v_lshlrev_b32 v194, 16, v237
    v_and_b32 v195, s47, v237
    v_lshlrev_b32 v196, 16, v238
    v_and_b32 v197, s47, v238
    v_lshlrev_b32 v198, 16, v239
    v_and_b32 v199, s47, v239
    v_cmp_gt_u32 vcc, 2048, v254
    s_mov_b64 s[4:5], vcc
    s_branch B_wc
B_ww:
    ds_read_b32 v19, v251
B_wc:
    s_waitcnt lgkmcnt(0)
    v_cmp_ne_u32 vcc, 4, v19
    s_cbranch_vccz B_wd
    s_sub_u32 s3, s3, 1
    s_cbranch_scc0 B_ww
    s_mov_b32 s3, 0
B_wd:
    s_setprio 0
    ds_read_b64_tr_b16 v[20:21], v216 offset:0
    ds_read_b64_tr_b16 v[22:23], v216 offset:2048
    ds_read_b64_tr_b16 v[24:25], v217 offset:0
    ds_read_b64_tr_b16 v[26:27], v217 offset:2048
    ds_read_b64_tr_b16 v[28:29], v218 offset:0
    ds_read_b64_tr_b16 v[30:31], v218 offset:2048
    ds_read_b64_tr_b16 v[32:33], v219 offset:0
    ds_read_b64_tr_b16 v[34:35], v219 offset:2048
    ds_read_b64_tr_b16 v[36:37], v216 offset:4096
    ds_read_b64_tr_b16 v[38:39], v216 offset:6144
    ds_read_b64_tr_b16 v[40:41], v217 offset:4096
    ds_read_b64_tr_b16 v[42:43], v217 offset:6144
    ds_read_b64_tr_b16 v[44:45], v218 offset:4096
HB0_1:
    s_cbranch_execz HB0_2
    ds_read_b64_tr_b16 v[46:47], v218 offset:6144
    ds_read_b64_tr_b16 v[48:49], v219 offset:4096
    ds_read_b64_tr_b16 v[50:51], v219 offset:6144
    ds_read_b64_tr_b16 v[52:53], v216 offset:8192
    ds_read_b64_tr_b16 v[54:55], v216 offset:10240
    ds_read_b64_tr_b16 v[56:57], v217 offset:8192
    ds_read_b64_tr_b16 v[58:59], v217 offset:10240
    ds_read_b64_tr_b16 v[60:61], v218 offset:8192
    ds_read_b64_tr_b16 v[62:63], v218 offset:10240
    ds_read_b64_tr_b16 v[64:65], v219 offset:8192
    ds_read_b64_tr_b16 v[66:67], v219 offset:10240
    ds_read_b64_tr_b16 v[68:69], v216 offset:12288
    ds_read_b64_tr_b16 v[70:71], v216 offset:14336
    ds_read_b64_tr_b16 v[72:73], v217 offset:12288
    ds_read_b64_tr_b16 v[74:75], v217 offset:14336
    ds_read_b64_tr_b16 v[76:77], v218 offset:12288
    ds_read_b64_tr_b16 v[78:79], v218 offset:14336
    ds_read_b64_tr_b16 v[80:81], v219 offset:12288
    ds_read_b64_tr_b16 v[82:83], v219 offset:14336
    s_cmp_eq_u32 s62, 0
    s_cbranch_scc1 B_nap
    s_mov_b64 exec, s[18:19]
    buffer_load_dword v18, v203, s[24:27], s17 offen sc1
    s_mov_b64 exec, -1
B_nap:
    ds_read_b64_tr_b16 v[84:85], v216 offset:16384
    ds_read_b64_tr_b16 v[86:87], v216 offset:18432
    ds_read_b64_tr_b16 v[88:89], v217 offset:16384
    ds_read_b64_tr_b16 v[90:91], v217 offset:18432
    ds_read_b64_tr_b16 v[92:93], v218 offset:16384
    ds_read_b64_tr_b16 v[94:95], v218 offset:18432
    ds_read_b64_tr_b16 v[96:97], v219 offset:16384
    ds_read_b64_tr_b16 v[98:99], v219 offset:18432
    ds_read_b64_tr_b16 v[100:101], v216 offset:20480
    ds_read_b64_tr_b16 v[102:103], v216 offset:22528
HB0_2:
    s_cbranch_execz HB0_3
    ds_read_b64_tr_b16 v[104:105], v217 offset:20480
    ds_read_b64_tr_b16 v[106:107], v217 offset:22528
    ds_read_b64_tr_b16 v[108:109], v218 offset:20480
    ds_read_b64_tr_b16 v[110:111], v218 offset:22528
    ds_read_b64_tr_b16 v[112:113], v219 offset:20480
    ds_read_b64_tr_b16 v[114:115], v219 offset:22528
    ds_read_b64_tr_b16 v[116:117], v216 offset:24576
    ds_read_b64_tr_b16 v[118:119], v216 offset:26624
    ds_read_b64_tr_b16 v[120:121], v217 offset:24576
    ds_read_b64_tr_b16 v[122:123], v217 offset:26624
    ds_read_b64_tr_b16 v[124:125], v218 offset:24576
    ds_read_b64_tr_b16 v[126:127], v218 offset:26624
    ds_read_b64_tr_b16 v[128:129], v219 offset:24576
    ds_read_b64_tr_b16 v[130:131], v219 offset:26624
    s_cmp_ge_u32 s48, 6
    s_cbranch_scc1 B_no
    s_waitcnt lgkmcnt(0)
    v_mfma_f32_16x16x32_bf16 v[184:187], v[20:23], v[204:207], v[184:187]
    v_mfma_f32_16x16x32_bf16 v[188:191], v[24:27], v[204:207], v[188:191]
    v_mfma_f32_16x16x32_bf16 v[192:195], v[28:31], v[204:207], v[192:195]
    v_mfma_f32_16x16x32_bf16 v[196:199], v[32:35], v[204:207], v[196:199]
    s_waitcnt lgkmcnt(0)
    v_mfma_f32_16x16x32_bf16 v[184:187], v[36:39], v[208:211], v[184:187]
    v_mfma_f32_16x16x32_bf16 v[188:191], v[40:43], v[208:211], v[188:191]
    v_mfma_f32_16x16x32_bf16 v[192:195], v[44:47], v[208:211], v[192:195]
    v_mfma_f32_16x16x32_bf16 v[196:199], v[48:51], v[208:211], v[196:199]
    s_branch B_n2
B_rds:
    ds_read_b64_tr_b16 v[132:133], v216 offset:28672
    ds_read_b64_tr_b16 v[134:135], v216 offset:30720
    ds_read_b64_tr_b16 v[136:137], v217 offset:28672
    ds_read_b64_tr_b16 v[138:139], v217 offset:30720
    ds_read_b64_tr_b16 v[140:141], v218 offset:28672
    ds_read_b64_tr_b16 v[142:143], v218 offset:30720
    ds_read_b64_tr_b16 v[144:145], v219 offset:28672
HB0_3:
    s_cbranch_execz HB0_4
    ds_read_b64_tr_b16 v[146:147], v219 offset:30720
    ds_read_b64_tr_b16 v[148:149], v216 offset:32768
    ds_read_b64_tr_b16 v[150:151], v216 offset:34816
    ds_read_b64_tr_b16 v[152:153], v217 offset:32768
    ds_read_b64_tr_b16 v[154:155], v217 offset:34816
    ds_read_b64_tr_b16 v[156:157], v218 offset:32768
    ds_read_b64_tr_b16 v[158:159], v218 offset:34816
    ds_read_b64_tr_b16 v[160:161], v219 offset:32768
    ds_read_b64_tr_b16 v[162:163], v219 offset:34816
    ds_read_b64_tr_b16 v[20:21], v216 offset:36864
    ds_read_b64_tr_b16 v[22:23], v216 offset:38912
    ds_read_b64_tr_b16 v[24:25], v217 offset:36864
    ds_read_b64_tr_b16 v[26:27], v217 offset:38912
    ds_read_b64_tr_b16 v[28:29], v218 offset:36864
    ds_read_b64_tr_b16 v[30:31], v218 offset:38912
    ds_read_b64_tr_b16 v[32:33], v219 offset:36864
    ds_read_b64_tr_b16 v[34:35], v219 offset:38912
    ds_read_b64_tr_b16 v[36:37], v220 offset:0
    ds_read_b64_tr_b16 v[38:39], v220 offset:2048
    ds_read_b64_tr_b16 v[40:41], v221 offset:0
    ds_read_b64_tr_b16 v[42:43], v221 offset:2048
    ds_read_b64_tr_b16 v[44:45], v222 offset:0
    ds_read_b64_tr_b16 v[46:47], v222 offset:2048
    ds_read_b64_tr_b16 v[48:49], v223 offset:0
    ds_read_b64_tr_b16 v[50:51], v223 offset:2048
    s_setpc_b64 s[98:99]
B_no:
    s_call_b64 s[98:99], B_rds
    v_mul_u32_u24 v4, 12, v0
    s_add_u32 s58, s100, 512
    s_add_u32 s59, s100, 24832
    s_add_u32 s60, s100, 49152
    s_add_u32 s12, s100, 73472
    s_add_u32 s13, s100, 97792
HB0_4:
    s_cbranch_execz HB0_5
    v_and_b32 v5, 31, v0
    v_mul_u32_u24 v5, 3, v5
    s_mul_i32 s64, s53, 96
    s_sub_u32 s65, 1014, s55
    v_mov_b32 v6, 0xfffff000
    v_add_u32 v7, -10, v5
    v_cmp_gt_u32 vcc, s65, v7
    v_add3_u32 v7, v5, s64, 0
    s_nop 0
    v_cndmask_b32 v8, 0, v7, vcc
    v_cndmask_b32 v204, 0, v6, vcc
    v_add_u32 v7, -9, v5
    v_cmp_gt_u32 vcc, s65, v7
    v_add3_u32 v7, v5, s64, 1
    s_nop 0
    v_cndmask_b32 v9, 0, v7, vcc
    v_cndmask_b32 v205, 0, v6, vcc
    v_add_u32 v7, -8, v5
    v_cmp_gt_u32 vcc, s65, v7
    v_add3_u32 v7, v5, s64, 2
    s_nop 0
    v_cndmask_b32 v10, 0, v7, vcc
    v_cndmask_b32 v206, 0, v6, vcc
    v_mov_b32 v7, s54
    v_lshlrev_b32 v11, 11, v200
    s_setprio 2
B_n2:
    s_cmp_eq_u32 s62, 0
    s_cbranch_scc1 B_run
    s_mov_b64 exec, s[18:19]
    s_branch B_pw
B_poll:
    buffer_load_dword v18, v203, s[24:27], s17 offen sc1
B_pw:
    s_waitcnt vmcnt(0)
    v_cmp_ne_u32 vcc, s54, v18
    s_cbranch_vccz B_go
    s_sub_u32 s3, s3, 1
    s_cbranch_scc0 B_poll
    s_mov_b32 s3, 0
B_go:
    s_mov_b64 exec, -1
    s_add_u32 s14, s14, 2048
    s_cmp_eq_u32 s14, s15
    s_cselect_b32 s14, s1, s14
    buffer_load_dwordx4 v[168:171], v249, s[24:27], s14 offen offset:0 sc1
    buffer_load_dwordx4 v[172:175], v249, s[24:27], s14 offen offset:1024 sc1
    s_add_u32 s14, s14, 2048
    s_cmp_eq_u32 s14, s15
    s_cselect_b32 s14, s1, s14
    buffer_load_dwordx4 v[176:179], v249, s[24:27], s14 offen offset:0 sc1
    buffer_load_dwordx4 v[180:183], v249, s[24:27], s14 offen offset:1024 sc1
    s_add_u32 s14, s14, 2048
HB0_5:
    s_cbranch_execz HB0_6
    s_cmp_eq_u32 s14, s15
    s_cselect_b32 s14, s1, s14
    buffer_load_dwordx4 v[212:215], v249, s[24:27], s14 offen offset:0 sc1
    buffer_load_dwordx4 v[12:15], v249, s[24:27], s14 offen offset:1024 sc1
B_run:
    s_cmp_ge_u32 s48, 6
    s_cbranch_scc1 B_half
    s_call_b64 s[98:99], B_rds
    s_cmp_ge_u32 s48, 4
    s_cbranch_scc1 B_half
    s_setprio 1
    s_waitcnt vmcnt(5) lgkmcnt(15)
    v_mfma_f32_16x16x32_bf16 v[184:187], v[52:55], v[168:171], v[184:187]
    v_mfma_f32_16x16x32_bf16 v[188:191], v[56:59], v[168:171], v[188:191]
    ds_read_b64_tr_b16 v[52:53], v220 offset:4096
    v_mfma_f32_16x16x32_bf16 v[192:195], v[60:63], v[168:171], v[192:195]
    ds_read_b64_tr_b16 v[54:55], v220 offset:6144
    v_mfma_f32_16x16x32_bf16 v[196:199], v[64:67], v[168:171], v[196:199]
    s_add_u32 s14, s14, 2048
    s_cmp_eq_u32 s14, s15
    s_cselect_b32 s14, s1, s14
    buffer_load_dwordx4 v[164:167], v249, s[24:27], s14 offen offset:0 sc1
    ds_read_b64_tr_b16 v[56:57], v221 offset:4096
    s_waitcnt vmcnt(5) lgkmcnt(15)
    v_mfma_f32_16x16x32_bf16 v[184:187], v[68:71], v[172:175], v[184:187]
    ds_read_b64_tr_b16 v[58:59], v221 offset:6144
    ds_read_b64_tr_b16 v[60:61], v222 offset:4096
    v_mfma_f32_16x16x32_bf16 v[188:191], v[72:75], v[172:175], v[188:191]
    ds_read_b64_tr_b16 v[62:63], v222 offset:6144
    v_mfma_f32_16x16x32_bf16 v[192:195], v[76:79], v[172:175], v[192:195]
    ds_read_b64_tr_b16 v[64:65], v223 offset:4096
    v_mfma_f32_16x16x32_bf16 v[196:199], v[80:83], v[172:175], v[196:199]
    buffer_load_dwordx4 v[232:235], v249, s[24:27], s14 offen offset:1024 sc1
    ds_read_b64_tr_b16 v[66:67], v223 offset:6144
    s_waitcnt vmcnt(5) lgkmcnt(15)
    v_mfma_f32_16x16x32_bf16 v[184:187], v[84:87], v[176:179], v[184:187]
    ds_read_b64_tr_b16 v[68:69], v220 offset:8192
    ds_read_b64_tr_b16 v[70:71], v220 offset:10240
    v_mfma_f32_16x16x32_bf16 v[188:191], v[88:91], v[176:179], v[188:191]
HB0_6:
    s_cbranch_execz HB0_7
    ds_read_b64_tr_b16 v[72:73], v221 offset:8192
    v_mfma_f32_16x16x32_bf16 v[192:195], v[92:95], v[176:179], v[192:195]
    ds_read_b64_tr_b16 v[74:75], v221 offset:10240
    v_mfma_f32_16x16x32_bf16 v[196:199], v[96:99], v[176:179], v[196:199]
    s_mov_b32 s14, s16
    buffer_load_dwordx4 v[236:239], v249, s[24:27], s14 offen offset:0 sc1
    ds_read_b64_tr_b16 v[76:77], v222 offset:8192
    s_waitcnt vmcnt(5) lgkmcnt(15)
    v_mfma_f32_16x16x32_bf16 v[184:187], v[100:103], v[180:183], v[184:187]
    ds_read_b64_tr_b16 v[78:79], v222 offset:10240
    ds_read_b64_tr_b16 v[80:81], v223 offset:8192
    v_mfma_f32_16x16x32_bf16 v[188:191], v[104:107], v[180:183], v[188:191]
    ds_read_b64_tr_b16 v[82:83], v223 offset:10240
    v_mfma_f32_16x16x32_bf16 v[192:195], v[108:111], v[180:183], v[192:195]
    ds_read_b64_tr_b16 v[84:85], v220 offset:12288
    v_mfma_f32_16x16x32_bf16 v[196:199], v[112:115], v[180:183], v[196:199]
    buffer_load_dwordx4 v[168:171], v249, s[24:27], s14 offen offset:1024 sc1
    ds_read_b64_tr_b16 v[86:87], v220 offset:14336
    s_waitcnt vmcnt(5) lgkmcnt(15)
    v_mfma_f32_16x16x32_bf16 v[184:187], v[116:119], v[212:215], v[184:187]
    ds_read_b64_tr_b16 v[88:89], v221 offset:12288
    ds_read_b64_tr_b16 v[90:91], v221 offset:14336
    v_mfma_f32_16x16x32_bf16 v[188:191], v[120:123], v[212:215], v[188:191]
    ds_read_b64_tr_b16 v[92:93], v222 offset:12288
    v_mfma_f32_16x16x32_bf16 v[192:195], v[124:127], v[212:215], v[192:195]
    ds_read_b64_tr_b16 v[94:95], v222 offset:14336
    v_mfma_f32_16x16x32_bf16 v[196:199], v[128:131], v[212:215], v[196:199]
    s_add_u32 s14, s14, 2048
    s_cmp_eq_u32 s14, s15
    s_cselect_b32 s14, s1, s14
    buffer_load_dwordx4 v[172:175], v249, s[24:27], s14 offen offset:0 sc1
    ds_read_b64_tr_b16 v[96:97], v223 offset:12288
    s_waitcnt vmcnt(5) lgkmcnt(15)
    v_mfma_f32_16x16x32_bf16 v[184:187], v[132:135], v[12:15], v[184:187]
HB0_7:
    s_cbranch_execz HB0_8
    ds_read_b64_tr_b16 v[98:99], v223 offset:14336
    ds_read_b64_tr_b16 v[100:101], v220 offset:16384
    v_mfma_f32_16x16x32_bf16 v[188:191], v[136:139], v[12:15], v[188:191]
    ds_read_b64_tr_b16 v[102:103], v220 offset:18432
    v_mfma_f32_16x16x32_bf16 v[192:195], v[140:143], v[12:15], v[192:195]
    ds_read_b64_tr_b16 v[104:105], v221 offset:16384
    v_mfma_f32_16x16x32_bf16 v[196:199], v[144:147], v[12:15], v[196:199]
    buffer_load_dwordx4 v[176:179], v249, s[24:27], s14 offen offset:1024 sc1
    ds_read_b64_tr_b16 v[106:107], v221 offset:18432
    s_waitcnt vmcnt(5) lgkmcnt(15)
    v_mfma_f32_16x16x32_bf16 v[184:187], v[148:151], v[164:167], v[184:187]
    ds_read_b64_tr_b16 v[108:109], v222 offset:16384
    ds_read_b64_tr_b16 v[110:111], v222 offset:18432
    v_mfma_f32_16x16x32_bf16 v[188:191], v[152:155], v[164:167], v[188:191]
    ds_read_b64_tr_b16 v[112:113], v223 offset:16384
    v_mfma_f32_16x16x32_bf16 v[192:195], v[156:159], v[164:167], v[192:195]
    ds_read_b64_tr_b16 v[114:115], v223 offset:18432
    v_mfma_f32_16x16x32_bf16 v[196:199], v[160:163], v[164:167], v[196:199]
    s_add_u32 s14, s14, 2048
    s_cmp_eq_u32 s14, s15
    s_cselect_b32 s14, s1, s14
    buffer_load_dwordx4 v[180:183], v249, s[24:27], s14 offen offset:0 sc1
    ds_read_b64_tr_b16 v[116:117], v220 offset:20480
    s_waitcnt vmcnt(5) lgkmcnt(15)
    v_mfma_f32_16x16x32_bf16 v[184:187], v[20:23], v[232:235], v[184:187]
    ds_read_b64_tr_b16 v[118:119], v220 offset:22528
    ds_read_b64_tr_b16 v[120:121], v221 offset:20480
    v_mfma_f32_16x16x32_bf16 v[188:191], v[24:27], v[232:235], v[188:191]
    ds_read_b64_tr_b16 v[122:123], v221 offset:22528
    v_mfma_f32_16x16x32_bf16 v[192:195], v[28:31], v[232:235], v[192:195]
    ds_read_b64_tr_b16 v[124:125], v222 offset:20480
    v_mfma_f32_16x16x32_bf16 v[196:199], v[32:35], v[232:235], v[196:199]
    buffer_load_dwordx4 v[212:215], v249, s[24:27], s14 offen offset:1024 sc1
    ds_read_b64_tr_b16 v[126:127], v222 offset:22528
HB0_8:
    s_cbranch_execz HB0_9
    s_waitcnt vmcnt(5) lgkmcnt(15)
    v_mfma_f32_16x16x32_bf16 v[184:187], v[36:39], v[236:239], v[184:187]
    ds_read_b64_tr_b16 v[128:129], v223 offset:20480
    ds_read_b64_tr_b16 v[130:131], v223 offset:22528
    v_mfma_f32_16x16x32_bf16 v[188:191], v[40:43], v[236:239], v[188:191]
    ds_read_b64_tr_b16 v[132:133], v220 offset:24576
    v_mfma_f32_16x16x32_bf16 v[192:195], v[44:47], v[236:239], v[192:195]
    ds_read_b64_tr_b16 v[134:135], v220 offset:26624
    v_mfma_f32_16x16x32_bf16 v[196:199], v[48:51], v[236:239], v[196:199]
    s_add_u32 s14, s14, 2048
    s_cmp_eq_u32 s14, s15
    s_cselect_b32 s14, s1, s14
    buffer_load_dwordx4 v[12:15], v249, s[24:27], s14 offen offset:0 sc1
    ds_read_b64_tr_b16 v[136:137], v221 offset:24576
    s_waitcnt vmcnt(5) lgkmcnt(15)
    v_mfma_f32_16x16x32_bf16 v[184:187], v[52:55], v[168:171], v[184:187]
    ds_read_b64_tr_b16 v[138:139], v221 offset:26624
    ds_read_b64_tr_b16 v[140:141], v222 offset:24576
    v_mfma_f32_16x16x32_bf16 v[188:191], v[56:59], v[168:171], v[188:191]
    ds_read_b64_tr_b16 v[142:143], v222 offset:26624
    v_mfma_f32_16x16x32_bf16 v[192:195], v[60:63], v[168:171], v[192:195]
    ds_read_b64_tr_b16 v[144:145], v223 offset:24576
    v_mfma_f32_16x16x32_bf16 v[196:199], v[64:67], v[168:171], v[196:199]
    buffer_load_dwordx4 v[164:167], v249, s[24:27], s14 offen offset:1024 sc1
    ds_read_b64_tr_b16 v[146:147], v223 offset:26624
    s_waitcnt vmcnt(5) lgkmcnt(15)
    v_mfma_f32_16x16x32_bf16 v[184:187], v[68:71], v[172:175], v[184:187]
    ds_read_b64_tr_b16 v[148:149], v220 offset:28672
    ds_read_b64_tr_b16 v[150:151], v220 offset:30720
    v_mfma_f32_16x16x32_bf16 v[188:191], v[72:75], v[172:175], v[188:191]
    ds_read_b64_tr_b16 v[152:153], v221 offset:28672
    v_mfma_f32_16x16x32_bf16 v[192:195], v[76:79], v[172:175], v[192:195]
    ds_read_b64_tr_b16 v[154:155], v221 offset:30720
    v_mfma_f32_16x16x32_bf16 v[196:199], v[80:83], v[172:175], v[196:199]
HB0_9:
    s_cbranch_execz HB0_10
    s_add_u32 s14, s14, 2048
    s_cmp_eq_u32 s14, s15
    s_cselect_b32 s14, s1, s14
    buffer_load_dwordx4 v[232:235], v249, s[24:27], s14 offen offset:0 sc1
    ds_read_b64_tr_b16 v[156:157], v222 offset:28672
    s_waitcnt vmcnt(5) lgkmcnt(15)
    v_mfma_f32_16x16x32_bf16 v[184:187], v[84:87], v[176:179], v[184:187]
    ds_read_b64_tr_b16 v[158:159], v222 offset:30720
    ds_read_b64_tr_b16 v[160:161], v223 offset:28672
    v_mfma_f32_16x16x32_bf16 v[188:191], v[88:91], v[176:179], v[188:191]
    ds_read_b64_tr_b16 v[162:163], v223 offset:30720
    v_mfma_f32_16x16x32_bf16 v[192:195], v[92:95], v[176:179], v[192:195]
    ds_read_b64_tr_b16 v[20:21], v220 offset:32768
    v_mfma_f32_16x16x32_bf16 v[196:199], v[96:99], v[176:179], v[196:199]
    buffer_load_dwordx4 v[236:239], v249, s[24:27], s14 offen offset:1024 sc1
    ds_read_b64_tr_b16 v[22:23], v220 offset:34816
    s_waitcnt vmcnt(5) lgkmcnt(15)
    v_mfma_f32_16x16x32_bf16 v[184:187], v[100:103], v[180:183], v[184:187]
    ds_read_b64_tr_b16 v[24:25], v221 offset:32768
    ds_read_b64_tr_b16 v[26:27], v221 offset:34816
    v_mfma_f32_16x16x32_bf16 v[188:191], v[104:107], v[180:183], v[188:191]
    ds_read_b64_tr_b16 v[28:29], v222 offset:32768
    v_mfma_f32_16x16x32_bf16 v[192:195], v[108:111], v[180:183], v[192:195]
    ds_read_b64_tr_b16 v[30:31], v222 offset:34816
    v_mfma_f32_16x16x32_bf16 v[196:199], v[112:115], v[180:183], v[196:199]
    ds_read_b64_tr_b16 v[32:33], v223 offset:32768
    s_waitcnt vmcnt(4) lgkmcnt(15)
    v_mfma_f32_16x16x32_bf16 v[184:187], v[116:119], v[212:215], v[184:187]
    ds_read_b64_tr_b16 v[34:35], v223 offset:34816
    ds_read_b64_tr_b16 v[36:37], v220 offset:36864
    v_mfma_f32_16x16x32_bf16 v[188:191], v[120:123], v[212:215], v[188:191]
    ds_read_b64_tr_b16 v[38:39], v220 offset:38912
    v_mfma_f32_16x16x32_bf16 v[192:195], v[124:127], v[212:215], v[192:195]
    ds_read_b64_tr_b16 v[40:41], v221 offset:36864
HB0_10:
    s_cbranch_execz HB_ret
    v_mfma_f32_16x16x32_bf16 v[196:199], v[128:131], v[212:215], v[196:199]
    ds_read_b64_tr_b16 v[42:43], v221 offset:38912
    s_waitcnt vmcnt(3) lgkmcnt(15)
    v_mfma_f32_16x16x32_bf16 v[184:187], v[132:135], v[12:15], v[184:187]
    ds_read_b64_tr_b16 v[44:45], v222 offset:36864
    ds_read_b64_tr_b16 v[46:47], v222 offset:38912
    v_mfma_f32_16x16x32_bf16 v[188:191], v[136:139], v[12:15], v[188:191]
    ds_read_b64_tr_b16 v[48:49], v223 offset:36864
    v_mfma_f32_16x16x32_bf16 v[192:195], v[140:143], v[12:15], v[192:195]
    ds_read_b64_tr_b16 v[50:51], v223 offset:38912
    v_mfma_f32_16x16x32_bf16 v[196:199], v[144:147], v[12:15], v[196:199]
    s_waitcnt vmcnt(2) lgkmcnt(15)
    v_mfma_f32_16x16x32_bf16 v[184:187], v[148:151], v[164:167], v[184:187]
    v_mfma_f32_16x16x32_bf16 v[188:191], v[152:155], v[164:167], v[188:191]
    v_mfma_f32_16x16x32_bf16 v[192:195], v[156:159], v[164:167], v[192:195]
    v_mfma_f32_16x16x32_bf16 v[196:199], v[160:163], v[164:167], v[196:199]
    ds_read_b32 v10, v251 offset:4
    s_waitcnt vmcnt(1) lgkmcnt(9)
    v_mfma_f32_16x16x32_bf16 v[184:187], v[20:23], v[232:235], v[184:187]
    v_mfma_f32_16x16x32_bf16 v[188:191], v[24:27], v[232:235], v[188:191]
    v_mfma_f32_16x16x32_bf16 v[192:195], v[28:31], v[232:235], v[192:195]
    v_mfma_f32_16x16x32_bf16 v[196:199], v[32:35], v[232:235], v[196:199]
    s_waitcnt vmcnt(0) lgkmcnt(1)
    v_mfma_f32_16x16x32_bf16 v[184:187], v[36:39], v[236:239], v[184:187]
    v_mfma_f32_16x16x32_bf16 v[188:191], v[40:43], v[236:239], v[188:191]
    v_mfma_f32_16x16x32_bf16 v[192:195], v[44:47], v[236:239], v[192:195]
    v_mfma_f32_16x16x32_bf16 v[196:199], v[48:51], v[236:239], v[196:199]
    s_branch B_epi
B_half:
    s_add_u32 s14, s14, 2048
    s_cmp_eq_u32 s14, s15
    s_cselect_b32 s14, s1, s14
    buffer_load_dwordx4 v[164:167], v249, s[24:27], s14 offen offset:0 sc1
    buffer_load_dwordx4 v[232:235], v249, s[24:27], s14 offen offset:1024 sc1
    s_mov_b32 s14, s16
    buffer_load_dwordx4 v[236:239], v249, s[24:27], s14 offen offset:0 sc1
HB1_0:
    s_cbranch_execz HB1_1
    s_cmp_lg_u32 s48, 6
    s_cbranch_scc1 E_end
    s_setprio 3
E_poll:
    s_mov_b32 exec_hi, 0x0fffffff
    buffer_load_dword v17, v203, s[24:27], s100 offen sc1
    s_mov_b32 exec_hi, -1
    buffer_load_dwordx3 v[224:226], v4, s[24:27], s58 offen sc1
    buffer_load_dwordx3 v[228:230], v4, s[24:27], s59 offen sc1
    buffer_load_dwordx3 v[240:242], v4, s[24:27], s60 offen sc1
    buffer_load_dwordx3 v[244:246], v4, s[24:27], s12 offen sc1
    buffer_load_dwordx3 v[208:210], v4, s[24:27], s13 offen sc1
E_chk:
    s_waitcnt vmcnt(5)
    v_cmp_ne_u32 vcc, s54, v17
    s_lshl_b64 vcc, vcc, 4
    s_cbranch_scc0 E_go
    s_sleep 1
    s_sub_u32 s3, s3, 1
    s_cbranch_scc0 E_poll
    s_mov_b32 s3, 0
E_go:
    s_waitcnt vmcnt(4)
    s_waitcnt vmcnt(3)
    v_add_f32 v252, v224, v228
    v_add_f32 v253, v225, v229
    v_add_f32 v254, v226, v230
    v_lshlrev_b32 v224, 16, v224
    v_lshlrev_b32 v225, 16, v225
    v_lshlrev_b32 v226, 16, v226
    v_lshlrev_b32 v228, 16, v228
    v_lshlrev_b32 v229, 16, v229
    v_lshlrev_b32 v230, 16, v230
    v_add_f32 v224, v224, v228
    v_add_f32 v225, v225, v229
    v_add_f32 v226, v226, v230
    s_waitcnt vmcnt(2)
    v_add_f32 v252, v252, v240
    v_add_f32 v253, v253, v241
    v_add_f32 v254, v254, v242
    v_lshlrev_b32 v240, 16, v240
    v_lshlrev_b32 v241, 16, v241
    v_lshlrev_b32 v242, 16, v242
    v_add_f32 v224, v224, v240
    v_add_f32 v225, v225, v241
    v_add_f32 v226, v226, v242
    s_waitcnt vmcnt(1)
    v_add_f32 v252, v252, v244
    v_add_f32 v253, v253, v245
    v_add_f32 v254, v254, v246
    v_lshlrev_b32 v244, 16, v244
    v_lshlrev_b32 v245, 16, v245
    v_lshlrev_b32 v246, 16, v246
    v_add_f32 v224, v224, v244
    v_add_f32 v225, v225, v245
    v_add_f32 v226, v226, v246
    s_waitcnt vmcnt(0)
    v_add_f32 v252, v252, v208
    v_add_f32 v253, v253, v209
HB1_1:
    s_cbranch_execz HB1_2
    v_add_f32 v254, v254, v210
    v_lshlrev_b32 v208, 16, v208
    v_lshlrev_b32 v209, 16, v209
    v_lshlrev_b32 v210, 16, v210
    v_add_f32 v224, v224, v208
    v_add_f32 v225, v225, v209
    v_add_f32 v226, v226, v210
    v_permlane32_swap_b32 v224, v252
    v_permlane32_swap_b32 v225, v253
    v_permlane32_swap_b32 v226, v254
    v_add_f32 v224, v224, v252
    v_add_f32 v225, v225, v253
    v_add_f32 v226, v226, v254
    v_rsq_f32 v252, v224
    v_rsq_f32 v253, v225
    v_rsq_f32 v254, v226
    v_permlane32_swap_b32 v252, v228
    v_permlane32_swap_b32 v253, v229
    v_permlane32_swap_b32 v254, v230
    v_mul_f32 v224, v224, v228
    v_mul_f32 v225, v225, v229
    v_mul_f32 v226, v226, v230
    v_and_or_b32 v252, v224, v204, v8
    v_and_or_b32 v253, v225, v205, v9
    v_and_or_b32 v254, v226, v206, v10
    v_max3_i32 v6, v252, v253, v254
    s_nop 1
    v_max_i32_dpp v6, v6, v6 row_ror:1 row_mask:0xf bank_mask:0xf
    s_nop 1
    v_max_i32_dpp v6, v6, v6 row_ror:2 row_mask:0xf bank_mask:0xf
    s_nop 1
    v_max_i32_dpp v6, v6, v6 row_ror:4 row_mask:0xf bank_mask:0xf
    s_nop 1
    v_max_i32_dpp v6, v6, v6 row_ror:8 row_mask:0xf bank_mask:0xf
    v_mov_b32 v5, v6
    s_nop 1
    v_permlane16_swap_b32 v6, v5
    s_mov_b64 exec, 0xffff
    s_cmp_lg_u32 s51, 0
    v_max3_i32 v6, v6, v5, 1
    s_cbranch_scc1 E_np
    buffer_store_dwordx2 v[6:7], v11, s[24:27], s45 offen sc1
E_np:
    ds_write_b32 v251, v6 offset:4
    s_mov_b64 exec, -1
E_end:
    s_waitcnt vmcnt(8) lgkmcnt(15)
    v_mfma_f32_16x16x32_bf16 v[184:187], v[52:55], v[168:171], v[184:187]
    v_mfma_f32_16x16x32_bf16 v[188:191], v[56:59], v[168:171], v[188:191]
    v_mfma_f32_16x16x32_bf16 v[192:195], v[60:63], v[168:171], v[192:195]
HB1_2:
    s_cbranch_execz HB1_3
    v_mfma_f32_16x16x32_bf16 v[196:199], v[64:67], v[168:171], v[196:199]
    s_waitcnt vmcnt(7) lgkmcnt(15)
    v_mfma_f32_16x16x32_bf16 v[184:187], v[68:71], v[172:175], v[184:187]
    v_mfma_f32_16x16x32_bf16 v[188:191], v[72:75], v[172:175], v[188:191]
    v_mfma_f32_16x16x32_bf16 v[192:195], v[76:79], v[172:175], v[192:195]
    v_mfma_f32_16x16x32_bf16 v[196:199], v[80:83], v[172:175], v[196:199]
    s_waitcnt vmcnt(6) lgkmcnt(15)
    v_mfma_f32_16x16x32_bf16 v[184:187], v[84:87], v[176:179], v[184:187]
    v_mfma_f32_16x16x32_bf16 v[188:191], v[88:91], v[176:179], v[188:191]
    v_mfma_f32_16x16x32_bf16 v[192:195], v[92:95], v[176:179], v[192:195]
    v_mfma_f32_16x16x32_bf16 v[196:199], v[96:99], v[176:179], v[196:199]
    s_waitcnt vmcnt(5) lgkmcnt(15)
    v_mfma_f32_16x16x32_bf16 v[184:187], v[100:103], v[180:183], v[184:187]
    v_mfma_f32_16x16x32_bf16 v[188:191], v[104:107], v[180:183], v[188:191]
    v_mfma_f32_16x16x32_bf16 v[192:195], v[108:111], v[180:183], v[192:195]
    v_mfma_f32_16x16x32_bf16 v[196:199], v[112:115], v[180:183], v[196:199]
    s_waitcnt vmcnt(4) lgkmcnt(15)
    v_mfma_f32_16x16x32_bf16 v[184:187], v[116:119], v[212:215], v[184:187]
    v_mfma_f32_16x16x32_bf16 v[188:191], v[120:123], v[212:215], v[188:191]
    v_mfma_f32_16x16x32_bf16 v[192:195], v[124:127], v[212:215], v[192:195]
    v_mfma_f32_16x16x32_bf16 v[196:199], v[128:131], v[212:215], v[196:199]
    s_waitcnt vmcnt(3) lgkmcnt(15)
    v_mfma_f32_16x16x32_bf16 v[184:187], v[132:135], v[12:15], v[184:187]
    v_mfma_f32_16x16x32_bf16 v[188:191], v[136:139], v[12:15], v[188:191]
    v_mfma_f32_16x16x32_bf16 v[192:195], v[140:143], v[12:15], v[192:195]
    v_mfma_f32_16x16x32_bf16 v[196:199], v[144:147], v[12:15], v[196:199]
    s_waitcnt vmcnt(2) lgkmcnt(15)
    v_mfma_f32_16x16x32_bf16 v[184:187], v[148:151], v[164:167], v[184:187]
    v_mfma_f32_16x16x32_bf16 v[188:191], v[152:155], v[164:167], v[188:191]
    v_mfma_f32_16x16x32_bf16 v[192:195], v[156:159], v[164:167], v[192:195]
    v_mfma_f32_16x16x32_bf16 v[196:199], v[160:163], v[164:167], v[196:199]
    s_waitcnt vmcnt(1) lgkmcnt(8)
    v_mfma_f32_16x16x32_bf16 v[184:187], v[20:23], v[232:235], v[184:187]
    v_mfma_f32_16x16x32_bf16 v[188:191], v[24:27], v[232:235], v[188:191]
    v_mfma_f32_16x16x32_bf16 v[192:195], v[28:31], v[232:235], v[192:195]
HB1_3:
    s_cbranch_execz HB1_4
    v_mfma_f32_16x16x32_bf16 v[196:199], v[32:35], v[232:235], v[196:199]
    s_waitcnt vmcnt(0) lgkmcnt(0)
    v_mfma_f32_16x16x32_bf16 v[184:187], v[36:39], v[236:239], v[184:187]
    v_mfma_f32_16x16x32_bf16 v[188:191], v[40:43], v[236:239], v[188:191]
    v_mfma_f32_16x16x32_bf16 v[192:195], v[44:47], v[236:239], v[192:195]
    v_mfma_f32_16x16x32_bf16 v[196:199], v[48:51], v[236:239], v[196:199]
    s_lshl_b32 s61, s56, 12
    s_add_u32 s61, s61, 135168
    v_add_u32 v16, s61, v202
    s_lshl_b32 s61, s56, 2
    s_add_u32 s61, s61, 160760
    v_mov_b32 v18, s61
    s_cmp_eq_u32 s101, 0
    s_cbranch_scc1 B_rx0
    ds_write_b128 v16, v[184:187] offset:0
    ds_write_b128 v16, v[188:191] offset:1024
    ds_write_b128 v16, v[192:195] offset:2048
    ds_write_b128 v16, v[196:199] offset:3072
    v_mov_b32 v19, 1
    s_waitcnt lgkmcnt(0)
    ds_write_b32 v18, v19
    s_branch L_fin
B_rx0:
B_rx:
    ds_read_b32 v19, v18
    s_waitcnt lgkmcnt(0)
    v_cmp_eq_u32 vcc, 0, v19
    s_cbranch_vccz B_rd
    s_sub_u32 s3, s3, 1
    s_cbranch_scc0 B_rx
    s_mov_b32 s3, 0
B_rd:
    ds_read_b32 v10, v251 offset:4
    ds_read_b128 v[100:103], v16 offset:0
    ds_read_b128 v[104:107], v16 offset:1024
    ds_read_b128 v[108:111], v16 offset:2048
    ds_read_b128 v[112:115], v16 offset:3072
    s_waitcnt lgkmcnt(0)
    v_add_f32 v184, v184, v100
    v_add_f32 v185, v185, v101
    v_add_f32 v186, v186, v102
    v_add_f32 v187, v187, v103
    v_add_f32 v188, v188, v104
    v_add_f32 v189, v189, v105
    v_add_f32 v190, v190, v106
    v_add_f32 v191, v191, v107
    v_add_f32 v192, v192, v108
    v_add_f32 v193, v193, v109
HB1_4:
    s_cbranch_execz HB1_5
    v_add_f32 v194, v194, v110
    v_add_f32 v195, v195, v111
    v_add_f32 v196, v196, v112
    v_add_f32 v197, v197, v113
    v_add_f32 v198, v198, v114
    v_add_f32 v199, v199, v115
B_epi:
    s_waitcnt lgkmcnt(0)
    v_cmp_eq_u32 vcc, 0, v10
    v_and_b32 v10, 0xfff, v10
    s_cbranch_vccnz B_ew
B_eg:
    v_cmp_eq_u32 s[68:69], v10, v226
    v_add_u32 v10, s54, v10
    v_mov_b32 v16, 0x3f803f80
    v_mov_b32 v15, s54
    s_add_u32 s63, s1, 20480
    s_lshl_b32 s64, s51, 8
    s_add_u32 s64, s64, s63
    v_cvt_pk_bf16_f32 v52, v184, v185
    v_cvt_pk_bf16_f32 v53, v186, v187
    v_cvt_pk_bf16_f32 v54, v188, v189
    v_cvt_pk_bf16_f32 v55, v190, v191
    v_cvt_pk_bf16_f32 v56, v192, v193
    v_cvt_pk_bf16_f32 v57, v194, v195
    v_cvt_pk_bf16_f32 v58, v196, v197
    v_cvt_pk_bf16_f32 v59, v198, v199
    s_cmp_eq_u64 s[68:69], 0
    s_cbranch_scc1 B_np2
    s_mov_b64 exec, s[68:69]
    ds_write_b128 v228, v[52:55] offset:0
    ds_write_b128 v228, v[56:59] offset:16
    s_mov_b64 exec, -1
    ds_read_b64 v[8:9], v252
    s_waitcnt lgkmcnt(0)
    buffer_store_dwordx3 v[8:10], v224, s[24:27], s44 offen sc1
B_np2:
    v_dot2_f32_bf16 v12, v52, v16, 0
    v_dot2_f32_bf16 v13, v52, v52, 0
    v_dot2_f32_bf16 v14, v52, v240, 0
    v_dot2_f32_bf16 v12, v53, v16, v12
    v_dot2_f32_bf16 v13, v53, v53, v13
    v_dot2_f32_bf16 v14, v53, v241, v14
    v_dot2_f32_bf16 v12, v54, v16, v12
HB1_5:
    s_cbranch_execz HB1_6
    v_dot2_f32_bf16 v13, v54, v54, v13
    v_dot2_f32_bf16 v14, v54, v242, v14
    v_dot2_f32_bf16 v12, v55, v16, v12
    v_dot2_f32_bf16 v13, v55, v55, v13
    v_dot2_f32_bf16 v14, v55, v243, v14
    v_dot2_f32_bf16 v12, v56, v16, v12
    v_dot2_f32_bf16 v13, v56, v56, v13
    v_dot2_f32_bf16 v14, v56, v244, v14
    v_dot2_f32_bf16 v12, v57, v16, v12
    v_dot2_f32_bf16 v13, v57, v57, v13
    v_dot2_f32_bf16 v14, v57, v245, v14
    v_dot2_f32_bf16 v12, v58, v16, v12
    v_dot2_f32_bf16 v13, v58, v58, v13
    v_dot2_f32_bf16 v14, v58, v246, v14
    v_dot2_f32_bf16 v12, v59, v16, v12
    v_dot2_f32_bf16 v13, v59, v59, v13
    v_dot2_f32_bf16 v14, v59, v247, v14
    s_nop 0
    v_mov_b32 v17, v12
    v_mov_b32 v18, v13
    v_mov_b32 v19, v14
    v_permlane32_swap_b32 v17, v12
    v_permlane32_swap_b32 v18, v13
    v_permlane32_swap_b32 v19, v14
    v_add_f32 v12, v12, v17
    v_add_f32 v13, v13, v18
    v_add_f32 v14, v14, v19
    v_mov_b32 v17, v12
    v_mov_b32 v18, v13
    v_mov_b32 v19, v14
    v_permlane16_swap_b32 v17, v12
    v_permlane16_swap_b32 v18, v13
    v_permlane16_swap_b32 v19, v14
    v_add_f32 v12, v12, v17
    v_add_f32 v13, v13, v18
    v_add_f32 v14, v14, v19
    s_mov_b64 exec, 0xffff
    s_cmp_eq_u32 s49, 0
    s_cbranch_scc1 sts_9
    buffer_store_dwordx4 v[12:15], v202, s[24:27], s64 offen
std_10:
    s_mov_b64 exec, -1
    v_lshlrev_b32 v36, 16, v52
    v_and_b32 v37, s47, v52
HB1_6:
    s_cbranch_execz HB1_7
    v_lshlrev_b32 v38, 16, v53
    v_and_b32 v39, s47, v53
    v_lshlrev_b32 v40, 16, v54
    v_and_b32 v41, s47, v54
    v_lshlrev_b32 v42, 16, v55
    v_and_b32 v43, s47, v55
    v_lshlrev_b32 v44, 16, v56
    v_and_b32 v45, s47, v56
    v_lshlrev_b32 v46, 16, v57
    v_and_b32 v47, s47, v57
    v_lshlrev_b32 v48, 16, v58
    v_and_b32 v49, s47, v58
    v_lshlrev_b32 v50, 16, v59
    v_and_b32 v51, s47, v59
    v_mov_b32 v108, 0
    v_mov_b32 v109, 0
    v_mov_b32 v110, 0
    v_mov_b32 v111, s54
    v_mov_b32 v11, s54
    v_lshlrev_b32 v7, 11, v200
    s_add_u32 s45, s45, 32768
    s_sub_u32 s44, s44, 131072
S_poll:
    buffer_load_dwordx4 v[100:103], v202, s[24:27], s63 offen sc1
    buffer_load_dwordx4 v[104:107], v202, s[24:27], s63 offen offset:1024 sc1
    s_mov_b32 exec_hi, 0
    buffer_load_dwordx4 v[108:111], v202, s[24:27], s63 offen offset:2048 sc1
    s_mov_b32 exec_hi, -1
    s_waitcnt vmcnt(0)
    v_cmp_ne_u32 vcc, s54, v103
    v_cmp_ne_u32 s[64:65], s54, v107
    v_cmp_ne_u32 s[66:67], s54, v111
    s_or_b64 vcc, vcc, s[64:65]
    s_or_b64 vcc, vcc, s[66:67]
    s_cbranch_vccz S_got
    s_sub_u32 s3, s3, 1
    s_cbranch_scc0 S_poll
    s_mov_b32 s3, 0
S_got:
    v_add_f32 v12, v100, v104
    v_add_f32 v13, v101, v105
    v_add_f32 v14, v102, v106
    v_add_f32 v12, v12, v108
    v_add_f32 v13, v13, v109
    v_add_f32 v14, v14, v110
    v_mov_b32 v17, v12
    v_mov_b32 v18, v13
    v_mov_b32 v19, v14
    v_permlane32_swap_b32 v17, v12
    v_permlane32_swap_b32 v18, v13
    v_permlane32_swap_b32 v19, v14
    v_add_f32 v12, v12, v17
    v_add_f32 v13, v13, v18
    v_add_f32 v14, v14, v19
    v_mov_b32 v17, v12
    v_mov_b32 v18, v13
    v_mov_b32 v19, v14
    v_permlane16_swap_b32 v17, v12
HB1_7:
    s_cbranch_execz HB1_8
    v_permlane16_swap_b32 v18, v13
    v_permlane16_swap_b32 v19, v14
    v_add_f32 v12, v12, v17
    v_add_f32 v13, v13, v18
    v_add_f32 v14, v14, v19
    v_mul_f32 v12, 0x3acccccd, v12
    v_mul_f32 v13, 0x3acccccd, v13
    v_fma_f32 v13, -v12, v12, v13
    v_max_f32 v13, 0, v13
    v_cvt_pk_bf16_f32 v13, v13, v13
    v_and_b32 v13, 0xffff0000, v13
    v_add_f32 v13, 0x3727c5ac, v13
    v_cvt_pk_bf16_f32 v13, v13, v13
    v_and_b32 v13, 0xffff0000, v13
    v_sqrt_f32 v13, v13
    v_cvt_pk_bf16_f32 v12, v12, v12
    v_and_b32 v12, 0xffff0000, v12
    v_cvt_pk_bf16_f32 v13, v13, v13
    v_and_b32 v13, 0xffff0000, v13
    v_rcp_f32 v13, v13
    v_fma_f32 v14, -v12, v248, v14
    v_mul_f32 v14, v14, v13
    v_ashrrev_i32 v6, 31, v14
    v_or_b32 v6, 0x80000000, v6
    v_xor_b32 v6, v6, v14
    v_and_b32 v6, 0xfffff000, v6
    v_or_b32 v6, v6, v226
    s_and_b64 exec, s[4:5], 0xffff
    ds_max_u32 v251, v6 offset:12
    s_mov_b64 exec, -1
    v_sub_f32 v20, v36, v12
    v_sub_f32 v21, v37, v12
    v_sub_f32 v22, v38, v12
    v_sub_f32 v23, v39, v12
    v_sub_f32 v24, v40, v12
    v_sub_f32 v25, v41, v12
    v_sub_f32 v26, v42, v12
    v_sub_f32 v27, v43, v12
    s_waitcnt lgkmcnt(0)
    s_barrier
    ds_read_b32 v10, v251 offset:12
    v_sub_f32 v28, v44, v12
    v_sub_f32 v29, v45, v12
    v_sub_f32 v30, v46, v12
    v_sub_f32 v31, v47, v12
HB1_8:
    s_cbranch_execz HB1_9
    v_sub_f32 v32, v48, v12
    v_sub_f32 v33, v49, v12
    v_sub_f32 v34, v50, v12
    v_sub_f32 v35, v51, v12
    s_or_b32 s64, s51, s48
    s_waitcnt lgkmcnt(0)
    s_cbranch_scc1 S_nc
    s_mov_b64 exec, 0xffff
    buffer_store_dwordx2 v[10:11], v7, s[24:27], s45 offen sc1
    s_mov_b64 exec, -1
S_nc:
    v_cmp_eq_u32 s[68:69], v10, v6
    v_cvt_pk_bf16_f32 v60, v20, v21
    v_cvt_pk_bf16_f32 v61, v22, v23
    v_cvt_pk_bf16_f32 v62, v24, v25
    v_cvt_pk_bf16_f32 v63, v26, v27
    v_cvt_pk_bf16_f32 v64, v28, v29
    v_cvt_pk_bf16_f32 v65, v30, v31
    v_cvt_pk_bf16_f32 v66, v32, v33
    v_cvt_pk_bf16_f32 v67, v34, v35
    v_lshlrev_b32 v20, 16, v60
    v_and_b32 v21, s47, v60
    v_lshlrev_b32 v22, 16, v61
    v_and_b32 v23, s47, v61
    v_lshlrev_b32 v24, 16, v62
    v_and_b32 v25, s47, v62
    v_lshlrev_b32 v26, 16, v63
    v_and_b32 v27, s47, v63
    v_lshlrev_b32 v28, 16, v64
    v_and_b32 v29, s47, v64
    v_lshlrev_b32 v30, 16, v65
    v_and_b32 v31, s47, v65
    v_lshlrev_b32 v32, 16, v66
    v_and_b32 v33, s47, v66
    v_lshlrev_b32 v34, 16, v67
    v_and_b32 v35, s47, v67
    v_mul_f32 v20, v20, v13
    v_mul_f32 v21, v21, v13
    v_mul_f32 v22, v22, v13
    v_mul_f32 v23, v23, v13
    v_mul_f32 v24, v24, v13
    v_mul_f32 v25, v25, v13
    v_mul_f32 v26, v26, v13
    v_mul_f32 v27, v27, v13
    v_mul_f32 v28, v28, v13
    v_mul_f32 v29, v29, v13
    v_mul_f32 v30, v30, v13
    v_mul_f32 v31, v31, v13
    v_mul_f32 v32, v32, v13
    v_mul_f32 v33, v33, v13
    v_mul_f32 v34, v34, v13
    v_mul_f32 v35, v35, v13
    v_cvt_pk_bf16_f32 v60, v20, v21
HB1_9:
    s_cbranch_execz HB1_10
    v_cvt_pk_bf16_f32 v61, v22, v23
    v_cvt_pk_bf16_f32 v62, v24, v25
    v_cvt_pk_bf16_f32 v63, v26, v27
    v_cvt_pk_bf16_f32 v64, v28, v29
    v_cvt_pk_bf16_f32 v65, v30, v31
    v_cvt_pk_bf16_f32 v66, v32, v33
    v_cvt_pk_bf16_f32 v67, v34, v35
    v_lshlrev_b32 v20, 16, v60
    v_and_b32 v21, s47, v60
    v_lshlrev_b32 v22, 16, v61
    v_and_b32 v23, s47, v61
    v_lshlrev_b32 v24, 16, v62
    v_and_b32 v25, s47, v62
    v_lshlrev_b32 v26, 16, v63
    v_and_b32 v27, s47, v63
    v_lshlrev_b32 v28, 16, v64
    v_and_b32 v29, s47, v64
    v_lshlrev_b32 v30, 16, v65
    v_and_b32 v31, s47, v65
    v_lshlrev_b32 v32, 16, v66
    v_and_b32 v33, s47, v66
    v_lshlrev_b32 v34, 16, v67
    v_and_b32 v35, s47, v67
    v_add_f32 v20, v20, v36
    v_add_f32 v21, v21, v37
    v_add_f32 v22, v22, v38
    v_add_f32 v23, v23, v39
    v_add_f32 v24, v24, v40
    v_add_f32 v25, v25, v41
    v_add_f32 v26, v26, v42
    v_add_f32 v27, v27, v43
    v_add_f32 v28, v28, v44
    v_add_f32 v29, v29, v45
    v_add_f32 v30, v30, v46
    v_add_f32 v31, v31, v47
    v_add_f32 v32, v32, v48
    v_add_f32 v33, v33, v49
    v_add_f32 v34, v34, v50
    v_add_f32 v35, v35, v51
    v_cvt_pk_bf16_f32 v60, v20, v21
    v_cvt_pk_bf16_f32 v61, v22, v23
    v_cvt_pk_bf16_f32 v62, v24, v25
    v_cvt_pk_bf16_f32 v63, v26, v27
    v_cvt_pk_bf16_f32 v64, v28, v29
    v_cvt_pk_bf16_f32 v65, v30, v31
    v_cvt_pk_bf16_f32 v66, v32, v33
    v_cvt_pk_bf16_f32 v67, v34, v35
HB1_10:
    s_cbranch_execz HB_ret
    v_permlane16_swap_b32 v60, v62
    v_permlane16_swap_b32 v61, v63
    v_permlane16_swap_b32 v64, v66
    v_permlane16_swap_b32 v65, v67
    s_and_b64 s[68:69], s[68:69], s[4:5]
    s_cbranch_scc0 S_out
    s_mov_b64 exec, s[68:69]
    buffer_store_dwordx4 v[60:63], v225, s[40:43], 0 offen offset:0 sc1
    buffer_store_dwordx4 v[64:67], v225, s[40:43], 0 offen offset:64 sc1
    s_mov_b64 exec, s[68:69]
    ds_write_b128 v228, v[52:55] offset:0
    ds_write_b128 v228, v[56:59] offset:16
    s_mov_b64 exec, -1
    ds_read_b64 v[8:9], v252
    v_and_b32 v10, 0xfff, v10
    v_add_u32 v10, s54, v10
S_out:
    s_not_b64 exec, s[68:69]
    buffer_store_dwordx4 v[60:63], v225, s[40:43], 0 offen offset:0 sc1
    buffer_store_dwordx4 v[64:67], v225, s[40:43], 0 offen offset:64 sc1
    s_cmp_eq_u64 s[68:69], 0
    s_cbranch_scc1 L_fin
    s_mov_b64 exec, 0xffff
    s_waitcnt vmcnt(2) lgkmcnt(0)
    buffer_store_dwordx3 v[8:10], v224, s[24:27], s44 offen sc1
L_fin:
L_end:
    s_endpgm
AT_mask:
    v_mov_b32 v17, 0xf149f2ca
    v_cmp_le_i32 vcc, 8, v212
    s_nop 1
    v_cndmask_b32 v60, v17, v60, vcc
    v_cmp_le_i32 vcc, 7, v212
    s_nop 1
    v_cndmask_b32 v61, v17, v61, vcc
    v_cmp_le_i32 vcc, 6, v212
    s_nop 1
    v_cndmask_b32 v62, v17, v62, vcc
    v_cmp_le_i32 vcc, 5, v212
    s_nop 1
    v_cndmask_b32 v63, v17, v63, vcc
    v_cmp_le_i32 vcc, 4, v212
    s_nop 1
    v_cndmask_b32 v64, v17, v64, vcc
    v_cmp_le_i32 vcc, 3, v212
    s_nop 1
    v_cndmask_b32 v65, v17, v65, vcc
    v_cmp_le_i32 vcc, 2, v212
    s_nop 1
    v_cndmask_b32 v66, v17, v66, vcc
    v_cmp_le_i32 vcc, 1, v212
    s_nop 1
    v_cndmask_b32 v67, v17, v67, vcc
    v_cmp_le_i32 vcc, 0, v212
    s_nop 1
    v_cndmask_b32 v68, v17, v68, vcc
    v_cmp_le_i32 vcc, -1, v212
    s_nop 1
    v_cndmask_b32 v69, v17, v69, vcc
    v_cmp_le_i32 vcc, -2, v212
    s_nop 1
    v_cndmask_b32 v70, v17, v70, vcc
    v_cmp_le_i32 vcc, -3, v212
    s_nop 1
    v_cndmask_b32 v71, v17, v71, vcc
    s_branch AT_nomask
sts_1:
    buffer_store_dwordx4 v[80:83], v213, s[24:27], s12 offen offset:0 sc1
    buffer_store_dwordx4 v[84:87], v213, s[24:27], s12 offen offset:512 sc1
    s_branch std_2
AT_vs:
    ds_read_b32 v17, v251 offset:8
    s_sub_u32 s3, s3, 1
    s_cbranch_scc0 AT_vc
    s_mov_b32 s3, 0
    s_branch AT_vg
sts_3:
    buffer_store_dwordx4 v[204:207], v249, s[24:27], s22 offen offset:0 sc1
    buffer_store_dwordx4 v[208:211], v249, s[24:27], s22 offen offset:1024 sc1
    s_branch std_4
sts_5:
    buffer_store_short_d16_hi v20, v164, s[24:27], s65 offen sc1
    s_branch std_6
sts_7:
    buffer_store_dword v79, v203, s[24:27], s23 offen sc1
    s_branch std_8
B_ew:
    s_sleep 1
    ds_read_b32 v10, v251 offset:4
    s_sub_u32 s3, s3, 1
    s_cbranch_scc0 B_epi
    s_mov_b32 s3, 0
    s_waitcnt lgkmcnt(0)
    s_branch B_eg
sts_9:
    buffer_store_dwordx4 v[12:15], v202, s[24:27], s64 offen sc1
    s_branch std_10
LD_cont:
    v_and_b32 v0, 63, v0
    s_mov_b32 s3, 0x40000
    s_mov_b32 s47, 0xffff0000
    s_mov_b32 s26, 7340032
    s_mov_b32 s27, 0x00020000
    s_mov_b32 s38, 819200
    s_mov_b32 s39, 0x00020000
    s_mov_b32 s42, 2621440
    s_mov_b32 s43, 0x00020000
    s_sub_u32 s52, s51, 5
    s_cselect_b32 s52, s51, s52
    s_buffer_load_dword s54, s[24:27], 0
    v_lshl_add_u32 v4, s60, 3, v1
    v_mul_u32_u24 v5, 1280, v4
    v_lshlrev_b32 v7, 1, v2
    v_bitop3_b32 v7, v0, 7, v7 bitop3:0x6a
    v_lshl_add_u32 v5, v7, 4, v5
    v_lshl_add_u32 v16, s51, 7, v5
    s_lshl_b32 s71, s53, 11
    s_add_u32 s71, s71, 81920
    s_mul_i32 s62, s60, 24
    v_add_u32 v17, s62, v0
    v_lshlrev_b32 v18, 4, v17
    v_cmp_gt_u32 vcc, 24, v0
    v_add_u32 v19, 72, v0
    v_lshlrev_b32 v19, 4, v19
    v_cndmask_b32 v18, v19, v18, vcc
    s_lshl_b32 s62, s51, 2
    s_add_u32 s62, s62, s60
    s_lshl_b32 s62, s62, 8
    s_sub_u32 s62, s62, s71
    s_add_u32 s62, s62, 1243488
    v_add_u32 v19, s62, v19
    v_cmp_lt_u32 vcc, 33, v0
    s_nop 1
    v_cndmask_b32 v18, v18, v19, vcc
    v_cmp_lt_u32 vcc, 49, v0
    s_nop 1
    v_cndmask_b32 v18, v18, 2.0, vcc
    v_mov_b32 v28, 0
    v_mov_b32 v29, 0
    v_mov_b32 v30, 0
    v_mov_b32 v31, 0
    s_lshl_b32 s62, s60, 6
    v_add_u32 v4, s62, v0
    v_lshlrev_b32 v35, 4, v4
    v_add_u32 v35, 135168, v35
    ds_write_b128 v35, v[28:31] offset:0
    ds_write_b128 v35, v[28:31] offset:4096
    ds_write_b128 v35, v[28:31] offset:8192
    ds_write_b128 v35, v[28:31] offset:12288
    ds_write_b128 v35, v[28:31] offset:16384
    ds_write_b128 v35, v[28:31] offset:20480
    v_lshrrev_b32 v5, 1, v4
    v_min_u32 v5, 61, v5
    v_mul_u32_u24 v5, 400, v5
    v_and_b32 v6, 1, v4
    v_lshl_add_u32 v5, v6, 4, v5
    v_add_u32 v5, 110624, v5
    ds_write_b128 v5, v[28:31]
    v_mov_b32 v6, 159776
    ds_write_b64 v6, v[28:29]
    v_and_b32 v4, 31, v0
    v_lshlrev_b32 v5, 7, v4
    s_lshl_b32 s62, s51, 11
    v_add_u32 v6, s62, v5
    s_lshl_b32 s62, s51, 8
    s_add_u32 s62, s62, 17408
    v_add_u32 v7, s62, v5
    v_cmp_lt_u32 vcc, 23, v4
    s_nop 1
    v_cndmask_b32 v6, v6, v7, vcc
    v_and_b32 v7, 128, v5
    v_add_u32 v7, 23040, v7
    v_cmp_lt_u32 vcc, 25, v4
    s_nop 1
    v_cndmask_b32 v6, v6, v7, vcc
    v_lshrrev_b32 v7, 5, v0
    v_mul_u32_u24 v7, 24320, v7
    v_add_u32 v36, v6, v7
    s_mov_b32 vcc_hi, 0xfcff0000
    s_cmp_eq_u32 s60, 0
    s_cselect_b32 vcc_lo, 0xf0ff5555, vcc_hi
    v_cndmask_b32 v36, v36, 2.0, vcc
    s_waitcnt lgkmcnt(0)
    s_add_u32 s54, s54, 2654435761
    s_lshl_b32 s62, s60, 10
    s_add_u32 s62, s62, 36864
    s_add_u32 s63, s51, 3
    s_sub_u32 s61, s63, 10
    s_cselect_b32 s63, s63, s61
    s_mul_i32 s63, s63, 81920
    s_call_b64 s[98:99], S_late
    s_call_b64 s[98:99], LD_issue
    s_waitcnt vmcnt(9)
    s_barrier
    s_bitcmp0_b32 s60, 0
    s_cselect_b32 s16, s14, s16
    s_cselect_b32 s17, s15, s17
    s_mov_b64 s[14:15], s[18:19]
    s_and_b32 s17, s17, 0xffff
    s_mov_b32 s18, 1966080
    s_mov_b32 s19, 0x00020000
    s_lshr_b32 s58, s60, 1
    s_lshl1_add_u32 s58, s2, s58
    s_mul_i32 s61, s58, 21846
    s_lshr_b32 s61, s61, 16
    s_mul_i32 s67, s61, 3
    s_sub_u32 s58, s58, s67
    s_mul_i32 s61, s61, 3072
    s_lshl_b32 s58, s58, 10
    s_add_u32 s58, s58, s61
    s_cmp_lt_u32 s61, 73728
    s_cselect_b32 s58, 2.0, s58
    s_buffer_load_dword s59, s[16:19], s58 offset:384
    s_buffer_load_dword s59, s[16:19], s58 offset:448
    s_buffer_load_dword s59, s[16:19], s58 offset:491904
    s_buffer_load_dword s59, s[16:19], s58 offset:491968
    s_add_u32 s58, s58, 983040
    s_call_b64 s[98:99], LD_issue
    s_call_b64 s[98:99], S_late2
    s_waitcnt vmcnt(9)
    s_barrier
    s_buffer_load_dword s59, s[16:19], s58 offset:384
    s_buffer_load_dword s59, s[16:19], s58 offset:448
    s_buffer_load_dword s59, s[16:19], s58 offset:491904
    s_buffer_load_dword s59, s[16:19], s58 offset:491968
    s_call_b64 s[98:99], LD_issue
    s_call_b64 s[98:99], S_late3
    s_waitcnt vmcnt(9)
    s_barrier
    s_call_b64 s[98:99], LD_issue
    s_call_b64 s[98:99], S_late4
    s_waitcnt vmcnt(9)
    s_barrier
    s_call_b64 s[98:99], LD_issue
    s_waitcnt vmcnt(9)
    s_barrier
    s_call_b64 s[98:99], LD_issue
    s_waitcnt vmcnt(9)
    s_barrier
    s_call_b64 s[98:99], LD_issue
    s_waitcnt vmcnt(9)
    s_barrier
    s_call_b64 s[98:99], LD_issue
    s_waitcnt vmcnt(9)
    s_barrier
    buffer_load_dwordx4 v[20:23], v18, s[24:27], s71 offen sc1
    s_call_b64 s[98:99], LD_issue
    s_waitcnt vmcnt(9)
    s_barrier
    v_mov_b32 v24, 163072
    ds_read_b32 v24, v24
    s_mov_b32 m0, s62
    s_add_u32 s62, s62, 4096
    buffer_load_dwordx4 v16, s[36:39], s63 offen lds
    s_add_u32 s63, s63, 40960
    s_mov_b32 m0, s62
    s_add_u32 s62, s62, 4096
    buffer_load_dwordx4 v16, s[36:39], s63 offen lds
    s_add_u32 s63, s63, 40960
    s_cmp_eq_u32 s63, 819200
    s_cselect_b32 s63, 0, s63
    s_mov_b32 m0, s62
    s_add_u32 s62, s62, 4096
    buffer_load_dwordx4 v16, s[36:39], s63 offen lds
    s_add_u32 s63, s63, 40960
    s_mov_b32 m0, s62
    s_add_u32 s62, s62, 4096
    buffer_load_dwordx4 v16, s[36:39], s63 offen lds
    s_add_u32 s63, s63, 40960
    s_cmp_eq_u32 s63, 819200
    s_cselect_b32 s63, 0, s63
    s_mov_b32 m0, s62
    s_add_u32 s62, s62, 4096
    buffer_load_dwordx4 v16, s[36:39], s63 offen lds
    s_add_u32 s63, s63, 40960
    s_mov_b32 m0, s62
    s_add_u32 s62, s62, 4096
    buffer_load_dwordx4 v16, s[36:39], s63 offen lds
    s_add_u32 s63, s63, 40960
    s_cmp_eq_u32 s63, 819200
    s_cselect_b32 s63, 0, s63
    s_mov_b32 m0, s62
    s_add_u32 s62, s62, 4096
    buffer_load_dwordx4 v16, s[36:39], s63 offen lds
    s_add_u32 s63, s63, 40960
    s_mov_b32 exec_hi, 3
    v_cmp_ne_u32 vcc, s54, v22
    s_cbranch_vccz LD_rs
LD_rsp:
    buffer_load_dwordx4 v[20:23], v18, s[24:27], s71 offen sc1
    s_waitcnt vmcnt(0)
    v_cmp_ne_u32 vcc, s54, v22
    s_cbranch_vccz LD_rs
    s_sleep 1
    s_sub_u32 s3, s3, 1
    s_cbranch_scc0 LD_rsp
    s_mov_b32 s3, 0
LD_rs:
    s_getreg_b32 s61, hwreg(HW_REG_XCC_ID)
    v_cmp_ne_u32 vcc, s61, v20
    s_lshr_b64 vcc, vcc, 24
    s_cselect_b32 s49, 0, 1
    s_lshl_b32 s61, s60, 5
    s_add_u32 s61, s61, 160828
    s_mov_b32 exec_hi, 0x3fffc
    s_mov_b32 exec_lo, 0
    v_cmp_eq_u32 vcc, s54, v22
    v_lshl_add_u32 v4, v0, 1, s61
    s_waitcnt lgkmcnt(0)
    v_mul_f32 v24, 0xbacccccd, v24
    v_fmac_f32 v21, v20, v24
    v_cndmask_b32 v21, 0, v21, vcc
    ds_write_b16_d16_hi v4, v21
    s_mov_b32 exec_hi, 0
    s_mov_b32 exec_lo, 0xffffff
    v_lshlrev_b32 v4, 3, v17
    v_add_u32 v4, 159808, v4
    ds_write_b64 v4, v[20:21]
    v_mov_b32 v4, 160768
    v_mov_b32 v5, s49
    ds_write_b32 v4, v5
    ds_write_b64 v4, v[28:29] offset:8
    ds_write_b64 v4, v[28:29] offset:16
    ds_write_b64 v4, v[28:29] offset:24
    s_mov_b64 exec, -1
    s_waitcnt vmcnt(7) lgkmcnt(0)
    s_barrier
    s_mov_b32 m0, s62
    s_add_u32 s62, s62, 4096
    buffer_load_dwordx4 v16, s[36:39], s63 offen lds
    s_add_u32 s63, s63, 40960
    s_cmp_eq_u32 s63, 819200
    s_cselect_b32 s63, 0, s63
    s_mov_b32 m0, s62
    s_add_u32 s62, s62, 4096
    buffer_load_dwordx4 v16, s[36:39], s63 offen lds
    s_add_u32 s63, s63, 40960
    s_mov_b32 m0, s62
    s_add_u32 s62, s62, 4096
    buffer_load_dwordx4 v16, s[36:39], s63 offen lds
    s_add_u32 s63, s63, 40960
    s_cmp_eq_u32 s63, 819200
    s_cselect_b32 s63, 0, s63
    s_mov_b32 m0, s62
    s_add_u32 s62, s62, 4096
    buffer_load_dwordx4 v16, s[36:39], s63 offen lds
    s_add_u32 s63, s63, 40960
    s_mov_b32 m0, s62
    s_add_u32 s62, s62, 4096
    buffer_load_dwordx4 v16, s[36:39], s63 offen lds
    s_add_u32 s63, s63, 40960
    s_cmp_eq_u32 s63, 819200
    s_cselect_b32 s63, 0, s63
    s_mov_b32 m0, s62
    s_add_u32 s62, s62, 4096
    buffer_load_dwordx4 v16, s[36:39], s63 offen lds
    s_add_u32 s63, s63, 40960
    s_mov_b32 m0, s62
    s_add_u32 s62, s62, 4096
    buffer_load_dwordx4 v16, s[36:39], s63 offen lds
    s_add_u32 s63, s63, 40960
    s_cmp_eq_u32 s63, 819200
    s_cselect_b32 s63, 0, s63
    s_cmp_eq_u32 s60, 3
    s_cbranch_scc1 pf_11
    s_mul_i32 s67, s53, 6
    s_lshl_b32 s68, s60, 1
    s_add_u32 s67, s67, s68
    s_mul_i32 s67, s67, 24320
    s_add_u32 s67, s67, 1310720
    buffer_load_dword v182, v36, s[24:27], s67 offen sc1
    s_mov_b64 exec, -1
    s_branch pf_12
pf_11:
    v_lshlrev_b32 v4, 7, v0
    s_mov_b64 exec, 7
    buffer_load_dword v182, v4, s[24:27], s57 offen sc1
    s_mov_b64 exec, -1
pf_12:
    v_mov_b32 v99, v16
    s_branch AT_start
F_start:
    v_and_b32 v0, 63, v0
    s_mov_b32 s3, 0x40000
    s_mov_b32 s47, 0xffff0000
    s_mov_b32 s26, 7340032
    s_mov_b32 s27, 0x00020000
    s_mov_b32 s38, 819200
    s_mov_b32 s39, 0x00020000
    s_mov_b32 s42, 2621440
    s_mov_b32 s43, 0x00020000
    s_and_b32 s49, s2, 7
    s_lshl_b32 s49, s49, 1
    s_add_u32 s49, s49, s56
    s_sub_u32 s49, s49, 30
    s_and_b32 s50, s48, 1
    s_lshr_b32 s51, s48, 1
    s_mul_i32 s52, s48, 6144
    s_mul_i32 s61, s49, 192
    v_mov_b32 v5, 128
    v_add_u32 v1, 0, v0
    v_mul_u32_u24 v2, 171, v1
    v_lshrrev_b32 v2, 11, v2
    v_mul_u32_u24 v3, 12, v2
    v_sub_u32 v3, v1, v3
    v_mul_u32_u24 v2, 3072, v2
    v_lshl_add_u32 v3, v3, 4, s61
    v_lshrrev_b32 v4, 8, v3
    v_cmp_eq_u32 vcc, 9, v4
    s_nop 1
    v_cndmask_b32 v4, 0, v5, vcc
    v_xad_u32 v210, v3, v4, v2
    v_add_u32 v1, 64, v0
    v_mul_u32_u24 v2, 171, v1
    v_lshrrev_b32 v2, 11, v2
    v_mul_u32_u24 v3, 12, v2
    v_sub_u32 v3, v1, v3
    v_mul_u32_u24 v2, 3072, v2
    v_lshl_add_u32 v3, v3, 4, s61
    v_lshrrev_b32 v4, 8, v3
    v_cmp_eq_u32 vcc, 9, v4
    s_nop 1
    v_cndmask_b32 v4, 0, v5, vcc
    v_xad_u32 v211, v3, v4, v2
    v_add_u32 v1, 128, v0
    v_mul_u32_u24 v2, 171, v1
    v_lshrrev_b32 v2, 11, v2
    v_mul_u32_u24 v3, 12, v2
    v_sub_u32 v3, v1, v3
    v_mul_u32_u24 v2, 3072, v2
    v_lshl_add_u32 v3, v3, 4, s61
    v_lshrrev_b32 v4, 8, v3
    v_cmp_eq_u32 vcc, 9, v4
    s_nop 1
    v_cndmask_b32 v4, 0, v5, vcc
    v_xad_u32 v212, v3, v4, v2
    s_mul_i32 s60, s51, 491520
    s_mov_b32 s30, 1966080
    s_mov_b32 s31, 0x00020000
    s_waitcnt lgkmcnt(0)
    s_cmp_eq_u32 s50, 0
    s_cselect_b32 s28, s14, s16
    s_cselect_b32 s29, s15, s17
    s_add_u32 m0, s52, 0
    s_add_u32 s62, s60, 0
    buffer_load_dwordx4 v210, s[28:31], s62 offen lds
    s_add_u32 m0, s52, 1024
    s_add_u32 s62, s60, 0
    buffer_load_dwordx4 v211, s[28:31], s62 offen lds
    s_add_u32 m0, s52, 2048
    s_add_u32 s62, s60, 0
    buffer_load_dwordx4 v212, s[28:31], s62 offen lds
    s_add_u32 m0, s52, 3072
    s_add_u32 s62, s60, 49152
    buffer_load_dwordx4 v210, s[28:31], s62 offen lds
    s_add_u32 m0, s52, 4096
    s_add_u32 s62, s60, 49152
    buffer_load_dwordx4 v211, s[28:31], s62 offen lds
    s_add_u32 m0, s52, 5120
    s_add_u32 s62, s60, 49152
    buffer_load_dwordx4 v212, s[28:31], s62 offen lds
    s_load_dword s54, s[24:25], 0
    s_mov_b32 s4, s12
    s_and_b32 s5, s13, 0xffff
    s_mov_b32 s6, 1280
    s_mov_b32 s7, 0x00020000
    s_mov_b32 s32, s18
    s_and_b32 s33, s19, 0xffff
    s_mov_b32 s34, 1966080
    s_mov_b32 s35, 0x00020000
    s_cmp_lg_u32 s48, 7
    s_cbranch_scc1 F_ntlb
    s_lshr_b32 s63, 25945, s49
    s_bitcmp0_b32 s63, 0
    s_cbranch_scc1 F_ntlb
    v_lshlrev_b32 v7, 16, v0
    buffer_load_dword v219, v7, s[40:43], 0 offen sc1
    buffer_load_dword v219, v7, s[36:39], 0 offen
    v_lshlrev_b32 v7, 17, v0
    buffer_load_dword v219, v7, s[24:27], 64 offen sc1
F_ntlb:
    s_add_u32 m0, s52, 49152
    s_add_u32 s62, s60, 98304
    buffer_load_dwordx4 v210, s[28:31], s62 offen lds
    s_add_u32 m0, s52, 50176
    s_add_u32 s62, s60, 98304
    buffer_load_dwordx4 v211, s[28:31], s62 offen lds
    s_add_u32 m0, s52, 51200
    s_add_u32 s62, s60, 98304
    buffer_load_dwordx4 v212, s[28:31], s62 offen lds
    s_add_u32 m0, s52, 52224
    s_add_u32 s62, s60, 147456
    buffer_load_dwordx4 v210, s[28:31], s62 offen lds
    s_add_u32 m0, s52, 53248
    s_add_u32 s62, s60, 147456
    buffer_load_dwordx4 v211, s[28:31], s62 offen lds
    s_add_u32 m0, s52, 54272
    s_add_u32 s62, s60, 147456
    buffer_load_dwordx4 v212, s[28:31], s62 offen lds
    s_mul_i32 s53, s48, 5120
    s_mul_i32 s61, s49, 122880
    s_add_u32 s61, s61, s53
    s_and_b32 s63, s48, 2
    s_lshl_b32 s63, s63, 2
    v_add_u32 v1, 0, v0
    v_mul_u32_u24 v2, 205, v1
    v_lshrrev_b32 v2, 14, v2
    v_lshl_or_b32 v2, v2, 1, s63
    v_xor_b32 v1, v1, v2
    v_lshlrev_b32 v213, 4, v1
    v_add_u32 v1, 64, v0
    v_mul_u32_u24 v2, 205, v1
    v_lshrrev_b32 v2, 14, v2
    v_lshl_or_b32 v2, v2, 1, s63
    v_xor_b32 v1, v1, v2
    v_lshlrev_b32 v214, 4, v1
    v_add_u32 v1, 128, v0
    v_mul_u32_u24 v2, 205, v1
    v_lshrrev_b32 v2, 14, v2
    v_lshl_or_b32 v2, v2, 1, s63
    v_xor_b32 v1, v1, v2
    v_lshlrev_b32 v215, 4, v1
    v_add_u32 v1, 192, v0
    v_mul_u32_u24 v2, 205, v1
    v_lshrrev_b32 v2, 14, v2
    v_lshl_or_b32 v2, v2, 1, s63
    v_xor_b32 v1, v1, v2
    v_lshlrev_b32 v216, 4, v1
    v_add_u32 v1, 256, v0
    v_mul_u32_u24 v2, 205, v1
    v_lshrrev_b32 v2, 14, v2
    v_lshl_or_b32 v2, v2, 1, s63
    v_xor_b32 v1, v1, v2
    v_lshlrev_b32 v217, 4, v1
    v_lshrrev_b32 v2, 4, v0
    v_bfe_u32 v1, v0, 2, 2
    v_lshl_add_u32 v3, v2, 3, v1
    v_and_b32 v4, 3, v0
    v_lshlrev_b32 v4, 3, v4
    v_mul_u32_u24 v5, 192, v3
    s_and_b32 s63, s48, 5
    s_mul_i32 s63, s63, 6144
    s_and_b32 s66, s51, 1
    s_mul_i32 s64, s66, 96
    s_add_u32 s63, s63, s64
    v_add3_u32 v218, v5, v4, s63
    v_and_b32 v6, 1, v2
    v_lshl_or_b32 v6, v6, 2, v1
    v_lshlrev_b32 v6, 5, v6
    v_mul_u32_u24 v3, 1280, v3
    s_mul_i32 s63, s48, 160
    s_add_u32 s64, s63, 0
    v_add_u32 v7, s64, v4
    v_xor_b32 v7, v7, v6
    v_add_u32 v200, v7, v3
    v_add_u32 v205, 98304, v200
    s_add_u32 s64, s63, 32
    v_add_u32 v7, s64, v4
    v_xor_b32 v7, v7, v6
    v_add_u32 v201, v7, v3
    v_add_u32 v206, 98304, v201
    s_add_u32 s64, s63, 64
    v_add_u32 v7, s64, v4
    v_xor_b32 v7, v7, v6
    v_add_u32 v202, v7, v3
    v_add_u32 v207, 98304, v202
    s_add_u32 s64, s63, 96
    v_add_u32 v7, s64, v4
    v_xor_b32 v7, v7, v6
    v_add_u32 v203, v7, v3
    v_add_u32 v208, 98304, v203
    s_add_u32 s64, s63, 128
    v_add_u32 v7, s64, v4
    v_xor_b32 v7, v7, v6
    v_add_u32 v204, v7, v3
    v_add_u32 v209, 98304, v204
    s_waitcnt lgkmcnt(0)
    s_add_u32 s54, s54, 2654435761
    s_mov_b32 s67, 0x3f803f80
    v_mov_b32 v220, s67
    v_mov_b32 v221, s67
    v_mov_b32 v222, s67
    v_mov_b32 v223, s67
    v_mov_b64 v[232:233], 0
    v_mov_b64 v[234:235], 0
    v_mov_b64 v[236:237], 0
    v_mov_b64 v[238:239], 0
    v_mov_b64 v[240:241], 0
    v_mov_b64 v[242:243], 0
    v_lshlrev_b32 v16, 3, v0
    buffer_load_dwordx2 v[10:11], v16, s[4:7], 0 offen offset:0
    buffer_load_dwordx2 v[12:13], v16, s[4:7], 0 offen offset:512
    buffer_load_dwordx2 v[14:15], v16, s[4:7], 0 offen offset:1024
    v_lshlrev_b32 v1, 4, v0
    v_lshlrev_b32 v7, 6, v0
    s_lshl_b32 s15, s49, 11
    s_add_u32 s15, s15, 196608
    s_add_u32 s70, s15, 32768
    s_cmp_eq_u32 s48, 7
    s_cselect_b32 s65, s70, 2.0
    s_mov_b64 exec, 0xffffff
    buffer_load_dword v219, v7, s[24:27], s65 offen sc1
    s_mov_b64 exec, -1
    v_mov_b32 v8, 140288
    v_mov_b32 v224, 0
    v_mov_b32 v225, 0
    v_mov_b32 v226, 0
    v_mov_b32 v227, 0
    ds_write_b128 v8, v[224:227] offset:0
    ds_write_b128 v8, v[224:227] offset:16
    ds_write_b128 v8, v[224:227] offset:32
    ds_write_b128 v8, v[224:227] offset:3648
    ds_write_b128 v8, v[224:227] offset:3664
    ds_write_b128 v8, v[224:227] offset:3776
    ds_write_b128 v8, v[224:227] offset:3792
    s_mul_i32 s65, s48, 1344
    s_add_u32 s45, s65, 16384
    v_lshl_add_u32 v16, v0, 2, s45
    v_and_b32 v19, 15, v0
    v_bfe_u32 v5, v0, 1, 1
    v_mov_b32 v6, 0x44444444
    v_mov_b32 v9, 0xeeeeeeee
    v_cmp_eq_u32 vcc, 1, v5
    s_nop 1
    v_cndmask_b32 v252, v6, v9, vcc
    v_lshlrev_b32 v6, 4, v2
    v_lshl_add_u32 v6, v5, 7, v6
    v_add_u32 v6, v6, v8
    v_bfe_u32 v3, v0, 2, 2
    v_and_b32 v4, 1, v0
    v_lshl_add_u32 v3, v3, 1, v4
    v_mul_u32_u24 v9, 1344, v3
    v_mul_u32_u24 v5, 672, v5
    v_add_u32 v9, v9, v5
    v_lshrrev_b32 v3, 1, v2
    v_mul_u32_u24 v3, 160, v3
    v_and_b32 v4, 1, v2
    v_lshl_add_u32 v3, v4, 4, v3
    s_lshr_b32 s65, s48, 2
    s_mul_i32 s63, s65, 320
    v_add3_u32 v9, v9, v3, s63
    s_lshl1_add_u32 s65, s65, s50
    s_mul_i32 s65, s65, 768
    s_mul_i32 s66, s66, 384
    s_add_u32 s65, s65, s66
    v_lshl_add_u32 v3, v19, 3, s65
    v_add_u32 v230, 140544, v3
    v_mul_u32_u24 v4, 3328, v2
    v_add_u32 v3, v3, v4
    s_mul_i32 s65, s48, 48
    v_add_u32 v4, s65, v0
    v_bfe_u32 v5, v4, 1, 1
    v_lshlrev_b32 v5, 7, v5
    v_and_b32 v17, 1, v4
    v_lshl_add_u32 v5, v17, 1, v5
    v_and_b32 v17, 0xfc, v4
    v_add_u32 v5, v5, v17
    v_lshrrev_b32 v17, 6, v4
    v_lshl_add_u32 v5, v17, 5, v5
    v_add_u32 v5, v5, v8
    v_lshlrev_b32 v4, 3, v4
    v_and_b32 v17, 7, v0
    v_lshlrev_b32 v18, 4, v17
    v_lshl_add_u32 v18, v2, 11, v18
    v_lshrrev_b32 v19, 3, v19
    v_lshl_add_u32 v229, v19, 12, v18
    s_lshl_b32 s8, s48, 13
    s_lshl_b32 s65, s49, 7
    s_add_u32 s8, s8, s65
    s_add_u32 s8, s8, 16384
    s_sub_u32 s44, s48, 2
    s_lshl_b32 s14, s49, 12
    s_lshl_b32 s65, s44, 11
    s_add_u32 s14, s14, s65
    s_add_u32 s14, s14, 16384
    s_lshr_b32 s65, s49, 1
    s_lshl_b32 s65, s65, 6
    s_lshl3_add_u32 s65, s49, s65
    s_and_b32 s66, s44, 1
    s_movk_i32 s19, 0xff
    s_cselect_b32 s18, s19, 0x00ff00ff
    s_mul_i32 s66, s66, 48
    s_add_u32 s65, s65, s66
    v_and_b32 v18, 1, v2
    v_lshrrev_b32 v19, 1, v2
    v_lshl_or_b32 v18, v18, 1, v19
    v_min_u32 v18, 2, v18
    v_lshl_add_u32 v18, v18, 4, v17
    v_add_u32 v18, s65, v18
    v_bfe_u32 v19, v18, 1, 1
    v_mul_u32_u24 v19, 672, v19
    v_and_b32 v17, 1, v18
    v_lshl_add_u32 v19, v17, 1, v19
    v_and_b32 v17, 0xffc, v18
    v_add_u32 v19, v19, v17
    v_lshlrev_b32 v18, 1, v18
    v_mov_b32 v17, v229
    s_sub_u32 s65, s54, 1
    v_mov_b32 v227, s65
    s_mov_b32 exec_hi, 0
    buffer_store_dwordx4 v[224:227], v17, s[24:27], s8 offen sc1
    s_mov_b32 exec_hi, -1
    s_lshr_b32 s68, s48, 1
    s_mul_i32 s68, s68, 3328
    s_lshl2_add_u32 s68, s50, s68
    s_lshr_b32 s16, s49, 2
    s_mul_i32 s16, s16, 61440
    s_add_u32 s16, s16, 262144
    s_mov_b32 s17, 0
    s_mov_b32 s20, 16
    v_add_u32 v228, 140544, v4
    s_lshl_b32 s65, s48, 2
    v_add_u32 v231, s65, v8
    s_cmp_lg_u32 s48, 6
    s_cbranch_scc1 HF_ret
    s_mov_b64 exec, 0
    s_branch HF0_0
HF_ret:
    s_mov_b64 exec, -1
    s_waitcnt vmcnt(11)
    s_barrier
    ds_read_b64_tr_b16 v[20:21], v218 offset:0
    ds_read_b64_tr_b16 v[22:23], v218 offset:768
    ds_read_b64_tr_b16 v[24:25], v218 offset:12288
    ds_read_b64_tr_b16 v[26:27], v218 offset:13056
    ds_read_b64_tr_b16 v[28:29], v218 offset:32
    ds_read_b64_tr_b16 v[30:31], v218 offset:800
    ds_read_b64_tr_b16 v[32:33], v218 offset:12320
    ds_read_b64_tr_b16 v[34:35], v218 offset:13088
    ds_read_b64_tr_b16 v[36:37], v218 offset:64
    ds_read_b64_tr_b16 v[38:39], v218 offset:832
    ds_read_b64_tr_b16 v[40:41], v218 offset:12352
    ds_read_b64_tr_b16 v[42:43], v218 offset:13120
    s_waitcnt lgkmcnt(0)
    s_barrier
    s_add_u32 m0, s52, 0
    s_add_u32 s62, s60, 196608
    buffer_load_dwordx4 v210, s[28:31], s62 offen lds
    s_add_u32 m0, s52, 1024
    s_add_u32 s62, s60, 196608
    buffer_load_dwordx4 v211, s[28:31], s62 offen lds
    s_add_u32 m0, s52, 2048
    s_add_u32 s62, s60, 196608
    buffer_load_dwordx4 v212, s[28:31], s62 offen lds
    s_add_u32 m0, s52, 3072
    s_add_u32 s62, s60, 245760
    buffer_load_dwordx4 v210, s[28:31], s62 offen lds
    s_add_u32 m0, s52, 4096
    s_add_u32 s62, s60, 245760
    buffer_load_dwordx4 v211, s[28:31], s62 offen lds
    s_add_u32 m0, s52, 5120
    s_add_u32 s62, s60, 245760
    buffer_load_dwordx4 v212, s[28:31], s62 offen lds
    v_smfmac_f32_16x16x64_bf16 v[232:235], v[220:223], v[20:27], v252
    v_smfmac_f32_16x16x64_bf16 v[236:239], v[220:223], v[28:35], v252
    v_smfmac_f32_16x16x64_bf16 v[240:243], v[220:223], v[36:43], v252
    s_waitcnt vmcnt(11)
    s_barrier
    ds_read_b64_tr_b16 v[44:45], v218 offset:49152
    ds_read_b64_tr_b16 v[46:47], v218 offset:49920
    ds_read_b64_tr_b16 v[48:49], v218 offset:61440
    ds_read_b64_tr_b16 v[50:51], v218 offset:62208
    ds_read_b64_tr_b16 v[52:53], v218 offset:49184
    ds_read_b64_tr_b16 v[54:55], v218 offset:49952
    ds_read_b64_tr_b16 v[56:57], v218 offset:61472
    ds_read_b64_tr_b16 v[58:59], v218 offset:62240
    ds_read_b64_tr_b16 v[60:61], v218 offset:49216
    ds_read_b64_tr_b16 v[62:63], v218 offset:49984
    ds_read_b64_tr_b16 v[64:65], v218 offset:61504
    ds_read_b64_tr_b16 v[66:67], v218 offset:62272
    s_waitcnt lgkmcnt(0)
    s_barrier
    s_add_u32 m0, s52, 49152
    s_add_u32 s62, s60, 294912
    buffer_load_dwordx4 v210, s[28:31], s62 offen lds
    s_add_u32 m0, s52, 50176
    s_add_u32 s62, s60, 294912
    buffer_load_dwordx4 v211, s[28:31], s62 offen lds
    s_add_u32 m0, s52, 51200
    s_add_u32 s62, s60, 294912
    buffer_load_dwordx4 v212, s[28:31], s62 offen lds
    s_add_u32 m0, s52, 52224
    s_add_u32 s62, s60, 344064
    buffer_load_dwordx4 v210, s[28:31], s62 offen lds
    s_add_u32 m0, s52, 53248
    s_add_u32 s62, s60, 344064
    buffer_load_dwordx4 v211, s[28:31], s62 offen lds
    s_add_u32 m0, s52, 54272
    s_add_u32 s62, s60, 344064
    buffer_load_dwordx4 v212, s[28:31], s62 offen lds
    v_smfmac_f32_16x16x64_bf16 v[232:235], v[220:223], v[44:51], v252
    v_smfmac_f32_16x16x64_bf16 v[236:239], v[220:223], v[52:59], v252
    v_smfmac_f32_16x16x64_bf16 v[240:243], v[220:223], v[60:67], v252
    s_waitcnt vmcnt(6)
    s_barrier
    ds_read_b64_tr_b16 v[68:69], v218 offset:0
    ds_read_b64_tr_b16 v[70:71], v218 offset:768
    ds_read_b64_tr_b16 v[72:73], v218 offset:12288
    ds_read_b64_tr_b16 v[74:75], v218 offset:13056
    ds_read_b64_tr_b16 v[76:77], v218 offset:32
    ds_read_b64_tr_b16 v[78:79], v218 offset:800
    ds_read_b64_tr_b16 v[80:81], v218 offset:12320
    ds_read_b64_tr_b16 v[82:83], v218 offset:13088
    ds_read_b64_tr_b16 v[84:85], v218 offset:64
    ds_read_b64_tr_b16 v[86:87], v218 offset:832
    ds_read_b64_tr_b16 v[88:89], v218 offset:12352
    ds_read_b64_tr_b16 v[90:91], v218 offset:13120
    s_waitcnt lgkmcnt(0)
    s_barrier
    s_add_u32 m0, s52, 0
    s_add_u32 s62, s60, 393216
    buffer_load_dwordx4 v210, s[28:31], s62 offen lds
    s_add_u32 m0, s52, 1024
    s_add_u32 s62, s60, 393216
    buffer_load_dwordx4 v211, s[28:31], s62 offen lds
    s_add_u32 m0, s52, 2048
    s_add_u32 s62, s60, 393216
    buffer_load_dwordx4 v212, s[28:31], s62 offen lds
    s_add_u32 m0, s52, 3072
    s_add_u32 s62, s60, 442368
    buffer_load_dwordx4 v210, s[28:31], s62 offen lds
    s_add_u32 m0, s52, 4096
    s_add_u32 s62, s60, 442368
    buffer_load_dwordx4 v211, s[28:31], s62 offen lds
    s_add_u32 m0, s52, 5120
    s_add_u32 s62, s60, 442368
    buffer_load_dwordx4 v212, s[28:31], s62 offen lds
    v_smfmac_f32_16x16x64_bf16 v[232:235], v[220:223], v[68:75], v252
    v_smfmac_f32_16x16x64_bf16 v[236:239], v[220:223], v[76:83], v252
    v_smfmac_f32_16x16x64_bf16 v[240:243], v[220:223], v[84:91], v252
    v_dot2_f32_bf16 v226, v10, s67, 0
    v_dot2_f32_bf16 v226, v11, s67, v226
    v_dot2_f32_bf16 v226, v12, s67, v226
    v_dot2_f32_bf16 v226, v13, s67, v226
    v_dot2_f32_bf16 v226, v14, s67, v226
    v_dot2_f32_bf16 v226, v15, s67, v226
    s_nop 2
    v_add_f32_dpp v226, v226, v226 row_ror:1 row_mask:0xf bank_mask:0xf
    s_nop 1
    v_add_f32_dpp v226, v226, v226 row_ror:2 row_mask:0xf bank_mask:0xf
    s_nop 1
    v_add_f32_dpp v226, v226, v226 row_ror:4 row_mask:0xf bank_mask:0xf
    s_nop 1
    v_add_f32_dpp v226, v226, v226 row_ror:8 row_mask:0xf bank_mask:0xf
    v_mov_b32 v229, v226
    s_nop 1
    v_permlane32_swap_b32 v226, v229
    v_add_f32 v226, v226, v229
    v_mov_b32 v229, v226
    s_nop 1
    v_permlane16_swap_b32 v226, v229
    v_add_f32 v226, v226, v229
    s_nop 0
    v_readfirstlane_b32 s55, v226
    s_waitcnt vmcnt(6)
    s_barrier
    ds_read_b64_tr_b16 v[92:93], v218 offset:49152
    ds_read_b64_tr_b16 v[94:95], v218 offset:49920
    ds_read_b64_tr_b16 v[96:97], v218 offset:61440
    ds_read_b64_tr_b16 v[98:99], v218 offset:62208
    ds_read_b64_tr_b16 v[100:101], v218 offset:49184
    ds_read_b64_tr_b16 v[102:103], v218 offset:49952
    ds_read_b64_tr_b16 v[104:105], v218 offset:61472
    ds_read_b64_tr_b16 v[106:107], v218 offset:62240
    ds_read_b64_tr_b16 v[108:109], v218 offset:49216
    ds_read_b64_tr_b16 v[110:111], v218 offset:49984
    ds_read_b64_tr_b16 v[112:113], v218 offset:61504
    ds_read_b64_tr_b16 v[114:115], v218 offset:62272
    s_waitcnt lgkmcnt(0)
    s_barrier
    s_mul_i32 s62, s49, 3
    s_add_u32 s62, s62, 0
    s_lshr_b32 s63, s62, 2
    s_cmp_eq_u32 s63, 9
    s_cselect_b32 s63, 2, 0
    s_xor_b32 s62, s62, s63
    s_mul_i32 s62, s62, 40960
    s_add_u32 s62, s62, s53
    s_add_u32 m0, s53, 98304
    s_nop 0
    buffer_load_dwordx4 v213, s[32:35], s62 offen lds
    s_add_u32 m0, s53, 99328
    s_nop 0
    buffer_load_dwordx4 v214, s[32:35], s62 offen lds
    s_add_u32 m0, s53, 100352
    s_nop 0
    buffer_load_dwordx4 v215, s[32:35], s62 offen lds
    s_add_u32 m0, s53, 101376
    s_nop 0
    buffer_load_dwordx4 v216, s[32:35], s62 offen lds
    s_add_u32 m0, s53, 102400
    s_nop 0
    buffer_load_dwordx4 v217, s[32:35], s62 offen lds
    s_mul_i32 s62, s49, 3
    s_add_u32 s62, s62, 1
    s_lshr_b32 s63, s62, 2
    s_cmp_eq_u32 s63, 9
    s_cselect_b32 s63, 2, 0
    s_xor_b32 s62, s62, s63
    s_mul_i32 s62, s62, 40960
    s_add_u32 s62, s62, s53
    s_add_u32 m0, s53, 49152
    s_nop 0
    buffer_load_dwordx4 v213, s[32:35], s62 offen lds
    s_add_u32 m0, s53, 50176
    s_nop 0
    buffer_load_dwordx4 v214, s[32:35], s62 offen lds
    s_add_u32 m0, s53, 51200
    s_nop 0
    buffer_load_dwordx4 v215, s[32:35], s62 offen lds
    s_add_u32 m0, s53, 52224
    s_nop 0
    buffer_load_dwordx4 v216, s[32:35], s62 offen lds
    s_add_u32 m0, s53, 53248
    s_nop 0
    buffer_load_dwordx4 v217, s[32:35], s62 offen lds
    v_smfmac_f32_16x16x64_bf16 v[232:235], v[220:223], v[92:99], v252
    v_smfmac_f32_16x16x64_bf16 v[236:239], v[220:223], v[100:107], v252
    v_smfmac_f32_16x16x64_bf16 v[240:243], v[220:223], v[108:115], v252
    s_waitcnt vmcnt(10)
    s_barrier
    ds_read_b64_tr_b16 v[116:117], v218 offset:0
    ds_read_b64_tr_b16 v[118:119], v218 offset:768
    ds_read_b64_tr_b16 v[120:121], v218 offset:12288
    ds_read_b64_tr_b16 v[122:123], v218 offset:13056
    ds_read_b64_tr_b16 v[124:125], v218 offset:32
    ds_read_b64_tr_b16 v[126:127], v218 offset:800
    ds_read_b64_tr_b16 v[128:129], v218 offset:12320
    ds_read_b64_tr_b16 v[130:131], v218 offset:13088
    ds_read_b64_tr_b16 v[132:133], v218 offset:64
    ds_read_b64_tr_b16 v[134:135], v218 offset:832
    ds_read_b64_tr_b16 v[136:137], v218 offset:12352
    ds_read_b64_tr_b16 v[138:139], v218 offset:13120
    s_waitcnt lgkmcnt(0)
    s_barrier
    s_mul_i32 s62, s49, 3
    s_add_u32 s62, s62, 2
    s_lshr_b32 s63, s62, 2
    s_cmp_eq_u32 s63, 9
    s_cselect_b32 s63, 2, 0
    s_xor_b32 s62, s62, s63
    s_mul_i32 s62, s62, 40960
    s_add_u32 s62, s62, s53
    s_add_u32 m0, s53, 0
    s_nop 0
    buffer_load_dwordx4 v213, s[32:35], s62 offen lds
    s_add_u32 m0, s53, 1024
    s_nop 0
    buffer_load_dwordx4 v214, s[32:35], s62 offen lds
    s_add_u32 m0, s53, 2048
    s_nop 0
    buffer_load_dwordx4 v215, s[32:35], s62 offen lds
    s_add_u32 m0, s53, 3072
    s_nop 0
    buffer_load_dwordx4 v216, s[32:35], s62 offen lds
    s_add_u32 m0, s53, 4096
    s_nop 0
    buffer_load_dwordx4 v217, s[32:35], s62 offen lds
    v_smfmac_f32_16x16x64_bf16 v[232:235], v[220:223], v[116:123], v252
    v_smfmac_f32_16x16x64_bf16 v[236:239], v[220:223], v[124:131], v252
    v_smfmac_f32_16x16x64_bf16 v[240:243], v[220:223], v[132:139], v252
    s_mov_b64 exec, 0xffff
    s_nop 8
    v_pk_add_f32 v[232:233], v[232:233], v[234:235]
    ds_write_b64 v230, v[232:233] offset:0
    v_pk_add_f32 v[236:237], v[236:237], v[238:239]
    ds_write_b64 v230, v[236:237] offset:128
    v_pk_add_f32 v[240:241], v[240:241], v[242:243]
    ds_write_b64 v230, v[240:241] offset:256
    s_mov_b64 exec, -1
    s_waitcnt lgkmcnt(0)
    s_waitcnt vmcnt(5)
    s_barrier
    ds_read2st64_b32 v[232:233], v228 offset0:0 offset1:3
    ds_read2st64_b32 v[234:235], v228 offset0:6 offset1:9
    ds_read_b64_tr_b16 v[140:141], v205 offset:0
    ds_read_b64_tr_b16 v[142:143], v205 offset:5120
    ds_read_b64_tr_b16 v[152:153], v206 offset:0
    ds_read_b64_tr_b16 v[154:155], v206 offset:5120
    ds_read_b64_tr_b16 v[164:165], v207 offset:0
    ds_read_b64_tr_b16 v[166:167], v207 offset:5120
    ds_read_b64_tr_b16 v[176:177], v208 offset:0
    ds_read_b64_tr_b16 v[178:179], v208 offset:5120
    ds_read_b64_tr_b16 v[188:189], v209 offset:0
    ds_read_b64_tr_b16 v[190:191], v209 offset:5120
    ds_read_b64_tr_b16 v[144:145], v200 offset:49152
    ds_read_b64_tr_b16 v[146:147], v200 offset:54272
    ds_read_b64_tr_b16 v[156:157], v201 offset:49152
    ds_read_b64_tr_b16 v[158:159], v201 offset:54272
    ds_read_b64_tr_b16 v[168:169], v202 offset:49152
    ds_read_b64_tr_b16 v[170:171], v202 offset:54272
    ds_read_b64_tr_b16 v[180:181], v203 offset:49152
    ds_read_b64_tr_b16 v[182:183], v203 offset:54272
    ds_read_b64_tr_b16 v[192:193], v204 offset:49152
    ds_read_b64_tr_b16 v[194:195], v204 offset:54272
    s_waitcnt lgkmcnt(0)
    v_add_f32 v0, v232, v234
    v_add_f32 v2, v233, v235
    s_waitcnt vmcnt(0)
    s_barrier
    ds_read_b64_tr_b16 v[148:149], v200 offset:0
    ds_read_b64_tr_b16 v[150:151], v200 offset:5120
    ds_read_b64_tr_b16 v[160:161], v201 offset:0
    ds_read_b64_tr_b16 v[162:163], v201 offset:5120
    ds_read_b64_tr_b16 v[172:173], v202 offset:0
    ds_read_b64_tr_b16 v[174:175], v202 offset:5120
    ds_read_b64_tr_b16 v[184:185], v203 offset:0
    ds_read_b64_tr_b16 v[186:187], v203 offset:5120
    ds_read_b64_tr_b16 v[196:197], v204 offset:0
    ds_read_b64_tr_b16 v[198:199], v204 offset:5120
    s_waitcnt lgkmcnt(0)
F_rdy:
HF0_0:
    s_cbranch_execz HF0_1
    s_cmp_lg_u32 s48, 0
    s_cbranch_scc1 F_wait
    s_mov_b64 exec, 0xffffff
F_poll:
    buffer_load_dwordx2 v[224:225], v7, s[24:27], s15 offen sc1
    s_waitcnt vmcnt(0)
    v_cmp_ne_u32 vcc, s54, v225
    s_cbranch_vccz F_got
    s_sleep 1
    s_sub_u32 s3, s3, 1
    s_cbranch_scc0 F_poll
    s_mov_b32 s3, 0
F_got:
    s_mov_b64 exec, -1
    v_max_u32_dpp v226, v224, v224 row_ror:1 row_mask:0xf bank_mask:0xf
    s_nop 1
    v_max_u32_dpp v226, v226, v226 row_ror:2 row_mask:0xf bank_mask:0xf
    s_nop 1
    v_max_u32_dpp v226, v226, v226 row_ror:4 row_mask:0xf bank_mask:0xf
    s_nop 1
    v_max_u32_dpp v226, v226, v226 row_ror:8 row_mask:0xf bank_mask:0xf
    s_nop 0
    v_readlane_b32 s60, v226, 0
    v_readlane_b32 s62, v226, 16
HF0_1:
    s_cbranch_execz HF0_2
    s_max_u32 s60, s60, s62
    s_max_u32 s60, s60, 1376257
    s_sub_u32 s60, s60, 1376256
    v_cmp_le_u32 vcc, s60, v224
    s_nop 1
    v_mbcnt_lo_u32_b32 v226, vcc_lo, 0
    v_cmp_gt_u32 s[62:63], 8, v226
    v_lshl_add_u32 v226, v226, 2, v8
    s_and_b64 exec, vcc, s[62:63]
    ds_write_b32 v226, v224 offset:0
    s_mov_b64 exec, -1
    s_waitcnt lgkmcnt(0)
F_wait:
    s_barrier
    ds_read_b32 v224, v231 offset:0
    s_waitcnt lgkmcnt(0)
    v_readfirstlane_b32 s60, v224
F_redo:
    v_mov_b64 v[232:233], 0
    v_mov_b64 v[234:235], 0
    v_mov_b64 v[236:237], 0
    v_mov_b64 v[238:239], 0
    v_mov_b64 v[240:241], 0
    v_mov_b64 v[242:243], 0
    s_and_b32 s61, s60, 0xfff
    s_cbranch_scc0 F_b1
    s_lshr_b32 s62, s61, 4
    s_mul_i32 s62, s62, 171
    s_lshr_b32 s62, s62, 10
    s_mul_i32 s62, s62, 2560
    s_add_u32 s62, s62, s16
    s_add_u32 s63, s54, s61
    v_mov_b64 v[228:229], 0
    v_mov_b32 v230, s63
F_row:
    buffer_load_dwordx3 v[220:222], v1, s[24:27], s62 offen sc1
    buffer_load_dwordx3 v[224:226], v1, s[24:27], s62 offen offset:1024 sc1
    s_mov_b32 exec_hi, 0
    buffer_load_dwordx3 v[228:230], v1, s[24:27], s62 offen offset:2048 sc1
    s_mov_b32 exec_hi, -1
    s_waitcnt vmcnt(0)
    ds_write2_b32 v16, v220, v221 offset0:0 offset1:168
    ds_write2_b32 v16, v224, v225 offset0:64 offset1:232
    s_mov_b32 exec_hi, 0
    ds_write_b32 v16, v228 offset:512
    ds_write_b32 v16, v229 offset:1184
    s_mov_b32 exec_hi, -1
    v_cmp_ne_u32 vcc, s63, v222
HF0_2:
    s_cbranch_execz HF0_3
    v_cmp_ne_u32 s[64:65], s63, v226
    s_or_b64 vcc, vcc, s[64:65]
    v_cmp_ne_u32 s[64:65], s63, v230
    s_or_b64 vcc, vcc, s[64:65]
    s_cbranch_scc0 F_ok
    s_sub_u32 s20, s20, 1
    s_cbranch_scc0 F_row
F_b1:
    s_waitcnt lgkmcnt(0)
    s_barrier
    ds_read_b128 v[200:203], v9 offset:16384
    ds_read_b128 v[204:207], v9 offset:16416
    ds_read_b128 v[208:211], v9 offset:16448
    ds_read_b128 v[212:215], v9 offset:16480
    ds_read_b128 v[216:219], v9 offset:16512
    s_waitcnt lgkmcnt(4)
    v_smfmac_f32_16x16x64_bf16 v[232:235], v[200:203], v[20:27], v252
    v_smfmac_f32_16x16x64_bf16 v[236:239], v[200:203], v[28:35], v252
    v_smfmac_f32_16x16x64_bf16 v[240:243], v[200:203], v[36:43], v252
    s_waitcnt lgkmcnt(3)
    v_smfmac_f32_16x16x64_bf16 v[232:235], v[204:207], v[44:51], v252
    v_smfmac_f32_16x16x64_bf16 v[236:239], v[204:207], v[52:59], v252
    v_smfmac_f32_16x16x64_bf16 v[240:243], v[204:207], v[60:67], v252
    s_waitcnt lgkmcnt(2)
    v_smfmac_f32_16x16x64_bf16 v[232:235], v[208:211], v[68:75], v252
    v_smfmac_f32_16x16x64_bf16 v[236:239], v[208:211], v[76:83], v252
    v_smfmac_f32_16x16x64_bf16 v[240:243], v[208:211], v[84:91], v252
    s_waitcnt lgkmcnt(1)
    v_smfmac_f32_16x16x64_bf16 v[232:235], v[212:215], v[92:99], v252
    v_smfmac_f32_16x16x64_bf16 v[236:239], v[212:215], v[100:107], v252
    v_smfmac_f32_16x16x64_bf16 v[240:243], v[212:215], v[108:115], v252
    s_waitcnt lgkmcnt(0)
    v_smfmac_f32_16x16x64_bf16 v[232:235], v[216:219], v[116:123], v252
    v_smfmac_f32_16x16x64_bf16 v[236:239], v[216:219], v[124:131], v252
    v_smfmac_f32_16x16x64_bf16 v[240:243], v[216:219], v[132:139], v252
    s_nop 8
    s_branch F_pw2
F_ok:
    v_dot2_f32_bf16 v222, v220, s67, 0
    v_dot2_f32_bf16 v223, v220, v220, 0
    v_dot2_f32_bf16 v226, v220, v10, 0
HF0_3:
    s_cbranch_execz HF0_4
    v_dot2_f32_bf16 v222, v221, s67, v222
    v_dot2_f32_bf16 v223, v221, v221, v223
    v_dot2_f32_bf16 v226, v221, v11, v226
    v_dot2_f32_bf16 v222, v224, s67, v222
    v_dot2_f32_bf16 v223, v224, v224, v223
    v_dot2_f32_bf16 v226, v224, v12, v226
    v_dot2_f32_bf16 v222, v225, s67, v222
    v_dot2_f32_bf16 v223, v225, v225, v223
    v_dot2_f32_bf16 v226, v225, v13, v226
    v_dot2_f32_bf16 v222, v228, s67, v222
    v_dot2_f32_bf16 v223, v228, v228, v223
    v_dot2_f32_bf16 v226, v228, v14, v226
    v_dot2_f32_bf16 v222, v229, s67, v222
    v_dot2_f32_bf16 v223, v229, v229, v223
    v_dot2_f32_bf16 v226, v229, v15, v226
    s_waitcnt lgkmcnt(0)
    s_barrier
    ds_read_b128 v[200:203], v9 offset:16384
    ds_read_b128 v[204:207], v9 offset:16416
    ds_read_b128 v[208:211], v9 offset:16448
    ds_read_b128 v[212:215], v9 offset:16480
    ds_read_b128 v[216:219], v9 offset:16512
    v_mov_b32 v227, v226
    v_permlane32_swap_b32 v222, v223
    s_nop 0
    v_permlane32_swap_b32 v226, v227
    v_add_f32 v222, v222, v223
    v_add_f32 v226, v226, v227
    v_mov_b32 v224, s68
    v_mov_b32 v223, s45
    v_permlane16_swap_b32 v222, v226
    v_add_f32 v222, v222, v226
    s_waitcnt lgkmcnt(4)
    v_smfmac_f32_16x16x64_bf16 v[232:235], v[200:203], v[20:27], v252
    v_add_f32_dpp v222, v222, v222 row_ror:1 row_mask:0xf bank_mask:0xf
    s_nop 1
    v_add_f32_dpp v222, v222, v222 row_ror:2 row_mask:0xf bank_mask:0xf
    v_smfmac_f32_16x16x64_bf16 v[236:239], v[200:203], v[28:35], v252
HF0_4:
    s_cbranch_execz HF0_5
    s_nop 0
    v_add_f32_dpp v222, v222, v222 row_ror:4 row_mask:0xf bank_mask:0xf
    s_nop 1
    v_add_f32_dpp v222, v222, v222 row_ror:8 row_mask:0xf bank_mask:0xf
    v_smfmac_f32_16x16x64_bf16 v[240:243], v[200:203], v[36:43], v252
    v_readlane_b32 s64, v222, 32
    v_readlane_b32 s65, v222, 16
    s_waitcnt lgkmcnt(3)
    v_smfmac_f32_16x16x64_bf16 v[232:235], v[204:207], v[44:51], v252
    v_mov_b32 v220, v222
    v_mov_b32 v221, s64
    v_smfmac_f32_16x16x64_bf16 v[236:239], v[204:207], v[52:59], v252
    v_mul_f32 v220, 0x3acccccd, v220
    v_mul_f32 v221, 0x3acccccd, v221
    v_smfmac_f32_16x16x64_bf16 v[240:243], v[204:207], v[60:67], v252
    v_fma_f32 v221, -v220, v220, v221
    v_max_f32 v221, 0, v221
    s_waitcnt lgkmcnt(2)
    v_smfmac_f32_16x16x64_bf16 v[232:235], v[208:211], v[68:75], v252
    v_cvt_pk_bf16_f32 v221, v221, v221
    v_and_b32 v221, 0xffff0000, v221
    v_smfmac_f32_16x16x64_bf16 v[236:239], v[208:211], v[76:83], v252
    v_add_f32 v221, 0x3727c5ac, v221
    v_cvt_pk_bf16_f32 v221, v221, v221
    v_smfmac_f32_16x16x64_bf16 v[240:243], v[208:211], v[84:91], v252
    v_and_b32 v221, 0xffff0000, v221
    v_sqrt_f32 v221, v221
    s_waitcnt lgkmcnt(1)
    v_smfmac_f32_16x16x64_bf16 v[232:235], v[212:215], v[92:99], v252
    v_cvt_pk_bf16_f32 v220, v220, v220
    v_and_b32 v220, 0xffff0000, v220
    v_smfmac_f32_16x16x64_bf16 v[236:239], v[212:215], v[100:107], v252
    v_cvt_pk_bf16_f32 v221, v221, v221
    v_and_b32 v221, 0xffff0000, v221
    v_smfmac_f32_16x16x64_bf16 v[240:243], v[212:215], v[108:115], v252
    v_rcp_f32 v221, v221
    v_mul_f32 v222, s55, v220
HF0_5:
    s_cbranch_execz HF0_6
    s_waitcnt lgkmcnt(0)
    v_smfmac_f32_16x16x64_bf16 v[232:235], v[216:219], v[116:123], v252
    v_sub_f32 v222, s65, v222
    v_mul_f32 v222, v222, v221
    v_smfmac_f32_16x16x64_bf16 v[236:239], v[216:219], v[124:131], v252
    v_ashrrev_i32 v225, 31, v222
    v_or_b32 v225, 0x80000000, v225
    v_smfmac_f32_16x16x64_bf16 v[240:243], v[216:219], v[132:139], v252
    v_xor_b32 v225, v225, v222
    v_and_b32 v225, 0xfffff000, v225
    v_or_b32 v225, s61, v225
    s_mov_b64 exec, 1
    ds_write2_b32 v224, v220, v221 offset0:0 offset1:2
    ds_write2_b32 v224, v222, v223 offset0:4 offset1:6
    ds_max_u64 v8, v[224:225] offset:32
    s_mov_b64 exec, -1
F_pw2:
    v_pk_add_f32 v[232:233], v[232:233], v[234:235]
    ds_write_b64 v3, v[232:233] offset:256
    v_pk_add_f32 v[236:237], v[236:237], v[238:239]
    ds_write_b64 v3, v[236:237] offset:384
    v_pk_add_f32 v[240:241], v[240:241], v[242:243]
    ds_write_b64 v3, v[240:241] offset:512
    s_cmp_ge_u32 s48, 2
    v_mov_b64 v[244:245], 0
    v_mov_b64 v[246:247], 0
    v_mov_b64 v[248:249], 0
    v_mov_b64 v[250:251], 0
    s_waitcnt lgkmcnt(0)
    s_barrier
    ds_read_b64 v[224:225], v8 offset:32
    v_mov_b64 v[232:233], 0
    v_mov_b64 v[234:235], 0
    v_mov_b64 v[236:237], 0
    v_mov_b64 v[238:239], 0
    v_mov_b64 v[240:241], 0
    v_mov_b64 v[242:243], 0
    s_waitcnt lgkmcnt(0)
    s_cbranch_scc1 F_gu
    v_add_u32 v227, v224, v4
    ds_read2_b32 v[228:229], v224 offset0:0 offset1:2
    ds_read2st64_b32 v[208:209], v227 offset0:1 offset1:4
    ds_read2st64_b32 v[210:211], v227 offset0:7 offset1:10
    s_waitcnt lgkmcnt(1)
    v_fma_f32 v208, -v228, v0, v208
HF0_6:
    s_cbranch_execz HF0_7
    v_fma_f32 v209, -v228, v2, v209
    s_waitcnt lgkmcnt(0)
    v_add_f32 v208, v208, v210
    v_add_f32 v209, v209, v211
    v_mul_f32 v208, v208, v229
    v_mul_f32 v209, v209, v229
    v_cvt_pk_bf16_f32 v209, v208, v209
    v_lshlrev_b32 v208, 16, v209
    v_mul_f32 v210, 0xbfb8aa3b, v208
    v_exp_f32 v210, v210
    v_and_b32 v209, s47, v209
    v_add_f32 v210, 1.0, v210
    v_rcp_f32 v210, v210
    s_mov_b32 exec_hi, 0xffff
    v_mul_f32 v208, v208, v210
    v_cvt_pk_bf16_f32 v208, v208, v208
    v_and_b32 v208, 0xffff0000, v208
    v_mul_f32 v208, v208, v209
    v_cvt_pk_bf16_f32 v208, v208, v208
    ds_write_b16 v5, v208 offset:3584
    s_mov_b64 exec, -1
    s_waitcnt lgkmcnt(0)
F_gu:
    s_barrier
    ds_read_b128 v[200:203], v6 offset:3584
    ds_read_b128 v[204:207], v6 offset:3648
    v_readfirstlane_b32 s61, v225
    v_mov_b32 v220, 0
    s_and_b32 s61, s61, 0xfff
    s_add_u32 s63, s54, s61
    v_mov_b32 v215, s63
    s_waitcnt lgkmcnt(1)
    v_smfmac_f32_16x16x64_bf16 v[232:235], v[200:203], v[140:147], v252
    v_smfmac_f32_16x16x64_bf16 v[236:239], v[200:203], v[152:159], v252
    v_smfmac_f32_16x16x64_bf16 v[240:243], v[200:203], v[164:171], v252
    v_smfmac_f32_16x16x64_bf16 v[244:247], v[200:203], v[176:183], v252
    v_smfmac_f32_16x16x64_bf16 v[248:251], v[200:203], v[188:195], v252
    s_cmp_lg_u32 s48, 7
    s_cbranch_scc1 F_n7
    s_mov_b64 exec, 0xffffff
    buffer_load_dwordx2 v[220:221], v7, s[24:27], s70 offen sc1
    s_mov_b64 exec, -1
F_n7:
    s_waitcnt lgkmcnt(0)
    v_smfmac_f32_16x16x64_bf16 v[232:235], v[204:207], v[144:151], v252
    v_smfmac_f32_16x16x64_bf16 v[236:239], v[204:207], v[156:163], v252
HF0_7:
    s_cbranch_execz HF0_8
    v_smfmac_f32_16x16x64_bf16 v[240:243], v[204:207], v[168:175], v252
    v_smfmac_f32_16x16x64_bf16 v[244:247], v[204:207], v[180:187], v252
    v_smfmac_f32_16x16x64_bf16 v[248:251], v[204:207], v[192:199], v252
    s_nop 7
    v_add_f32 v212, v232, v234
    v_add_f32 v213, v236, v238
    v_add_f32 v214, v240, v242
    s_mov_b32 exec_lo, s47
    v_add_f32 v212, v244, v246
    v_add_f32 v213, v248, v250
    s_mov_b32 exec_lo, -1
    s_mov_b32 exec_hi, 0
    buffer_store_dwordx4 v[212:215], v17, s[24:27], s8 offen sc1
    s_mov_b32 exec_hi, -1
    s_cmp_lt_u32 s44, 2
    s_cbranch_scc0 F_rest
    ds_read2_b32 v[228:229], v224 offset0:0 offset1:2
    ds_read2_b32 v[230:231], v224 offset0:4 offset1:6
    s_lshr_b32 s65, s61, 4
    s_mul_i32 s65, s65, 171
    s_lshr_b32 s65, s65, 10
    s_mul_i32 s64, s65, 2560
    s_add_u32 s64, s64, 131072
    s_mul_i32 s71, s65, 96
    s_sub_u32 s66, s61, s71
    s_lshr_b32 s71, s65, 1
    s_mul_i32 s71, s71, 86
    s_add_u32 s66, s66, s71
    s_sub_u32 s66, s66, 10
    s_lshl_b32 s66, s66, 1
    s_and_b32 s65, s65, 1
    s_add_u32 s66, s66, s65
    s_mul_i32 s66, s66, 1280
    v_lshrrev_b32 v223, 3, v18
    v_lshlrev_b32 v223, 4, v223
    s_waitcnt lgkmcnt(0)
    v_add_u32 v226, v231, v19
    v_and_b32 v226, 0xfffe, v226
    ds_read_u16 v226, v226
    v_cvt_pk_bf16_f32 v231, v230, v230
    v_and_b32 v231, 0xffff0000, v231
    v_mul_f32 v231, 0xbfb8aa3b, v231
    v_exp_f32 v231, v231
    s_nop 0
    v_add_f32 v231, 1.0, v231
HF0_8:
    s_cbranch_execz HF0_9
    v_rcp_f32 v231, v231
    s_waitcnt lgkmcnt(0)
    v_lshlrev_b32 v226, 16, v226
    v_cvt_pk_bf16_f32 v231, v231, v231
    v_and_b32 v231, 0xffff0000, v231
    v_sub_f32 v227, v226, v228
    v_cvt_pk_bf16_f32 v227, v227, v227
    v_and_b32 v227, 0xffff0000, v227
    v_mul_f32 v227, v227, v229
    v_cvt_pk_bf16_f32 v227, v227, v227
    v_and_b32 v227, 0xffff0000, v227
    s_waitcnt vmcnt(0)
F_yp:
    buffer_load_dwordx4 v[200:203], v1, s[24:27], s14 offen sc1
    buffer_load_dwordx4 v[204:207], v1, s[24:27], s14 offen offset:1024 sc1
    s_mov_b64 exec, s[18:19]
    buffer_load_dword v222, v223, s[24:27], s64 offen offset:8 sc1
    s_mov_b64 exec, -1
    s_waitcnt vmcnt(1)
    ds_read_b32 v224, v8 offset:40
    v_cmp_ne_u32 vcc, s63, v203
    v_cmp_ne_u32 s[58:59], s63, v207
    v_add_f32 v200, v200, v204
    v_add_f32 v201, v201, v205
    v_add_f32 v202, v202, v206
    s_or_b64 vcc, vcc, s[58:59]
    s_cbranch_scc1 F_chk
    v_mov_b32 v203, v202
    v_permlane32_swap_b32 v200, v201
    s_nop 0
    v_permlane32_swap_b32 v202, v203
    v_add_f32 v200, v200, v201
    v_add_f32 v202, v202, v203
    s_nop 1
    v_permlane16_swap_b32 v200, v202
    v_add_f32 v200, v200, v202
    s_nop 1
    v_add_f32_dpp v200, v200, v200 row_ror:8 row_mask:0xf bank_mask:0xf
    v_cvt_pk_bf16_f32 v200, v200, v200
    v_and_b32 v200, 0xffff0000, v200
    v_mul_f32 v200, v200, v231
    v_cvt_pk_bf16_f32 v200, v200, v200
    v_and_b32 v200, 0xffff0000, v200
    v_add_f32 v200, v200, v227
    v_cvt_pk_bf16_f32 v200, v200, v200
    v_and_b32 v200, 0xffff0000, v200
HF0_9:
    s_cbranch_execz HF0_10
    v_add_f32 v200, v200, v226
    v_cvt_pk_bf16_f32 v200, v200, v200
F_vf:
    s_mov_b64 exec, s[18:19]
    s_waitcnt vmcnt(0) lgkmcnt(0)
    v_readfirstlane_b32 s60, v224
    v_cmp_ne_u32 vcc, s63, v222
    s_and_b32 s62, s60, 0xfff
    s_cmp_lg_u32 s62, s61
    s_cbranch_scc1 F_vw
    s_cbranch_vccnz F_vl
    buffer_store_short v200, v18, s[40:43], s66 offen
    s_or_b32 s65, s49, s44
    s_cbranch_scc1 L_fin
    s_mov_b64 exec, 1
    v_mov_b32 v9, 0
    v_mov_b32 v10, s54
    buffer_store_dword v10, v9, s[24:27], 0 offen
    s_branch L_fin
F_vw:
    s_cmp_lg_u32 s62, 0
    s_cbranch_scc1 F_vx
    s_cbranch_vccz F_vn
F_vl:
    buffer_load_dword v222, v223, s[24:27], s64 offen offset:8 sc1
F_vn:
    ds_read_b32 v224, v8 offset:40
    s_sub_u32 s3, s3, 1
    s_cbranch_scc0 F_vf
    s_mov_b32 s3, 0
    s_branch L_fin
F_vx:
    s_cmp_eq_u32 s17, 0
    s_cbranch_scc1 F_again
    s_branch L_fin
F_chk:
    s_waitcnt lgkmcnt(0)
    v_readfirstlane_b32 s60, v224
    s_and_b32 s62, s60, 0xfff
    s_cselect_b32 s62, s62, s61
    s_cmp_lg_u32 s62, s61
    s_cbranch_scc1 F_vx
    s_sub_u32 s3, s3, 1
    s_cbranch_scc0 F_yp
    s_mov_b32 s3, 0
    s_branch L_fin
F_rest:
    s_cmp_lg_u32 s17, 0
    s_cbranch_scc1 L_fin
    s_cmp_lg_u32 s48, 7
    s_cbranch_scc1 F_tw
    s_mov_b64 exec, 0xffffff
    s_waitcnt vmcnt(1)
    s_branch F_tc
F_tp:
    buffer_load_dwordx2 v[220:221], v7, s[24:27], s70 offen sc1
    s_waitcnt vmcnt(0)
F_tc:
    v_cmp_ne_u32 vcc, s54, v221
    s_cbranch_vccz F_tg
    s_sub_u32 s3, s3, 1
    s_cbranch_scc0 F_tp
    s_mov_b32 s3, 0
F_tg:
HF0_10:
    s_cbranch_execz HF_ret
    s_mov_b64 exec, -1
    v_max_u32_dpp v222, v220, v220 row_ror:1 row_mask:0xf bank_mask:0xf
    s_nop 1
    v_max_u32_dpp v222, v222, v222 row_ror:2 row_mask:0xf bank_mask:0xf
    s_nop 1
    v_max_u32_dpp v222, v222, v222 row_ror:4 row_mask:0xf bank_mask:0xf
    s_nop 1
    v_max_u32_dpp v222, v222, v222 row_ror:8 row_mask:0xf bank_mask:0xf
    s_nop 0
    v_readlane_b32 s60, v222, 0
    v_readlane_b32 s62, v222, 16
    s_max_u32 s60, s60, s62
    s_and_b32 s62, s60, 0xfff
    s_cselect_b32 s60, s60, 1
    v_mov_b32 v220, s60
    ds_write_b32 v8, v220 offset:40
F_tw:
    ds_read_b32 v224, v8 offset:40
    s_waitcnt lgkmcnt(0)
    v_readfirstlane_b32 s60, v224
    s_and_b32 s62, s60, 0xfff
    s_cbranch_scc1 F_tk
    s_sleep 2
    s_sub_u32 s3, s3, 1
    s_cbranch_scc0 F_tw
    s_mov_b32 s3, 0
    s_branch L_fin
F_tk:
    s_cmp_eq_u32 s62, s61
    s_cbranch_scc1 L_fin
F_again:
    s_mov_b64 exec, -1
    s_waitcnt vmcnt(0)
    s_mov_b32 s17, 1
    s_mov_b32 s16, 131072
    s_mov_b32 s20, 0x40000
    v_mov_b64 v[224:225], 0
    s_cmp_eq_u32 s48, 0
    s_cselect_b32 s60, s60, 0
    s_cbranch_scc0 F_redo
    ds_write_b64 v8, v[224:225] offset:32
    s_branch F_redo
L_last:
.section .rodata,"a"
.p2align 6
.amdhsa_kernel sequential_preLN__sliding_local_dilated__moe_arch_mod__prompt_kernel
  .amdhsa_next_free_vgpr 256
  .amdhsa_next_free_sgpr 102
  .amdhsa_accum_offset 256
  .amdhsa_group_segment_fixed_size 0
  .amdhsa_kernarg_size 88
  .amdhsa_user_sgpr_count 2
  .amdhsa_user_sgpr_kernarg_segment_ptr 1
  .amdhsa_system_sgpr_workgroup_id_x 1
  .amdhsa_float_denorm_mode_32 3
  .amdhsa_float_denorm_mode_16_64 3
.end_amdhsa_kernel
```

```asm
; @launch grid=(256,1,1) block=(512,1,1) lds=163840
.amdgcn_target "amdgcn-amd-amdhsa--gfx950"
.text
.globl sequential_preLN__sliding_local_dilated__moe_arch_mod__prompt_kernel
.p2align 8
.type sequential_preLN__sliding_local_dilated__moe_arch_mod__prompt_kernel,@function
sequential_preLN__sliding_local_dilated__moe_arch_mod__prompt_kernel:
    s_load_dwordx2 s[28:29], s[0:1], 0
    s_load_dwordx2 s[32:33], s[0:1], 8
    v_readfirstlane_b32 s48, v0
    s_load_dwordx2 s[24:25], s[0:1], 80
    s_load_dwordx2 s[36:37], s[0:1], 16
    s_load_dwordx2 s[40:41], s[0:1], 64
    s_load_dwordx8 s[12:19], s[0:1], 32
    s_lshr_b32 s56, s2, 3
    s_lshr_b32 s48, s48, 6
    s_cmp_ge_u32 s2, 240
    s_cbranch_scc1 F_pre
    s_mul_i32 s51, s56, 86
    s_lshr_b32 s51, s51, 8
    s_and_b32 s66, s2, 7
    s_sub_u32 s53, s66, s51
    s_mul_i32 s53, s53, 3
    s_add_u32 s53, s53, s56
    s_lshr_b32 s55, s53, 1
    s_and_b32 s50, s53, 1
    s_mul_i32 s55, s55, 86
    s_sub_u32 s55, s55, 10
    s_mov_b32 s30, 2621440
    s_mov_b32 s31, 0x00020000
    s_sub_u32 s60, s48, 4
    s_cbranch_scc1 C_pre
    s_lshl_b32 s62, s60, 2
    s_and_b32 s62, s62, 4
    v_bfe_u32 v1, v0, 3, 3
    v_bfe_u32 v2, v0, 4, 2
    v_bitop3_b32 v3, v0, 7, s62 bitop3:0x6a
    s_mul_i32 s62, s60, 24
    s_add_u32 s62, s62, s55
    s_lshl1_add_u32 s62, s62, s50
    s_mul_i32 s62, s62, 1280
    v_xor_b32 v4, v3, v2
    v_mul_u32_u24 v5, 2560, v1
    v_lshl_add_u32 v4, v4, 4, s62
    s_movk_i32 s63, 20480
    v_add_u32 v10, v4, v5
    v_bitop3_b32 v6, v1, 2, v3 bitop3:0x6a
    v_xad_u32 v11, v10, 64, s63
    v_add_u32 v12, 40960, v10
    s_mul_i32 s62, s60, 30720
    s_lshl_b32 s63, s51, 7
    s_add_u32 s62, s62, s63
    v_mul_u32_u24 v5, 3840, v1
    v_lshl_add_u32 v6, v6, 4, s62
    s_mul_i32 s66, s66, 5
    s_lshr_b32 s66, s66, 2
    v_add_u32 v13, v5, v6
    s_mul_i32 s65, s60, 3072
    v_add_u32 v14, 256, v13
    v_add_u32 v15, 512, v13
    s_mov_b32 s34, 2457600
    s_mov_b32 s35, 0x00020000
    s_mov_b32 s64, s65
    s_add_u32 s70, s65, 110592
    s_waitcnt lgkmcnt(0)
    s_call_b64 s[98:99], LD_issue
    s_branch LD_cont
LD_issue:
    s_mov_b32 m0, s65
    s_lshl_b32 s67, s66, 7
    buffer_load_dwordx4 v10, s[28:31], s67 offen lds
    s_add_u32 m0, s65, 1024
    s_mul_i32 s68, s66, 245760
    buffer_load_dwordx4 v11, s[28:31], s67 offen lds
    s_add_u32 m0, s65, 2048
    s_add_u32 s69, s68, 122880
    buffer_load_dwordx4 v12, s[28:31], s67 offen lds
    s_add_u32 m0, s65, 12288
    s_add_u32 s66, s66, 1
    buffer_load_dwordx4 v13, s[32:35], s68 offen offset:0 lds
    buffer_load_dwordx4 v14, s[32:35], s68 offen offset:1024 lds
    buffer_load_dwordx4 v15, s[32:35], s68 offen offset:2048 lds
    s_add_u32 m0, s65, 24576
    s_cmp_eq_u32 s66, 10
    s_cselect_b32 s66, 0, s66
    buffer_load_dwordx4 v13, s[32:35], s69 offen offset:0 lds
    buffer_load_dwordx4 v14, s[32:35], s69 offen offset:1024 lds
    buffer_load_dwordx4 v15, s[32:35], s69 offen offset:2048 lds
    s_add_u32 s65, s65, 36864
    s_cmp_eq_u32 s65, s70
    s_cselect_b32 s65, s64, s65
    s_setpc_b64 s[98:99]
F_pre:
    s_cmp_ge_u32 s2, 256
    s_cbranch_scc1 L_end
    s_getpc_b64 s[58:59]
P_main:
    v_lshlrev_b32 v2, 7, v0
    v_cmp_gt_u32 vcc, L_last-P_main, v2
    s_nop 1
    v_cndmask_b32 v2, 0, v2, vcc
    global_load_dword v219, v2, s[58:59]
    s_branch F_start
C_pre:
    v_and_b32 v0, 63, v0
    s_mov_b32 s3, 0x40000
    s_mov_b32 s47, 0xffff0000
    s_mov_b32 s26, 7340032
    s_mov_b32 s27, 0x00020000
    s_mov_b32 s38, 819200
    s_mov_b32 s39, 0x00020000
    s_mov_b32 s42, 2621440
    s_mov_b32 s43, 0x00020000
    s_sub_u32 s52, s51, 5
    s_cselect_b32 s52, s51, s52
    v_and_b32 v1, 15, v0
    v_lshrrev_b32 v2, 4, v0
    s_mov_b32 s64, 0x21698350
    s_movk_i32 s65, 0x74
    s_lshl_b32 s62, s51, 2
    s_lshr_b64 s[64:65], s[64:65], s62
    s_and_b32 s64, s64, 15
    s_mul_i32 s60, s64, 12
    s_lshl_b32 s61, s48, 2
    s_add_u32 s60, s60, s61
    v_add_u32 v10, s60, v2
    v_add_u32 v11, s55, v10
    v_cmp_gt_i32 vcc, 0, v11
    v_lshl_add_u32 v11, v11, 1, s50
    v_mul_u32_u24 v11, 1280, v11
    v_lshl_add_u32 v11, v1, 4, v11
    v_cndmask_b32 v11, v11, 2.0, vcc
    s_mov_b32 s34, 1280
    s_mov_b32 s35, 0x00020000
    s_lshl_b32 s62, s53, 1
    s_add_u32 s62, s62, s64
    s_mul_i32 s62, s62, 4
    s_add_u32 s62, s62, s61
    s_sub_u32 s62, s62, 32
    s_cmp_lt_u32 s48, 1
    s_cselect_b32 s62, s62, 640
    s_mul_i32 s63, s64, 24
    s_add_u32 s63, s63, s53
    s_add_u32 s63, s63, 192
    s_cmp_lt_u32 s64, 8
    s_cselect_b32 s65, 3, 0
    s_cselect_b32 s62, s63, s62
    s_cselect_b32 s63, 192, 1
    v_lshlrev_b32 v58, 4, v0
    v_lshlrev_b32 v59, 2, v0
    s_waitcnt lgkmcnt(0)
    s_buffer_load_dword s54, s[24:27], 0
    s_mov_b64 s[32:33], s[12:13]
    s_cmp_lt_u32 s48, s65
    s_cbranch_scc0 A_nors
    buffer_load_dwordx4 v[20:23], v11, s[28:31], 0 offen offset:0
    buffer_load_dwordx4 v[24:27], v11, s[28:31], 0 offen offset:256
    buffer_load_dwordx4 v[28:31], v11, s[28:31], 0 offen offset:512
    buffer_load_dwordx4 v[32:35], v11, s[28:31], 0 offen offset:768
    buffer_load_dwordx4 v[36:39], v11, s[28:31], 0 offen offset:1024
    s_branch A_cons
A_nors:
    s_cmp_lg_u32 s48, 3
    s_cbranch_scc1 A_nowr
    buffer_load_dwordx4 v[48:51], v58, s[32:35], 0 offen
    buffer_load_dword v52, v59, s[32:35], 0 offen offset:1024
A_nowr:
    s_cmp_ge_u32 s62, 640
    s_cbranch_scc1 A_cons
    v_mul_u32_u24 v10, s63, v2
    v_add_u32 v10, s62, v10
    v_lshlrev_b32 v12, 4, v1
    v_mul_u32_u24 v11, 1280, v10
    v_add_u32 v11, v11, v12
    buffer_load_dwordx4 v[76:79], v12, s[32:35], 0 offen offset:0
    buffer_load_dwordx4 v[80:83], v12, s[32:35], 0 offen offset:256
    buffer_load_dwordx4 v[84:87], v12, s[32:35], 0 offen offset:512
    buffer_load_dwordx4 v[88:91], v12, s[32:35], 0 offen offset:768
    buffer_load_dwordx4 v[92:95], v12, s[32:35], 0 offen offset:1024
    buffer_load_dwordx4 v[20:23], v11, s[36:39], 0 offen offset:0
    buffer_load_dwordx4 v[24:27], v11, s[36:39], 0 offen offset:256
    buffer_load_dwordx4 v[28:31], v11, s[36:39], 0 offen offset:512
    buffer_load_dwordx4 v[32:35], v11, s[36:39], 0 offen offset:768
    buffer_load_dwordx4 v[36:39], v11, s[36:39], 0 offen offset:1024
A_cons:
    v_mov_b32 v99, 2.0
    v_lshrrev_b32 v3, 1, v1
    v_xor_b32 v3, v3, v2
    v_lshlrev_b32 v3, 4, v3
    v_lshl_add_u32 v4, v1, 7, v3
    v_xor_b32 v5, 64, v4
    v_cmp_eq_u32 vcc, 0, v1
    v_mov_b32 v3, 159744
    s_nop 0
    v_cndmask_b32 v6, v4, v3, vcc
    v_cndmask_b32 v7, v5, v3, vcc
    v_cndmask_b32 v8, 1, 0, vcc
    v_bfe_u32 v14, v0, 2, 2
    v_and_b32 v15, 3, v0
    v_lshrrev_b32 v16, 1, v14
    v_and_b32 v17, 1, v2
    v_lshl_or_b32 v16, v17, 1, v16
    v_xor_b32 v16, s48, v16
    v_lshlrev_b32 v16, 5, v16
    v_lshl_add_u32 v16, v15, 3, v16
    v_lshl_add_u32 v16, v14, 7, v16
    v_mul_u32_u24 v17, 3072, v2
    v_add_u32 v9, v16, v17
    v_mov_b32 v16, 0x3f803f80
    v_mov_b32 v17, v16
    v_mov_b32 v18, v16
    v_mov_b32 v19, v16
    ds_write_b128 v3, v[16:19]
    v_mov_b64 v[100:101], 0
    v_mov_b64 v[102:103], 0
    v_mov_b64 v[104:105], 0
    v_mov_b64 v[106:107], 0
    v_mov_b64 v[108:109], 0
    v_mov_b64 v[110:111], 0
    v_mov_b64 v[112:113], 0
    v_mov_b64 v[114:115], 0
    v_mov_b64 v[116:117], 0
    v_mov_b64 v[118:119], 0
    v_mov_b64 v[120:121], 0
    v_mov_b64 v[122:123], 0
    v_mov_b64 v[124:125], 0
    v_mov_b64 v[126:127], 0
    v_mov_b64 v[128:129], 0
    v_mov_b64 v[130:131], 0
    v_mov_b64 v[132:133], 0
    v_mov_b64 v[134:135], 0
    v_mov_b64 v[136:137], 0
    v_mov_b64 v[138:139], 0
    v_mov_b64 v[140:141], 0
    v_mov_b64 v[142:143], 0
    v_mov_b64 v[144:145], 0
    v_mov_b64 v[146:147], 0
    v_mov_b64 v[148:149], 0
    v_mov_b64 v[150:151], 0
    v_mov_b64 v[152:153], 0
    v_mov_b64 v[154:155], 0
    v_mov_b64 v[156:157], 0
    v_mov_b64 v[158:159], 0
    v_mov_b64 v[160:161], 0
    v_mov_b64 v[162:163], 0
    v_mov_b64 v[164:165], 0
    v_mov_b64 v[166:167], 0
    v_mov_b64 v[168:169], 0
    v_mov_b64 v[170:171], 0
    s_call_b64 s[98:99], S_late
    s_call_b64 s[98:99], S_late2
    s_call_b64 s[98:99], S_late3
    s_call_b64 s[98:99], S_late4
    s_branch A_c2
S_late:
    v_and_b32 v200, 15, v0
    v_lshrrev_b32 v201, 4, v0
    v_lshlrev_b32 v202, 4, v0
    v_lshlrev_b32 v203, 2, v0
    v_lshrrev_b32 v64, 5, v0
    v_and_b32 v65, 12, v200
    s_lshl_b32 s4, s52, 3
    s_sub_u32 s4, 96768, s4
    s_min_u32 s5, s48, 5
    s_lshl_b32 s6, s5, 4
    v_add_u32 v67, s6, v200
    v_mul_u32_u24 v68, 400, v67
    v_mad_u32_u24 v66, v201, 40, s4
    v_add_u32 v71, v68, v66
    v_subrev_u32 v205, 3072, v71
    v_mul_u32_u24 v72, 5, v201
    v_subrev_u32 v72, s52, v72
    v_mov_b32 v73, 159776
    v_add_u32 v74, 0, v72
    v_cmp_gt_u32 vcc, 16, v74
    v_add_u32 v74, 0, v71
    s_nop 0
    v_cndmask_b32 v204, v73, v74, vcc
    v_add_u32 v74, 1, v72
    v_cmp_gt_u32 vcc, 16, v74
    v_add_u32 v74, 8, v71
    s_nop 0
    v_cndmask_b32 v229, v73, v74, vcc
    v_add_u32 v74, 2, v72
    v_cmp_gt_u32 vcc, 16, v74
    v_add_u32 v74, 16, v71
    s_nop 0
    v_cndmask_b32 v230, v73, v74, vcc
    v_add_u32 v74, 3, v72
    v_cmp_gt_u32 vcc, 16, v74
    v_add_u32 v74, 24, v71
    s_nop 0
    v_cndmask_b32 v231, v73, v74, vcc
    v_add_u32 v74, 4, v72
    v_cmp_gt_u32 vcc, 16, v74
    v_add_u32 v74, 32, v71
    s_nop 0
    v_cndmask_b32 v255, v73, v74, vcc
    v_lshlrev_b32 v208, 3, v67
    v_add_u32 v208, 159808, v208
    v_add_u32 v69, s6, v65
    v_lshlrev_b32 v209, 3, v69
    v_add_u32 v209, 159748, v209
    v_and_b32 v70, 3, v0
    v_cmp_gt_u32 vcc, 1, v70
    v_mov_b32 v73, s47
    s_nop 0
    v_cndmask_b32 v207, 0, v73, vcc
    v_cmp_gt_u32 vcc, 3, v70
    s_nop 1
    v_cndmask_b32 v211, 0, v73, vcc
    v_cmp_gt_u32 vcc, 2, v70
    s_nop 1
    v_cndmask_b32 v211, v211, -1, vcc
    s_setpc_b64 s[98:99]
S_late2:
    s_lshl_b32 s7, s5, 12
    s_add_u32 s7, s7, 135184
    v_lshl_add_u32 v66, v0, 6, s7
    v_lshl_add_u32 v210, v65, 1, v66
    s_add_u32 s13, s6, s55
    v_add_u32 v212, s13, v65
    s_mul_i32 s8, s53, 6
    s_mul_i32 s9, s8, 24320
    s_add_u32 s9, s9, 1310720
    s_mul_i32 s0, s48, 24320
    s_add_u32 s0, s0, s9
    v_lshlrev_b32 v206, 4, v200
    v_lshl_add_u32 v206, v64, 8, v206
    v_xor_b32 v213, 256, v206
    v_lshl_add_u32 v213, v64, 12, v213
    s_cmp_lg_u32 s52, 0
    s_cselect_b32 s20, 0x0000ffff, 0
    s_cmp_lg_u32 s52, 4
    s_cselect_b32 s21, s47, 0
    s_cmp_eq_u32 s48, 0
    s_cselect_b32 s7, 0xff00ff00, -1
    s_and_b32 s20, s20, s7
    s_and_b32 s21, s21, s7
    s_lshl_b32 s7, s51, 11
    s_add_u32 s22, s0, s7
    s_sub_u32 s12, s22, 2048
    s_add_u32 s100, s9, 23040
    s_lshr_b32 s7, s51, 1
    s_mul_i32 s7, s7, 23552
    s_mul_i32 s57, s51, 384
    s_add_u32 s7, s7, s57
    s_add_u32 s7, s7, 23552
    s_add_u32 s57, s7, s9
    s_mul_i32 s7, s48, 10
    s_add_u32 s7, s7, s51
    s_lshl_b32 s7, s7, 2
    s_add_u32 s23, s100, s7
    s_sub_u32 s56, s48, 2
    s_cmp_lt_u32 s48, 6
    s_cselect_b32 s101, 0, 1
    s_cselect_b32 s56, s48, s56
    s_mul_i32 s1, s56, 24320
    s_add_u32 s1, s1, s9
    s_add_u32 s8, s8, s56
    s_mul_i32 s44, s53, 2560
    s_lshl_b32 s7, s51, 8
    s_add_u32 s44, s44, s7
    s_add_u32 s44, s44, 262144
    s_lshl_b32 s45, s53, 6
    s_add_u32 s45, s45, 196608
    s_setpc_b64 s[98:99]
S_late3:
    v_bfe_u32 v68, v0, 2, 2
    v_and_b32 v69, 3, v0
    v_lshl_add_u32 v70, v201, 3, v68
    s_lshl_b32 s7, s48, 4
    s_sub_u32 s7, s7, 16
    v_add_u32 v71, s7, v70
    v_and_b32 v72, 15, v71
    v_max_i32 v71, v71, v72
    v_mul_u32_u24 v71, 400, v71
    v_lshl_add_u32 v71, v69, 3, v71
    v_add_u32 v214, 97024, v71
    v_and_b32 v72, 1, v201
    s_cmp_eq_u32 s48, 0
    s_cselect_b32 s7, 8, 0
    v_cmp_gt_u32 vcc, s7, v200
    s_nop 1
    v_cndmask_b32 v249, v202, 2.0, vcc
    v_lshrrev_b32 v71, 1, v68
    v_lshl_or_b32 v71, v72, 1, v71
    v_lshl_add_u32 v70, v201, 2, v68
    v_lshlrev_b32 v70, 7, v70
    v_lshl_add_u32 v70, v69, 3, v70
    s_mul_i32 s7, s101, 40960
    s_add_u32 s7, s7, 12288
    v_add_u32 v70, s7, v70
    s_mul_i32 s7, s101, 36864
    s_sub_u32 s7, 40960, s7
    v_xor_b32 v73, 0, v71
    v_lshl_add_u32 v216, v73, 5, v70
    v_add_u32 v220, s7, v216
    v_xor_b32 v73, 1, v71
    v_lshl_add_u32 v217, v73, 5, v70
    v_add_u32 v221, s7, v217
    v_xor_b32 v73, 2, v71
    v_lshl_add_u32 v218, v73, 5, v70
    v_add_u32 v222, s7, v218
    v_xor_b32 v73, 3, v71
    v_lshl_add_u32 v219, v73, 5, v70
    v_add_u32 v223, s7, v219
    s_setpc_b64 s[98:99]
S_late4:
    s_lshl_b32 s7, s56, 4
    v_add_u32 v73, s7, v200
    v_cmp_gt_u32 vcc, 10, v73
    v_add_u32 v73, s55, v73
    v_lshl_add_u32 v73, v73, 1, s50
    v_mul_u32_u24 v74, 1280, v73
    s_lshl_b32 s7, s51, 7
    v_lshl_add_u32 v75, v201, 3, s7
    v_add_u32 v74, v74, v75
    v_cndmask_b32 v253, v74, 2.0, vcc
    v_cndmask_b32 v254, v73, -1, vcc
    v_add_u32 v227, 161792, v75
    v_mul_u32_u24 v224, 61440, v201
    v_lshl_add_u32 v224, v200, 4, v224
    s_mov_b32 s7, 161024
    v_lshl_add_u32 v228, v201, 5, s7
    v_lshl_add_u32 v252, v69, 5, s7
    v_lshl_add_u32 v252, v68, 3, v252
    v_mul_u32_u24 v225, 24, v72
    v_add_u32 v225, v225, v253
    v_lshl_add_u32 v226, s8, 4, v200
    s_cmp_eq_u32 s101, 1
    s_cselect_b64 vcc, -1, 0
    v_cndmask_b32 v250, v225, 2.0, vcc
    v_mov_b32 v251, 160784
    s_add_u32 s7, s52, 5
    s_cmp_lt_u32 s51, 5
    s_cselect_b32 s7, s7, s52
    s_lshl_b32 s7, s7, 11
    s_add_u32 s16, s7, s1
    s_lshl_b32 s7, s51, 11
    s_add_u32 s14, s7, s1
    s_add_u32 s15, s1, 20480
    s_cmp_eq_u32 s101, 1
    s_cselect_b32 s14, s16, s14
    s_cselect_b32 s18, 0x3e0, 62
    s_lshl_b32 s7, s101, 10
    s_add_u32 s16, s16, s7
    s_cmp_lt_u32 s48, 4
    s_cselect_b32 s18, 0x3fe, s18
    s_lshl_b32 s18, s18, s51
    s_lshr_b32 s7, s18, 10
    s_or_b32 s18, s18, s7
    s_and_b32 s18, s18, 0x3ff
    s_mov_b32 s19, 0
    s_mul_i32 s17, s56, 40
    s_add_u32 s17, s17, s100
    s_lshl_b32 s7, s48, 12
    s_add_u32 s7, s7, 135168
    v_lshl_add_u32 v73, v200, 6, s7
    v_lshl_add_u32 v73, v201, 4, v73
    v_add_u32 v74, s52, v201
    s_add_u32 s46, s52, 0
    s_mul_i32 s46, s46, 52
    s_lshr_b32 s46, s46, 8
    v_lshl_add_u32 v172, s46, 10, v73
    s_add_u32 s46, s52, 3
    s_mul_i32 s46, s46, 52
    s_lshr_b32 s46, s46, 8
    v_lshl_add_u32 v173, s46, 10, v73
    s_mul_i32 s46, s46, 5
    s_sub_u32 s46, s46, 0
    v_cmp_le_i32 s[4:5], s46, v74
    s_add_u32 s46, s52, 4
    s_mul_i32 s46, s46, 52
    s_lshr_b32 s46, s46, 8
    v_lshl_add_u32 v174, s46, 10, v73
    s_add_u32 s46, s52, 7
    s_mul_i32 s46, s46, 52
    s_lshr_b32 s46, s46, 8
    v_lshl_add_u32 v175, s46, 10, v73
    s_mul_i32 s46, s46, 5
    s_sub_u32 s46, s46, 4
    v_cmp_le_i32 s[6:7], s46, v74
    s_add_u32 s46, s52, 8
    s_mul_i32 s46, s46, 52
    s_lshr_b32 s46, s46, 8
    v_lshl_add_u32 v176, s46, 10, v73
    s_add_u32 s46, s52, 11
    s_mul_i32 s46, s46, 52
    s_lshr_b32 s46, s46, 8
    v_lshl_add_u32 v177, s46, 10, v73
    s_mul_i32 s46, s46, 5
    s_sub_u32 s46, s46, 8
    v_cmp_le_i32 s[8:9], s46, v74
    s_add_u32 s46, s52, 12
    s_mul_i32 s46, s46, 52
    s_lshr_b32 s46, s46, 8
    v_lshl_add_u32 v178, s46, 10, v73
    s_add_u32 s46, s52, 15
    s_mul_i32 s46, s46, 52
    s_lshr_b32 s46, s46, 8
    v_lshl_add_u32 v179, s46, 10, v73
    s_mul_i32 s46, s46, 5
    s_sub_u32 s46, s46, 12
    v_cmp_le_i32 s[10:11], s46, v74
    s_setpc_b64 s[98:99]
A_c2:
    s_waitcnt lgkmcnt(0)
    s_add_u32 s54, s54, 2654435761
    s_lshl_b32 s63, s53, 11
    s_add_u32 s63, s63, 81920
    v_mov_b32 v42, s54
    v_lshlrev_b32 v10, 4, v10
    s_cmp_lt_u32 s48, s65
    s_cbranch_scc0 A_nos
    s_waitcnt vmcnt(4)
    v_dot2_f32_bf16 v40, v20, v16, 0
    v_dot2_f32_bf16 v41, v20, v20, 0
    v_dot2_f32_bf16 v44, v21, v16, 0
    v_dot2_f32_bf16 v45, v21, v21, 0
    v_dot2_f32_bf16 v40, v22, v16, v40
    v_dot2_f32_bf16 v41, v22, v22, v41
    v_dot2_f32_bf16 v44, v23, v16, v44
    v_dot2_f32_bf16 v45, v23, v23, v45
    s_waitcnt vmcnt(3)
    v_dot2_f32_bf16 v40, v24, v16, v40
    v_dot2_f32_bf16 v41, v24, v24, v41
    v_dot2_f32_bf16 v44, v25, v16, v44
    v_dot2_f32_bf16 v45, v25, v25, v45
    v_dot2_f32_bf16 v40, v26, v16, v40
    v_dot2_f32_bf16 v41, v26, v26, v41
    v_dot2_f32_bf16 v44, v27, v16, v44
    v_dot2_f32_bf16 v45, v27, v27, v45
    s_waitcnt vmcnt(2)
    v_dot2_f32_bf16 v40, v28, v16, v40
    v_dot2_f32_bf16 v41, v28, v28, v41
    v_dot2_f32_bf16 v44, v29, v16, v44
    v_dot2_f32_bf16 v45, v29, v29, v45
    v_dot2_f32_bf16 v40, v30, v16, v40
    v_dot2_f32_bf16 v41, v30, v30, v41
    v_dot2_f32_bf16 v44, v31, v16, v44
    v_dot2_f32_bf16 v45, v31, v31, v45
    s_waitcnt vmcnt(1)
    v_dot2_f32_bf16 v40, v32, v16, v40
    v_dot2_f32_bf16 v41, v32, v32, v41
    v_dot2_f32_bf16 v44, v33, v16, v44
    v_dot2_f32_bf16 v45, v33, v33, v45
    v_dot2_f32_bf16 v40, v34, v16, v40
    v_dot2_f32_bf16 v41, v34, v34, v41
    v_dot2_f32_bf16 v44, v35, v16, v44
    v_dot2_f32_bf16 v45, v35, v35, v45
    s_waitcnt vmcnt(0)
    v_dot2_f32_bf16 v40, v36, v16, v40
    v_dot2_f32_bf16 v41, v36, v36, v41
    v_dot2_f32_bf16 v44, v37, v16, v44
    v_dot2_f32_bf16 v45, v37, v37, v45
    v_dot2_f32_bf16 v40, v38, v16, v40
    v_dot2_f32_bf16 v41, v38, v38, v41
    v_dot2_f32_bf16 v44, v39, v16, v44
    v_dot2_f32_bf16 v45, v39, v39, v45
A_red:
    s_nop 1
    v_add_f32 v40, v40, v44
    v_add_f32 v41, v41, v45
    s_nop 0
    v_add_f32_dpp v40, v40, v40 row_ror:1 row_mask:0xf bank_mask:0xf
    v_add_f32_dpp v41, v41, v41 row_ror:1 row_mask:0xf bank_mask:0xf
    s_nop 0
    v_add_f32_dpp v40, v40, v40 row_ror:2 row_mask:0xf bank_mask:0xf
    v_add_f32_dpp v41, v41, v41 row_ror:2 row_mask:0xf bank_mask:0xf
    s_nop 0
    v_add_f32_dpp v40, v40, v40 row_ror:4 row_mask:0xf bank_mask:0xf
    v_add_f32_dpp v41, v41, v41 row_ror:4 row_mask:0xf bank_mask:0xf
    s_nop 0
    v_add_f32_dpp v40, v40, v40 row_ror:8 row_mask:0xf bank_mask:0xf
    v_add_f32_dpp v41, v41, v41 row_ror:8 row_mask:0xf bank_mask:0xf
    s_cselect_b32 s64, s63, 1245184
    s_cbranch_scc0 A_nln
    v_mul_f32 v40, 0x3acccccd, v40
    v_mul_f32 v41, 0x3acccccd, v41
    v_fma_f32 v41, -v40, v40, v41
    v_max_f32 v41, 0, v41
    v_cvt_pk_bf16_f32 v41, v41, v41
    v_and_b32 v41, 0xffff0000, v41
    v_add_f32 v41, 0x3727c5ac, v41
    v_cvt_pk_bf16_f32 v41, v41, v41
    v_and_b32 v41, 0xffff0000, v41
    v_sqrt_f32 v41, v41
    v_cvt_pk_bf16_f32 v40, v40, v40
    v_and_b32 v40, 0xffff0000, v40
    v_cvt_pk_bf16_f32 v41, v41, v41
    v_and_b32 v41, 0xffff0000, v41
    v_rcp_f32 v41, v41
A_nln:
    s_mov_b32 exec_lo, 0x00010001
    s_mov_b32 exec_hi, 0x00010001
    buffer_store_dwordx3 v[40:42], v10, s[24:27], s64 offen sc1
    s_mov_b64 exec, -1
A_w3:
    s_cmp_lg_u32 s48, 3
    s_cbranch_scc1 A_go
    s_getreg_b32 s61, hwreg(HW_REG_XCC_ID)
    s_lshl_b32 s64, s51, 4
    s_add_u32 s64, s64, 1536
    v_mov_b32 v44, s61
    v_mov_b32 v43, s64
    v_mov_b32 v46, s54
    s_mov_b64 exec, 1
    buffer_store_dwordx3 v[44:46], v43, s[24:27], s63 offen sc1
    s_mov_b64 exec, -1
    v_add_u32 v58, 161792, v58
    v_add_u32 v59, 161792, v59
    s_cmp_lt_u32 s62, 640
    s_cbranch_scc1 A_w3l
    s_waitcnt vmcnt(1)
A_w3l:
    ds_write_b128 v58, v[48:51]
    ds_write_b32 v59, v52 offset:1024
    v_dot2_f32_bf16 v25, v48, v16, 0
    v_dot2_f32_bf16 v25, v49, v16, v25
    v_dot2_f32_bf16 v25, v50, v16, v25
    v_dot2_f32_bf16 v25, v51, v16, v25
    v_dot2_f32_bf16 v25, v52, v16, v25
    s_nop 2
    v_add_f32_dpp v25, v25, v25 row_ror:1 row_mask:0xf bank_mask:0xf
    s_nop 1
    v_add_f32_dpp v25, v25, v25 row_ror:2 row_mask:0xf bank_mask:0xf
    s_nop 1
    v_add_f32_dpp v25, v25, v25 row_ror:4 row_mask:0xf bank_mask:0xf
    s_nop 1
    v_add_f32_dpp v25, v25, v25 row_ror:8 row_mask:0xf bank_mask:0xf
    v_mov_b32 v26, v25
    s_nop 1
    v_permlane32_swap_b32 v25, v26
    v_add_f32 v25, v25, v26
    v_mov_b32 v26, v25
    s_nop 1
    v_permlane16_swap_b32 v25, v26
    v_add_f32 v25, v25, v26
    v_mov_b32 v58, 161792
    ds_write_b32 v58, v25 offset:1280
    s_waitcnt lgkmcnt(0)
    s_branch A_go
A_nos:
    s_cmp_ge_u32 s62, 640
    s_cbranch_scc1 A_w3
    s_waitcnt vmcnt(4)
    v_dot2_f32_bf16 v40, v20, v16, 0
    v_dot2_f32_bf16 v41, v20, v76, 0
    v_dot2_f32_bf16 v44, v21, v16, 0
    v_dot2_f32_bf16 v45, v21, v77, 0
    v_dot2_f32_bf16 v40, v22, v16, v40
    v_dot2_f32_bf16 v41, v22, v78, v41
    v_dot2_f32_bf16 v44, v23, v16, v44
    v_dot2_f32_bf16 v45, v23, v79, v45
    s_waitcnt vmcnt(3)
    v_dot2_f32_bf16 v40, v24, v16, v40
    v_dot2_f32_bf16 v41, v24, v80, v41
    v_dot2_f32_bf16 v44, v25, v16, v44
    v_dot2_f32_bf16 v45, v25, v81, v45
    v_dot2_f32_bf16 v40, v26, v16, v40
    v_dot2_f32_bf16 v41, v26, v82, v41
    v_dot2_f32_bf16 v44, v27, v16, v44
    v_dot2_f32_bf16 v45, v27, v83, v45
    s_waitcnt vmcnt(2)
    v_dot2_f32_bf16 v40, v28, v16, v40
    v_dot2_f32_bf16 v41, v28, v84, v41
    v_dot2_f32_bf16 v44, v29, v16, v44
    v_dot2_f32_bf16 v45, v29, v85, v45
    v_dot2_f32_bf16 v40, v30, v16, v40
    v_dot2_f32_bf16 v41, v30, v86, v41
    v_dot2_f32_bf16 v44, v31, v16, v44
    v_dot2_f32_bf16 v45, v31, v87, v45
    s_waitcnt vmcnt(1)
    v_dot2_f32_bf16 v40, v32, v16, v40
    v_dot2_f32_bf16 v41, v32, v88, v41
    v_dot2_f32_bf16 v44, v33, v16, v44
    v_dot2_f32_bf16 v45, v33, v89, v45
    v_dot2_f32_bf16 v40, v34, v16, v40
    v_dot2_f32_bf16 v41, v34, v90, v41
    v_dot2_f32_bf16 v44, v35, v16, v44
    v_dot2_f32_bf16 v45, v35, v91, v45
    s_waitcnt vmcnt(0)
    v_dot2_f32_bf16 v40, v36, v16, v40
    v_dot2_f32_bf16 v41, v36, v92, v41
    v_dot2_f32_bf16 v44, v37, v16, v44
    v_dot2_f32_bf16 v45, v37, v93, v45
    v_dot2_f32_bf16 v40, v38, v16, v40
    v_dot2_f32_bf16 v41, v38, v94, v41
    v_dot2_f32_bf16 v44, v39, v16, v44
    v_dot2_f32_bf16 v45, v39, v95, v45
    s_branch A_red
A_go:
    v_lshlrev_b32 v18, 3, v1
    v_add_u32 v18, 159808, v18
    v_mul_u32_u24 v3, 400, v1
    v_lshl_add_u32 v3, v2, 3, v3
    s_lshl_b32 s60, s48, 5
    s_add_u32 s60, s60, 96768
    v_add_u32 v3, s60, v3
    v_mov_b32 v17, 160768
    s_mov_b32 s60, 0
    v_add_u32 v14, s60, v9
    v_mad_u32_u24 v10, v8, s60, v6
    v_add_u32 v12, s60, v4
    v_mad_u32_u24 v11, v8, s60, v7
    v_add_u32 v13, s60, v5
    s_mov_b32 s61, 0
    s_barrier
    ds_read_b64_tr_b16 v[44:45], v14 offset:12288
    ds_read_b64_tr_b16 v[46:47], v14 offset:12800
    ds_read_b64_tr_b16 v[48:49], v14 offset:13312
    ds_read_b64_tr_b16 v[50:51], v14 offset:13824
    ds_read_b64_tr_b16 v[52:53], v14 offset:14336
    ds_read_b64_tr_b16 v[54:55], v14 offset:14848
    ds_read_b128 v[20:23], v10
    ds_read_b128 v[24:27], v12 offset:2048
    ds_read_b128 v[28:31], v12 offset:4096
    ds_read_b128 v[32:35], v12 offset:6144
    ds_read_b128 v[36:39], v12 offset:8192
    ds_read_b128 v[40:43], v12 offset:10240
A_loop:
    s_waitcnt lgkmcnt(0)
    v_mfma_f32_16x16x32_bf16 v[100:103], v[44:47], v[20:23], v[100:103]
    ds_read_b64_tr_b16 v[80:81], v14 offset:24576
    v_mfma_f32_16x16x32_bf16 v[104:107], v[48:51], v[20:23], v[104:107]
    ds_read_b64_tr_b16 v[82:83], v14 offset:25088
    v_mfma_f32_16x16x32_bf16 v[108:111], v[52:55], v[20:23], v[108:111]
    ds_read_b64_tr_b16 v[84:85], v14 offset:25600
    v_mfma_f32_16x16x32_bf16 v[112:115], v[44:47], v[24:27], v[112:115]
    ds_read_b64_tr_b16 v[86:87], v14 offset:26112
    v_mfma_f32_16x16x32_bf16 v[116:119], v[48:51], v[24:27], v[116:119]
    ds_read_b64_tr_b16 v[88:89], v14 offset:26624
    v_mfma_f32_16x16x32_bf16 v[120:123], v[52:55], v[24:27], v[120:123]
    ds_read_b64_tr_b16 v[90:91], v14 offset:27136
    v_mfma_f32_16x16x32_bf16 v[124:127], v[44:47], v[28:31], v[124:127]
    ds_read_b128 v[56:59], v11
    v_mfma_f32_16x16x32_bf16 v[128:131], v[48:51], v[28:31], v[128:131]
    ds_read_b128 v[60:63], v13 offset:2048
    v_mfma_f32_16x16x32_bf16 v[132:135], v[52:55], v[28:31], v[132:135]
    ds_read_b128 v[64:67], v13 offset:4096
    v_mfma_f32_16x16x32_bf16 v[136:139], v[44:47], v[32:35], v[136:139]
    ds_read_b128 v[68:71], v13 offset:6144
    v_mfma_f32_16x16x32_bf16 v[140:143], v[48:51], v[32:35], v[140:143]
    ds_read_b128 v[72:75], v13 offset:8192
    v_mfma_f32_16x16x32_bf16 v[144:147], v[52:55], v[32:35], v[144:147]
    ds_read_b128 v[76:79], v13 offset:10240
    v_mfma_f32_16x16x32_bf16 v[148:151], v[44:47], v[36:39], v[148:151]
    s_add_u32 s60, s60, 36864
    v_mfma_f32_16x16x32_bf16 v[152:155], v[48:51], v[36:39], v[152:155]
    s_add_u32 s61, s61, 1
    v_mfma_f32_16x16x32_bf16 v[156:159], v[52:55], v[36:39], v[156:159]
    s_cmp_eq_u32 s60, 110592
    v_mfma_f32_16x16x32_bf16 v[160:163], v[44:47], v[40:43], v[160:163]
    s_cselect_b32 s60, 0, s60
    v_mfma_f32_16x16x32_bf16 v[164:167], v[48:51], v[40:43], v[164:167]
    s_cmp_lt_u32 s61, 9
    v_mfma_f32_16x16x32_bf16 v[168:171], v[52:55], v[40:43], v[168:171]
    s_waitcnt lgkmcnt(0)
    v_mfma_f32_16x16x32_bf16 v[100:103], v[80:83], v[56:59], v[100:103]
    v_add_u32 v14, s60, v9
    v_mfma_f32_16x16x32_bf16 v[104:107], v[84:87], v[56:59], v[104:107]
    v_mad_u32_u24 v10, v8, s60, v6
    v_mfma_f32_16x16x32_bf16 v[108:111], v[88:91], v[56:59], v[108:111]
    v_add_u32 v12, s60, v4
    v_mfma_f32_16x16x32_bf16 v[112:115], v[80:83], v[60:63], v[112:115]
    v_mad_u32_u24 v11, v8, s60, v7
    v_mfma_f32_16x16x32_bf16 v[116:119], v[84:87], v[60:63], v[116:119]
    v_add_u32 v13, s60, v5
    v_mfma_f32_16x16x32_bf16 v[120:123], v[88:91], v[60:63], v[120:123]
    s_barrier
    v_mfma_f32_16x16x32_bf16 v[124:127], v[80:83], v[64:67], v[124:127]
    ds_read_b64_tr_b16 v[44:45], v14 offset:12288
    ds_read_b64_tr_b16 v[46:47], v14 offset:12800
    v_mfma_f32_16x16x32_bf16 v[128:131], v[84:87], v[64:67], v[128:131]
    ds_read_b64_tr_b16 v[48:49], v14 offset:13312
    ds_read_b64_tr_b16 v[50:51], v14 offset:13824
    v_mfma_f32_16x16x32_bf16 v[132:135], v[88:91], v[64:67], v[132:135]
    ds_read_b64_tr_b16 v[52:53], v14 offset:14336
    ds_read_b64_tr_b16 v[54:55], v14 offset:14848
    v_mfma_f32_16x16x32_bf16 v[136:139], v[80:83], v[68:71], v[136:139]
    ds_read_b128 v[20:23], v10
    ds_read_b128 v[24:27], v12 offset:2048
    v_mfma_f32_16x16x32_bf16 v[140:143], v[84:87], v[68:71], v[140:143]
    ds_read_b128 v[28:31], v12 offset:4096
    ds_read_b128 v[32:35], v12 offset:6144
    v_mfma_f32_16x16x32_bf16 v[144:147], v[88:91], v[68:71], v[144:147]
    ds_read_b128 v[36:39], v12 offset:8192
    ds_read_b128 v[40:43], v12 offset:10240
    v_mfma_f32_16x16x32_bf16 v[148:151], v[80:83], v[72:75], v[148:151]
    v_mfma_f32_16x16x32_bf16 v[152:155], v[84:87], v[72:75], v[152:155]
    v_mfma_f32_16x16x32_bf16 v[156:159], v[88:91], v[72:75], v[156:159]
    v_mfma_f32_16x16x32_bf16 v[160:163], v[80:83], v[76:79], v[160:163]
    v_mfma_f32_16x16x32_bf16 v[164:167], v[84:87], v[76:79], v[164:167]
    v_mfma_f32_16x16x32_bf16 v[168:171], v[88:91], v[76:79], v[168:171]
    s_cbranch_scc1 A_loop
A_tail:
    s_waitcnt lgkmcnt(0)
    v_mfma_f32_16x16x32_bf16 v[108:111], v[52:55], v[20:23], v[108:111]
    ds_read_b64_tr_b16 v[80:81], v14 offset:24576
    ds_read_b64_tr_b16 v[82:83], v14 offset:25088
    v_mfma_f32_16x16x32_bf16 v[120:123], v[52:55], v[24:27], v[120:123]
    ds_read_b64_tr_b16 v[84:85], v14 offset:25600
    ds_read_b64_tr_b16 v[86:87], v14 offset:26112
    v_mfma_f32_16x16x32_bf16 v[132:135], v[52:55], v[28:31], v[132:135]
    ds_read_b128 v[56:59], v11
    ds_read_b128 v[60:63], v13 offset:2048
    v_mfma_f32_16x16x32_bf16 v[144:147], v[52:55], v[32:35], v[144:147]
    ds_read_b64 v[184:185], v18 offset:0
    ds_read_b64 v[186:187], v18 offset:128
    v_mfma_f32_16x16x32_bf16 v[156:159], v[52:55], v[36:39], v[156:159]
    ds_read_b128 v[64:67], v13 offset:4096
    ds_read_b128 v[68:71], v13 offset:6144
    v_mfma_f32_16x16x32_bf16 v[168:171], v[52:55], v[40:43], v[168:171]
    ds_read_b128 v[72:75], v13 offset:8192
    ds_read_b128 v[76:79], v13 offset:10240
    v_mfma_f32_16x16x32_bf16 v[100:103], v[44:47], v[20:23], v[100:103]
    ds_read_b64_tr_b16 v[88:89], v14 offset:26624
    ds_read_b64_tr_b16 v[90:91], v14 offset:27136
    v_mfma_f32_16x16x32_bf16 v[104:107], v[48:51], v[20:23], v[104:107]
    ds_read_b64 v[188:189], v18 offset:256
    ds_read_b64 v[190:191], v18 offset:384
    v_mfma_f32_16x16x32_bf16 v[112:115], v[44:47], v[24:27], v[112:115]
    ds_read_b64 v[192:193], v18 offset:512
    ds_read_b64 v[194:195], v18 offset:640
    v_mfma_f32_16x16x32_bf16 v[116:119], v[48:51], v[24:27], v[116:119]
    ds_read_b32 v17, v17
    s_waitcnt lgkmcnt(11)
    v_mfma_f32_16x16x32_bf16 v[100:103], v[80:83], v[56:59], v[100:103]
    ds_read_b32 v16, v208 offset:4
    ds_read2_b32 v[4:5], v209 offset0:0 offset1:2
    v_mfma_f32_16x16x32_bf16 v[104:107], v[84:87], v[56:59], v[104:107]
    ds_read2_b32 v[6:7], v209 offset0:4 offset1:6
    ds_read2_b32 v[8:9], v209 offset0:8 offset1:10
    v_mfma_f32_16x16x32_bf16 v[112:115], v[80:83], v[60:63], v[112:115]
    ds_read2_b32 v[10:11], v209 offset0:12 offset1:14
    ds_read2_b32 v[12:13], v209 offset0:16 offset1:18
    v_mfma_f32_16x16x32_bf16 v[116:119], v[84:87], v[60:63], v[116:119]
    ds_read2_b32 v[14:15], v209 offset0:20 offset1:22
    s_waitcnt lgkmcnt(7)
    v_mfma_f32_16x16x32_bf16 v[124:127], v[44:47], v[28:31], v[124:127]
    v_mov_b32_dpp v20, v100 row_newbcast:0 row_mask:0xf bank_mask:0xf
    v_mov_b32_dpp v21, v101 row_newbcast:0 row_mask:0xf bank_mask:0xf
    v_mov_b32_dpp v22, v102 row_newbcast:0 row_mask:0xf bank_mask:0xf
    v_mfma_f32_16x16x32_bf16 v[128:131], v[48:51], v[28:31], v[128:131]
    v_mov_b32_dpp v23, v103 row_newbcast:0 row_mask:0xf bank_mask:0xf
    v_mov_b32_dpp v24, v104 row_newbcast:0 row_mask:0xf bank_mask:0xf
    v_mov_b32_dpp v25, v105 row_newbcast:0 row_mask:0xf bank_mask:0xf
    v_mfma_f32_16x16x32_bf16 v[124:127], v[80:83], v[64:67], v[124:127]
    v_mov_b32_dpp v26, v106 row_newbcast:0 row_mask:0xf bank_mask:0xf
    v_mov_b32_dpp v27, v107 row_newbcast:0 row_mask:0xf bank_mask:0xf
    v_pk_fma_f32 v[100:101], v[184:185], v[20:21], v[100:101] op_sel_hi:[0,1,1] neg_lo:[1,0,0] neg_hi:[1,0,0]
    v_mfma_f32_16x16x32_bf16 v[128:131], v[84:87], v[64:67], v[128:131]
    v_pk_fma_f32 v[102:103], v[184:185], v[22:23], v[102:103] op_sel_hi:[0,1,1] neg_lo:[1,0,0] neg_hi:[1,0,0]
    v_pk_fma_f32 v[104:105], v[184:185], v[24:25], v[104:105] op_sel_hi:[0,1,1] neg_lo:[1,0,0] neg_hi:[1,0,0]
    v_pk_fma_f32 v[106:107], v[184:185], v[26:27], v[106:107] op_sel_hi:[0,1,1] neg_lo:[1,0,0] neg_hi:[1,0,0]
    v_mfma_f32_16x16x32_bf16 v[136:139], v[44:47], v[32:35], v[136:139]
    v_cvt_pk_bf16_f32 v100, v100, v101
    v_cvt_pk_bf16_f32 v101, v102, v103
    ds_write_b64 v3, v[100:101] offset:0
    v_mfma_f32_16x16x32_bf16 v[140:143], v[48:51], v[32:35], v[140:143]
    v_cvt_pk_bf16_f32 v104, v104, v105
    v_cvt_pk_bf16_f32 v105, v106, v107
    ds_write_b64 v3, v[104:105] offset:128
    v_mfma_f32_16x16x32_bf16 v[136:139], v[80:83], v[68:71], v[136:139]
    v_pk_fma_f32 v[112:113], v[186:187], v[20:21], v[112:113] op_sel_hi:[0,1,1] neg_lo:[1,0,0] neg_hi:[1,0,0]
    v_pk_fma_f32 v[114:115], v[186:187], v[22:23], v[114:115] op_sel_hi:[0,1,1] neg_lo:[1,0,0] neg_hi:[1,0,0]
    v_pk_fma_f32 v[116:117], v[186:187], v[24:25], v[116:117] op_sel_hi:[0,1,1] neg_lo:[1,0,0] neg_hi:[1,0,0]
    v_mfma_f32_16x16x32_bf16 v[140:143], v[84:87], v[68:71], v[140:143]
    v_pk_fma_f32 v[118:119], v[186:187], v[26:27], v[118:119] op_sel_hi:[0,1,1] neg_lo:[1,0,0] neg_hi:[1,0,0]
    v_cvt_pk_bf16_f32 v112, v112, v113
    v_cvt_pk_bf16_f32 v113, v114, v115
    v_mfma_f32_16x16x32_bf16 v[148:151], v[44:47], v[36:39], v[148:151]
    ds_write_b64 v3, v[112:113] offset:6400
    v_cvt_pk_bf16_f32 v116, v116, v117
    v_cvt_pk_bf16_f32 v117, v118, v119
    v_mfma_f32_16x16x32_bf16 v[152:155], v[48:51], v[36:39], v[152:155]
    ds_write_b64 v3, v[116:117] offset:6528
    v_readfirstlane_b32 s49, v17
    s_mov_b32 s60, 0x07060503
    v_mfma_f32_16x16x32_bf16 v[148:151], v[80:83], v[72:75], v[148:151]
    s_mov_b32 s61, 0x07060502
    s_mov_b32 s62, 0x07060501
    s_mov_b32 s63, 0x04000c0c
    v_mfma_f32_16x16x32_bf16 v[152:155], v[84:87], v[72:75], v[152:155]
    v_pk_fma_f32 v[124:125], v[188:189], v[20:21], v[124:125] op_sel_hi:[0,1,1] neg_lo:[1,0,0] neg_hi:[1,0,0]
    v_pk_fma_f32 v[126:127], v[188:189], v[22:23], v[126:127] op_sel_hi:[0,1,1] neg_lo:[1,0,0] neg_hi:[1,0,0]
    v_pk_fma_f32 v[128:129], v[188:189], v[24:25], v[128:129] op_sel_hi:[0,1,1] neg_lo:[1,0,0] neg_hi:[1,0,0]
    v_mfma_f32_16x16x32_bf16 v[160:163], v[44:47], v[40:43], v[160:163]
    v_pk_fma_f32 v[130:131], v[188:189], v[26:27], v[130:131] op_sel_hi:[0,1,1] neg_lo:[1,0,0] neg_hi:[1,0,0]
    v_cvt_pk_bf16_f32 v124, v124, v125
    v_cvt_pk_bf16_f32 v125, v126, v127
    v_mfma_f32_16x16x32_bf16 v[164:167], v[48:51], v[40:43], v[164:167]
    ds_write_b64 v3, v[124:125] offset:12800
    v_cvt_pk_bf16_f32 v128, v128, v129
    v_cvt_pk_bf16_f32 v129, v130, v131
    v_mfma_f32_16x16x32_bf16 v[160:163], v[80:83], v[76:79], v[160:163]
    ds_write_b64 v3, v[128:129] offset:12928
    s_mov_b32 s64, 0x0706000c
    s_mov_b32 s66, 0x11111111
    v_mfma_f32_16x16x32_bf16 v[164:167], v[84:87], v[76:79], v[164:167]
    s_mov_b32 s67, s66
    s_mov_b32 s68, 0x33333333
    v_pk_fma_f32 v[136:137], v[190:191], v[20:21], v[136:137] op_sel_hi:[0,1,1] neg_lo:[1,0,0] neg_hi:[1,0,0]
    v_mfma_f32_16x16x32_bf16 v[108:111], v[88:91], v[56:59], v[108:111]
    v_pk_fma_f32 v[138:139], v[190:191], v[22:23], v[138:139] op_sel_hi:[0,1,1] neg_lo:[1,0,0] neg_hi:[1,0,0]
    v_pk_fma_f32 v[140:141], v[190:191], v[24:25], v[140:141] op_sel_hi:[0,1,1] neg_lo:[1,0,0] neg_hi:[1,0,0]
    v_pk_fma_f32 v[142:143], v[190:191], v[26:27], v[142:143] op_sel_hi:[0,1,1] neg_lo:[1,0,0] neg_hi:[1,0,0]
    v_mfma_f32_16x16x32_bf16 v[120:123], v[88:91], v[60:63], v[120:123]
    v_cvt_pk_bf16_f32 v136, v136, v137
    v_cvt_pk_bf16_f32 v137, v138, v139
    ds_write_b64 v3, v[136:137] offset:19200
    v_mfma_f32_16x16x32_bf16 v[132:135], v[88:91], v[64:67], v[132:135]
    v_cvt_pk_bf16_f32 v140, v140, v141
    v_cvt_pk_bf16_f32 v141, v142, v143
    ds_write_b64 v3, v[140:141] offset:19328
    v_mfma_f32_16x16x32_bf16 v[144:147], v[88:91], v[68:71], v[144:147]
    s_mov_b32 s69, s68
    s_mov_b32 s70, 0x77777777
    s_mov_b32 s71, s70
    v_mfma_f32_16x16x32_bf16 v[156:159], v[88:91], v[72:75], v[156:159]
    v_pk_fma_f32 v[148:149], v[192:193], v[20:21], v[148:149] op_sel_hi:[0,1,1] neg_lo:[1,0,0] neg_hi:[1,0,0]
    v_pk_fma_f32 v[150:151], v[192:193], v[22:23], v[150:151] op_sel_hi:[0,1,1] neg_lo:[1,0,0] neg_hi:[1,0,0]
    v_pk_fma_f32 v[152:153], v[192:193], v[24:25], v[152:153] op_sel_hi:[0,1,1] neg_lo:[1,0,0] neg_hi:[1,0,0]
    v_mfma_f32_16x16x32_bf16 v[168:171], v[88:91], v[76:79], v[168:171]
    v_pk_fma_f32 v[154:155], v[192:193], v[26:27], v[154:155] op_sel_hi:[0,1,1] neg_lo:[1,0,0] neg_hi:[1,0,0]
    v_cvt_pk_bf16_f32 v148, v148, v149
    v_cvt_pk_bf16_f32 v149, v150, v151
    ds_write_b64 v3, v[148:149] offset:25600
    v_cvt_pk_bf16_f32 v152, v152, v153
    v_cvt_pk_bf16_f32 v153, v154, v155
    ds_write_b64 v3, v[152:153] offset:25728
    v_pk_fma_f32 v[160:161], v[194:195], v[20:21], v[160:161] op_sel_hi:[0,1,1] neg_lo:[1,0,0] neg_hi:[1,0,0]
    v_pk_fma_f32 v[162:163], v[194:195], v[22:23], v[162:163] op_sel_hi:[0,1,1] neg_lo:[1,0,0] neg_hi:[1,0,0]
    v_pk_fma_f32 v[164:165], v[194:195], v[24:25], v[164:165] op_sel_hi:[0,1,1] neg_lo:[1,0,0] neg_hi:[1,0,0]
    v_pk_fma_f32 v[166:167], v[194:195], v[26:27], v[166:167] op_sel_hi:[0,1,1] neg_lo:[1,0,0] neg_hi:[1,0,0]
    v_cvt_pk_bf16_f32 v160, v160, v161
    v_cvt_pk_bf16_f32 v161, v162, v163
    ds_write_b64 v3, v[160:161] offset:32000
    v_cvt_pk_bf16_f32 v164, v164, v165
    v_cvt_pk_bf16_f32 v165, v166, v167
    ds_write_b64 v3, v[164:165] offset:32128
    s_setprio 2
    s_branch AT_e2
AT_start:
    s_setprio 3
    ds_read_b32 v16, v208 offset:4
    ds_read2_b32 v[4:5], v209 offset0:0 offset1:2
    ds_read2_b32 v[6:7], v209 offset0:4 offset1:6
    ds_read2_b32 v[8:9], v209 offset0:8 offset1:10
    ds_read2_b32 v[10:11], v209 offset0:12 offset1:14
    ds_read2_b32 v[12:13], v209 offset0:16 offset1:18
    ds_read2_b32 v[14:15], v209 offset0:20 offset1:22
    s_mov_b32 s60, 0x07060503
    s_mov_b32 s61, 0x07060502
    s_mov_b32 s62, 0x07060501
    s_mov_b32 s63, 0x04000c0c
    s_mov_b32 s64, 0x0706000c
    s_mov_b32 s66, 0x11111111
    s_mov_b32 s67, s66
    s_mov_b32 s68, 0x33333333
    s_mov_b32 s69, s68
    s_mov_b32 s70, 0x77777777
    s_mov_b32 s71, s70
    v_mov_b32 v3, 0
AT_e2:
    s_waitcnt lgkmcnt(0)
    s_barrier
    s_cmp_lt_u32 s48, 6
    s_cbranch_scc1 AT_qk
    s_lshl_b32 s65, s48, 10
    s_add_u32 s65, s65, 8192
    v_subrev_u32 v98, 20480, v99
    s_mul_i32 s66, s51, 81920
    s_add_u32 m0, s65, 0
    s_nop 0
    buffer_load_dwordx4 v99, s[36:39], s66 offen lds
    s_add_u32 m0, s65, -2048
    s_nop 0
    buffer_load_dwordx4 v98, s[36:39], s66 offen lds
    s_add_u32 s66, s66, 40960
    s_add_u32 m0, s65, 4096
    s_nop 0
    buffer_load_dwordx4 v99, s[36:39], s66 offen lds
    s_add_u32 m0, s65, 2048
    s_nop 0
    buffer_load_dwordx4 v98, s[36:39], s66 offen lds
    s_add_u32 s66, s66, 40960
    s_cmp_eq_u32 s66, 819200
    s_cselect_b32 s66, 0, s66
    s_add_u32 m0, s65, 8192
    s_nop 0
    buffer_load_dwordx4 v99, s[36:39], s66 offen lds
    s_add_u32 m0, s65, 6144
    s_nop 0
    buffer_load_dwordx4 v98, s[36:39], s66 offen lds
    s_add_u32 s66, s66, 40960
    s_add_u32 m0, s65, 12288
    s_nop 0
    buffer_load_dwordx4 v99, s[36:39], s66 offen lds
    s_add_u32 m0, s65, 10240
    s_nop 0
    buffer_load_dwordx4 v98, s[36:39], s66 offen lds
    s_add_u32 s66, s66, 40960
    s_cmp_eq_u32 s66, 819200
    s_cselect_b32 s66, 0, s66
    s_add_u32 m0, s65, 16384
    s_nop 0
    buffer_load_dwordx4 v99, s[36:39], s66 offen lds
    s_add_u32 m0, s65, 14336
    s_nop 0
    buffer_load_dwordx4 v98, s[36:39], s66 offen lds
    s_add_u32 s66, s66, 40960
    s_add_u32 m0, s65, 20480
    s_nop 0
    buffer_load_dwordx4 v99, s[36:39], s66 offen lds
    s_add_u32 m0, s65, 18432
    s_nop 0
    buffer_load_dwordx4 v98, s[36:39], s66 offen lds
    buffer_load_dwordx4 v[232:235], v250, s[28:31], 0 offen offset:0
    buffer_load_dwordx4 v[236:239], v250, s[28:31], 0 offen offset:64
    s_mov_b64 exec, 0
    s_cmp_eq_u32 s48, 6
    s_cbranch_scc1 HB0_0
    s_branch HB1_0
HB_ret:
    s_mov_b64 exec, -1
    s_mov_b32 s62, 1
    s_waitcnt vmcnt(0)
    v_mov_b32 v19, 1
    s_mov_b64 exec, 1
    ds_add_u32 v251, v19
    s_mov_b64 exec, -1
    s_branch B_start
AT_qk:
    ds_read_b64 v[20:21], v204
    ds_read_b64 v[30:31], v205 offset:0
    ds_read_b64 v[40:41], v205 offset:1600
    ds_read_b64 v[50:51], v205 offset:3200
    ds_read_b64 v[22:23], v229
    ds_read_b64 v[32:33], v205 offset:8
    ds_read_b64 v[42:43], v205 offset:1608
    ds_read_b64 v[52:53], v205 offset:3208
    ds_read_b64 v[24:25], v230
    ds_read_b64 v[34:35], v205 offset:16
    ds_read_b64 v[44:45], v205 offset:1616
    ds_read_b64 v[54:55], v205 offset:3216
    ds_read_b64 v[26:27], v231
    ds_read_b64 v[36:37], v205 offset:24
    ds_read_b64 v[46:47], v205 offset:1624
    ds_read_b64 v[56:57], v205 offset:3224
    ds_read_b64 v[28:29], v255
    ds_read_b64 v[38:39], v205 offset:32
    ds_read_b64 v[48:49], v205 offset:1632
    ds_read_b64 v[58:59], v205 offset:3232
    v_cndmask_b32 v13, v13, v5, s[66:67]
    v_cndmask_b32 v14, v14, v6, s[68:69]
    v_cndmask_b32 v15, v15, v7, s[70:71]
    v_mov_b32 v79, s54
    v_mov_b32 v83, s54
    v_mov_b32 v87, s54
    v_mov_b64 v[88:89], 0
    v_mov_b64 v[90:91], 0
    v_mov_b64 v[92:93], 0
    v_mov_b64 v[94:95], 0
    v_mul_f32 v16, 0x3ea52b5c, v16
    v_mul_f32 v148, v16, v8
    v_mul_f32 v149, v16, v9
    v_mul_f32 v150, v16, v10
    v_mul_f32 v151, v16, v11
    v_mul_f32 v152, v16, v12
    v_mul_f32 v153, v16, v13
    v_mul_f32 v154, v16, v14
    v_mul_f32 v155, v16, v15
    s_waitcnt lgkmcnt(15)
    v_mfma_f32_4x4x4_16b_bf16 v[60:63], v[30:31], v[20:21], 0
    v_mfma_f32_4x4x4_16b_bf16 v[64:67], v[40:41], v[20:21], 0
    v_mfma_f32_4x4x4_16b_bf16 v[68:71], v[50:51], v[20:21], 0
    s_waitcnt lgkmcnt(12)
    v_mfma_f32_4x4x4_16b_bf16 v[60:63], v[32:33], v[22:23], v[60:63]
    v_mfma_f32_4x4x4_16b_bf16 v[64:67], v[42:43], v[22:23], v[64:67]
    v_mfma_f32_4x4x4_16b_bf16 v[68:71], v[52:53], v[22:23], v[68:71]
    s_waitcnt lgkmcnt(8)
    v_mfma_f32_4x4x4_16b_bf16 v[60:63], v[34:35], v[24:25], v[60:63]
    v_mfma_f32_4x4x4_16b_bf16 v[64:67], v[44:45], v[24:25], v[64:67]
    v_mfma_f32_4x4x4_16b_bf16 v[68:71], v[54:55], v[24:25], v[68:71]
    s_waitcnt lgkmcnt(4)
    v_mfma_f32_4x4x4_16b_bf16 v[60:63], v[36:37], v[26:27], v[60:63]
    v_mfma_f32_4x4x4_16b_bf16 v[64:67], v[46:47], v[26:27], v[64:67]
    v_mfma_f32_4x4x4_16b_bf16 v[68:71], v[56:57], v[26:27], v[68:71]
    s_waitcnt lgkmcnt(0)
    v_mfma_f32_4x4x4_16b_bf16 v[60:63], v[38:39], v[28:29], v[60:63]
    v_mfma_f32_4x4x4_16b_bf16 v[64:67], v[48:49], v[28:29], v[64:67]
    v_mfma_f32_4x4x4_16b_bf16 v[68:71], v[58:59], v[28:29], v[68:71]
    s_cmp_lt_i32 s13, 8
    s_cbranch_scc1 AT_mask
AT_nomask:
    s_nop 2
    v_cndmask_b32 v69, v69, v61, s[66:67]
    v_cndmask_b32 v70, v70, v62, s[68:69]
    v_cndmask_b32 v71, v71, v63, s[70:71]
    v_pk_mul_f32 v[64:65], v[64:65], v[148:149]
    v_pk_mul_f32 v[66:67], v[66:67], v[150:151]
    v_pk_mul_f32 v[68:69], v[68:69], v[152:153]
    v_pk_mul_f32 v[70:71], v[70:71], v[154:155]
    v_perm_b32 v80, v64, v67, s60
    v_perm_b32 v81, v65, v67, s61
    v_perm_b32 v82, v66, v67, s62
    v_perm_b32 v84, v68, v71, s60
    v_perm_b32 v85, v69, v71, s61
    v_perm_b32 v86, v70, v71, s62
    s_mov_b64 exec, s[20:21]
    s_cmp_eq_u32 s49, 0
    s_cbranch_scc1 sts_1
    buffer_store_dwordx4 v[80:83], v213, s[24:27], s12 offen offset:0
    buffer_store_dwordx4 v[84:87], v213, s[24:27], s12 offen offset:512
std_2:
    s_mov_b64 exec, -1
    s_cmp_ge_u32 s48, 4
    s_cbranch_scc1 AT_vw
    v_mov_b32_dpp v196, v108 row_newbcast:0 row_mask:0xf bank_mask:0xf
    v_mov_b32_dpp v197, v109 row_newbcast:0 row_mask:0xf bank_mask:0xf
    v_mov_b32_dpp v198, v110 row_newbcast:0 row_mask:0xf bank_mask:0xf
    v_mov_b32_dpp v199, v111 row_newbcast:0 row_mask:0xf bank_mask:0xf
    v_pk_fma_f32 v[108:109], v[184:185], v[196:197], v[108:109] op_sel_hi:[0,1,1] neg_lo:[1,0,0] neg_hi:[1,0,0]
    v_pk_fma_f32 v[120:121], v[186:187], v[196:197], v[120:121] op_sel_hi:[0,1,1] neg_lo:[1,0,0] neg_hi:[1,0,0]
    v_pk_fma_f32 v[132:133], v[188:189], v[196:197], v[132:133] op_sel_hi:[0,1,1] neg_lo:[1,0,0] neg_hi:[1,0,0]
    v_pk_fma_f32 v[110:111], v[184:185], v[198:199], v[110:111] op_sel_hi:[0,1,1] neg_lo:[1,0,0] neg_hi:[1,0,0]
    v_pk_fma_f32 v[122:123], v[186:187], v[198:199], v[122:123] op_sel_hi:[0,1,1] neg_lo:[1,0,0] neg_hi:[1,0,0]
    v_pk_fma_f32 v[134:135], v[188:189], v[198:199], v[134:135] op_sel_hi:[0,1,1] neg_lo:[1,0,0] neg_hi:[1,0,0]
    v_cvt_pk_bf16_f32 v108, v108, v109
    v_cvt_pk_bf16_f32 v120, v120, v121
    v_cvt_pk_bf16_f32 v132, v132, v133
    v_cvt_pk_bf16_f32 v109, v110, v111
    v_cvt_pk_bf16_f32 v121, v122, v123
    v_cvt_pk_bf16_f32 v133, v134, v135
    ds_write_b64 v3, v[108:109] offset:256
    ds_write_b64 v3, v[120:121] offset:6656
    ds_write_b64 v3, v[132:133] offset:13056
    v_pk_fma_f32 v[144:145], v[190:191], v[196:197], v[144:145] op_sel_hi:[0,1,1] neg_lo:[1,0,0] neg_hi:[1,0,0]
    v_pk_fma_f32 v[156:157], v[192:193], v[196:197], v[156:157] op_sel_hi:[0,1,1] neg_lo:[1,0,0] neg_hi:[1,0,0]
    v_pk_fma_f32 v[168:169], v[194:195], v[196:197], v[168:169] op_sel_hi:[0,1,1] neg_lo:[1,0,0] neg_hi:[1,0,0]
    v_pk_fma_f32 v[146:147], v[190:191], v[198:199], v[146:147] op_sel_hi:[0,1,1] neg_lo:[1,0,0] neg_hi:[1,0,0]
    v_pk_fma_f32 v[158:159], v[192:193], v[198:199], v[158:159] op_sel_hi:[0,1,1] neg_lo:[1,0,0] neg_hi:[1,0,0]
    v_pk_fma_f32 v[170:171], v[194:195], v[198:199], v[170:171] op_sel_hi:[0,1,1] neg_lo:[1,0,0] neg_hi:[1,0,0]
    v_cvt_pk_bf16_f32 v144, v144, v145
    v_cvt_pk_bf16_f32 v156, v156, v157
    v_cvt_pk_bf16_f32 v168, v168, v169
    v_cvt_pk_bf16_f32 v145, v146, v147
    v_cvt_pk_bf16_f32 v157, v158, v159
    v_cvt_pk_bf16_f32 v169, v170, v171
    ds_write_b64 v3, v[144:145] offset:19456
    ds_write_b64 v3, v[156:157] offset:25856
    ds_write_b64 v3, v[168:169] offset:32256
    v_mov_b32 v19, 1
    s_mov_b64 exec, 1
    ds_add_u32 v251, v19 offset:8
    s_mov_b64 exec, -1
AT_vw:
    v_lshl_add_u32 v17, v201, 3, v251
    ds_read2_b64 v[156:159], v17 offset0:14 offset1:18
    ds_read2_b64 v[160:163], v17 offset0:22 offset1:26
    v_and_b32 v164, 2, v201
    v_lshl_add_u32 v164, v200, 2, v164
    s_lshl_b32 s65, s48, 6
    s_add_u32 s65, s65, s57
    s_mov_b64 exec, s[20:21]
AT_poll:
    buffer_load_dwordx4 v[88:91], v206, s[24:27], s22 offen offset:0 sc1
    buffer_load_dwordx4 v[92:95], v206, s[24:27], s22 offen offset:512 sc1
AT_pw:
    s_waitcnt vmcnt(0)
    v_cmp_ne_u32 vcc, s54, v91
    v_cmp_ne_u32 s[58:59], s54, v95
    s_or_b64 vcc, vcc, s[58:59]
    s_cbranch_vccz AT_got
    s_sub_u32 s3, s3, 1
    s_cbranch_scc0 AT_poll
    s_mov_b32 s3, 0
AT_got:
    s_mov_b64 exec, -1
    ds_read_b32 v17, v251 offset:8
    buffer_load_dwordx4 v[232:235], v250, s[28:31], 0 offen offset:0
    buffer_load_dwordx4 v[236:239], v250, s[28:31], 0 offen offset:64
    v_perm_b32 v91, v88, v89, s63
    v_perm_b32 v95, v92, v93, s63
    v_perm_b32 v91, v91, v90, s64
    v_perm_b32 v95, v95, v94, s64
    v_pk_add_f32 v[64:65], v[64:65], v[88:89]
    v_pk_add_f32 v[68:69], v[68:69], v[92:93]
    v_pk_add_f32 v[66:67], v[66:67], v[90:91]
    v_pk_add_f32 v[70:71], v[70:71], v[94:95]
    v_max3_f32 v18, v64, v65, v66
    v_max3_f32 v19, v67, v68, v69
    v_max3_f32 v18, v18, v70, v71
    v_max_f32 v18, v18, v19
    v_pk_add_f32 v[64:65], v[64:65], v[18:19] op_sel_hi:[1,0] neg_lo:[0,1] neg_hi:[0,1]
    v_pk_add_f32 v[66:67], v[66:67], v[18:19] op_sel_hi:[1,0] neg_lo:[0,1] neg_hi:[0,1]
    v_pk_add_f32 v[68:69], v[68:69], v[18:19] op_sel_hi:[1,0] neg_lo:[0,1] neg_hi:[0,1]
    v_pk_add_f32 v[70:71], v[70:71], v[18:19] op_sel_hi:[1,0] neg_lo:[0,1] neg_hi:[0,1]
AT_vc:
    s_waitcnt lgkmcnt(0)
    v_cmp_ne_u32 vcc, 4, v17
    s_cbranch_vccnz AT_vs
AT_vg:
    ds_read_b64_tr_b16 v[100:101], v214 offset:0
    ds_read_b64_tr_b16 v[102:103], v214 offset:1600
    ds_read_b64_tr_b16 v[104:105], v214 offset:32
    ds_read_b64_tr_b16 v[106:107], v214 offset:1632
    ds_read_b64_tr_b16 v[108:109], v214 offset:64
    ds_read_b64_tr_b16 v[110:111], v214 offset:1664
    ds_read_b64_tr_b16 v[112:113], v214 offset:96
    ds_read_b64_tr_b16 v[114:115], v214 offset:1696
    v_exp_f32 v64, v64
    v_exp_f32 v65, v65
    v_exp_f32 v66, v66
    v_exp_f32 v67, v67
    v_exp_f32 v68, v68
    v_exp_f32 v69, v69
    v_exp_f32 v70, v70
    v_exp_f32 v71, v71
    v_pk_add_f32 v[20:21], v[64:65], v[66:67]
    v_pk_add_f32 v[22:23], v[68:69], v[70:71]
    v_pk_add_f32 v[20:21], v[20:21], v[22:23]
    v_add_f32 v20, v20, v21
    v_rcp_f32 v20, v20
    v_pk_mul_f32 v[64:65], v[64:65], v[8:9]
    v_pk_mul_f32 v[66:67], v[66:67], v[10:11]
    v_pk_mul_f32 v[68:69], v[68:69], v[12:13]
    v_pk_mul_f32 v[70:71], v[70:71], v[14:15]
    v_pk_mul_f32 v[64:65], v[64:65], v[20:21] op_sel_hi:[1,0]
    v_pk_mul_f32 v[66:67], v[66:67], v[20:21] op_sel_hi:[1,0]
    v_pk_mul_f32 v[68:69], v[68:69], v[20:21] op_sel_hi:[1,0]
    v_pk_mul_f32 v[70:71], v[70:71], v[20:21] op_sel_hi:[1,0]
    v_cvt_pk_bf16_f32 v24, v64, v65
    v_cvt_pk_bf16_f32 v25, v66, v67
    v_cvt_pk_bf16_f32 v26, v68, v69
    v_cvt_pk_bf16_f32 v27, v70, v71
    ds_write_b64 v210, v[24:25] offset:8
    v_and_b32 v28, v26, v207
    v_and_b32 v29, v27, v211
    ds_write_b64 v210, v[28:29]
    v_xor_b32 v26, v26, v28
    v_xor_b32 v27, v27, v29
    ds_write_b64 v210, v[26:27] offset:16
    ds_read_b128 v[116:119], v172
    ds_read_b128 v[120:123], v173
    ds_read_b128 v[124:127], v174
    ds_read_b128 v[128:131], v175
    ds_read_b128 v[132:135], v176
    ds_read_b128 v[136:139], v177
    ds_read_b128 v[140:143], v178
    ds_read_b128 v[144:147], v179
    s_cmp_lt_u32 s48, 4
    s_cbranch_scc1 AT_pv
    v_mov_b32 v19, 1
    s_mov_b64 exec, 1
    ds_add_u32 v251, v19
    s_mov_b64 exec, -1
AT_pv:
    s_waitcnt lgkmcnt(6)
    v_mfma_f32_16x16x32_bf16 v[20:23], v[100:103], v[116:119], 0
    v_mfma_f32_16x16x32_bf16 v[24:27], v[100:103], v[120:123], 0
    s_waitcnt lgkmcnt(4)
    v_mfma_f32_16x16x32_bf16 v[28:31], v[104:107], v[124:127], 0
    v_mfma_f32_16x16x32_bf16 v[32:35], v[104:107], v[128:131], 0
    s_waitcnt lgkmcnt(2)
    v_mfma_f32_16x16x32_bf16 v[36:39], v[108:111], v[132:135], 0
    v_mfma_f32_16x16x32_bf16 v[40:43], v[108:111], v[136:139], 0
    s_waitcnt lgkmcnt(0)
    v_mfma_f32_16x16x32_bf16 v[44:47], v[112:115], v[140:143], 0
    v_mfma_f32_16x16x32_bf16 v[48:51], v[112:115], v[144:147], 0
    v_cndmask_b32 v20, v20, v24, s[4:5]
    v_cndmask_b32 v21, v21, v25, s[4:5]
    v_cndmask_b32 v22, v22, v26, s[4:5]
    v_cndmask_b32 v23, v23, v27, s[4:5]
    v_cvt_pk_bf16_f32 v204, v20, v21
    v_cvt_pk_bf16_f32 v205, v22, v23
    v_cndmask_b32 v28, v28, v32, s[6:7]
    v_cndmask_b32 v29, v29, v33, s[6:7]
    v_cndmask_b32 v30, v30, v34, s[6:7]
    v_cndmask_b32 v31, v31, v35, s[6:7]
    v_cvt_pk_bf16_f32 v206, v28, v29
    v_cvt_pk_bf16_f32 v207, v30, v31
    v_cndmask_b32 v36, v36, v40, s[8:9]
    v_cndmask_b32 v37, v37, v41, s[8:9]
    v_cndmask_b32 v38, v38, v42, s[8:9]
    v_cndmask_b32 v39, v39, v43, s[8:9]
    v_cvt_pk_bf16_f32 v208, v36, v37
    v_cvt_pk_bf16_f32 v209, v38, v39
    v_cndmask_b32 v44, v44, v48, s[10:11]
    v_cndmask_b32 v45, v45, v49, s[10:11]
    v_cndmask_b32 v46, v46, v50, s[10:11]
    v_cndmask_b32 v47, v47, v51, s[10:11]
    v_cvt_pk_bf16_f32 v210, v44, v45
    v_cvt_pk_bf16_f32 v211, v46, v47
    s_cmp_eq_u32 s49, 0
    s_cbranch_scc1 sts_3
    buffer_store_dwordx4 v[204:207], v249, s[24:27], s22 offen offset:0
    buffer_store_dwordx4 v[208:211], v249, s[24:27], s22 offen offset:1024
std_4:
    s_mov_b64 exec, s[18:19]
    buffer_load_dword v18, v203, s[24:27], s17 offen sc1
    s_mov_b64 exec, -1
    v_dot2_f32_bf16 v20, v204, v156, 0
    v_dot2_f32_bf16 v21, v204, v204, 0
    v_dot2_f32_bf16 v20, v205, v157, v20
    v_dot2_f32_bf16 v21, v205, v205, v21
    v_dot2_f32_bf16 v20, v206, v158, v20
    v_dot2_f32_bf16 v21, v206, v206, v21
    v_dot2_f32_bf16 v20, v207, v159, v20
    v_dot2_f32_bf16 v21, v207, v207, v21
    v_dot2_f32_bf16 v20, v208, v160, v20
    v_dot2_f32_bf16 v21, v208, v208, v21
    v_dot2_f32_bf16 v20, v209, v161, v20
    v_dot2_f32_bf16 v21, v209, v209, v21
    v_dot2_f32_bf16 v20, v210, v162, v20
    v_dot2_f32_bf16 v21, v210, v210, v21
    v_dot2_f32_bf16 v20, v211, v163, v20
    v_dot2_f32_bf16 v21, v211, v211, v21
    s_nop 2
    v_permlane32_swap_b32 v20, v21
    v_add_f32 v20, v20, v21
    v_mov_b32 v21, v20
    s_nop 1
    v_permlane16_swap_b32 v20, v21
    s_mov_b32 exec_lo, 0xffff
    s_mov_b32 exec_hi, 0xffff
    v_add_f32 v20, v20, v21
    s_cmp_eq_u32 s49, 0
    s_cbranch_scc1 sts_5
    buffer_store_short_d16_hi v20, v164, s[24:27], s65 offen
std_6:
    s_mov_b64 exec, -1
    s_waitcnt vmcnt(2)
    s_mov_b64 exec, 1
    s_cmp_eq_u32 s49, 0
    s_cbranch_scc1 sts_7
    buffer_store_dword v79, v203, s[24:27], s23 offen
std_8:
    s_mov_b64 exec, -1
    s_waitcnt vmcnt(2)
    v_cmp_ne_u32 vcc, s54, v18
    s_and_b32 s62, vcc_lo, s18
    s_cbranch_scc1 B_st0
    s_add_u32 s14, s14, 2048
    s_cmp_eq_u32 s14, s15
    s_cselect_b32 s14, s1, s14
    buffer_load_dwordx4 v[168:171], v249, s[24:27], s14 offen offset:0 sc1
    buffer_load_dwordx4 v[172:175], v249, s[24:27], s14 offen offset:1024 sc1
    s_add_u32 s14, s14, 2048
    s_cmp_eq_u32 s14, s15
    s_cselect_b32 s14, s1, s14
    buffer_load_dwordx4 v[176:179], v249, s[24:27], s14 offen offset:0 sc1
    buffer_load_dwordx4 v[180:183], v249, s[24:27], s14 offen offset:1024 sc1
    s_add_u32 s14, s14, 2048
    s_cmp_eq_u32 s14, s15
    s_cselect_b32 s14, s1, s14
    buffer_load_dwordx4 v[212:215], v249, s[24:27], s14 offen offset:0 sc1
    buffer_load_dwordx4 v[12:15], v249, s[24:27], s14 offen offset:1024 sc1
B_st0:
B_start:
HB0_0:
    s_cbranch_execz HB0_1
    ds_read_b32 v19, v251
    ds_read2_b64 v[240:243], v227 offset0:0 offset1:4
    ds_read2_b64 v[244:247], v227 offset0:8 offset1:12
    ds_read_b32 v248, v251 offset:2288
    v_permlane16_swap_b32 v232, v234
HB0_1:
    s_cbranch_execz HB0_2
    v_permlane16_swap_b32 v233, v235
    v_permlane16_swap_b32 v236, v238
    v_permlane16_swap_b32 v237, v239
    v_lshlrev_b32 v184, 16, v232
    v_and_b32 v185, s47, v232
    v_lshlrev_b32 v186, 16, v233
    v_and_b32 v187, s47, v233
    v_lshlrev_b32 v188, 16, v234
    v_and_b32 v189, s47, v234
    v_lshlrev_b32 v190, 16, v235
    v_and_b32 v191, s47, v235
    v_lshlrev_b32 v192, 16, v236
    v_and_b32 v193, s47, v236
    v_lshlrev_b32 v194, 16, v237
    v_and_b32 v195, s47, v237
    v_lshlrev_b32 v196, 16, v238
    v_and_b32 v197, s47, v238
    v_lshlrev_b32 v198, 16, v239
    v_and_b32 v199, s47, v239
    v_cmp_gt_u32 vcc, 2048, v254
    s_mov_b64 s[4:5], vcc
    s_branch B_wc
B_ww:
    ds_read_b32 v19, v251
B_wc:
    s_waitcnt lgkmcnt(0)
    v_cmp_ne_u32 vcc, 4, v19
    s_cbranch_vccz B_wd
    s_sub_u32 s3, s3, 1
    s_cbranch_scc0 B_ww
    s_mov_b32 s3, 0
B_wd:
    s_mov_b32 exec_lo, 0x00010001
    s_mov_b32 exec_hi, 0x00010001
    v_mov_b32 v240, 0x3f803f80
    v_mov_b32 v241, 0x3f803f80
    v_mov_b32 v242, 0x3f803f80
    v_mov_b32 v243, 0x3f803f80
    v_mov_b32 v244, 0x3f803f80
    v_mov_b32 v245, 0x3f803f80
    v_mov_b32 v246, 0x3f803f80
    v_mov_b32 v247, 0x3f803f80
    s_mov_b64 exec, -1
    s_setprio 0
    ds_read_b64_tr_b16 v[20:21], v216 offset:0
    ds_read_b64_tr_b16 v[22:23], v216 offset:2048
    ds_read_b64_tr_b16 v[24:25], v217 offset:0
    ds_read_b64_tr_b16 v[26:27], v217 offset:2048
    ds_read_b64_tr_b16 v[28:29], v218 offset:0
HB0_2:
    s_cbranch_execz HB0_3
    ds_read_b64_tr_b16 v[30:31], v218 offset:2048
    ds_read_b64_tr_b16 v[32:33], v219 offset:0
    ds_read_b64_tr_b16 v[34:35], v219 offset:2048
    ds_read_b64_tr_b16 v[36:37], v216 offset:4096
    ds_read_b64_tr_b16 v[38:39], v216 offset:6144
    ds_read_b64_tr_b16 v[40:41], v217 offset:4096
    ds_read_b64_tr_b16 v[42:43], v217 offset:6144
    ds_read_b64_tr_b16 v[44:45], v218 offset:4096
    ds_read_b64_tr_b16 v[46:47], v218 offset:6144
    ds_read_b64_tr_b16 v[48:49], v219 offset:4096
    ds_read_b64_tr_b16 v[50:51], v219 offset:6144
    ds_read_b64_tr_b16 v[52:53], v216 offset:8192
    ds_read_b64_tr_b16 v[54:55], v216 offset:10240
    ds_read_b64_tr_b16 v[56:57], v217 offset:8192
    ds_read_b64_tr_b16 v[58:59], v217 offset:10240
    ds_read_b64_tr_b16 v[60:61], v218 offset:8192
    ds_read_b64_tr_b16 v[62:63], v218 offset:10240
    ds_read_b64_tr_b16 v[64:65], v219 offset:8192
    ds_read_b64_tr_b16 v[66:67], v219 offset:10240
    ds_read_b64_tr_b16 v[68:69], v216 offset:12288
    ds_read_b64_tr_b16 v[70:71], v216 offset:14336
    ds_read_b64_tr_b16 v[72:73], v217 offset:12288
    ds_read_b64_tr_b16 v[74:75], v217 offset:14336
    ds_read_b64_tr_b16 v[76:77], v218 offset:12288
    ds_read_b64_tr_b16 v[78:79], v218 offset:14336
    ds_read_b64_tr_b16 v[80:81], v219 offset:12288
    ds_read_b64_tr_b16 v[82:83], v219 offset:14336
    s_cmp_eq_u32 s62, 0
    s_cbranch_scc1 B_nap
    s_mov_b64 exec, s[18:19]
    buffer_load_dword v18, v203, s[24:27], s17 offen sc1
    s_mov_b64 exec, -1
B_nap:
    ds_read_b64_tr_b16 v[84:85], v216 offset:16384
    ds_read_b64_tr_b16 v[86:87], v216 offset:18432
HB0_3:
    s_cbranch_execz HB0_4
    ds_read_b64_tr_b16 v[88:89], v217 offset:16384
    ds_read_b64_tr_b16 v[90:91], v217 offset:18432
    ds_read_b64_tr_b16 v[92:93], v218 offset:16384
    ds_read_b64_tr_b16 v[94:95], v218 offset:18432
    ds_read_b64_tr_b16 v[96:97], v219 offset:16384
    ds_read_b64_tr_b16 v[98:99], v219 offset:18432
    ds_read_b64_tr_b16 v[100:101], v216 offset:20480
    ds_read_b64_tr_b16 v[102:103], v216 offset:22528
    ds_read_b64_tr_b16 v[104:105], v217 offset:20480
    ds_read_b64_tr_b16 v[106:107], v217 offset:22528
    ds_read_b64_tr_b16 v[108:109], v218 offset:20480
    ds_read_b64_tr_b16 v[110:111], v218 offset:22528
    ds_read_b64_tr_b16 v[112:113], v219 offset:20480
    ds_read_b64_tr_b16 v[114:115], v219 offset:22528
    ds_read_b64_tr_b16 v[116:117], v216 offset:24576
    ds_read_b64_tr_b16 v[118:119], v216 offset:26624
    ds_read_b64_tr_b16 v[120:121], v217 offset:24576
    ds_read_b64_tr_b16 v[122:123], v217 offset:26624
    ds_read_b64_tr_b16 v[124:125], v218 offset:24576
    ds_read_b64_tr_b16 v[126:127], v218 offset:26624
    ds_read_b64_tr_b16 v[128:129], v219 offset:24576
    ds_read_b64_tr_b16 v[130:131], v219 offset:26624
    s_cmp_ge_u32 s48, 6
    s_cbranch_scc1 B_no
    s_waitcnt lgkmcnt(0)
    v_mfma_f32_16x16x32_bf16 v[184:187], v[20:23], v[204:207], v[184:187]
    v_mfma_f32_16x16x32_bf16 v[188:191], v[24:27], v[204:207], v[188:191]
    v_mfma_f32_16x16x32_bf16 v[192:195], v[28:31], v[204:207], v[192:195]
    v_mfma_f32_16x16x32_bf16 v[196:199], v[32:35], v[204:207], v[196:199]
    s_waitcnt lgkmcnt(0)
    v_mfma_f32_16x16x32_bf16 v[184:187], v[36:39], v[208:211], v[184:187]
    v_mfma_f32_16x16x32_bf16 v[188:191], v[40:43], v[208:211], v[188:191]
    v_mfma_f32_16x16x32_bf16 v[192:195], v[44:47], v[208:211], v[192:195]
HB0_4:
    s_cbranch_execz HB0_5
    v_mfma_f32_16x16x32_bf16 v[196:199], v[48:51], v[208:211], v[196:199]
    s_branch B_n2
B_rds:
    ds_read_b64_tr_b16 v[132:133], v216 offset:28672
    ds_read_b64_tr_b16 v[134:135], v216 offset:30720
    ds_read_b64_tr_b16 v[136:137], v217 offset:28672
    ds_read_b64_tr_b16 v[138:139], v217 offset:30720
    ds_read_b64_tr_b16 v[140:141], v218 offset:28672
    ds_read_b64_tr_b16 v[142:143], v218 offset:30720
    ds_read_b64_tr_b16 v[144:145], v219 offset:28672
    ds_read_b64_tr_b16 v[146:147], v219 offset:30720
    ds_read_b64_tr_b16 v[148:149], v216 offset:32768
    ds_read_b64_tr_b16 v[150:151], v216 offset:34816
    ds_read_b64_tr_b16 v[152:153], v217 offset:32768
    ds_read_b64_tr_b16 v[154:155], v217 offset:34816
    ds_read_b64_tr_b16 v[156:157], v218 offset:32768
    ds_read_b64_tr_b16 v[158:159], v218 offset:34816
    ds_read_b64_tr_b16 v[160:161], v219 offset:32768
    ds_read_b64_tr_b16 v[162:163], v219 offset:34816
    ds_read_b64_tr_b16 v[20:21], v216 offset:36864
    ds_read_b64_tr_b16 v[22:23], v216 offset:38912
    ds_read_b64_tr_b16 v[24:25], v217 offset:36864
    ds_read_b64_tr_b16 v[26:27], v217 offset:38912
    ds_read_b64_tr_b16 v[28:29], v218 offset:36864
    ds_read_b64_tr_b16 v[30:31], v218 offset:38912
    ds_read_b64_tr_b16 v[32:33], v219 offset:36864
    ds_read_b64_tr_b16 v[34:35], v219 offset:38912
    ds_read_b64_tr_b16 v[36:37], v220 offset:0
    ds_read_b64_tr_b16 v[38:39], v220 offset:2048
    ds_read_b64_tr_b16 v[40:41], v221 offset:0
    ds_read_b64_tr_b16 v[42:43], v221 offset:2048
    ds_read_b64_tr_b16 v[44:45], v222 offset:0
    ds_read_b64_tr_b16 v[46:47], v222 offset:2048
HB0_5:
    s_cbranch_execz HB0_6
    ds_read_b64_tr_b16 v[48:49], v223 offset:0
    ds_read_b64_tr_b16 v[50:51], v223 offset:2048
    s_setpc_b64 s[98:99]
B_no:
    s_call_b64 s[98:99], B_rds
    v_mul_u32_u24 v4, 12, v0
    s_add_u32 s58, s100, 512
    s_add_u32 s59, s100, 24832
    s_add_u32 s60, s100, 49152
    s_add_u32 s12, s100, 73472
    s_add_u32 s13, s100, 97792
    v_and_b32 v5, 31, v0
    v_mul_u32_u24 v5, 3, v5
    s_mul_i32 s64, s53, 96
    s_sub_u32 s65, 1014, s55
    v_mov_b32 v6, 0xfffff000
    v_add_u32 v7, -10, v5
    v_cmp_gt_u32 vcc, s65, v7
    v_add3_u32 v7, v5, s64, 0
    s_nop 0
    v_cndmask_b32 v8, 0, v7, vcc
    v_cndmask_b32 v204, 0, v6, vcc
    v_add_u32 v7, -9, v5
    v_cmp_gt_u32 vcc, s65, v7
    v_add3_u32 v7, v5, s64, 1
    s_nop 0
    v_cndmask_b32 v9, 0, v7, vcc
    v_cndmask_b32 v205, 0, v6, vcc
    v_add_u32 v7, -8, v5
    v_cmp_gt_u32 vcc, s65, v7
    v_add3_u32 v7, v5, s64, 2
    s_nop 0
    v_cndmask_b32 v10, 0, v7, vcc
    v_cndmask_b32 v206, 0, v6, vcc
    v_mov_b32 v7, s54
    v_lshlrev_b32 v11, 11, v200
    s_setprio 2
B_n2:
    s_cmp_eq_u32 s62, 0
    s_cbranch_scc1 B_run
    s_mov_b64 exec, s[18:19]
    s_branch B_pw
B_poll:
    buffer_load_dword v18, v203, s[24:27], s17 offen sc1
B_pw:
    s_waitcnt vmcnt(0)
    v_cmp_ne_u32 vcc, s54, v18
    s_cbranch_vccz B_go
    s_sub_u32 s3, s3, 1
    s_cbranch_scc0 B_poll
    s_mov_b32 s3, 0
B_go:
    s_mov_b64 exec, -1
    s_add_u32 s14, s14, 2048
HB0_6:
    s_cbranch_execz HB0_7
    s_cmp_eq_u32 s14, s15
    s_cselect_b32 s14, s1, s14
    buffer_load_dwordx4 v[168:171], v249, s[24:27], s14 offen offset:0 sc1
    buffer_load_dwordx4 v[172:175], v249, s[24:27], s14 offen offset:1024 sc1
    s_add_u32 s14, s14, 2048
    s_cmp_eq_u32 s14, s15
    s_cselect_b32 s14, s1, s14
    buffer_load_dwordx4 v[176:179], v249, s[24:27], s14 offen offset:0 sc1
    buffer_load_dwordx4 v[180:183], v249, s[24:27], s14 offen offset:1024 sc1
    s_add_u32 s14, s14, 2048
    s_cmp_eq_u32 s14, s15
    s_cselect_b32 s14, s1, s14
    buffer_load_dwordx4 v[212:215], v249, s[24:27], s14 offen offset:0 sc1
    buffer_load_dwordx4 v[12:15], v249, s[24:27], s14 offen offset:1024 sc1
B_run:
    s_cmp_ge_u32 s48, 6
    s_cbranch_scc1 B_half
    s_call_b64 s[98:99], B_rds
    s_cmp_ge_u32 s48, 4
    s_cbranch_scc1 B_half
    s_setprio 1
    s_waitcnt vmcnt(5) lgkmcnt(15)
    v_mfma_f32_16x16x32_bf16 v[184:187], v[52:55], v[168:171], v[184:187]
    v_mfma_f32_16x16x32_bf16 v[188:191], v[56:59], v[168:171], v[188:191]
    ds_read_b64_tr_b16 v[52:53], v220 offset:4096
    v_mfma_f32_16x16x32_bf16 v[192:195], v[60:63], v[168:171], v[192:195]
    ds_read_b64_tr_b16 v[54:55], v220 offset:6144
    v_mfma_f32_16x16x32_bf16 v[196:199], v[64:67], v[168:171], v[196:199]
    s_add_u32 s14, s14, 2048
    s_cmp_eq_u32 s14, s15
    s_cselect_b32 s14, s1, s14
    buffer_load_dwordx4 v[164:167], v249, s[24:27], s14 offen offset:0 sc1
    ds_read_b64_tr_b16 v[56:57], v221 offset:4096
    s_waitcnt vmcnt(5) lgkmcnt(15)
    v_mfma_f32_16x16x32_bf16 v[184:187], v[68:71], v[172:175], v[184:187]
    ds_read_b64_tr_b16 v[58:59], v221 offset:6144
    ds_read_b64_tr_b16 v[60:61], v222 offset:4096
    v_mfma_f32_16x16x32_bf16 v[188:191], v[72:75], v[172:175], v[188:191]
    ds_read_b64_tr_b16 v[62:63], v222 offset:6144
    v_mfma_f32_16x16x32_bf16 v[192:195], v[76:79], v[172:175], v[192:195]
HB0_7:
    s_cbranch_execz HB0_8
    ds_read_b64_tr_b16 v[64:65], v223 offset:4096
    v_mfma_f32_16x16x32_bf16 v[196:199], v[80:83], v[172:175], v[196:199]
    buffer_load_dwordx4 v[232:235], v249, s[24:27], s14 offen offset:1024 sc1
    ds_read_b64_tr_b16 v[66:67], v223 offset:6144
    s_waitcnt vmcnt(5) lgkmcnt(15)
    v_mfma_f32_16x16x32_bf16 v[184:187], v[84:87], v[176:179], v[184:187]
    ds_read_b64_tr_b16 v[68:69], v220 offset:8192
    ds_read_b64_tr_b16 v[70:71], v220 offset:10240
    v_mfma_f32_16x16x32_bf16 v[188:191], v[88:91], v[176:179], v[188:191]
    ds_read_b64_tr_b16 v[72:73], v221 offset:8192
    v_mfma_f32_16x16x32_bf16 v[192:195], v[92:95], v[176:179], v[192:195]
    ds_read_b64_tr_b16 v[74:75], v221 offset:10240
    v_mfma_f32_16x16x32_bf16 v[196:199], v[96:99], v[176:179], v[196:199]
    s_mov_b32 s14, s16
    buffer_load_dwordx4 v[236:239], v249, s[24:27], s14 offen offset:0 sc1
    ds_read_b64_tr_b16 v[76:77], v222 offset:8192
    s_waitcnt vmcnt(5) lgkmcnt(15)
    v_mfma_f32_16x16x32_bf16 v[184:187], v[100:103], v[180:183], v[184:187]
    ds_read_b64_tr_b16 v[78:79], v222 offset:10240
    ds_read_b64_tr_b16 v[80:81], v223 offset:8192
    v_mfma_f32_16x16x32_bf16 v[188:191], v[104:107], v[180:183], v[188:191]
    ds_read_b64_tr_b16 v[82:83], v223 offset:10240
    v_mfma_f32_16x16x32_bf16 v[192:195], v[108:111], v[180:183], v[192:195]
    ds_read_b64_tr_b16 v[84:85], v220 offset:12288
    v_mfma_f32_16x16x32_bf16 v[196:199], v[112:115], v[180:183], v[196:199]
    buffer_load_dwordx4 v[168:171], v249, s[24:27], s14 offen offset:1024 sc1
    ds_read_b64_tr_b16 v[86:87], v220 offset:14336
    s_waitcnt vmcnt(5) lgkmcnt(15)
    v_mfma_f32_16x16x32_bf16 v[184:187], v[116:119], v[212:215], v[184:187]
    ds_read_b64_tr_b16 v[88:89], v221 offset:12288
    ds_read_b64_tr_b16 v[90:91], v221 offset:14336
    v_mfma_f32_16x16x32_bf16 v[188:191], v[120:123], v[212:215], v[188:191]
    ds_read_b64_tr_b16 v[92:93], v222 offset:12288
    v_mfma_f32_16x16x32_bf16 v[192:195], v[124:127], v[212:215], v[192:195]
HB0_8:
    s_cbranch_execz HB0_9
    ds_read_b64_tr_b16 v[94:95], v222 offset:14336
    v_mfma_f32_16x16x32_bf16 v[196:199], v[128:131], v[212:215], v[196:199]
    s_add_u32 s14, s14, 2048
    s_cmp_eq_u32 s14, s15
    s_cselect_b32 s14, s1, s14
    buffer_load_dwordx4 v[172:175], v249, s[24:27], s14 offen offset:0 sc1
    ds_read_b64_tr_b16 v[96:97], v223 offset:12288
    s_waitcnt vmcnt(5) lgkmcnt(15)
    v_mfma_f32_16x16x32_bf16 v[184:187], v[132:135], v[12:15], v[184:187]
    ds_read_b64_tr_b16 v[98:99], v223 offset:14336
    ds_read_b64_tr_b16 v[100:101], v220 offset:16384
    v_mfma_f32_16x16x32_bf16 v[188:191], v[136:139], v[12:15], v[188:191]
    ds_read_b64_tr_b16 v[102:103], v220 offset:18432
    v_mfma_f32_16x16x32_bf16 v[192:195], v[140:143], v[12:15], v[192:195]
    ds_read_b64_tr_b16 v[104:105], v221 offset:16384
    v_mfma_f32_16x16x32_bf16 v[196:199], v[144:147], v[12:15], v[196:199]
    buffer_load_dwordx4 v[176:179], v249, s[24:27], s14 offen offset:1024 sc1
    ds_read_b64_tr_b16 v[106:107], v221 offset:18432
    s_waitcnt vmcnt(5) lgkmcnt(15)
    v_mfma_f32_16x16x32_bf16 v[184:187], v[148:151], v[164:167], v[184:187]
    ds_read_b64_tr_b16 v[108:109], v222 offset:16384
    ds_read_b64_tr_b16 v[110:111], v222 offset:18432
    v_mfma_f32_16x16x32_bf16 v[188:191], v[152:155], v[164:167], v[188:191]
    ds_read_b64_tr_b16 v[112:113], v223 offset:16384
    v_mfma_f32_16x16x32_bf16 v[192:195], v[156:159], v[164:167], v[192:195]
    ds_read_b64_tr_b16 v[114:115], v223 offset:18432
    v_mfma_f32_16x16x32_bf16 v[196:199], v[160:163], v[164:167], v[196:199]
    s_add_u32 s14, s14, 2048
    s_cmp_eq_u32 s14, s15
    s_cselect_b32 s14, s1, s14
    buffer_load_dwordx4 v[180:183], v249, s[24:27], s14 offen offset:0 sc1
    ds_read_b64_tr_b16 v[116:117], v220 offset:20480
    s_waitcnt vmcnt(5) lgkmcnt(15)
    v_mfma_f32_16x16x32_bf16 v[184:187], v[20:23], v[232:235], v[184:187]
    ds_read_b64_tr_b16 v[118:119], v220 offset:22528
HB0_9:
    s_cbranch_execz HB0_10
    ds_read_b64_tr_b16 v[120:121], v221 offset:20480
    v_mfma_f32_16x16x32_bf16 v[188:191], v[24:27], v[232:235], v[188:191]
    ds_read_b64_tr_b16 v[122:123], v221 offset:22528
    v_mfma_f32_16x16x32_bf16 v[192:195], v[28:31], v[232:235], v[192:195]
    ds_read_b64_tr_b16 v[124:125], v222 offset:20480
    v_mfma_f32_16x16x32_bf16 v[196:199], v[32:35], v[232:235], v[196:199]
    buffer_load_dwordx4 v[212:215], v249, s[24:27], s14 offen offset:1024 sc1
    ds_read_b64_tr_b16 v[126:127], v222 offset:22528
    s_waitcnt vmcnt(5) lgkmcnt(15)
    v_mfma_f32_16x16x32_bf16 v[184:187], v[36:39], v[236:239], v[184:187]
    ds_read_b64_tr_b16 v[128:129], v223 offset:20480
    ds_read_b64_tr_b16 v[130:131], v223 offset:22528
    v_mfma_f32_16x16x32_bf16 v[188:191], v[40:43], v[236:239], v[188:191]
    ds_read_b64_tr_b16 v[132:133], v220 offset:24576
    v_mfma_f32_16x16x32_bf16 v[192:195], v[44:47], v[236:239], v[192:195]
    ds_read_b64_tr_b16 v[134:135], v220 offset:26624
    v_mfma_f32_16x16x32_bf16 v[196:199], v[48:51], v[236:239], v[196:199]
    s_add_u32 s14, s14, 2048
    s_cmp_eq_u32 s14, s15
    s_cselect_b32 s14, s1, s14
    buffer_load_dwordx4 v[12:15], v249, s[24:27], s14 offen offset:0 sc1
    ds_read_b64_tr_b16 v[136:137], v221 offset:24576
    s_waitcnt vmcnt(5) lgkmcnt(15)
    v_mfma_f32_16x16x32_bf16 v[184:187], v[52:55], v[168:171], v[184:187]
    ds_read_b64_tr_b16 v[138:139], v221 offset:26624
    ds_read_b64_tr_b16 v[140:141], v222 offset:24576
    v_mfma_f32_16x16x32_bf16 v[188:191], v[56:59], v[168:171], v[188:191]
    ds_read_b64_tr_b16 v[142:143], v222 offset:26624
    v_mfma_f32_16x16x32_bf16 v[192:195], v[60:63], v[168:171], v[192:195]
    ds_read_b64_tr_b16 v[144:145], v223 offset:24576
    v_mfma_f32_16x16x32_bf16 v[196:199], v[64:67], v[168:171], v[196:199]
    buffer_load_dwordx4 v[164:167], v249, s[24:27], s14 offen offset:1024 sc1
    ds_read_b64_tr_b16 v[146:147], v223 offset:26624
HB0_10:
    s_cbranch_execz HB_ret
    s_waitcnt vmcnt(5) lgkmcnt(15)
    v_mfma_f32_16x16x32_bf16 v[184:187], v[68:71], v[172:175], v[184:187]
    ds_read_b64_tr_b16 v[148:149], v220 offset:28672
    ds_read_b64_tr_b16 v[150:151], v220 offset:30720
    v_mfma_f32_16x16x32_bf16 v[188:191], v[72:75], v[172:175], v[188:191]
    ds_read_b64_tr_b16 v[152:153], v221 offset:28672
    v_mfma_f32_16x16x32_bf16 v[192:195], v[76:79], v[172:175], v[192:195]
    ds_read_b64_tr_b16 v[154:155], v221 offset:30720
    v_mfma_f32_16x16x32_bf16 v[196:199], v[80:83], v[172:175], v[196:199]
    s_add_u32 s14, s14, 2048
    s_cmp_eq_u32 s14, s15
    s_cselect_b32 s14, s1, s14
    buffer_load_dwordx4 v[232:235], v249, s[24:27], s14 offen offset:0 sc1
    ds_read_b64_tr_b16 v[156:157], v222 offset:28672
    s_waitcnt vmcnt(5) lgkmcnt(15)
    v_mfma_f32_16x16x32_bf16 v[184:187], v[84:87], v[176:179], v[184:187]
    ds_read_b64_tr_b16 v[158:159], v222 offset:30720
    ds_read_b64_tr_b16 v[160:161], v223 offset:28672
    v_mfma_f32_16x16x32_bf16 v[188:191], v[88:91], v[176:179], v[188:191]
    ds_read_b64_tr_b16 v[162:163], v223 offset:30720
    v_mfma_f32_16x16x32_bf16 v[192:195], v[92:95], v[176:179], v[192:195]
    ds_read_b64_tr_b16 v[20:21], v220 offset:32768
    v_mfma_f32_16x16x32_bf16 v[196:199], v[96:99], v[176:179], v[196:199]
    buffer_load_dwordx4 v[236:239], v249, s[24:27], s14 offen offset:1024 sc1
    ds_read_b64_tr_b16 v[22:23], v220 offset:34816
    s_waitcnt vmcnt(5) lgkmcnt(15)
    v_mfma_f32_16x16x32_bf16 v[184:187], v[100:103], v[180:183], v[184:187]
    ds_read_b64_tr_b16 v[24:25], v221 offset:32768
    ds_read_b64_tr_b16 v[26:27], v221 offset:34816
    v_mfma_f32_16x16x32_bf16 v[188:191], v[104:107], v[180:183], v[188:191]
    ds_read_b64_tr_b16 v[28:29], v222 offset:32768
    v_mfma_f32_16x16x32_bf16 v[192:195], v[108:111], v[180:183], v[192:195]
    ds_read_b64_tr_b16 v[30:31], v222 offset:34816
    v_mfma_f32_16x16x32_bf16 v[196:199], v[112:115], v[180:183], v[196:199]
HB1_0:
    s_cbranch_execz HB1_1
    ds_read_b64_tr_b16 v[32:33], v223 offset:32768
    s_waitcnt vmcnt(4) lgkmcnt(15)
    v_mfma_f32_16x16x32_bf16 v[184:187], v[116:119], v[212:215], v[184:187]
    ds_read_b64_tr_b16 v[34:35], v223 offset:34816
    ds_read_b64_tr_b16 v[36:37], v220 offset:36864
    v_mfma_f32_16x16x32_bf16 v[188:191], v[120:123], v[212:215], v[188:191]
    ds_read_b64_tr_b16 v[38:39], v220 offset:38912
    v_mfma_f32_16x16x32_bf16 v[192:195], v[124:127], v[212:215], v[192:195]
    ds_read_b64_tr_b16 v[40:41], v221 offset:36864
    v_mfma_f32_16x16x32_bf16 v[196:199], v[128:131], v[212:215], v[196:199]
    ds_read_b64_tr_b16 v[42:43], v221 offset:38912
    s_waitcnt vmcnt(3) lgkmcnt(15)
    v_mfma_f32_16x16x32_bf16 v[184:187], v[132:135], v[12:15], v[184:187]
    ds_read_b64_tr_b16 v[44:45], v222 offset:36864
    ds_read_b64_tr_b16 v[46:47], v222 offset:38912
    v_mfma_f32_16x16x32_bf16 v[188:191], v[136:139], v[12:15], v[188:191]
    ds_read_b64_tr_b16 v[48:49], v223 offset:36864
    v_mfma_f32_16x16x32_bf16 v[192:195], v[140:143], v[12:15], v[192:195]
    ds_read_b64_tr_b16 v[50:51], v223 offset:38912
    v_mfma_f32_16x16x32_bf16 v[196:199], v[144:147], v[12:15], v[196:199]
    s_waitcnt vmcnt(2) lgkmcnt(15)
    v_mfma_f32_16x16x32_bf16 v[184:187], v[148:151], v[164:167], v[184:187]
    v_mfma_f32_16x16x32_bf16 v[188:191], v[152:155], v[164:167], v[188:191]
    v_mfma_f32_16x16x32_bf16 v[192:195], v[156:159], v[164:167], v[192:195]
    v_mfma_f32_16x16x32_bf16 v[196:199], v[160:163], v[164:167], v[196:199]
    ds_read_b32 v10, v251 offset:4
    s_waitcnt vmcnt(1) lgkmcnt(9)
    v_mfma_f32_16x16x32_bf16 v[184:187], v[20:23], v[232:235], v[184:187]
    v_mfma_f32_16x16x32_bf16 v[188:191], v[24:27], v[232:235], v[188:191]
    v_mfma_f32_16x16x32_bf16 v[192:195], v[28:31], v[232:235], v[192:195]
    v_mfma_f32_16x16x32_bf16 v[196:199], v[32:35], v[232:235], v[196:199]
    s_waitcnt vmcnt(0) lgkmcnt(1)
    v_mfma_f32_16x16x32_bf16 v[184:187], v[36:39], v[236:239], v[184:187]
    v_mfma_f32_16x16x32_bf16 v[188:191], v[40:43], v[236:239], v[188:191]
HB1_1:
    s_cbranch_execz HB1_2
    v_mfma_f32_16x16x32_bf16 v[192:195], v[44:47], v[236:239], v[192:195]
    v_mfma_f32_16x16x32_bf16 v[196:199], v[48:51], v[236:239], v[196:199]
    s_branch B_epi
B_half:
    s_add_u32 s14, s14, 2048
    s_cmp_eq_u32 s14, s15
    s_cselect_b32 s14, s1, s14
    buffer_load_dwordx4 v[164:167], v249, s[24:27], s14 offen offset:0 sc1
    buffer_load_dwordx4 v[232:235], v249, s[24:27], s14 offen offset:1024 sc1
    s_mov_b32 s14, s16
    buffer_load_dwordx4 v[236:239], v249, s[24:27], s14 offen offset:0 sc1
    s_cmp_lg_u32 s48, 6
    s_cbranch_scc1 E_end
    s_setprio 3
E_poll:
    s_mov_b32 exec_hi, 0x0fffffff
    buffer_load_dword v17, v203, s[24:27], s100 offen sc1
    s_mov_b32 exec_hi, -1
    buffer_load_dwordx3 v[224:226], v4, s[24:27], s58 offen sc1
    buffer_load_dwordx3 v[228:230], v4, s[24:27], s59 offen sc1
    buffer_load_dwordx3 v[240:242], v4, s[24:27], s60 offen sc1
    buffer_load_dwordx3 v[244:246], v4, s[24:27], s12 offen sc1
    buffer_load_dwordx3 v[208:210], v4, s[24:27], s13 offen sc1
E_chk:
    s_waitcnt vmcnt(5)
    v_cmp_ne_u32 vcc, s54, v17
    s_lshl_b64 vcc, vcc, 4
    s_cbranch_scc0 E_go
    s_sleep 1
    s_sub_u32 s3, s3, 1
    s_cbranch_scc0 E_poll
    s_mov_b32 s3, 0
E_go:
    s_waitcnt vmcnt(4)
    s_waitcnt vmcnt(3)
    v_add_f32 v252, v224, v228
    v_add_f32 v253, v225, v229
    v_add_f32 v254, v226, v230
    v_lshlrev_b32 v224, 16, v224
    v_lshlrev_b32 v225, 16, v225
    v_lshlrev_b32 v226, 16, v226
    v_lshlrev_b32 v228, 16, v228
    v_lshlrev_b32 v229, 16, v229
    v_lshlrev_b32 v230, 16, v230
    v_add_f32 v224, v224, v228
    v_add_f32 v225, v225, v229
    v_add_f32 v226, v226, v230
    s_waitcnt vmcnt(2)
    v_add_f32 v252, v252, v240
    v_add_f32 v253, v253, v241
    v_add_f32 v254, v254, v242
    v_lshlrev_b32 v240, 16, v240
    v_lshlrev_b32 v241, 16, v241
    v_lshlrev_b32 v242, 16, v242
HB1_2:
    s_cbranch_execz HB1_3
    v_add_f32 v224, v224, v240
    v_add_f32 v225, v225, v241
    v_add_f32 v226, v226, v242
    s_waitcnt vmcnt(1)
    v_add_f32 v252, v252, v244
    v_add_f32 v253, v253, v245
    v_add_f32 v254, v254, v246
    v_lshlrev_b32 v244, 16, v244
    v_lshlrev_b32 v245, 16, v245
    v_lshlrev_b32 v246, 16, v246
    v_add_f32 v224, v224, v244
    v_add_f32 v225, v225, v245
    v_add_f32 v226, v226, v246
    s_waitcnt vmcnt(0)
    v_add_f32 v252, v252, v208
    v_add_f32 v253, v253, v209
    v_add_f32 v254, v254, v210
    v_lshlrev_b32 v208, 16, v208
    v_lshlrev_b32 v209, 16, v209
    v_lshlrev_b32 v210, 16, v210
    v_add_f32 v224, v224, v208
    v_add_f32 v225, v225, v209
    v_add_f32 v226, v226, v210
    v_permlane32_swap_b32 v224, v252
    v_permlane32_swap_b32 v225, v253
    v_permlane32_swap_b32 v226, v254
    v_add_f32 v224, v224, v252
    v_add_f32 v225, v225, v253
    v_add_f32 v226, v226, v254
    v_rsq_f32 v252, v224
    v_rsq_f32 v253, v225
    v_rsq_f32 v254, v226
    v_permlane32_swap_b32 v252, v228
    v_permlane32_swap_b32 v253, v229
    v_permlane32_swap_b32 v254, v230
    v_mul_f32 v224, v224, v228
    v_mul_f32 v225, v225, v229
    v_mul_f32 v226, v226, v230
    v_and_or_b32 v252, v224, v204, v8
    v_and_or_b32 v253, v225, v205, v9
    v_and_or_b32 v254, v226, v206, v10
    v_max3_i32 v6, v252, v253, v254
    s_nop 1
    v_max_i32_dpp v6, v6, v6 row_ror:1 row_mask:0xf bank_mask:0xf
    s_nop 1
    v_max_i32_dpp v6, v6, v6 row_ror:2 row_mask:0xf bank_mask:0xf
    s_nop 1
    v_max_i32_dpp v6, v6, v6 row_ror:4 row_mask:0xf bank_mask:0xf
    s_nop 1
    v_max_i32_dpp v6, v6, v6 row_ror:8 row_mask:0xf bank_mask:0xf
    v_mov_b32 v5, v6
    s_nop 1
    v_permlane16_swap_b32 v6, v5
    s_mov_b64 exec, 0xffff
HB1_3:
    s_cbranch_execz HB1_4
    s_cmp_lg_u32 s51, 0
    v_max3_i32 v6, v6, v5, 1
    s_cbranch_scc1 E_np
    buffer_store_dwordx2 v[6:7], v11, s[24:27], s45 offen sc1
E_np:
    ds_write_b32 v251, v6 offset:4
    s_mov_b64 exec, -1
E_end:
    s_waitcnt vmcnt(8) lgkmcnt(15)
    v_mfma_f32_16x16x32_bf16 v[184:187], v[52:55], v[168:171], v[184:187]
    v_mfma_f32_16x16x32_bf16 v[188:191], v[56:59], v[168:171], v[188:191]
    v_mfma_f32_16x16x32_bf16 v[192:195], v[60:63], v[168:171], v[192:195]
    v_mfma_f32_16x16x32_bf16 v[196:199], v[64:67], v[168:171], v[196:199]
    s_waitcnt vmcnt(7) lgkmcnt(15)
    v_mfma_f32_16x16x32_bf16 v[184:187], v[68:71], v[172:175], v[184:187]
    v_mfma_f32_16x16x32_bf16 v[188:191], v[72:75], v[172:175], v[188:191]
    v_mfma_f32_16x16x32_bf16 v[192:195], v[76:79], v[172:175], v[192:195]
    v_mfma_f32_16x16x32_bf16 v[196:199], v[80:83], v[172:175], v[196:199]
    s_waitcnt vmcnt(6) lgkmcnt(15)
    v_mfma_f32_16x16x32_bf16 v[184:187], v[84:87], v[176:179], v[184:187]
    v_mfma_f32_16x16x32_bf16 v[188:191], v[88:91], v[176:179], v[188:191]
    v_mfma_f32_16x16x32_bf16 v[192:195], v[92:95], v[176:179], v[192:195]
    v_mfma_f32_16x16x32_bf16 v[196:199], v[96:99], v[176:179], v[196:199]
    s_waitcnt vmcnt(5) lgkmcnt(15)
    v_mfma_f32_16x16x32_bf16 v[184:187], v[100:103], v[180:183], v[184:187]
    v_mfma_f32_16x16x32_bf16 v[188:191], v[104:107], v[180:183], v[188:191]
    v_mfma_f32_16x16x32_bf16 v[192:195], v[108:111], v[180:183], v[192:195]
    v_mfma_f32_16x16x32_bf16 v[196:199], v[112:115], v[180:183], v[196:199]
    s_waitcnt vmcnt(4) lgkmcnt(15)
    v_mfma_f32_16x16x32_bf16 v[184:187], v[116:119], v[212:215], v[184:187]
    v_mfma_f32_16x16x32_bf16 v[188:191], v[120:123], v[212:215], v[188:191]
    v_mfma_f32_16x16x32_bf16 v[192:195], v[124:127], v[212:215], v[192:195]
    v_mfma_f32_16x16x32_bf16 v[196:199], v[128:131], v[212:215], v[196:199]
    s_waitcnt vmcnt(3) lgkmcnt(15)
    v_mfma_f32_16x16x32_bf16 v[184:187], v[132:135], v[12:15], v[184:187]
    v_mfma_f32_16x16x32_bf16 v[188:191], v[136:139], v[12:15], v[188:191]
    v_mfma_f32_16x16x32_bf16 v[192:195], v[140:143], v[12:15], v[192:195]
    v_mfma_f32_16x16x32_bf16 v[196:199], v[144:147], v[12:15], v[196:199]
HB1_4:
    s_cbranch_execz HB1_5
    s_waitcnt vmcnt(2) lgkmcnt(15)
    v_mfma_f32_16x16x32_bf16 v[184:187], v[148:151], v[164:167], v[184:187]
    v_mfma_f32_16x16x32_bf16 v[188:191], v[152:155], v[164:167], v[188:191]
    v_mfma_f32_16x16x32_bf16 v[192:195], v[156:159], v[164:167], v[192:195]
    v_mfma_f32_16x16x32_bf16 v[196:199], v[160:163], v[164:167], v[196:199]
    s_waitcnt vmcnt(1) lgkmcnt(8)
    v_mfma_f32_16x16x32_bf16 v[184:187], v[20:23], v[232:235], v[184:187]
    v_mfma_f32_16x16x32_bf16 v[188:191], v[24:27], v[232:235], v[188:191]
    v_mfma_f32_16x16x32_bf16 v[192:195], v[28:31], v[232:235], v[192:195]
    v_mfma_f32_16x16x32_bf16 v[196:199], v[32:35], v[232:235], v[196:199]
    s_cmp_eq_u32 s48, 6
    s_cbranch_scc1 B_w6
    s_waitcnt vmcnt(0)
B_w6:
    s_waitcnt lgkmcnt(0)
    v_mfma_f32_16x16x32_bf16 v[184:187], v[36:39], v[236:239], v[184:187]
    v_mfma_f32_16x16x32_bf16 v[188:191], v[40:43], v[236:239], v[188:191]
    v_mfma_f32_16x16x32_bf16 v[192:195], v[44:47], v[236:239], v[192:195]
    v_mfma_f32_16x16x32_bf16 v[196:199], v[48:51], v[236:239], v[196:199]
    s_lshl_b32 s61, s56, 12
    s_add_u32 s61, s61, 135168
    v_add_u32 v16, s61, v202
    s_lshl_b32 s61, s56, 2
    s_add_u32 s61, s61, 160760
    v_mov_b32 v18, s61
    s_cmp_eq_u32 s101, 0
    s_cbranch_scc1 B_rx0
    ds_write_b128 v16, v[184:187] offset:0
    ds_write_b128 v16, v[188:191] offset:1024
    ds_write_b128 v16, v[192:195] offset:2048
    ds_write_b128 v16, v[196:199] offset:3072
    v_mov_b32 v19, 1
    s_waitcnt lgkmcnt(0)
    ds_write_b32 v18, v19
    s_branch L_fin
B_rx0:
B_rx:
    ds_read_b32 v19, v18
    s_waitcnt lgkmcnt(0)
    v_cmp_eq_u32 vcc, 0, v19
    s_cbranch_vccz B_rd
    s_sub_u32 s3, s3, 1
    s_cbranch_scc0 B_rx
    s_mov_b32 s3, 0
B_rd:
    ds_read_b32 v10, v251 offset:4
HB1_5:
    s_cbranch_execz HB1_6
    ds_read_b128 v[100:103], v16 offset:0
    ds_read_b128 v[104:107], v16 offset:1024
    ds_read_b128 v[108:111], v16 offset:2048
    ds_read_b128 v[112:115], v16 offset:3072
    s_waitcnt lgkmcnt(0)
    v_add_f32 v184, v184, v100
    v_add_f32 v185, v185, v101
    v_add_f32 v186, v186, v102
    v_add_f32 v187, v187, v103
    v_add_f32 v188, v188, v104
    v_add_f32 v189, v189, v105
    v_add_f32 v190, v190, v106
    v_add_f32 v191, v191, v107
    v_add_f32 v192, v192, v108
    v_add_f32 v193, v193, v109
    v_add_f32 v194, v194, v110
    v_add_f32 v195, v195, v111
    v_add_f32 v196, v196, v112
    v_add_f32 v197, v197, v113
    v_add_f32 v198, v198, v114
    v_add_f32 v199, v199, v115
B_epi:
    s_waitcnt lgkmcnt(0)
    v_cmp_eq_u32 vcc, 0, v10
    v_and_b32 v10, 0xfff, v10
    s_cbranch_vccnz B_ew
B_eg:
    v_cmp_eq_u32 s[68:69], v10, v226
    v_add_u32 v10, s54, v10
    v_mov_b32 v16, 0x3f803f80
    v_mov_b32 v15, s54
    s_add_u32 s63, s1, 20480
    s_lshl_b32 s64, s51, 8
    s_add_u32 s64, s64, s63
    v_cvt_pk_bf16_f32 v52, v184, v185
    v_cvt_pk_bf16_f32 v53, v186, v187
    v_cvt_pk_bf16_f32 v54, v188, v189
    v_cvt_pk_bf16_f32 v55, v190, v191
    v_cvt_pk_bf16_f32 v56, v192, v193
    v_cvt_pk_bf16_f32 v57, v194, v195
    v_cvt_pk_bf16_f32 v58, v196, v197
    v_cvt_pk_bf16_f32 v59, v198, v199
    s_cmp_eq_u64 s[68:69], 0
    s_cbranch_scc1 B_np2
    s_mov_b64 exec, s[68:69]
    ds_write_b128 v228, v[52:55] offset:0
    ds_write_b128 v228, v[56:59] offset:16
    s_mov_b64 exec, -1
HB1_6:
    s_cbranch_execz HB1_7
    ds_read_b64 v[8:9], v252
    s_waitcnt lgkmcnt(0)
    buffer_store_dwordx3 v[8:10], v224, s[24:27], s44 offen sc1
B_np2:
    v_mfma_f32_16x16x32_bf16 v[12:15], v[240:243], v[52:55], 0
    v_mfma_f32_16x16x32_bf16 v[12:15], v[244:247], v[56:59], v[12:15]
    v_dot2_f32_bf16 v16, v52, v52, 0
    v_dot2_f32_bf16 v17, v53, v53, 0
    v_dot2_f32_bf16 v16, v54, v54, v16
    v_dot2_f32_bf16 v17, v55, v55, v17
    v_dot2_f32_bf16 v16, v56, v56, v16
    v_dot2_f32_bf16 v17, v57, v57, v17
    v_dot2_f32_bf16 v16, v58, v58, v16
    v_dot2_f32_bf16 v17, v59, v59, v17
    s_nop 2
    v_add_f32 v16, v16, v17
    v_mov_b32 v17, v16
    s_nop 1
    v_permlane32_swap_b32 v16, v17
    v_add_f32 v16, v16, v17
    v_mov_b32 v17, v16
    v_mov_b32 v15, s54
    s_nop 0
    v_permlane16_swap_b32 v16, v17
    v_add_f32 v13, v16, v17
    s_mov_b64 exec, 0xffff
    s_cmp_eq_u32 s49, 0
    s_cbranch_scc1 sts_9
    buffer_store_dwordx4 v[12:15], v202, s[24:27], s64 offen
std_10:
    s_mov_b64 exec, -1
    v_lshlrev_b32 v36, 16, v52
    v_and_b32 v37, s47, v52
    v_lshlrev_b32 v38, 16, v53
    v_and_b32 v39, s47, v53
    v_lshlrev_b32 v40, 16, v54
    v_and_b32 v41, s47, v54
    v_lshlrev_b32 v42, 16, v55
    v_and_b32 v43, s47, v55
    v_lshlrev_b32 v44, 16, v56
    v_and_b32 v45, s47, v56
    v_lshlrev_b32 v46, 16, v57
    v_and_b32 v47, s47, v57
    v_lshlrev_b32 v48, 16, v58
    v_and_b32 v49, s47, v58
    v_lshlrev_b32 v50, 16, v59
    v_and_b32 v51, s47, v59
    v_mov_b32 v108, 0
    v_mov_b32 v109, 0
    v_mov_b32 v110, 0
HB1_7:
    s_cbranch_execz HB1_8
    v_mov_b32 v111, s54
    v_mov_b32 v11, s54
    v_lshlrev_b32 v7, 11, v200
    s_add_u32 s45, s45, 32768
    s_sub_u32 s44, s44, 131072
    buffer_load_dwordx4 v[100:103], v202, s[24:27], s63 offen offset:0 sc1
    buffer_load_dwordx4 v[104:107], v202, s[24:27], s63 offen offset:1024 sc1
    s_mov_b32 exec_hi, 0
    buffer_load_dwordx4 v[108:111], v202, s[24:27], s63 offen offset:2048 sc1
    s_mov_b32 exec_hi, -1
    s_branch S_pw
S_poll:
    s_mov_b64 exec, s[58:59]
    s_cbranch_execz S_r0
    buffer_load_dwordx4 v[100:103], v202, s[24:27], s63 offen offset:0 sc1
S_r0:
    s_mov_b64 exec, s[64:65]
    s_cbranch_execz S_r1
    buffer_load_dwordx4 v[104:107], v202, s[24:27], s63 offen offset:1024 sc1
S_r1:
    s_mov_b64 exec, s[66:67]
    s_cbranch_execz S_r2
    buffer_load_dwordx4 v[108:111], v202, s[24:27], s63 offen offset:2048 sc1
S_r2:
    s_mov_b64 exec, -1
S_pw:
    s_waitcnt vmcnt(0)
    v_cmp_ne_u32 s[58:59], s54, v103
    v_cmp_ne_u32 s[64:65], s54, v107
    v_cmp_ne_u32 s[66:67], s54, v111
    s_or_b64 vcc, s[58:59], s[64:65]
    s_or_b64 vcc, vcc, s[66:67]
    s_cbranch_scc0 S_got
    s_sub_u32 s3, s3, 1
    s_cbranch_scc0 S_poll
    s_mov_b32 s3, 0
S_got:
    v_add_f32 v12, v100, v104
    v_add_f32 v13, v101, v105
    v_add_f32 v14, v102, v106
    v_add_f32 v12, v12, v108
    v_add_f32 v13, v13, v109
    v_add_f32 v14, v14, v110
    v_mov_b32 v17, v12
    v_mov_b32 v18, v13
    v_mov_b32 v19, v14
    v_permlane32_swap_b32 v17, v12
    v_permlane32_swap_b32 v18, v13
    v_permlane32_swap_b32 v19, v14
    v_add_f32 v12, v12, v17
    v_add_f32 v13, v13, v18
    v_add_f32 v14, v14, v19
    v_mov_b32 v17, v12
    v_mov_b32 v18, v13
    v_mov_b32 v19, v14
    v_permlane16_swap_b32 v17, v12
    v_permlane16_swap_b32 v18, v13
    v_permlane16_swap_b32 v19, v14
HB1_8:
    s_cbranch_execz HB1_9
    v_add_f32 v12, v12, v17
    v_add_f32 v13, v13, v18
    v_add_f32 v14, v14, v19
    v_mul_f32 v12, 0x3acccccd, v12
    v_mul_f32 v13, 0x3acccccd, v13
    v_fma_f32 v13, -v12, v12, v13
    v_max_f32 v13, 0, v13
    v_cvt_pk_bf16_f32 v13, v13, v13
    v_and_b32 v13, 0xffff0000, v13
    v_add_f32 v13, 0x3727c5ac, v13
    v_cvt_pk_bf16_f32 v13, v13, v13
    v_and_b32 v13, 0xffff0000, v13
    v_sqrt_f32 v13, v13
    v_cvt_pk_bf16_f32 v12, v12, v12
    v_and_b32 v12, 0xffff0000, v12
    v_cvt_pk_bf16_f32 v13, v13, v13
    v_and_b32 v13, 0xffff0000, v13
    v_rcp_f32 v13, v13
    v_fma_f32 v14, -v12, v248, v14
    v_mul_f32 v14, v14, v13
    v_ashrrev_i32 v6, 31, v14
    v_or_b32 v6, 0x80000000, v6
    v_xor_b32 v6, v6, v14
    v_and_b32 v6, 0xfffff000, v6
    v_or_b32 v6, v6, v226
    s_and_b64 exec, s[4:5], 0xffff
    ds_max_u32 v251, v6 offset:12
    s_mov_b64 exec, -1
    s_and_b64 s[68:69], s[68:69], s[4:5]
    s_cbranch_scc0 S_ne
    s_call_b64 s[98:99], S_ln
    s_mov_b64 exec, s[68:69]
    buffer_store_dwordx4 v[60:63], v225, s[40:43], 0 offen offset:0 sc1
    buffer_store_dwordx4 v[64:67], v225, s[40:43], 0 offen offset:64 sc1
    s_mov_b64 exec, -1
S_ne:
    s_waitcnt lgkmcnt(0)
    s_barrier
    ds_read_b32 v10, v251 offset:12
    s_or_b32 s64, s51, s48
    s_waitcnt lgkmcnt(0)
    s_cbranch_scc1 S_nc
    s_mov_b64 exec, 0xffff
HB1_9:
    s_cbranch_execz HB1_10
    buffer_store_dwordx2 v[10:11], v7, s[24:27], s45 offen sc1
    s_mov_b64 exec, -1
S_nc:
    v_cmp_eq_u32 s[60:61], v10, v6
    s_cmp_lg_u64 s[68:69], 0
    s_cbranch_scc1 S_l2
    s_call_b64 s[98:99], S_ln
S_l2:
    s_and_b64 s[60:61], s[60:61], s[4:5]
    s_cbranch_scc0 S_out
    s_andn2_b64 exec, s[60:61], s[68:69]
    s_cbranch_execz S_l3
    buffer_store_dwordx4 v[60:63], v225, s[40:43], 0 offen offset:0 sc1
    buffer_store_dwordx4 v[64:67], v225, s[40:43], 0 offen offset:64 sc1
S_l3:
    s_mov_b64 exec, s[60:61]
    ds_write_b128 v228, v[52:55] offset:0
    ds_write_b128 v228, v[56:59] offset:16
    s_mov_b64 exec, -1
    ds_read_b64 v[8:9], v252
    v_and_b32 v10, 0xfff, v10
    v_add_u32 v10, s54, v10
    s_mov_b64 exec, 0xffff
    s_waitcnt vmcnt(0) lgkmcnt(0)
    buffer_store_dwordx3 v[8:10], v224, s[24:27], s44 offen sc1
S_out:
    s_nor_b64 exec, s[60:61], s[68:69]
    buffer_store_dwordx4 v[60:63], v225, s[40:43], 0 offen offset:0 sc1
    buffer_store_dwordx4 v[64:67], v225, s[40:43], 0 offen offset:64 sc1
    s_mov_b64 exec, -1
    s_branch L_fin
S_ln:
    v_pk_add_f32 v[20:21], v[36:37], v[12:13] op_sel_hi:[1,0] neg_lo:[0,1] neg_hi:[0,1]
    v_pk_add_f32 v[22:23], v[38:39], v[12:13] op_sel_hi:[1,0] neg_lo:[0,1] neg_hi:[0,1]
    v_pk_add_f32 v[24:25], v[40:41], v[12:13] op_sel_hi:[1,0] neg_lo:[0,1] neg_hi:[0,1]
    v_pk_add_f32 v[26:27], v[42:43], v[12:13] op_sel_hi:[1,0] neg_lo:[0,1] neg_hi:[0,1]
    v_pk_add_f32 v[28:29], v[44:45], v[12:13] op_sel_hi:[1,0] neg_lo:[0,1] neg_hi:[0,1]
    v_pk_add_f32 v[30:31], v[46:47], v[12:13] op_sel_hi:[1,0] neg_lo:[0,1] neg_hi:[0,1]
    v_pk_add_f32 v[32:33], v[48:49], v[12:13] op_sel_hi:[1,0] neg_lo:[0,1] neg_hi:[0,1]
    v_pk_add_f32 v[34:35], v[50:51], v[12:13] op_sel_hi:[1,0] neg_lo:[0,1] neg_hi:[0,1]
    v_cvt_pk_bf16_f32 v60, v20, v21
    v_cvt_pk_bf16_f32 v61, v22, v23
    v_cvt_pk_bf16_f32 v62, v24, v25
    v_cvt_pk_bf16_f32 v63, v26, v27
HB1_10:
    s_cbranch_execz HB1_11
    v_cvt_pk_bf16_f32 v64, v28, v29
    v_cvt_pk_bf16_f32 v65, v30, v31
    v_cvt_pk_bf16_f32 v66, v32, v33
    v_cvt_pk_bf16_f32 v67, v34, v35
    v_lshlrev_b32 v20, 16, v60
    v_and_b32 v21, s47, v60
    v_lshlrev_b32 v22, 16, v61
    v_and_b32 v23, s47, v61
    v_lshlrev_b32 v24, 16, v62
    v_and_b32 v25, s47, v62
    v_lshlrev_b32 v26, 16, v63
    v_and_b32 v27, s47, v63
    v_lshlrev_b32 v28, 16, v64
    v_and_b32 v29, s47, v64
    v_lshlrev_b32 v30, 16, v65
    v_and_b32 v31, s47, v65
    v_lshlrev_b32 v32, 16, v66
    v_and_b32 v33, s47, v66
    v_lshlrev_b32 v34, 16, v67
    v_and_b32 v35, s47, v67
    v_pk_mul_f32 v[20:21], v[20:21], v[12:13] op_sel:[0,1]
    v_pk_mul_f32 v[22:23], v[22:23], v[12:13] op_sel:[0,1]
    v_pk_mul_f32 v[24:25], v[24:25], v[12:13] op_sel:[0,1]
    v_pk_mul_f32 v[26:27], v[26:27], v[12:13] op_sel:[0,1]
    v_pk_mul_f32 v[28:29], v[28:29], v[12:13] op_sel:[0,1]
    v_pk_mul_f32 v[30:31], v[30:31], v[12:13] op_sel:[0,1]
    v_pk_mul_f32 v[32:33], v[32:33], v[12:13] op_sel:[0,1]
    v_pk_mul_f32 v[34:35], v[34:35], v[12:13] op_sel:[0,1]
    v_cvt_pk_bf16_f32 v60, v20, v21
    v_cvt_pk_bf16_f32 v61, v22, v23
    v_cvt_pk_bf16_f32 v62, v24, v25
    v_cvt_pk_bf16_f32 v63, v26, v27
    v_cvt_pk_bf16_f32 v64, v28, v29
    v_cvt_pk_bf16_f32 v65, v30, v31
    v_cvt_pk_bf16_f32 v66, v32, v33
    v_cvt_pk_bf16_f32 v67, v34, v35
    v_lshlrev_b32 v20, 16, v60
    v_and_b32 v21, s47, v60
    v_lshlrev_b32 v22, 16, v61
    v_and_b32 v23, s47, v61
    v_lshlrev_b32 v24, 16, v62
    v_and_b32 v25, s47, v62
    v_lshlrev_b32 v26, 16, v63
HB1_11:
    s_cbranch_execz HB_ret
    v_and_b32 v27, s47, v63
    v_lshlrev_b32 v28, 16, v64
    v_and_b32 v29, s47, v64
    v_lshlrev_b32 v30, 16, v65
    v_and_b32 v31, s47, v65
    v_lshlrev_b32 v32, 16, v66
    v_and_b32 v33, s47, v66
    v_lshlrev_b32 v34, 16, v67
    v_and_b32 v35, s47, v67
    v_pk_add_f32 v[20:21], v[20:21], v[36:37]
    v_pk_add_f32 v[22:23], v[22:23], v[38:39]
    v_pk_add_f32 v[24:25], v[24:25], v[40:41]
    v_pk_add_f32 v[26:27], v[26:27], v[42:43]
    v_pk_add_f32 v[28:29], v[28:29], v[44:45]
    v_pk_add_f32 v[30:31], v[30:31], v[46:47]
    v_pk_add_f32 v[32:33], v[32:33], v[48:49]
    v_pk_add_f32 v[34:35], v[34:35], v[50:51]
    v_cvt_pk_bf16_f32 v60, v20, v21
    v_cvt_pk_bf16_f32 v61, v22, v23
    v_cvt_pk_bf16_f32 v62, v24, v25
    v_cvt_pk_bf16_f32 v63, v26, v27
    v_cvt_pk_bf16_f32 v64, v28, v29
    v_cvt_pk_bf16_f32 v65, v30, v31
    v_cvt_pk_bf16_f32 v66, v32, v33
    v_cvt_pk_bf16_f32 v67, v34, v35
    v_permlane16_swap_b32 v60, v62
    v_permlane16_swap_b32 v61, v63
    v_permlane16_swap_b32 v64, v66
    v_permlane16_swap_b32 v65, v67
    s_setpc_b64 s[98:99]
L_fin:
L_end:
    s_endpgm
AT_mask:
    v_mov_b32 v17, 0xf149f2ca
    v_cmp_le_i32 vcc, 8, v212
    s_nop 1
    v_cndmask_b32 v60, v17, v60, vcc
    v_cmp_le_i32 vcc, 7, v212
    s_nop 1
    v_cndmask_b32 v61, v17, v61, vcc
    v_cmp_le_i32 vcc, 6, v212
    s_nop 1
    v_cndmask_b32 v62, v17, v62, vcc
    v_cmp_le_i32 vcc, 5, v212
    s_nop 1
    v_cndmask_b32 v63, v17, v63, vcc
    v_cmp_le_i32 vcc, 4, v212
    s_nop 1
    v_cndmask_b32 v64, v17, v64, vcc
    v_cmp_le_i32 vcc, 3, v212
    s_nop 1
    v_cndmask_b32 v65, v17, v65, vcc
    v_cmp_le_i32 vcc, 2, v212
    s_nop 1
    v_cndmask_b32 v66, v17, v66, vcc
    v_cmp_le_i32 vcc, 1, v212
    s_nop 1
    v_cndmask_b32 v67, v17, v67, vcc
    v_cmp_le_i32 vcc, 0, v212
    s_nop 1
    v_cndmask_b32 v68, v17, v68, vcc
    v_cmp_le_i32 vcc, -1, v212
    s_nop 1
    v_cndmask_b32 v69, v17, v69, vcc
    v_cmp_le_i32 vcc, -2, v212
    s_nop 1
    v_cndmask_b32 v70, v17, v70, vcc
    v_cmp_le_i32 vcc, -3, v212
    s_nop 1
    v_cndmask_b32 v71, v17, v71, vcc
    s_branch AT_nomask
sts_1:
    buffer_store_dwordx4 v[80:83], v213, s[24:27], s12 offen offset:0 sc1
    buffer_store_dwordx4 v[84:87], v213, s[24:27], s12 offen offset:512 sc1
    s_branch std_2
AT_vs:
    ds_read_b32 v17, v251 offset:8
    s_sub_u32 s3, s3, 1
    s_cbranch_scc0 AT_vc
    s_mov_b32 s3, 0
    s_branch AT_vg
sts_3:
    buffer_store_dwordx4 v[204:207], v249, s[24:27], s22 offen offset:0 sc1
    buffer_store_dwordx4 v[208:211], v249, s[24:27], s22 offen offset:1024 sc1
    s_branch std_4
sts_5:
    buffer_store_short_d16_hi v20, v164, s[24:27], s65 offen sc1
    s_branch std_6
sts_7:
    buffer_store_dword v79, v203, s[24:27], s23 offen sc1
    s_branch std_8
B_ew:
    s_sleep 1
    ds_read_b32 v10, v251 offset:4
    s_sub_u32 s3, s3, 1
    s_cbranch_scc0 B_epi
    s_mov_b32 s3, 0
    s_waitcnt lgkmcnt(0)
    s_branch B_eg
sts_9:
    buffer_store_dwordx4 v[12:15], v202, s[24:27], s64 offen sc1
    s_branch std_10
LD_cont:
    v_and_b32 v0, 63, v0
    s_mov_b32 s3, 0x40000
    s_mov_b32 s47, 0xffff0000
    s_mov_b32 s26, 7340032
    s_mov_b32 s27, 0x00020000
    s_mov_b32 s38, 819200
    s_mov_b32 s39, 0x00020000
    s_mov_b32 s42, 2621440
    s_mov_b32 s43, 0x00020000
    s_sub_u32 s52, s51, 5
    s_cselect_b32 s52, s51, s52
    s_buffer_load_dword s54, s[24:27], 0
    v_lshl_add_u32 v4, s60, 3, v1
    v_mul_u32_u24 v5, 1280, v4
    v_lshlrev_b32 v7, 1, v2
    v_bitop3_b32 v7, v0, 7, v7 bitop3:0x6a
    v_lshl_add_u32 v5, v7, 4, v5
    v_lshl_add_u32 v16, s51, 7, v5
    s_lshl_b32 s71, s53, 11
    s_add_u32 s71, s71, 81920
    s_mul_i32 s62, s60, 24
    v_add_u32 v17, s62, v0
    v_lshlrev_b32 v18, 4, v17
    v_cmp_gt_u32 vcc, 24, v0
    v_add_u32 v19, 72, v0
    v_lshlrev_b32 v19, 4, v19
    v_cndmask_b32 v18, v19, v18, vcc
    s_lshl_b32 s62, s51, 2
    s_add_u32 s62, s62, s60
    s_lshl_b32 s62, s62, 8
    s_sub_u32 s62, s62, s71
    s_add_u32 s62, s62, 1243488
    v_add_u32 v19, s62, v19
    v_cmp_lt_u32 vcc, 33, v0
    s_nop 1
    v_cndmask_b32 v18, v18, v19, vcc
    v_cmp_lt_u32 vcc, 49, v0
    s_nop 1
    v_cndmask_b32 v18, v18, 2.0, vcc
    v_mov_b32 v28, 0
    v_mov_b32 v29, 0
    v_mov_b32 v30, 0
    v_mov_b32 v31, 0
    s_lshl_b32 s62, s60, 6
    v_add_u32 v4, s62, v0
    v_lshlrev_b32 v35, 4, v4
    v_add_u32 v35, 135168, v35
    ds_write_b128 v35, v[28:31] offset:0
    ds_write_b128 v35, v[28:31] offset:4096
    ds_write_b128 v35, v[28:31] offset:8192
    ds_write_b128 v35, v[28:31] offset:12288
    ds_write_b128 v35, v[28:31] offset:16384
    ds_write_b128 v35, v[28:31] offset:20480
    v_lshrrev_b32 v5, 1, v4
    v_min_u32 v5, 61, v5
    v_mul_u32_u24 v5, 400, v5
    v_and_b32 v6, 1, v4
    v_lshl_add_u32 v5, v6, 4, v5
    v_add_u32 v5, 110624, v5
    ds_write_b128 v5, v[28:31]
    v_mov_b32 v6, 159776
    ds_write_b64 v6, v[28:29]
    v_and_b32 v4, 31, v0
    v_lshlrev_b32 v5, 7, v4
    s_lshl_b32 s62, s51, 11
    v_add_u32 v6, s62, v5
    s_lshl_b32 s62, s51, 8
    s_add_u32 s62, s62, 17408
    v_add_u32 v7, s62, v5
    v_cmp_lt_u32 vcc, 23, v4
    s_nop 1
    v_cndmask_b32 v6, v6, v7, vcc
    v_and_b32 v7, 128, v5
    v_add_u32 v7, 23040, v7
    v_cmp_lt_u32 vcc, 25, v4
    s_nop 1
    v_cndmask_b32 v6, v6, v7, vcc
    v_lshrrev_b32 v7, 5, v0
    v_mul_u32_u24 v7, 24320, v7
    v_add_u32 v36, v6, v7
    s_mov_b32 vcc_hi, 0xfcff0000
    s_cmp_eq_u32 s60, 0
    s_cselect_b32 vcc_lo, 0xf0ff5555, vcc_hi
    v_cndmask_b32 v36, v36, 2.0, vcc
    s_waitcnt lgkmcnt(0)
    s_add_u32 s54, s54, 2654435761
    s_lshl_b32 s62, s60, 10
    s_add_u32 s62, s62, 36864
    s_add_u32 s63, s51, 3
    s_sub_u32 s61, s63, 10
    s_cselect_b32 s63, s63, s61
    s_mul_i32 s63, s63, 81920
    s_call_b64 s[98:99], S_late
    s_call_b64 s[98:99], S_late2
    s_call_b64 s[98:99], LD_issue
    s_waitcnt vmcnt(9)
    s_barrier
    s_bitcmp0_b32 s60, 0
    s_cselect_b32 s16, s14, s16
    s_cselect_b32 s17, s15, s17
    s_mov_b64 s[14:15], s[18:19]
    s_and_b32 s17, s17, 0xffff
    s_mov_b32 s18, 1966080
    s_mov_b32 s19, 0x00020000
    s_lshr_b32 s58, s60, 1
    s_lshl1_add_u32 s58, s2, s58
    s_mul_i32 s61, s58, 21846
    s_lshr_b32 s61, s61, 16
    s_mul_i32 s67, s61, 3
    s_sub_u32 s58, s58, s67
    s_mul_i32 s61, s61, 3072
    s_lshl_b32 s58, s58, 10
    s_add_u32 s58, s58, s61
    s_cmp_lt_u32 s61, 73728
    s_cselect_b32 s58, 2.0, s58
    s_buffer_load_dword s59, s[16:19], s58 offset:384
    s_buffer_load_dword s59, s[16:19], s58 offset:448
    s_buffer_load_dword s59, s[16:19], s58 offset:491904
    s_buffer_load_dword s59, s[16:19], s58 offset:491968
    s_add_u32 s58, s58, 983040
    s_call_b64 s[98:99], LD_issue
    s_waitcnt vmcnt(9)
    s_barrier
    s_buffer_load_dword s59, s[16:19], s58 offset:384
    s_buffer_load_dword s59, s[16:19], s58 offset:448
    s_buffer_load_dword s59, s[16:19], s58 offset:491904
    s_buffer_load_dword s59, s[16:19], s58 offset:491968
    s_mul_i32 s58, s60, 61440
    s_add_u32 s58, s58, s44
    s_call_b64 s[98:99], LD_issue
    s_waitcnt vmcnt(9)
    s_barrier
    s_buffer_load_dword s59, s[24:27], s58 offset:0
    s_buffer_load_dword s59, s[24:27], s58 offset:64
    s_buffer_load_dword s59, s[24:27], s58 offset:128
    s_buffer_load_dword s59, s[24:27], s58 offset:192
    s_lshl_b32 s58, s60, 6
    s_add_u32 s58, s58, s44
    s_sub_u32 s58, s58, 131072
    s_call_b64 s[98:99], LD_issue
    s_waitcnt vmcnt(9)
    s_barrier
    s_buffer_load_dword s59, s[24:27], s58
    s_call_b64 s[98:99], LD_issue
    s_waitcnt vmcnt(9)
    s_barrier
    s_call_b64 s[98:99], LD_issue
    s_waitcnt vmcnt(9)
    s_barrier
    s_call_b64 s[98:99], LD_issue
    s_waitcnt vmcnt(9)
    s_barrier
    s_call_b64 s[98:99], LD_issue
    s_waitcnt vmcnt(9)
    s_barrier
    buffer_load_dwordx4 v[20:23], v18, s[24:27], s71 offen sc1
    s_call_b64 s[98:99], LD_issue
    s_waitcnt vmcnt(9)
    s_barrier
    v_mov_b32 v24, 163072
    ds_read_b32 v24, v24
    s_mov_b32 m0, s62
    s_add_u32 s62, s62, 4096
    buffer_load_dwordx4 v16, s[36:39], s63 offen lds
    s_add_u32 s63, s63, 40960
    s_mov_b32 m0, s62
    s_add_u32 s62, s62, 4096
    buffer_load_dwordx4 v16, s[36:39], s63 offen lds
    s_add_u32 s63, s63, 40960
    s_cmp_eq_u32 s63, 819200
    s_cselect_b32 s63, 0, s63
    s_mov_b32 m0, s62
    s_add_u32 s62, s62, 4096
    buffer_load_dwordx4 v16, s[36:39], s63 offen lds
    s_add_u32 s63, s63, 40960
    s_mov_b32 m0, s62
    s_add_u32 s62, s62, 4096
    buffer_load_dwordx4 v16, s[36:39], s63 offen lds
    s_add_u32 s63, s63, 40960
    s_cmp_eq_u32 s63, 819200
    s_cselect_b32 s63, 0, s63
    s_mov_b32 m0, s62
    s_add_u32 s62, s62, 4096
    buffer_load_dwordx4 v16, s[36:39], s63 offen lds
    s_add_u32 s63, s63, 40960
    s_mov_b32 m0, s62
    s_add_u32 s62, s62, 4096
    buffer_load_dwordx4 v16, s[36:39], s63 offen lds
    s_add_u32 s63, s63, 40960
    s_cmp_eq_u32 s63, 819200
    s_cselect_b32 s63, 0, s63
    s_mov_b32 m0, s62
    s_add_u32 s62, s62, 4096
    buffer_load_dwordx4 v16, s[36:39], s63 offen lds
    s_add_u32 s63, s63, 40960
    s_mov_b32 exec_hi, 3
    v_cmp_ne_u32 vcc, s54, v22
    s_cbranch_vccz LD_rs
LD_rsp:
    buffer_load_dwordx4 v[20:23], v18, s[24:27], s71 offen sc1
    s_waitcnt vmcnt(0)
    v_cmp_ne_u32 vcc, s54, v22
    s_cbranch_vccz LD_rs
    s_sleep 1
    s_sub_u32 s3, s3, 1
    s_cbranch_scc0 LD_rsp
    s_mov_b32 s3, 0
LD_rs:
    s_getreg_b32 s61, hwreg(HW_REG_XCC_ID)
    v_cmp_ne_u32 vcc, s61, v20
    s_lshr_b64 vcc, vcc, 24
    s_cselect_b32 s49, 0, 1
    s_lshl_b32 s61, s60, 5
    s_add_u32 s61, s61, 160828
    s_mov_b32 exec_hi, 0x3fffc
    s_mov_b32 exec_lo, 0
    v_cmp_eq_u32 vcc, s54, v22
    v_lshl_add_u32 v4, v0, 1, s61
    s_waitcnt lgkmcnt(0)
    v_mul_f32 v24, 0xbacccccd, v24
    v_fmac_f32 v21, v20, v24
    v_cndmask_b32 v21, 0, v21, vcc
    ds_write_b16_d16_hi v4, v21
    s_mov_b32 exec_hi, 0
    s_mov_b32 exec_lo, 0xffffff
    v_lshlrev_b32 v4, 3, v17
    v_add_u32 v4, 159808, v4
    ds_write_b64 v4, v[20:21]
    v_mov_b32 v4, 160768
    v_mov_b32 v5, s49
    ds_write_b32 v4, v5
    ds_write_b64 v4, v[28:29] offset:8
    ds_write_b64 v4, v[28:29] offset:16
    ds_write_b64 v4, v[28:29] offset:24
    s_mov_b64 exec, -1
    s_waitcnt vmcnt(7) lgkmcnt(0)
    s_barrier
    s_mov_b32 m0, s62
    s_add_u32 s62, s62, 4096
    buffer_load_dwordx4 v16, s[36:39], s63 offen lds
    s_add_u32 s63, s63, 40960
    s_cmp_eq_u32 s63, 819200
    s_cselect_b32 s63, 0, s63
    s_mov_b32 m0, s62
    s_add_u32 s62, s62, 4096
    buffer_load_dwordx4 v16, s[36:39], s63 offen lds
    s_add_u32 s63, s63, 40960
    s_mov_b32 m0, s62
    s_add_u32 s62, s62, 4096
    buffer_load_dwordx4 v16, s[36:39], s63 offen lds
    s_add_u32 s63, s63, 40960
    s_cmp_eq_u32 s63, 819200
    s_cselect_b32 s63, 0, s63
    s_mov_b32 m0, s62
    s_add_u32 s62, s62, 4096
    buffer_load_dwordx4 v16, s[36:39], s63 offen lds
    s_add_u32 s63, s63, 40960
    s_mov_b32 m0, s62
    s_add_u32 s62, s62, 4096
    buffer_load_dwordx4 v16, s[36:39], s63 offen lds
    s_add_u32 s63, s63, 40960
    s_cmp_eq_u32 s63, 819200
    s_cselect_b32 s63, 0, s63
    s_mov_b32 m0, s62
    s_add_u32 s62, s62, 4096
    buffer_load_dwordx4 v16, s[36:39], s63 offen lds
    s_add_u32 s63, s63, 40960
    s_mov_b32 m0, s62
    s_add_u32 s62, s62, 4096
    buffer_load_dwordx4 v16, s[36:39], s63 offen lds
    s_add_u32 s63, s63, 40960
    s_cmp_eq_u32 s63, 819200
    s_cselect_b32 s63, 0, s63
    s_cmp_eq_u32 s60, 3
    s_cbranch_scc1 pf_11
    s_mul_i32 s67, s53, 6
    s_lshl_b32 s68, s60, 1
    s_add_u32 s67, s67, s68
    s_mul_i32 s67, s67, 24320
    s_add_u32 s67, s67, 1310720
    buffer_load_dword v182, v36, s[24:27], s67 offen sc1
    s_mov_b64 exec, -1
    s_branch pf_12
pf_11:
    v_lshlrev_b32 v4, 7, v0
    s_mov_b64 exec, 7
    buffer_load_dword v182, v4, s[24:27], s57 offen sc1
    s_mov_b64 exec, -1
pf_12:
    s_call_b64 s[98:99], S_late3
    s_call_b64 s[98:99], S_late4
    v_mov_b32 v99, v16
    s_branch AT_start
F_start:
    v_and_b32 v0, 63, v0
    s_mov_b32 s3, 0x40000
    s_mov_b32 s47, 0xffff0000
    s_mov_b32 s26, 7340032
    s_mov_b32 s27, 0x00020000
    s_mov_b32 s38, 819200
    s_mov_b32 s39, 0x00020000
    s_mov_b32 s42, 2621440
    s_mov_b32 s43, 0x00020000
    s_and_b32 s49, s2, 7
    s_lshl_b32 s49, s49, 1
    s_add_u32 s49, s49, s56
    s_sub_u32 s49, s49, 30
    s_and_b32 s50, s48, 1
    s_lshr_b32 s51, s48, 1
    s_mul_i32 s52, s48, 6144
    s_mul_i32 s61, s49, 192
    v_mov_b32 v5, 128
    v_add_u32 v1, 0, v0
    v_mul_u32_u24 v2, 171, v1
    v_lshrrev_b32 v2, 11, v2
    v_mul_u32_u24 v3, 12, v2
    v_sub_u32 v3, v1, v3
    v_mul_u32_u24 v2, 3072, v2
    v_lshl_add_u32 v3, v3, 4, s61
    v_lshrrev_b32 v4, 8, v3
    v_cmp_eq_u32 vcc, 9, v4
    s_nop 1
    v_cndmask_b32 v4, 0, v5, vcc
    v_xad_u32 v210, v3, v4, v2
    v_add_u32 v1, 64, v0
    v_mul_u32_u24 v2, 171, v1
    v_lshrrev_b32 v2, 11, v2
    v_mul_u32_u24 v3, 12, v2
    v_sub_u32 v3, v1, v3
    v_mul_u32_u24 v2, 3072, v2
    v_lshl_add_u32 v3, v3, 4, s61
    v_lshrrev_b32 v4, 8, v3
    v_cmp_eq_u32 vcc, 9, v4
    s_nop 1
    v_cndmask_b32 v4, 0, v5, vcc
    v_xad_u32 v211, v3, v4, v2
    v_add_u32 v1, 128, v0
    v_mul_u32_u24 v2, 171, v1
    v_lshrrev_b32 v2, 11, v2
    v_mul_u32_u24 v3, 12, v2
    v_sub_u32 v3, v1, v3
    v_mul_u32_u24 v2, 3072, v2
    v_lshl_add_u32 v3, v3, 4, s61
    v_lshrrev_b32 v4, 8, v3
    v_cmp_eq_u32 vcc, 9, v4
    s_nop 1
    v_cndmask_b32 v4, 0, v5, vcc
    v_xad_u32 v212, v3, v4, v2
    s_mul_i32 s60, s51, 491520
    s_mov_b32 s30, 1966080
    s_mov_b32 s31, 0x00020000
    s_waitcnt lgkmcnt(0)
    s_cmp_eq_u32 s50, 0
    s_cselect_b32 s28, s14, s16
    s_cselect_b32 s29, s15, s17
    s_add_u32 m0, s52, 0
    s_add_u32 s62, s60, 0
    buffer_load_dwordx4 v210, s[28:31], s62 offen lds
    s_add_u32 m0, s52, 1024
    s_add_u32 s62, s60, 0
    buffer_load_dwordx4 v211, s[28:31], s62 offen lds
    s_add_u32 m0, s52, 2048
    s_add_u32 s62, s60, 0
    buffer_load_dwordx4 v212, s[28:31], s62 offen lds
    s_add_u32 m0, s52, 3072
    s_add_u32 s62, s60, 49152
    buffer_load_dwordx4 v210, s[28:31], s62 offen lds
    s_add_u32 m0, s52, 4096
    s_add_u32 s62, s60, 49152
    buffer_load_dwordx4 v211, s[28:31], s62 offen lds
    s_add_u32 m0, s52, 5120
    s_add_u32 s62, s60, 49152
    buffer_load_dwordx4 v212, s[28:31], s62 offen lds
    s_load_dword s54, s[24:25], 0
    s_mov_b32 s4, s12
    s_and_b32 s5, s13, 0xffff
    s_mov_b32 s6, 1280
    s_mov_b32 s7, 0x00020000
    s_mov_b32 s32, s18
    s_and_b32 s33, s19, 0xffff
    s_mov_b32 s34, 1966080
    s_mov_b32 s35, 0x00020000
    s_cmp_lg_u32 s48, 7
    s_cbranch_scc1 F_ntlb
    s_lshr_b32 s63, 25945, s49
    s_bitcmp0_b32 s63, 0
    s_cbranch_scc1 F_ntlb
    v_lshlrev_b32 v7, 16, v0
    buffer_load_dword v219, v7, s[40:43], 0 offen sc1
    buffer_load_dword v219, v7, s[36:39], 0 offen
    v_lshlrev_b32 v7, 17, v0
    buffer_load_dword v219, v7, s[24:27], 64 offen sc1
F_ntlb:
    s_barrier
    s_add_u32 m0, s52, 49152
    s_add_u32 s62, s60, 98304
    buffer_load_dwordx4 v210, s[28:31], s62 offen lds
    s_add_u32 m0, s52, 50176
    s_add_u32 s62, s60, 98304
    buffer_load_dwordx4 v211, s[28:31], s62 offen lds
    s_add_u32 m0, s52, 51200
    s_add_u32 s62, s60, 98304
    buffer_load_dwordx4 v212, s[28:31], s62 offen lds
    s_add_u32 m0, s52, 52224
    s_add_u32 s62, s60, 147456
    buffer_load_dwordx4 v210, s[28:31], s62 offen lds
    s_add_u32 m0, s52, 53248
    s_add_u32 s62, s60, 147456
    buffer_load_dwordx4 v211, s[28:31], s62 offen lds
    s_add_u32 m0, s52, 54272
    s_add_u32 s62, s60, 147456
    buffer_load_dwordx4 v212, s[28:31], s62 offen lds
    s_mul_i32 s53, s48, 5120
    s_mul_i32 s61, s49, 122880
    s_add_u32 s61, s61, s53
    s_and_b32 s63, s48, 2
    s_lshl_b32 s63, s63, 2
    v_add_u32 v1, 0, v0
    v_mul_u32_u24 v2, 205, v1
    v_lshrrev_b32 v2, 14, v2
    v_lshl_or_b32 v2, v2, 1, s63
    v_xor_b32 v1, v1, v2
    v_lshlrev_b32 v213, 4, v1
    v_add_u32 v1, 64, v0
    v_mul_u32_u24 v2, 205, v1
    v_lshrrev_b32 v2, 14, v2
    v_lshl_or_b32 v2, v2, 1, s63
    v_xor_b32 v1, v1, v2
    v_lshlrev_b32 v214, 4, v1
    v_add_u32 v1, 128, v0
    v_mul_u32_u24 v2, 205, v1
    v_lshrrev_b32 v2, 14, v2
    v_lshl_or_b32 v2, v2, 1, s63
    v_xor_b32 v1, v1, v2
    v_lshlrev_b32 v215, 4, v1
    v_add_u32 v1, 192, v0
    v_mul_u32_u24 v2, 205, v1
    v_lshrrev_b32 v2, 14, v2
    v_lshl_or_b32 v2, v2, 1, s63
    v_xor_b32 v1, v1, v2
    v_lshlrev_b32 v216, 4, v1
    v_add_u32 v1, 256, v0
    v_mul_u32_u24 v2, 205, v1
    v_lshrrev_b32 v2, 14, v2
    v_lshl_or_b32 v2, v2, 1, s63
    v_xor_b32 v1, v1, v2
    v_lshlrev_b32 v217, 4, v1
    v_lshrrev_b32 v2, 4, v0
    v_bfe_u32 v1, v0, 2, 2
    v_lshl_add_u32 v3, v2, 3, v1
    v_and_b32 v4, 3, v0
    v_lshlrev_b32 v4, 3, v4
    v_mul_u32_u24 v5, 192, v3
    s_and_b32 s63, s48, 5
    s_mul_i32 s63, s63, 6144
    s_and_b32 s66, s51, 1
    s_mul_i32 s64, s66, 96
    s_add_u32 s63, s63, s64
    v_add3_u32 v218, v5, v4, s63
    v_and_b32 v6, 1, v2
    v_lshl_or_b32 v6, v6, 2, v1
    v_lshlrev_b32 v6, 5, v6
    v_mul_u32_u24 v3, 1280, v3
    s_mul_i32 s63, s48, 160
    s_add_u32 s64, s63, 0
    v_add_u32 v7, s64, v4
    v_xor_b32 v7, v7, v6
    v_add_u32 v200, v7, v3
    v_add_u32 v205, 98304, v200
    s_add_u32 s64, s63, 32
    v_add_u32 v7, s64, v4
    v_xor_b32 v7, v7, v6
    v_add_u32 v201, v7, v3
    v_add_u32 v206, 98304, v201
    s_add_u32 s64, s63, 64
    v_add_u32 v7, s64, v4
    v_xor_b32 v7, v7, v6
    v_add_u32 v202, v7, v3
    v_add_u32 v207, 98304, v202
    s_add_u32 s64, s63, 96
    v_add_u32 v7, s64, v4
    v_xor_b32 v7, v7, v6
    v_add_u32 v203, v7, v3
    v_add_u32 v208, 98304, v203
    s_add_u32 s64, s63, 128
    v_add_u32 v7, s64, v4
    v_xor_b32 v7, v7, v6
    v_add_u32 v204, v7, v3
    v_add_u32 v209, 98304, v204
    s_waitcnt lgkmcnt(0)
    s_add_u32 s54, s54, 2654435761
    s_mov_b32 s67, 0x3f803f80
    v_mov_b32 v220, s67
    v_mov_b32 v221, s67
    v_mov_b32 v222, s67
    v_mov_b32 v223, s67
    v_mov_b64 v[232:233], 0
    v_mov_b64 v[234:235], 0
    v_mov_b64 v[236:237], 0
    v_mov_b64 v[238:239], 0
    v_mov_b64 v[240:241], 0
    v_mov_b64 v[242:243], 0
    v_lshlrev_b32 v16, 3, v0
    buffer_load_dwordx2 v[10:11], v16, s[4:7], 0 offen offset:0
    buffer_load_dwordx2 v[12:13], v16, s[4:7], 0 offen offset:512
    buffer_load_dwordx2 v[14:15], v16, s[4:7], 0 offen offset:1024
    v_lshlrev_b32 v1, 4, v0
    v_lshlrev_b32 v7, 6, v0
    s_lshl_b32 s15, s49, 11
    s_add_u32 s15, s15, 196608
    s_add_u32 s70, s15, 32768
    s_cmp_eq_u32 s48, 7
    s_cselect_b32 s65, s70, 2.0
    s_mov_b64 exec, 0xffffff
    buffer_load_dword v219, v7, s[24:27], s65 offen sc1
    s_mov_b64 exec, -1
    v_mov_b32 v8, 140288
    v_mov_b32 v224, 0
    v_mov_b32 v225, 0
    v_mov_b32 v226, 0
    v_mov_b32 v227, 0
    ds_write_b128 v8, v[224:227] offset:0
    ds_write_b128 v8, v[224:227] offset:16
    ds_write_b128 v8, v[224:227] offset:32
    ds_write_b128 v8, v[224:227] offset:3648
    ds_write_b128 v8, v[224:227] offset:3664
    ds_write_b128 v8, v[224:227] offset:3776
    ds_write_b128 v8, v[224:227] offset:3792
    s_mul_i32 s65, s48, 1344
    s_add_u32 s45, s65, 16384
    v_lshl_add_u32 v16, v0, 2, s45
    v_and_b32 v19, 15, v0
    v_bfe_u32 v5, v0, 1, 1
    v_mov_b32 v6, 0x44444444
    v_mov_b32 v9, 0xeeeeeeee
    v_cmp_eq_u32 vcc, 1, v5
    s_nop 1
    v_cndmask_b32 v252, v6, v9, vcc
    v_lshlrev_b32 v6, 4, v2
    v_lshl_add_u32 v6, v5, 7, v6
    v_add_u32 v6, v6, v8
    v_bfe_u32 v3, v0, 2, 2
    v_and_b32 v4, 1, v0
    v_lshl_add_u32 v3, v3, 1, v4
    v_mul_u32_u24 v9, 1344, v3
    v_mul_u32_u24 v5, 672, v5
    v_add_u32 v9, v9, v5
    v_lshrrev_b32 v3, 1, v2
    v_mul_u32_u24 v3, 160, v3
    v_and_b32 v4, 1, v2
    v_lshl_add_u32 v3, v4, 4, v3
    s_lshr_b32 s65, s48, 2
    s_mul_i32 s63, s65, 320
    v_add3_u32 v9, v9, v3, s63
    s_lshl1_add_u32 s65, s65, s50
    s_mul_i32 s65, s65, 768
    s_mul_i32 s66, s66, 384
    s_add_u32 s65, s65, s66
    v_lshl_add_u32 v3, v19, 3, s65
    v_add_u32 v230, 140544, v3
    v_mul_u32_u24 v4, 3328, v2
    v_add_u32 v3, v3, v4
    s_mul_i32 s65, s48, 48
    v_add_u32 v4, s65, v0
    v_bfe_u32 v5, v4, 1, 1
    v_lshlrev_b32 v5, 7, v5
    v_and_b32 v17, 1, v4
    v_lshl_add_u32 v5, v17, 1, v5
    v_and_b32 v17, 0xfc, v4
    v_add_u32 v5, v5, v17
    v_lshrrev_b32 v17, 6, v4
    v_lshl_add_u32 v5, v17, 5, v5
    v_add_u32 v5, v5, v8
    v_lshlrev_b32 v4, 3, v4
    v_and_b32 v17, 7, v0
    v_lshlrev_b32 v18, 4, v17
    v_lshl_add_u32 v18, v2, 11, v18
    v_lshrrev_b32 v19, 3, v19
    v_lshl_add_u32 v229, v19, 12, v18
    s_lshl_b32 s8, s48, 13
    s_lshl_b32 s65, s49, 7
    s_add_u32 s8, s8, s65
    s_add_u32 s8, s8, 16384
    s_sub_u32 s44, s48, 2
    s_lshl_b32 s14, s49, 12
    s_lshl_b32 s65, s44, 11
    s_add_u32 s14, s14, s65
    s_add_u32 s14, s14, 16384
    s_lshr_b32 s65, s49, 1
    s_lshl_b32 s65, s65, 6
    s_lshl3_add_u32 s65, s49, s65
    s_and_b32 s66, s44, 1
    s_movk_i32 s19, 0xff
    s_cselect_b32 s18, s19, 0x00ff00ff
    s_mul_i32 s66, s66, 48
    s_add_u32 s65, s65, s66
    v_and_b32 v18, 1, v2
    v_lshrrev_b32 v19, 1, v2
    v_lshl_or_b32 v18, v18, 1, v19
    v_min_u32 v18, 2, v18
    v_lshl_add_u32 v18, v18, 4, v17
    v_add_u32 v18, s65, v18
    v_bfe_u32 v19, v18, 1, 1
    v_mul_u32_u24 v19, 672, v19
    v_and_b32 v17, 1, v18
    v_lshl_add_u32 v19, v17, 1, v19
    v_and_b32 v17, 0xffc, v18
    v_add_u32 v19, v19, v17
    v_lshlrev_b32 v18, 1, v18
    v_mov_b32 v17, v229
    s_sub_u32 s65, s54, 1
    v_mov_b32 v227, s65
    s_mov_b32 exec_hi, 0
    buffer_store_dwordx4 v[224:227], v17, s[24:27], s8 offen sc1
    s_mov_b32 exec_hi, -1
    s_lshr_b32 s68, s48, 1
    s_mul_i32 s68, s68, 3328
    s_lshl2_add_u32 s68, s50, s68
    s_lshr_b32 s16, s49, 2
    s_mul_i32 s16, s16, 61440
    s_add_u32 s16, s16, 262144
    s_mov_b32 s17, 0
    s_mov_b32 s20, 16
    v_add_u32 v228, 140544, v4
    s_lshl_b32 s65, s48, 2
    v_add_u32 v231, s65, v8
    s_mov_b64 exec, 0
    s_cmp_eq_u32 s48, 0
    s_cbranch_scc1 HF0_0
    s_cmp_eq_u32 s48, 1
    s_cbranch_scc1 HF1_0
    s_cmp_eq_u32 s48, 2
    s_cbranch_scc1 HF2_0
    s_cmp_eq_u32 s48, 3
    s_cbranch_scc1 HF3_0
    s_cmp_eq_u32 s48, 4
    s_cbranch_scc1 HF4_0
    s_cmp_eq_u32 s48, 5
    s_cbranch_scc1 HF5_0
HF_ret:
    s_mov_b64 exec, -1
    s_waitcnt vmcnt(11)
    s_barrier
    ds_read_b64_tr_b16 v[20:21], v218 offset:0
    ds_read_b64_tr_b16 v[22:23], v218 offset:768
    ds_read_b64_tr_b16 v[24:25], v218 offset:12288
    ds_read_b64_tr_b16 v[26:27], v218 offset:13056
    ds_read_b64_tr_b16 v[28:29], v218 offset:32
    ds_read_b64_tr_b16 v[30:31], v218 offset:800
    ds_read_b64_tr_b16 v[32:33], v218 offset:12320
    ds_read_b64_tr_b16 v[34:35], v218 offset:13088
    ds_read_b64_tr_b16 v[36:37], v218 offset:64
    ds_read_b64_tr_b16 v[38:39], v218 offset:832
    ds_read_b64_tr_b16 v[40:41], v218 offset:12352
    ds_read_b64_tr_b16 v[42:43], v218 offset:13120
    s_waitcnt lgkmcnt(0)
    s_barrier
    s_add_u32 m0, s52, 0
    s_add_u32 s62, s60, 196608
    buffer_load_dwordx4 v210, s[28:31], s62 offen lds
    s_add_u32 m0, s52, 1024
    s_add_u32 s62, s60, 196608
    buffer_load_dwordx4 v211, s[28:31], s62 offen lds
    s_add_u32 m0, s52, 2048
    s_add_u32 s62, s60, 196608
    buffer_load_dwordx4 v212, s[28:31], s62 offen lds
    s_add_u32 m0, s52, 3072
    s_add_u32 s62, s60, 245760
    buffer_load_dwordx4 v210, s[28:31], s62 offen lds
    s_add_u32 m0, s52, 4096
    s_add_u32 s62, s60, 245760
    buffer_load_dwordx4 v211, s[28:31], s62 offen lds
    s_add_u32 m0, s52, 5120
    s_add_u32 s62, s60, 245760
    buffer_load_dwordx4 v212, s[28:31], s62 offen lds
    v_smfmac_f32_16x16x64_bf16 v[232:235], v[220:223], v[20:27], v252
    v_smfmac_f32_16x16x64_bf16 v[236:239], v[220:223], v[28:35], v252
    v_smfmac_f32_16x16x64_bf16 v[240:243], v[220:223], v[36:43], v252
    s_waitcnt vmcnt(11)
    s_barrier
    ds_read_b64_tr_b16 v[44:45], v218 offset:49152
    ds_read_b64_tr_b16 v[46:47], v218 offset:49920
    ds_read_b64_tr_b16 v[48:49], v218 offset:61440
    ds_read_b64_tr_b16 v[50:51], v218 offset:62208
    ds_read_b64_tr_b16 v[52:53], v218 offset:49184
    ds_read_b64_tr_b16 v[54:55], v218 offset:49952
    ds_read_b64_tr_b16 v[56:57], v218 offset:61472
    ds_read_b64_tr_b16 v[58:59], v218 offset:62240
    ds_read_b64_tr_b16 v[60:61], v218 offset:49216
    ds_read_b64_tr_b16 v[62:63], v218 offset:49984
    ds_read_b64_tr_b16 v[64:65], v218 offset:61504
    ds_read_b64_tr_b16 v[66:67], v218 offset:62272
    s_waitcnt lgkmcnt(0)
    s_barrier
    s_add_u32 m0, s52, 49152
    s_add_u32 s62, s60, 294912
    buffer_load_dwordx4 v210, s[28:31], s62 offen lds
    s_add_u32 m0, s52, 50176
    s_add_u32 s62, s60, 294912
    buffer_load_dwordx4 v211, s[28:31], s62 offen lds
    s_add_u32 m0, s52, 51200
    s_add_u32 s62, s60, 294912
    buffer_load_dwordx4 v212, s[28:31], s62 offen lds
    s_add_u32 m0, s52, 52224
    s_add_u32 s62, s60, 344064
    buffer_load_dwordx4 v210, s[28:31], s62 offen lds
    s_add_u32 m0, s52, 53248
    s_add_u32 s62, s60, 344064
    buffer_load_dwordx4 v211, s[28:31], s62 offen lds
    s_add_u32 m0, s52, 54272
    s_add_u32 s62, s60, 344064
    buffer_load_dwordx4 v212, s[28:31], s62 offen lds
    v_smfmac_f32_16x16x64_bf16 v[232:235], v[220:223], v[44:51], v252
    v_smfmac_f32_16x16x64_bf16 v[236:239], v[220:223], v[52:59], v252
    v_smfmac_f32_16x16x64_bf16 v[240:243], v[220:223], v[60:67], v252
    s_waitcnt vmcnt(6)
    s_barrier
    ds_read_b64_tr_b16 v[68:69], v218 offset:0
    ds_read_b64_tr_b16 v[70:71], v218 offset:768
    ds_read_b64_tr_b16 v[72:73], v218 offset:12288
    ds_read_b64_tr_b16 v[74:75], v218 offset:13056
    ds_read_b64_tr_b16 v[76:77], v218 offset:32
    ds_read_b64_tr_b16 v[78:79], v218 offset:800
    ds_read_b64_tr_b16 v[80:81], v218 offset:12320
    ds_read_b64_tr_b16 v[82:83], v218 offset:13088
    ds_read_b64_tr_b16 v[84:85], v218 offset:64
    ds_read_b64_tr_b16 v[86:87], v218 offset:832
    ds_read_b64_tr_b16 v[88:89], v218 offset:12352
    ds_read_b64_tr_b16 v[90:91], v218 offset:13120
    s_waitcnt lgkmcnt(0)
    s_barrier
    s_add_u32 m0, s52, 0
    s_add_u32 s62, s60, 393216
    buffer_load_dwordx4 v210, s[28:31], s62 offen lds
    s_add_u32 m0, s52, 1024
    s_add_u32 s62, s60, 393216
    buffer_load_dwordx4 v211, s[28:31], s62 offen lds
    s_add_u32 m0, s52, 2048
    s_add_u32 s62, s60, 393216
    buffer_load_dwordx4 v212, s[28:31], s62 offen lds
    s_add_u32 m0, s52, 3072
    s_add_u32 s62, s60, 442368
    buffer_load_dwordx4 v210, s[28:31], s62 offen lds
    s_add_u32 m0, s52, 4096
    s_add_u32 s62, s60, 442368
    buffer_load_dwordx4 v211, s[28:31], s62 offen lds
    s_add_u32 m0, s52, 5120
    s_add_u32 s62, s60, 442368
    buffer_load_dwordx4 v212, s[28:31], s62 offen lds
    v_smfmac_f32_16x16x64_bf16 v[232:235], v[220:223], v[68:75], v252
    v_smfmac_f32_16x16x64_bf16 v[236:239], v[220:223], v[76:83], v252
    v_smfmac_f32_16x16x64_bf16 v[240:243], v[220:223], v[84:91], v252
    v_dot2_f32_bf16 v226, v10, s67, 0
    v_dot2_f32_bf16 v226, v11, s67, v226
    v_dot2_f32_bf16 v226, v12, s67, v226
    v_dot2_f32_bf16 v226, v13, s67, v226
    v_dot2_f32_bf16 v226, v14, s67, v226
    v_dot2_f32_bf16 v226, v15, s67, v226
    s_nop 2
    v_add_f32_dpp v226, v226, v226 row_ror:1 row_mask:0xf bank_mask:0xf
    s_nop 1
    v_add_f32_dpp v226, v226, v226 row_ror:2 row_mask:0xf bank_mask:0xf
    s_nop 1
    v_add_f32_dpp v226, v226, v226 row_ror:4 row_mask:0xf bank_mask:0xf
    s_nop 1
    v_add_f32_dpp v226, v226, v226 row_ror:8 row_mask:0xf bank_mask:0xf
    v_mov_b32 v229, v226
    s_nop 1
    v_permlane32_swap_b32 v226, v229
    v_add_f32 v226, v226, v229
    v_mov_b32 v229, v226
    s_nop 1
    v_permlane16_swap_b32 v226, v229
    v_add_f32 v226, v226, v229
    s_nop 0
    v_readfirstlane_b32 s55, v226
    s_waitcnt vmcnt(6)
    s_barrier
    ds_read_b64_tr_b16 v[92:93], v218 offset:49152
    ds_read_b64_tr_b16 v[94:95], v218 offset:49920
    ds_read_b64_tr_b16 v[96:97], v218 offset:61440
    ds_read_b64_tr_b16 v[98:99], v218 offset:62208
    ds_read_b64_tr_b16 v[100:101], v218 offset:49184
    ds_read_b64_tr_b16 v[102:103], v218 offset:49952
    ds_read_b64_tr_b16 v[104:105], v218 offset:61472
    ds_read_b64_tr_b16 v[106:107], v218 offset:62240
    ds_read_b64_tr_b16 v[108:109], v218 offset:49216
    ds_read_b64_tr_b16 v[110:111], v218 offset:49984
    ds_read_b64_tr_b16 v[112:113], v218 offset:61504
    ds_read_b64_tr_b16 v[114:115], v218 offset:62272
    s_waitcnt lgkmcnt(0)
    s_barrier
    s_mul_i32 s62, s49, 3
    s_add_u32 s62, s62, 0
    s_lshr_b32 s63, s62, 2
    s_cmp_eq_u32 s63, 9
    s_cselect_b32 s63, 2, 0
    s_xor_b32 s62, s62, s63
    s_mul_i32 s62, s62, 40960
    s_add_u32 s62, s62, s53
    s_add_u32 m0, s53, 98304
    s_nop 0
    buffer_load_dwordx4 v213, s[32:35], s62 offen lds
    s_add_u32 m0, s53, 99328
    s_nop 0
    buffer_load_dwordx4 v214, s[32:35], s62 offen lds
    s_add_u32 m0, s53, 100352
    s_nop 0
    buffer_load_dwordx4 v215, s[32:35], s62 offen lds
    s_add_u32 m0, s53, 101376
    s_nop 0
    buffer_load_dwordx4 v216, s[32:35], s62 offen lds
    s_add_u32 m0, s53, 102400
    s_nop 0
    buffer_load_dwordx4 v217, s[32:35], s62 offen lds
    s_mul_i32 s62, s49, 3
    s_add_u32 s62, s62, 1
    s_lshr_b32 s63, s62, 2
    s_cmp_eq_u32 s63, 9
    s_cselect_b32 s63, 2, 0
    s_xor_b32 s62, s62, s63
    s_mul_i32 s62, s62, 40960
    s_add_u32 s62, s62, s53
    s_add_u32 m0, s53, 49152
    s_nop 0
    buffer_load_dwordx4 v213, s[32:35], s62 offen lds
    s_add_u32 m0, s53, 50176
    s_nop 0
    buffer_load_dwordx4 v214, s[32:35], s62 offen lds
    s_add_u32 m0, s53, 51200
    s_nop 0
    buffer_load_dwordx4 v215, s[32:35], s62 offen lds
    s_add_u32 m0, s53, 52224
    s_nop 0
    buffer_load_dwordx4 v216, s[32:35], s62 offen lds
    s_add_u32 m0, s53, 53248
    s_nop 0
    buffer_load_dwordx4 v217, s[32:35], s62 offen lds
    v_smfmac_f32_16x16x64_bf16 v[232:235], v[220:223], v[92:99], v252
    v_smfmac_f32_16x16x64_bf16 v[236:239], v[220:223], v[100:107], v252
    v_smfmac_f32_16x16x64_bf16 v[240:243], v[220:223], v[108:115], v252
    s_waitcnt vmcnt(10)
    s_barrier
    ds_read_b64_tr_b16 v[116:117], v218 offset:0
    ds_read_b64_tr_b16 v[118:119], v218 offset:768
    ds_read_b64_tr_b16 v[120:121], v218 offset:12288
    ds_read_b64_tr_b16 v[122:123], v218 offset:13056
    ds_read_b64_tr_b16 v[124:125], v218 offset:32
    ds_read_b64_tr_b16 v[126:127], v218 offset:800
    ds_read_b64_tr_b16 v[128:129], v218 offset:12320
    ds_read_b64_tr_b16 v[130:131], v218 offset:13088
    ds_read_b64_tr_b16 v[132:133], v218 offset:64
    ds_read_b64_tr_b16 v[134:135], v218 offset:832
    ds_read_b64_tr_b16 v[136:137], v218 offset:12352
    ds_read_b64_tr_b16 v[138:139], v218 offset:13120
    s_waitcnt lgkmcnt(0)
    s_barrier
    s_mul_i32 s62, s49, 3
    s_add_u32 s62, s62, 2
    s_lshr_b32 s63, s62, 2
    s_cmp_eq_u32 s63, 9
    s_cselect_b32 s63, 2, 0
    s_xor_b32 s62, s62, s63
    s_mul_i32 s62, s62, 40960
    s_add_u32 s62, s62, s53
    s_add_u32 m0, s53, 0
    s_nop 0
    buffer_load_dwordx4 v213, s[32:35], s62 offen lds
    s_add_u32 m0, s53, 1024
    s_nop 0
    buffer_load_dwordx4 v214, s[32:35], s62 offen lds
    s_add_u32 m0, s53, 2048
    s_nop 0
    buffer_load_dwordx4 v215, s[32:35], s62 offen lds
    s_add_u32 m0, s53, 3072
    s_nop 0
    buffer_load_dwordx4 v216, s[32:35], s62 offen lds
    s_add_u32 m0, s53, 4096
    s_nop 0
    buffer_load_dwordx4 v217, s[32:35], s62 offen lds
    s_cmp_eq_u32 s48, 0
    s_cselect_b32 s65, s15, 2.0
    s_mov_b64 exec, 0xffffff
    buffer_load_dwordx2 v[224:225], v7, s[24:27], s65 offen sc1
    s_mov_b64 exec, -1
    v_smfmac_f32_16x16x64_bf16 v[232:235], v[220:223], v[116:123], v252
    v_smfmac_f32_16x16x64_bf16 v[236:239], v[220:223], v[124:131], v252
    v_smfmac_f32_16x16x64_bf16 v[240:243], v[220:223], v[132:139], v252
    s_mov_b64 exec, 0xffff
    s_nop 8
    v_pk_add_f32 v[232:233], v[232:233], v[234:235]
    ds_write_b64 v230, v[232:233] offset:0
    v_pk_add_f32 v[236:237], v[236:237], v[238:239]
    ds_write_b64 v230, v[236:237] offset:128
    v_pk_add_f32 v[240:241], v[240:241], v[242:243]
    ds_write_b64 v230, v[240:241] offset:256
    s_mov_b64 exec, -1
    s_waitcnt lgkmcnt(0)
    s_waitcnt vmcnt(6)
    s_barrier
    ds_read2st64_b32 v[232:233], v228 offset0:0 offset1:3
    ds_read2st64_b32 v[234:235], v228 offset0:6 offset1:9
    ds_read_b64_tr_b16 v[140:141], v205 offset:0
    ds_read_b64_tr_b16 v[142:143], v205 offset:5120
    ds_read_b64_tr_b16 v[152:153], v206 offset:0
    ds_read_b64_tr_b16 v[154:155], v206 offset:5120
    ds_read_b64_tr_b16 v[164:165], v207 offset:0
    ds_read_b64_tr_b16 v[166:167], v207 offset:5120
    ds_read_b64_tr_b16 v[176:177], v208 offset:0
    ds_read_b64_tr_b16 v[178:179], v208 offset:5120
    ds_read_b64_tr_b16 v[188:189], v209 offset:0
    ds_read_b64_tr_b16 v[190:191], v209 offset:5120
    ds_read_b64_tr_b16 v[144:145], v200 offset:49152
    ds_read_b64_tr_b16 v[146:147], v200 offset:54272
    ds_read_b64_tr_b16 v[156:157], v201 offset:49152
    ds_read_b64_tr_b16 v[158:159], v201 offset:54272
    ds_read_b64_tr_b16 v[168:169], v202 offset:49152
    ds_read_b64_tr_b16 v[170:171], v202 offset:54272
    ds_read_b64_tr_b16 v[180:181], v203 offset:49152
    ds_read_b64_tr_b16 v[182:183], v203 offset:54272
    ds_read_b64_tr_b16 v[192:193], v204 offset:49152
    ds_read_b64_tr_b16 v[194:195], v204 offset:54272
    s_waitcnt lgkmcnt(0)
    v_add_f32 v0, v232, v234
    v_add_f32 v2, v233, v235
    s_waitcnt vmcnt(1)
    s_barrier
    ds_read_b64_tr_b16 v[148:149], v200 offset:0
    ds_read_b64_tr_b16 v[150:151], v200 offset:5120
    ds_read_b64_tr_b16 v[160:161], v201 offset:0
    ds_read_b64_tr_b16 v[162:163], v201 offset:5120
    ds_read_b64_tr_b16 v[172:173], v202 offset:0
    ds_read_b64_tr_b16 v[174:175], v202 offset:5120
    ds_read_b64_tr_b16 v[184:185], v203 offset:0
    ds_read_b64_tr_b16 v[186:187], v203 offset:5120
    ds_read_b64_tr_b16 v[196:197], v204 offset:0
    ds_read_b64_tr_b16 v[198:199], v204 offset:5120
    s_waitcnt lgkmcnt(0)
F_rdy:
HF0_0:
    s_cbranch_execz HF_ret
    s_cmp_lg_u32 s48, 0
    s_cbranch_scc1 F_wait
    s_mov_b64 exec, 0xffffff
    s_branch F_pw
F_poll:
    buffer_load_dwordx2 v[224:225], v7, s[24:27], s15 offen sc1
F_pw:
    s_waitcnt vmcnt(0)
    v_cmp_ne_u32 vcc, s54, v225
    s_cbranch_vccz F_got
    s_sleep 1
    s_sub_u32 s3, s3, 1
    s_cbranch_scc0 F_poll
    s_mov_b32 s3, 0
F_got:
    s_mov_b64 exec, -1
    v_max_u32_dpp v226, v224, v224 row_ror:1 row_mask:0xf bank_mask:0xf
    s_nop 1
    v_max_u32_dpp v226, v226, v226 row_ror:2 row_mask:0xf bank_mask:0xf
    s_nop 1
    v_max_u32_dpp v226, v226, v226 row_ror:4 row_mask:0xf bank_mask:0xf
    s_nop 1
    v_max_u32_dpp v226, v226, v226 row_ror:8 row_mask:0xf bank_mask:0xf
    s_nop 0
    v_readlane_b32 s60, v226, 0
    v_readlane_b32 s62, v226, 16
    s_max_u32 s60, s60, s62
    s_max_u32 s60, s60, 1376257
    s_sub_u32 s60, s60, 1376256
    v_cmp_le_u32 vcc, s60, v224
    s_nop 1
    v_mbcnt_lo_u32_b32 v226, vcc_lo, 0
    v_cmp_gt_u32 s[62:63], 8, v226
    v_lshl_add_u32 v226, v226, 2, v8
    s_and_b64 exec, vcc, s[62:63]
    ds_write_b32 v226, v224 offset:0
    s_mov_b64 exec, -1
HF1_0:
    s_cbranch_execz HF1_1
    s_waitcnt lgkmcnt(0)
F_wait:
    s_waitcnt vmcnt(0)
    s_barrier
    ds_read_b32 v224, v231 offset:0
    s_waitcnt lgkmcnt(0)
    v_readfirstlane_b32 s60, v224
F_redo:
    v_mov_b64 v[232:233], 0
    v_mov_b64 v[234:235], 0
    v_mov_b64 v[236:237], 0
    v_mov_b64 v[238:239], 0
    v_mov_b64 v[240:241], 0
    v_mov_b64 v[242:243], 0
    s_and_b32 s61, s60, 0xfff
    s_cbranch_scc0 F_b1
    s_lshr_b32 s62, s61, 4
    s_mul_i32 s62, s62, 171
    s_lshr_b32 s62, s62, 10
    s_mul_i32 s62, s62, 2560
    s_add_u32 s62, s62, s16
    s_add_u32 s63, s54, s61
    v_mov_b64 v[228:229], 0
    v_mov_b32 v230, s63
    buffer_load_dwordx3 v[220:222], v1, s[24:27], s62 offen offset:0 sc1
    buffer_load_dwordx3 v[224:226], v1, s[24:27], s62 offen offset:1024 sc1
    s_mov_b32 exec_hi, 0
    buffer_load_dwordx3 v[228:230], v1, s[24:27], s62 offen offset:2048 sc1
    s_mov_b32 exec_hi, -1
    s_branch F_rw
F_row:
    s_mov_b64 exec, s[58:59]
    s_cbranch_execz F_r0
    buffer_load_dwordx3 v[220:222], v1, s[24:27], s62 offen offset:0 sc1
F_r0:
    s_mov_b64 exec, s[64:65]
    s_cbranch_execz F_r1
    buffer_load_dwordx3 v[224:226], v1, s[24:27], s62 offen offset:1024 sc1
F_r1:
    s_mov_b64 exec, s[10:11]
    s_cbranch_execz F_r2
    buffer_load_dwordx3 v[228:230], v1, s[24:27], s62 offen offset:2048 sc1
F_r2:
    s_mov_b64 exec, -1
F_rw:
    s_waitcnt vmcnt(0)
    ds_write2_b32 v16, v220, v221 offset0:0 offset1:168
    ds_write2_b32 v16, v224, v225 offset0:64 offset1:232
    s_mov_b32 exec_hi, 0
    ds_write_b32 v16, v228 offset:512
    ds_write_b32 v16, v229 offset:1184
    s_mov_b32 exec_hi, -1
    v_cmp_ne_u32 s[58:59], s63, v222
    v_cmp_ne_u32 s[64:65], s63, v226
HF1_1:
    s_cbranch_execz HF_ret
    v_cmp_ne_u32 s[10:11], s63, v230
    s_or_b64 vcc, s[58:59], s[64:65]
    s_or_b64 vcc, vcc, s[10:11]
    s_cbranch_scc0 F_ok
    s_sub_u32 s20, s20, 1
    s_cbranch_scc0 F_row
F_b1:
    s_waitcnt lgkmcnt(0)
    s_barrier
    ds_read_b128 v[200:203], v9 offset:16384
    ds_read_b128 v[204:207], v9 offset:16416
    ds_read_b128 v[208:211], v9 offset:16448
    ds_read_b128 v[212:215], v9 offset:16480
    ds_read_b128 v[216:219], v9 offset:16512
    s_waitcnt lgkmcnt(4)
    v_smfmac_f32_16x16x64_bf16 v[232:235], v[200:203], v[20:27], v252
    v_smfmac_f32_16x16x64_bf16 v[236:239], v[200:203], v[28:35], v252
    v_smfmac_f32_16x16x64_bf16 v[240:243], v[200:203], v[36:43], v252
    s_waitcnt lgkmcnt(3)
    v_smfmac_f32_16x16x64_bf16 v[232:235], v[204:207], v[44:51], v252
    v_smfmac_f32_16x16x64_bf16 v[236:239], v[204:207], v[52:59], v252
    v_smfmac_f32_16x16x64_bf16 v[240:243], v[204:207], v[60:67], v252
    s_waitcnt lgkmcnt(2)
    v_smfmac_f32_16x16x64_bf16 v[232:235], v[208:211], v[68:75], v252
    v_smfmac_f32_16x16x64_bf16 v[236:239], v[208:211], v[76:83], v252
    v_smfmac_f32_16x16x64_bf16 v[240:243], v[208:211], v[84:91], v252
    s_waitcnt lgkmcnt(1)
    v_smfmac_f32_16x16x64_bf16 v[232:235], v[212:215], v[92:99], v252
    v_smfmac_f32_16x16x64_bf16 v[236:239], v[212:215], v[100:107], v252
    v_smfmac_f32_16x16x64_bf16 v[240:243], v[212:215], v[108:115], v252
    s_waitcnt lgkmcnt(0)
    v_smfmac_f32_16x16x64_bf16 v[232:235], v[216:219], v[116:123], v252
    v_smfmac_f32_16x16x64_bf16 v[236:239], v[216:219], v[124:131], v252
    v_smfmac_f32_16x16x64_bf16 v[240:243], v[216:219], v[132:139], v252
    s_nop 8
    s_branch F_pw2
F_ok:
    v_dot2_f32_bf16 v222, v220, s67, 0
    v_dot2_f32_bf16 v223, v220, v220, 0
    v_dot2_f32_bf16 v226, v220, v10, 0
HF2_0:
    s_cbranch_execz HF2_1
    v_dot2_f32_bf16 v222, v221, s67, v222
    v_dot2_f32_bf16 v223, v221, v221, v223
    v_dot2_f32_bf16 v226, v221, v11, v226
    v_dot2_f32_bf16 v222, v224, s67, v222
    v_dot2_f32_bf16 v223, v224, v224, v223
    v_dot2_f32_bf16 v226, v224, v12, v226
    v_dot2_f32_bf16 v222, v225, s67, v222
    v_dot2_f32_bf16 v223, v225, v225, v223
    v_dot2_f32_bf16 v226, v225, v13, v226
    v_dot2_f32_bf16 v222, v228, s67, v222
    v_dot2_f32_bf16 v223, v228, v228, v223
    v_dot2_f32_bf16 v226, v228, v14, v226
    v_dot2_f32_bf16 v222, v229, s67, v222
    v_dot2_f32_bf16 v223, v229, v229, v223
    v_dot2_f32_bf16 v226, v229, v15, v226
    s_waitcnt lgkmcnt(0)
    s_barrier
    ds_read_b128 v[200:203], v9 offset:16384
    ds_read_b128 v[204:207], v9 offset:16416
    ds_read_b128 v[208:211], v9 offset:16448
    ds_read_b128 v[212:215], v9 offset:16480
    ds_read_b128 v[216:219], v9 offset:16512
    v_mov_b32 v227, v226
    v_permlane32_swap_b32 v222, v223
    s_nop 0
    v_permlane32_swap_b32 v226, v227
    v_add_f32 v222, v222, v223
    v_add_f32 v226, v226, v227
    v_mov_b32 v224, s68
    v_mov_b32 v223, s45
    v_permlane16_swap_b32 v222, v226
    v_add_f32 v222, v222, v226
    s_waitcnt lgkmcnt(4)
    v_smfmac_f32_16x16x64_bf16 v[232:235], v[200:203], v[20:27], v252
    v_add_f32_dpp v222, v222, v222 row_ror:1 row_mask:0xf bank_mask:0xf
    s_nop 1
    v_add_f32_dpp v222, v222, v222 row_ror:2 row_mask:0xf bank_mask:0xf
    v_smfmac_f32_16x16x64_bf16 v[236:239], v[200:203], v[28:35], v252
    s_nop 0
HF2_1:
    s_cbranch_execz HF_ret
    v_add_f32_dpp v222, v222, v222 row_ror:4 row_mask:0xf bank_mask:0xf
    s_nop 1
    v_add_f32_dpp v222, v222, v222 row_ror:8 row_mask:0xf bank_mask:0xf
    v_smfmac_f32_16x16x64_bf16 v[240:243], v[200:203], v[36:43], v252
    v_readlane_b32 s64, v222, 32
    v_readlane_b32 s65, v222, 16
    s_waitcnt lgkmcnt(3)
    v_smfmac_f32_16x16x64_bf16 v[232:235], v[204:207], v[44:51], v252
    v_mov_b32 v220, v222
    v_mov_b32 v221, s64
    v_smfmac_f32_16x16x64_bf16 v[236:239], v[204:207], v[52:59], v252
    v_mul_f32 v220, 0x3acccccd, v220
    v_mul_f32 v221, 0x3acccccd, v221
    v_smfmac_f32_16x16x64_bf16 v[240:243], v[204:207], v[60:67], v252
    v_fma_f32 v221, -v220, v220, v221
    v_max_f32 v221, 0, v221
    s_waitcnt lgkmcnt(2)
    v_smfmac_f32_16x16x64_bf16 v[232:235], v[208:211], v[68:75], v252
    v_cvt_pk_bf16_f32 v221, v221, v221
    v_and_b32 v221, 0xffff0000, v221
    v_smfmac_f32_16x16x64_bf16 v[236:239], v[208:211], v[76:83], v252
    v_add_f32 v221, 0x3727c5ac, v221
    v_cvt_pk_bf16_f32 v221, v221, v221
    v_smfmac_f32_16x16x64_bf16 v[240:243], v[208:211], v[84:91], v252
    v_and_b32 v221, 0xffff0000, v221
    v_sqrt_f32 v221, v221
    s_waitcnt lgkmcnt(1)
    v_smfmac_f32_16x16x64_bf16 v[232:235], v[212:215], v[92:99], v252
    v_cvt_pk_bf16_f32 v220, v220, v220
    v_and_b32 v220, 0xffff0000, v220
    v_smfmac_f32_16x16x64_bf16 v[236:239], v[212:215], v[100:107], v252
    v_cvt_pk_bf16_f32 v221, v221, v221
    v_and_b32 v221, 0xffff0000, v221
    v_smfmac_f32_16x16x64_bf16 v[240:243], v[212:215], v[108:115], v252
    v_rcp_f32 v221, v221
    v_mul_f32 v222, s55, v220
    s_waitcnt lgkmcnt(0)
HF3_0:
    s_cbranch_execz HF3_1
    v_smfmac_f32_16x16x64_bf16 v[232:235], v[216:219], v[116:123], v252
    v_sub_f32 v222, s65, v222
    v_mul_f32 v222, v222, v221
    v_smfmac_f32_16x16x64_bf16 v[236:239], v[216:219], v[124:131], v252
    v_ashrrev_i32 v225, 31, v222
    v_or_b32 v225, 0x80000000, v225
    v_smfmac_f32_16x16x64_bf16 v[240:243], v[216:219], v[132:139], v252
    v_xor_b32 v225, v225, v222
    v_and_b32 v225, 0xfffff000, v225
    v_or_b32 v225, s61, v225
    s_mov_b64 exec, 1
    ds_write2_b32 v224, v220, v221 offset0:0 offset1:2
    ds_write2_b32 v224, v222, v223 offset0:4 offset1:6
    ds_max_u64 v8, v[224:225] offset:32
    s_mov_b64 exec, -1
F_pw2:
    v_pk_add_f32 v[232:233], v[232:233], v[234:235]
    ds_write_b64 v3, v[232:233] offset:256
    v_pk_add_f32 v[236:237], v[236:237], v[238:239]
    ds_write_b64 v3, v[236:237] offset:384
    v_pk_add_f32 v[240:241], v[240:241], v[242:243]
    ds_write_b64 v3, v[240:241] offset:512
    s_cmp_ge_u32 s48, 2
    v_mov_b64 v[244:245], 0
    v_mov_b64 v[246:247], 0
    v_mov_b64 v[248:249], 0
    v_mov_b64 v[250:251], 0
    s_waitcnt lgkmcnt(0)
    s_barrier
    ds_read_b64 v[224:225], v8 offset:32
    v_mov_b64 v[232:233], 0
    v_mov_b64 v[234:235], 0
    v_mov_b64 v[236:237], 0
    v_mov_b64 v[238:239], 0
    v_mov_b64 v[240:241], 0
    v_mov_b64 v[242:243], 0
    s_waitcnt lgkmcnt(0)
    s_cbranch_scc1 F_gu
    v_add_u32 v227, v224, v4
    ds_read2_b32 v[228:229], v224 offset0:0 offset1:2
    ds_read2st64_b32 v[208:209], v227 offset0:1 offset1:4
    ds_read2st64_b32 v[210:211], v227 offset0:7 offset1:10
    s_waitcnt lgkmcnt(1)
    v_fma_f32 v208, -v228, v0, v208
    v_fma_f32 v209, -v228, v2, v209
HF3_1:
    s_cbranch_execz HF_ret
    s_waitcnt lgkmcnt(0)
    v_add_f32 v208, v208, v210
    v_add_f32 v209, v209, v211
    v_mul_f32 v208, v208, v229
    v_mul_f32 v209, v209, v229
    v_cvt_pk_bf16_f32 v209, v208, v209
    v_lshlrev_b32 v208, 16, v209
    v_mul_f32 v210, 0xbfb8aa3b, v208
    v_exp_f32 v210, v210
    v_and_b32 v209, s47, v209
    v_add_f32 v210, 1.0, v210
    v_rcp_f32 v210, v210
    s_mov_b32 exec_hi, 0xffff
    v_mul_f32 v208, v208, v210
    v_cvt_pk_bf16_f32 v208, v208, v208
    v_and_b32 v208, 0xffff0000, v208
    v_mul_f32 v208, v208, v209
    v_cvt_pk_bf16_f32 v208, v208, v208
    ds_write_b16 v5, v208 offset:3584
    s_mov_b64 exec, -1
    s_waitcnt lgkmcnt(0)
F_gu:
    s_barrier
    ds_read_b128 v[200:203], v6 offset:3584
    ds_read_b128 v[204:207], v6 offset:3648
    v_readfirstlane_b32 s61, v225
    v_mov_b32 v220, 0
    s_and_b32 s61, s61, 0xfff
    s_add_u32 s63, s54, s61
    v_mov_b32 v215, s63
    s_waitcnt lgkmcnt(1)
    v_smfmac_f32_16x16x64_bf16 v[232:235], v[200:203], v[140:147], v252
    v_smfmac_f32_16x16x64_bf16 v[236:239], v[200:203], v[152:159], v252
    v_smfmac_f32_16x16x64_bf16 v[240:243], v[200:203], v[164:171], v252
    v_smfmac_f32_16x16x64_bf16 v[244:247], v[200:203], v[176:183], v252
    v_smfmac_f32_16x16x64_bf16 v[248:251], v[200:203], v[188:195], v252
    s_cmp_lg_u32 s48, 7
    s_cbranch_scc1 F_n7
    s_mov_b64 exec, 0xffffff
    buffer_load_dwordx2 v[220:221], v7, s[24:27], s70 offen sc1
    s_mov_b64 exec, -1
F_n7:
    s_waitcnt lgkmcnt(0)
    v_smfmac_f32_16x16x64_bf16 v[232:235], v[204:207], v[144:151], v252
    v_smfmac_f32_16x16x64_bf16 v[236:239], v[204:207], v[156:163], v252
HF4_0:
    s_cbranch_execz HF4_1
    v_smfmac_f32_16x16x64_bf16 v[240:243], v[204:207], v[168:175], v252
    v_smfmac_f32_16x16x64_bf16 v[244:247], v[204:207], v[180:187], v252
    v_smfmac_f32_16x16x64_bf16 v[248:251], v[204:207], v[192:199], v252
    s_nop 7
    v_add_f32 v212, v232, v234
    v_add_f32 v213, v236, v238
    v_add_f32 v214, v240, v242
    s_mov_b32 exec_lo, s47
    v_add_f32 v212, v244, v246
    v_add_f32 v213, v248, v250
    s_mov_b32 exec_lo, -1
    s_mov_b32 exec_hi, 0
    buffer_store_dwordx4 v[212:215], v17, s[24:27], s8 offen sc1
    s_mov_b32 exec_hi, -1
    s_cmp_lt_u32 s44, 2
    s_cbranch_scc0 F_rest
    ds_read2_b32 v[228:229], v224 offset0:0 offset1:2
    ds_read2_b32 v[230:231], v224 offset0:4 offset1:6
    s_lshr_b32 s65, s61, 4
    s_mul_i32 s65, s65, 171
    s_lshr_b32 s65, s65, 10
    s_mul_i32 s64, s65, 2560
    s_add_u32 s64, s64, 131072
    s_mul_i32 s71, s65, 96
    s_sub_u32 s66, s61, s71
    s_lshr_b32 s71, s65, 1
    s_mul_i32 s71, s71, 86
    s_add_u32 s66, s66, s71
    s_sub_u32 s66, s66, 10
    s_lshl_b32 s66, s66, 1
    s_and_b32 s65, s65, 1
    s_add_u32 s66, s66, s65
    s_mul_i32 s66, s66, 1280
    v_lshrrev_b32 v223, 3, v18
    v_lshlrev_b32 v223, 4, v223
    s_waitcnt lgkmcnt(0)
    v_add_u32 v226, v231, v19
    v_and_b32 v226, 0xfffe, v226
    ds_read_u16 v226, v226
    v_cvt_pk_bf16_f32 v231, v230, v230
    v_and_b32 v231, 0xffff0000, v231
    v_mul_f32 v231, 0xbfb8aa3b, v231
    v_exp_f32 v231, v231
    s_nop 0
    v_add_f32 v231, 1.0, v231
    v_rcp_f32 v231, v231
HF4_1:
    s_cbranch_execz HF_ret
    s_waitcnt lgkmcnt(0)
    v_lshlrev_b32 v226, 16, v226
    v_cvt_pk_bf16_f32 v231, v231, v231
    v_and_b32 v231, 0xffff0000, v231
    v_sub_f32 v227, v226, v228
    v_cvt_pk_bf16_f32 v227, v227, v227
    v_and_b32 v227, 0xffff0000, v227
    v_mul_f32 v227, v227, v229
    v_cvt_pk_bf16_f32 v227, v227, v227
    v_and_b32 v227, 0xffff0000, v227
    s_waitcnt vmcnt(0)
F_yp:
    buffer_load_dwordx4 v[200:203], v1, s[24:27], s14 offen sc1
    buffer_load_dwordx4 v[204:207], v1, s[24:27], s14 offen offset:1024 sc1
    s_mov_b64 exec, s[18:19]
    buffer_load_dword v222, v223, s[24:27], s64 offen offset:8 sc1
    s_mov_b64 exec, -1
    s_waitcnt vmcnt(1)
    ds_read_b32 v224, v8 offset:40
    v_cmp_ne_u32 vcc, s63, v203
    v_cmp_ne_u32 s[58:59], s63, v207
    v_add_f32 v200, v200, v204
    v_add_f32 v201, v201, v205
    v_add_f32 v202, v202, v206
    s_or_b64 vcc, vcc, s[58:59]
    s_cbranch_scc1 F_chk
    v_mov_b32 v203, v202
    v_permlane32_swap_b32 v200, v201
    s_nop 0
    v_permlane32_swap_b32 v202, v203
    v_add_f32 v200, v200, v201
    v_add_f32 v202, v202, v203
    s_nop 1
    v_permlane16_swap_b32 v200, v202
    v_add_f32 v200, v200, v202
    s_nop 1
    v_add_f32_dpp v200, v200, v200 row_ror:8 row_mask:0xf bank_mask:0xf
    v_cvt_pk_bf16_f32 v200, v200, v200
    v_and_b32 v200, 0xffff0000, v200
    v_mul_f32 v200, v200, v231
    v_cvt_pk_bf16_f32 v200, v200, v200
    v_and_b32 v200, 0xffff0000, v200
    v_add_f32 v200, v200, v227
    v_cvt_pk_bf16_f32 v200, v200, v200
    v_and_b32 v200, 0xffff0000, v200
    v_add_f32 v200, v200, v226
HF5_0:
    s_cbranch_execz HF5_1
    v_cvt_pk_bf16_f32 v200, v200, v200
F_vf:
    s_mov_b64 exec, s[18:19]
    s_waitcnt vmcnt(0) lgkmcnt(0)
    v_readfirstlane_b32 s60, v224
    v_cmp_ne_u32 vcc, s63, v222
    s_and_b32 s62, s60, 0xfff
    s_cmp_lg_u32 s62, s61
    s_cbranch_scc1 F_vw
    s_cbranch_vccnz F_vl
    buffer_store_short v200, v18, s[40:43], s66 offen
    s_or_b32 s65, s49, s44
    s_cbranch_scc1 L_fin
    s_mov_b64 exec, 1
    v_mov_b32 v9, 0
    v_mov_b32 v10, s54
    buffer_store_dword v10, v9, s[24:27], 0 offen
    s_branch L_fin
F_vw:
    s_cmp_lg_u32 s62, 0
    s_cbranch_scc1 F_vx
    s_cbranch_vccz F_vn
F_vl:
    buffer_load_dword v222, v223, s[24:27], s64 offen offset:8 sc1
F_vn:
    ds_read_b32 v224, v8 offset:40
    s_sub_u32 s3, s3, 1
    s_cbranch_scc0 F_vf
    s_mov_b32 s3, 0
    s_branch L_fin
F_vx:
    s_cmp_eq_u32 s17, 0
    s_cbranch_scc1 F_again
    s_branch L_fin
F_chk:
    s_waitcnt lgkmcnt(0)
    v_readfirstlane_b32 s60, v224
    s_and_b32 s62, s60, 0xfff
    s_cselect_b32 s62, s62, s61
    s_cmp_lg_u32 s62, s61
    s_cbranch_scc1 F_vx
    s_sub_u32 s3, s3, 1
    s_cbranch_scc0 F_yp
    s_mov_b32 s3, 0
    s_branch L_fin
F_rest:
    s_cmp_lg_u32 s17, 0
    s_cbranch_scc1 L_fin
    s_cmp_lg_u32 s48, 7
    s_cbranch_scc1 F_tw
    s_mov_b64 exec, 0xffffff
    s_waitcnt vmcnt(1)
    s_branch F_tc
F_tp:
    buffer_load_dwordx2 v[220:221], v7, s[24:27], s70 offen sc1
    s_waitcnt vmcnt(0)
F_tc:
    v_cmp_ne_u32 vcc, s54, v221
    s_cbranch_vccz F_tg
    s_sub_u32 s3, s3, 1
    s_cbranch_scc0 F_tp
    s_mov_b32 s3, 0
F_tg:
    s_mov_b64 exec, -1
HF5_1:
    s_cbranch_execz HF_ret
    v_max_u32_dpp v222, v220, v220 row_ror:1 row_mask:0xf bank_mask:0xf
    s_nop 1
    v_max_u32_dpp v222, v222, v222 row_ror:2 row_mask:0xf bank_mask:0xf
    s_nop 1
    v_max_u32_dpp v222, v222, v222 row_ror:4 row_mask:0xf bank_mask:0xf
    s_nop 1
    v_max_u32_dpp v222, v222, v222 row_ror:8 row_mask:0xf bank_mask:0xf
    s_nop 0
    v_readlane_b32 s60, v222, 0
    v_readlane_b32 s62, v222, 16
    s_max_u32 s60, s60, s62
    s_and_b32 s62, s60, 0xfff
    s_cselect_b32 s60, s60, 1
    v_mov_b32 v220, s60
    ds_write_b32 v8, v220 offset:40
F_tw:
    ds_read_b32 v224, v8 offset:40
    s_waitcnt lgkmcnt(0)
    v_readfirstlane_b32 s60, v224
    s_and_b32 s62, s60, 0xfff
    s_cbranch_scc1 F_tk
    s_sleep 2
    s_sub_u32 s3, s3, 1
    s_cbranch_scc0 F_tw
    s_mov_b32 s3, 0
    s_branch L_fin
F_tk:
    s_cmp_eq_u32 s62, s61
    s_cbranch_scc1 L_fin
F_again:
    s_mov_b64 exec, -1
    s_waitcnt vmcnt(0)
    s_mov_b32 s17, 1
    s_mov_b32 s16, 131072
    s_mov_b32 s20, 0x40000
    v_mov_b64 v[224:225], 0
    s_cmp_eq_u32 s48, 0
    s_cselect_b32 s60, s60, 0
    s_cbranch_scc0 F_redo
    ds_write_b64 v8, v[224:225] offset:32
    s_branch F_redo
L_last:
.section .rodata,"a"
.p2align 6
.amdhsa_kernel sequential_preLN__sliding_local_dilated__moe_arch_mod__prompt_kernel
  .amdhsa_next_free_vgpr 256
  .amdhsa_next_free_sgpr 102
  .amdhsa_accum_offset 256
  .amdhsa_group_segment_fixed_size 0
  .amdhsa_kernarg_size 88
  .amdhsa_user_sgpr_count 2
  .amdhsa_user_sgpr_kernarg_segment_ptr 1
  .amdhsa_system_sgpr_workgroup_id_x 1
  .amdhsa_float_denorm_mode_32 3
  .amdhsa_float_denorm_mode_16_64 3
.end_amdhsa_kernel
```

```asm
; @launch grid=(256,1,1) block=(512,1,1) lds=163840
.amdgcn_target "amdgcn-amd-amdhsa--gfx950"
.text
.globl sequential_preLN__sliding_local_dilated__moe_arch_mod__prompt_kernel
.p2align 8
.type sequential_preLN__sliding_local_dilated__moe_arch_mod__prompt_kernel,@function
sequential_preLN__sliding_local_dilated__moe_arch_mod__prompt_kernel:
    s_load_dwordx2 s[28:29], s[0:1], 0
    s_load_dwordx2 s[32:33], s[0:1], 8
    v_readfirstlane_b32 s48, v0
    s_load_dwordx2 s[24:25], s[0:1], 80
    s_load_dwordx2 s[36:37], s[0:1], 16
    s_load_dwordx2 s[40:41], s[0:1], 64
    s_load_dwordx8 s[12:19], s[0:1], 32
    s_lshr_b32 s56, s2, 3
    s_lshr_b32 s48, s48, 6
    s_cmp_ge_u32 s2, 240
    s_cbranch_scc1 F_pre
    s_mul_i32 s51, s56, 86
    s_lshr_b32 s51, s51, 8
    s_and_b32 s66, s2, 7
    s_sub_u32 s53, s66, s51
    s_mul_i32 s53, s53, 3
    s_add_u32 s53, s53, s56
    s_lshr_b32 s55, s53, 1
    s_and_b32 s50, s53, 1
    s_mul_i32 s55, s55, 86
    s_sub_u32 s55, s55, 10
    s_mov_b32 s30, 2621440
    s_mov_b32 s31, 0x00020000
    s_sub_u32 s60, s48, 4
    s_cbranch_scc1 C_pre
    s_lshl_b32 s62, s60, 2
    s_and_b32 s62, s62, 4
    v_bfe_u32 v1, v0, 3, 3
    v_bfe_u32 v2, v0, 4, 2
    v_bitop3_b32 v3, v0, 7, s62 bitop3:0x6a
    s_mul_i32 s62, s60, 24
    s_add_u32 s62, s62, s55
    s_lshl1_add_u32 s62, s62, s50
    s_mul_i32 s62, s62, 1280
    v_xor_b32 v4, v3, v2
    v_mul_u32_u24 v5, 2560, v1
    v_lshl_add_u32 v4, v4, 4, s62
    s_movk_i32 s63, 20480
    v_add_u32 v10, v4, v5
    v_bitop3_b32 v6, v1, 2, v3 bitop3:0x6a
    v_xad_u32 v11, v10, 64, s63
    v_add_u32 v12, 40960, v10
    s_mul_i32 s62, s60, 30720
    s_lshl_b32 s63, s51, 7
    s_add_u32 s62, s62, s63
    v_mul_u32_u24 v5, 3840, v1
    v_lshl_add_u32 v6, v6, 4, s62
    s_mov_b32 s71, s51
    v_add_u32 v13, v5, v6
    s_mul_i32 s65, s60, 3072
    v_add_u32 v14, 256, v13
    v_add_u32 v15, 512, v13
    s_mov_b32 s34, 2457600
    s_mov_b32 s35, 0x00020000
    s_mov_b32 s64, s65
    s_add_u32 s70, s65, 110592
    s_waitcnt lgkmcnt(0)
    s_call_b64 s[98:99], LD_issue
    s_branch LD_cont
LD_issue:
    s_cmp_ge_u32 s66, s71
    s_addc_u32 s68, s66, 0
    s_mov_b32 m0, s65
    s_lshl_b32 s67, s68, 7
    buffer_load_dwordx4 v10, s[28:31], s67 offen lds
    s_add_u32 m0, s65, 1024
    s_mul_i32 s68, s68, 245760
    buffer_load_dwordx4 v11, s[28:31], s67 offen lds
    s_add_u32 m0, s65, 2048
    s_add_u32 s69, s68, 122880
    buffer_load_dwordx4 v12, s[28:31], s67 offen lds
    s_add_u32 m0, s65, 12288
    s_add_u32 s66, s66, 1
    buffer_load_dwordx4 v13, s[32:35], s68 offen offset:0 lds
    buffer_load_dwordx4 v14, s[32:35], s68 offen offset:1024 lds
    buffer_load_dwordx4 v15, s[32:35], s68 offen offset:2048 lds
    s_add_u32 m0, s65, 24576
    s_cmp_eq_u32 s66, 9
    s_cselect_b32 s66, 0, s66
    buffer_load_dwordx4 v13, s[32:35], s69 offen offset:0 lds
    buffer_load_dwordx4 v14, s[32:35], s69 offen offset:1024 lds
    buffer_load_dwordx4 v15, s[32:35], s69 offen offset:2048 lds
    s_add_u32 s65, s65, 36864
    s_cmp_eq_u32 s65, s70
    s_cselect_b32 s65, s64, s65
    s_setpc_b64 s[98:99]
F_pre:
    s_cmp_ge_u32 s2, 256
    s_cbranch_scc1 L_end
    s_getpc_b64 s[58:59]
P_main:
    v_lshlrev_b32 v2, 7, v0
    v_cmp_gt_u32 vcc, L_last-P_main, v2
    s_nop 1
    v_cndmask_b32 v2, 0, v2, vcc
    global_load_dword v219, v2, s[58:59]
    s_branch F_start
C_pre:
    v_and_b32 v0, 63, v0
    s_mov_b32 s3, 0x40000
    s_mov_b32 s47, 0xffff0000
    s_mov_b32 s26, 7340032
    s_mov_b32 s27, 0x00020000
    s_mov_b32 s38, 819200
    s_mov_b32 s39, 0x00020000
    s_mov_b32 s42, 2621440
    s_mov_b32 s43, 0x00020000
    s_sub_u32 s52, s51, 5
    s_cselect_b32 s52, s51, s52
    v_and_b32 v1, 15, v0
    v_lshrrev_b32 v2, 4, v0
    s_mov_b32 s64, 0x21698350
    s_movk_i32 s65, 0x74
    s_lshl_b32 s62, s51, 2
    s_lshr_b64 s[64:65], s[64:65], s62
    s_and_b32 s64, s64, 15
    s_mul_i32 s60, s64, 12
    s_lshl_b32 s61, s48, 2
    s_add_u32 s60, s60, s61
    v_add_u32 v10, s60, v2
    v_add_u32 v11, s55, v10
    v_cmp_gt_i32 vcc, 0, v11
    v_lshl_add_u32 v11, v11, 1, s50
    v_mul_u32_u24 v11, 1280, v11
    v_lshl_add_u32 v11, v1, 4, v11
    v_cndmask_b32 v11, v11, 2.0, vcc
    s_mov_b32 s34, 1280
    s_mov_b32 s35, 0x00020000
    s_lshl_b32 s62, s53, 1
    s_add_u32 s62, s62, s64
    s_mul_i32 s62, s62, 4
    s_add_u32 s62, s62, s61
    s_sub_u32 s62, s62, 32
    s_cmp_lt_u32 s48, 1
    s_cselect_b32 s62, s62, 640
    s_mul_i32 s63, s64, 24
    s_add_u32 s63, s63, s53
    s_add_u32 s63, s63, 192
    s_cmp_lt_u32 s64, 8
    s_cselect_b32 s65, 3, 0
    s_cselect_b32 s62, s63, s62
    s_cselect_b32 s63, 192, 1
    v_lshlrev_b32 v58, 4, v0
    v_lshlrev_b32 v59, 2, v0
    s_waitcnt lgkmcnt(0)
    s_buffer_load_dword s54, s[24:27], 0
    s_mov_b64 s[32:33], s[12:13]
    s_cmp_lt_u32 s48, s65
    s_cbranch_scc0 A_nors
    buffer_load_dwordx4 v[20:23], v11, s[28:31], 0 offen offset:0
    buffer_load_dwordx4 v[24:27], v11, s[28:31], 0 offen offset:256
    buffer_load_dwordx4 v[28:31], v11, s[28:31], 0 offen offset:512
    buffer_load_dwordx4 v[32:35], v11, s[28:31], 0 offen offset:768
    buffer_load_dwordx4 v[36:39], v11, s[28:31], 0 offen offset:1024
    s_branch A_cons
A_nors:
    s_cmp_lg_u32 s48, 3
    s_cbranch_scc1 A_nowr
    buffer_load_dwordx4 v[48:51], v58, s[32:35], 0 offen
    buffer_load_dword v52, v59, s[32:35], 0 offen offset:1024
A_nowr:
    s_cmp_ge_u32 s62, 640
    s_cbranch_scc1 A_cons
    v_mul_u32_u24 v10, s63, v2
    v_add_u32 v10, s62, v10
    v_lshlrev_b32 v12, 4, v1
    v_mul_u32_u24 v11, 1280, v10
    v_add_u32 v11, v11, v12
    buffer_load_dwordx4 v[76:79], v12, s[32:35], 0 offen offset:0
    buffer_load_dwordx4 v[80:83], v12, s[32:35], 0 offen offset:256
    buffer_load_dwordx4 v[84:87], v12, s[32:35], 0 offen offset:512
    buffer_load_dwordx4 v[88:91], v12, s[32:35], 0 offen offset:768
    buffer_load_dwordx4 v[92:95], v12, s[32:35], 0 offen offset:1024
    buffer_load_dwordx4 v[20:23], v11, s[36:39], 0 offen offset:0
    buffer_load_dwordx4 v[24:27], v11, s[36:39], 0 offen offset:256
    buffer_load_dwordx4 v[28:31], v11, s[36:39], 0 offen offset:512
    buffer_load_dwordx4 v[32:35], v11, s[36:39], 0 offen offset:768
    buffer_load_dwordx4 v[36:39], v11, s[36:39], 0 offen offset:1024
A_cons:
    v_mov_b32 v99, 2.0
    v_lshrrev_b32 v3, 1, v1
    v_xor_b32 v3, v3, v2
    v_lshlrev_b32 v3, 4, v3
    v_lshl_add_u32 v4, v1, 7, v3
    v_xor_b32 v5, 64, v4
    v_cmp_eq_u32 vcc, 0, v1
    v_mov_b32 v3, 159744
    s_nop 0
    v_cndmask_b32 v6, v4, v3, vcc
    v_cndmask_b32 v7, v5, v3, vcc
    v_cndmask_b32 v8, 1, 0, vcc
    v_bfe_u32 v14, v0, 2, 2
    v_and_b32 v15, 3, v0
    v_lshrrev_b32 v16, 1, v14
    v_and_b32 v17, 1, v2
    v_lshl_or_b32 v16, v17, 1, v16
    v_xor_b32 v16, s48, v16
    v_lshlrev_b32 v16, 5, v16
    v_lshl_add_u32 v16, v15, 3, v16
    v_lshl_add_u32 v16, v14, 7, v16
    v_mul_u32_u24 v17, 3072, v2
    v_add_u32 v9, v16, v17
    v_mov_b32 v16, 0x3f803f80
    v_mov_b32 v17, v16
    v_mov_b32 v18, v16
    v_mov_b32 v19, v16
    ds_write_b128 v3, v[16:19]
    v_mov_b64 v[100:101], 0
    v_mov_b64 v[102:103], 0
    v_mov_b64 v[104:105], 0
    v_mov_b64 v[106:107], 0
    v_mov_b64 v[108:109], 0
    v_mov_b64 v[110:111], 0
    v_mov_b64 v[112:113], 0
    v_mov_b64 v[114:115], 0
    v_mov_b64 v[116:117], 0
    v_mov_b64 v[118:119], 0
    v_mov_b64 v[120:121], 0
    v_mov_b64 v[122:123], 0
    v_mov_b64 v[124:125], 0
    v_mov_b64 v[126:127], 0
    v_mov_b64 v[128:129], 0
    v_mov_b64 v[130:131], 0
    v_mov_b64 v[132:133], 0
    v_mov_b64 v[134:135], 0
    v_mov_b64 v[136:137], 0
    v_mov_b64 v[138:139], 0
    v_mov_b64 v[140:141], 0
    v_mov_b64 v[142:143], 0
    v_mov_b64 v[144:145], 0
    v_mov_b64 v[146:147], 0
    v_mov_b64 v[148:149], 0
    v_mov_b64 v[150:151], 0
    v_mov_b64 v[152:153], 0
    v_mov_b64 v[154:155], 0
    v_mov_b64 v[156:157], 0
    v_mov_b64 v[158:159], 0
    v_mov_b64 v[160:161], 0
    v_mov_b64 v[162:163], 0
    v_mov_b64 v[164:165], 0
    v_mov_b64 v[166:167], 0
    v_mov_b64 v[168:169], 0
    v_mov_b64 v[170:171], 0
    s_call_b64 s[98:99], S_late
    s_call_b64 s[98:99], S_late2
    s_call_b64 s[98:99], S_late3
    s_call_b64 s[98:99], S_late4
    s_branch A_c2
S_late:
    v_and_b32 v200, 15, v0
    v_lshrrev_b32 v201, 4, v0
    v_lshlrev_b32 v202, 4, v0
    v_lshlrev_b32 v203, 2, v0
    v_lshrrev_b32 v64, 5, v0
    v_and_b32 v65, 12, v200
    s_lshl_b32 s4, s52, 3
    s_sub_u32 s4, 96768, s4
    s_min_u32 s5, s48, 5
    s_lshl_b32 s6, s5, 4
    v_add_u32 v67, s6, v200
    v_mul_u32_u24 v68, 400, v67
    v_mad_u32_u24 v66, v201, 40, s4
    v_add_u32 v71, v68, v66
    v_subrev_u32 v205, 3072, v71
    v_mul_u32_u24 v72, 5, v201
    v_subrev_u32 v72, s52, v72
    v_mov_b32 v73, 159776
    v_add_u32 v74, 0, v72
    v_cmp_gt_u32 vcc, 16, v74
    v_add_u32 v74, 0, v71
    s_nop 0
    v_cndmask_b32 v204, v73, v74, vcc
    v_add_u32 v74, 1, v72
    v_cmp_gt_u32 vcc, 16, v74
    v_add_u32 v74, 8, v71
    s_nop 0
    v_cndmask_b32 v229, v73, v74, vcc
    v_add_u32 v74, 2, v72
    v_cmp_gt_u32 vcc, 16, v74
    v_add_u32 v74, 16, v71
    s_nop 0
    v_cndmask_b32 v230, v73, v74, vcc
    v_add_u32 v74, 3, v72
    v_cmp_gt_u32 vcc, 16, v74
    v_add_u32 v74, 24, v71
    s_nop 0
    v_cndmask_b32 v231, v73, v74, vcc
    v_add_u32 v74, 4, v72
    v_cmp_gt_u32 vcc, 16, v74
    v_add_u32 v74, 32, v71
    s_nop 0
    v_cndmask_b32 v255, v73, v74, vcc
    v_lshlrev_b32 v208, 3, v67
    v_add_u32 v208, 159808, v208
    v_add_u32 v69, s6, v65
    v_lshlrev_b32 v209, 3, v69
    v_add_u32 v209, 159748, v209
    v_and_b32 v70, 3, v0
    v_cmp_gt_u32 vcc, 1, v70
    v_mov_b32 v73, s47
    s_nop 0
    v_cndmask_b32 v207, 0, v73, vcc
    v_cmp_gt_u32 vcc, 3, v70
    s_nop 1
    v_cndmask_b32 v211, 0, v73, vcc
    v_cmp_gt_u32 vcc, 2, v70
    s_nop 1
    v_cndmask_b32 v211, v211, -1, vcc
    s_setpc_b64 s[98:99]
S_late2:
    s_lshl_b32 s7, s5, 12
    s_add_u32 s7, s7, 135184
    v_lshl_add_u32 v66, v0, 6, s7
    v_lshl_add_u32 v210, v65, 1, v66
    s_add_u32 s13, s6, s55
    v_add_u32 v212, s13, v65
    s_mul_i32 s8, s53, 6
    s_mul_i32 s9, s8, 24320
    s_add_u32 s9, s9, 1310720
    s_mul_i32 s0, s48, 24320
    s_add_u32 s0, s0, s9
    v_lshlrev_b32 v206, 4, v200
    v_lshl_add_u32 v206, v64, 8, v206
    v_xor_b32 v213, 256, v206
    v_lshl_add_u32 v213, v64, 12, v213
    s_cmp_lg_u32 s52, 0
    s_cselect_b32 s20, 0x0000ffff, 0
    s_cmp_lg_u32 s52, 4
    s_cselect_b32 s21, s47, 0
    s_cmp_eq_u32 s48, 0
    s_cselect_b32 s7, 0xff00ff00, -1
    s_and_b32 s20, s20, s7
    s_and_b32 s21, s21, s7
    s_lshl_b32 s7, s51, 11
    s_add_u32 s22, s0, s7
    s_sub_u32 s12, s22, 2048
    s_add_u32 s100, s9, 23040
    s_lshr_b32 s7, s51, 1
    s_mul_i32 s7, s7, 23552
    s_mul_i32 s57, s51, 384
    s_add_u32 s7, s7, s57
    s_add_u32 s7, s7, 23552
    s_add_u32 s57, s7, s9
    s_mul_i32 s7, s48, 10
    s_add_u32 s7, s7, s51
    s_lshl_b32 s7, s7, 2
    s_add_u32 s23, s100, s7
    s_sub_u32 s56, s48, 2
    s_cmp_lt_u32 s48, 6
    s_cselect_b32 s101, 0, 1
    s_cselect_b32 s56, s48, s56
    s_mul_i32 s1, s56, 24320
    s_add_u32 s1, s1, s9
    s_add_u32 s8, s8, s56
    s_mul_i32 s44, s53, 2560
    s_lshl_b32 s7, s51, 8
    s_add_u32 s44, s44, s7
    s_add_u32 s44, s44, 262144
    s_lshl_b32 s45, s53, 6
    s_add_u32 s45, s45, 196608
    s_setpc_b64 s[98:99]
S_late3:
    v_bfe_u32 v68, v0, 2, 2
    v_and_b32 v69, 3, v0
    v_lshl_add_u32 v70, v201, 3, v68
    s_lshl_b32 s7, s48, 4
    s_sub_u32 s7, s7, 16
    v_add_u32 v71, s7, v70
    v_and_b32 v72, 15, v71
    v_max_i32 v71, v71, v72
    v_mul_u32_u24 v71, 400, v71
    v_lshl_add_u32 v71, v69, 3, v71
    v_add_u32 v214, 97024, v71
    v_and_b32 v72, 1, v201
    s_cmp_eq_u32 s48, 0
    s_cselect_b32 s7, 8, 0
    v_cmp_gt_u32 vcc, s7, v200
    s_nop 1
    v_cndmask_b32 v249, v202, 2.0, vcc
    v_lshrrev_b32 v71, 1, v68
    v_lshl_or_b32 v71, v72, 1, v71
    v_lshl_add_u32 v70, v201, 2, v68
    v_lshlrev_b32 v70, 7, v70
    v_lshl_add_u32 v70, v69, 3, v70
    s_mul_i32 s7, s101, 40960
    s_add_u32 s7, s7, 12288
    v_add_u32 v70, s7, v70
    s_mul_i32 s7, s101, 36864
    s_sub_u32 s7, 40960, s7
    v_xor_b32 v73, 0, v71
    v_lshl_add_u32 v216, v73, 5, v70
    v_add_u32 v220, s7, v216
    v_xor_b32 v73, 1, v71
    v_lshl_add_u32 v217, v73, 5, v70
    v_add_u32 v221, s7, v217
    v_xor_b32 v73, 2, v71
    v_lshl_add_u32 v218, v73, 5, v70
    v_add_u32 v222, s7, v218
    v_xor_b32 v73, 3, v71
    v_lshl_add_u32 v219, v73, 5, v70
    v_add_u32 v223, s7, v219
    s_setpc_b64 s[98:99]
S_late4:
    s_lshl_b32 s7, s56, 4
    v_add_u32 v73, s7, v200
    v_cmp_gt_u32 vcc, 10, v73
    v_add_u32 v73, s55, v73
    v_lshl_add_u32 v73, v73, 1, s50
    v_mul_u32_u24 v74, 1280, v73
    s_lshl_b32 s7, s51, 7
    v_lshl_add_u32 v75, v201, 3, s7
    v_add_u32 v74, v74, v75
    v_cndmask_b32 v253, v74, 2.0, vcc
    v_cndmask_b32 v254, v73, -1, vcc
    v_add_u32 v227, 161792, v75
    v_mul_u32_u24 v224, 61440, v201
    v_lshl_add_u32 v224, v200, 4, v224
    s_mov_b32 s7, 161024
    v_lshl_add_u32 v228, v201, 5, s7
    v_lshl_add_u32 v252, v69, 5, s7
    v_lshl_add_u32 v252, v68, 3, v252
    v_mul_u32_u24 v225, 24, v72
    v_add_u32 v225, v225, v253
    v_lshl_add_u32 v226, s8, 4, v200
    s_cmp_eq_u32 s101, 1
    s_cselect_b64 vcc, -1, 0
    v_lshrrev_b32 v73, 1, v200
    v_lshrrev_b32 v74, 1, v201
    v_xor_b32 v73, v73, v74
    v_lshlrev_b32 v73, 4, v73
    v_lshl_add_u32 v73, v72, 3, v73
    v_lshl_add_u32 v73, v200, 7, v73
    v_lshl_add_u32 v250, s56, 11, v73
    v_mov_b32 v251, 160784
    s_add_u32 s7, s52, 5
    s_cmp_lt_u32 s51, 5
    s_cselect_b32 s7, s7, s52
    s_lshl_b32 s7, s7, 11
    s_add_u32 s16, s7, s1
    s_lshl_b32 s7, s51, 11
    s_add_u32 s14, s7, s1
    s_add_u32 s15, s1, 20480
    s_cmp_eq_u32 s101, 1
    s_cselect_b32 s14, s16, s14
    s_cselect_b32 s18, 0x3e0, 62
    s_lshl_b32 s7, s101, 10
    s_add_u32 s16, s16, s7
    s_cmp_lt_u32 s48, 4
    s_cselect_b32 s18, 0x3fe, s18
    s_lshl_b32 s18, s18, s51
    s_lshr_b32 s7, s18, 10
    s_or_b32 s18, s18, s7
    s_and_b32 s18, s18, 0x3ff
    s_mov_b32 s19, 0
    s_mul_i32 s17, s56, 40
    s_add_u32 s17, s17, s100
    s_lshl_b32 s7, s48, 12
    s_add_u32 s7, s7, 135168
    v_lshl_add_u32 v73, v200, 6, s7
    v_lshl_add_u32 v73, v201, 4, v73
    v_add_u32 v74, s52, v201
    s_add_u32 s46, s52, 0
    s_mul_i32 s46, s46, 52
    s_lshr_b32 s46, s46, 8
    v_lshl_add_u32 v172, s46, 10, v73
    s_add_u32 s46, s52, 3
    s_mul_i32 s46, s46, 52
    s_lshr_b32 s46, s46, 8
    v_lshl_add_u32 v173, s46, 10, v73
    s_mul_i32 s46, s46, 5
    s_sub_u32 s46, s46, 0
    v_cmp_le_i32 s[4:5], s46, v74
    s_add_u32 s46, s52, 4
    s_mul_i32 s46, s46, 52
    s_lshr_b32 s46, s46, 8
    v_lshl_add_u32 v174, s46, 10, v73
    s_add_u32 s46, s52, 7
    s_mul_i32 s46, s46, 52
    s_lshr_b32 s46, s46, 8
    v_lshl_add_u32 v175, s46, 10, v73
    s_mul_i32 s46, s46, 5
    s_sub_u32 s46, s46, 4
    v_cmp_le_i32 s[6:7], s46, v74
    s_add_u32 s46, s52, 8
    s_mul_i32 s46, s46, 52
    s_lshr_b32 s46, s46, 8
    v_lshl_add_u32 v176, s46, 10, v73
    s_add_u32 s46, s52, 11
    s_mul_i32 s46, s46, 52
    s_lshr_b32 s46, s46, 8
    v_lshl_add_u32 v177, s46, 10, v73
    s_mul_i32 s46, s46, 5
    s_sub_u32 s46, s46, 8
    v_cmp_le_i32 s[8:9], s46, v74
    s_add_u32 s46, s52, 12
    s_mul_i32 s46, s46, 52
    s_lshr_b32 s46, s46, 8
    v_lshl_add_u32 v178, s46, 10, v73
    s_add_u32 s46, s52, 15
    s_mul_i32 s46, s46, 52
    s_lshr_b32 s46, s46, 8
    v_lshl_add_u32 v179, s46, 10, v73
    s_mul_i32 s46, s46, 5
    s_sub_u32 s46, s46, 12
    v_cmp_le_i32 s[10:11], s46, v74
    s_setpc_b64 s[98:99]
A_c2:
    s_waitcnt lgkmcnt(0)
    s_add_u32 s54, s54, 2654435761
    s_lshl_b32 s63, s53, 11
    s_add_u32 s63, s63, 81920
    v_mov_b32 v42, s54
    v_lshlrev_b32 v10, 4, v10
    s_cmp_lt_u32 s48, s65
    s_cbranch_scc0 A_nos
    s_waitcnt vmcnt(4)
    v_dot2_f32_bf16 v40, v20, v16, 0
    v_dot2_f32_bf16 v41, v20, v20, 0
    v_dot2_f32_bf16 v44, v21, v16, 0
    v_dot2_f32_bf16 v45, v21, v21, 0
    v_dot2_f32_bf16 v40, v22, v16, v40
    v_dot2_f32_bf16 v41, v22, v22, v41
    v_dot2_f32_bf16 v44, v23, v16, v44
    v_dot2_f32_bf16 v45, v23, v23, v45
    s_waitcnt vmcnt(3)
    v_dot2_f32_bf16 v40, v24, v16, v40
    v_dot2_f32_bf16 v41, v24, v24, v41
    v_dot2_f32_bf16 v44, v25, v16, v44
    v_dot2_f32_bf16 v45, v25, v25, v45
    v_dot2_f32_bf16 v40, v26, v16, v40
    v_dot2_f32_bf16 v41, v26, v26, v41
    v_dot2_f32_bf16 v44, v27, v16, v44
    v_dot2_f32_bf16 v45, v27, v27, v45
    s_waitcnt vmcnt(2)
    v_dot2_f32_bf16 v40, v28, v16, v40
    v_dot2_f32_bf16 v41, v28, v28, v41
    v_dot2_f32_bf16 v44, v29, v16, v44
    v_dot2_f32_bf16 v45, v29, v29, v45
    v_dot2_f32_bf16 v40, v30, v16, v40
    v_dot2_f32_bf16 v41, v30, v30, v41
    v_dot2_f32_bf16 v44, v31, v16, v44
    v_dot2_f32_bf16 v45, v31, v31, v45
    s_waitcnt vmcnt(1)
    v_dot2_f32_bf16 v40, v32, v16, v40
    v_dot2_f32_bf16 v41, v32, v32, v41
    v_dot2_f32_bf16 v44, v33, v16, v44
    v_dot2_f32_bf16 v45, v33, v33, v45
    v_dot2_f32_bf16 v40, v34, v16, v40
    v_dot2_f32_bf16 v41, v34, v34, v41
    v_dot2_f32_bf16 v44, v35, v16, v44
    v_dot2_f32_bf16 v45, v35, v35, v45
    s_waitcnt vmcnt(0)
    v_dot2_f32_bf16 v40, v36, v16, v40
    v_dot2_f32_bf16 v41, v36, v36, v41
    v_dot2_f32_bf16 v44, v37, v16, v44
    v_dot2_f32_bf16 v45, v37, v37, v45
    v_dot2_f32_bf16 v40, v38, v16, v40
    v_dot2_f32_bf16 v41, v38, v38, v41
    v_dot2_f32_bf16 v44, v39, v16, v44
    v_dot2_f32_bf16 v45, v39, v39, v45
A_red:
    s_nop 1
    v_add_f32 v40, v40, v44
    v_add_f32 v41, v41, v45
    s_nop 0
    v_add_f32_dpp v40, v40, v40 row_ror:1 row_mask:0xf bank_mask:0xf
    v_add_f32_dpp v41, v41, v41 row_ror:1 row_mask:0xf bank_mask:0xf
    s_nop 0
    v_add_f32_dpp v40, v40, v40 row_ror:2 row_mask:0xf bank_mask:0xf
    v_add_f32_dpp v41, v41, v41 row_ror:2 row_mask:0xf bank_mask:0xf
    s_nop 0
    v_add_f32_dpp v40, v40, v40 row_ror:4 row_mask:0xf bank_mask:0xf
    v_add_f32_dpp v41, v41, v41 row_ror:4 row_mask:0xf bank_mask:0xf
    s_nop 0
    v_add_f32_dpp v40, v40, v40 row_ror:8 row_mask:0xf bank_mask:0xf
    v_add_f32_dpp v41, v41, v41 row_ror:8 row_mask:0xf bank_mask:0xf
    s_cselect_b32 s64, s63, 1245184
    s_cbranch_scc0 A_nln
    v_mul_f32 v40, 0x3acccccd, v40
    v_mul_f32 v41, 0x3acccccd, v41
    v_fma_f32 v41, -v40, v40, v41
    v_max_f32 v41, 0, v41
    v_cvt_pk_bf16_f32 v41, v41, v41
    v_and_b32 v41, 0xffff0000, v41
    v_add_f32 v41, 0x3727c5ac, v41
    v_cvt_pk_bf16_f32 v41, v41, v41
    v_and_b32 v41, 0xffff0000, v41
    v_sqrt_f32 v41, v41
    v_cvt_pk_bf16_f32 v40, v40, v40
    v_and_b32 v40, 0xffff0000, v40
    v_cvt_pk_bf16_f32 v41, v41, v41
    v_and_b32 v41, 0xffff0000, v41
    v_rcp_f32 v41, v41
A_nln:
    s_mov_b32 exec_lo, 0x00010001
    s_mov_b32 exec_hi, 0x00010001
    buffer_store_dwordx3 v[40:42], v10, s[24:27], s64 offen sc1
    s_mov_b64 exec, -1
A_w3:
    s_cmp_lg_u32 s48, 3
    s_cbranch_scc1 A_go
    s_getreg_b32 s61, hwreg(HW_REG_XCC_ID)
    s_lshl_b32 s64, s51, 4
    s_add_u32 s64, s64, 1536
    v_mov_b32 v44, s61
    v_mov_b32 v43, s64
    v_mov_b32 v46, s54
    s_mov_b64 exec, 1
    buffer_store_dwordx3 v[44:46], v43, s[24:27], s63 offen sc1
    s_mov_b64 exec, -1
    v_add_u32 v58, 161792, v58
    v_add_u32 v59, 161792, v59
    s_cmp_lt_u32 s62, 640
    s_cbranch_scc1 A_w3l
    s_waitcnt vmcnt(1)
A_w3l:
    ds_write_b128 v58, v[48:51]
    ds_write_b32 v59, v52 offset:1024
    v_dot2_f32_bf16 v25, v48, v16, 0
    v_dot2_f32_bf16 v25, v49, v16, v25
    v_dot2_f32_bf16 v25, v50, v16, v25
    v_dot2_f32_bf16 v25, v51, v16, v25
    v_dot2_f32_bf16 v25, v52, v16, v25
    s_nop 2
    v_add_f32_dpp v25, v25, v25 row_ror:1 row_mask:0xf bank_mask:0xf
    s_nop 1
    v_add_f32_dpp v25, v25, v25 row_ror:2 row_mask:0xf bank_mask:0xf
    s_nop 1
    v_add_f32_dpp v25, v25, v25 row_ror:4 row_mask:0xf bank_mask:0xf
    s_nop 1
    v_add_f32_dpp v25, v25, v25 row_ror:8 row_mask:0xf bank_mask:0xf
    v_mov_b32 v26, v25
    s_nop 1
    v_permlane32_swap_b32 v25, v26
    v_add_f32 v25, v25, v26
    v_mov_b32 v26, v25
    s_nop 1
    v_permlane16_swap_b32 v25, v26
    v_add_f32 v25, v25, v26
    v_mov_b32 v58, 161792
    ds_write_b32 v58, v25 offset:1280
    s_waitcnt lgkmcnt(0)
    s_branch A_go
A_nos:
    s_cmp_ge_u32 s62, 640
    s_cbranch_scc1 A_w3
    s_waitcnt vmcnt(4)
    v_dot2_f32_bf16 v40, v20, v16, 0
    v_dot2_f32_bf16 v41, v20, v76, 0
    v_dot2_f32_bf16 v44, v21, v16, 0
    v_dot2_f32_bf16 v45, v21, v77, 0
    v_dot2_f32_bf16 v40, v22, v16, v40
    v_dot2_f32_bf16 v41, v22, v78, v41
    v_dot2_f32_bf16 v44, v23, v16, v44
    v_dot2_f32_bf16 v45, v23, v79, v45
    s_waitcnt vmcnt(3)
    v_dot2_f32_bf16 v40, v24, v16, v40
    v_dot2_f32_bf16 v41, v24, v80, v41
    v_dot2_f32_bf16 v44, v25, v16, v44
    v_dot2_f32_bf16 v45, v25, v81, v45
    v_dot2_f32_bf16 v40, v26, v16, v40
    v_dot2_f32_bf16 v41, v26, v82, v41
    v_dot2_f32_bf16 v44, v27, v16, v44
    v_dot2_f32_bf16 v45, v27, v83, v45
    s_waitcnt vmcnt(2)
    v_dot2_f32_bf16 v40, v28, v16, v40
    v_dot2_f32_bf16 v41, v28, v84, v41
    v_dot2_f32_bf16 v44, v29, v16, v44
    v_dot2_f32_bf16 v45, v29, v85, v45
    v_dot2_f32_bf16 v40, v30, v16, v40
    v_dot2_f32_bf16 v41, v30, v86, v41
    v_dot2_f32_bf16 v44, v31, v16, v44
    v_dot2_f32_bf16 v45, v31, v87, v45
    s_waitcnt vmcnt(1)
    v_dot2_f32_bf16 v40, v32, v16, v40
    v_dot2_f32_bf16 v41, v32, v88, v41
    v_dot2_f32_bf16 v44, v33, v16, v44
    v_dot2_f32_bf16 v45, v33, v89, v45
    v_dot2_f32_bf16 v40, v34, v16, v40
    v_dot2_f32_bf16 v41, v34, v90, v41
    v_dot2_f32_bf16 v44, v35, v16, v44
    v_dot2_f32_bf16 v45, v35, v91, v45
    s_waitcnt vmcnt(0)
    v_dot2_f32_bf16 v40, v36, v16, v40
    v_dot2_f32_bf16 v41, v36, v92, v41
    v_dot2_f32_bf16 v44, v37, v16, v44
    v_dot2_f32_bf16 v45, v37, v93, v45
    v_dot2_f32_bf16 v40, v38, v16, v40
    v_dot2_f32_bf16 v41, v38, v94, v41
    v_dot2_f32_bf16 v44, v39, v16, v44
    v_dot2_f32_bf16 v45, v39, v95, v45
    s_branch A_red
A_go:
    v_lshlrev_b32 v18, 3, v1
    v_add_u32 v18, 159808, v18
    v_mul_u32_u24 v3, 400, v1
    v_lshl_add_u32 v3, v2, 3, v3
    s_lshl_b32 s60, s48, 5
    s_add_u32 s60, s60, 96768
    v_add_u32 v3, s60, v3
    v_mov_b32 v17, 160768
    s_mov_b32 s60, 0
    v_add_u32 v14, s60, v9
    v_mad_u32_u24 v10, v8, s60, v6
    v_add_u32 v12, s60, v4
    v_mad_u32_u24 v11, v8, s60, v7
    v_add_u32 v13, s60, v5
    s_mov_b32 s61, 0
    s_barrier
    ds_read_b64_tr_b16 v[44:45], v14 offset:12288
    ds_read_b64_tr_b16 v[46:47], v14 offset:12800
    ds_read_b64_tr_b16 v[48:49], v14 offset:13312
    ds_read_b64_tr_b16 v[50:51], v14 offset:13824
    ds_read_b64_tr_b16 v[52:53], v14 offset:14336
    ds_read_b64_tr_b16 v[54:55], v14 offset:14848
    ds_read_b128 v[20:23], v10
    ds_read_b128 v[24:27], v12 offset:2048
    ds_read_b128 v[28:31], v12 offset:4096
    ds_read_b128 v[32:35], v12 offset:6144
    ds_read_b128 v[36:39], v12 offset:8192
    ds_read_b128 v[40:43], v12 offset:10240
A_loop:
    s_waitcnt lgkmcnt(0)
    v_mfma_f32_16x16x32_bf16 v[100:103], v[44:47], v[20:23], v[100:103]
    ds_read_b64_tr_b16 v[80:81], v14 offset:24576
    v_mfma_f32_16x16x32_bf16 v[104:107], v[48:51], v[20:23], v[104:107]
    ds_read_b64_tr_b16 v[82:83], v14 offset:25088
    v_mfma_f32_16x16x32_bf16 v[108:111], v[52:55], v[20:23], v[108:111]
    ds_read_b64_tr_b16 v[84:85], v14 offset:25600
    v_mfma_f32_16x16x32_bf16 v[112:115], v[44:47], v[24:27], v[112:115]
    ds_read_b64_tr_b16 v[86:87], v14 offset:26112
    v_mfma_f32_16x16x32_bf16 v[116:119], v[48:51], v[24:27], v[116:119]
    ds_read_b64_tr_b16 v[88:89], v14 offset:26624
    v_mfma_f32_16x16x32_bf16 v[120:123], v[52:55], v[24:27], v[120:123]
    ds_read_b64_tr_b16 v[90:91], v14 offset:27136
    v_mfma_f32_16x16x32_bf16 v[124:127], v[44:47], v[28:31], v[124:127]
    ds_read_b128 v[56:59], v11
    v_mfma_f32_16x16x32_bf16 v[128:131], v[48:51], v[28:31], v[128:131]
    ds_read_b128 v[60:63], v13 offset:2048
    v_mfma_f32_16x16x32_bf16 v[132:135], v[52:55], v[28:31], v[132:135]
    ds_read_b128 v[64:67], v13 offset:4096
    v_mfma_f32_16x16x32_bf16 v[136:139], v[44:47], v[32:35], v[136:139]
    ds_read_b128 v[68:71], v13 offset:6144
    v_mfma_f32_16x16x32_bf16 v[140:143], v[48:51], v[32:35], v[140:143]
    ds_read_b128 v[72:75], v13 offset:8192
    v_mfma_f32_16x16x32_bf16 v[144:147], v[52:55], v[32:35], v[144:147]
    ds_read_b128 v[76:79], v13 offset:10240
    v_mfma_f32_16x16x32_bf16 v[148:151], v[44:47], v[36:39], v[148:151]
    s_add_u32 s60, s60, 36864
    v_mfma_f32_16x16x32_bf16 v[152:155], v[48:51], v[36:39], v[152:155]
    s_add_u32 s61, s61, 1
    v_mfma_f32_16x16x32_bf16 v[156:159], v[52:55], v[36:39], v[156:159]
    s_cmp_eq_u32 s60, 110592
    v_mfma_f32_16x16x32_bf16 v[160:163], v[44:47], v[40:43], v[160:163]
    s_cselect_b32 s60, 0, s60
    v_mfma_f32_16x16x32_bf16 v[164:167], v[48:51], v[40:43], v[164:167]
    s_cmp_lt_u32 s61, 9
    v_mfma_f32_16x16x32_bf16 v[168:171], v[52:55], v[40:43], v[168:171]
    s_waitcnt lgkmcnt(0)
    v_mfma_f32_16x16x32_bf16 v[100:103], v[80:83], v[56:59], v[100:103]
    v_add_u32 v14, s60, v9
    v_mfma_f32_16x16x32_bf16 v[104:107], v[84:87], v[56:59], v[104:107]
    v_mad_u32_u24 v10, v8, s60, v6
    v_mfma_f32_16x16x32_bf16 v[108:111], v[88:91], v[56:59], v[108:111]
    v_add_u32 v12, s60, v4
    v_mfma_f32_16x16x32_bf16 v[112:115], v[80:83], v[60:63], v[112:115]
    v_mad_u32_u24 v11, v8, s60, v7
    v_mfma_f32_16x16x32_bf16 v[116:119], v[84:87], v[60:63], v[116:119]
    v_add_u32 v13, s60, v5
    v_mfma_f32_16x16x32_bf16 v[120:123], v[88:91], v[60:63], v[120:123]
    s_barrier
    v_mfma_f32_16x16x32_bf16 v[124:127], v[80:83], v[64:67], v[124:127]
    ds_read_b64_tr_b16 v[44:45], v14 offset:12288
    ds_read_b64_tr_b16 v[46:47], v14 offset:12800
    v_mfma_f32_16x16x32_bf16 v[128:131], v[84:87], v[64:67], v[128:131]
    ds_read_b64_tr_b16 v[48:49], v14 offset:13312
    ds_read_b64_tr_b16 v[50:51], v14 offset:13824
    v_mfma_f32_16x16x32_bf16 v[132:135], v[88:91], v[64:67], v[132:135]
    ds_read_b64_tr_b16 v[52:53], v14 offset:14336
    ds_read_b64_tr_b16 v[54:55], v14 offset:14848
    v_mfma_f32_16x16x32_bf16 v[136:139], v[80:83], v[68:71], v[136:139]
    ds_read_b128 v[20:23], v10
    ds_read_b128 v[24:27], v12 offset:2048
    v_mfma_f32_16x16x32_bf16 v[140:143], v[84:87], v[68:71], v[140:143]
    ds_read_b128 v[28:31], v12 offset:4096
    ds_read_b128 v[32:35], v12 offset:6144
    v_mfma_f32_16x16x32_bf16 v[144:147], v[88:91], v[68:71], v[144:147]
    ds_read_b128 v[36:39], v12 offset:8192
    ds_read_b128 v[40:43], v12 offset:10240
    v_mfma_f32_16x16x32_bf16 v[148:151], v[80:83], v[72:75], v[148:151]
    v_mfma_f32_16x16x32_bf16 v[152:155], v[84:87], v[72:75], v[152:155]
    v_mfma_f32_16x16x32_bf16 v[156:159], v[88:91], v[72:75], v[156:159]
    v_mfma_f32_16x16x32_bf16 v[160:163], v[80:83], v[76:79], v[160:163]
    v_mfma_f32_16x16x32_bf16 v[164:167], v[84:87], v[76:79], v[164:167]
    v_mfma_f32_16x16x32_bf16 v[168:171], v[88:91], v[76:79], v[168:171]
    s_cbranch_scc1 A_loop
A_tail:
    s_waitcnt lgkmcnt(0)
    v_mfma_f32_16x16x32_bf16 v[108:111], v[52:55], v[20:23], v[108:111]
    ds_read_b64_tr_b16 v[80:81], v14 offset:24576
    ds_read_b64_tr_b16 v[82:83], v14 offset:25088
    v_mfma_f32_16x16x32_bf16 v[120:123], v[52:55], v[24:27], v[120:123]
    ds_read_b64_tr_b16 v[84:85], v14 offset:25600
    ds_read_b64_tr_b16 v[86:87], v14 offset:26112
    v_mfma_f32_16x16x32_bf16 v[132:135], v[52:55], v[28:31], v[132:135]
    ds_read_b128 v[56:59], v11
    ds_read_b128 v[60:63], v13 offset:2048
    v_mfma_f32_16x16x32_bf16 v[144:147], v[52:55], v[32:35], v[144:147]
    ds_read_b64 v[184:185], v18 offset:0
    ds_read_b64 v[186:187], v18 offset:128
    v_mfma_f32_16x16x32_bf16 v[156:159], v[52:55], v[36:39], v[156:159]
    ds_read_b128 v[64:67], v13 offset:4096
    ds_read_b128 v[68:71], v13 offset:6144
    v_mfma_f32_16x16x32_bf16 v[168:171], v[52:55], v[40:43], v[168:171]
    ds_read_b128 v[72:75], v13 offset:8192
    ds_read_b128 v[76:79], v13 offset:10240
    v_mfma_f32_16x16x32_bf16 v[100:103], v[44:47], v[20:23], v[100:103]
    ds_read_b64_tr_b16 v[88:89], v14 offset:26624
    ds_read_b64_tr_b16 v[90:91], v14 offset:27136
    v_mfma_f32_16x16x32_bf16 v[104:107], v[48:51], v[20:23], v[104:107]
    ds_read_b64 v[188:189], v18 offset:256
    ds_read_b64 v[190:191], v18 offset:384
    v_mfma_f32_16x16x32_bf16 v[112:115], v[44:47], v[24:27], v[112:115]
    ds_read_b64 v[192:193], v18 offset:512
    ds_read_b64 v[194:195], v18 offset:640
    v_mfma_f32_16x16x32_bf16 v[116:119], v[48:51], v[24:27], v[116:119]
    ds_read_b32 v17, v17
    s_waitcnt lgkmcnt(11)
    v_mfma_f32_16x16x32_bf16 v[100:103], v[80:83], v[56:59], v[100:103]
    ds_read_b32 v16, v208 offset:4
    ds_read2_b32 v[4:5], v209 offset0:0 offset1:2
    v_mfma_f32_16x16x32_bf16 v[104:107], v[84:87], v[56:59], v[104:107]
    ds_read2_b32 v[6:7], v209 offset0:4 offset1:6
    ds_read2_b32 v[8:9], v209 offset0:8 offset1:10
    v_mfma_f32_16x16x32_bf16 v[112:115], v[80:83], v[60:63], v[112:115]
    ds_read2_b32 v[10:11], v209 offset0:12 offset1:14
    ds_read2_b32 v[12:13], v209 offset0:16 offset1:18
    v_mfma_f32_16x16x32_bf16 v[116:119], v[84:87], v[60:63], v[116:119]
    ds_read2_b32 v[14:15], v209 offset0:20 offset1:22
    s_waitcnt lgkmcnt(7)
    v_mfma_f32_16x16x32_bf16 v[124:127], v[44:47], v[28:31], v[124:127]
    v_mov_b32_dpp v20, v100 row_newbcast:0 row_mask:0xf bank_mask:0xf
    v_mov_b32_dpp v21, v101 row_newbcast:0 row_mask:0xf bank_mask:0xf
    v_mov_b32_dpp v22, v102 row_newbcast:0 row_mask:0xf bank_mask:0xf
    v_mfma_f32_16x16x32_bf16 v[128:131], v[48:51], v[28:31], v[128:131]
    v_mov_b32_dpp v23, v103 row_newbcast:0 row_mask:0xf bank_mask:0xf
    v_mov_b32_dpp v24, v104 row_newbcast:0 row_mask:0xf bank_mask:0xf
    v_mov_b32_dpp v25, v105 row_newbcast:0 row_mask:0xf bank_mask:0xf
    v_mfma_f32_16x16x32_bf16 v[124:127], v[80:83], v[64:67], v[124:127]
    v_mov_b32_dpp v26, v106 row_newbcast:0 row_mask:0xf bank_mask:0xf
    v_mov_b32_dpp v27, v107 row_newbcast:0 row_mask:0xf bank_mask:0xf
    v_pk_fma_f32 v[100:101], v[184:185], v[20:21], v[100:101] op_sel_hi:[0,1,1] neg_lo:[1,0,0] neg_hi:[1,0,0]
    v_mfma_f32_16x16x32_bf16 v[128:131], v[84:87], v[64:67], v[128:131]
    v_pk_fma_f32 v[102:103], v[184:185], v[22:23], v[102:103] op_sel_hi:[0,1,1] neg_lo:[1,0,0] neg_hi:[1,0,0]
    v_pk_fma_f32 v[104:105], v[184:185], v[24:25], v[104:105] op_sel_hi:[0,1,1] neg_lo:[1,0,0] neg_hi:[1,0,0]
    v_pk_fma_f32 v[106:107], v[184:185], v[26:27], v[106:107] op_sel_hi:[0,1,1] neg_lo:[1,0,0] neg_hi:[1,0,0]
    v_mfma_f32_16x16x32_bf16 v[136:139], v[44:47], v[32:35], v[136:139]
    v_cvt_pk_bf16_f32 v100, v100, v101
    v_cvt_pk_bf16_f32 v101, v102, v103
    ds_write_b64 v3, v[100:101] offset:0
    v_mfma_f32_16x16x32_bf16 v[140:143], v[48:51], v[32:35], v[140:143]
    v_cvt_pk_bf16_f32 v104, v104, v105
    v_cvt_pk_bf16_f32 v105, v106, v107
    ds_write_b64 v3, v[104:105] offset:128
    v_mfma_f32_16x16x32_bf16 v[136:139], v[80:83], v[68:71], v[136:139]
    v_pk_fma_f32 v[112:113], v[186:187], v[20:21], v[112:113] op_sel_hi:[0,1,1] neg_lo:[1,0,0] neg_hi:[1,0,0]
    v_pk_fma_f32 v[114:115], v[186:187], v[22:23], v[114:115] op_sel_hi:[0,1,1] neg_lo:[1,0,0] neg_hi:[1,0,0]
    v_pk_fma_f32 v[116:117], v[186:187], v[24:25], v[116:117] op_sel_hi:[0,1,1] neg_lo:[1,0,0] neg_hi:[1,0,0]
    v_mfma_f32_16x16x32_bf16 v[140:143], v[84:87], v[68:71], v[140:143]
    v_pk_fma_f32 v[118:119], v[186:187], v[26:27], v[118:119] op_sel_hi:[0,1,1] neg_lo:[1,0,0] neg_hi:[1,0,0]
    v_cvt_pk_bf16_f32 v112, v112, v113
    v_cvt_pk_bf16_f32 v113, v114, v115
    v_mfma_f32_16x16x32_bf16 v[148:151], v[44:47], v[36:39], v[148:151]
    ds_write_b64 v3, v[112:113] offset:6400
    v_cvt_pk_bf16_f32 v116, v116, v117
    v_cvt_pk_bf16_f32 v117, v118, v119
    v_mfma_f32_16x16x32_bf16 v[152:155], v[48:51], v[36:39], v[152:155]
    ds_write_b64 v3, v[116:117] offset:6528
    v_readfirstlane_b32 s49, v17
    s_mov_b32 s60, 0x07060503
    v_mfma_f32_16x16x32_bf16 v[148:151], v[80:83], v[72:75], v[148:151]
    s_mov_b32 s61, 0x07060502
    s_mov_b32 s62, 0x07060501
    s_mov_b32 s63, 0x04000c0c
    v_mfma_f32_16x16x32_bf16 v[152:155], v[84:87], v[72:75], v[152:155]
    v_pk_fma_f32 v[124:125], v[188:189], v[20:21], v[124:125] op_sel_hi:[0,1,1] neg_lo:[1,0,0] neg_hi:[1,0,0]
    v_pk_fma_f32 v[126:127], v[188:189], v[22:23], v[126:127] op_sel_hi:[0,1,1] neg_lo:[1,0,0] neg_hi:[1,0,0]
    v_pk_fma_f32 v[128:129], v[188:189], v[24:25], v[128:129] op_sel_hi:[0,1,1] neg_lo:[1,0,0] neg_hi:[1,0,0]
    v_mfma_f32_16x16x32_bf16 v[160:163], v[44:47], v[40:43], v[160:163]
    v_pk_fma_f32 v[130:131], v[188:189], v[26:27], v[130:131] op_sel_hi:[0,1,1] neg_lo:[1,0,0] neg_hi:[1,0,0]
    v_cvt_pk_bf16_f32 v124, v124, v125
    v_cvt_pk_bf16_f32 v125, v126, v127
    v_mfma_f32_16x16x32_bf16 v[164:167], v[48:51], v[40:43], v[164:167]
    ds_write_b64 v3, v[124:125] offset:12800
    v_cvt_pk_bf16_f32 v128, v128, v129
    v_cvt_pk_bf16_f32 v129, v130, v131
    v_mfma_f32_16x16x32_bf16 v[160:163], v[80:83], v[76:79], v[160:163]
    ds_write_b64 v3, v[128:129] offset:12928
    s_mov_b32 s64, 0x0706000c
    s_mov_b32 s66, 0x11111111
    v_mfma_f32_16x16x32_bf16 v[164:167], v[84:87], v[76:79], v[164:167]
    s_mov_b32 s67, s66
    s_mov_b32 s68, 0x33333333
    v_pk_fma_f32 v[136:137], v[190:191], v[20:21], v[136:137] op_sel_hi:[0,1,1] neg_lo:[1,0,0] neg_hi:[1,0,0]
    v_mfma_f32_16x16x32_bf16 v[108:111], v[88:91], v[56:59], v[108:111]
    v_pk_fma_f32 v[138:139], v[190:191], v[22:23], v[138:139] op_sel_hi:[0,1,1] neg_lo:[1,0,0] neg_hi:[1,0,0]
    v_pk_fma_f32 v[140:141], v[190:191], v[24:25], v[140:141] op_sel_hi:[0,1,1] neg_lo:[1,0,0] neg_hi:[1,0,0]
    v_pk_fma_f32 v[142:143], v[190:191], v[26:27], v[142:143] op_sel_hi:[0,1,1] neg_lo:[1,0,0] neg_hi:[1,0,0]
    v_mfma_f32_16x16x32_bf16 v[120:123], v[88:91], v[60:63], v[120:123]
    v_cvt_pk_bf16_f32 v136, v136, v137
    v_cvt_pk_bf16_f32 v137, v138, v139
    ds_write_b64 v3, v[136:137] offset:19200
    v_mfma_f32_16x16x32_bf16 v[132:135], v[88:91], v[64:67], v[132:135]
    v_cvt_pk_bf16_f32 v140, v140, v141
    v_cvt_pk_bf16_f32 v141, v142, v143
    ds_write_b64 v3, v[140:141] offset:19328
    v_mfma_f32_16x16x32_bf16 v[144:147], v[88:91], v[68:71], v[144:147]
    s_mov_b32 s69, s68
    s_mov_b32 s70, 0x77777777
    s_mov_b32 s71, s70
    v_mfma_f32_16x16x32_bf16 v[156:159], v[88:91], v[72:75], v[156:159]
    v_pk_fma_f32 v[148:149], v[192:193], v[20:21], v[148:149] op_sel_hi:[0,1,1] neg_lo:[1,0,0] neg_hi:[1,0,0]
    v_pk_fma_f32 v[150:151], v[192:193], v[22:23], v[150:151] op_sel_hi:[0,1,1] neg_lo:[1,0,0] neg_hi:[1,0,0]
    v_pk_fma_f32 v[152:153], v[192:193], v[24:25], v[152:153] op_sel_hi:[0,1,1] neg_lo:[1,0,0] neg_hi:[1,0,0]
    v_mfma_f32_16x16x32_bf16 v[168:171], v[88:91], v[76:79], v[168:171]
    v_pk_fma_f32 v[154:155], v[192:193], v[26:27], v[154:155] op_sel_hi:[0,1,1] neg_lo:[1,0,0] neg_hi:[1,0,0]
    v_cvt_pk_bf16_f32 v148, v148, v149
    v_cvt_pk_bf16_f32 v149, v150, v151
    ds_write_b64 v3, v[148:149] offset:25600
    v_cvt_pk_bf16_f32 v152, v152, v153
    v_cvt_pk_bf16_f32 v153, v154, v155
    ds_write_b64 v3, v[152:153] offset:25728
    v_pk_fma_f32 v[160:161], v[194:195], v[20:21], v[160:161] op_sel_hi:[0,1,1] neg_lo:[1,0,0] neg_hi:[1,0,0]
    v_pk_fma_f32 v[162:163], v[194:195], v[22:23], v[162:163] op_sel_hi:[0,1,1] neg_lo:[1,0,0] neg_hi:[1,0,0]
    v_pk_fma_f32 v[164:165], v[194:195], v[24:25], v[164:165] op_sel_hi:[0,1,1] neg_lo:[1,0,0] neg_hi:[1,0,0]
    v_pk_fma_f32 v[166:167], v[194:195], v[26:27], v[166:167] op_sel_hi:[0,1,1] neg_lo:[1,0,0] neg_hi:[1,0,0]
    v_cvt_pk_bf16_f32 v160, v160, v161
    v_cvt_pk_bf16_f32 v161, v162, v163
    ds_write_b64 v3, v[160:161] offset:32000
    v_cvt_pk_bf16_f32 v164, v164, v165
    v_cvt_pk_bf16_f32 v165, v166, v167
    ds_write_b64 v3, v[164:165] offset:32128
    s_setprio 2
    s_branch AT_e2
AT_start:
    s_setprio 3
    ds_read_b32 v16, v208 offset:4
    ds_read2_b32 v[4:5], v209 offset0:0 offset1:2
    ds_read2_b32 v[6:7], v209 offset0:4 offset1:6
    ds_read2_b32 v[8:9], v209 offset0:8 offset1:10
    ds_read2_b32 v[10:11], v209 offset0:12 offset1:14
    ds_read2_b32 v[12:13], v209 offset0:16 offset1:18
    ds_read2_b32 v[14:15], v209 offset0:20 offset1:22
    s_mov_b32 s60, 0x07060503
    s_mov_b32 s61, 0x07060502
    s_mov_b32 s62, 0x07060501
    s_mov_b32 s63, 0x04000c0c
    s_mov_b32 s64, 0x0706000c
    s_mov_b32 s66, 0x11111111
    s_mov_b32 s67, s66
    s_mov_b32 s68, 0x33333333
    s_mov_b32 s69, s68
    s_mov_b32 s70, 0x77777777
    s_mov_b32 s71, s70
    v_mov_b32 v3, 0
AT_e2:
    s_waitcnt lgkmcnt(0)
    s_barrier
    s_cmp_lt_u32 s48, 6
    s_cbranch_scc1 AT_qk
    s_lshl_b32 s65, s48, 10
    s_add_u32 s65, s65, 8192
    v_subrev_u32 v98, 20480, v99
    s_mul_i32 s66, s51, 81920
    s_add_u32 m0, s65, 0
    s_nop 0
    buffer_load_dwordx4 v99, s[36:39], s66 offen lds
    s_add_u32 m0, s65, -2048
    s_nop 0
    buffer_load_dwordx4 v98, s[36:39], s66 offen lds
    s_add_u32 s66, s66, 40960
    s_add_u32 m0, s65, 4096
    s_nop 0
    buffer_load_dwordx4 v99, s[36:39], s66 offen lds
    s_add_u32 m0, s65, 2048
    s_nop 0
    buffer_load_dwordx4 v98, s[36:39], s66 offen lds
    s_add_u32 s66, s66, 40960
    s_cmp_eq_u32 s66, 819200
    s_cselect_b32 s66, 0, s66
    s_add_u32 m0, s65, 8192
    s_nop 0
    buffer_load_dwordx4 v99, s[36:39], s66 offen lds
    s_add_u32 m0, s65, 6144
    s_nop 0
    buffer_load_dwordx4 v98, s[36:39], s66 offen lds
    s_add_u32 s66, s66, 40960
    s_add_u32 m0, s65, 12288
    s_nop 0
    buffer_load_dwordx4 v99, s[36:39], s66 offen lds
    s_add_u32 m0, s65, 10240
    s_nop 0
    buffer_load_dwordx4 v98, s[36:39], s66 offen lds
    s_add_u32 s66, s66, 40960
    s_cmp_eq_u32 s66, 819200
    s_cselect_b32 s66, 0, s66
    s_add_u32 m0, s65, 16384
    s_nop 0
    buffer_load_dwordx4 v99, s[36:39], s66 offen lds
    s_add_u32 m0, s65, 14336
    s_nop 0
    buffer_load_dwordx4 v98, s[36:39], s66 offen lds
    s_add_u32 s66, s66, 40960
    s_add_u32 m0, s65, 20480
    s_nop 0
    buffer_load_dwordx4 v99, s[36:39], s66 offen lds
    s_add_u32 m0, s65, 18432
    s_nop 0
    buffer_load_dwordx4 v98, s[36:39], s66 offen lds
    s_mov_b32 s62, 1
    s_waitcnt vmcnt(0)
    v_mov_b32 v19, 1
    s_mov_b64 exec, 1
    ds_add_u32 v251, v19
    s_mov_b64 exec, -1
    s_branch B_start
AT_qk:
    ds_read_b64 v[20:21], v204
    ds_read_b64 v[30:31], v205 offset:0
    ds_read_b64 v[40:41], v205 offset:1600
    ds_read_b64 v[50:51], v205 offset:3200
    ds_read_b64 v[22:23], v229
    ds_read_b64 v[32:33], v205 offset:8
    ds_read_b64 v[42:43], v205 offset:1608
    ds_read_b64 v[52:53], v205 offset:3208
    ds_read_b64 v[24:25], v230
    ds_read_b64 v[34:35], v205 offset:16
    ds_read_b64 v[44:45], v205 offset:1616
    ds_read_b64 v[54:55], v205 offset:3216
    ds_read_b64 v[26:27], v231
    ds_read_b64 v[36:37], v205 offset:24
    ds_read_b64 v[46:47], v205 offset:1624
    ds_read_b64 v[56:57], v205 offset:3224
    ds_read_b64 v[28:29], v255
    ds_read_b64 v[38:39], v205 offset:32
    ds_read_b64 v[48:49], v205 offset:1632
    ds_read_b64 v[58:59], v205 offset:3232
    v_cndmask_b32 v13, v13, v5, s[66:67]
    v_cndmask_b32 v14, v14, v6, s[68:69]
    v_cndmask_b32 v15, v15, v7, s[70:71]
    v_mov_b32 v79, s54
    v_mov_b32 v83, s54
    v_mov_b32 v87, s54
    v_mov_b64 v[88:89], 0
    v_mov_b64 v[90:91], 0
    v_mov_b64 v[92:93], 0
    v_mov_b64 v[94:95], 0
    v_mul_f32 v16, 0x3ea52b5c, v16
    v_mul_f32 v148, v16, v8
    v_mul_f32 v149, v16, v9
    v_mul_f32 v150, v16, v10
    v_mul_f32 v151, v16, v11
    v_mul_f32 v152, v16, v12
    v_mul_f32 v153, v16, v13
    v_mul_f32 v154, v16, v14
    v_mul_f32 v155, v16, v15
    s_waitcnt lgkmcnt(15)
    v_mfma_f32_4x4x4_16b_bf16 v[60:63], v[30:31], v[20:21], 0
    v_mfma_f32_4x4x4_16b_bf16 v[64:67], v[40:41], v[20:21], 0
    v_mfma_f32_4x4x4_16b_bf16 v[68:71], v[50:51], v[20:21], 0
    s_waitcnt lgkmcnt(12)
    v_mfma_f32_4x4x4_16b_bf16 v[60:63], v[32:33], v[22:23], v[60:63]
    v_mfma_f32_4x4x4_16b_bf16 v[64:67], v[42:43], v[22:23], v[64:67]
    v_mfma_f32_4x4x4_16b_bf16 v[68:71], v[52:53], v[22:23], v[68:71]
    s_waitcnt lgkmcnt(8)
    v_mfma_f32_4x4x4_16b_bf16 v[60:63], v[34:35], v[24:25], v[60:63]
    v_mfma_f32_4x4x4_16b_bf16 v[64:67], v[44:45], v[24:25], v[64:67]
    v_mfma_f32_4x4x4_16b_bf16 v[68:71], v[54:55], v[24:25], v[68:71]
    s_waitcnt lgkmcnt(4)
    v_mfma_f32_4x4x4_16b_bf16 v[60:63], v[36:37], v[26:27], v[60:63]
    v_mfma_f32_4x4x4_16b_bf16 v[64:67], v[46:47], v[26:27], v[64:67]
    v_mfma_f32_4x4x4_16b_bf16 v[68:71], v[56:57], v[26:27], v[68:71]
    s_waitcnt lgkmcnt(0)
    v_mfma_f32_4x4x4_16b_bf16 v[60:63], v[38:39], v[28:29], v[60:63]
    v_mfma_f32_4x4x4_16b_bf16 v[64:67], v[48:49], v[28:29], v[64:67]
    v_mfma_f32_4x4x4_16b_bf16 v[68:71], v[58:59], v[28:29], v[68:71]
    s_cmp_lt_i32 s13, 8
    s_cbranch_scc1 AT_mask
AT_nomask:
    s_nop 2
    v_cndmask_b32 v69, v69, v61, s[66:67]
    v_cndmask_b32 v70, v70, v62, s[68:69]
    v_cndmask_b32 v71, v71, v63, s[70:71]
    v_pk_mul_f32 v[64:65], v[64:65], v[148:149]
    v_pk_mul_f32 v[66:67], v[66:67], v[150:151]
    v_pk_mul_f32 v[68:69], v[68:69], v[152:153]
    v_pk_mul_f32 v[70:71], v[70:71], v[154:155]
    v_perm_b32 v80, v64, v67, s60
    v_perm_b32 v81, v65, v67, s61
    v_perm_b32 v82, v66, v67, s62
    v_perm_b32 v84, v68, v71, s60
    v_perm_b32 v85, v69, v71, s61
    v_perm_b32 v86, v70, v71, s62
    s_mov_b64 exec, s[20:21]
    s_cmp_eq_u32 s49, 0
    s_cbranch_scc1 sts_1
    buffer_store_dwordx4 v[80:83], v213, s[24:27], s12 offen offset:0
    buffer_store_dwordx4 v[84:87], v213, s[24:27], s12 offen offset:512
std_2:
    s_mov_b64 exec, -1
    s_cmp_ge_u32 s48, 4
    s_cbranch_scc1 AT_vw
    v_mov_b32_dpp v196, v108 row_newbcast:0 row_mask:0xf bank_mask:0xf
    v_mov_b32_dpp v197, v109 row_newbcast:0 row_mask:0xf bank_mask:0xf
    v_mov_b32_dpp v198, v110 row_newbcast:0 row_mask:0xf bank_mask:0xf
    v_mov_b32_dpp v199, v111 row_newbcast:0 row_mask:0xf bank_mask:0xf
    v_pk_fma_f32 v[108:109], v[184:185], v[196:197], v[108:109] op_sel_hi:[0,1,1] neg_lo:[1,0,0] neg_hi:[1,0,0]
    v_pk_fma_f32 v[120:121], v[186:187], v[196:197], v[120:121] op_sel_hi:[0,1,1] neg_lo:[1,0,0] neg_hi:[1,0,0]
    v_pk_fma_f32 v[132:133], v[188:189], v[196:197], v[132:133] op_sel_hi:[0,1,1] neg_lo:[1,0,0] neg_hi:[1,0,0]
    v_pk_fma_f32 v[110:111], v[184:185], v[198:199], v[110:111] op_sel_hi:[0,1,1] neg_lo:[1,0,0] neg_hi:[1,0,0]
    v_pk_fma_f32 v[122:123], v[186:187], v[198:199], v[122:123] op_sel_hi:[0,1,1] neg_lo:[1,0,0] neg_hi:[1,0,0]
    v_pk_fma_f32 v[134:135], v[188:189], v[198:199], v[134:135] op_sel_hi:[0,1,1] neg_lo:[1,0,0] neg_hi:[1,0,0]
    v_cvt_pk_bf16_f32 v108, v108, v109
    v_cvt_pk_bf16_f32 v120, v120, v121
    v_cvt_pk_bf16_f32 v132, v132, v133
    v_cvt_pk_bf16_f32 v109, v110, v111
    v_cvt_pk_bf16_f32 v121, v122, v123
    v_cvt_pk_bf16_f32 v133, v134, v135
    ds_write_b64 v3, v[108:109] offset:256
    ds_write_b64 v3, v[120:121] offset:6656
    ds_write_b64 v3, v[132:133] offset:13056
    v_pk_fma_f32 v[144:145], v[190:191], v[196:197], v[144:145] op_sel_hi:[0,1,1] neg_lo:[1,0,0] neg_hi:[1,0,0]
    v_pk_fma_f32 v[156:157], v[192:193], v[196:197], v[156:157] op_sel_hi:[0,1,1] neg_lo:[1,0,0] neg_hi:[1,0,0]
    v_pk_fma_f32 v[168:169], v[194:195], v[196:197], v[168:169] op_sel_hi:[0,1,1] neg_lo:[1,0,0] neg_hi:[1,0,0]
    v_pk_fma_f32 v[146:147], v[190:191], v[198:199], v[146:147] op_sel_hi:[0,1,1] neg_lo:[1,0,0] neg_hi:[1,0,0]
    v_pk_fma_f32 v[158:159], v[192:193], v[198:199], v[158:159] op_sel_hi:[0,1,1] neg_lo:[1,0,0] neg_hi:[1,0,0]
    v_pk_fma_f32 v[170:171], v[194:195], v[198:199], v[170:171] op_sel_hi:[0,1,1] neg_lo:[1,0,0] neg_hi:[1,0,0]
    v_cvt_pk_bf16_f32 v144, v144, v145
    v_cvt_pk_bf16_f32 v156, v156, v157
    v_cvt_pk_bf16_f32 v168, v168, v169
    v_cvt_pk_bf16_f32 v145, v146, v147
    v_cvt_pk_bf16_f32 v157, v158, v159
    v_cvt_pk_bf16_f32 v169, v170, v171
    ds_write_b64 v3, v[144:145] offset:19456
    ds_write_b64 v3, v[156:157] offset:25856
    ds_write_b64 v3, v[168:169] offset:32256
    v_mov_b32 v19, 1
    s_mov_b64 exec, 1
    ds_add_u32 v251, v19 offset:8
    s_mov_b64 exec, -1
AT_vw:
    v_lshl_add_u32 v17, v201, 3, v251
    ds_read2_b64 v[156:159], v17 offset0:14 offset1:18
    ds_read2_b64 v[160:163], v17 offset0:22 offset1:26
    v_and_b32 v164, 2, v201
    v_lshl_add_u32 v164, v200, 2, v164
    s_lshl_b32 s65, s48, 6
    s_add_u32 s65, s65, s57
    s_mov_b64 exec, s[20:21]
AT_poll:
    buffer_load_dwordx4 v[88:91], v206, s[24:27], s22 offen offset:0 sc1
    buffer_load_dwordx4 v[92:95], v206, s[24:27], s22 offen offset:512 sc1
AT_pw:
    s_waitcnt vmcnt(0)
    v_cmp_ne_u32 vcc, s54, v91
    v_cmp_ne_u32 s[58:59], s54, v95
    s_or_b64 vcc, vcc, s[58:59]
    s_cbranch_vccz AT_got
    s_sub_u32 s3, s3, 1
    s_cbranch_scc0 AT_poll
    s_mov_b32 s3, 0
AT_got:
    s_mov_b64 exec, -1
    ds_read_b32 v17, v251 offset:8
    s_cmp_lt_u32 s48, 4
    s_cbranch_scc1 AT_w0
    v_mov_b32 v19, 1
    s_mov_b64 exec, 1
    ds_add_u32 v251, v19
    s_mov_b64 exec, -1
AT_w0:
    v_perm_b32 v91, v88, v89, s63
    v_perm_b32 v95, v92, v93, s63
    v_perm_b32 v91, v91, v90, s64
    v_perm_b32 v95, v95, v94, s64
    v_pk_add_f32 v[64:65], v[64:65], v[88:89]
    v_pk_add_f32 v[68:69], v[68:69], v[92:93]
    v_pk_add_f32 v[66:67], v[66:67], v[90:91]
    v_pk_add_f32 v[70:71], v[70:71], v[94:95]
    v_max3_f32 v18, v64, v65, v66
    v_max3_f32 v19, v67, v68, v69
    v_max3_f32 v18, v18, v70, v71
    v_max_f32 v18, v18, v19
    v_pk_add_f32 v[64:65], v[64:65], v[18:19] op_sel_hi:[1,0] neg_lo:[0,1] neg_hi:[0,1]
    v_pk_add_f32 v[66:67], v[66:67], v[18:19] op_sel_hi:[1,0] neg_lo:[0,1] neg_hi:[0,1]
    v_pk_add_f32 v[68:69], v[68:69], v[18:19] op_sel_hi:[1,0] neg_lo:[0,1] neg_hi:[0,1]
    v_pk_add_f32 v[70:71], v[70:71], v[18:19] op_sel_hi:[1,0] neg_lo:[0,1] neg_hi:[0,1]
AT_vc:
    s_waitcnt lgkmcnt(0)
    v_cmp_ne_u32 vcc, 4, v17
    s_cbranch_vccnz AT_vs
AT_vg:
    ds_read_b64_tr_b16 v[100:101], v214 offset:0
    ds_read_b64_tr_b16 v[102:103], v214 offset:1600
    ds_read_b64_tr_b16 v[104:105], v214 offset:32
    ds_read_b64_tr_b16 v[106:107], v214 offset:1632
    ds_read_b64_tr_b16 v[108:109], v214 offset:64
    ds_read_b64_tr_b16 v[110:111], v214 offset:1664
    ds_read_b64_tr_b16 v[112:113], v214 offset:96
    ds_read_b64_tr_b16 v[114:115], v214 offset:1696
    v_exp_f32 v64, v64
    v_exp_f32 v65, v65
    v_exp_f32 v66, v66
    v_exp_f32 v67, v67
    v_exp_f32 v68, v68
    v_exp_f32 v69, v69
    v_exp_f32 v70, v70
    v_exp_f32 v71, v71
    v_pk_add_f32 v[20:21], v[64:65], v[66:67]
    v_pk_add_f32 v[22:23], v[68:69], v[70:71]
    v_pk_add_f32 v[20:21], v[20:21], v[22:23]
    v_add_f32 v20, v20, v21
    v_rcp_f32 v20, v20
    v_pk_mul_f32 v[64:65], v[64:65], v[8:9]
    v_pk_mul_f32 v[66:67], v[66:67], v[10:11]
    v_pk_mul_f32 v[68:69], v[68:69], v[12:13]
    v_pk_mul_f32 v[70:71], v[70:71], v[14:15]
    v_pk_mul_f32 v[64:65], v[64:65], v[20:21] op_sel_hi:[1,0]
    v_pk_mul_f32 v[66:67], v[66:67], v[20:21] op_sel_hi:[1,0]
    v_pk_mul_f32 v[68:69], v[68:69], v[20:21] op_sel_hi:[1,0]
    v_pk_mul_f32 v[70:71], v[70:71], v[20:21] op_sel_hi:[1,0]
    v_cvt_pk_bf16_f32 v24, v64, v65
    v_cvt_pk_bf16_f32 v25, v66, v67
    v_cvt_pk_bf16_f32 v26, v68, v69
    v_cvt_pk_bf16_f32 v27, v70, v71
    ds_write_b64 v210, v[24:25] offset:8
    v_and_b32 v28, v26, v207
    v_and_b32 v29, v27, v211
    ds_write_b64 v210, v[28:29]
    v_xor_b32 v26, v26, v28
    v_xor_b32 v27, v27, v29
    ds_write_b64 v210, v[26:27] offset:16
    ds_read_b128 v[116:119], v172
    ds_read_b128 v[120:123], v173
    ds_read_b128 v[124:127], v174
    ds_read_b128 v[128:131], v175
    ds_read_b128 v[132:135], v176
    ds_read_b128 v[136:139], v177
    ds_read_b128 v[140:143], v178
    ds_read_b128 v[144:147], v179
    s_cmp_lt_u32 s48, 4
    s_cbranch_scc1 AT_pv
    s_lshl_b32 s58, s48, 2
    s_add_u32 s58, s58, 160760
    v_mov_b32 v18, s58
    v_mov_b32 v19, 1
    ds_write_b32 v18, v19
AT_pv:
    s_waitcnt lgkmcnt(6)
    v_mfma_f32_16x16x32_bf16 v[20:23], v[100:103], v[116:119], 0
    v_mfma_f32_16x16x32_bf16 v[24:27], v[100:103], v[120:123], 0
    s_waitcnt lgkmcnt(4)
    v_mfma_f32_16x16x32_bf16 v[28:31], v[104:107], v[124:127], 0
    v_mfma_f32_16x16x32_bf16 v[32:35], v[104:107], v[128:131], 0
    s_waitcnt lgkmcnt(2)
    v_mfma_f32_16x16x32_bf16 v[36:39], v[108:111], v[132:135], 0
    v_mfma_f32_16x16x32_bf16 v[40:43], v[108:111], v[136:139], 0
    s_waitcnt lgkmcnt(0)
    v_mfma_f32_16x16x32_bf16 v[44:47], v[112:115], v[140:143], 0
    v_mfma_f32_16x16x32_bf16 v[48:51], v[112:115], v[144:147], 0
    v_cndmask_b32 v20, v20, v24, s[4:5]
    v_cndmask_b32 v21, v21, v25, s[4:5]
    v_cndmask_b32 v22, v22, v26, s[4:5]
    v_cndmask_b32 v23, v23, v27, s[4:5]
    v_cvt_pk_bf16_f32 v204, v20, v21
    v_cvt_pk_bf16_f32 v205, v22, v23
    v_cndmask_b32 v28, v28, v32, s[6:7]
    v_cndmask_b32 v29, v29, v33, s[6:7]
    v_cndmask_b32 v30, v30, v34, s[6:7]
    v_cndmask_b32 v31, v31, v35, s[6:7]
    v_cvt_pk_bf16_f32 v206, v28, v29
    v_cvt_pk_bf16_f32 v207, v30, v31
    v_cndmask_b32 v36, v36, v40, s[8:9]
    v_cndmask_b32 v37, v37, v41, s[8:9]
    v_cndmask_b32 v38, v38, v42, s[8:9]
    v_cndmask_b32 v39, v39, v43, s[8:9]
    v_cvt_pk_bf16_f32 v208, v36, v37
    v_cvt_pk_bf16_f32 v209, v38, v39
    v_cndmask_b32 v44, v44, v48, s[10:11]
    v_cndmask_b32 v45, v45, v49, s[10:11]
    v_cndmask_b32 v46, v46, v50, s[10:11]
    v_cndmask_b32 v47, v47, v51, s[10:11]
    v_cvt_pk_bf16_f32 v210, v44, v45
    v_cvt_pk_bf16_f32 v211, v46, v47
    s_cmp_eq_u32 s49, 0
    s_cbranch_scc1 sts_3
    buffer_store_dwordx4 v[204:207], v249, s[24:27], s22 offen offset:0
    buffer_store_dwordx4 v[208:211], v249, s[24:27], s22 offen offset:1024
std_4:
    s_mov_b64 exec, s[18:19]
    buffer_load_dword v18, v203, s[24:27], s17 offen sc1
    s_mov_b64 exec, -1
    v_dot2_f32_bf16 v20, v204, v156, 0
    v_dot2_f32_bf16 v21, v204, v204, 0
    v_dot2_f32_bf16 v20, v205, v157, v20
    v_dot2_f32_bf16 v21, v205, v205, v21
    v_dot2_f32_bf16 v20, v206, v158, v20
    v_dot2_f32_bf16 v21, v206, v206, v21
    v_dot2_f32_bf16 v20, v207, v159, v20
    v_dot2_f32_bf16 v21, v207, v207, v21
    v_dot2_f32_bf16 v20, v208, v160, v20
    v_dot2_f32_bf16 v21, v208, v208, v21
    v_dot2_f32_bf16 v20, v209, v161, v20
    v_dot2_f32_bf16 v21, v209, v209, v21
    v_dot2_f32_bf16 v20, v210, v162, v20
    v_dot2_f32_bf16 v21, v210, v210, v21
    v_dot2_f32_bf16 v20, v211, v163, v20
    v_dot2_f32_bf16 v21, v211, v211, v21
    s_nop 2
    v_permlane32_swap_b32 v20, v21
    v_add_f32 v20, v20, v21
    v_mov_b32 v21, v20
    s_nop 1
    v_permlane16_swap_b32 v20, v21
    s_mov_b32 exec_lo, 0xffff
    s_mov_b32 exec_hi, 0xffff
    v_add_f32 v20, v20, v21
    s_cmp_eq_u32 s49, 0
    s_cbranch_scc1 sts_5
    buffer_store_short_d16_hi v20, v164, s[24:27], s65 offen
std_6:
    s_mov_b64 exec, -1
    s_waitcnt vmcnt(2)
    s_mov_b64 exec, 1
    s_cmp_eq_u32 s49, 0
    s_cbranch_scc1 sts_7
    buffer_store_dword v79, v203, s[24:27], s23 offen
std_8:
    s_mov_b64 exec, -1
    s_waitcnt vmcnt(2)
    v_cmp_ne_u32 vcc, s54, v18
    s_and_b32 s62, vcc_lo, s18
    s_cbranch_scc1 B_st0
    s_add_u32 s14, s14, 2048
    s_cmp_eq_u32 s14, s15
    s_cselect_b32 s14, s1, s14
    buffer_load_dwordx4 v[168:171], v249, s[24:27], s14 offen offset:0 sc1
    buffer_load_dwordx4 v[172:175], v249, s[24:27], s14 offen offset:1024 sc1
    s_add_u32 s14, s14, 2048
    s_cmp_eq_u32 s14, s15
    s_cselect_b32 s14, s1, s14
    buffer_load_dwordx4 v[176:179], v249, s[24:27], s14 offen offset:0 sc1
    buffer_load_dwordx4 v[180:183], v249, s[24:27], s14 offen offset:1024 sc1
    s_add_u32 s14, s14, 2048
    s_cmp_eq_u32 s14, s15
    s_cselect_b32 s14, s1, s14
    buffer_load_dwordx4 v[212:215], v249, s[24:27], s14 offen offset:0 sc1
    buffer_load_dwordx4 v[12:15], v249, s[24:27], s14 offen offset:1024 sc1
B_st0:
B_start:
    ds_read_b32 v19, v251
    ds_read2_b64 v[240:243], v227 offset0:0 offset1:4
    ds_read2_b64 v[244:247], v227 offset0:8 offset1:12
    ds_read_b32 v248, v251 offset:2288
    ds_read_b64 v[232:233], v250
    v_xor_b32 v4, 32, v250
    ds_read_b64 v[234:235], v4
    v_xor_b32 v5, 64, v250
    ds_read_b64 v[236:237], v5
    v_xor_b32 v6, 96, v250
    ds_read_b64 v[238:239], v6
    v_cmp_gt_u32 vcc, 2048, v254
    s_mov_b64 s[4:5], vcc
    s_branch B_wc
B_ww:
    ds_read_b32 v19, v251
B_wc:
    s_waitcnt lgkmcnt(0)
    v_cmp_ne_u32 vcc, 4, v19
    s_cbranch_vccz B_wd
    s_sleep 1
    s_sub_u32 s3, s3, 1
    s_cbranch_scc0 B_ww
    s_mov_b32 s3, 0
B_wd:
    s_mov_b32 exec_lo, 0x00010001
    s_mov_b32 exec_hi, 0x00010001
    v_mov_b32 v240, 0x3f803f80
    v_mov_b32 v241, 0x3f803f80
    v_mov_b32 v242, 0x3f803f80
    v_mov_b32 v243, 0x3f803f80
    v_mov_b32 v244, 0x3f803f80
    v_mov_b32 v245, 0x3f803f80
    v_mov_b32 v246, 0x3f803f80
    v_mov_b32 v247, 0x3f803f80
    s_mov_b64 exec, -1
    s_setprio 0
    s_cmp_ge_u32 s48, 6
    s_cbranch_scc1 B_r2
    ds_read_b64_tr_b16 v[20:21], v216 offset:0
    ds_read_b64_tr_b16 v[22:23], v216 offset:2048
    ds_read_b64_tr_b16 v[24:25], v217 offset:0
    ds_read_b64_tr_b16 v[26:27], v217 offset:2048
    ds_read_b64_tr_b16 v[28:29], v218 offset:0
    ds_read_b64_tr_b16 v[30:31], v218 offset:2048
    ds_read_b64_tr_b16 v[32:33], v219 offset:0
    ds_read_b64_tr_b16 v[34:35], v219 offset:2048
    ds_read_b64_tr_b16 v[36:37], v216 offset:4096
    ds_read_b64_tr_b16 v[38:39], v216 offset:6144
    ds_read_b64_tr_b16 v[40:41], v217 offset:4096
    ds_read_b64_tr_b16 v[42:43], v217 offset:6144
    ds_read_b64_tr_b16 v[44:45], v218 offset:4096
    ds_read_b64_tr_b16 v[46:47], v218 offset:6144
    ds_read_b64_tr_b16 v[48:49], v219 offset:4096
    ds_read_b64_tr_b16 v[50:51], v219 offset:6144
B_r2:
    ds_read_b64_tr_b16 v[52:53], v216 offset:8192
    ds_read_b64_tr_b16 v[54:55], v216 offset:10240
    ds_read_b64_tr_b16 v[56:57], v217 offset:8192
    ds_read_b64_tr_b16 v[58:59], v217 offset:10240
    ds_read_b64_tr_b16 v[60:61], v218 offset:8192
    ds_read_b64_tr_b16 v[62:63], v218 offset:10240
    ds_read_b64_tr_b16 v[64:65], v219 offset:8192
    ds_read_b64_tr_b16 v[66:67], v219 offset:10240
    ds_read_b64_tr_b16 v[68:69], v216 offset:12288
    ds_read_b64_tr_b16 v[70:71], v216 offset:14336
    ds_read_b64_tr_b16 v[72:73], v217 offset:12288
    ds_read_b64_tr_b16 v[74:75], v217 offset:14336
    ds_read_b64_tr_b16 v[76:77], v218 offset:12288
    ds_read_b64_tr_b16 v[78:79], v218 offset:14336
    ds_read_b64_tr_b16 v[80:81], v219 offset:12288
    ds_read_b64_tr_b16 v[82:83], v219 offset:14336
    s_cmp_eq_u32 s62, 0
    s_cbranch_scc1 B_nap
    s_mov_b64 exec, s[18:19]
    buffer_load_dword v18, v203, s[24:27], s17 offen sc1
    s_mov_b64 exec, -1
B_nap:
    ds_read_b64_tr_b16 v[84:85], v216 offset:16384
    ds_read_b64_tr_b16 v[86:87], v216 offset:18432
    ds_read_b64_tr_b16 v[88:89], v217 offset:16384
    ds_read_b64_tr_b16 v[90:91], v217 offset:18432
    ds_read_b64_tr_b16 v[92:93], v218 offset:16384
    ds_read_b64_tr_b16 v[94:95], v218 offset:18432
    ds_read_b64_tr_b16 v[96:97], v219 offset:16384
    ds_read_b64_tr_b16 v[98:99], v219 offset:18432
    ds_read_b64_tr_b16 v[100:101], v216 offset:20480
    ds_read_b64_tr_b16 v[102:103], v216 offset:22528
    ds_read_b64_tr_b16 v[104:105], v217 offset:20480
    ds_read_b64_tr_b16 v[106:107], v217 offset:22528
    ds_read_b64_tr_b16 v[108:109], v218 offset:20480
    ds_read_b64_tr_b16 v[110:111], v218 offset:22528
    ds_read_b64_tr_b16 v[112:113], v219 offset:20480
    ds_read_b64_tr_b16 v[114:115], v219 offset:22528
    ds_read_b64_tr_b16 v[116:117], v216 offset:24576
    ds_read_b64_tr_b16 v[118:119], v216 offset:26624
    ds_read_b64_tr_b16 v[120:121], v217 offset:24576
    ds_read_b64_tr_b16 v[122:123], v217 offset:26624
    ds_read_b64_tr_b16 v[124:125], v218 offset:24576
    ds_read_b64_tr_b16 v[126:127], v218 offset:26624
    ds_read_b64_tr_b16 v[128:129], v219 offset:24576
    ds_read_b64_tr_b16 v[130:131], v219 offset:26624
    s_cmp_ge_u32 s48, 6
    s_cbranch_scc1 B_no
    v_lshlrev_b32 v184, 16, v232
    v_and_b32 v185, s47, v232
    v_lshlrev_b32 v186, 16, v233
    v_and_b32 v187, s47, v233
    v_lshlrev_b32 v188, 16, v234
    v_and_b32 v189, s47, v234
    v_lshlrev_b32 v190, 16, v235
    v_and_b32 v191, s47, v235
    v_lshlrev_b32 v192, 16, v236
    v_and_b32 v193, s47, v236
    v_lshlrev_b32 v194, 16, v237
    v_and_b32 v195, s47, v237
    v_lshlrev_b32 v196, 16, v238
    v_and_b32 v197, s47, v238
    v_lshlrev_b32 v198, 16, v239
    v_and_b32 v199, s47, v239
    s_waitcnt lgkmcnt(0)
    v_mfma_f32_16x16x32_bf16 v[184:187], v[20:23], v[204:207], v[184:187]
    v_mfma_f32_16x16x32_bf16 v[188:191], v[24:27], v[204:207], v[188:191]
    v_mfma_f32_16x16x32_bf16 v[192:195], v[28:31], v[204:207], v[192:195]
    v_mfma_f32_16x16x32_bf16 v[196:199], v[32:35], v[204:207], v[196:199]
    s_waitcnt lgkmcnt(0)
    v_mfma_f32_16x16x32_bf16 v[184:187], v[36:39], v[208:211], v[184:187]
    v_mfma_f32_16x16x32_bf16 v[188:191], v[40:43], v[208:211], v[188:191]
    v_mfma_f32_16x16x32_bf16 v[192:195], v[44:47], v[208:211], v[192:195]
    v_mfma_f32_16x16x32_bf16 v[196:199], v[48:51], v[208:211], v[196:199]
    s_branch B_n2
B_rds:
    ds_read_b64_tr_b16 v[132:133], v216 offset:28672
    ds_read_b64_tr_b16 v[134:135], v216 offset:30720
    ds_read_b64_tr_b16 v[136:137], v217 offset:28672
    ds_read_b64_tr_b16 v[138:139], v217 offset:30720
    ds_read_b64_tr_b16 v[140:141], v218 offset:28672
    ds_read_b64_tr_b16 v[142:143], v218 offset:30720
    ds_read_b64_tr_b16 v[144:145], v219 offset:28672
    ds_read_b64_tr_b16 v[146:147], v219 offset:30720
    ds_read_b64_tr_b16 v[148:149], v216 offset:32768
    ds_read_b64_tr_b16 v[150:151], v216 offset:34816
    ds_read_b64_tr_b16 v[152:153], v217 offset:32768
    ds_read_b64_tr_b16 v[154:155], v217 offset:34816
    ds_read_b64_tr_b16 v[156:157], v218 offset:32768
    ds_read_b64_tr_b16 v[158:159], v218 offset:34816
    ds_read_b64_tr_b16 v[160:161], v219 offset:32768
    ds_read_b64_tr_b16 v[162:163], v219 offset:34816
    ds_read_b64_tr_b16 v[20:21], v216 offset:36864
    ds_read_b64_tr_b16 v[22:23], v216 offset:38912
    ds_read_b64_tr_b16 v[24:25], v217 offset:36864
    ds_read_b64_tr_b16 v[26:27], v217 offset:38912
    ds_read_b64_tr_b16 v[28:29], v218 offset:36864
    ds_read_b64_tr_b16 v[30:31], v218 offset:38912
    ds_read_b64_tr_b16 v[32:33], v219 offset:36864
    ds_read_b64_tr_b16 v[34:35], v219 offset:38912
    ds_read_b64_tr_b16 v[36:37], v220 offset:0
    ds_read_b64_tr_b16 v[38:39], v220 offset:2048
    ds_read_b64_tr_b16 v[40:41], v221 offset:0
    ds_read_b64_tr_b16 v[42:43], v221 offset:2048
    ds_read_b64_tr_b16 v[44:45], v222 offset:0
    ds_read_b64_tr_b16 v[46:47], v222 offset:2048
    ds_read_b64_tr_b16 v[48:49], v223 offset:0
    ds_read_b64_tr_b16 v[50:51], v223 offset:2048
    s_setpc_b64 s[98:99]
B_no:
    v_mov_b64 v[184:185], 0
    v_mov_b64 v[186:187], 0
    v_mov_b64 v[188:189], 0
    v_mov_b64 v[190:191], 0
    v_mov_b64 v[192:193], 0
    v_mov_b64 v[194:195], 0
    v_mov_b64 v[196:197], 0
    v_mov_b64 v[198:199], 0
    s_call_b64 s[98:99], B_rds
    v_mul_u32_u24 v4, 12, v0
    s_add_u32 s58, s100, 512
    s_add_u32 s59, s100, 24832
    s_add_u32 s60, s100, 49152
    s_add_u32 s12, s100, 73472
    s_add_u32 s13, s100, 97792
    v_and_b32 v5, 31, v0
    v_mul_u32_u24 v5, 3, v5
    s_mul_i32 s64, s53, 96
    s_sub_u32 s65, 1014, s55
    v_mov_b32 v6, 0xfffff000
    v_add_u32 v7, -10, v5
    v_cmp_gt_u32 vcc, s65, v7
    v_add3_u32 v7, v5, s64, 0
    s_nop 0
    v_cndmask_b32 v8, 0, v7, vcc
    v_cndmask_b32 v204, 0, v6, vcc
    v_add_u32 v7, -9, v5
    v_cmp_gt_u32 vcc, s65, v7
    v_add3_u32 v7, v5, s64, 1
    s_nop 0
    v_cndmask_b32 v9, 0, v7, vcc
    v_cndmask_b32 v205, 0, v6, vcc
    v_add_u32 v7, -8, v5
    v_cmp_gt_u32 vcc, s65, v7
    v_add3_u32 v7, v5, s64, 2
    s_nop 0
    v_cndmask_b32 v10, 0, v7, vcc
    v_cndmask_b32 v206, 0, v6, vcc
    v_mov_b32 v7, s54
    v_lshlrev_b32 v11, 11, v200
    s_setprio 2
B_n2:
    s_cmp_eq_u32 s62, 0
    s_cbranch_scc1 B_run
    s_mov_b64 exec, s[18:19]
    s_branch B_pw
B_poll:
    buffer_load_dword v18, v203, s[24:27], s17 offen sc1
B_pw:
    s_waitcnt vmcnt(0)
    v_cmp_ne_u32 vcc, s54, v18
    s_cbranch_vccz B_go
    s_sub_u32 s3, s3, 1
    s_cbranch_scc0 B_poll
    s_mov_b32 s3, 0
B_go:
    s_mov_b64 exec, -1
    s_add_u32 s14, s14, 2048
    s_cmp_eq_u32 s14, s15
    s_cselect_b32 s14, s1, s14
    buffer_load_dwordx4 v[168:171], v249, s[24:27], s14 offen offset:0 sc1
    buffer_load_dwordx4 v[172:175], v249, s[24:27], s14 offen offset:1024 sc1
    s_add_u32 s14, s14, 2048
    s_cmp_eq_u32 s14, s15
    s_cselect_b32 s14, s1, s14
    buffer_load_dwordx4 v[176:179], v249, s[24:27], s14 offen offset:0 sc1
    buffer_load_dwordx4 v[180:183], v249, s[24:27], s14 offen offset:1024 sc1
    s_add_u32 s14, s14, 2048
    s_cmp_eq_u32 s14, s15
    s_cselect_b32 s14, s1, s14
    buffer_load_dwordx4 v[212:215], v249, s[24:27], s14 offen offset:0 sc1
    buffer_load_dwordx4 v[12:15], v249, s[24:27], s14 offen offset:1024 sc1
B_run:
    s_cmp_ge_u32 s48, 6
    s_cbranch_scc1 B_half
    s_call_b64 s[98:99], B_rds
    s_cmp_ge_u32 s48, 4
    s_cbranch_scc1 B_half
    s_setprio 1
    s_waitcnt vmcnt(5) lgkmcnt(15)
    v_mfma_f32_16x16x32_bf16 v[184:187], v[52:55], v[168:171], v[184:187]
    v_mfma_f32_16x16x32_bf16 v[188:191], v[56:59], v[168:171], v[188:191]
    ds_read_b64_tr_b16 v[52:53], v220 offset:4096
    v_mfma_f32_16x16x32_bf16 v[192:195], v[60:63], v[168:171], v[192:195]
    ds_read_b64_tr_b16 v[54:55], v220 offset:6144
    v_mfma_f32_16x16x32_bf16 v[196:199], v[64:67], v[168:171], v[196:199]
    s_add_u32 s14, s14, 2048
    s_cmp_eq_u32 s14, s15
    s_cselect_b32 s14, s1, s14
    buffer_load_dwordx4 v[164:167], v249, s[24:27], s14 offen offset:0 sc1
    ds_read_b64_tr_b16 v[56:57], v221 offset:4096
    s_waitcnt vmcnt(5) lgkmcnt(15)
    v_mfma_f32_16x16x32_bf16 v[184:187], v[68:71], v[172:175], v[184:187]
    ds_read_b64_tr_b16 v[58:59], v221 offset:6144
    ds_read_b64_tr_b16 v[60:61], v222 offset:4096
    v_mfma_f32_16x16x32_bf16 v[188:191], v[72:75], v[172:175], v[188:191]
    ds_read_b64_tr_b16 v[62:63], v222 offset:6144
    v_mfma_f32_16x16x32_bf16 v[192:195], v[76:79], v[172:175], v[192:195]
    ds_read_b64_tr_b16 v[64:65], v223 offset:4096
    v_mfma_f32_16x16x32_bf16 v[196:199], v[80:83], v[172:175], v[196:199]
    buffer_load_dwordx4 v[232:235], v249, s[24:27], s14 offen offset:1024 sc1
    ds_read_b64_tr_b16 v[66:67], v223 offset:6144
    s_waitcnt vmcnt(5) lgkmcnt(15)
    v_mfma_f32_16x16x32_bf16 v[184:187], v[84:87], v[176:179], v[184:187]
    ds_read_b64_tr_b16 v[68:69], v220 offset:8192
    ds_read_b64_tr_b16 v[70:71], v220 offset:10240
    v_mfma_f32_16x16x32_bf16 v[188:191], v[88:91], v[176:179], v[188:191]
    ds_read_b64_tr_b16 v[72:73], v221 offset:8192
    v_mfma_f32_16x16x32_bf16 v[192:195], v[92:95], v[176:179], v[192:195]
    ds_read_b64_tr_b16 v[74:75], v221 offset:10240
    v_mfma_f32_16x16x32_bf16 v[196:199], v[96:99], v[176:179], v[196:199]
    s_mov_b32 s14, s16
    buffer_load_dwordx4 v[236:239], v249, s[24:27], s14 offen offset:0 sc1
    ds_read_b64_tr_b16 v[76:77], v222 offset:8192
    s_waitcnt vmcnt(5) lgkmcnt(15)
    v_mfma_f32_16x16x32_bf16 v[184:187], v[100:103], v[180:183], v[184:187]
    ds_read_b64_tr_b16 v[78:79], v222 offset:10240
    ds_read_b64_tr_b16 v[80:81], v223 offset:8192
    v_mfma_f32_16x16x32_bf16 v[188:191], v[104:107], v[180:183], v[188:191]
    ds_read_b64_tr_b16 v[82:83], v223 offset:10240
    v_mfma_f32_16x16x32_bf16 v[192:195], v[108:111], v[180:183], v[192:195]
    ds_read_b64_tr_b16 v[84:85], v220 offset:12288
    v_mfma_f32_16x16x32_bf16 v[196:199], v[112:115], v[180:183], v[196:199]
    buffer_load_dwordx4 v[168:171], v249, s[24:27], s14 offen offset:1024 sc1
    ds_read_b64_tr_b16 v[86:87], v220 offset:14336
    s_waitcnt vmcnt(5) lgkmcnt(15)
    v_mfma_f32_16x16x32_bf16 v[184:187], v[116:119], v[212:215], v[184:187]
    ds_read_b64_tr_b16 v[88:89], v221 offset:12288
    ds_read_b64_tr_b16 v[90:91], v221 offset:14336
    v_mfma_f32_16x16x32_bf16 v[188:191], v[120:123], v[212:215], v[188:191]
    ds_read_b64_tr_b16 v[92:93], v222 offset:12288
    v_mfma_f32_16x16x32_bf16 v[192:195], v[124:127], v[212:215], v[192:195]
    ds_read_b64_tr_b16 v[94:95], v222 offset:14336
    v_mfma_f32_16x16x32_bf16 v[196:199], v[128:131], v[212:215], v[196:199]
    s_add_u32 s14, s14, 2048
    s_cmp_eq_u32 s14, s15
    s_cselect_b32 s14, s1, s14
    buffer_load_dwordx4 v[172:175], v249, s[24:27], s14 offen offset:0 sc1
    ds_read_b64_tr_b16 v[96:97], v223 offset:12288
    s_waitcnt vmcnt(5) lgkmcnt(15)
    v_mfma_f32_16x16x32_bf16 v[184:187], v[132:135], v[12:15], v[184:187]
    ds_read_b64_tr_b16 v[98:99], v223 offset:14336
    ds_read_b64_tr_b16 v[100:101], v220 offset:16384
    v_mfma_f32_16x16x32_bf16 v[188:191], v[136:139], v[12:15], v[188:191]
    ds_read_b64_tr_b16 v[102:103], v220 offset:18432
    v_mfma_f32_16x16x32_bf16 v[192:195], v[140:143], v[12:15], v[192:195]
    ds_read_b64_tr_b16 v[104:105], v221 offset:16384
    v_mfma_f32_16x16x32_bf16 v[196:199], v[144:147], v[12:15], v[196:199]
    buffer_load_dwordx4 v[176:179], v249, s[24:27], s14 offen offset:1024 sc1
    ds_read_b64_tr_b16 v[106:107], v221 offset:18432
    s_waitcnt vmcnt(5) lgkmcnt(15)
    v_mfma_f32_16x16x32_bf16 v[184:187], v[148:151], v[164:167], v[184:187]
    ds_read_b64_tr_b16 v[108:109], v222 offset:16384
    ds_read_b64_tr_b16 v[110:111], v222 offset:18432
    v_mfma_f32_16x16x32_bf16 v[188:191], v[152:155], v[164:167], v[188:191]
    ds_read_b64_tr_b16 v[112:113], v223 offset:16384
    v_mfma_f32_16x16x32_bf16 v[192:195], v[156:159], v[164:167], v[192:195]
    ds_read_b64_tr_b16 v[114:115], v223 offset:18432
    v_mfma_f32_16x16x32_bf16 v[196:199], v[160:163], v[164:167], v[196:199]
    s_add_u32 s14, s14, 2048
    s_cmp_eq_u32 s14, s15
    s_cselect_b32 s14, s1, s14
    buffer_load_dwordx4 v[180:183], v249, s[24:27], s14 offen offset:0 sc1
    ds_read_b64_tr_b16 v[116:117], v220 offset:20480
    s_waitcnt vmcnt(5) lgkmcnt(15)
    v_mfma_f32_16x16x32_bf16 v[184:187], v[20:23], v[232:235], v[184:187]
    ds_read_b64_tr_b16 v[118:119], v220 offset:22528
    ds_read_b64_tr_b16 v[120:121], v221 offset:20480
    v_mfma_f32_16x16x32_bf16 v[188:191], v[24:27], v[232:235], v[188:191]
    ds_read_b64_tr_b16 v[122:123], v221 offset:22528
    v_mfma_f32_16x16x32_bf16 v[192:195], v[28:31], v[232:235], v[192:195]
    ds_read_b64_tr_b16 v[124:125], v222 offset:20480
    v_mfma_f32_16x16x32_bf16 v[196:199], v[32:35], v[232:235], v[196:199]
    buffer_load_dwordx4 v[212:215], v249, s[24:27], s14 offen offset:1024 sc1
    ds_read_b64_tr_b16 v[126:127], v222 offset:22528
    s_waitcnt vmcnt(5) lgkmcnt(15)
    v_mfma_f32_16x16x32_bf16 v[184:187], v[36:39], v[236:239], v[184:187]
    ds_read_b64_tr_b16 v[128:129], v223 offset:20480
    ds_read_b64_tr_b16 v[130:131], v223 offset:22528
    v_mfma_f32_16x16x32_bf16 v[188:191], v[40:43], v[236:239], v[188:191]
    ds_read_b64_tr_b16 v[132:133], v220 offset:24576
    v_mfma_f32_16x16x32_bf16 v[192:195], v[44:47], v[236:239], v[192:195]
    ds_read_b64_tr_b16 v[134:135], v220 offset:26624
    v_mfma_f32_16x16x32_bf16 v[196:199], v[48:51], v[236:239], v[196:199]
    s_add_u32 s14, s14, 2048
    s_cmp_eq_u32 s14, s15
    s_cselect_b32 s14, s1, s14
    buffer_load_dwordx4 v[12:15], v249, s[24:27], s14 offen offset:0 sc1
    ds_read_b64_tr_b16 v[136:137], v221 offset:24576
    s_waitcnt vmcnt(5) lgkmcnt(15)
    v_mfma_f32_16x16x32_bf16 v[184:187], v[52:55], v[168:171], v[184:187]
    ds_read_b64_tr_b16 v[138:139], v221 offset:26624
    ds_read_b64_tr_b16 v[140:141], v222 offset:24576
    v_mfma_f32_16x16x32_bf16 v[188:191], v[56:59], v[168:171], v[188:191]
    ds_read_b64_tr_b16 v[142:143], v222 offset:26624
    v_mfma_f32_16x16x32_bf16 v[192:195], v[60:63], v[168:171], v[192:195]
    ds_read_b64_tr_b16 v[144:145], v223 offset:24576
    v_mfma_f32_16x16x32_bf16 v[196:199], v[64:67], v[168:171], v[196:199]
    buffer_load_dwordx4 v[164:167], v249, s[24:27], s14 offen offset:1024 sc1
    ds_read_b64_tr_b16 v[146:147], v223 offset:26624
    s_waitcnt vmcnt(5) lgkmcnt(15)
    v_mfma_f32_16x16x32_bf16 v[184:187], v[68:71], v[172:175], v[184:187]
    ds_read_b64_tr_b16 v[148:149], v220 offset:28672
    ds_read_b64_tr_b16 v[150:151], v220 offset:30720
    v_mfma_f32_16x16x32_bf16 v[188:191], v[72:75], v[172:175], v[188:191]
    ds_read_b64_tr_b16 v[152:153], v221 offset:28672
    v_mfma_f32_16x16x32_bf16 v[192:195], v[76:79], v[172:175], v[192:195]
    ds_read_b64_tr_b16 v[154:155], v221 offset:30720
    v_mfma_f32_16x16x32_bf16 v[196:199], v[80:83], v[172:175], v[196:199]
    s_add_u32 s14, s14, 2048
    s_cmp_eq_u32 s14, s15
    s_cselect_b32 s14, s1, s14
    buffer_load_dwordx4 v[232:235], v249, s[24:27], s14 offen offset:0 sc1
    ds_read_b64_tr_b16 v[156:157], v222 offset:28672
    s_waitcnt vmcnt(5) lgkmcnt(15)
    v_mfma_f32_16x16x32_bf16 v[184:187], v[84:87], v[176:179], v[184:187]
    ds_read_b64_tr_b16 v[158:159], v222 offset:30720
    ds_read_b64_tr_b16 v[160:161], v223 offset:28672
    v_mfma_f32_16x16x32_bf16 v[188:191], v[88:91], v[176:179], v[188:191]
    ds_read_b64_tr_b16 v[162:163], v223 offset:30720
    v_mfma_f32_16x16x32_bf16 v[192:195], v[92:95], v[176:179], v[192:195]
    ds_read_b64_tr_b16 v[20:21], v220 offset:32768
    v_mfma_f32_16x16x32_bf16 v[196:199], v[96:99], v[176:179], v[196:199]
    buffer_load_dwordx4 v[236:239], v249, s[24:27], s14 offen offset:1024 sc1
    ds_read_b64_tr_b16 v[22:23], v220 offset:34816
    s_waitcnt vmcnt(5) lgkmcnt(15)
    v_mfma_f32_16x16x32_bf16 v[184:187], v[100:103], v[180:183], v[184:187]
    ds_read_b64_tr_b16 v[24:25], v221 offset:32768
    ds_read_b64_tr_b16 v[26:27], v221 offset:34816
    v_mfma_f32_16x16x32_bf16 v[188:191], v[104:107], v[180:183], v[188:191]
    ds_read_b64_tr_b16 v[28:29], v222 offset:32768
    v_mfma_f32_16x16x32_bf16 v[192:195], v[108:111], v[180:183], v[192:195]
    ds_read_b64_tr_b16 v[30:31], v222 offset:34816
    v_mfma_f32_16x16x32_bf16 v[196:199], v[112:115], v[180:183], v[196:199]
    ds_read_b64_tr_b16 v[32:33], v223 offset:32768
    s_waitcnt vmcnt(4) lgkmcnt(15)
    v_mfma_f32_16x16x32_bf16 v[184:187], v[116:119], v[212:215], v[184:187]
    ds_read_b64_tr_b16 v[34:35], v223 offset:34816
    ds_read_b64_tr_b16 v[36:37], v220 offset:36864
    v_mfma_f32_16x16x32_bf16 v[188:191], v[120:123], v[212:215], v[188:191]
    ds_read_b64_tr_b16 v[38:39], v220 offset:38912
    v_mfma_f32_16x16x32_bf16 v[192:195], v[124:127], v[212:215], v[192:195]
    ds_read_b64_tr_b16 v[40:41], v221 offset:36864
    v_mfma_f32_16x16x32_bf16 v[196:199], v[128:131], v[212:215], v[196:199]
    ds_read_b64_tr_b16 v[42:43], v221 offset:38912
    s_waitcnt vmcnt(3) lgkmcnt(15)
    v_mfma_f32_16x16x32_bf16 v[184:187], v[132:135], v[12:15], v[184:187]
    ds_read_b64_tr_b16 v[44:45], v222 offset:36864
    ds_read_b64_tr_b16 v[46:47], v222 offset:38912
    v_mfma_f32_16x16x32_bf16 v[188:191], v[136:139], v[12:15], v[188:191]
    ds_read_b64_tr_b16 v[48:49], v223 offset:36864
    v_mfma_f32_16x16x32_bf16 v[192:195], v[140:143], v[12:15], v[192:195]
    ds_read_b64_tr_b16 v[50:51], v223 offset:38912
    v_mfma_f32_16x16x32_bf16 v[196:199], v[144:147], v[12:15], v[196:199]
    s_waitcnt vmcnt(2) lgkmcnt(15)
    v_mfma_f32_16x16x32_bf16 v[184:187], v[148:151], v[164:167], v[184:187]
    v_mfma_f32_16x16x32_bf16 v[188:191], v[152:155], v[164:167], v[188:191]
    v_mfma_f32_16x16x32_bf16 v[192:195], v[156:159], v[164:167], v[192:195]
    v_mfma_f32_16x16x32_bf16 v[196:199], v[160:163], v[164:167], v[196:199]
    ds_read_b32 v10, v251 offset:4
    s_waitcnt vmcnt(1) lgkmcnt(9)
    v_mfma_f32_16x16x32_bf16 v[184:187], v[20:23], v[232:235], v[184:187]
    v_mfma_f32_16x16x32_bf16 v[188:191], v[24:27], v[232:235], v[188:191]
    v_mfma_f32_16x16x32_bf16 v[192:195], v[28:31], v[232:235], v[192:195]
    v_mfma_f32_16x16x32_bf16 v[196:199], v[32:35], v[232:235], v[196:199]
    s_waitcnt vmcnt(0) lgkmcnt(1)
    v_mfma_f32_16x16x32_bf16 v[184:187], v[36:39], v[236:239], v[184:187]
    v_mfma_f32_16x16x32_bf16 v[188:191], v[40:43], v[236:239], v[188:191]
    v_mfma_f32_16x16x32_bf16 v[192:195], v[44:47], v[236:239], v[192:195]
    v_mfma_f32_16x16x32_bf16 v[196:199], v[48:51], v[236:239], v[196:199]
    s_branch B_epi
B_half:
    s_add_u32 s14, s14, 2048
    s_cmp_eq_u32 s14, s15
    s_cselect_b32 s14, s1, s14
    buffer_load_dwordx4 v[164:167], v249, s[24:27], s14 offen offset:0 sc1
    buffer_load_dwordx4 v[232:235], v249, s[24:27], s14 offen offset:1024 sc1
    s_mov_b32 s14, s16
    buffer_load_dwordx4 v[236:239], v249, s[24:27], s14 offen offset:0 sc1
    s_cmp_lg_u32 s48, 6
    s_cbranch_scc1 E_end
    s_setprio 3
E_poll:
    s_mov_b32 exec_hi, 0x0fffffff
    buffer_load_dword v17, v203, s[24:27], s100 offen sc1
    s_mov_b32 exec_hi, -1
    buffer_load_dwordx3 v[224:226], v4, s[24:27], s58 offen sc1
    buffer_load_dwordx3 v[228:230], v4, s[24:27], s59 offen sc1
    buffer_load_dwordx3 v[240:242], v4, s[24:27], s60 offen sc1
    buffer_load_dwordx3 v[244:246], v4, s[24:27], s12 offen sc1
    buffer_load_dwordx3 v[208:210], v4, s[24:27], s13 offen sc1
E_chk:
    s_waitcnt vmcnt(5)
    v_cmp_ne_u32 vcc, s54, v17
    s_lshl_b64 vcc, vcc, 4
    s_cbranch_scc0 E_go
    s_sleep 1
    s_sub_u32 s3, s3, 1
    s_cbranch_scc0 E_poll
    s_mov_b32 s3, 0
E_go:
    s_waitcnt vmcnt(4)
    s_waitcnt vmcnt(3)
    v_add_f32 v252, v224, v228
    v_add_f32 v253, v225, v229
    v_add_f32 v254, v226, v230
    v_lshlrev_b32 v224, 16, v224
    v_lshlrev_b32 v225, 16, v225
    v_lshlrev_b32 v226, 16, v226
    v_lshlrev_b32 v228, 16, v228
    v_lshlrev_b32 v229, 16, v229
    v_lshlrev_b32 v230, 16, v230
    v_add_f32 v224, v224, v228
    v_add_f32 v225, v225, v229
    v_add_f32 v226, v226, v230
    s_waitcnt vmcnt(2)
    v_add_f32 v252, v252, v240
    v_add_f32 v253, v253, v241
    v_add_f32 v254, v254, v242
    v_lshlrev_b32 v240, 16, v240
    v_lshlrev_b32 v241, 16, v241
    v_lshlrev_b32 v242, 16, v242
    v_add_f32 v224, v224, v240
    v_add_f32 v225, v225, v241
    v_add_f32 v226, v226, v242
    s_waitcnt vmcnt(1)
    v_add_f32 v252, v252, v244
    v_add_f32 v253, v253, v245
    v_add_f32 v254, v254, v246
    v_lshlrev_b32 v244, 16, v244
    v_lshlrev_b32 v245, 16, v245
    v_lshlrev_b32 v246, 16, v246
    v_add_f32 v224, v224, v244
    v_add_f32 v225, v225, v245
    v_add_f32 v226, v226, v246
    s_waitcnt vmcnt(0)
    v_add_f32 v252, v252, v208
    v_add_f32 v253, v253, v209
    v_add_f32 v254, v254, v210
    v_lshlrev_b32 v208, 16, v208
    v_lshlrev_b32 v209, 16, v209
    v_lshlrev_b32 v210, 16, v210
    v_add_f32 v224, v224, v208
    v_add_f32 v225, v225, v209
    v_add_f32 v226, v226, v210
    v_permlane32_swap_b32 v224, v252
    v_permlane32_swap_b32 v225, v253
    v_permlane32_swap_b32 v226, v254
    v_add_f32 v224, v224, v252
    v_add_f32 v225, v225, v253
    v_add_f32 v226, v226, v254
    v_rsq_f32 v252, v224
    v_rsq_f32 v253, v225
    v_rsq_f32 v254, v226
    v_permlane32_swap_b32 v252, v228
    v_permlane32_swap_b32 v253, v229
    v_permlane32_swap_b32 v254, v230
    v_mul_f32 v224, v224, v228
    v_mul_f32 v225, v225, v229
    v_mul_f32 v226, v226, v230
    v_and_or_b32 v252, v224, v204, v8
    v_and_or_b32 v253, v225, v205, v9
    v_and_or_b32 v254, v226, v206, v10
    v_max3_i32 v6, v252, v253, v254
    s_nop 1
    v_max_i32_dpp v6, v6, v6 row_ror:1 row_mask:0xf bank_mask:0xf
    s_nop 1
    v_max_i32_dpp v6, v6, v6 row_ror:2 row_mask:0xf bank_mask:0xf
    s_nop 1
    v_max_i32_dpp v6, v6, v6 row_ror:4 row_mask:0xf bank_mask:0xf
    s_nop 1
    v_max_i32_dpp v6, v6, v6 row_ror:8 row_mask:0xf bank_mask:0xf
    v_mov_b32 v5, v6
    s_nop 1
    v_permlane16_swap_b32 v6, v5
    s_mov_b64 exec, 0xffff
    s_cmp_lg_u32 s51, 0
    v_max3_i32 v6, v6, v5, 1
    s_cbranch_scc1 E_np
    buffer_store_dwordx2 v[6:7], v11, s[24:27], s45 offen sc1
E_np:
    ds_write_b32 v251, v6 offset:4
    s_mov_b64 exec, -1
E_end:
    s_waitcnt vmcnt(8) lgkmcnt(15)
    v_mfma_f32_16x16x32_bf16 v[184:187], v[52:55], v[168:171], v[184:187]
    v_mfma_f32_16x16x32_bf16 v[188:191], v[56:59], v[168:171], v[188:191]
    v_mfma_f32_16x16x32_bf16 v[192:195], v[60:63], v[168:171], v[192:195]
    v_mfma_f32_16x16x32_bf16 v[196:199], v[64:67], v[168:171], v[196:199]
    s_waitcnt vmcnt(7) lgkmcnt(15)
    v_mfma_f32_16x16x32_bf16 v[184:187], v[68:71], v[172:175], v[184:187]
    v_mfma_f32_16x16x32_bf16 v[188:191], v[72:75], v[172:175], v[188:191]
    v_mfma_f32_16x16x32_bf16 v[192:195], v[76:79], v[172:175], v[192:195]
    v_mfma_f32_16x16x32_bf16 v[196:199], v[80:83], v[172:175], v[196:199]
    ds_read_b32 v10, v251 offset:4
    s_waitcnt vmcnt(6) lgkmcnt(15)
    v_mfma_f32_16x16x32_bf16 v[184:187], v[84:87], v[176:179], v[184:187]
    v_mfma_f32_16x16x32_bf16 v[188:191], v[88:91], v[176:179], v[188:191]
    v_mfma_f32_16x16x32_bf16 v[192:195], v[92:95], v[176:179], v[192:195]
    v_mfma_f32_16x16x32_bf16 v[196:199], v[96:99], v[176:179], v[196:199]
    s_waitcnt lgkmcnt(0)
    v_and_b32 v9, 0xfff, v10
    s_nop 0
    v_readfirstlane_b32 s64, v9
    s_lshr_b32 s64, s64, 4
    s_mul_i32 s65, s53, 6
    s_add_u32 s65, s65, s56
    s_cmp_lg_u32 s64, s65
    s_cbranch_scc1 B_nb
    s_setprio 3
B_nb:
    s_waitcnt vmcnt(5) lgkmcnt(15)
    v_mfma_f32_16x16x32_bf16 v[184:187], v[100:103], v[180:183], v[184:187]
    v_mfma_f32_16x16x32_bf16 v[188:191], v[104:107], v[180:183], v[188:191]
    v_mfma_f32_16x16x32_bf16 v[192:195], v[108:111], v[180:183], v[192:195]
    v_mfma_f32_16x16x32_bf16 v[196:199], v[112:115], v[180:183], v[196:199]
    s_waitcnt vmcnt(4) lgkmcnt(15)
    v_mfma_f32_16x16x32_bf16 v[184:187], v[116:119], v[212:215], v[184:187]
    v_mfma_f32_16x16x32_bf16 v[188:191], v[120:123], v[212:215], v[188:191]
    v_mfma_f32_16x16x32_bf16 v[192:195], v[124:127], v[212:215], v[192:195]
    v_mfma_f32_16x16x32_bf16 v[196:199], v[128:131], v[212:215], v[196:199]
    s_waitcnt vmcnt(3) lgkmcnt(15)
    v_mfma_f32_16x16x32_bf16 v[184:187], v[132:135], v[12:15], v[184:187]
    v_mfma_f32_16x16x32_bf16 v[188:191], v[136:139], v[12:15], v[188:191]
    v_mfma_f32_16x16x32_bf16 v[192:195], v[140:143], v[12:15], v[192:195]
    v_mfma_f32_16x16x32_bf16 v[196:199], v[144:147], v[12:15], v[196:199]
    s_waitcnt vmcnt(2) lgkmcnt(15)
    v_mfma_f32_16x16x32_bf16 v[184:187], v[148:151], v[164:167], v[184:187]
    v_mfma_f32_16x16x32_bf16 v[188:191], v[152:155], v[164:167], v[188:191]
    v_mfma_f32_16x16x32_bf16 v[192:195], v[156:159], v[164:167], v[192:195]
    v_mfma_f32_16x16x32_bf16 v[196:199], v[160:163], v[164:167], v[196:199]
    s_waitcnt vmcnt(1) lgkmcnt(9)
    v_mfma_f32_16x16x32_bf16 v[184:187], v[20:23], v[232:235], v[184:187]
    v_mfma_f32_16x16x32_bf16 v[188:191], v[24:27], v[232:235], v[188:191]
    v_mfma_f32_16x16x32_bf16 v[192:195], v[28:31], v[232:235], v[192:195]
    v_mfma_f32_16x16x32_bf16 v[196:199], v[32:35], v[232:235], v[196:199]
    s_cmp_eq_u32 s48, 6
    s_cbranch_scc1 B_w6
    s_waitcnt vmcnt(0)
B_w6:
    s_waitcnt lgkmcnt(1)
    v_mfma_f32_16x16x32_bf16 v[184:187], v[36:39], v[236:239], v[184:187]
    v_mfma_f32_16x16x32_bf16 v[188:191], v[40:43], v[236:239], v[188:191]
    v_mfma_f32_16x16x32_bf16 v[192:195], v[44:47], v[236:239], v[192:195]
    v_mfma_f32_16x16x32_bf16 v[196:199], v[48:51], v[236:239], v[196:199]
    s_lshl_b32 s61, s56, 12
    s_add_u32 s61, s61, 135168
    v_add_u32 v16, s61, v202
    s_lshl_b32 s61, s56, 2
    s_add_u32 s61, s61, 160760
    v_mov_b32 v18, s61
    s_cmp_eq_u32 s101, 0
    s_cbranch_scc1 B_rx0
B_pf:
    ds_read_b32 v19, v18
    s_waitcnt lgkmcnt(0)
    v_cmp_eq_u32 vcc, 0, v19
    s_cbranch_vccz B_pg
    s_sleep 1
    s_sub_u32 s3, s3, 1
    s_cbranch_scc0 B_pf
    s_mov_b32 s3, 0
B_pg:
    ds_write_b128 v16, v[184:187] offset:0
    ds_write_b128 v16, v[188:191] offset:1024
    ds_write_b128 v16, v[192:195] offset:2048
    ds_write_b128 v16, v[196:199] offset:3072
    v_mov_b32 v19, 2
    s_waitcnt lgkmcnt(0)
    ds_write_b32 v18, v19
    s_branch L_fin
B_rx0:
B_rx:
    ds_read_b32 v19, v18
    s_waitcnt lgkmcnt(0)
    v_cmp_ne_u32 vcc, 2, v19
    s_cbranch_vccz B_rd
    s_sub_u32 s3, s3, 1
    s_cbranch_scc0 B_rx
    s_mov_b32 s3, 0
B_rd:
    ds_read_b32 v10, v251 offset:4
    ds_read_b128 v[100:103], v16 offset:0
    ds_read_b128 v[104:107], v16 offset:1024
    ds_read_b128 v[108:111], v16 offset:2048
    ds_read_b128 v[112:115], v16 offset:3072
    s_waitcnt lgkmcnt(0)
    v_add_f32 v184, v184, v100
    v_add_f32 v185, v185, v101
    v_add_f32 v186, v186, v102
    v_add_f32 v187, v187, v103
    v_add_f32 v188, v188, v104
    v_add_f32 v189, v189, v105
    v_add_f32 v190, v190, v106
    v_add_f32 v191, v191, v107
    v_add_f32 v192, v192, v108
    v_add_f32 v193, v193, v109
    v_add_f32 v194, v194, v110
    v_add_f32 v195, v195, v111
    v_add_f32 v196, v196, v112
    v_add_f32 v197, v197, v113
    v_add_f32 v198, v198, v114
    v_add_f32 v199, v199, v115
B_epi:
    s_waitcnt lgkmcnt(0)
    v_cmp_eq_u32 vcc, 0, v10
    v_and_b32 v10, 0xfff, v10
    s_cbranch_vccnz B_ew
B_eg:
    v_cmp_eq_u32 s[68:69], v10, v226
    v_add_u32 v10, s54, v10
    v_mov_b32 v16, 0x3f803f80
    v_mov_b32 v15, s54
    s_add_u32 s63, s1, 20480
    s_lshl_b32 s64, s51, 8
    s_add_u32 s64, s64, s63
    v_cvt_pk_bf16_f32 v52, v184, v185
    v_cvt_pk_bf16_f32 v53, v186, v187
    v_cvt_pk_bf16_f32 v54, v188, v189
    v_cvt_pk_bf16_f32 v55, v190, v191
    v_cvt_pk_bf16_f32 v56, v192, v193
    v_cvt_pk_bf16_f32 v57, v194, v195
    v_cvt_pk_bf16_f32 v58, v196, v197
    v_cvt_pk_bf16_f32 v59, v198, v199
    s_cmp_eq_u64 s[68:69], 0
    s_cbranch_scc1 B_np2
    s_mov_b64 exec, s[68:69]
    ds_write_b128 v228, v[52:55] offset:0
    ds_write_b128 v228, v[56:59] offset:16
    s_mov_b64 exec, -1
    ds_read_b64 v[8:9], v252
    s_waitcnt lgkmcnt(0)
    buffer_store_dwordx3 v[8:10], v224, s[24:27], s44 offen sc1
B_np2:
    v_mfma_f32_16x16x32_bf16 v[12:15], v[240:243], v[52:55], 0
    v_mfma_f32_16x16x32_bf16 v[12:15], v[244:247], v[56:59], v[12:15]
    v_dot2_f32_bf16 v16, v52, v52, 0
    v_dot2_f32_bf16 v17, v53, v53, 0
    v_dot2_f32_bf16 v16, v54, v54, v16
    v_dot2_f32_bf16 v17, v55, v55, v17
    v_dot2_f32_bf16 v16, v56, v56, v16
    v_dot2_f32_bf16 v17, v57, v57, v17
    v_dot2_f32_bf16 v16, v58, v58, v16
    v_dot2_f32_bf16 v17, v59, v59, v17
    s_nop 2
    v_add_f32 v16, v16, v17
    v_mov_b32 v17, v16
    s_nop 1
    v_permlane32_swap_b32 v16, v17
    v_add_f32 v16, v16, v17
    v_mov_b32 v17, v16
    v_mov_b32 v15, s54
    s_nop 0
    v_permlane16_swap_b32 v16, v17
    v_add_f32 v13, v16, v17
    s_mov_b64 exec, 0xffff
    s_cmp_eq_u32 s49, 0
    s_cbranch_scc1 sts_9
    buffer_store_dwordx4 v[12:15], v202, s[24:27], s64 offen
std_10:
    s_mov_b64 exec, -1
    v_lshlrev_b32 v36, 16, v52
    v_and_b32 v37, s47, v52
    v_lshlrev_b32 v38, 16, v53
    v_and_b32 v39, s47, v53
    v_lshlrev_b32 v40, 16, v54
    v_and_b32 v41, s47, v54
    v_lshlrev_b32 v42, 16, v55
    v_and_b32 v43, s47, v55
    v_lshlrev_b32 v44, 16, v56
    v_and_b32 v45, s47, v56
    v_lshlrev_b32 v46, 16, v57
    v_and_b32 v47, s47, v57
    v_lshlrev_b32 v48, 16, v58
    v_and_b32 v49, s47, v58
    v_lshlrev_b32 v50, 16, v59
    v_and_b32 v51, s47, v59
    v_mov_b32 v108, 0
    v_mov_b32 v109, 0
    v_mov_b32 v110, 0
    v_mov_b32 v111, s54
    v_mov_b32 v11, s54
    v_lshlrev_b32 v7, 11, v200
    s_add_u32 s45, s45, 32768
    s_sub_u32 s44, s44, 131072
    buffer_load_dwordx4 v[100:103], v202, s[24:27], s63 offen offset:0 sc1
    buffer_load_dwordx4 v[104:107], v202, s[24:27], s63 offen offset:1024 sc1
    s_mov_b32 exec_hi, 0
    buffer_load_dwordx4 v[108:111], v202, s[24:27], s63 offen offset:2048 sc1
    s_mov_b32 exec_hi, -1
    s_branch S_pw
S_poll:
    s_mov_b64 exec, s[58:59]
    s_cbranch_execz S_r0
    buffer_load_dwordx4 v[100:103], v202, s[24:27], s63 offen offset:0 sc1
S_r0:
    s_mov_b64 exec, s[64:65]
    s_cbranch_execz S_r1
    buffer_load_dwordx4 v[104:107], v202, s[24:27], s63 offen offset:1024 sc1
S_r1:
    s_mov_b64 exec, s[66:67]
    s_cbranch_execz S_r2
    buffer_load_dwordx4 v[108:111], v202, s[24:27], s63 offen offset:2048 sc1
S_r2:
    s_mov_b64 exec, -1
S_pw:
    s_waitcnt vmcnt(0)
    v_cmp_ne_u32 s[58:59], s54, v103
    v_cmp_ne_u32 s[64:65], s54, v107
    v_cmp_ne_u32 s[66:67], s54, v111
    s_or_b64 vcc, s[58:59], s[64:65]
    s_or_b64 vcc, vcc, s[66:67]
    s_cbranch_scc0 S_got
    s_sub_u32 s3, s3, 1
    s_cbranch_scc0 S_poll
    s_mov_b32 s3, 0
S_got:
    v_add_f32 v12, v100, v104
    v_add_f32 v13, v101, v105
    v_add_f32 v14, v102, v106
    v_add_f32 v12, v12, v108
    v_add_f32 v13, v13, v109
    v_add_f32 v14, v14, v110
    v_mov_b32 v17, v12
    v_mov_b32 v18, v13
    v_mov_b32 v19, v14
    v_permlane32_swap_b32 v17, v12
    v_permlane32_swap_b32 v18, v13
    v_permlane32_swap_b32 v19, v14
    v_add_f32 v12, v12, v17
    v_add_f32 v13, v13, v18
    v_add_f32 v14, v14, v19
    v_mov_b32 v17, v12
    v_mov_b32 v18, v13
    v_mov_b32 v19, v14
    v_permlane16_swap_b32 v17, v12
    v_permlane16_swap_b32 v18, v13
    v_permlane16_swap_b32 v19, v14
    v_add_f32 v12, v12, v17
    v_add_f32 v13, v13, v18
    v_add_f32 v14, v14, v19
    v_mul_f32 v12, 0x3acccccd, v12
    v_mul_f32 v13, 0x3acccccd, v13
    v_fma_f32 v13, -v12, v12, v13
    v_max_f32 v13, 0, v13
    v_cvt_pk_bf16_f32 v13, v13, v13
    v_and_b32 v13, 0xffff0000, v13
    v_add_f32 v13, 0x3727c5ac, v13
    v_cvt_pk_bf16_f32 v13, v13, v13
    v_and_b32 v13, 0xffff0000, v13
    v_sqrt_f32 v13, v13
    v_cvt_pk_bf16_f32 v12, v12, v12
    v_and_b32 v12, 0xffff0000, v12
    v_cvt_pk_bf16_f32 v13, v13, v13
    v_and_b32 v13, 0xffff0000, v13
    v_rcp_f32 v13, v13
    v_fma_f32 v14, -v12, v248, v14
    v_mul_f32 v14, v14, v13
    v_ashrrev_i32 v6, 31, v14
    v_or_b32 v6, 0x80000000, v6
    v_xor_b32 v6, v6, v14
    v_and_b32 v6, 0xfffff000, v6
    v_or_b32 v6, v6, v226
    s_and_b64 exec, s[4:5], 0xffff
    ds_max_u32 v251, v6 offset:12
    s_mov_b64 exec, -1
    s_and_b64 s[68:69], s[68:69], s[4:5]
    s_cbranch_scc0 S_ne
    s_call_b64 s[98:99], S_ln
    s_mov_b64 exec, s[68:69]
    buffer_store_dwordx4 v[60:63], v225, s[40:43], 0 offen offset:0 sc1
    buffer_store_dwordx4 v[64:67], v225, s[40:43], 0 offen offset:64 sc1
    s_mov_b64 exec, -1
S_ne:
    s_waitcnt lgkmcnt(0)
    s_barrier
    ds_read_b32 v10, v251 offset:12
    s_or_b32 s64, s51, s48
    s_waitcnt lgkmcnt(0)
    s_cbranch_scc1 S_nc
    s_mov_b64 exec, 0xffff
    buffer_store_dwordx2 v[10:11], v7, s[24:27], s45 offen sc1
    s_mov_b64 exec, -1
S_nc:
    v_cmp_eq_u32 s[60:61], v10, v6
    s_cmp_lg_u64 s[68:69], 0
    s_cbranch_scc1 S_l2
    s_call_b64 s[98:99], S_ln
S_l2:
    s_and_b64 s[60:61], s[60:61], s[4:5]
    s_cbranch_scc0 S_out
    s_andn2_b64 exec, s[60:61], s[68:69]
    s_cbranch_execz S_l3
    buffer_store_dwordx4 v[60:63], v225, s[40:43], 0 offen offset:0 sc1
    buffer_store_dwordx4 v[64:67], v225, s[40:43], 0 offen offset:64 sc1
S_l3:
    s_mov_b64 exec, s[60:61]
    ds_write_b128 v228, v[52:55] offset:0
    ds_write_b128 v228, v[56:59] offset:16
    s_mov_b64 exec, -1
    ds_read_b64 v[8:9], v252
    v_and_b32 v10, 0xfff, v10
    v_add_u32 v10, s54, v10
    s_mov_b64 exec, 0xffff
    s_waitcnt vmcnt(0) lgkmcnt(0)
    buffer_store_dwordx3 v[8:10], v224, s[24:27], s44 offen sc1
S_out:
    s_nor_b64 exec, s[60:61], s[68:69]
    buffer_store_dwordx4 v[60:63], v225, s[40:43], 0 offen offset:0 sc1
    buffer_store_dwordx4 v[64:67], v225, s[40:43], 0 offen offset:64 sc1
    s_mov_b64 exec, -1
    s_branch L_fin
S_ln:
    v_pk_add_f32 v[20:21], v[36:37], v[12:13] op_sel_hi:[1,0] neg_lo:[0,1] neg_hi:[0,1]
    v_pk_add_f32 v[22:23], v[38:39], v[12:13] op_sel_hi:[1,0] neg_lo:[0,1] neg_hi:[0,1]
    v_pk_add_f32 v[24:25], v[40:41], v[12:13] op_sel_hi:[1,0] neg_lo:[0,1] neg_hi:[0,1]
    v_pk_add_f32 v[26:27], v[42:43], v[12:13] op_sel_hi:[1,0] neg_lo:[0,1] neg_hi:[0,1]
    v_pk_add_f32 v[28:29], v[44:45], v[12:13] op_sel_hi:[1,0] neg_lo:[0,1] neg_hi:[0,1]
    v_pk_add_f32 v[30:31], v[46:47], v[12:13] op_sel_hi:[1,0] neg_lo:[0,1] neg_hi:[0,1]
    v_pk_add_f32 v[32:33], v[48:49], v[12:13] op_sel_hi:[1,0] neg_lo:[0,1] neg_hi:[0,1]
    v_pk_add_f32 v[34:35], v[50:51], v[12:13] op_sel_hi:[1,0] neg_lo:[0,1] neg_hi:[0,1]
    v_cvt_pk_bf16_f32 v60, v20, v21
    v_cvt_pk_bf16_f32 v61, v22, v23
    v_cvt_pk_bf16_f32 v62, v24, v25
    v_cvt_pk_bf16_f32 v63, v26, v27
    v_cvt_pk_bf16_f32 v64, v28, v29
    v_cvt_pk_bf16_f32 v65, v30, v31
    v_cvt_pk_bf16_f32 v66, v32, v33
    v_cvt_pk_bf16_f32 v67, v34, v35
    v_lshlrev_b32 v20, 16, v60
    v_and_b32 v21, s47, v60
    v_lshlrev_b32 v22, 16, v61
    v_and_b32 v23, s47, v61
    v_lshlrev_b32 v24, 16, v62
    v_and_b32 v25, s47, v62
    v_lshlrev_b32 v26, 16, v63
    v_and_b32 v27, s47, v63
    v_lshlrev_b32 v28, 16, v64
    v_and_b32 v29, s47, v64
    v_lshlrev_b32 v30, 16, v65
    v_and_b32 v31, s47, v65
    v_lshlrev_b32 v32, 16, v66
    v_and_b32 v33, s47, v66
    v_lshlrev_b32 v34, 16, v67
    v_and_b32 v35, s47, v67
    v_pk_mul_f32 v[20:21], v[20:21], v[12:13] op_sel:[0,1]
    v_pk_mul_f32 v[22:23], v[22:23], v[12:13] op_sel:[0,1]
    v_pk_mul_f32 v[24:25], v[24:25], v[12:13] op_sel:[0,1]
    v_pk_mul_f32 v[26:27], v[26:27], v[12:13] op_sel:[0,1]
    v_pk_mul_f32 v[28:29], v[28:29], v[12:13] op_sel:[0,1]
    v_pk_mul_f32 v[30:31], v[30:31], v[12:13] op_sel:[0,1]
    v_pk_mul_f32 v[32:33], v[32:33], v[12:13] op_sel:[0,1]
    v_pk_mul_f32 v[34:35], v[34:35], v[12:13] op_sel:[0,1]
    v_cvt_pk_bf16_f32 v60, v20, v21
    v_cvt_pk_bf16_f32 v61, v22, v23
    v_cvt_pk_bf16_f32 v62, v24, v25
    v_cvt_pk_bf16_f32 v63, v26, v27
    v_cvt_pk_bf16_f32 v64, v28, v29
    v_cvt_pk_bf16_f32 v65, v30, v31
    v_cvt_pk_bf16_f32 v66, v32, v33
    v_cvt_pk_bf16_f32 v67, v34, v35
    v_lshlrev_b32 v20, 16, v60
    v_and_b32 v21, s47, v60
    v_lshlrev_b32 v22, 16, v61
    v_and_b32 v23, s47, v61
    v_lshlrev_b32 v24, 16, v62
    v_and_b32 v25, s47, v62
    v_lshlrev_b32 v26, 16, v63
    v_and_b32 v27, s47, v63
    v_lshlrev_b32 v28, 16, v64
    v_and_b32 v29, s47, v64
    v_lshlrev_b32 v30, 16, v65
    v_and_b32 v31, s47, v65
    v_lshlrev_b32 v32, 16, v66
    v_and_b32 v33, s47, v66
    v_lshlrev_b32 v34, 16, v67
    v_and_b32 v35, s47, v67
    v_pk_add_f32 v[20:21], v[20:21], v[36:37]
    v_pk_add_f32 v[22:23], v[22:23], v[38:39]
    v_pk_add_f32 v[24:25], v[24:25], v[40:41]
    v_pk_add_f32 v[26:27], v[26:27], v[42:43]
    v_pk_add_f32 v[28:29], v[28:29], v[44:45]
    v_pk_add_f32 v[30:31], v[30:31], v[46:47]
    v_pk_add_f32 v[32:33], v[32:33], v[48:49]
    v_pk_add_f32 v[34:35], v[34:35], v[50:51]
    v_cvt_pk_bf16_f32 v60, v20, v21
    v_cvt_pk_bf16_f32 v61, v22, v23
    v_cvt_pk_bf16_f32 v62, v24, v25
    v_cvt_pk_bf16_f32 v63, v26, v27
    v_cvt_pk_bf16_f32 v64, v28, v29
    v_cvt_pk_bf16_f32 v65, v30, v31
    v_cvt_pk_bf16_f32 v66, v32, v33
    v_cvt_pk_bf16_f32 v67, v34, v35
    v_permlane16_swap_b32 v60, v62
    v_permlane16_swap_b32 v61, v63
    v_permlane16_swap_b32 v64, v66
    v_permlane16_swap_b32 v65, v67
    s_setpc_b64 s[98:99]
L_fin:
L_end:
    s_endpgm
AT_mask:
    v_mov_b32 v17, 0xf149f2ca
    v_cmp_le_i32 vcc, 8, v212
    s_nop 1
    v_cndmask_b32 v60, v17, v60, vcc
    v_cmp_le_i32 vcc, 7, v212
    s_nop 1
    v_cndmask_b32 v61, v17, v61, vcc
    v_cmp_le_i32 vcc, 6, v212
    s_nop 1
    v_cndmask_b32 v62, v17, v62, vcc
    v_cmp_le_i32 vcc, 5, v212
    s_nop 1
    v_cndmask_b32 v63, v17, v63, vcc
    v_cmp_le_i32 vcc, 4, v212
    s_nop 1
    v_cndmask_b32 v64, v17, v64, vcc
    v_cmp_le_i32 vcc, 3, v212
    s_nop 1
    v_cndmask_b32 v65, v17, v65, vcc
    v_cmp_le_i32 vcc, 2, v212
    s_nop 1
    v_cndmask_b32 v66, v17, v66, vcc
    v_cmp_le_i32 vcc, 1, v212
    s_nop 1
    v_cndmask_b32 v67, v17, v67, vcc
    v_cmp_le_i32 vcc, 0, v212
    s_nop 1
    v_cndmask_b32 v68, v17, v68, vcc
    v_cmp_le_i32 vcc, -1, v212
    s_nop 1
    v_cndmask_b32 v69, v17, v69, vcc
    v_cmp_le_i32 vcc, -2, v212
    s_nop 1
    v_cndmask_b32 v70, v17, v70, vcc
    v_cmp_le_i32 vcc, -3, v212
    s_nop 1
    v_cndmask_b32 v71, v17, v71, vcc
    s_branch AT_nomask
sts_1:
    buffer_store_dwordx4 v[80:83], v213, s[24:27], s12 offen offset:0 sc1
    buffer_store_dwordx4 v[84:87], v213, s[24:27], s12 offen offset:512 sc1
    s_branch std_2
AT_vs:
    ds_read_b32 v17, v251 offset:8
    s_sub_u32 s3, s3, 1
    s_cbranch_scc0 AT_vc
    s_mov_b32 s3, 0
    s_branch AT_vg
sts_3:
    buffer_store_dwordx4 v[204:207], v249, s[24:27], s22 offen offset:0 sc1
    buffer_store_dwordx4 v[208:211], v249, s[24:27], s22 offen offset:1024 sc1
    s_branch std_4
sts_5:
    buffer_store_short_d16_hi v20, v164, s[24:27], s65 offen sc1
    s_branch std_6
sts_7:
    buffer_store_dword v79, v203, s[24:27], s23 offen sc1
    s_branch std_8
B_ew:
    s_sleep 1
    ds_read_b32 v10, v251 offset:4
    s_sub_u32 s3, s3, 1
    s_cbranch_scc0 B_epi
    s_mov_b32 s3, 0
    s_waitcnt lgkmcnt(0)
    s_branch B_eg
sts_9:
    buffer_store_dwordx4 v[12:15], v202, s[24:27], s64 offen sc1
    s_branch std_10
LD_cont:
    v_and_b32 v0, 63, v0
    s_mov_b32 s3, 0x40000
    s_mov_b32 s47, 0xffff0000
    s_mov_b32 s26, 7340032
    s_mov_b32 s27, 0x00020000
    s_mov_b32 s38, 819200
    s_mov_b32 s39, 0x00020000
    s_mov_b32 s42, 2621440
    s_mov_b32 s43, 0x00020000
    s_sub_u32 s52, s51, 5
    s_cselect_b32 s52, s51, s52
    s_buffer_load_dword s54, s[24:27], 0
    v_lshl_add_u32 v4, s60, 3, v1
    v_mul_u32_u24 v5, 1280, v4
    v_lshlrev_b32 v7, 1, v2
    v_bitop3_b32 v7, v0, 7, v7 bitop3:0x6a
    v_lshl_add_u32 v5, v7, 4, v5
    v_lshl_add_u32 v16, s51, 7, v5
    s_lshl_b32 s46, s53, 11
    s_add_u32 s46, s46, 81920
    s_mul_i32 s62, s60, 24
    v_add_u32 v17, s62, v0
    v_lshlrev_b32 v18, 4, v17
    v_cmp_gt_u32 vcc, 24, v0
    v_add_u32 v19, 72, v0
    v_lshlrev_b32 v19, 4, v19
    v_cndmask_b32 v18, v19, v18, vcc
    s_lshl_b32 s62, s51, 2
    s_add_u32 s62, s62, s60
    s_lshl_b32 s62, s62, 8
    s_sub_u32 s62, s62, s46
    s_add_u32 s62, s62, 1243488
    v_add_u32 v19, s62, v19
    v_cmp_lt_u32 vcc, 33, v0
    s_nop 1
    v_cndmask_b32 v18, v18, v19, vcc
    v_cmp_lt_u32 vcc, 49, v0
    s_nop 1
    v_cndmask_b32 v18, v18, 2.0, vcc
    v_mov_b32 v28, 0
    v_mov_b32 v29, 0
    v_mov_b32 v30, 0
    v_mov_b32 v31, 0
    s_lshl_b32 s62, s60, 6
    v_add_u32 v4, s62, v0
    v_lshlrev_b32 v35, 4, v4
    v_add_u32 v35, 135168, v35
    ds_write_b128 v35, v[28:31] offset:0
    ds_write_b128 v35, v[28:31] offset:4096
    ds_write_b128 v35, v[28:31] offset:8192
    ds_write_b128 v35, v[28:31] offset:12288
    ds_write_b128 v35, v[28:31] offset:16384
    ds_write_b128 v35, v[28:31] offset:20480
    v_lshrrev_b32 v5, 1, v4
    v_min_u32 v5, 61, v5
    v_mul_u32_u24 v5, 400, v5
    v_and_b32 v6, 1, v4
    v_lshl_add_u32 v5, v6, 4, v5
    v_add_u32 v5, 110624, v5
    ds_write_b128 v5, v[28:31]
    v_mov_b32 v6, 159776
    ds_write_b64 v6, v[28:29]
    v_and_b32 v4, 31, v0
    v_lshlrev_b32 v5, 7, v4
    s_lshl_b32 s62, s51, 11
    v_add_u32 v6, s62, v5
    s_lshl_b32 s62, s51, 8
    s_add_u32 s62, s62, 17408
    v_add_u32 v7, s62, v5
    v_cmp_lt_u32 vcc, 23, v4
    s_nop 1
    v_cndmask_b32 v6, v6, v7, vcc
    v_and_b32 v7, 128, v5
    v_add_u32 v7, 23040, v7
    v_cmp_lt_u32 vcc, 25, v4
    s_nop 1
    v_cndmask_b32 v6, v6, v7, vcc
    v_lshrrev_b32 v7, 5, v0
    v_mul_u32_u24 v7, 24320, v7
    v_add_u32 v36, v6, v7
    s_mov_b32 vcc_hi, 0xfcff0000
    s_cmp_eq_u32 s60, 0
    s_cselect_b32 vcc_lo, 0xf0ff5555, vcc_hi
    v_cndmask_b32 v36, v36, 2.0, vcc
    s_waitcnt lgkmcnt(0)
    s_add_u32 s54, s54, 2654435761
    s_lshl_b32 s62, s60, 10
    s_add_u32 s62, s62, 36864
    s_add_u32 s63, s51, 3
    s_sub_u32 s61, s63, 10
    s_cselect_b32 s63, s63, s61
    s_mul_i32 s63, s63, 81920
    s_call_b64 s[98:99], S_late
    s_call_b64 s[98:99], S_late2
    s_call_b64 s[98:99], LD_issue
    s_waitcnt vmcnt(9)
    s_barrier
    s_bitcmp0_b32 s60, 0
    s_cselect_b32 s16, s14, s16
    s_cselect_b32 s17, s15, s17
    s_mov_b64 s[14:15], s[18:19]
    s_and_b32 s17, s17, 0xffff
    s_mov_b32 s18, 1966080
    s_mov_b32 s19, 0x00020000
    s_lshr_b32 s58, s60, 1
    s_lshl1_add_u32 s58, s2, s58
    s_mul_i32 s61, s58, 21846
    s_lshr_b32 s61, s61, 16
    s_mul_i32 s67, s61, 3
    s_sub_u32 s58, s58, s67
    s_mul_i32 s61, s61, 3072
    s_lshl_b32 s58, s58, 10
    s_add_u32 s58, s58, s61
    s_cmp_lt_u32 s61, 73728
    s_cselect_b32 s58, 2.0, s58
    s_buffer_load_dword s59, s[16:19], s58 offset:384
    s_buffer_load_dword s59, s[16:19], s58 offset:448
    s_buffer_load_dword s59, s[16:19], s58 offset:491904
    s_buffer_load_dword s59, s[16:19], s58 offset:491968
    s_add_u32 s58, s58, 983040
    s_call_b64 s[98:99], LD_issue
    s_waitcnt vmcnt(9)
    s_barrier
    s_buffer_load_dword s59, s[16:19], s58 offset:384
    s_buffer_load_dword s59, s[16:19], s58 offset:448
    s_buffer_load_dword s59, s[16:19], s58 offset:491904
    s_buffer_load_dword s59, s[16:19], s58 offset:491968
    s_lshl2_add_u32 s58, s53, s60
    s_mul_i32 s61, s58, 86
    s_lshr_b32 s61, s61, 8
    s_mul_i32 s67, s61, 3
    s_sub_u32 s58, s58, s67
    s_mul_i32 s58, s58, 1280
    s_mul_i32 s61, s61, 7680
    s_add_u32 s58, s58, s61
    s_mul_i32 s61, s51, 245888
    s_add_u32 s58, s58, s61
    s_call_b64 s[98:99], LD_issue
    s_waitcnt vmcnt(9)
    s_barrier
    s_buffer_load_dword s59, s[32:35], s58 offset:0
    s_buffer_load_dword s59, s[32:35], s58 offset:64
    s_buffer_load_dword s59, s[32:35], s58 offset:3840
    s_buffer_load_dword s59, s[32:35], s58 offset:3904
    s_mul_i32 s58, s60, 61440
    s_add_u32 s58, s58, s44
    s_call_b64 s[98:99], LD_issue
    s_waitcnt vmcnt(9)
    s_barrier
    s_buffer_load_dword s59, s[24:27], s58 offset:0
    s_buffer_load_dword s59, s[24:27], s58 offset:64
    s_buffer_load_dword s59, s[24:27], s58 offset:128
    s_buffer_load_dword s59, s[24:27], s58 offset:192
    s_lshl_b32 s58, s60, 6
    s_add_u32 s58, s58, s44
    s_sub_u32 s58, s58, 131072
    s_call_b64 s[98:99], LD_issue
    s_waitcnt vmcnt(9)
    s_barrier
    s_buffer_load_dword s59, s[24:27], s58
    s_call_b64 s[98:99], LD_issue
    s_waitcnt vmcnt(9)
    s_barrier
    s_call_b64 s[98:99], LD_issue
    s_waitcnt vmcnt(9)
    s_barrier
    s_call_b64 s[98:99], LD_issue
    s_waitcnt vmcnt(9)
    s_barrier
    buffer_load_dwordx4 v[20:23], v18, s[24:27], s46 offen sc1
    s_mov_b32 s66, s51
    s_movk_i32 s71, 99
    s_call_b64 s[98:99], LD_issue
    s_waitcnt vmcnt(9)
    s_barrier
    v_mov_b32 v24, 163072
    ds_read_b32 v24, v24
    s_mov_b32 m0, s62
    s_add_u32 s62, s62, 4096
    buffer_load_dwordx4 v16, s[36:39], s63 offen lds
    s_add_u32 s63, s63, 40960
    s_mov_b32 m0, s62
    s_add_u32 s62, s62, 4096
    buffer_load_dwordx4 v16, s[36:39], s63 offen lds
    s_add_u32 s63, s63, 40960
    s_cmp_eq_u32 s63, 819200
    s_cselect_b32 s63, 0, s63
    s_mov_b32 m0, s62
    s_add_u32 s62, s62, 4096
    buffer_load_dwordx4 v16, s[36:39], s63 offen lds
    s_add_u32 s63, s63, 40960
    s_mov_b32 m0, s62
    s_add_u32 s62, s62, 4096
    buffer_load_dwordx4 v16, s[36:39], s63 offen lds
    s_add_u32 s63, s63, 40960
    s_cmp_eq_u32 s63, 819200
    s_cselect_b32 s63, 0, s63
    s_mov_b32 m0, s62
    s_add_u32 s62, s62, 4096
    buffer_load_dwordx4 v16, s[36:39], s63 offen lds
    s_add_u32 s63, s63, 40960
    s_mov_b32 m0, s62
    s_add_u32 s62, s62, 4096
    buffer_load_dwordx4 v16, s[36:39], s63 offen lds
    s_add_u32 s63, s63, 40960
    s_cmp_eq_u32 s63, 819200
    s_cselect_b32 s63, 0, s63
    s_mov_b32 m0, s62
    s_add_u32 s62, s62, 4096
    buffer_load_dwordx4 v16, s[36:39], s63 offen lds
    s_add_u32 s63, s63, 40960
    s_mov_b32 exec_hi, 3
    v_cmp_ne_u32 vcc, s54, v22
    s_cbranch_vccz LD_rs
LD_rsp:
    buffer_load_dwordx4 v[20:23], v18, s[24:27], s46 offen sc1
    s_waitcnt vmcnt(0)
    v_cmp_ne_u32 vcc, s54, v22
    s_cbranch_vccz LD_rs
    s_sleep 1
    s_sub_u32 s3, s3, 1
    s_cbranch_scc0 LD_rsp
    s_mov_b32 s3, 0
LD_rs:
    s_getreg_b32 s61, hwreg(HW_REG_XCC_ID)
    v_cmp_ne_u32 vcc, s61, v20
    s_lshr_b64 vcc, vcc, 24
    s_cselect_b32 s49, 0, 1
    s_lshl_b32 s61, s60, 5
    s_add_u32 s61, s61, 160828
    s_mov_b32 exec_hi, 0x3fffc
    s_mov_b32 exec_lo, 0
    v_cmp_eq_u32 vcc, s54, v22
    v_lshl_add_u32 v4, v0, 1, s61
    s_waitcnt lgkmcnt(0)
    v_mul_f32 v24, 0xbacccccd, v24
    v_fmac_f32 v21, v20, v24
    v_cndmask_b32 v21, 0, v21, vcc
    ds_write_b16_d16_hi v4, v21
    s_mov_b32 exec_hi, 0
    s_mov_b32 exec_lo, 0xffffff
    v_lshlrev_b32 v4, 3, v17
    v_add_u32 v4, 159808, v4
    ds_write_b64 v4, v[20:21]
    v_mov_b32 v4, 160768
    v_mov_b32 v5, s49
    ds_write_b32 v4, v5
    ds_write_b64 v4, v[28:29] offset:8
    ds_write_b64 v4, v[28:29] offset:16
    ds_write_b64 v4, v[28:29] offset:24
    ds_write_b64 v4, v[28:29] offset:32
    s_mov_b64 exec, -1
    s_waitcnt vmcnt(7) lgkmcnt(0)
    s_barrier
    s_mov_b32 m0, s62
    s_add_u32 s62, s62, 4096
    buffer_load_dwordx4 v16, s[36:39], s63 offen lds
    s_add_u32 s63, s63, 40960
    s_cmp_eq_u32 s63, 819200
    s_cselect_b32 s63, 0, s63
    s_mov_b32 m0, s62
    s_add_u32 s62, s62, 4096
    buffer_load_dwordx4 v16, s[36:39], s63 offen lds
    s_add_u32 s63, s63, 40960
    s_mov_b32 m0, s62
    s_add_u32 s62, s62, 4096
    buffer_load_dwordx4 v16, s[36:39], s63 offen lds
    s_add_u32 s63, s63, 40960
    s_cmp_eq_u32 s63, 819200
    s_cselect_b32 s63, 0, s63
    s_mov_b32 m0, s62
    s_add_u32 s62, s62, 4096
    buffer_load_dwordx4 v16, s[36:39], s63 offen lds
    s_add_u32 s63, s63, 40960
    s_mov_b32 m0, s62
    s_add_u32 s62, s62, 4096
    buffer_load_dwordx4 v16, s[36:39], s63 offen lds
    s_add_u32 s63, s63, 40960
    s_cmp_eq_u32 s63, 819200
    s_cselect_b32 s63, 0, s63
    s_mov_b32 m0, s62
    s_add_u32 s62, s62, 4096
    buffer_load_dwordx4 v16, s[36:39], s63 offen lds
    s_add_u32 s63, s63, 40960
    s_mov_b32 m0, s62
    s_add_u32 s62, s62, 4096
    buffer_load_dwordx4 v16, s[36:39], s63 offen lds
    s_add_u32 s63, s63, 40960
    s_cmp_eq_u32 s63, 819200
    s_cselect_b32 s63, 0, s63
    s_cmp_eq_u32 s60, 3
    s_cbranch_scc1 pf_11
    s_mul_i32 s67, s53, 6
    s_lshl_b32 s68, s60, 1
    s_add_u32 s67, s67, s68
    s_mul_i32 s67, s67, 24320
    s_add_u32 s67, s67, 1310720
    buffer_load_dword v182, v36, s[24:27], s67 offen sc1
    s_mov_b64 exec, -1
    s_branch pf_12
pf_11:
    v_lshlrev_b32 v4, 7, v0
    s_mov_b64 exec, 7
    buffer_load_dword v182, v4, s[24:27], s57 offen sc1
    s_mov_b64 exec, -1
pf_12:
    s_call_b64 s[98:99], S_late3
    s_call_b64 s[98:99], S_late4
    v_mov_b32 v99, v16
    s_branch AT_start
F_start:
    v_and_b32 v0, 63, v0
    s_mov_b32 s3, 0x40000
    s_mov_b32 s47, 0xffff0000
    s_mov_b32 s26, 7340032
    s_mov_b32 s27, 0x00020000
    s_mov_b32 s38, 819200
    s_mov_b32 s39, 0x00020000
    s_mov_b32 s42, 2621440
    s_mov_b32 s43, 0x00020000
    s_and_b32 s49, s2, 7
    s_lshl_b32 s49, s49, 1
    s_add_u32 s49, s49, s56
    s_sub_u32 s49, s49, 30
    s_and_b32 s50, s48, 1
    s_lshr_b32 s51, s48, 1
    s_mul_i32 s52, s48, 6144
    s_mul_i32 s61, s49, 192
    v_mov_b32 v5, 128
    v_add_u32 v1, 0, v0
    v_mul_u32_u24 v2, 171, v1
    v_lshrrev_b32 v2, 11, v2
    v_mul_u32_u24 v3, 12, v2
    v_sub_u32 v3, v1, v3
    v_mul_u32_u24 v2, 3072, v2
    v_lshl_add_u32 v3, v3, 4, s61
    v_lshrrev_b32 v4, 8, v3
    v_cmp_eq_u32 vcc, 9, v4
    s_nop 1
    v_cndmask_b32 v4, 0, v5, vcc
    v_xad_u32 v210, v3, v4, v2
    v_add_u32 v1, 64, v0
    v_mul_u32_u24 v2, 171, v1
    v_lshrrev_b32 v2, 11, v2
    v_mul_u32_u24 v3, 12, v2
    v_sub_u32 v3, v1, v3
    v_mul_u32_u24 v2, 3072, v2
    v_lshl_add_u32 v3, v3, 4, s61
    v_lshrrev_b32 v4, 8, v3
    v_cmp_eq_u32 vcc, 9, v4
    s_nop 1
    v_cndmask_b32 v4, 0, v5, vcc
    v_xad_u32 v211, v3, v4, v2
    v_add_u32 v1, 128, v0
    v_mul_u32_u24 v2, 171, v1
    v_lshrrev_b32 v2, 11, v2
    v_mul_u32_u24 v3, 12, v2
    v_sub_u32 v3, v1, v3
    v_mul_u32_u24 v2, 3072, v2
    v_lshl_add_u32 v3, v3, 4, s61
    v_lshrrev_b32 v4, 8, v3
    v_cmp_eq_u32 vcc, 9, v4
    s_nop 1
    v_cndmask_b32 v4, 0, v5, vcc
    v_xad_u32 v212, v3, v4, v2
    s_mul_i32 s60, s51, 491520
    s_mov_b32 s30, 1966080
    s_mov_b32 s31, 0x00020000
    s_waitcnt lgkmcnt(0)
    s_cmp_eq_u32 s50, 0
    s_cselect_b32 s28, s14, s16
    s_cselect_b32 s29, s15, s17
    s_add_u32 m0, s52, 0
    s_add_u32 s62, s60, 0
    buffer_load_dwordx4 v210, s[28:31], s62 offen lds
    s_add_u32 m0, s52, 1024
    s_add_u32 s62, s60, 0
    buffer_load_dwordx4 v211, s[28:31], s62 offen lds
    s_add_u32 m0, s52, 2048
    s_add_u32 s62, s60, 0
    buffer_load_dwordx4 v212, s[28:31], s62 offen lds
    s_add_u32 m0, s52, 3072
    s_add_u32 s62, s60, 49152
    buffer_load_dwordx4 v210, s[28:31], s62 offen lds
    s_add_u32 m0, s52, 4096
    s_add_u32 s62, s60, 49152
    buffer_load_dwordx4 v211, s[28:31], s62 offen lds
    s_add_u32 m0, s52, 5120
    s_add_u32 s62, s60, 49152
    buffer_load_dwordx4 v212, s[28:31], s62 offen lds
    s_load_dword s54, s[24:25], 0
    s_mov_b32 s4, s12
    s_and_b32 s5, s13, 0xffff
    s_mov_b32 s6, 1280
    s_mov_b32 s7, 0x00020000
    s_mov_b32 s32, s18
    s_and_b32 s33, s19, 0xffff
    s_mov_b32 s34, 1966080
    s_mov_b32 s35, 0x00020000
    s_cmp_lg_u32 s48, 7
    s_cbranch_scc1 F_ntlb
    s_lshr_b32 s63, 25945, s49
    s_bitcmp0_b32 s63, 0
    s_cbranch_scc1 F_ntlb
    v_lshlrev_b32 v7, 16, v0
    buffer_load_dword v219, v7, s[40:43], 0 offen sc1
    buffer_load_dword v219, v7, s[36:39], 0 offen
    v_lshlrev_b32 v7, 17, v0
    buffer_load_dword v219, v7, s[24:27], 64 offen sc1
F_ntlb:
    s_barrier
    s_add_u32 m0, s52, 49152
    s_add_u32 s62, s60, 98304
    buffer_load_dwordx4 v210, s[28:31], s62 offen lds
    s_add_u32 m0, s52, 50176
    s_add_u32 s62, s60, 98304
    buffer_load_dwordx4 v211, s[28:31], s62 offen lds
    s_add_u32 m0, s52, 51200
    s_add_u32 s62, s60, 98304
    buffer_load_dwordx4 v212, s[28:31], s62 offen lds
    s_add_u32 m0, s52, 52224
    s_add_u32 s62, s60, 147456
    buffer_load_dwordx4 v210, s[28:31], s62 offen lds
    s_add_u32 m0, s52, 53248
    s_add_u32 s62, s60, 147456
    buffer_load_dwordx4 v211, s[28:31], s62 offen lds
    s_add_u32 m0, s52, 54272
    s_add_u32 s62, s60, 147456
    buffer_load_dwordx4 v212, s[28:31], s62 offen lds
    s_mul_i32 s53, s48, 5120
    s_mul_i32 s61, s49, 122880
    s_add_u32 s61, s61, s53
    s_and_b32 s63, s48, 2
    s_lshl_b32 s63, s63, 2
    v_add_u32 v1, 0, v0
    v_mul_u32_u24 v2, 205, v1
    v_lshrrev_b32 v2, 14, v2
    v_lshl_or_b32 v2, v2, 1, s63
    v_xor_b32 v1, v1, v2
    v_lshlrev_b32 v213, 4, v1
    v_add_u32 v1, 64, v0
    v_mul_u32_u24 v2, 205, v1
    v_lshrrev_b32 v2, 14, v2
    v_lshl_or_b32 v2, v2, 1, s63
    v_xor_b32 v1, v1, v2
    v_lshlrev_b32 v214, 4, v1
    v_add_u32 v1, 128, v0
    v_mul_u32_u24 v2, 205, v1
    v_lshrrev_b32 v2, 14, v2
    v_lshl_or_b32 v2, v2, 1, s63
    v_xor_b32 v1, v1, v2
    v_lshlrev_b32 v215, 4, v1
    v_add_u32 v1, 192, v0
    v_mul_u32_u24 v2, 205, v1
    v_lshrrev_b32 v2, 14, v2
    v_lshl_or_b32 v2, v2, 1, s63
    v_xor_b32 v1, v1, v2
    v_lshlrev_b32 v216, 4, v1
    v_add_u32 v1, 256, v0
    v_mul_u32_u24 v2, 205, v1
    v_lshrrev_b32 v2, 14, v2
    v_lshl_or_b32 v2, v2, 1, s63
    v_xor_b32 v1, v1, v2
    v_lshlrev_b32 v217, 4, v1
    v_lshrrev_b32 v2, 4, v0
    v_bfe_u32 v1, v0, 2, 2
    v_lshl_add_u32 v3, v2, 3, v1
    v_and_b32 v4, 3, v0
    v_lshlrev_b32 v4, 3, v4
    v_mul_u32_u24 v5, 192, v3
    s_and_b32 s63, s48, 5
    s_mul_i32 s63, s63, 6144
    s_and_b32 s66, s51, 1
    s_mul_i32 s64, s66, 96
    s_add_u32 s63, s63, s64
    v_add3_u32 v218, v5, v4, s63
    v_and_b32 v6, 1, v2
    v_lshl_or_b32 v6, v6, 2, v1
    v_lshlrev_b32 v6, 5, v6
    v_mul_u32_u24 v3, 1280, v3
    s_mul_i32 s63, s48, 160
    s_add_u32 s64, s63, 0
    v_add_u32 v7, s64, v4
    v_xor_b32 v7, v7, v6
    v_add_u32 v200, v7, v3
    v_add_u32 v205, 98304, v200
    s_add_u32 s64, s63, 32
    v_add_u32 v7, s64, v4
    v_xor_b32 v7, v7, v6
    v_add_u32 v201, v7, v3
    v_add_u32 v206, 98304, v201
    s_add_u32 s64, s63, 64
    v_add_u32 v7, s64, v4
    v_xor_b32 v7, v7, v6
    v_add_u32 v202, v7, v3
    v_add_u32 v207, 98304, v202
    s_add_u32 s64, s63, 96
    v_add_u32 v7, s64, v4
    v_xor_b32 v7, v7, v6
    v_add_u32 v203, v7, v3
    v_add_u32 v208, 98304, v203
    s_add_u32 s64, s63, 128
    v_add_u32 v7, s64, v4
    v_xor_b32 v7, v7, v6
    v_add_u32 v204, v7, v3
    v_add_u32 v209, 98304, v204
    s_waitcnt lgkmcnt(0)
    s_add_u32 s54, s54, 2654435761
    s_mov_b32 s67, 0x3f803f80
    v_mov_b32 v220, s67
    v_mov_b32 v221, s67
    v_mov_b32 v222, s67
    v_mov_b32 v223, s67
    v_mov_b64 v[232:233], 0
    v_mov_b64 v[234:235], 0
    v_mov_b64 v[236:237], 0
    v_mov_b64 v[238:239], 0
    v_mov_b64 v[240:241], 0
    v_mov_b64 v[242:243], 0
    v_lshlrev_b32 v16, 3, v0
    buffer_load_dwordx2 v[10:11], v16, s[4:7], 0 offen offset:0
    buffer_load_dwordx2 v[12:13], v16, s[4:7], 0 offen offset:512
    buffer_load_dwordx2 v[14:15], v16, s[4:7], 0 offen offset:1024
    v_lshlrev_b32 v1, 4, v0
    v_lshlrev_b32 v7, 6, v0
    s_lshl_b32 s15, s49, 11
    s_add_u32 s15, s15, 196608
    s_add_u32 s70, s15, 32768
    s_cmp_eq_u32 s48, 7
    s_cselect_b32 s65, s70, 2.0
    s_mov_b64 exec, 0xffffff
    buffer_load_dword v219, v7, s[24:27], s65 offen sc1
    s_mov_b64 exec, -1
    v_mov_b32 v8, 155648
    v_mov_b32 v224, 0
    v_mov_b32 v225, 0
    v_mov_b32 v226, 0
    v_mov_b32 v227, 0
    ds_write_b128 v8, v[224:227] offset:0
    ds_write_b128 v8, v[224:227] offset:16
    ds_write_b128 v8, v[224:227] offset:32
    ds_write_b128 v8, v[224:227] offset:3648
    ds_write_b128 v8, v[224:227] offset:3664
    ds_write_b128 v8, v[224:227] offset:3776
    ds_write_b128 v8, v[224:227] offset:3792
    s_mul_i32 s65, s48, 1344
    s_add_u32 s45, s65, 16384
    v_lshl_add_u32 v16, v0, 2, s45
    v_and_b32 v19, 15, v0
    v_bfe_u32 v5, v0, 1, 1
    v_mov_b32 v6, 0x44444444
    v_mov_b32 v9, 0xeeeeeeee
    v_cmp_eq_u32 vcc, 1, v5
    s_nop 1
    v_cndmask_b32 v252, v6, v9, vcc
    v_lshlrev_b32 v6, 4, v2
    v_lshl_add_u32 v6, v5, 7, v6
    v_add_u32 v6, v6, v8
    v_bfe_u32 v3, v0, 2, 2
    v_and_b32 v4, 1, v0
    v_lshl_add_u32 v3, v3, 1, v4
    v_mul_u32_u24 v9, 1344, v3
    v_mul_u32_u24 v5, 672, v5
    v_add_u32 v9, v9, v5
    v_lshrrev_b32 v3, 1, v2
    v_mul_u32_u24 v3, 160, v3
    v_and_b32 v4, 1, v2
    v_lshl_add_u32 v3, v4, 4, v3
    s_lshr_b32 s65, s48, 2
    s_mul_i32 s63, s65, 320
    v_add3_u32 v9, v9, v3, s63
    s_lshl1_add_u32 s65, s65, s50
    s_mul_i32 s65, s65, 768
    s_mul_i32 s66, s66, 384
    s_add_u32 s65, s65, s66
    v_lshl_add_u32 v3, v19, 3, s65
    v_add_u32 v230, 155904, v3
    v_mul_u32_u24 v4, 3328, v2
    v_add_u32 v3, v3, v4
    s_mul_i32 s65, s48, 48
    v_add_u32 v4, s65, v0
    v_bfe_u32 v5, v4, 1, 1
    v_lshlrev_b32 v5, 7, v5
    v_and_b32 v17, 1, v4
    v_lshl_add_u32 v5, v17, 1, v5
    v_and_b32 v17, 0xfc, v4
    v_add_u32 v5, v5, v17
    v_lshrrev_b32 v17, 6, v4
    v_lshl_add_u32 v5, v17, 5, v5
    v_add_u32 v5, v5, v8
    v_lshlrev_b32 v4, 3, v4
    v_and_b32 v17, 7, v0
    v_lshlrev_b32 v18, 4, v17
    v_lshl_add_u32 v18, v2, 11, v18
    v_lshrrev_b32 v19, 3, v19
    v_lshl_add_u32 v229, v19, 12, v18
    s_lshl_b32 s8, s48, 13
    s_lshl_b32 s65, s49, 7
    s_add_u32 s8, s8, s65
    s_add_u32 s8, s8, 16384
    s_sub_u32 s44, s48, 2
    s_lshl_b32 s14, s49, 12
    s_lshl_b32 s65, s44, 11
    s_add_u32 s14, s14, s65
    s_add_u32 s14, s14, 16384
    s_lshr_b32 s65, s49, 1
    s_lshl_b32 s65, s65, 6
    s_lshl3_add_u32 s65, s49, s65
    s_and_b32 s66, s44, 1
    s_movk_i32 s19, 0xff
    s_cselect_b32 s18, s19, 0x00ff00ff
    s_mul_i32 s66, s66, 48
    s_add_u32 s65, s65, s66
    v_and_b32 v18, 1, v2
    v_lshrrev_b32 v19, 1, v2
    v_lshl_or_b32 v18, v18, 1, v19
    v_min_u32 v18, 2, v18
    v_lshl_add_u32 v18, v18, 4, v17
    v_add_u32 v18, s65, v18
    v_bfe_u32 v19, v18, 1, 1
    v_mul_u32_u24 v19, 672, v19
    v_and_b32 v17, 1, v18
    v_lshl_add_u32 v19, v17, 1, v19
    v_and_b32 v17, 0xffc, v18
    v_add_u32 v19, v19, v17
    v_lshlrev_b32 v18, 1, v18
    v_mov_b32 v17, v229
    s_sub_u32 s65, s54, 1
    v_mov_b32 v227, s65
    s_mov_b32 exec_hi, 0
    buffer_store_dwordx4 v[224:227], v17, s[24:27], s8 offen sc1
    s_mov_b32 exec_hi, -1
    s_lshr_b32 s68, s48, 1
    s_mul_i32 s68, s68, 3328
    s_lshl2_add_u32 s68, s50, s68
    s_lshr_b32 s16, s49, 2
    s_mul_i32 s16, s16, 61440
    s_add_u32 s16, s16, 262144
    s_mov_b32 s17, 0
    s_mov_b32 s20, 16
    v_add_u32 v228, 155904, v4
    s_lshl_b32 s65, s48, 2
    v_add_u32 v231, s65, v8
    s_mov_b64 exec, 0
    s_cmp_eq_u32 s48, 0
    s_cbranch_scc1 HF0_0
    s_cmp_eq_u32 s48, 1
    s_cbranch_scc1 HF1_0
    s_cmp_eq_u32 s48, 2
    s_cbranch_scc1 HF2_0
    s_cmp_eq_u32 s48, 3
    s_cbranch_scc1 HF3_0
    s_cmp_eq_u32 s48, 4
    s_cbranch_scc1 HF4_0
    s_cmp_eq_u32 s48, 5
    s_cbranch_scc1 HF5_0
HF_ret:
    s_mov_b64 exec, -1
    s_add_u32 m0, s52, 98304
    s_add_u32 s62, s60, 196608
    buffer_load_dwordx4 v210, s[28:31], s62 offen lds
    s_add_u32 m0, s52, 99328
    s_add_u32 s62, s60, 196608
    buffer_load_dwordx4 v211, s[28:31], s62 offen lds
    s_add_u32 m0, s52, 100352
    s_add_u32 s62, s60, 196608
    buffer_load_dwordx4 v212, s[28:31], s62 offen lds
    s_add_u32 m0, s52, 101376
    s_add_u32 s62, s60, 245760
    buffer_load_dwordx4 v210, s[28:31], s62 offen lds
    s_add_u32 m0, s52, 102400
    s_add_u32 s62, s60, 245760
    buffer_load_dwordx4 v211, s[28:31], s62 offen lds
    s_add_u32 m0, s52, 103424
    s_add_u32 s62, s60, 245760
    buffer_load_dwordx4 v212, s[28:31], s62 offen lds
    s_waitcnt vmcnt(17)
    s_barrier
    ds_read_b64_tr_b16 v[20:21], v218 offset:0
    ds_read_b64_tr_b16 v[22:23], v218 offset:768
    ds_read_b64_tr_b16 v[24:25], v218 offset:12288
    ds_read_b64_tr_b16 v[26:27], v218 offset:13056
    ds_read_b64_tr_b16 v[28:29], v218 offset:32
    ds_read_b64_tr_b16 v[30:31], v218 offset:800
    ds_read_b64_tr_b16 v[32:33], v218 offset:12320
    ds_read_b64_tr_b16 v[34:35], v218 offset:13088
    ds_read_b64_tr_b16 v[36:37], v218 offset:64
    ds_read_b64_tr_b16 v[38:39], v218 offset:832
    ds_read_b64_tr_b16 v[40:41], v218 offset:12352
    ds_read_b64_tr_b16 v[42:43], v218 offset:13120
    s_waitcnt lgkmcnt(0)
    s_barrier
    s_add_u32 m0, s52, 0
    s_add_u32 s62, s60, 294912
    buffer_load_dwordx4 v210, s[28:31], s62 offen lds
    s_add_u32 m0, s52, 1024
    s_add_u32 s62, s60, 294912
    buffer_load_dwordx4 v211, s[28:31], s62 offen lds
    s_add_u32 m0, s52, 2048
    s_add_u32 s62, s60, 294912
    buffer_load_dwordx4 v212, s[28:31], s62 offen lds
    s_add_u32 m0, s52, 3072
    s_add_u32 s62, s60, 344064
    buffer_load_dwordx4 v210, s[28:31], s62 offen lds
    s_add_u32 m0, s52, 4096
    s_add_u32 s62, s60, 344064
    buffer_load_dwordx4 v211, s[28:31], s62 offen lds
    s_add_u32 m0, s52, 5120
    s_add_u32 s62, s60, 344064
    buffer_load_dwordx4 v212, s[28:31], s62 offen lds
    v_smfmac_f32_16x16x64_bf16 v[232:235], v[220:223], v[20:27], v252
    v_smfmac_f32_16x16x64_bf16 v[236:239], v[220:223], v[28:35], v252
    v_smfmac_f32_16x16x64_bf16 v[240:243], v[220:223], v[36:43], v252
    s_waitcnt vmcnt(17)
    s_barrier
    ds_read_b64_tr_b16 v[44:45], v218 offset:49152
    ds_read_b64_tr_b16 v[46:47], v218 offset:49920
    ds_read_b64_tr_b16 v[48:49], v218 offset:61440
    ds_read_b64_tr_b16 v[50:51], v218 offset:62208
    ds_read_b64_tr_b16 v[52:53], v218 offset:49184
    ds_read_b64_tr_b16 v[54:55], v218 offset:49952
    ds_read_b64_tr_b16 v[56:57], v218 offset:61472
    ds_read_b64_tr_b16 v[58:59], v218 offset:62240
    ds_read_b64_tr_b16 v[60:61], v218 offset:49216
    ds_read_b64_tr_b16 v[62:63], v218 offset:49984
    ds_read_b64_tr_b16 v[64:65], v218 offset:61504
    ds_read_b64_tr_b16 v[66:67], v218 offset:62272
    s_waitcnt lgkmcnt(0)
    s_barrier
    s_add_u32 m0, s52, 49152
    s_add_u32 s62, s60, 393216
    buffer_load_dwordx4 v210, s[28:31], s62 offen lds
    s_add_u32 m0, s52, 50176
    s_add_u32 s62, s60, 393216
    buffer_load_dwordx4 v211, s[28:31], s62 offen lds
    s_add_u32 m0, s52, 51200
    s_add_u32 s62, s60, 393216
    buffer_load_dwordx4 v212, s[28:31], s62 offen lds
    s_add_u32 m0, s52, 52224
    s_add_u32 s62, s60, 442368
    buffer_load_dwordx4 v210, s[28:31], s62 offen lds
    s_add_u32 m0, s52, 53248
    s_add_u32 s62, s60, 442368
    buffer_load_dwordx4 v211, s[28:31], s62 offen lds
    s_add_u32 m0, s52, 54272
    s_add_u32 s62, s60, 442368
    buffer_load_dwordx4 v212, s[28:31], s62 offen lds
    v_smfmac_f32_16x16x64_bf16 v[232:235], v[220:223], v[44:51], v252
    v_smfmac_f32_16x16x64_bf16 v[236:239], v[220:223], v[52:59], v252
    v_smfmac_f32_16x16x64_bf16 v[240:243], v[220:223], v[60:67], v252
    s_waitcnt vmcnt(12)
    s_barrier
    v_add_u32 v229, 98304, v218
    ds_read_b64_tr_b16 v[68:69], v229 offset:0
    ds_read_b64_tr_b16 v[70:71], v229 offset:768
    ds_read_b64_tr_b16 v[72:73], v229 offset:12288
    ds_read_b64_tr_b16 v[74:75], v229 offset:13056
    ds_read_b64_tr_b16 v[76:77], v229 offset:32
    ds_read_b64_tr_b16 v[78:79], v229 offset:800
    ds_read_b64_tr_b16 v[80:81], v229 offset:12320
    ds_read_b64_tr_b16 v[82:83], v229 offset:13088
    ds_read_b64_tr_b16 v[84:85], v229 offset:64
    ds_read_b64_tr_b16 v[86:87], v229 offset:832
    ds_read_b64_tr_b16 v[88:89], v229 offset:12352
    ds_read_b64_tr_b16 v[90:91], v229 offset:13120
    s_waitcnt lgkmcnt(0)
    s_barrier
    s_mul_i32 s62, s49, 3
    s_add_u32 s62, s62, 0
    s_lshr_b32 s63, s62, 2
    s_cmp_eq_u32 s63, 9
    s_cselect_b32 s63, 2, 0
    s_xor_b32 s62, s62, s63
    s_mul_i32 s62, s62, 40960
    s_add_u32 s62, s62, s53
    s_add_u32 m0, s53, 98304
    s_nop 0
    buffer_load_dwordx4 v213, s[32:35], s62 offen lds
    s_add_u32 m0, s53, 99328
    s_nop 0
    buffer_load_dwordx4 v214, s[32:35], s62 offen lds
    s_add_u32 m0, s53, 100352
    s_nop 0
    buffer_load_dwordx4 v215, s[32:35], s62 offen lds
    s_add_u32 m0, s53, 101376
    s_nop 0
    buffer_load_dwordx4 v216, s[32:35], s62 offen lds
    s_add_u32 m0, s53, 102400
    s_nop 0
    buffer_load_dwordx4 v217, s[32:35], s62 offen lds
    v_smfmac_f32_16x16x64_bf16 v[232:235], v[220:223], v[68:75], v252
    v_smfmac_f32_16x16x64_bf16 v[236:239], v[220:223], v[76:83], v252
    v_smfmac_f32_16x16x64_bf16 v[240:243], v[220:223], v[84:91], v252
    v_dot2_f32_bf16 v226, v10, s67, 0
    v_dot2_f32_bf16 v226, v11, s67, v226
    v_dot2_f32_bf16 v226, v12, s67, v226
    v_dot2_f32_bf16 v226, v13, s67, v226
    v_dot2_f32_bf16 v226, v14, s67, v226
    v_dot2_f32_bf16 v226, v15, s67, v226
    s_nop 2
    v_add_f32_dpp v226, v226, v226 row_ror:1 row_mask:0xf bank_mask:0xf
    s_nop 1
    v_add_f32_dpp v226, v226, v226 row_ror:2 row_mask:0xf bank_mask:0xf
    s_nop 1
    v_add_f32_dpp v226, v226, v226 row_ror:4 row_mask:0xf bank_mask:0xf
    s_nop 1
    v_add_f32_dpp v226, v226, v226 row_ror:8 row_mask:0xf bank_mask:0xf
    v_mov_b32 v229, v226
    s_nop 1
    v_permlane32_swap_b32 v226, v229
    v_add_f32 v226, v226, v229
    v_mov_b32 v229, v226
    s_nop 1
    v_permlane16_swap_b32 v226, v229
    v_add_f32 v226, v226, v229
    s_nop 0
    v_readfirstlane_b32 s55, v226
    s_waitcnt vmcnt(11)
    s_barrier
    ds_read_b64_tr_b16 v[92:93], v218 offset:0
    ds_read_b64_tr_b16 v[94:95], v218 offset:768
    ds_read_b64_tr_b16 v[96:97], v218 offset:12288
    ds_read_b64_tr_b16 v[98:99], v218 offset:13056
    ds_read_b64_tr_b16 v[100:101], v218 offset:32
    ds_read_b64_tr_b16 v[102:103], v218 offset:800
    ds_read_b64_tr_b16 v[104:105], v218 offset:12320
    ds_read_b64_tr_b16 v[106:107], v218 offset:13088
    ds_read_b64_tr_b16 v[108:109], v218 offset:64
    ds_read_b64_tr_b16 v[110:111], v218 offset:832
    ds_read_b64_tr_b16 v[112:113], v218 offset:12352
    ds_read_b64_tr_b16 v[114:115], v218 offset:13120
    s_waitcnt lgkmcnt(0)
    s_barrier
    s_mul_i32 s62, s49, 3
    s_add_u32 s62, s62, 1
    s_lshr_b32 s63, s62, 2
    s_cmp_eq_u32 s63, 9
    s_cselect_b32 s63, 2, 0
    s_xor_b32 s62, s62, s63
    s_mul_i32 s62, s62, 40960
    s_add_u32 s62, s62, s53
    s_add_u32 m0, s53, 0
    s_nop 0
    buffer_load_dwordx4 v213, s[32:35], s62 offen lds
    s_add_u32 m0, s53, 1024
    s_nop 0
    buffer_load_dwordx4 v214, s[32:35], s62 offen lds
    s_add_u32 m0, s53, 2048
    s_nop 0
    buffer_load_dwordx4 v215, s[32:35], s62 offen lds
    s_add_u32 m0, s53, 3072
    s_nop 0
    buffer_load_dwordx4 v216, s[32:35], s62 offen lds
    s_add_u32 m0, s53, 4096
    s_nop 0
    buffer_load_dwordx4 v217, s[32:35], s62 offen lds
    v_smfmac_f32_16x16x64_bf16 v[232:235], v[220:223], v[92:99], v252
    v_smfmac_f32_16x16x64_bf16 v[236:239], v[220:223], v[100:107], v252
    v_smfmac_f32_16x16x64_bf16 v[240:243], v[220:223], v[108:115], v252
    s_waitcnt vmcnt(10)
    s_barrier
    ds_read_b64_tr_b16 v[116:117], v218 offset:49152
    ds_read_b64_tr_b16 v[118:119], v218 offset:49920
    ds_read_b64_tr_b16 v[120:121], v218 offset:61440
    ds_read_b64_tr_b16 v[122:123], v218 offset:62208
    ds_read_b64_tr_b16 v[124:125], v218 offset:49184
    ds_read_b64_tr_b16 v[126:127], v218 offset:49952
    ds_read_b64_tr_b16 v[128:129], v218 offset:61472
    ds_read_b64_tr_b16 v[130:131], v218 offset:62240
    ds_read_b64_tr_b16 v[132:133], v218 offset:49216
    ds_read_b64_tr_b16 v[134:135], v218 offset:49984
    ds_read_b64_tr_b16 v[136:137], v218 offset:61504
    ds_read_b64_tr_b16 v[138:139], v218 offset:62272
    s_waitcnt lgkmcnt(0)
    s_barrier
    s_mul_i32 s62, s49, 3
    s_add_u32 s62, s62, 2
    s_lshr_b32 s63, s62, 2
    s_cmp_eq_u32 s63, 9
    s_cselect_b32 s63, 2, 0
    s_xor_b32 s62, s62, s63
    s_mul_i32 s62, s62, 40960
    s_add_u32 s62, s62, s53
    s_add_u32 m0, s53, 49152
    s_nop 0
    buffer_load_dwordx4 v213, s[32:35], s62 offen lds
    s_add_u32 m0, s53, 50176
    s_nop 0
    buffer_load_dwordx4 v214, s[32:35], s62 offen lds
    s_add_u32 m0, s53, 51200
    s_nop 0
    buffer_load_dwordx4 v215, s[32:35], s62 offen lds
    s_add_u32 m0, s53, 52224
    s_nop 0
    buffer_load_dwordx4 v216, s[32:35], s62 offen lds
    s_add_u32 m0, s53, 53248
    s_nop 0
    buffer_load_dwordx4 v217, s[32:35], s62 offen lds
    s_cmp_eq_u32 s48, 0
    s_cselect_b32 s65, s15, 2.0
    s_mov_b64 exec, 0xffffff
    buffer_load_dwordx2 v[224:225], v7, s[24:27], s65 offen sc1
    s_mov_b64 exec, -1
    v_smfmac_f32_16x16x64_bf16 v[232:235], v[220:223], v[116:123], v252
    v_smfmac_f32_16x16x64_bf16 v[236:239], v[220:223], v[124:131], v252
    v_smfmac_f32_16x16x64_bf16 v[240:243], v[220:223], v[132:139], v252
    s_mov_b64 exec, 0xffff
    s_nop 8
    v_pk_add_f32 v[232:233], v[232:233], v[234:235]
    ds_write_b64 v230, v[232:233] offset:0
    v_pk_add_f32 v[236:237], v[236:237], v[238:239]
    ds_write_b64 v230, v[236:237] offset:128
    v_pk_add_f32 v[240:241], v[240:241], v[242:243]
    ds_write_b64 v230, v[240:241] offset:256
    s_mov_b64 exec, -1
    s_waitcnt lgkmcnt(0)
    s_waitcnt vmcnt(6)
    s_barrier
    ds_read2st64_b32 v[232:233], v228 offset0:0 offset1:3
    ds_read2st64_b32 v[234:235], v228 offset0:6 offset1:9
    ds_read_b64_tr_b16 v[140:141], v205 offset:0
    ds_read_b64_tr_b16 v[142:143], v205 offset:5120
    ds_read_b64_tr_b16 v[152:153], v206 offset:0
    ds_read_b64_tr_b16 v[154:155], v206 offset:5120
    ds_read_b64_tr_b16 v[164:165], v207 offset:0
    ds_read_b64_tr_b16 v[166:167], v207 offset:5120
    ds_read_b64_tr_b16 v[176:177], v208 offset:0
    ds_read_b64_tr_b16 v[178:179], v208 offset:5120
    ds_read_b64_tr_b16 v[188:189], v209 offset:0
    ds_read_b64_tr_b16 v[190:191], v209 offset:5120
    ds_read_b64_tr_b16 v[144:145], v200 offset:0
    ds_read_b64_tr_b16 v[146:147], v200 offset:5120
    ds_read_b64_tr_b16 v[156:157], v201 offset:0
    ds_read_b64_tr_b16 v[158:159], v201 offset:5120
    ds_read_b64_tr_b16 v[168:169], v202 offset:0
    ds_read_b64_tr_b16 v[170:171], v202 offset:5120
    ds_read_b64_tr_b16 v[180:181], v203 offset:0
    ds_read_b64_tr_b16 v[182:183], v203 offset:5120
    ds_read_b64_tr_b16 v[192:193], v204 offset:0
    ds_read_b64_tr_b16 v[194:195], v204 offset:5120
    s_waitcnt lgkmcnt(0)
    v_add_f32 v0, v232, v234
    v_add_f32 v2, v233, v235
    s_waitcnt vmcnt(1)
    s_barrier
    ds_read_b64_tr_b16 v[148:149], v200 offset:49152
    ds_read_b64_tr_b16 v[150:151], v200 offset:54272
    ds_read_b64_tr_b16 v[160:161], v201 offset:49152
    ds_read_b64_tr_b16 v[162:163], v201 offset:54272
    ds_read_b64_tr_b16 v[172:173], v202 offset:49152
    ds_read_b64_tr_b16 v[174:175], v202 offset:54272
    ds_read_b64_tr_b16 v[184:185], v203 offset:49152
    ds_read_b64_tr_b16 v[186:187], v203 offset:54272
    ds_read_b64_tr_b16 v[196:197], v204 offset:49152
    ds_read_b64_tr_b16 v[198:199], v204 offset:54272
    s_waitcnt lgkmcnt(0)
F_rdy:
HF0_0:
    s_cbranch_execz HF_ret
    s_cmp_lg_u32 s48, 0
    s_cbranch_scc1 F_wait
    s_mov_b64 exec, 0xffffff
    s_branch F_pw
F_poll:
    buffer_load_dwordx2 v[224:225], v7, s[24:27], s15 offen sc1
F_pw:
    s_waitcnt vmcnt(0)
    v_cmp_ne_u32 vcc, s54, v225
    s_cbranch_vccz F_got
    s_sleep 1
    s_sub_u32 s3, s3, 1
    s_cbranch_scc0 F_poll
    s_mov_b32 s3, 0
F_got:
    s_mov_b64 exec, -1
    v_max_u32_dpp v226, v224, v224 row_ror:1 row_mask:0xf bank_mask:0xf
    s_nop 1
    v_max_u32_dpp v226, v226, v226 row_ror:2 row_mask:0xf bank_mask:0xf
    s_nop 1
    v_max_u32_dpp v226, v226, v226 row_ror:4 row_mask:0xf bank_mask:0xf
    s_nop 1
    v_max_u32_dpp v226, v226, v226 row_ror:8 row_mask:0xf bank_mask:0xf
    s_nop 0
    v_readlane_b32 s60, v226, 0
    v_readlane_b32 s62, v226, 16
    s_max_u32 s60, s60, s62
    s_max_u32 s60, s60, 1376257
    s_sub_u32 s60, s60, 1376256
    v_cmp_le_u32 vcc, s60, v224
    s_nop 1
    v_mbcnt_lo_u32_b32 v226, vcc_lo, 0
    v_cmp_gt_u32 s[62:63], 8, v226
    v_lshl_add_u32 v226, v226, 2, v8
    s_and_b64 exec, vcc, s[62:63]
    ds_write_b32 v226, v224 offset:0
    s_mov_b64 exec, -1
    s_waitcnt lgkmcnt(0)
F_wait:
    s_waitcnt vmcnt(0)
    s_barrier
    ds_read_b32 v224, v231 offset:0
    s_waitcnt lgkmcnt(0)
    v_readfirstlane_b32 s60, v224
F_redo:
    v_mov_b64 v[232:233], 0
    v_mov_b64 v[234:235], 0
    v_mov_b64 v[236:237], 0
    v_mov_b64 v[238:239], 0
HF1_0:
    s_cbranch_execz HF1_1
    v_mov_b64 v[240:241], 0
    v_mov_b64 v[242:243], 0
    s_and_b32 s61, s60, 0xfff
    s_cbranch_scc0 F_b1
    s_lshr_b32 s62, s61, 4
    s_mul_i32 s62, s62, 171
    s_lshr_b32 s62, s62, 10
    s_mul_i32 s62, s62, 2560
    s_add_u32 s62, s62, s16
    s_add_u32 s63, s54, s61
    v_mov_b64 v[228:229], 0
    v_mov_b32 v230, s63
    buffer_load_dwordx3 v[220:222], v1, s[24:27], s62 offen offset:0 sc1
    buffer_load_dwordx3 v[224:226], v1, s[24:27], s62 offen offset:1024 sc1
    s_mov_b32 exec_hi, 0
    buffer_load_dwordx3 v[228:230], v1, s[24:27], s62 offen offset:2048 sc1
    s_mov_b32 exec_hi, -1
    s_branch F_rw
F_row:
    s_mov_b64 exec, s[58:59]
    s_cbranch_execz F_r0
    buffer_load_dwordx3 v[220:222], v1, s[24:27], s62 offen offset:0 sc1
F_r0:
    s_mov_b64 exec, s[64:65]
    s_cbranch_execz F_r1
    buffer_load_dwordx3 v[224:226], v1, s[24:27], s62 offen offset:1024 sc1
F_r1:
    s_mov_b64 exec, s[10:11]
    s_cbranch_execz F_r2
    buffer_load_dwordx3 v[228:230], v1, s[24:27], s62 offen offset:2048 sc1
F_r2:
    s_mov_b64 exec, -1
F_rw:
    s_waitcnt vmcnt(0)
    ds_write2_b32 v16, v220, v221 offset0:0 offset1:168
    ds_write2_b32 v16, v224, v225 offset0:64 offset1:232
    s_mov_b32 exec_hi, 0
    ds_write_b32 v16, v228 offset:512
    ds_write_b32 v16, v229 offset:1184
    s_mov_b32 exec_hi, -1
    v_cmp_ne_u32 s[58:59], s63, v222
    v_cmp_ne_u32 s[64:65], s63, v226
    v_cmp_ne_u32 s[10:11], s63, v230
    s_or_b64 vcc, s[58:59], s[64:65]
    s_or_b64 vcc, vcc, s[10:11]
    s_cbranch_scc0 F_ok
    s_sub_u32 s20, s20, 1
    s_cbranch_scc0 F_row
F_b1:
    s_waitcnt lgkmcnt(0)
    s_barrier
    ds_read_b128 v[200:203], v9 offset:16384
HF1_1:
    s_cbranch_execz HF_ret
    ds_read_b128 v[204:207], v9 offset:16416
    ds_read_b128 v[208:211], v9 offset:16448
    ds_read_b128 v[212:215], v9 offset:16480
    ds_read_b128 v[216:219], v9 offset:16512
    s_waitcnt lgkmcnt(4)
    v_smfmac_f32_16x16x64_bf16 v[232:235], v[200:203], v[20:27], v252
    v_smfmac_f32_16x16x64_bf16 v[236:239], v[200:203], v[28:35], v252
    v_smfmac_f32_16x16x64_bf16 v[240:243], v[200:203], v[36:43], v252
    s_waitcnt lgkmcnt(3)
    v_smfmac_f32_16x16x64_bf16 v[232:235], v[204:207], v[44:51], v252
    v_smfmac_f32_16x16x64_bf16 v[236:239], v[204:207], v[52:59], v252
    v_smfmac_f32_16x16x64_bf16 v[240:243], v[204:207], v[60:67], v252
    s_waitcnt lgkmcnt(2)
    v_smfmac_f32_16x16x64_bf16 v[232:235], v[208:211], v[68:75], v252
    v_smfmac_f32_16x16x64_bf16 v[236:239], v[208:211], v[76:83], v252
    v_smfmac_f32_16x16x64_bf16 v[240:243], v[208:211], v[84:91], v252
    s_waitcnt lgkmcnt(1)
    v_smfmac_f32_16x16x64_bf16 v[232:235], v[212:215], v[92:99], v252
    v_smfmac_f32_16x16x64_bf16 v[236:239], v[212:215], v[100:107], v252
    v_smfmac_f32_16x16x64_bf16 v[240:243], v[212:215], v[108:115], v252
    s_waitcnt lgkmcnt(0)
    v_smfmac_f32_16x16x64_bf16 v[232:235], v[216:219], v[116:123], v252
    v_smfmac_f32_16x16x64_bf16 v[236:239], v[216:219], v[124:131], v252
    v_smfmac_f32_16x16x64_bf16 v[240:243], v[216:219], v[132:139], v252
    s_nop 8
    s_branch F_pw2
F_ok:
    v_dot2_f32_bf16 v222, v220, s67, 0
    v_dot2_f32_bf16 v223, v220, v220, 0
    v_dot2_f32_bf16 v226, v220, v10, 0
    v_dot2_f32_bf16 v222, v221, s67, v222
    v_dot2_f32_bf16 v223, v221, v221, v223
    v_dot2_f32_bf16 v226, v221, v11, v226
    v_dot2_f32_bf16 v222, v224, s67, v222
    v_dot2_f32_bf16 v223, v224, v224, v223
    v_dot2_f32_bf16 v226, v224, v12, v226
HF2_0:
    s_cbranch_execz HF2_1
    v_dot2_f32_bf16 v222, v225, s67, v222
    v_dot2_f32_bf16 v223, v225, v225, v223
    v_dot2_f32_bf16 v226, v225, v13, v226
    v_dot2_f32_bf16 v222, v228, s67, v222
    v_dot2_f32_bf16 v223, v228, v228, v223
    v_dot2_f32_bf16 v226, v228, v14, v226
    v_dot2_f32_bf16 v222, v229, s67, v222
    v_dot2_f32_bf16 v223, v229, v229, v223
    v_dot2_f32_bf16 v226, v229, v15, v226
    s_waitcnt lgkmcnt(0)
    s_barrier
    ds_read_b128 v[200:203], v9 offset:16384
    ds_read_b128 v[204:207], v9 offset:16416
    ds_read_b128 v[208:211], v9 offset:16448
    ds_read_b128 v[212:215], v9 offset:16480
    ds_read_b128 v[216:219], v9 offset:16512
    v_mov_b32 v227, v226
    v_permlane32_swap_b32 v222, v223
    s_nop 0
    v_permlane32_swap_b32 v226, v227
    v_add_f32 v222, v222, v223
    v_add_f32 v226, v226, v227
    v_mov_b32 v224, s68
    v_mov_b32 v223, s45
    v_permlane16_swap_b32 v222, v226
    v_add_f32 v222, v222, v226
    s_waitcnt lgkmcnt(4)
    v_smfmac_f32_16x16x64_bf16 v[232:235], v[200:203], v[20:27], v252
    v_add_f32_dpp v222, v222, v222 row_ror:1 row_mask:0xf bank_mask:0xf
    s_nop 1
    v_add_f32_dpp v222, v222, v222 row_ror:2 row_mask:0xf bank_mask:0xf
    v_smfmac_f32_16x16x64_bf16 v[236:239], v[200:203], v[28:35], v252
    s_nop 0
    v_add_f32_dpp v222, v222, v222 row_ror:4 row_mask:0xf bank_mask:0xf
    s_nop 1
    v_add_f32_dpp v222, v222, v222 row_ror:8 row_mask:0xf bank_mask:0xf
    v_smfmac_f32_16x16x64_bf16 v[240:243], v[200:203], v[36:43], v252
    v_readlane_b32 s64, v222, 32
    v_readlane_b32 s65, v222, 16
    s_waitcnt lgkmcnt(3)
HF2_1:
    s_cbranch_execz HF_ret
    v_smfmac_f32_16x16x64_bf16 v[232:235], v[204:207], v[44:51], v252
    v_mov_b32 v220, v222
    v_mov_b32 v221, s64
    v_smfmac_f32_16x16x64_bf16 v[236:239], v[204:207], v[52:59], v252
    v_mul_f32 v220, 0x3acccccd, v220
    v_mul_f32 v221, 0x3acccccd, v221
    v_smfmac_f32_16x16x64_bf16 v[240:243], v[204:207], v[60:67], v252
    v_fma_f32 v221, -v220, v220, v221
    v_max_f32 v221, 0, v221
    s_waitcnt lgkmcnt(2)
    v_smfmac_f32_16x16x64_bf16 v[232:235], v[208:211], v[68:75], v252
    v_cvt_pk_bf16_f32 v221, v221, v221
    v_and_b32 v221, 0xffff0000, v221
    v_smfmac_f32_16x16x64_bf16 v[236:239], v[208:211], v[76:83], v252
    v_add_f32 v221, 0x3727c5ac, v221
    v_cvt_pk_bf16_f32 v221, v221, v221
    v_smfmac_f32_16x16x64_bf16 v[240:243], v[208:211], v[84:91], v252
    v_and_b32 v221, 0xffff0000, v221
    v_sqrt_f32 v221, v221
    s_waitcnt lgkmcnt(1)
    v_smfmac_f32_16x16x64_bf16 v[232:235], v[212:215], v[92:99], v252
    v_cvt_pk_bf16_f32 v220, v220, v220
    v_and_b32 v220, 0xffff0000, v220
    v_smfmac_f32_16x16x64_bf16 v[236:239], v[212:215], v[100:107], v252
    v_cvt_pk_bf16_f32 v221, v221, v221
    v_and_b32 v221, 0xffff0000, v221
    v_smfmac_f32_16x16x64_bf16 v[240:243], v[212:215], v[108:115], v252
    v_rcp_f32 v221, v221
    v_mul_f32 v222, s55, v220
    s_waitcnt lgkmcnt(0)
    v_smfmac_f32_16x16x64_bf16 v[232:235], v[216:219], v[116:123], v252
    v_sub_f32 v222, s65, v222
    v_mul_f32 v222, v222, v221
    v_smfmac_f32_16x16x64_bf16 v[236:239], v[216:219], v[124:131], v252
    v_ashrrev_i32 v225, 31, v222
    v_or_b32 v225, 0x80000000, v225
    v_smfmac_f32_16x16x64_bf16 v[240:243], v[216:219], v[132:139], v252
    v_xor_b32 v225, v225, v222
HF3_0:
    s_cbranch_execz HF3_1
    v_and_b32 v225, 0xfffff000, v225
    v_or_b32 v225, s61, v225
    s_mov_b64 exec, 1
    ds_write2_b32 v224, v220, v221 offset0:0 offset1:2
    ds_write2_b32 v224, v222, v223 offset0:4 offset1:6
    ds_max_u64 v8, v[224:225] offset:32
    s_mov_b64 exec, -1
F_pw2:
    v_pk_add_f32 v[232:233], v[232:233], v[234:235]
    ds_write_b64 v3, v[232:233] offset:256
    v_pk_add_f32 v[236:237], v[236:237], v[238:239]
    ds_write_b64 v3, v[236:237] offset:384
    v_pk_add_f32 v[240:241], v[240:241], v[242:243]
    ds_write_b64 v3, v[240:241] offset:512
    s_cmp_ge_u32 s48, 2
    v_mov_b64 v[244:245], 0
    v_mov_b64 v[246:247], 0
    v_mov_b64 v[248:249], 0
    v_mov_b64 v[250:251], 0
    s_waitcnt lgkmcnt(0)
    s_barrier
    ds_read_b64 v[224:225], v8 offset:32
    v_mov_b64 v[232:233], 0
    v_mov_b64 v[234:235], 0
    v_mov_b64 v[236:237], 0
    v_mov_b64 v[238:239], 0
    v_mov_b64 v[240:241], 0
    v_mov_b64 v[242:243], 0
    s_waitcnt lgkmcnt(0)
    s_cbranch_scc1 F_gu
    v_add_u32 v227, v224, v4
    ds_read2_b32 v[228:229], v224 offset0:0 offset1:2
    ds_read2st64_b32 v[208:209], v227 offset0:1 offset1:4
    ds_read2st64_b32 v[210:211], v227 offset0:7 offset1:10
    s_waitcnt lgkmcnt(1)
    v_fma_f32 v208, -v228, v0, v208
    v_fma_f32 v209, -v228, v2, v209
    s_waitcnt lgkmcnt(0)
    v_add_f32 v208, v208, v210
    v_add_f32 v209, v209, v211
    v_mul_f32 v208, v208, v229
    v_mul_f32 v209, v209, v229
    v_cvt_pk_bf16_f32 v209, v208, v209
    v_lshlrev_b32 v208, 16, v209
    v_mul_f32 v210, 0xbfb8aa3b, v208
    v_exp_f32 v210, v210
HF3_1:
    s_cbranch_execz HF_ret
    v_and_b32 v209, s47, v209
    v_add_f32 v210, 1.0, v210
    v_rcp_f32 v210, v210
    s_mov_b32 exec_hi, 0xffff
    v_mul_f32 v208, v208, v210
    v_cvt_pk_bf16_f32 v208, v208, v208
    v_and_b32 v208, 0xffff0000, v208
    v_mul_f32 v208, v208, v209
    v_cvt_pk_bf16_f32 v208, v208, v208
    ds_write_b16 v5, v208 offset:3584
    s_mov_b64 exec, -1
    s_waitcnt lgkmcnt(0)
F_gu:
    s_barrier
    ds_read_b128 v[200:203], v6 offset:3584
    ds_read_b128 v[204:207], v6 offset:3648
    v_readfirstlane_b32 s61, v225
    v_mov_b32 v220, 0
    s_and_b32 s61, s61, 0xfff
    s_add_u32 s63, s54, s61
    v_mov_b32 v215, s63
    s_waitcnt lgkmcnt(1)
    v_smfmac_f32_16x16x64_bf16 v[232:235], v[200:203], v[140:147], v252
    v_smfmac_f32_16x16x64_bf16 v[236:239], v[200:203], v[152:159], v252
    v_smfmac_f32_16x16x64_bf16 v[240:243], v[200:203], v[164:171], v252
    v_smfmac_f32_16x16x64_bf16 v[244:247], v[200:203], v[176:183], v252
    v_smfmac_f32_16x16x64_bf16 v[248:251], v[200:203], v[188:195], v252
    s_cmp_lg_u32 s48, 7
    s_cbranch_scc1 F_n7
    s_mov_b64 exec, 0xffffff
    buffer_load_dwordx2 v[220:221], v7, s[24:27], s70 offen sc1
    s_mov_b64 exec, -1
F_n7:
    s_waitcnt lgkmcnt(0)
    v_smfmac_f32_16x16x64_bf16 v[232:235], v[204:207], v[144:151], v252
    v_smfmac_f32_16x16x64_bf16 v[236:239], v[204:207], v[156:163], v252
    v_smfmac_f32_16x16x64_bf16 v[240:243], v[204:207], v[168:175], v252
    v_smfmac_f32_16x16x64_bf16 v[244:247], v[204:207], v[180:187], v252
    v_smfmac_f32_16x16x64_bf16 v[248:251], v[204:207], v[192:199], v252
    s_nop 7
    v_add_f32 v212, v232, v234
    v_add_f32 v213, v236, v238
    v_add_f32 v214, v240, v242
    s_mov_b32 exec_lo, s47
    v_add_f32 v212, v244, v246
    v_add_f32 v213, v248, v250
    s_mov_b32 exec_lo, -1
HF4_0:
    s_cbranch_execz HF4_1
    s_mov_b32 exec_hi, 0
    buffer_store_dwordx4 v[212:215], v17, s[24:27], s8 offen sc1
    s_mov_b32 exec_hi, -1
    s_cmp_lt_u32 s44, 2
    s_cbranch_scc0 F_rest
    ds_read2_b32 v[228:229], v224 offset0:0 offset1:2
    ds_read2_b32 v[230:231], v224 offset0:4 offset1:6
    s_lshr_b32 s65, s61, 4
    s_mul_i32 s65, s65, 171
    s_lshr_b32 s65, s65, 10
    s_mul_i32 s64, s65, 2560
    s_add_u32 s64, s64, 131072
    s_mul_i32 s71, s65, 96
    s_sub_u32 s66, s61, s71
    s_lshr_b32 s71, s65, 1
    s_mul_i32 s71, s71, 86
    s_add_u32 s66, s66, s71
    s_sub_u32 s66, s66, 10
    s_lshl_b32 s66, s66, 1
    s_and_b32 s65, s65, 1
    s_add_u32 s66, s66, s65
    s_mul_i32 s66, s66, 1280
    v_lshrrev_b32 v223, 3, v18
    v_lshlrev_b32 v223, 4, v223
    s_waitcnt lgkmcnt(0)
    v_add_u32 v226, v231, v19
    v_and_b32 v226, 0xfffe, v226
    ds_read_u16 v226, v226
    v_cvt_pk_bf16_f32 v231, v230, v230
    v_and_b32 v231, 0xffff0000, v231
    v_mul_f32 v231, 0xbfb8aa3b, v231
    v_exp_f32 v231, v231
    s_nop 0
    v_add_f32 v231, 1.0, v231
    v_rcp_f32 v231, v231
    s_waitcnt lgkmcnt(0)
    v_lshlrev_b32 v226, 16, v226
    v_cvt_pk_bf16_f32 v231, v231, v231
    v_and_b32 v231, 0xffff0000, v231
    v_sub_f32 v227, v226, v228
    v_cvt_pk_bf16_f32 v227, v227, v227
    v_and_b32 v227, 0xffff0000, v227
    v_mul_f32 v227, v227, v229
HF4_1:
    s_cbranch_execz HF_ret
    v_cvt_pk_bf16_f32 v227, v227, v227
    v_and_b32 v227, 0xffff0000, v227
    s_waitcnt vmcnt(0)
F_yp:
    buffer_load_dwordx4 v[200:203], v1, s[24:27], s14 offen sc1
    buffer_load_dwordx4 v[204:207], v1, s[24:27], s14 offen offset:1024 sc1
    s_mov_b64 exec, s[18:19]
    buffer_load_dword v222, v223, s[24:27], s64 offen offset:8 sc1
    s_mov_b64 exec, -1
    s_waitcnt vmcnt(1)
    ds_read_b32 v224, v8 offset:40
    v_cmp_ne_u32 vcc, s63, v203
    v_cmp_ne_u32 s[58:59], s63, v207
    v_add_f32 v200, v200, v204
    v_add_f32 v201, v201, v205
    v_add_f32 v202, v202, v206
    s_or_b64 vcc, vcc, s[58:59]
    s_cbranch_scc1 F_chk
    v_mov_b32 v203, v202
    v_permlane32_swap_b32 v200, v201
    s_nop 0
    v_permlane32_swap_b32 v202, v203
    v_add_f32 v200, v200, v201
    v_add_f32 v202, v202, v203
    s_nop 1
    v_permlane16_swap_b32 v200, v202
    v_add_f32 v200, v200, v202
    s_nop 1
    v_add_f32_dpp v200, v200, v200 row_ror:8 row_mask:0xf bank_mask:0xf
    v_cvt_pk_bf16_f32 v200, v200, v200
    v_and_b32 v200, 0xffff0000, v200
    v_mul_f32 v200, v200, v231
    v_cvt_pk_bf16_f32 v200, v200, v200
    v_and_b32 v200, 0xffff0000, v200
    v_add_f32 v200, v200, v227
    v_cvt_pk_bf16_f32 v200, v200, v200
    v_and_b32 v200, 0xffff0000, v200
    v_add_f32 v200, v200, v226
    v_cvt_pk_bf16_f32 v200, v200, v200
F_vf:
    s_mov_b64 exec, s[18:19]
    s_waitcnt vmcnt(0) lgkmcnt(0)
    v_readfirstlane_b32 s60, v224
    v_cmp_ne_u32 vcc, s63, v222
    s_and_b32 s62, s60, 0xfff
    s_cmp_lg_u32 s62, s61
    s_cbranch_scc1 F_vw
    s_cbranch_vccnz F_vl
    buffer_store_short v200, v18, s[40:43], s66 offen
HF5_0:
    s_cbranch_execz HF5_1
    s_or_b32 s65, s49, s44
    s_cbranch_scc1 L_fin
    s_mov_b64 exec, 1
    v_mov_b32 v9, 0
    v_mov_b32 v10, s54
    buffer_store_dword v10, v9, s[24:27], 0 offen
    s_branch L_fin
F_vw:
    s_cmp_lg_u32 s62, 0
    s_cbranch_scc1 F_vx
    s_cbranch_vccz F_vn
F_vl:
    buffer_load_dword v222, v223, s[24:27], s64 offen offset:8 sc1
F_vn:
    ds_read_b32 v224, v8 offset:40
    s_sub_u32 s3, s3, 1
    s_cbranch_scc0 F_vf
    s_mov_b32 s3, 0
    s_branch L_fin
F_vx:
    s_cmp_eq_u32 s17, 0
    s_cbranch_scc1 F_again
    s_branch L_fin
F_chk:
    s_waitcnt lgkmcnt(0)
    v_readfirstlane_b32 s60, v224
    s_and_b32 s62, s60, 0xfff
    s_cselect_b32 s62, s62, s61
    s_cmp_lg_u32 s62, s61
    s_cbranch_scc1 F_vx
    s_sub_u32 s3, s3, 1
    s_cbranch_scc0 F_yp
    s_mov_b32 s3, 0
    s_branch L_fin
F_rest:
    s_cmp_lg_u32 s17, 0
    s_cbranch_scc1 L_fin
    s_cmp_lg_u32 s48, 7
    s_cbranch_scc1 F_tw
    s_mov_b64 exec, 0xffffff
    s_waitcnt vmcnt(1)
    s_branch F_tc
F_tp:
    buffer_load_dwordx2 v[220:221], v7, s[24:27], s70 offen sc1
    s_waitcnt vmcnt(0)
F_tc:
    v_cmp_ne_u32 vcc, s54, v221
    s_cbranch_vccz F_tg
    s_sub_u32 s3, s3, 1
    s_cbranch_scc0 F_tp
    s_mov_b32 s3, 0
F_tg:
    s_mov_b64 exec, -1
    v_max_u32_dpp v222, v220, v220 row_ror:1 row_mask:0xf bank_mask:0xf
    s_nop 1
    v_max_u32_dpp v222, v222, v222 row_ror:2 row_mask:0xf bank_mask:0xf
    s_nop 1
    v_max_u32_dpp v222, v222, v222 row_ror:4 row_mask:0xf bank_mask:0xf
    s_nop 1
    v_max_u32_dpp v222, v222, v222 row_ror:8 row_mask:0xf bank_mask:0xf
    s_nop 0
HF5_1:
    s_cbranch_execz HF_ret
    v_readlane_b32 s60, v222, 0
    v_readlane_b32 s62, v222, 16
    s_max_u32 s60, s60, s62
    s_and_b32 s62, s60, 0xfff
    s_cselect_b32 s60, s60, 1
    v_mov_b32 v220, s60
    ds_write_b32 v8, v220 offset:40
F_tw:
    ds_read_b32 v224, v8 offset:40
    s_waitcnt lgkmcnt(0)
    v_readfirstlane_b32 s60, v224
    s_and_b32 s62, s60, 0xfff
    s_cbranch_scc1 F_tk
    s_sleep 2
    s_sub_u32 s3, s3, 1
    s_cbranch_scc0 F_tw
    s_mov_b32 s3, 0
    s_branch L_fin
F_tk:
    s_cmp_eq_u32 s62, s61
    s_cbranch_scc1 L_fin
F_again:
    s_mov_b64 exec, -1
    s_waitcnt vmcnt(0)
    s_mov_b32 s17, 1
    s_mov_b32 s16, 131072
    s_mov_b32 s20, 0x40000
    v_mov_b64 v[224:225], 0
    s_cmp_eq_u32 s48, 0
    s_cselect_b32 s60, s60, 0
    s_cbranch_scc0 F_redo
    ds_write_b64 v8, v[224:225] offset:32
    s_branch F_redo
L_last:
.section .rodata,"a"
.p2align 6
.amdhsa_kernel sequential_preLN__sliding_local_dilated__moe_arch_mod__prompt_kernel
  .amdhsa_next_free_vgpr 256
  .amdhsa_next_free_sgpr 102
  .amdhsa_accum_offset 256
  .amdhsa_group_segment_fixed_size 0
  .amdhsa_kernarg_size 88
  .amdhsa_user_sgpr_count 2
  .amdhsa_user_sgpr_kernarg_segment_ptr 1
  .amdhsa_system_sgpr_workgroup_id_x 1
  .amdhsa_float_denorm_mode_32 3
  .amdhsa_float_denorm_mode_16_64 3
.end_amdhsa_kernel
```

```asm
; @launch grid=(256,1,1) block=(512,1,1) lds=163840
.amdgcn_target "amdgcn-amd-amdhsa--gfx950"
.text
.globl sequential_preLN__sliding_local_dilated__moe_arch_mod__prompt_kernel
.p2align 8
.type sequential_preLN__sliding_local_dilated__moe_arch_mod__prompt_kernel,@function
sequential_preLN__sliding_local_dilated__moe_arch_mod__prompt_kernel:
    s_load_dwordx2 s[28:29], s[0:1], 0
    s_load_dwordx2 s[32:33], s[0:1], 8
    v_readfirstlane_b32 s48, v0
    s_load_dwordx2 s[24:25], s[0:1], 80
    s_load_dwordx2 s[36:37], s[0:1], 16
    s_load_dwordx2 s[40:41], s[0:1], 64
    s_load_dwordx8 s[12:19], s[0:1], 32
    s_lshr_b32 s56, s2, 3
    s_lshr_b32 s48, s48, 6
    s_cmp_ge_u32 s2, 240
    s_cbranch_scc1 F_pre
    s_mul_i32 s51, s56, 86
    s_lshr_b32 s51, s51, 8
    s_and_b32 s66, s2, 7
    s_sub_u32 s53, s66, s51
    s_mul_i32 s53, s53, 3
    s_add_u32 s53, s53, s56
    s_lshr_b32 s55, s53, 1
    s_and_b32 s50, s53, 1
    s_mul_i32 s55, s55, 86
    s_sub_u32 s55, s55, 10
    s_mov_b32 s30, 2621440
    s_mov_b32 s31, 0x00020000
    s_sub_u32 s60, s48, 4
    s_cbranch_scc1 C_pre
    s_lshl_b32 s62, s60, 2
    s_and_b32 s62, s62, 4
    v_bfe_u32 v1, v0, 3, 3
    v_bfe_u32 v2, v0, 4, 2
    v_bitop3_b32 v3, v0, 7, s62 bitop3:0x6a
    s_mul_i32 s62, s60, 24
    s_add_u32 s62, s62, s55
    s_lshl1_add_u32 s62, s62, s50
    s_mul_i32 s62, s62, 1280
    v_xor_b32 v4, v3, v2
    v_mul_u32_u24 v5, 2560, v1
    v_lshl_add_u32 v4, v4, 4, s62
    s_movk_i32 s63, 20480
    v_add_u32 v10, v4, v5
    v_bitop3_b32 v6, v1, 2, v3 bitop3:0x6a
    v_xad_u32 v11, v10, 64, s63
    v_add_u32 v12, 40960, v10
    s_mul_i32 s62, s60, 30720
    s_lshl_b32 s63, s51, 7
    s_add_u32 s62, s62, s63
    v_mul_u32_u24 v5, 3840, v1
    v_lshl_add_u32 v6, v6, 4, s62
    s_mov_b32 s71, s51
    v_add_u32 v13, v5, v6
    s_mul_i32 s65, s60, 3072
    v_add_u32 v14, 256, v13
    v_add_u32 v15, 512, v13
    s_mov_b32 s34, 2457600
    s_mov_b32 s35, 0x00020000
    s_mov_b32 s64, s65
    s_add_u32 s70, s65, 110592
    s_waitcnt lgkmcnt(0)
    s_call_b64 s[98:99], LD_issue
    s_branch LD_cont
LD_issue:
    s_cmp_ge_u32 s66, s71
    s_addc_u32 s68, s66, 0
    s_mov_b32 m0, s65
    s_lshl_b32 s67, s68, 7
    buffer_load_dwordx4 v10, s[28:31], s67 offen lds
    s_add_u32 m0, s65, 1024
    s_mul_i32 s68, s68, 245760
    buffer_load_dwordx4 v11, s[28:31], s67 offen lds
    s_add_u32 m0, s65, 2048
    s_add_u32 s69, s68, 122880
    buffer_load_dwordx4 v12, s[28:31], s67 offen lds
    s_add_u32 m0, s65, 12288
    s_add_u32 s66, s66, 1
    buffer_load_dwordx4 v13, s[32:35], s68 offen offset:0 lds
    buffer_load_dwordx4 v14, s[32:35], s68 offen offset:1024 lds
    buffer_load_dwordx4 v15, s[32:35], s68 offen offset:2048 lds
    s_add_u32 m0, s65, 24576
    s_cmp_eq_u32 s66, 9
    s_cselect_b32 s66, 0, s66
    buffer_load_dwordx4 v13, s[32:35], s69 offen offset:0 lds
    buffer_load_dwordx4 v14, s[32:35], s69 offen offset:1024 lds
    buffer_load_dwordx4 v15, s[32:35], s69 offen offset:2048 lds
    s_add_u32 s65, s65, 36864
    s_cmp_eq_u32 s65, s70
    s_cselect_b32 s65, s64, s65
    s_setpc_b64 s[98:99]
F_pre:
    s_cmp_ge_u32 s2, 256
    s_cbranch_scc1 L_end
    s_getpc_b64 s[58:59]
P_main:
    v_lshlrev_b32 v2, 7, v0
    v_cmp_gt_u32 vcc, L_last-P_main, v2
    s_nop 1
    v_cndmask_b32 v2, 0, v2, vcc
    global_load_dword v219, v2, s[58:59]
    s_branch F_start
C_pre:
    v_and_b32 v0, 63, v0
    s_mov_b32 s3, 0x40000
    s_mov_b32 s47, 0xffff0000
    s_mov_b32 s26, 7340032
    s_mov_b32 s27, 0x00020000
    s_mov_b32 s38, 819200
    s_mov_b32 s39, 0x00020000
    s_mov_b32 s42, 2621440
    s_mov_b32 s43, 0x00020000
    s_sub_u32 s52, s51, 5
    s_cselect_b32 s52, s51, s52
    v_and_b32 v1, 15, v0
    v_lshrrev_b32 v2, 4, v0
    s_mov_b32 s64, 0x21698350
    s_movk_i32 s65, 0x74
    s_lshl_b32 s62, s51, 2
    s_lshr_b64 s[64:65], s[64:65], s62
    s_and_b32 s64, s64, 15
    s_mul_i32 s60, s64, 12
    s_lshl_b32 s61, s48, 2
    s_add_u32 s60, s60, s61
    v_add_u32 v10, s60, v2
    v_add_u32 v11, s55, v10
    v_cmp_gt_i32 vcc, 0, v11
    v_lshl_add_u32 v11, v11, 1, s50
    v_mul_u32_u24 v11, 1280, v11
    v_lshl_add_u32 v11, v1, 4, v11
    v_cndmask_b32 v11, v11, 2.0, vcc
    s_mov_b32 s34, 1280
    s_mov_b32 s35, 0x00020000
    s_lshl_b32 s62, s53, 1
    s_add_u32 s62, s62, s64
    s_mul_i32 s62, s62, 4
    s_add_u32 s62, s62, s61
    s_sub_u32 s62, s62, 32
    s_cmp_lt_u32 s48, 1
    s_cselect_b32 s62, s62, 640
    s_mul_i32 s63, s64, 24
    s_add_u32 s63, s63, s53
    s_add_u32 s63, s63, 192
    s_cmp_lt_u32 s64, 8
    s_cselect_b32 s65, 3, 0
    s_cselect_b32 s62, s63, s62
    s_cselect_b32 s63, 192, 1
    v_lshlrev_b32 v58, 4, v0
    v_lshlrev_b32 v59, 2, v0
    s_waitcnt lgkmcnt(0)
    s_buffer_load_dword s54, s[24:27], 0
    s_mov_b64 s[32:33], s[12:13]
    s_cmp_lt_u32 s48, s65
    s_cbranch_scc0 A_nors
    buffer_load_dwordx4 v[20:23], v11, s[28:31], 0 offen offset:0
    buffer_load_dwordx4 v[24:27], v11, s[28:31], 0 offen offset:256
    buffer_load_dwordx4 v[28:31], v11, s[28:31], 0 offen offset:512
    buffer_load_dwordx4 v[32:35], v11, s[28:31], 0 offen offset:768
    buffer_load_dwordx4 v[36:39], v11, s[28:31], 0 offen offset:1024
    s_branch A_cons
A_nors:
    s_cmp_lg_u32 s48, 3
    s_cbranch_scc1 A_nowr
    buffer_load_dwordx4 v[48:51], v58, s[32:35], 0 offen
    buffer_load_dword v52, v59, s[32:35], 0 offen offset:1024
A_nowr:
    s_cmp_ge_u32 s62, 640
    s_cbranch_scc1 A_cons
    v_mul_u32_u24 v10, s63, v2
    v_add_u32 v10, s62, v10
    v_lshlrev_b32 v12, 4, v1
    v_mul_u32_u24 v11, 1280, v10
    v_add_u32 v11, v11, v12
    buffer_load_dwordx4 v[76:79], v12, s[32:35], 0 offen offset:0
    buffer_load_dwordx4 v[80:83], v12, s[32:35], 0 offen offset:256
    buffer_load_dwordx4 v[84:87], v12, s[32:35], 0 offen offset:512
    buffer_load_dwordx4 v[88:91], v12, s[32:35], 0 offen offset:768
    buffer_load_dwordx4 v[92:95], v12, s[32:35], 0 offen offset:1024
    buffer_load_dwordx4 v[20:23], v11, s[36:39], 0 offen offset:0
    buffer_load_dwordx4 v[24:27], v11, s[36:39], 0 offen offset:256
    buffer_load_dwordx4 v[28:31], v11, s[36:39], 0 offen offset:512
    buffer_load_dwordx4 v[32:35], v11, s[36:39], 0 offen offset:768
    buffer_load_dwordx4 v[36:39], v11, s[36:39], 0 offen offset:1024
A_cons:
    v_mov_b32 v99, 2.0
    v_lshrrev_b32 v3, 1, v1
    v_xor_b32 v3, v3, v2
    v_lshlrev_b32 v3, 4, v3
    v_lshl_add_u32 v4, v1, 7, v3
    v_xor_b32 v5, 64, v4
    v_cmp_eq_u32 vcc, 0, v1
    v_mov_b32 v3, 159744
    s_nop 0
    v_cndmask_b32 v6, v4, v3, vcc
    v_cndmask_b32 v7, v5, v3, vcc
    v_cndmask_b32 v8, 1, 0, vcc
    v_bfe_u32 v14, v0, 2, 2
    v_and_b32 v15, 3, v0
    v_lshrrev_b32 v16, 1, v14
    v_and_b32 v17, 1, v2
    v_lshl_or_b32 v16, v17, 1, v16
    v_xor_b32 v16, s48, v16
    v_lshlrev_b32 v16, 5, v16
    v_lshl_add_u32 v16, v15, 3, v16
    v_lshl_add_u32 v16, v14, 7, v16
    v_mul_u32_u24 v17, 3072, v2
    v_add_u32 v9, v16, v17
    v_mov_b32 v16, 0x3f803f80
    v_mov_b32 v17, v16
    v_mov_b32 v18, v16
    v_mov_b32 v19, v16
    ds_write_b128 v3, v[16:19]
    v_mov_b64 v[100:101], 0
    v_mov_b64 v[102:103], 0
    v_mov_b64 v[104:105], 0
    v_mov_b64 v[106:107], 0
    v_mov_b64 v[108:109], 0
    v_mov_b64 v[110:111], 0
    v_mov_b64 v[112:113], 0
    v_mov_b64 v[114:115], 0
    v_mov_b64 v[116:117], 0
    v_mov_b64 v[118:119], 0
    v_mov_b64 v[120:121], 0
    v_mov_b64 v[122:123], 0
    v_mov_b64 v[124:125], 0
    v_mov_b64 v[126:127], 0
    v_mov_b64 v[128:129], 0
    v_mov_b64 v[130:131], 0
    v_mov_b64 v[132:133], 0
    v_mov_b64 v[134:135], 0
    v_mov_b64 v[136:137], 0
    v_mov_b64 v[138:139], 0
    v_mov_b64 v[140:141], 0
    v_mov_b64 v[142:143], 0
    v_mov_b64 v[144:145], 0
    v_mov_b64 v[146:147], 0
    v_mov_b64 v[148:149], 0
    v_mov_b64 v[150:151], 0
    v_mov_b64 v[152:153], 0
    v_mov_b64 v[154:155], 0
    v_mov_b64 v[156:157], 0
    v_mov_b64 v[158:159], 0
    v_mov_b64 v[160:161], 0
    v_mov_b64 v[162:163], 0
    v_mov_b64 v[164:165], 0
    v_mov_b64 v[166:167], 0
    v_mov_b64 v[168:169], 0
    v_mov_b64 v[170:171], 0
    s_call_b64 s[98:99], S_late
    s_call_b64 s[98:99], S_late2
    s_call_b64 s[98:99], S_late3
    s_call_b64 s[98:99], S_late4
    s_branch A_c2
S_late:
    v_and_b32 v200, 15, v0
    v_lshrrev_b32 v201, 4, v0
    v_lshlrev_b32 v202, 4, v0
    v_lshlrev_b32 v203, 2, v0
    v_lshrrev_b32 v64, 5, v0
    v_and_b32 v65, 12, v200
    s_lshl_b32 s4, s52, 3
    s_sub_u32 s4, 96768, s4
    s_min_u32 s5, s48, 5
    s_lshl_b32 s6, s5, 4
    v_add_u32 v67, s6, v200
    v_mul_u32_u24 v68, 400, v67
    v_mad_u32_u24 v66, v201, 40, s4
    v_add_u32 v71, v68, v66
    v_subrev_u32 v205, 3072, v71
    v_mul_u32_u24 v72, 5, v201
    v_subrev_u32 v72, s52, v72
    v_mov_b32 v73, 159776
    v_add_u32 v74, 0, v72
    v_cmp_gt_u32 vcc, 16, v74
    v_add_u32 v74, 0, v71
    s_nop 0
    v_cndmask_b32 v204, v73, v74, vcc
    v_add_u32 v74, 1, v72
    v_cmp_gt_u32 vcc, 16, v74
    v_add_u32 v74, 8, v71
    s_nop 0
    v_cndmask_b32 v229, v73, v74, vcc
    v_add_u32 v74, 2, v72
    v_cmp_gt_u32 vcc, 16, v74
    v_add_u32 v74, 16, v71
    s_nop 0
    v_cndmask_b32 v230, v73, v74, vcc
    v_add_u32 v74, 3, v72
    v_cmp_gt_u32 vcc, 16, v74
    v_add_u32 v74, 24, v71
    s_nop 0
    v_cndmask_b32 v231, v73, v74, vcc
    v_add_u32 v74, 4, v72
    v_cmp_gt_u32 vcc, 16, v74
    v_add_u32 v74, 32, v71
    s_nop 0
    v_cndmask_b32 v255, v73, v74, vcc
    v_lshlrev_b32 v208, 3, v67
    v_add_u32 v208, 159808, v208
    v_add_u32 v69, s6, v65
    v_lshlrev_b32 v209, 3, v69
    v_add_u32 v209, 159748, v209
    v_and_b32 v70, 3, v0
    v_cmp_gt_u32 vcc, 1, v70
    v_mov_b32 v73, s47
    s_nop 0
    v_cndmask_b32 v207, 0, v73, vcc
    v_cmp_gt_u32 vcc, 3, v70
    s_nop 1
    v_cndmask_b32 v211, 0, v73, vcc
    v_cmp_gt_u32 vcc, 2, v70
    s_nop 1
    v_cndmask_b32 v211, v211, -1, vcc
    s_setpc_b64 s[98:99]
S_late2:
    s_lshl_b32 s7, s5, 12
    s_add_u32 s7, s7, 135184
    v_lshl_add_u32 v66, v0, 6, s7
    v_lshl_add_u32 v210, v65, 1, v66
    s_add_u32 s13, s6, s55
    v_add_u32 v212, s13, v65
    s_mul_i32 s8, s53, 6
    s_mul_i32 s9, s8, 24320
    s_add_u32 s9, s9, 1310720
    s_mul_i32 s0, s48, 24320
    s_add_u32 s0, s0, s9
    v_lshlrev_b32 v206, 4, v200
    v_lshl_add_u32 v206, v64, 8, v206
    v_xor_b32 v213, 256, v206
    v_lshl_add_u32 v213, v64, 12, v213
    s_cmp_lg_u32 s52, 0
    s_cselect_b32 s20, 0x0000ffff, 0
    s_cmp_lg_u32 s52, 4
    s_cselect_b32 s21, s47, 0
    s_cmp_eq_u32 s48, 0
    s_cselect_b32 s7, 0xff00ff00, -1
    s_and_b32 s20, s20, s7
    s_and_b32 s21, s21, s7
    s_lshl_b32 s7, s51, 11
    s_add_u32 s22, s0, s7
    s_sub_u32 s12, s22, 2048
    s_add_u32 s100, s9, 23040
    s_lshr_b32 s7, s51, 1
    s_mul_i32 s7, s7, 23552
    s_mul_i32 s57, s51, 384
    s_add_u32 s7, s7, s57
    s_add_u32 s7, s7, 23552
    s_add_u32 s57, s7, s9
    s_mul_i32 s7, s48, 10
    s_add_u32 s7, s7, s51
    s_lshl_b32 s7, s7, 2
    s_add_u32 s23, s100, s7
    s_sub_u32 s56, s48, 2
    s_cmp_lt_u32 s48, 6
    s_cselect_b32 s101, 0, 1
    s_cselect_b32 s56, s48, s56
    s_mul_i32 s1, s56, 24320
    s_add_u32 s1, s1, s9
    s_add_u32 s8, s8, s56
    s_mul_i32 s44, s53, 2560
    s_lshl_b32 s7, s51, 8
    s_add_u32 s44, s44, s7
    s_add_u32 s44, s44, 262144
    s_lshl_b32 s45, s53, 6
    s_add_u32 s45, s45, 196608
    s_setpc_b64 s[98:99]
S_late3:
    v_bfe_u32 v68, v0, 2, 2
    v_and_b32 v69, 3, v0
    v_lshl_add_u32 v70, v201, 3, v68
    s_lshl_b32 s7, s48, 4
    s_sub_u32 s7, s7, 16
    v_add_u32 v71, s7, v70
    v_and_b32 v72, 15, v71
    v_max_i32 v71, v71, v72
    v_mul_u32_u24 v71, 400, v71
    v_lshl_add_u32 v71, v69, 3, v71
    v_add_u32 v214, 97024, v71
    v_and_b32 v72, 1, v201
    s_cmp_eq_u32 s48, 0
    s_cselect_b32 s7, 8, 0
    v_cmp_gt_u32 vcc, s7, v200
    s_nop 1
    v_cndmask_b32 v249, v202, 2.0, vcc
    v_lshrrev_b32 v71, 1, v68
    v_lshl_or_b32 v71, v72, 1, v71
    v_lshl_add_u32 v70, v201, 2, v68
    v_lshlrev_b32 v70, 7, v70
    v_lshl_add_u32 v70, v69, 3, v70
    s_mul_i32 s7, s101, 40960
    s_add_u32 s7, s7, 12288
    v_add_u32 v70, s7, v70
    s_mul_i32 s7, s101, 36864
    s_sub_u32 s7, 40960, s7
    v_xor_b32 v73, 0, v71
    v_lshl_add_u32 v216, v73, 5, v70
    v_add_u32 v220, s7, v216
    v_xor_b32 v73, 1, v71
    v_lshl_add_u32 v217, v73, 5, v70
    v_add_u32 v221, s7, v217
    v_xor_b32 v73, 2, v71
    v_lshl_add_u32 v218, v73, 5, v70
    v_add_u32 v222, s7, v218
    v_xor_b32 v73, 3, v71
    v_lshl_add_u32 v219, v73, 5, v70
    v_add_u32 v223, s7, v219
    s_setpc_b64 s[98:99]
S_late4:
    s_lshl_b32 s7, s56, 4
    v_add_u32 v73, s7, v200
    v_cmp_gt_u32 vcc, 10, v73
    v_add_u32 v73, s55, v73
    v_lshl_add_u32 v73, v73, 1, s50
    v_mul_u32_u24 v74, 1280, v73
    s_lshl_b32 s7, s51, 7
    v_lshl_add_u32 v75, v201, 3, s7
    v_add_u32 v74, v74, v75
    v_cndmask_b32 v253, v74, 2.0, vcc
    v_cndmask_b32 v254, v73, -1, vcc
    v_add_u32 v227, 161792, v75
    v_mul_u32_u24 v224, 61440, v201
    v_lshl_add_u32 v224, v200, 4, v224
    s_mov_b32 s7, 161024
    v_lshl_add_u32 v228, v201, 5, s7
    v_lshl_add_u32 v252, v69, 5, s7
    v_lshl_add_u32 v252, v68, 3, v252
    v_mul_u32_u24 v225, 24, v72
    v_add_u32 v225, v225, v253
    v_lshl_add_u32 v226, s8, 4, v200
    s_cmp_eq_u32 s101, 1
    s_cselect_b64 vcc, -1, 0
    v_lshrrev_b32 v73, 1, v200
    v_lshrrev_b32 v74, 1, v201
    v_xor_b32 v73, v73, v74
    v_lshlrev_b32 v73, 4, v73
    v_lshl_add_u32 v73, v72, 3, v73
    v_lshl_add_u32 v73, v200, 7, v73
    v_lshl_add_u32 v250, s56, 11, v73
    v_mov_b32 v251, 160784
    s_add_u32 s7, s52, 5
    s_cmp_lt_u32 s51, 5
    s_cselect_b32 s7, s7, s52
    s_lshl_b32 s7, s7, 11
    s_add_u32 s16, s7, s1
    s_lshl_b32 s7, s51, 11
    s_add_u32 s14, s7, s1
    s_add_u32 s15, s1, 20480
    s_cmp_eq_u32 s101, 1
    s_cselect_b32 s14, s16, s14
    s_cselect_b32 s18, 0x3e0, 62
    s_lshl_b32 s7, s101, 10
    s_add_u32 s16, s16, s7
    s_cmp_lt_u32 s48, 4
    s_cselect_b32 s18, 0x3fe, s18
    s_lshl_b32 s18, s18, s51
    s_lshr_b32 s7, s18, 10
    s_or_b32 s18, s18, s7
    s_and_b32 s18, s18, 0x3ff
    s_mov_b32 s19, 0
    s_mul_i32 s17, s56, 40
    s_add_u32 s17, s17, s100
    s_lshl_b32 s7, s48, 12
    s_add_u32 s7, s7, 135168
    v_lshl_add_u32 v73, v200, 6, s7
    v_lshl_add_u32 v73, v201, 4, v73
    v_add_u32 v74, s52, v201
    s_add_u32 s69, s52, 0
    s_mul_i32 s69, s69, 52
    s_lshr_b32 s69, s69, 8
    v_lshl_add_u32 v172, s69, 10, v73
    s_add_u32 s69, s52, 3
    s_mul_i32 s69, s69, 52
    s_lshr_b32 s69, s69, 8
    v_lshl_add_u32 v173, s69, 10, v73
    s_mul_i32 s69, s69, 5
    s_sub_u32 s69, s69, 0
    v_cmp_le_i32 s[4:5], s69, v74
    s_add_u32 s69, s52, 4
    s_mul_i32 s69, s69, 52
    s_lshr_b32 s69, s69, 8
    v_lshl_add_u32 v174, s69, 10, v73
    s_add_u32 s69, s52, 7
    s_mul_i32 s69, s69, 52
    s_lshr_b32 s69, s69, 8
    v_lshl_add_u32 v175, s69, 10, v73
    s_mul_i32 s69, s69, 5
    s_sub_u32 s69, s69, 4
    v_cmp_le_i32 s[6:7], s69, v74
    s_add_u32 s69, s52, 8
    s_mul_i32 s69, s69, 52
    s_lshr_b32 s69, s69, 8
    v_lshl_add_u32 v176, s69, 10, v73
    s_add_u32 s69, s52, 11
    s_mul_i32 s69, s69, 52
    s_lshr_b32 s69, s69, 8
    v_lshl_add_u32 v177, s69, 10, v73
    s_mul_i32 s69, s69, 5
    s_sub_u32 s69, s69, 8
    v_cmp_le_i32 s[8:9], s69, v74
    s_add_u32 s69, s52, 12
    s_mul_i32 s69, s69, 52
    s_lshr_b32 s69, s69, 8
    v_lshl_add_u32 v178, s69, 10, v73
    s_add_u32 s69, s52, 15
    s_mul_i32 s69, s69, 52
    s_lshr_b32 s69, s69, 8
    v_lshl_add_u32 v179, s69, 10, v73
    s_mul_i32 s69, s69, 5
    s_sub_u32 s69, s69, 12
    v_cmp_le_i32 s[10:11], s69, v74
    s_setpc_b64 s[98:99]
A_c2:
    s_waitcnt lgkmcnt(0)
    s_add_u32 s54, s54, 2654435761
    s_lshl_b32 s63, s53, 11
    s_add_u32 s63, s63, 81920
    v_mov_b32 v42, s54
    v_lshlrev_b32 v10, 4, v10
    s_cmp_lt_u32 s48, s65
    s_cbranch_scc0 A_nos
    s_waitcnt vmcnt(4)
    v_dot2_f32_bf16 v40, v20, v16, 0
    v_dot2_f32_bf16 v41, v20, v20, 0
    v_dot2_f32_bf16 v44, v21, v16, 0
    v_dot2_f32_bf16 v45, v21, v21, 0
    v_dot2_f32_bf16 v40, v22, v16, v40
    v_dot2_f32_bf16 v41, v22, v22, v41
    v_dot2_f32_bf16 v44, v23, v16, v44
    v_dot2_f32_bf16 v45, v23, v23, v45
    s_waitcnt vmcnt(3)
    v_dot2_f32_bf16 v40, v24, v16, v40
    v_dot2_f32_bf16 v41, v24, v24, v41
    v_dot2_f32_bf16 v44, v25, v16, v44
    v_dot2_f32_bf16 v45, v25, v25, v45
    v_dot2_f32_bf16 v40, v26, v16, v40
    v_dot2_f32_bf16 v41, v26, v26, v41
    v_dot2_f32_bf16 v44, v27, v16, v44
    v_dot2_f32_bf16 v45, v27, v27, v45
    s_waitcnt vmcnt(2)
    v_dot2_f32_bf16 v40, v28, v16, v40
    v_dot2_f32_bf16 v41, v28, v28, v41
    v_dot2_f32_bf16 v44, v29, v16, v44
    v_dot2_f32_bf16 v45, v29, v29, v45
    v_dot2_f32_bf16 v40, v30, v16, v40
    v_dot2_f32_bf16 v41, v30, v30, v41
    v_dot2_f32_bf16 v44, v31, v16, v44
    v_dot2_f32_bf16 v45, v31, v31, v45
    s_waitcnt vmcnt(1)
    v_dot2_f32_bf16 v40, v32, v16, v40
    v_dot2_f32_bf16 v41, v32, v32, v41
    v_dot2_f32_bf16 v44, v33, v16, v44
    v_dot2_f32_bf16 v45, v33, v33, v45
    v_dot2_f32_bf16 v40, v34, v16, v40
    v_dot2_f32_bf16 v41, v34, v34, v41
    v_dot2_f32_bf16 v44, v35, v16, v44
    v_dot2_f32_bf16 v45, v35, v35, v45
    s_waitcnt vmcnt(0)
    v_dot2_f32_bf16 v40, v36, v16, v40
    v_dot2_f32_bf16 v41, v36, v36, v41
    v_dot2_f32_bf16 v44, v37, v16, v44
    v_dot2_f32_bf16 v45, v37, v37, v45
    v_dot2_f32_bf16 v40, v38, v16, v40
    v_dot2_f32_bf16 v41, v38, v38, v41
    v_dot2_f32_bf16 v44, v39, v16, v44
    v_dot2_f32_bf16 v45, v39, v39, v45
A_red:
    s_nop 1
    v_add_f32 v40, v40, v44
    v_add_f32 v41, v41, v45
    s_nop 0
    v_add_f32_dpp v40, v40, v40 row_ror:1 row_mask:0xf bank_mask:0xf
    v_add_f32_dpp v41, v41, v41 row_ror:1 row_mask:0xf bank_mask:0xf
    s_nop 0
    v_add_f32_dpp v40, v40, v40 row_ror:2 row_mask:0xf bank_mask:0xf
    v_add_f32_dpp v41, v41, v41 row_ror:2 row_mask:0xf bank_mask:0xf
    s_nop 0
    v_add_f32_dpp v40, v40, v40 row_ror:4 row_mask:0xf bank_mask:0xf
    v_add_f32_dpp v41, v41, v41 row_ror:4 row_mask:0xf bank_mask:0xf
    s_nop 0
    v_add_f32_dpp v40, v40, v40 row_ror:8 row_mask:0xf bank_mask:0xf
    v_add_f32_dpp v41, v41, v41 row_ror:8 row_mask:0xf bank_mask:0xf
    s_cselect_b32 s64, s63, 1245184
    s_cbranch_scc0 A_nln
    v_mul_f32 v40, 0x3acccccd, v40
    v_mul_f32 v41, 0x3acccccd, v41
    v_fma_f32 v41, -v40, v40, v41
    v_max_f32 v41, 0, v41
    v_cvt_pk_bf16_f32 v41, v41, v41
    v_and_b32 v41, 0xffff0000, v41
    v_add_f32 v41, 0x3727c5ac, v41
    v_cvt_pk_bf16_f32 v41, v41, v41
    v_and_b32 v41, 0xffff0000, v41
    v_sqrt_f32 v41, v41
    v_cvt_pk_bf16_f32 v40, v40, v40
    v_and_b32 v40, 0xffff0000, v40
    v_cvt_pk_bf16_f32 v41, v41, v41
    v_and_b32 v41, 0xffff0000, v41
    v_rcp_f32 v41, v41
A_nln:
    s_mov_b32 exec_lo, 0x00010001
    s_mov_b32 exec_hi, 0x00010001
    buffer_store_dwordx3 v[40:42], v10, s[24:27], s64 offen sc1
    s_mov_b64 exec, -1
A_w3:
    s_cmp_lg_u32 s48, 3
    s_cbranch_scc1 A_go
    s_getreg_b32 s61, hwreg(HW_REG_XCC_ID)
    s_lshl_b32 s64, s51, 4
    s_add_u32 s64, s64, 1536
    v_mov_b32 v44, s61
    v_mov_b32 v43, s64
    v_mov_b32 v46, s54
    s_mov_b64 exec, 1
    buffer_store_dwordx3 v[44:46], v43, s[24:27], s63 offen sc1
    s_mov_b64 exec, -1
    v_add_u32 v58, 161792, v58
    v_add_u32 v59, 161792, v59
    s_cmp_lt_u32 s62, 640
    s_cbranch_scc1 A_w3l
    s_waitcnt vmcnt(1)
A_w3l:
    ds_write_b128 v58, v[48:51]
    ds_write_b32 v59, v52 offset:1024
    v_dot2_f32_bf16 v25, v48, v16, 0
    v_dot2_f32_bf16 v25, v49, v16, v25
    v_dot2_f32_bf16 v25, v50, v16, v25
    v_dot2_f32_bf16 v25, v51, v16, v25
    v_dot2_f32_bf16 v25, v52, v16, v25
    s_nop 2
    v_add_f32_dpp v25, v25, v25 row_ror:1 row_mask:0xf bank_mask:0xf
    s_nop 1
    v_add_f32_dpp v25, v25, v25 row_ror:2 row_mask:0xf bank_mask:0xf
    s_nop 1
    v_add_f32_dpp v25, v25, v25 row_ror:4 row_mask:0xf bank_mask:0xf
    s_nop 1
    v_add_f32_dpp v25, v25, v25 row_ror:8 row_mask:0xf bank_mask:0xf
    v_mov_b32 v26, v25
    s_nop 1
    v_permlane32_swap_b32 v25, v26
    v_add_f32 v25, v25, v26
    v_mov_b32 v26, v25
    s_nop 1
    v_permlane16_swap_b32 v25, v26
    v_add_f32 v25, v25, v26
    v_mov_b32 v58, 161792
    ds_write_b32 v58, v25 offset:1280
    s_waitcnt lgkmcnt(0)
    s_branch A_go
A_nos:
    s_cmp_ge_u32 s62, 640
    s_cbranch_scc1 A_w3
    s_waitcnt vmcnt(4)
    v_dot2_f32_bf16 v40, v20, v16, 0
    v_dot2_f32_bf16 v41, v20, v76, 0
    v_dot2_f32_bf16 v44, v21, v16, 0
    v_dot2_f32_bf16 v45, v21, v77, 0
    v_dot2_f32_bf16 v40, v22, v16, v40
    v_dot2_f32_bf16 v41, v22, v78, v41
    v_dot2_f32_bf16 v44, v23, v16, v44
    v_dot2_f32_bf16 v45, v23, v79, v45
    s_waitcnt vmcnt(3)
    v_dot2_f32_bf16 v40, v24, v16, v40
    v_dot2_f32_bf16 v41, v24, v80, v41
    v_dot2_f32_bf16 v44, v25, v16, v44
    v_dot2_f32_bf16 v45, v25, v81, v45
    v_dot2_f32_bf16 v40, v26, v16, v40
    v_dot2_f32_bf16 v41, v26, v82, v41
    v_dot2_f32_bf16 v44, v27, v16, v44
    v_dot2_f32_bf16 v45, v27, v83, v45
    s_waitcnt vmcnt(2)
    v_dot2_f32_bf16 v40, v28, v16, v40
    v_dot2_f32_bf16 v41, v28, v84, v41
    v_dot2_f32_bf16 v44, v29, v16, v44
    v_dot2_f32_bf16 v45, v29, v85, v45
    v_dot2_f32_bf16 v40, v30, v16, v40
    v_dot2_f32_bf16 v41, v30, v86, v41
    v_dot2_f32_bf16 v44, v31, v16, v44
    v_dot2_f32_bf16 v45, v31, v87, v45
    s_waitcnt vmcnt(1)
    v_dot2_f32_bf16 v40, v32, v16, v40
    v_dot2_f32_bf16 v41, v32, v88, v41
    v_dot2_f32_bf16 v44, v33, v16, v44
    v_dot2_f32_bf16 v45, v33, v89, v45
    v_dot2_f32_bf16 v40, v34, v16, v40
    v_dot2_f32_bf16 v41, v34, v90, v41
    v_dot2_f32_bf16 v44, v35, v16, v44
    v_dot2_f32_bf16 v45, v35, v91, v45
    s_waitcnt vmcnt(0)
    v_dot2_f32_bf16 v40, v36, v16, v40
    v_dot2_f32_bf16 v41, v36, v92, v41
    v_dot2_f32_bf16 v44, v37, v16, v44
    v_dot2_f32_bf16 v45, v37, v93, v45
    v_dot2_f32_bf16 v40, v38, v16, v40
    v_dot2_f32_bf16 v41, v38, v94, v41
    v_dot2_f32_bf16 v44, v39, v16, v44
    v_dot2_f32_bf16 v45, v39, v95, v45
    s_branch A_red
A_go:
    v_lshlrev_b32 v18, 3, v1
    v_add_u32 v18, 159808, v18
    v_mul_u32_u24 v3, 400, v1
    v_lshl_add_u32 v3, v2, 3, v3
    s_lshl_b32 s60, s48, 5
    s_add_u32 s60, s60, 96768
    v_add_u32 v3, s60, v3
    v_mov_b32 v17, 160768
    s_mov_b32 s60, 0
    v_add_u32 v14, s60, v9
    v_mad_u32_u24 v10, v8, s60, v6
    v_add_u32 v12, s60, v4
    v_mad_u32_u24 v11, v8, s60, v7
    v_add_u32 v13, s60, v5
    s_mov_b32 s61, 0
    s_barrier
    ds_read_b64_tr_b16 v[44:45], v14 offset:12288
    ds_read_b64_tr_b16 v[46:47], v14 offset:12800
    ds_read_b64_tr_b16 v[48:49], v14 offset:13312
    ds_read_b64_tr_b16 v[50:51], v14 offset:13824
    ds_read_b64_tr_b16 v[52:53], v14 offset:14336
    ds_read_b64_tr_b16 v[54:55], v14 offset:14848
    ds_read_b128 v[20:23], v10
    ds_read_b128 v[24:27], v12 offset:2048
    ds_read_b128 v[28:31], v12 offset:4096
    ds_read_b128 v[32:35], v12 offset:6144
    ds_read_b128 v[36:39], v12 offset:8192
    ds_read_b128 v[40:43], v12 offset:10240
A_loop:
    s_waitcnt lgkmcnt(0)
    v_mfma_f32_16x16x32_bf16 v[100:103], v[44:47], v[20:23], v[100:103]
    ds_read_b64_tr_b16 v[80:81], v14 offset:24576
    v_mfma_f32_16x16x32_bf16 v[104:107], v[48:51], v[20:23], v[104:107]
    ds_read_b64_tr_b16 v[82:83], v14 offset:25088
    v_mfma_f32_16x16x32_bf16 v[108:111], v[52:55], v[20:23], v[108:111]
    ds_read_b64_tr_b16 v[84:85], v14 offset:25600
    v_mfma_f32_16x16x32_bf16 v[112:115], v[44:47], v[24:27], v[112:115]
    ds_read_b64_tr_b16 v[86:87], v14 offset:26112
    v_mfma_f32_16x16x32_bf16 v[116:119], v[48:51], v[24:27], v[116:119]
    ds_read_b64_tr_b16 v[88:89], v14 offset:26624
    v_mfma_f32_16x16x32_bf16 v[120:123], v[52:55], v[24:27], v[120:123]
    ds_read_b64_tr_b16 v[90:91], v14 offset:27136
    v_mfma_f32_16x16x32_bf16 v[124:127], v[44:47], v[28:31], v[124:127]
    ds_read_b128 v[56:59], v11
    v_mfma_f32_16x16x32_bf16 v[128:131], v[48:51], v[28:31], v[128:131]
    ds_read_b128 v[60:63], v13 offset:2048
    v_mfma_f32_16x16x32_bf16 v[132:135], v[52:55], v[28:31], v[132:135]
    ds_read_b128 v[64:67], v13 offset:4096
    v_mfma_f32_16x16x32_bf16 v[136:139], v[44:47], v[32:35], v[136:139]
    ds_read_b128 v[68:71], v13 offset:6144
    v_mfma_f32_16x16x32_bf16 v[140:143], v[48:51], v[32:35], v[140:143]
    ds_read_b128 v[72:75], v13 offset:8192
    v_mfma_f32_16x16x32_bf16 v[144:147], v[52:55], v[32:35], v[144:147]
    ds_read_b128 v[76:79], v13 offset:10240
    v_mfma_f32_16x16x32_bf16 v[148:151], v[44:47], v[36:39], v[148:151]
    s_add_u32 s60, s60, 36864
    v_mfma_f32_16x16x32_bf16 v[152:155], v[48:51], v[36:39], v[152:155]
    s_add_u32 s61, s61, 1
    v_mfma_f32_16x16x32_bf16 v[156:159], v[52:55], v[36:39], v[156:159]
    s_cmp_eq_u32 s60, 110592
    v_mfma_f32_16x16x32_bf16 v[160:163], v[44:47], v[40:43], v[160:163]
    s_cselect_b32 s60, 0, s60
    v_mfma_f32_16x16x32_bf16 v[164:167], v[48:51], v[40:43], v[164:167]
    s_cmp_lt_u32 s61, 9
    v_mfma_f32_16x16x32_bf16 v[168:171], v[52:55], v[40:43], v[168:171]
    s_waitcnt lgkmcnt(0)
    v_mfma_f32_16x16x32_bf16 v[100:103], v[80:83], v[56:59], v[100:103]
    v_add_u32 v14, s60, v9
    v_mfma_f32_16x16x32_bf16 v[104:107], v[84:87], v[56:59], v[104:107]
    v_mad_u32_u24 v10, v8, s60, v6
    v_mfma_f32_16x16x32_bf16 v[108:111], v[88:91], v[56:59], v[108:111]
    v_add_u32 v12, s60, v4
    v_mfma_f32_16x16x32_bf16 v[112:115], v[80:83], v[60:63], v[112:115]
    v_mad_u32_u24 v11, v8, s60, v7
    v_mfma_f32_16x16x32_bf16 v[116:119], v[84:87], v[60:63], v[116:119]
    v_add_u32 v13, s60, v5
    v_mfma_f32_16x16x32_bf16 v[120:123], v[88:91], v[60:63], v[120:123]
    s_barrier
    v_mfma_f32_16x16x32_bf16 v[124:127], v[80:83], v[64:67], v[124:127]
    ds_read_b64_tr_b16 v[44:45], v14 offset:12288
    ds_read_b64_tr_b16 v[46:47], v14 offset:12800
    v_mfma_f32_16x16x32_bf16 v[128:131], v[84:87], v[64:67], v[128:131]
    ds_read_b64_tr_b16 v[48:49], v14 offset:13312
    ds_read_b64_tr_b16 v[50:51], v14 offset:13824
    v_mfma_f32_16x16x32_bf16 v[132:135], v[88:91], v[64:67], v[132:135]
    ds_read_b64_tr_b16 v[52:53], v14 offset:14336
    ds_read_b64_tr_b16 v[54:55], v14 offset:14848
    v_mfma_f32_16x16x32_bf16 v[136:139], v[80:83], v[68:71], v[136:139]
    ds_read_b128 v[20:23], v10
    ds_read_b128 v[24:27], v12 offset:2048
    v_mfma_f32_16x16x32_bf16 v[140:143], v[84:87], v[68:71], v[140:143]
    ds_read_b128 v[28:31], v12 offset:4096
    ds_read_b128 v[32:35], v12 offset:6144
    v_mfma_f32_16x16x32_bf16 v[144:147], v[88:91], v[68:71], v[144:147]
    ds_read_b128 v[36:39], v12 offset:8192
    ds_read_b128 v[40:43], v12 offset:10240
    v_mfma_f32_16x16x32_bf16 v[148:151], v[80:83], v[72:75], v[148:151]
    v_mfma_f32_16x16x32_bf16 v[152:155], v[84:87], v[72:75], v[152:155]
    v_mfma_f32_16x16x32_bf16 v[156:159], v[88:91], v[72:75], v[156:159]
    v_mfma_f32_16x16x32_bf16 v[160:163], v[80:83], v[76:79], v[160:163]
    v_mfma_f32_16x16x32_bf16 v[164:167], v[84:87], v[76:79], v[164:167]
    v_mfma_f32_16x16x32_bf16 v[168:171], v[88:91], v[76:79], v[168:171]
    s_cbranch_scc1 A_loop
A_tail:
    s_waitcnt lgkmcnt(0)
    v_mfma_f32_16x16x32_bf16 v[108:111], v[52:55], v[20:23], v[108:111]
    ds_read_b64_tr_b16 v[80:81], v14 offset:24576
    ds_read_b64_tr_b16 v[82:83], v14 offset:25088
    v_mfma_f32_16x16x32_bf16 v[120:123], v[52:55], v[24:27], v[120:123]
    ds_read_b64_tr_b16 v[84:85], v14 offset:25600
    ds_read_b64_tr_b16 v[86:87], v14 offset:26112
    v_mfma_f32_16x16x32_bf16 v[132:135], v[52:55], v[28:31], v[132:135]
    ds_read_b128 v[56:59], v11
    ds_read_b128 v[60:63], v13 offset:2048
    v_mfma_f32_16x16x32_bf16 v[144:147], v[52:55], v[32:35], v[144:147]
    ds_read_b64 v[184:185], v18 offset:0
    ds_read_b64 v[186:187], v18 offset:128
    v_mfma_f32_16x16x32_bf16 v[156:159], v[52:55], v[36:39], v[156:159]
    ds_read_b128 v[64:67], v13 offset:4096
    ds_read_b128 v[68:71], v13 offset:6144
    v_mfma_f32_16x16x32_bf16 v[168:171], v[52:55], v[40:43], v[168:171]
    ds_read_b128 v[72:75], v13 offset:8192
    ds_read_b128 v[76:79], v13 offset:10240
    v_mfma_f32_16x16x32_bf16 v[100:103], v[44:47], v[20:23], v[100:103]
    ds_read_b64_tr_b16 v[88:89], v14 offset:26624
    ds_read_b64_tr_b16 v[90:91], v14 offset:27136
    v_mfma_f32_16x16x32_bf16 v[104:107], v[48:51], v[20:23], v[104:107]
    ds_read_b64 v[188:189], v18 offset:256
    ds_read_b64 v[190:191], v18 offset:384
    v_mfma_f32_16x16x32_bf16 v[112:115], v[44:47], v[24:27], v[112:115]
    ds_read_b64 v[192:193], v18 offset:512
    ds_read_b64 v[194:195], v18 offset:640
    v_mfma_f32_16x16x32_bf16 v[116:119], v[48:51], v[24:27], v[116:119]
    ds_read_b32 v17, v17
    s_waitcnt lgkmcnt(11)
    v_mfma_f32_16x16x32_bf16 v[100:103], v[80:83], v[56:59], v[100:103]
    ds_read_b32 v16, v208 offset:4
    ds_read2_b32 v[4:5], v209 offset0:0 offset1:2
    v_mfma_f32_16x16x32_bf16 v[104:107], v[84:87], v[56:59], v[104:107]
    ds_read2_b32 v[6:7], v209 offset0:4 offset1:6
    ds_read2_b32 v[8:9], v209 offset0:8 offset1:10
    v_mfma_f32_16x16x32_bf16 v[112:115], v[80:83], v[60:63], v[112:115]
    ds_read2_b32 v[10:11], v209 offset0:12 offset1:14
    ds_read2_b32 v[12:13], v209 offset0:16 offset1:18
    v_mfma_f32_16x16x32_bf16 v[116:119], v[84:87], v[60:63], v[116:119]
    ds_read2_b32 v[14:15], v209 offset0:20 offset1:22
    s_waitcnt lgkmcnt(7)
    v_mfma_f32_16x16x32_bf16 v[124:127], v[44:47], v[28:31], v[124:127]
    v_mov_b32_dpp v20, v100 row_newbcast:0 row_mask:0xf bank_mask:0xf
    v_mov_b32_dpp v21, v101 row_newbcast:0 row_mask:0xf bank_mask:0xf
    v_mov_b32_dpp v22, v102 row_newbcast:0 row_mask:0xf bank_mask:0xf
    v_mfma_f32_16x16x32_bf16 v[128:131], v[48:51], v[28:31], v[128:131]
    v_mov_b32_dpp v23, v103 row_newbcast:0 row_mask:0xf bank_mask:0xf
    v_mov_b32_dpp v24, v104 row_newbcast:0 row_mask:0xf bank_mask:0xf
    v_mov_b32_dpp v25, v105 row_newbcast:0 row_mask:0xf bank_mask:0xf
    v_mfma_f32_16x16x32_bf16 v[124:127], v[80:83], v[64:67], v[124:127]
    v_mov_b32_dpp v26, v106 row_newbcast:0 row_mask:0xf bank_mask:0xf
    v_mov_b32_dpp v27, v107 row_newbcast:0 row_mask:0xf bank_mask:0xf
    v_pk_fma_f32 v[100:101], v[184:185], v[20:21], v[100:101] op_sel_hi:[0,1,1] neg_lo:[1,0,0] neg_hi:[1,0,0]
    v_mfma_f32_16x16x32_bf16 v[128:131], v[84:87], v[64:67], v[128:131]
    v_pk_fma_f32 v[102:103], v[184:185], v[22:23], v[102:103] op_sel_hi:[0,1,1] neg_lo:[1,0,0] neg_hi:[1,0,0]
    v_pk_fma_f32 v[104:105], v[184:185], v[24:25], v[104:105] op_sel_hi:[0,1,1] neg_lo:[1,0,0] neg_hi:[1,0,0]
    v_pk_fma_f32 v[106:107], v[184:185], v[26:27], v[106:107] op_sel_hi:[0,1,1] neg_lo:[1,0,0] neg_hi:[1,0,0]
    v_mfma_f32_16x16x32_bf16 v[136:139], v[44:47], v[32:35], v[136:139]
    v_cvt_pk_bf16_f32 v100, v100, v101
    v_cvt_pk_bf16_f32 v101, v102, v103
    ds_write_b64 v3, v[100:101] offset:0
    v_mfma_f32_16x16x32_bf16 v[140:143], v[48:51], v[32:35], v[140:143]
    v_cvt_pk_bf16_f32 v104, v104, v105
    v_cvt_pk_bf16_f32 v105, v106, v107
    ds_write_b64 v3, v[104:105] offset:128
    v_mfma_f32_16x16x32_bf16 v[136:139], v[80:83], v[68:71], v[136:139]
    v_pk_fma_f32 v[112:113], v[186:187], v[20:21], v[112:113] op_sel_hi:[0,1,1] neg_lo:[1,0,0] neg_hi:[1,0,0]
    v_pk_fma_f32 v[114:115], v[186:187], v[22:23], v[114:115] op_sel_hi:[0,1,1] neg_lo:[1,0,0] neg_hi:[1,0,0]
    v_pk_fma_f32 v[116:117], v[186:187], v[24:25], v[116:117] op_sel_hi:[0,1,1] neg_lo:[1,0,0] neg_hi:[1,0,0]
    v_mfma_f32_16x16x32_bf16 v[140:143], v[84:87], v[68:71], v[140:143]
    v_pk_fma_f32 v[118:119], v[186:187], v[26:27], v[118:119] op_sel_hi:[0,1,1] neg_lo:[1,0,0] neg_hi:[1,0,0]
    v_cvt_pk_bf16_f32 v112, v112, v113
    v_cvt_pk_bf16_f32 v113, v114, v115
    v_mfma_f32_16x16x32_bf16 v[148:151], v[44:47], v[36:39], v[148:151]
    ds_write_b64 v3, v[112:113] offset:6400
    v_cvt_pk_bf16_f32 v116, v116, v117
    v_cvt_pk_bf16_f32 v117, v118, v119
    v_mfma_f32_16x16x32_bf16 v[152:155], v[48:51], v[36:39], v[152:155]
    ds_write_b64 v3, v[116:117] offset:6528
    v_readfirstlane_b32 s49, v17
    s_mov_b32 s60, 0x07060503
    v_mfma_f32_16x16x32_bf16 v[148:151], v[80:83], v[72:75], v[148:151]
    s_mov_b32 s61, 0x07060502
    s_mov_b32 s62, 0x07060501
    s_mov_b32 s63, 0x04000c0c
    v_mfma_f32_16x16x32_bf16 v[152:155], v[84:87], v[72:75], v[152:155]
    v_pk_fma_f32 v[124:125], v[188:189], v[20:21], v[124:125] op_sel_hi:[0,1,1] neg_lo:[1,0,0] neg_hi:[1,0,0]
    v_pk_fma_f32 v[126:127], v[188:189], v[22:23], v[126:127] op_sel_hi:[0,1,1] neg_lo:[1,0,0] neg_hi:[1,0,0]
    v_pk_fma_f32 v[128:129], v[188:189], v[24:25], v[128:129] op_sel_hi:[0,1,1] neg_lo:[1,0,0] neg_hi:[1,0,0]
    v_mfma_f32_16x16x32_bf16 v[160:163], v[44:47], v[40:43], v[160:163]
    v_pk_fma_f32 v[130:131], v[188:189], v[26:27], v[130:131] op_sel_hi:[0,1,1] neg_lo:[1,0,0] neg_hi:[1,0,0]
    v_cvt_pk_bf16_f32 v124, v124, v125
    v_cvt_pk_bf16_f32 v125, v126, v127
    v_mfma_f32_16x16x32_bf16 v[164:167], v[48:51], v[40:43], v[164:167]
    ds_write_b64 v3, v[124:125] offset:12800
    v_cvt_pk_bf16_f32 v128, v128, v129
    v_cvt_pk_bf16_f32 v129, v130, v131
    v_mfma_f32_16x16x32_bf16 v[160:163], v[80:83], v[76:79], v[160:163]
    ds_write_b64 v3, v[128:129] offset:12928
    s_mov_b32 s64, 0x0706000c
    s_mov_b32 s66, 0x11111111
    v_mfma_f32_16x16x32_bf16 v[164:167], v[84:87], v[76:79], v[164:167]
    s_mov_b32 s67, s66
    s_mov_b32 s68, 0x33333333
    v_pk_fma_f32 v[136:137], v[190:191], v[20:21], v[136:137] op_sel_hi:[0,1,1] neg_lo:[1,0,0] neg_hi:[1,0,0]
    v_mfma_f32_16x16x32_bf16 v[108:111], v[88:91], v[56:59], v[108:111]
    v_pk_fma_f32 v[138:139], v[190:191], v[22:23], v[138:139] op_sel_hi:[0,1,1] neg_lo:[1,0,0] neg_hi:[1,0,0]
    v_pk_fma_f32 v[140:141], v[190:191], v[24:25], v[140:141] op_sel_hi:[0,1,1] neg_lo:[1,0,0] neg_hi:[1,0,0]
    v_pk_fma_f32 v[142:143], v[190:191], v[26:27], v[142:143] op_sel_hi:[0,1,1] neg_lo:[1,0,0] neg_hi:[1,0,0]
    v_mfma_f32_16x16x32_bf16 v[120:123], v[88:91], v[60:63], v[120:123]
    v_cvt_pk_bf16_f32 v136, v136, v137
    v_cvt_pk_bf16_f32 v137, v138, v139
    ds_write_b64 v3, v[136:137] offset:19200
    v_mfma_f32_16x16x32_bf16 v[132:135], v[88:91], v[64:67], v[132:135]
    v_cvt_pk_bf16_f32 v140, v140, v141
    v_cvt_pk_bf16_f32 v141, v142, v143
    ds_write_b64 v3, v[140:141] offset:19328
    v_mfma_f32_16x16x32_bf16 v[144:147], v[88:91], v[68:71], v[144:147]
    s_mov_b32 s69, s68
    s_mov_b32 s70, 0x77777777
    s_mov_b32 s71, s70
    v_mfma_f32_16x16x32_bf16 v[156:159], v[88:91], v[72:75], v[156:159]
    v_pk_fma_f32 v[148:149], v[192:193], v[20:21], v[148:149] op_sel_hi:[0,1,1] neg_lo:[1,0,0] neg_hi:[1,0,0]
    v_pk_fma_f32 v[150:151], v[192:193], v[22:23], v[150:151] op_sel_hi:[0,1,1] neg_lo:[1,0,0] neg_hi:[1,0,0]
    v_pk_fma_f32 v[152:153], v[192:193], v[24:25], v[152:153] op_sel_hi:[0,1,1] neg_lo:[1,0,0] neg_hi:[1,0,0]
    v_mfma_f32_16x16x32_bf16 v[168:171], v[88:91], v[76:79], v[168:171]
    v_pk_fma_f32 v[154:155], v[192:193], v[26:27], v[154:155] op_sel_hi:[0,1,1] neg_lo:[1,0,0] neg_hi:[1,0,0]
    v_cvt_pk_bf16_f32 v148, v148, v149
    v_cvt_pk_bf16_f32 v149, v150, v151
    ds_write_b64 v3, v[148:149] offset:25600
    v_cvt_pk_bf16_f32 v152, v152, v153
    v_cvt_pk_bf16_f32 v153, v154, v155
    ds_write_b64 v3, v[152:153] offset:25728
    v_pk_fma_f32 v[160:161], v[194:195], v[20:21], v[160:161] op_sel_hi:[0,1,1] neg_lo:[1,0,0] neg_hi:[1,0,0]
    v_pk_fma_f32 v[162:163], v[194:195], v[22:23], v[162:163] op_sel_hi:[0,1,1] neg_lo:[1,0,0] neg_hi:[1,0,0]
    v_pk_fma_f32 v[164:165], v[194:195], v[24:25], v[164:165] op_sel_hi:[0,1,1] neg_lo:[1,0,0] neg_hi:[1,0,0]
    v_pk_fma_f32 v[166:167], v[194:195], v[26:27], v[166:167] op_sel_hi:[0,1,1] neg_lo:[1,0,0] neg_hi:[1,0,0]
    v_cvt_pk_bf16_f32 v160, v160, v161
    v_cvt_pk_bf16_f32 v161, v162, v163
    ds_write_b64 v3, v[160:161] offset:32000
    v_cvt_pk_bf16_f32 v164, v164, v165
    v_cvt_pk_bf16_f32 v165, v166, v167
    ds_write_b64 v3, v[164:165] offset:32128
    s_setprio 2
    s_branch AT_e2
AT_start:
    s_setprio 3
    ds_read_b32 v16, v208 offset:4
    ds_read2_b32 v[4:5], v209 offset0:0 offset1:2
    ds_read2_b32 v[6:7], v209 offset0:4 offset1:6
    ds_read2_b32 v[8:9], v209 offset0:8 offset1:10
    ds_read2_b32 v[10:11], v209 offset0:12 offset1:14
    ds_read2_b32 v[12:13], v209 offset0:16 offset1:18
    ds_read2_b32 v[14:15], v209 offset0:20 offset1:22
    s_mov_b32 s60, 0x07060503
    s_mov_b32 s61, 0x07060502
    s_mov_b32 s62, 0x07060501
    s_mov_b32 s63, 0x04000c0c
    s_mov_b32 s64, 0x0706000c
    s_mov_b32 s66, 0x11111111
    s_mov_b32 s67, s66
    s_mov_b32 s68, 0x33333333
    s_mov_b32 s69, s68
    s_mov_b32 s70, 0x77777777
    s_mov_b32 s71, s70
    v_mov_b32 v3, 0
AT_e2:
    s_waitcnt lgkmcnt(0)
    s_barrier
    s_branch AT_qk
AT_67:
    s_waitcnt vmcnt(11)
    ds_write_b128 v99, v[100:103] offset:2048
    s_waitcnt vmcnt(10)
    ds_write_b128 v99, v[104:107] offset:0
    s_waitcnt vmcnt(9)
    ds_write_b128 v99, v[108:111] offset:6144
    s_waitcnt vmcnt(8)
    ds_write_b128 v99, v[112:115] offset:4096
    s_waitcnt vmcnt(7)
    ds_write_b128 v99, v[116:119] offset:10240
    s_waitcnt vmcnt(6)
    ds_write_b128 v99, v[120:123] offset:8192
    s_waitcnt vmcnt(5)
    ds_write_b128 v99, v[124:127] offset:14336
    s_waitcnt vmcnt(4)
    ds_write_b128 v99, v[128:131] offset:12288
    s_waitcnt vmcnt(3)
    ds_write_b128 v99, v[132:135] offset:18432
    s_waitcnt vmcnt(2)
    ds_write_b128 v99, v[136:139] offset:16384
    s_waitcnt vmcnt(1)
    ds_write_b128 v99, v[140:143] offset:22528
    s_waitcnt vmcnt(0)
    ds_write_b128 v99, v[144:147] offset:20480
    v_mov_b32 v19, 1
    s_mov_b64 exec, 1
    ds_add_u32 v251, v19
    s_mov_b64 exec, -1
    s_mov_b32 s62, 1
    s_waitcnt vmcnt(0)
    s_branch B_start
AT_qk:
    ds_read_b64 v[20:21], v204
    ds_read_b64 v[30:31], v205 offset:0
    ds_read_b64 v[40:41], v205 offset:1600
    ds_read_b64 v[50:51], v205 offset:3200
    ds_read_b64 v[22:23], v229
    ds_read_b64 v[32:33], v205 offset:8
    ds_read_b64 v[42:43], v205 offset:1608
    ds_read_b64 v[52:53], v205 offset:3208
    ds_read_b64 v[24:25], v230
    ds_read_b64 v[34:35], v205 offset:16
    ds_read_b64 v[44:45], v205 offset:1616
    ds_read_b64 v[54:55], v205 offset:3216
    ds_read_b64 v[26:27], v231
    ds_read_b64 v[36:37], v205 offset:24
    ds_read_b64 v[46:47], v205 offset:1624
    ds_read_b64 v[56:57], v205 offset:3224
    ds_read_b64 v[28:29], v255
    ds_read_b64 v[38:39], v205 offset:32
    ds_read_b64 v[48:49], v205 offset:1632
    ds_read_b64 v[58:59], v205 offset:3232
    v_cndmask_b32 v13, v13, v5, s[66:67]
    v_cndmask_b32 v14, v14, v6, s[68:69]
    v_cndmask_b32 v15, v15, v7, s[70:71]
    v_mov_b32 v79, s54
    v_mov_b32 v83, s54
    v_mov_b32 v87, s54
    v_mov_b64 v[88:89], 0
    v_mov_b64 v[90:91], 0
    v_mov_b64 v[92:93], 0
    v_mov_b64 v[94:95], 0
    v_mul_f32 v16, 0x3ea52b5c, v16
    v_mul_f32 v148, v16, v8
    v_mul_f32 v149, v16, v9
    v_mul_f32 v150, v16, v10
    v_mul_f32 v151, v16, v11
    v_mul_f32 v152, v16, v12
    v_mul_f32 v153, v16, v13
    v_mul_f32 v154, v16, v14
    v_mul_f32 v155, v16, v15
    s_waitcnt lgkmcnt(15)
    v_mfma_f32_4x4x4_16b_bf16 v[60:63], v[30:31], v[20:21], 0
    v_mfma_f32_4x4x4_16b_bf16 v[64:67], v[40:41], v[20:21], 0
    v_mfma_f32_4x4x4_16b_bf16 v[68:71], v[50:51], v[20:21], 0
    s_waitcnt lgkmcnt(12)
    v_mfma_f32_4x4x4_16b_bf16 v[60:63], v[32:33], v[22:23], v[60:63]
    v_mfma_f32_4x4x4_16b_bf16 v[64:67], v[42:43], v[22:23], v[64:67]
    v_mfma_f32_4x4x4_16b_bf16 v[68:71], v[52:53], v[22:23], v[68:71]
    s_waitcnt lgkmcnt(8)
    v_mfma_f32_4x4x4_16b_bf16 v[60:63], v[34:35], v[24:25], v[60:63]
    v_mfma_f32_4x4x4_16b_bf16 v[64:67], v[44:45], v[24:25], v[64:67]
    v_mfma_f32_4x4x4_16b_bf16 v[68:71], v[54:55], v[24:25], v[68:71]
    s_waitcnt lgkmcnt(4)
    v_mfma_f32_4x4x4_16b_bf16 v[60:63], v[36:37], v[26:27], v[60:63]
    v_mfma_f32_4x4x4_16b_bf16 v[64:67], v[46:47], v[26:27], v[64:67]
    v_mfma_f32_4x4x4_16b_bf16 v[68:71], v[56:57], v[26:27], v[68:71]
    s_waitcnt lgkmcnt(0)
    v_mfma_f32_4x4x4_16b_bf16 v[60:63], v[38:39], v[28:29], v[60:63]
    v_mfma_f32_4x4x4_16b_bf16 v[64:67], v[48:49], v[28:29], v[64:67]
    v_mfma_f32_4x4x4_16b_bf16 v[68:71], v[58:59], v[28:29], v[68:71]
    s_cmp_lt_i32 s13, 8
    s_cbranch_scc1 AT_mask
AT_nomask:
    s_nop 2
    v_cndmask_b32 v69, v69, v61, s[66:67]
    v_cndmask_b32 v70, v70, v62, s[68:69]
    v_cndmask_b32 v71, v71, v63, s[70:71]
    v_pk_mul_f32 v[64:65], v[64:65], v[148:149]
    v_pk_mul_f32 v[66:67], v[66:67], v[150:151]
    v_pk_mul_f32 v[68:69], v[68:69], v[152:153]
    v_pk_mul_f32 v[70:71], v[70:71], v[154:155]
    v_perm_b32 v80, v64, v67, s60
    v_perm_b32 v81, v65, v67, s61
    v_perm_b32 v82, v66, v67, s62
    v_perm_b32 v84, v68, v71, s60
    v_perm_b32 v85, v69, v71, s61
    v_perm_b32 v86, v70, v71, s62
    s_mov_b64 exec, s[20:21]
    s_cmp_eq_u32 s49, 0
    s_cbranch_scc1 sts_1
    buffer_store_dwordx4 v[80:83], v213, s[24:27], s12 offen offset:0
    buffer_store_dwordx4 v[84:87], v213, s[24:27], s12 offen offset:512
std_2:
    s_mov_b64 exec, -1
    s_cmp_ge_u32 s48, 4
    s_cbranch_scc1 AT_vw
    v_mov_b32_dpp v196, v108 row_newbcast:0 row_mask:0xf bank_mask:0xf
    v_mov_b32_dpp v197, v109 row_newbcast:0 row_mask:0xf bank_mask:0xf
    v_mov_b32_dpp v198, v110 row_newbcast:0 row_mask:0xf bank_mask:0xf
    v_mov_b32_dpp v199, v111 row_newbcast:0 row_mask:0xf bank_mask:0xf
    v_pk_fma_f32 v[108:109], v[184:185], v[196:197], v[108:109] op_sel_hi:[0,1,1] neg_lo:[1,0,0] neg_hi:[1,0,0]
    v_pk_fma_f32 v[120:121], v[186:187], v[196:197], v[120:121] op_sel_hi:[0,1,1] neg_lo:[1,0,0] neg_hi:[1,0,0]
    v_pk_fma_f32 v[132:133], v[188:189], v[196:197], v[132:133] op_sel_hi:[0,1,1] neg_lo:[1,0,0] neg_hi:[1,0,0]
    v_pk_fma_f32 v[110:111], v[184:185], v[198:199], v[110:111] op_sel_hi:[0,1,1] neg_lo:[1,0,0] neg_hi:[1,0,0]
    v_pk_fma_f32 v[122:123], v[186:187], v[198:199], v[122:123] op_sel_hi:[0,1,1] neg_lo:[1,0,0] neg_hi:[1,0,0]
    v_pk_fma_f32 v[134:135], v[188:189], v[198:199], v[134:135] op_sel_hi:[0,1,1] neg_lo:[1,0,0] neg_hi:[1,0,0]
    v_cvt_pk_bf16_f32 v108, v108, v109
    v_cvt_pk_bf16_f32 v120, v120, v121
    v_cvt_pk_bf16_f32 v132, v132, v133
    v_cvt_pk_bf16_f32 v109, v110, v111
    v_cvt_pk_bf16_f32 v121, v122, v123
    v_cvt_pk_bf16_f32 v133, v134, v135
    ds_write_b64 v3, v[108:109] offset:256
    ds_write_b64 v3, v[120:121] offset:6656
    ds_write_b64 v3, v[132:133] offset:13056
    v_pk_fma_f32 v[144:145], v[190:191], v[196:197], v[144:145] op_sel_hi:[0,1,1] neg_lo:[1,0,0] neg_hi:[1,0,0]
    v_pk_fma_f32 v[156:157], v[192:193], v[196:197], v[156:157] op_sel_hi:[0,1,1] neg_lo:[1,0,0] neg_hi:[1,0,0]
    v_pk_fma_f32 v[168:169], v[194:195], v[196:197], v[168:169] op_sel_hi:[0,1,1] neg_lo:[1,0,0] neg_hi:[1,0,0]
    v_pk_fma_f32 v[146:147], v[190:191], v[198:199], v[146:147] op_sel_hi:[0,1,1] neg_lo:[1,0,0] neg_hi:[1,0,0]
    v_pk_fma_f32 v[158:159], v[192:193], v[198:199], v[158:159] op_sel_hi:[0,1,1] neg_lo:[1,0,0] neg_hi:[1,0,0]
    v_pk_fma_f32 v[170:171], v[194:195], v[198:199], v[170:171] op_sel_hi:[0,1,1] neg_lo:[1,0,0] neg_hi:[1,0,0]
    v_cvt_pk_bf16_f32 v144, v144, v145
    v_cvt_pk_bf16_f32 v156, v156, v157
    v_cvt_pk_bf16_f32 v168, v168, v169
    v_cvt_pk_bf16_f32 v145, v146, v147
    v_cvt_pk_bf16_f32 v157, v158, v159
    v_cvt_pk_bf16_f32 v169, v170, v171
    ds_write_b64 v3, v[144:145] offset:19456
    ds_write_b64 v3, v[156:157] offset:25856
    ds_write_b64 v3, v[168:169] offset:32256
    v_mov_b32 v19, 1
    s_mov_b64 exec, 1
    ds_add_u32 v251, v19 offset:8
    s_mov_b64 exec, -1
AT_vw:
    v_lshl_add_u32 v17, v201, 3, v251
    ds_read2_b64 v[156:159], v17 offset0:14 offset1:18
    ds_read2_b64 v[160:163], v17 offset0:22 offset1:26
    v_and_b32 v164, 2, v201
    v_lshl_add_u32 v164, v200, 2, v164
    s_lshl_b32 s65, s48, 6
    s_add_u32 s65, s65, s57
    s_mov_b64 exec, s[20:21]
AT_poll:
    buffer_load_dwordx4 v[88:91], v206, s[24:27], s22 offen offset:0 sc1
    buffer_load_dwordx4 v[92:95], v206, s[24:27], s22 offen offset:512 sc1
AT_pw:
    s_waitcnt vmcnt(0)
    v_cmp_ne_u32 vcc, s54, v91
    v_cmp_ne_u32 s[58:59], s54, v95
    s_or_b64 vcc, vcc, s[58:59]
    s_cbranch_vccz AT_got
    s_sub_u32 s3, s3, 1
    s_cbranch_scc0 AT_poll
    s_mov_b32 s3, 0
AT_got:
    s_mov_b64 exec, -1
    ds_read_b32 v17, v251 offset:8
    s_cmp_lt_u32 s48, 4
    s_cbranch_scc1 AT_w0
    v_mov_b32 v19, 1
    s_mov_b64 exec, 1
    ds_add_u32 v251, v19
    s_mov_b64 exec, -1
AT_w0:
    v_perm_b32 v91, v88, v89, s63
    v_perm_b32 v95, v92, v93, s63
    v_perm_b32 v91, v91, v90, s64
    v_perm_b32 v95, v95, v94, s64
    v_pk_add_f32 v[64:65], v[64:65], v[88:89]
    v_pk_add_f32 v[68:69], v[68:69], v[92:93]
    v_pk_add_f32 v[66:67], v[66:67], v[90:91]
    v_pk_add_f32 v[70:71], v[70:71], v[94:95]
    v_max3_f32 v18, v64, v65, v66
    v_max3_f32 v19, v67, v68, v69
    v_max3_f32 v18, v18, v70, v71
    v_max_f32 v18, v18, v19
    v_pk_add_f32 v[64:65], v[64:65], v[18:19] op_sel_hi:[1,0] neg_lo:[0,1] neg_hi:[0,1]
    v_pk_add_f32 v[66:67], v[66:67], v[18:19] op_sel_hi:[1,0] neg_lo:[0,1] neg_hi:[0,1]
    v_pk_add_f32 v[68:69], v[68:69], v[18:19] op_sel_hi:[1,0] neg_lo:[0,1] neg_hi:[0,1]
    v_pk_add_f32 v[70:71], v[70:71], v[18:19] op_sel_hi:[1,0] neg_lo:[0,1] neg_hi:[0,1]
AT_vc:
    s_waitcnt lgkmcnt(0)
    v_cmp_ne_u32 vcc, 4, v17
    s_cbranch_vccnz AT_vs
AT_vg:
    ds_read_b64_tr_b16 v[100:101], v214 offset:0
    ds_read_b64_tr_b16 v[102:103], v214 offset:1600
    ds_read_b64_tr_b16 v[104:105], v214 offset:32
    ds_read_b64_tr_b16 v[106:107], v214 offset:1632
    ds_read_b64_tr_b16 v[108:109], v214 offset:64
    ds_read_b64_tr_b16 v[110:111], v214 offset:1664
    ds_read_b64_tr_b16 v[112:113], v214 offset:96
    ds_read_b64_tr_b16 v[114:115], v214 offset:1696
    v_exp_f32 v64, v64
    v_exp_f32 v65, v65
    v_exp_f32 v66, v66
    v_exp_f32 v67, v67
    v_exp_f32 v68, v68
    v_exp_f32 v69, v69
    v_exp_f32 v70, v70
    v_exp_f32 v71, v71
    v_pk_add_f32 v[20:21], v[64:65], v[66:67]
    v_pk_add_f32 v[22:23], v[68:69], v[70:71]
    v_pk_add_f32 v[20:21], v[20:21], v[22:23]
    v_add_f32 v20, v20, v21
    v_rcp_f32 v20, v20
    v_pk_mul_f32 v[64:65], v[64:65], v[8:9]
    v_pk_mul_f32 v[66:67], v[66:67], v[10:11]
    v_pk_mul_f32 v[68:69], v[68:69], v[12:13]
    v_pk_mul_f32 v[70:71], v[70:71], v[14:15]
    v_pk_mul_f32 v[64:65], v[64:65], v[20:21] op_sel_hi:[1,0]
    v_pk_mul_f32 v[66:67], v[66:67], v[20:21] op_sel_hi:[1,0]
    v_pk_mul_f32 v[68:69], v[68:69], v[20:21] op_sel_hi:[1,0]
    v_pk_mul_f32 v[70:71], v[70:71], v[20:21] op_sel_hi:[1,0]
    v_cvt_pk_bf16_f32 v24, v64, v65
    v_cvt_pk_bf16_f32 v25, v66, v67
    v_cvt_pk_bf16_f32 v26, v68, v69
    v_cvt_pk_bf16_f32 v27, v70, v71
    ds_write_b64 v210, v[24:25] offset:8
    v_and_b32 v28, v26, v207
    v_and_b32 v29, v27, v211
    ds_write_b64 v210, v[28:29]
    v_xor_b32 v26, v26, v28
    v_xor_b32 v27, v27, v29
    ds_write_b64 v210, v[26:27] offset:16
    ds_read_b128 v[116:119], v172
    ds_read_b128 v[120:123], v173
    ds_read_b128 v[124:127], v174
    ds_read_b128 v[128:131], v175
    ds_read_b128 v[132:135], v176
    ds_read_b128 v[136:139], v177
    ds_read_b128 v[140:143], v178
    ds_read_b128 v[144:147], v179
    s_cmp_lt_u32 s48, 4
    s_cbranch_scc1 AT_pv
    s_lshl_b32 s58, s48, 2
    s_add_u32 s58, s58, 160760
    v_mov_b32 v18, s58
    v_mov_b32 v19, 1
    ds_write_b32 v18, v19
AT_pv:
    s_waitcnt lgkmcnt(6)
    v_mfma_f32_16x16x32_bf16 v[20:23], v[100:103], v[116:119], 0
    v_mfma_f32_16x16x32_bf16 v[24:27], v[100:103], v[120:123], 0
    s_waitcnt lgkmcnt(4)
    v_mfma_f32_16x16x32_bf16 v[28:31], v[104:107], v[124:127], 0
    v_mfma_f32_16x16x32_bf16 v[32:35], v[104:107], v[128:131], 0
    s_waitcnt lgkmcnt(2)
    v_mfma_f32_16x16x32_bf16 v[36:39], v[108:111], v[132:135], 0
    v_mfma_f32_16x16x32_bf16 v[40:43], v[108:111], v[136:139], 0
    s_waitcnt lgkmcnt(0)
    v_mfma_f32_16x16x32_bf16 v[44:47], v[112:115], v[140:143], 0
    v_mfma_f32_16x16x32_bf16 v[48:51], v[112:115], v[144:147], 0
    v_cndmask_b32 v20, v20, v24, s[4:5]
    v_cndmask_b32 v21, v21, v25, s[4:5]
    v_cndmask_b32 v22, v22, v26, s[4:5]
    v_cndmask_b32 v23, v23, v27, s[4:5]
    v_cvt_pk_bf16_f32 v204, v20, v21
    v_cvt_pk_bf16_f32 v205, v22, v23
    v_cndmask_b32 v28, v28, v32, s[6:7]
    v_cndmask_b32 v29, v29, v33, s[6:7]
    v_cndmask_b32 v30, v30, v34, s[6:7]
    v_cndmask_b32 v31, v31, v35, s[6:7]
    v_cvt_pk_bf16_f32 v206, v28, v29
    v_cvt_pk_bf16_f32 v207, v30, v31
    v_cndmask_b32 v36, v36, v40, s[8:9]
    v_cndmask_b32 v37, v37, v41, s[8:9]
    v_cndmask_b32 v38, v38, v42, s[8:9]
    v_cndmask_b32 v39, v39, v43, s[8:9]
    v_cvt_pk_bf16_f32 v208, v36, v37
    v_cvt_pk_bf16_f32 v209, v38, v39
    v_cndmask_b32 v44, v44, v48, s[10:11]
    v_cndmask_b32 v45, v45, v49, s[10:11]
    v_cndmask_b32 v46, v46, v50, s[10:11]
    v_cndmask_b32 v47, v47, v51, s[10:11]
    v_cvt_pk_bf16_f32 v210, v44, v45
    v_cvt_pk_bf16_f32 v211, v46, v47
    s_cmp_eq_u32 s49, 0
    s_cbranch_scc1 sts_3
    buffer_store_dwordx4 v[204:207], v249, s[24:27], s22 offen offset:0
    buffer_store_dwordx4 v[208:211], v249, s[24:27], s22 offen offset:1024
std_4:
    s_mov_b64 exec, s[18:19]
    buffer_load_dword v18, v203, s[24:27], s17 offen sc1
    s_mov_b64 exec, -1
    v_dot2_f32_bf16 v20, v204, v156, 0
    v_dot2_f32_bf16 v21, v204, v204, 0
    v_dot2_f32_bf16 v20, v205, v157, v20
    v_dot2_f32_bf16 v21, v205, v205, v21
    v_dot2_f32_bf16 v20, v206, v158, v20
    v_dot2_f32_bf16 v21, v206, v206, v21
    v_dot2_f32_bf16 v20, v207, v159, v20
    v_dot2_f32_bf16 v21, v207, v207, v21
    v_dot2_f32_bf16 v20, v208, v160, v20
    v_dot2_f32_bf16 v21, v208, v208, v21
    v_dot2_f32_bf16 v20, v209, v161, v20
    v_dot2_f32_bf16 v21, v209, v209, v21
    v_dot2_f32_bf16 v20, v210, v162, v20
    v_dot2_f32_bf16 v21, v210, v210, v21
    v_dot2_f32_bf16 v20, v211, v163, v20
    v_dot2_f32_bf16 v21, v211, v211, v21
    s_nop 2
    v_permlane32_swap_b32 v20, v21
    v_add_f32 v20, v20, v21
    v_mov_b32 v21, v20
    s_nop 1
    v_permlane16_swap_b32 v20, v21
    s_mov_b32 exec_lo, 0xffff
    s_mov_b32 exec_hi, 0xffff
    v_add_f32 v20, v20, v21
    s_cmp_eq_u32 s49, 0
    s_cbranch_scc1 sts_5
    buffer_store_short_d16_hi v20, v164, s[24:27], s65 offen
std_6:
    s_mov_b64 exec, -1
    s_waitcnt vmcnt(2)
    s_mov_b64 exec, 1
    s_cmp_eq_u32 s49, 0
    s_cbranch_scc1 sts_7
    buffer_store_dword v79, v203, s[24:27], s23 offen
std_8:
    s_mov_b64 exec, -1
    s_waitcnt vmcnt(2)
    v_cmp_ne_u32 vcc, s54, v18
    s_and_b32 s62, vcc_lo, s18
    s_cbranch_scc1 B_st0
    s_add_u32 s14, s14, 2048
    s_cmp_eq_u32 s14, s15
    s_cselect_b32 s14, s1, s14
    buffer_load_dwordx4 v[168:171], v249, s[24:27], s14 offen offset:0 sc1
    buffer_load_dwordx4 v[172:175], v249, s[24:27], s14 offen offset:1024 sc1
    s_add_u32 s14, s14, 2048
    s_cmp_eq_u32 s14, s15
    s_cselect_b32 s14, s1, s14
    buffer_load_dwordx4 v[176:179], v249, s[24:27], s14 offen offset:0 sc1
    buffer_load_dwordx4 v[180:183], v249, s[24:27], s14 offen offset:1024 sc1
    s_add_u32 s14, s14, 2048
    s_cmp_eq_u32 s14, s15
    s_cselect_b32 s14, s1, s14
    buffer_load_dwordx4 v[212:215], v249, s[24:27], s14 offen offset:0 sc1
    buffer_load_dwordx4 v[12:15], v249, s[24:27], s14 offen offset:1024 sc1
B_st0:
B_start:
    ds_read_b32 v19, v251
    ds_read2_b64 v[240:243], v227 offset0:0 offset1:4
    ds_read2_b64 v[244:247], v227 offset0:8 offset1:12
    ds_read_b32 v248, v251 offset:2288
    ds_read_b64 v[232:233], v250
    v_xor_b32 v4, 32, v250
    ds_read_b64 v[234:235], v4
    v_xor_b32 v5, 64, v250
    ds_read_b64 v[236:237], v5
    v_xor_b32 v6, 96, v250
    ds_read_b64 v[238:239], v6
    v_cmp_gt_u32 vcc, 2048, v254
    s_mov_b64 s[4:5], vcc
    s_branch B_wc
B_ww:
    ds_read_b32 v19, v251
B_wc:
    s_waitcnt lgkmcnt(0)
    v_cmp_ne_u32 vcc, 4, v19
    s_cbranch_vccz B_wd
    s_sleep 1
    s_sub_u32 s3, s3, 1
    s_cbranch_scc0 B_ww
    s_mov_b32 s3, 0
B_wd:
    s_mov_b32 exec_lo, 0x00010001
    s_mov_b32 exec_hi, 0x00010001
    v_mov_b32 v240, 0x3f803f80
    v_mov_b32 v241, 0x3f803f80
    v_mov_b32 v242, 0x3f803f80
    v_mov_b32 v243, 0x3f803f80
    v_mov_b32 v244, 0x3f803f80
    v_mov_b32 v245, 0x3f803f80
    v_mov_b32 v246, 0x3f803f80
    v_mov_b32 v247, 0x3f803f80
    s_mov_b64 exec, -1
    s_setprio 0
    s_cmp_ge_u32 s48, 6
    s_cbranch_scc1 B_r2
    ds_read_b64_tr_b16 v[20:21], v216 offset:0
    ds_read_b64_tr_b16 v[22:23], v216 offset:2048
    ds_read_b64_tr_b16 v[24:25], v217 offset:0
    ds_read_b64_tr_b16 v[26:27], v217 offset:2048
    ds_read_b64_tr_b16 v[28:29], v218 offset:0
    ds_read_b64_tr_b16 v[30:31], v218 offset:2048
    ds_read_b64_tr_b16 v[32:33], v219 offset:0
    ds_read_b64_tr_b16 v[34:35], v219 offset:2048
    ds_read_b64_tr_b16 v[36:37], v216 offset:4096
    ds_read_b64_tr_b16 v[38:39], v216 offset:6144
    ds_read_b64_tr_b16 v[40:41], v217 offset:4096
    ds_read_b64_tr_b16 v[42:43], v217 offset:6144
    ds_read_b64_tr_b16 v[44:45], v218 offset:4096
    ds_read_b64_tr_b16 v[46:47], v218 offset:6144
    ds_read_b64_tr_b16 v[48:49], v219 offset:4096
    ds_read_b64_tr_b16 v[50:51], v219 offset:6144
B_r2:
    ds_read_b64_tr_b16 v[52:53], v216 offset:8192
    ds_read_b64_tr_b16 v[54:55], v216 offset:10240
    ds_read_b64_tr_b16 v[56:57], v217 offset:8192
    ds_read_b64_tr_b16 v[58:59], v217 offset:10240
    ds_read_b64_tr_b16 v[60:61], v218 offset:8192
    ds_read_b64_tr_b16 v[62:63], v218 offset:10240
    ds_read_b64_tr_b16 v[64:65], v219 offset:8192
    ds_read_b64_tr_b16 v[66:67], v219 offset:10240
    ds_read_b64_tr_b16 v[68:69], v216 offset:12288
    ds_read_b64_tr_b16 v[70:71], v216 offset:14336
    ds_read_b64_tr_b16 v[72:73], v217 offset:12288
    ds_read_b64_tr_b16 v[74:75], v217 offset:14336
    ds_read_b64_tr_b16 v[76:77], v218 offset:12288
    ds_read_b64_tr_b16 v[78:79], v218 offset:14336
    ds_read_b64_tr_b16 v[80:81], v219 offset:12288
    ds_read_b64_tr_b16 v[82:83], v219 offset:14336
    s_cmp_eq_u32 s62, 0
    s_cbranch_scc1 B_nap
    s_mov_b64 exec, s[18:19]
    buffer_load_dword v18, v203, s[24:27], s17 offen sc1
    s_mov_b64 exec, -1
B_nap:
    ds_read_b64_tr_b16 v[84:85], v216 offset:16384
    ds_read_b64_tr_b16 v[86:87], v216 offset:18432
    ds_read_b64_tr_b16 v[88:89], v217 offset:16384
    ds_read_b64_tr_b16 v[90:91], v217 offset:18432
    ds_read_b64_tr_b16 v[92:93], v218 offset:16384
    ds_read_b64_tr_b16 v[94:95], v218 offset:18432
    ds_read_b64_tr_b16 v[96:97], v219 offset:16384
    ds_read_b64_tr_b16 v[98:99], v219 offset:18432
    ds_read_b64_tr_b16 v[100:101], v216 offset:20480
    ds_read_b64_tr_b16 v[102:103], v216 offset:22528
    ds_read_b64_tr_b16 v[104:105], v217 offset:20480
    ds_read_b64_tr_b16 v[106:107], v217 offset:22528
    ds_read_b64_tr_b16 v[108:109], v218 offset:20480
    ds_read_b64_tr_b16 v[110:111], v218 offset:22528
    ds_read_b64_tr_b16 v[112:113], v219 offset:20480
    ds_read_b64_tr_b16 v[114:115], v219 offset:22528
    ds_read_b64_tr_b16 v[116:117], v216 offset:24576
    ds_read_b64_tr_b16 v[118:119], v216 offset:26624
    ds_read_b64_tr_b16 v[120:121], v217 offset:24576
    ds_read_b64_tr_b16 v[122:123], v217 offset:26624
    ds_read_b64_tr_b16 v[124:125], v218 offset:24576
    ds_read_b64_tr_b16 v[126:127], v218 offset:26624
    ds_read_b64_tr_b16 v[128:129], v219 offset:24576
    ds_read_b64_tr_b16 v[130:131], v219 offset:26624
    s_cmp_ge_u32 s48, 6
    s_cbranch_scc1 B_no
    v_lshlrev_b32 v184, 16, v232
    v_and_b32 v185, s47, v232
    v_lshlrev_b32 v186, 16, v233
    v_and_b32 v187, s47, v233
    v_lshlrev_b32 v188, 16, v234
    v_and_b32 v189, s47, v234
    v_lshlrev_b32 v190, 16, v235
    v_and_b32 v191, s47, v235
    v_lshlrev_b32 v192, 16, v236
    v_and_b32 v193, s47, v236
    v_lshlrev_b32 v194, 16, v237
    v_and_b32 v195, s47, v237
    v_lshlrev_b32 v196, 16, v238
    v_and_b32 v197, s47, v238
    v_lshlrev_b32 v198, 16, v239
    v_and_b32 v199, s47, v239
    s_waitcnt lgkmcnt(0)
    v_mfma_f32_16x16x32_bf16 v[184:187], v[20:23], v[204:207], v[184:187]
    v_mfma_f32_16x16x32_bf16 v[188:191], v[24:27], v[204:207], v[188:191]
    v_mfma_f32_16x16x32_bf16 v[192:195], v[28:31], v[204:207], v[192:195]
    v_mfma_f32_16x16x32_bf16 v[196:199], v[32:35], v[204:207], v[196:199]
    s_waitcnt lgkmcnt(0)
    v_mfma_f32_16x16x32_bf16 v[184:187], v[36:39], v[208:211], v[184:187]
    v_mfma_f32_16x16x32_bf16 v[188:191], v[40:43], v[208:211], v[188:191]
    v_mfma_f32_16x16x32_bf16 v[192:195], v[44:47], v[208:211], v[192:195]
    v_mfma_f32_16x16x32_bf16 v[196:199], v[48:51], v[208:211], v[196:199]
    s_branch B_n2
B_rds:
    ds_read_b64_tr_b16 v[132:133], v216 offset:28672
    ds_read_b64_tr_b16 v[134:135], v216 offset:30720
    ds_read_b64_tr_b16 v[136:137], v217 offset:28672
    ds_read_b64_tr_b16 v[138:139], v217 offset:30720
    ds_read_b64_tr_b16 v[140:141], v218 offset:28672
    ds_read_b64_tr_b16 v[142:143], v218 offset:30720
    ds_read_b64_tr_b16 v[144:145], v219 offset:28672
    ds_read_b64_tr_b16 v[146:147], v219 offset:30720
    ds_read_b64_tr_b16 v[148:149], v216 offset:32768
    ds_read_b64_tr_b16 v[150:151], v216 offset:34816
    ds_read_b64_tr_b16 v[152:153], v217 offset:32768
    ds_read_b64_tr_b16 v[154:155], v217 offset:34816
    ds_read_b64_tr_b16 v[156:157], v218 offset:32768
    ds_read_b64_tr_b16 v[158:159], v218 offset:34816
    ds_read_b64_tr_b16 v[160:161], v219 offset:32768
    ds_read_b64_tr_b16 v[162:163], v219 offset:34816
    ds_read_b64_tr_b16 v[20:21], v216 offset:36864
    ds_read_b64_tr_b16 v[22:23], v216 offset:38912
    ds_read_b64_tr_b16 v[24:25], v217 offset:36864
    ds_read_b64_tr_b16 v[26:27], v217 offset:38912
    ds_read_b64_tr_b16 v[28:29], v218 offset:36864
    ds_read_b64_tr_b16 v[30:31], v218 offset:38912
    ds_read_b64_tr_b16 v[32:33], v219 offset:36864
    ds_read_b64_tr_b16 v[34:35], v219 offset:38912
    ds_read_b64_tr_b16 v[36:37], v220 offset:0
    ds_read_b64_tr_b16 v[38:39], v220 offset:2048
    ds_read_b64_tr_b16 v[40:41], v221 offset:0
    ds_read_b64_tr_b16 v[42:43], v221 offset:2048
    ds_read_b64_tr_b16 v[44:45], v222 offset:0
    ds_read_b64_tr_b16 v[46:47], v222 offset:2048
    ds_read_b64_tr_b16 v[48:49], v223 offset:0
    ds_read_b64_tr_b16 v[50:51], v223 offset:2048
    s_setpc_b64 s[98:99]
B_no:
    v_mov_b64 v[184:185], 0
    v_mov_b64 v[186:187], 0
    v_mov_b64 v[188:189], 0
    v_mov_b64 v[190:191], 0
    v_mov_b64 v[192:193], 0
    v_mov_b64 v[194:195], 0
    v_mov_b64 v[196:197], 0
    v_mov_b64 v[198:199], 0
    s_call_b64 s[98:99], B_rds
    v_mul_u32_u24 v4, 12, v0
    s_add_u32 s58, s100, 512
    s_add_u32 s59, s100, 24832
    s_add_u32 s60, s100, 49152
    s_add_u32 s12, s100, 73472
    s_add_u32 s13, s100, 97792
    v_and_b32 v5, 31, v0
    v_mul_u32_u24 v5, 3, v5
    s_mul_i32 s64, s53, 96
    s_sub_u32 s65, 1014, s55
    v_mov_b32 v6, 0xfffff000
    v_add_u32 v7, -10, v5
    v_cmp_gt_u32 vcc, s65, v7
    v_add3_u32 v7, v5, s64, 0
    s_nop 0
    v_cndmask_b32 v8, 0, v7, vcc
    v_cndmask_b32 v204, 0, v6, vcc
    v_add_u32 v7, -9, v5
    v_cmp_gt_u32 vcc, s65, v7
    v_add3_u32 v7, v5, s64, 1
    s_nop 0
    v_cndmask_b32 v9, 0, v7, vcc
    v_cndmask_b32 v205, 0, v6, vcc
    v_add_u32 v7, -8, v5
    v_cmp_gt_u32 vcc, s65, v7
    v_add3_u32 v7, v5, s64, 2
    s_nop 0
    v_cndmask_b32 v10, 0, v7, vcc
    v_cndmask_b32 v206, 0, v6, vcc
    v_mov_b32 v7, s54
    v_lshlrev_b32 v11, 11, v200
    s_setprio 2
B_n2:
    s_cmp_eq_u32 s62, 0
    s_cbranch_scc1 B_run
    s_mov_b64 exec, s[18:19]
    s_branch B_pw
B_poll:
    buffer_load_dword v18, v203, s[24:27], s17 offen sc1
B_pw:
    s_waitcnt vmcnt(0)
    v_cmp_ne_u32 vcc, s54, v18
    s_cbranch_vccz B_go
    s_sub_u32 s3, s3, 1
    s_cbranch_scc0 B_poll
    s_mov_b32 s3, 0
B_go:
    s_mov_b64 exec, -1
    s_add_u32 s14, s14, 2048
    s_cmp_eq_u32 s14, s15
    s_cselect_b32 s14, s1, s14
    buffer_load_dwordx4 v[168:171], v249, s[24:27], s14 offen offset:0 sc1
    buffer_load_dwordx4 v[172:175], v249, s[24:27], s14 offen offset:1024 sc1
    s_add_u32 s14, s14, 2048
    s_cmp_eq_u32 s14, s15
    s_cselect_b32 s14, s1, s14
    buffer_load_dwordx4 v[176:179], v249, s[24:27], s14 offen offset:0 sc1
    buffer_load_dwordx4 v[180:183], v249, s[24:27], s14 offen offset:1024 sc1
    s_add_u32 s14, s14, 2048
    s_cmp_eq_u32 s14, s15
    s_cselect_b32 s14, s1, s14
    buffer_load_dwordx4 v[212:215], v249, s[24:27], s14 offen offset:0 sc1
    buffer_load_dwordx4 v[12:15], v249, s[24:27], s14 offen offset:1024 sc1
B_run:
    s_cmp_ge_u32 s48, 6
    s_cbranch_scc1 B_half
    s_call_b64 s[98:99], B_rds
    s_cmp_ge_u32 s48, 4
    s_cbranch_scc1 B_half
    s_setprio 1
    s_waitcnt vmcnt(5) lgkmcnt(15)
    v_mfma_f32_16x16x32_bf16 v[184:187], v[52:55], v[168:171], v[184:187]
    v_mfma_f32_16x16x32_bf16 v[188:191], v[56:59], v[168:171], v[188:191]
    ds_read_b64_tr_b16 v[52:53], v220 offset:4096
    v_mfma_f32_16x16x32_bf16 v[192:195], v[60:63], v[168:171], v[192:195]
    ds_read_b64_tr_b16 v[54:55], v220 offset:6144
    v_mfma_f32_16x16x32_bf16 v[196:199], v[64:67], v[168:171], v[196:199]
    s_add_u32 s14, s14, 2048
    s_cmp_eq_u32 s14, s15
    s_cselect_b32 s14, s1, s14
    buffer_load_dwordx4 v[164:167], v249, s[24:27], s14 offen offset:0 sc1
    ds_read_b64_tr_b16 v[56:57], v221 offset:4096
    s_waitcnt vmcnt(5) lgkmcnt(15)
    v_mfma_f32_16x16x32_bf16 v[184:187], v[68:71], v[172:175], v[184:187]
    ds_read_b64_tr_b16 v[58:59], v221 offset:6144
    ds_read_b64_tr_b16 v[60:61], v222 offset:4096
    v_mfma_f32_16x16x32_bf16 v[188:191], v[72:75], v[172:175], v[188:191]
    ds_read_b64_tr_b16 v[62:63], v222 offset:6144
    v_mfma_f32_16x16x32_bf16 v[192:195], v[76:79], v[172:175], v[192:195]
    ds_read_b64_tr_b16 v[64:65], v223 offset:4096
    v_mfma_f32_16x16x32_bf16 v[196:199], v[80:83], v[172:175], v[196:199]
    buffer_load_dwordx4 v[232:235], v249, s[24:27], s14 offen offset:1024 sc1
    ds_read_b64_tr_b16 v[66:67], v223 offset:6144
    s_waitcnt vmcnt(5) lgkmcnt(15)
    v_mfma_f32_16x16x32_bf16 v[184:187], v[84:87], v[176:179], v[184:187]
    ds_read_b64_tr_b16 v[68:69], v220 offset:8192
    ds_read_b64_tr_b16 v[70:71], v220 offset:10240
    v_mfma_f32_16x16x32_bf16 v[188:191], v[88:91], v[176:179], v[188:191]
    ds_read_b64_tr_b16 v[72:73], v221 offset:8192
    v_mfma_f32_16x16x32_bf16 v[192:195], v[92:95], v[176:179], v[192:195]
    ds_read_b64_tr_b16 v[74:75], v221 offset:10240
    v_mfma_f32_16x16x32_bf16 v[196:199], v[96:99], v[176:179], v[196:199]
    s_mov_b32 s14, s16
    buffer_load_dwordx4 v[236:239], v249, s[24:27], s14 offen offset:0 sc1
    ds_read_b64_tr_b16 v[76:77], v222 offset:8192
    s_waitcnt vmcnt(5) lgkmcnt(15)
    v_mfma_f32_16x16x32_bf16 v[184:187], v[100:103], v[180:183], v[184:187]
    ds_read_b64_tr_b16 v[78:79], v222 offset:10240
    ds_read_b64_tr_b16 v[80:81], v223 offset:8192
    v_mfma_f32_16x16x32_bf16 v[188:191], v[104:107], v[180:183], v[188:191]
    ds_read_b64_tr_b16 v[82:83], v223 offset:10240
    v_mfma_f32_16x16x32_bf16 v[192:195], v[108:111], v[180:183], v[192:195]
    ds_read_b64_tr_b16 v[84:85], v220 offset:12288
    v_mfma_f32_16x16x32_bf16 v[196:199], v[112:115], v[180:183], v[196:199]
    buffer_load_dwordx4 v[168:171], v249, s[24:27], s14 offen offset:1024 sc1
    ds_read_b64_tr_b16 v[86:87], v220 offset:14336
    s_waitcnt vmcnt(5) lgkmcnt(15)
    v_mfma_f32_16x16x32_bf16 v[184:187], v[116:119], v[212:215], v[184:187]
    ds_read_b64_tr_b16 v[88:89], v221 offset:12288
    ds_read_b64_tr_b16 v[90:91], v221 offset:14336
    v_mfma_f32_16x16x32_bf16 v[188:191], v[120:123], v[212:215], v[188:191]
    ds_read_b64_tr_b16 v[92:93], v222 offset:12288
    v_mfma_f32_16x16x32_bf16 v[192:195], v[124:127], v[212:215], v[192:195]
    ds_read_b64_tr_b16 v[94:95], v222 offset:14336
    v_mfma_f32_16x16x32_bf16 v[196:199], v[128:131], v[212:215], v[196:199]
    s_add_u32 s14, s14, 2048
    s_cmp_eq_u32 s14, s15
    s_cselect_b32 s14, s1, s14
    buffer_load_dwordx4 v[172:175], v249, s[24:27], s14 offen offset:0 sc1
    ds_read_b64_tr_b16 v[96:97], v223 offset:12288
    s_waitcnt vmcnt(5) lgkmcnt(15)
    v_mfma_f32_16x16x32_bf16 v[184:187], v[132:135], v[12:15], v[184:187]
    ds_read_b64_tr_b16 v[98:99], v223 offset:14336
    ds_read_b64_tr_b16 v[100:101], v220 offset:16384
    v_mfma_f32_16x16x32_bf16 v[188:191], v[136:139], v[12:15], v[188:191]
    ds_read_b64_tr_b16 v[102:103], v220 offset:18432
    v_mfma_f32_16x16x32_bf16 v[192:195], v[140:143], v[12:15], v[192:195]
    ds_read_b64_tr_b16 v[104:105], v221 offset:16384
    v_mfma_f32_16x16x32_bf16 v[196:199], v[144:147], v[12:15], v[196:199]
    buffer_load_dwordx4 v[176:179], v249, s[24:27], s14 offen offset:1024 sc1
    ds_read_b64_tr_b16 v[106:107], v221 offset:18432
    s_waitcnt vmcnt(5) lgkmcnt(15)
    v_mfma_f32_16x16x32_bf16 v[184:187], v[148:151], v[164:167], v[184:187]
    ds_read_b64_tr_b16 v[108:109], v222 offset:16384
    ds_read_b64_tr_b16 v[110:111], v222 offset:18432
    v_mfma_f32_16x16x32_bf16 v[188:191], v[152:155], v[164:167], v[188:191]
    ds_read_b64_tr_b16 v[112:113], v223 offset:16384
    v_mfma_f32_16x16x32_bf16 v[192:195], v[156:159], v[164:167], v[192:195]
    ds_read_b64_tr_b16 v[114:115], v223 offset:18432
    v_mfma_f32_16x16x32_bf16 v[196:199], v[160:163], v[164:167], v[196:199]
    s_add_u32 s14, s14, 2048
    s_cmp_eq_u32 s14, s15
    s_cselect_b32 s14, s1, s14
    buffer_load_dwordx4 v[180:183], v249, s[24:27], s14 offen offset:0 sc1
    ds_read_b64_tr_b16 v[116:117], v220 offset:20480
    s_waitcnt vmcnt(5) lgkmcnt(15)
    v_mfma_f32_16x16x32_bf16 v[184:187], v[20:23], v[232:235], v[184:187]
    ds_read_b64_tr_b16 v[118:119], v220 offset:22528
    ds_read_b64_tr_b16 v[120:121], v221 offset:20480
    v_mfma_f32_16x16x32_bf16 v[188:191], v[24:27], v[232:235], v[188:191]
    ds_read_b64_tr_b16 v[122:123], v221 offset:22528
    v_mfma_f32_16x16x32_bf16 v[192:195], v[28:31], v[232:235], v[192:195]
    ds_read_b64_tr_b16 v[124:125], v222 offset:20480
    v_mfma_f32_16x16x32_bf16 v[196:199], v[32:35], v[232:235], v[196:199]
    buffer_load_dwordx4 v[212:215], v249, s[24:27], s14 offen offset:1024 sc1
    ds_read_b64_tr_b16 v[126:127], v222 offset:22528
    s_waitcnt vmcnt(5) lgkmcnt(15)
    v_mfma_f32_16x16x32_bf16 v[184:187], v[36:39], v[236:239], v[184:187]
    ds_read_b64_tr_b16 v[128:129], v223 offset:20480
    ds_read_b64_tr_b16 v[130:131], v223 offset:22528
    v_mfma_f32_16x16x32_bf16 v[188:191], v[40:43], v[236:239], v[188:191]
    ds_read_b64_tr_b16 v[132:133], v220 offset:24576
    v_mfma_f32_16x16x32_bf16 v[192:195], v[44:47], v[236:239], v[192:195]
    ds_read_b64_tr_b16 v[134:135], v220 offset:26624
    v_mfma_f32_16x16x32_bf16 v[196:199], v[48:51], v[236:239], v[196:199]
    s_add_u32 s14, s14, 2048
    s_cmp_eq_u32 s14, s15
    s_cselect_b32 s14, s1, s14
    buffer_load_dwordx4 v[12:15], v249, s[24:27], s14 offen offset:0 sc1
    ds_read_b64_tr_b16 v[136:137], v221 offset:24576
    s_waitcnt vmcnt(5) lgkmcnt(15)
    v_mfma_f32_16x16x32_bf16 v[184:187], v[52:55], v[168:171], v[184:187]
    ds_read_b64_tr_b16 v[138:139], v221 offset:26624
    ds_read_b64_tr_b16 v[140:141], v222 offset:24576
    v_mfma_f32_16x16x32_bf16 v[188:191], v[56:59], v[168:171], v[188:191]
    ds_read_b64_tr_b16 v[142:143], v222 offset:26624
    v_mfma_f32_16x16x32_bf16 v[192:195], v[60:63], v[168:171], v[192:195]
    ds_read_b64_tr_b16 v[144:145], v223 offset:24576
    v_mfma_f32_16x16x32_bf16 v[196:199], v[64:67], v[168:171], v[196:199]
    buffer_load_dwordx4 v[164:167], v249, s[24:27], s14 offen offset:1024 sc1
    ds_read_b64_tr_b16 v[146:147], v223 offset:26624
    s_waitcnt vmcnt(5) lgkmcnt(15)
    v_mfma_f32_16x16x32_bf16 v[184:187], v[68:71], v[172:175], v[184:187]
    ds_read_b64_tr_b16 v[148:149], v220 offset:28672
    ds_read_b64_tr_b16 v[150:151], v220 offset:30720
    v_mfma_f32_16x16x32_bf16 v[188:191], v[72:75], v[172:175], v[188:191]
    ds_read_b64_tr_b16 v[152:153], v221 offset:28672
    v_mfma_f32_16x16x32_bf16 v[192:195], v[76:79], v[172:175], v[192:195]
    ds_read_b64_tr_b16 v[154:155], v221 offset:30720
    v_mfma_f32_16x16x32_bf16 v[196:199], v[80:83], v[172:175], v[196:199]
    s_add_u32 s14, s14, 2048
    s_cmp_eq_u32 s14, s15
    s_cselect_b32 s14, s1, s14
    buffer_load_dwordx4 v[232:235], v249, s[24:27], s14 offen offset:0 sc1
    ds_read_b64_tr_b16 v[156:157], v222 offset:28672
    s_waitcnt vmcnt(5) lgkmcnt(15)
    v_mfma_f32_16x16x32_bf16 v[184:187], v[84:87], v[176:179], v[184:187]
    ds_read_b64_tr_b16 v[158:159], v222 offset:30720
    ds_read_b64_tr_b16 v[160:161], v223 offset:28672
    v_mfma_f32_16x16x32_bf16 v[188:191], v[88:91], v[176:179], v[188:191]
    ds_read_b64_tr_b16 v[162:163], v223 offset:30720
    v_mfma_f32_16x16x32_bf16 v[192:195], v[92:95], v[176:179], v[192:195]
    ds_read_b64_tr_b16 v[20:21], v220 offset:32768
    v_mfma_f32_16x16x32_bf16 v[196:199], v[96:99], v[176:179], v[196:199]
    buffer_load_dwordx4 v[236:239], v249, s[24:27], s14 offen offset:1024 sc1
    ds_read_b64_tr_b16 v[22:23], v220 offset:34816
    s_waitcnt vmcnt(5) lgkmcnt(15)
    v_mfma_f32_16x16x32_bf16 v[184:187], v[100:103], v[180:183], v[184:187]
    ds_read_b64_tr_b16 v[24:25], v221 offset:32768
    ds_read_b64_tr_b16 v[26:27], v221 offset:34816
    v_mfma_f32_16x16x32_bf16 v[188:191], v[104:107], v[180:183], v[188:191]
    ds_read_b64_tr_b16 v[28:29], v222 offset:32768
    v_mfma_f32_16x16x32_bf16 v[192:195], v[108:111], v[180:183], v[192:195]
    ds_read_b64_tr_b16 v[30:31], v222 offset:34816
    v_mfma_f32_16x16x32_bf16 v[196:199], v[112:115], v[180:183], v[196:199]
    ds_read_b64_tr_b16 v[32:33], v223 offset:32768
    s_waitcnt vmcnt(4) lgkmcnt(15)
    v_mfma_f32_16x16x32_bf16 v[184:187], v[116:119], v[212:215], v[184:187]
    ds_read_b64_tr_b16 v[34:35], v223 offset:34816
    ds_read_b64_tr_b16 v[36:37], v220 offset:36864
    v_mfma_f32_16x16x32_bf16 v[188:191], v[120:123], v[212:215], v[188:191]
    ds_read_b64_tr_b16 v[38:39], v220 offset:38912
    v_mfma_f32_16x16x32_bf16 v[192:195], v[124:127], v[212:215], v[192:195]
    ds_read_b64_tr_b16 v[40:41], v221 offset:36864
    v_mfma_f32_16x16x32_bf16 v[196:199], v[128:131], v[212:215], v[196:199]
    ds_read_b64_tr_b16 v[42:43], v221 offset:38912
    s_waitcnt vmcnt(3) lgkmcnt(15)
    v_mfma_f32_16x16x32_bf16 v[184:187], v[132:135], v[12:15], v[184:187]
    ds_read_b64_tr_b16 v[44:45], v222 offset:36864
    ds_read_b64_tr_b16 v[46:47], v222 offset:38912
    v_mfma_f32_16x16x32_bf16 v[188:191], v[136:139], v[12:15], v[188:191]
    ds_read_b64_tr_b16 v[48:49], v223 offset:36864
    v_mfma_f32_16x16x32_bf16 v[192:195], v[140:143], v[12:15], v[192:195]
    ds_read_b64_tr_b16 v[50:51], v223 offset:38912
    v_mfma_f32_16x16x32_bf16 v[196:199], v[144:147], v[12:15], v[196:199]
    s_waitcnt vmcnt(2) lgkmcnt(15)
    v_mfma_f32_16x16x32_bf16 v[184:187], v[148:151], v[164:167], v[184:187]
    v_mfma_f32_16x16x32_bf16 v[188:191], v[152:155], v[164:167], v[188:191]
    v_mfma_f32_16x16x32_bf16 v[192:195], v[156:159], v[164:167], v[192:195]
    v_mfma_f32_16x16x32_bf16 v[196:199], v[160:163], v[164:167], v[196:199]
    ds_read_b32 v10, v251 offset:4
    s_waitcnt vmcnt(1) lgkmcnt(9)
    v_mfma_f32_16x16x32_bf16 v[184:187], v[20:23], v[232:235], v[184:187]
    v_mfma_f32_16x16x32_bf16 v[188:191], v[24:27], v[232:235], v[188:191]
    v_mfma_f32_16x16x32_bf16 v[192:195], v[28:31], v[232:235], v[192:195]
    v_mfma_f32_16x16x32_bf16 v[196:199], v[32:35], v[232:235], v[196:199]
    s_waitcnt vmcnt(0) lgkmcnt(1)
    v_mfma_f32_16x16x32_bf16 v[184:187], v[36:39], v[236:239], v[184:187]
    v_mfma_f32_16x16x32_bf16 v[188:191], v[40:43], v[236:239], v[188:191]
    v_mfma_f32_16x16x32_bf16 v[192:195], v[44:47], v[236:239], v[192:195]
    v_mfma_f32_16x16x32_bf16 v[196:199], v[48:51], v[236:239], v[196:199]
    s_branch B_epi
B_half:
    s_add_u32 s14, s14, 2048
    s_cmp_eq_u32 s14, s15
    s_cselect_b32 s14, s1, s14
    buffer_load_dwordx4 v[164:167], v249, s[24:27], s14 offen offset:0 sc1
    buffer_load_dwordx4 v[232:235], v249, s[24:27], s14 offen offset:1024 sc1
    s_mov_b32 s14, s16
    buffer_load_dwordx4 v[236:239], v249, s[24:27], s14 offen offset:0 sc1
    s_cmp_lg_u32 s48, 6
    s_cbranch_scc1 E_end
    s_setprio 3
E_poll:
    s_mov_b32 exec_hi, 0x0fffffff
    buffer_load_dword v17, v203, s[24:27], s100 offen sc1
    s_mov_b32 exec_hi, -1
    buffer_load_dwordx3 v[224:226], v4, s[24:27], s58 offen sc1
    buffer_load_dwordx3 v[228:230], v4, s[24:27], s59 offen sc1
    buffer_load_dwordx3 v[240:242], v4, s[24:27], s60 offen sc1
    buffer_load_dwordx3 v[244:246], v4, s[24:27], s12 offen sc1
    buffer_load_dwordx3 v[208:210], v4, s[24:27], s13 offen sc1
E_chk:
    s_waitcnt vmcnt(5)
    v_cmp_ne_u32 vcc, s54, v17
    s_lshl_b64 vcc, vcc, 4
    s_cbranch_scc0 E_go
    s_sleep 1
    s_sub_u32 s3, s3, 1
    s_cbranch_scc0 E_poll
    s_mov_b32 s3, 0
E_go:
    s_waitcnt vmcnt(4)
    s_waitcnt vmcnt(3)
    v_add_f32 v252, v224, v228
    v_add_f32 v253, v225, v229
    v_add_f32 v254, v226, v230
    v_lshlrev_b32 v224, 16, v224
    v_lshlrev_b32 v225, 16, v225
    v_lshlrev_b32 v226, 16, v226
    v_lshlrev_b32 v228, 16, v228
    v_lshlrev_b32 v229, 16, v229
    v_lshlrev_b32 v230, 16, v230
    v_add_f32 v224, v224, v228
    v_add_f32 v225, v225, v229
    v_add_f32 v226, v226, v230
    s_waitcnt vmcnt(2)
    v_add_f32 v252, v252, v240
    v_add_f32 v253, v253, v241
    v_add_f32 v254, v254, v242
    v_lshlrev_b32 v240, 16, v240
    v_lshlrev_b32 v241, 16, v241
    v_lshlrev_b32 v242, 16, v242
    v_add_f32 v224, v224, v240
    v_add_f32 v225, v225, v241
    v_add_f32 v226, v226, v242
    s_waitcnt vmcnt(1)
    v_add_f32 v252, v252, v244
    v_add_f32 v253, v253, v245
    v_add_f32 v254, v254, v246
    v_lshlrev_b32 v244, 16, v244
    v_lshlrev_b32 v245, 16, v245
    v_lshlrev_b32 v246, 16, v246
    v_add_f32 v224, v224, v244
    v_add_f32 v225, v225, v245
    v_add_f32 v226, v226, v246
    s_waitcnt vmcnt(0)
    v_add_f32 v252, v252, v208
    v_add_f32 v253, v253, v209
    v_add_f32 v254, v254, v210
    v_lshlrev_b32 v208, 16, v208
    v_lshlrev_b32 v209, 16, v209
    v_lshlrev_b32 v210, 16, v210
    v_add_f32 v224, v224, v208
    v_add_f32 v225, v225, v209
    v_add_f32 v226, v226, v210
    v_permlane32_swap_b32 v224, v252
    v_permlane32_swap_b32 v225, v253
    v_permlane32_swap_b32 v226, v254
    v_add_f32 v224, v224, v252
    v_add_f32 v225, v225, v253
    v_add_f32 v226, v226, v254
    v_rsq_f32 v252, v224
    v_rsq_f32 v253, v225
    v_rsq_f32 v254, v226
    v_permlane32_swap_b32 v252, v228
    v_permlane32_swap_b32 v253, v229
    v_permlane32_swap_b32 v254, v230
    v_mul_f32 v224, v224, v228
    v_mul_f32 v225, v225, v229
    v_mul_f32 v226, v226, v230
    v_and_or_b32 v252, v224, v204, v8
    v_and_or_b32 v253, v225, v205, v9
    v_and_or_b32 v254, v226, v206, v10
    v_max3_i32 v6, v252, v253, v254
    s_nop 1
    v_max_i32_dpp v6, v6, v6 row_ror:1 row_mask:0xf bank_mask:0xf
    s_nop 1
    v_max_i32_dpp v6, v6, v6 row_ror:2 row_mask:0xf bank_mask:0xf
    s_nop 1
    v_max_i32_dpp v6, v6, v6 row_ror:4 row_mask:0xf bank_mask:0xf
    s_nop 1
    v_max_i32_dpp v6, v6, v6 row_ror:8 row_mask:0xf bank_mask:0xf
    v_mov_b32 v5, v6
    s_nop 1
    v_permlane16_swap_b32 v6, v5
    s_mov_b64 exec, 0xffff
    s_cmp_lg_u32 s51, 0
    v_max3_i32 v6, v6, v5, 1
    s_cbranch_scc1 E_np
    buffer_store_dwordx2 v[6:7], v11, s[24:27], s45 offen sc1
E_np:
    ds_write_b32 v251, v6 offset:4
    s_mov_b64 exec, -1
E_end:
    s_waitcnt vmcnt(8) lgkmcnt(15)
    v_mfma_f32_16x16x32_bf16 v[184:187], v[52:55], v[168:171], v[184:187]
    v_mfma_f32_16x16x32_bf16 v[188:191], v[56:59], v[168:171], v[188:191]
    v_mfma_f32_16x16x32_bf16 v[192:195], v[60:63], v[168:171], v[192:195]
    v_mfma_f32_16x16x32_bf16 v[196:199], v[64:67], v[168:171], v[196:199]
    s_waitcnt vmcnt(7) lgkmcnt(15)
    v_mfma_f32_16x16x32_bf16 v[184:187], v[68:71], v[172:175], v[184:187]
    v_mfma_f32_16x16x32_bf16 v[188:191], v[72:75], v[172:175], v[188:191]
    v_mfma_f32_16x16x32_bf16 v[192:195], v[76:79], v[172:175], v[192:195]
    v_mfma_f32_16x16x32_bf16 v[196:199], v[80:83], v[172:175], v[196:199]
    ds_read_b32 v10, v251 offset:4
    s_waitcnt vmcnt(6) lgkmcnt(15)
    v_mfma_f32_16x16x32_bf16 v[184:187], v[84:87], v[176:179], v[184:187]
    v_mfma_f32_16x16x32_bf16 v[188:191], v[88:91], v[176:179], v[188:191]
    v_mfma_f32_16x16x32_bf16 v[192:195], v[92:95], v[176:179], v[192:195]
    v_mfma_f32_16x16x32_bf16 v[196:199], v[96:99], v[176:179], v[196:199]
    s_waitcnt lgkmcnt(0)
    v_and_b32 v9, 0xfff, v10
    s_nop 0
    v_readfirstlane_b32 s64, v9
    s_lshr_b32 s64, s64, 4
    s_mul_i32 s65, s53, 6
    s_add_u32 s65, s65, s56
    s_cmp_lg_u32 s64, s65
    s_cbranch_scc1 B_nb
    s_setprio 3
B_nb:
    s_waitcnt vmcnt(5) lgkmcnt(15)
    v_mfma_f32_16x16x32_bf16 v[184:187], v[100:103], v[180:183], v[184:187]
    v_mfma_f32_16x16x32_bf16 v[188:191], v[104:107], v[180:183], v[188:191]
    v_mfma_f32_16x16x32_bf16 v[192:195], v[108:111], v[180:183], v[192:195]
    v_mfma_f32_16x16x32_bf16 v[196:199], v[112:115], v[180:183], v[196:199]
    s_waitcnt vmcnt(4) lgkmcnt(15)
    v_mfma_f32_16x16x32_bf16 v[184:187], v[116:119], v[212:215], v[184:187]
    v_mfma_f32_16x16x32_bf16 v[188:191], v[120:123], v[212:215], v[188:191]
    v_mfma_f32_16x16x32_bf16 v[192:195], v[124:127], v[212:215], v[192:195]
    v_mfma_f32_16x16x32_bf16 v[196:199], v[128:131], v[212:215], v[196:199]
    s_waitcnt vmcnt(3) lgkmcnt(15)
    v_mfma_f32_16x16x32_bf16 v[184:187], v[132:135], v[12:15], v[184:187]
    v_mfma_f32_16x16x32_bf16 v[188:191], v[136:139], v[12:15], v[188:191]
    v_mfma_f32_16x16x32_bf16 v[192:195], v[140:143], v[12:15], v[192:195]
    v_mfma_f32_16x16x32_bf16 v[196:199], v[144:147], v[12:15], v[196:199]
    s_waitcnt vmcnt(2) lgkmcnt(15)
    v_mfma_f32_16x16x32_bf16 v[184:187], v[148:151], v[164:167], v[184:187]
    v_mfma_f32_16x16x32_bf16 v[188:191], v[152:155], v[164:167], v[188:191]
    v_mfma_f32_16x16x32_bf16 v[192:195], v[156:159], v[164:167], v[192:195]
    v_mfma_f32_16x16x32_bf16 v[196:199], v[160:163], v[164:167], v[196:199]
    s_waitcnt vmcnt(1) lgkmcnt(9)
    v_mfma_f32_16x16x32_bf16 v[184:187], v[20:23], v[232:235], v[184:187]
    v_mfma_f32_16x16x32_bf16 v[188:191], v[24:27], v[232:235], v[188:191]
    v_mfma_f32_16x16x32_bf16 v[192:195], v[28:31], v[232:235], v[192:195]
    v_mfma_f32_16x16x32_bf16 v[196:199], v[32:35], v[232:235], v[196:199]
    s_cmp_eq_u32 s48, 6
    s_cbranch_scc1 B_w6
    s_waitcnt vmcnt(0)
B_w6:
    s_waitcnt lgkmcnt(1)
    v_mfma_f32_16x16x32_bf16 v[184:187], v[36:39], v[236:239], v[184:187]
    v_mfma_f32_16x16x32_bf16 v[188:191], v[40:43], v[236:239], v[188:191]
    v_mfma_f32_16x16x32_bf16 v[192:195], v[44:47], v[236:239], v[192:195]
    v_mfma_f32_16x16x32_bf16 v[196:199], v[48:51], v[236:239], v[196:199]
    s_lshl_b32 s61, s56, 12
    s_add_u32 s61, s61, 135168
    v_add_u32 v16, s61, v202
    s_lshl_b32 s61, s56, 2
    s_add_u32 s61, s61, 160760
    v_mov_b32 v18, s61
    s_cmp_eq_u32 s101, 0
    s_cbranch_scc1 B_rx0
B_pf:
    ds_read_b32 v19, v18
    s_waitcnt lgkmcnt(0)
    v_cmp_eq_u32 vcc, 0, v19
    s_cbranch_vccz B_pg
    s_sleep 1
    s_sub_u32 s3, s3, 1
    s_cbranch_scc0 B_pf
    s_mov_b32 s3, 0
B_pg:
    ds_write_b128 v16, v[184:187] offset:0
    ds_write_b128 v16, v[188:191] offset:1024
    ds_write_b128 v16, v[192:195] offset:2048
    ds_write_b128 v16, v[196:199] offset:3072
    v_mov_b32 v19, 2
    s_waitcnt lgkmcnt(0)
    ds_write_b32 v18, v19
    s_branch L_fin
B_rx0:
B_rx:
    ds_read_b32 v19, v18
    s_waitcnt lgkmcnt(0)
    v_cmp_ne_u32 vcc, 2, v19
    s_cbranch_vccz B_rd
    s_sub_u32 s3, s3, 1
    s_cbranch_scc0 B_rx
    s_mov_b32 s3, 0
B_rd:
    ds_read_b32 v10, v251 offset:4
    ds_read_b128 v[100:103], v16 offset:0
    ds_read_b128 v[104:107], v16 offset:1024
    ds_read_b128 v[108:111], v16 offset:2048
    ds_read_b128 v[112:115], v16 offset:3072
    s_waitcnt lgkmcnt(0)
    v_add_f32 v184, v184, v100
    v_add_f32 v185, v185, v101
    v_add_f32 v186, v186, v102
    v_add_f32 v187, v187, v103
    v_add_f32 v188, v188, v104
    v_add_f32 v189, v189, v105
    v_add_f32 v190, v190, v106
    v_add_f32 v191, v191, v107
    v_add_f32 v192, v192, v108
    v_add_f32 v193, v193, v109
    v_add_f32 v194, v194, v110
    v_add_f32 v195, v195, v111
    v_add_f32 v196, v196, v112
    v_add_f32 v197, v197, v113
    v_add_f32 v198, v198, v114
    v_add_f32 v199, v199, v115
B_epi:
    s_waitcnt lgkmcnt(0)
    v_cmp_eq_u32 vcc, 0, v10
    v_and_b32 v10, 0xfff, v10
    s_cbranch_vccnz B_ew
B_eg:
    v_cmp_eq_u32 s[68:69], v10, v226
    v_add_u32 v10, s54, v10
    v_mov_b32 v16, 0x3f803f80
    v_mov_b32 v15, s54
    s_add_u32 s63, s1, 20480
    s_lshl_b32 s64, s51, 8
    s_add_u32 s64, s64, s63
    v_cvt_pk_bf16_f32 v52, v184, v185
    v_cvt_pk_bf16_f32 v53, v186, v187
    v_cvt_pk_bf16_f32 v54, v188, v189
    v_cvt_pk_bf16_f32 v55, v190, v191
    v_cvt_pk_bf16_f32 v56, v192, v193
    v_cvt_pk_bf16_f32 v57, v194, v195
    v_cvt_pk_bf16_f32 v58, v196, v197
    v_cvt_pk_bf16_f32 v59, v198, v199
    s_cmp_eq_u64 s[68:69], 0
    s_cbranch_scc1 B_np2
    s_mov_b64 exec, s[68:69]
    ds_write_b128 v228, v[52:55] offset:0
    ds_write_b128 v228, v[56:59] offset:16
    s_mov_b64 exec, -1
    ds_read_b64 v[8:9], v252
    s_waitcnt lgkmcnt(0)
    buffer_store_dwordx3 v[8:10], v224, s[24:27], s44 offen sc1
B_np2:
    v_mfma_f32_16x16x32_bf16 v[12:15], v[240:243], v[52:55], 0
    v_mfma_f32_16x16x32_bf16 v[12:15], v[244:247], v[56:59], v[12:15]
    v_dot2_f32_bf16 v16, v52, v52, 0
    v_dot2_f32_bf16 v17, v53, v53, 0
    v_dot2_f32_bf16 v16, v54, v54, v16
    v_dot2_f32_bf16 v17, v55, v55, v17
    v_dot2_f32_bf16 v16, v56, v56, v16
    v_dot2_f32_bf16 v17, v57, v57, v17
    v_dot2_f32_bf16 v16, v58, v58, v16
    v_dot2_f32_bf16 v17, v59, v59, v17
    s_nop 2
    v_add_f32 v16, v16, v17
    v_mov_b32 v17, v16
    s_nop 1
    v_permlane32_swap_b32 v16, v17
    v_add_f32 v16, v16, v17
    v_mov_b32 v17, v16
    v_mov_b32 v15, s54
    s_nop 0
    v_permlane16_swap_b32 v16, v17
    v_add_f32 v13, v16, v17
    s_mov_b64 exec, 0xffff
    s_cmp_eq_u32 s49, 0
    s_cbranch_scc1 sts_9
    buffer_store_dwordx4 v[12:15], v202, s[24:27], s64 offen
std_10:
    s_mov_b64 exec, -1
    v_lshlrev_b32 v36, 16, v52
    v_and_b32 v37, s47, v52
    v_lshlrev_b32 v38, 16, v53
    v_and_b32 v39, s47, v53
    v_lshlrev_b32 v40, 16, v54
    v_and_b32 v41, s47, v54
    v_lshlrev_b32 v42, 16, v55
    v_and_b32 v43, s47, v55
    v_lshlrev_b32 v44, 16, v56
    v_and_b32 v45, s47, v56
    v_lshlrev_b32 v46, 16, v57
    v_and_b32 v47, s47, v57
    v_lshlrev_b32 v48, 16, v58
    v_and_b32 v49, s47, v58
    v_lshlrev_b32 v50, 16, v59
    v_and_b32 v51, s47, v59
    v_mov_b32 v108, 0
    v_mov_b32 v109, 0
    v_mov_b32 v110, 0
    v_mov_b32 v111, s54
    v_mov_b32 v11, s54
    v_mov_b32 v5, 1
    v_lshlrev_b32 v7, 11, v200
    s_add_u32 s45, s45, 32768
    s_sub_u32 s44, s44, 131072
    buffer_load_dwordx4 v[100:103], v202, s[24:27], s63 offen offset:0 sc1
    buffer_load_dwordx4 v[104:107], v202, s[24:27], s63 offen offset:1024 sc1
    s_mov_b32 exec_hi, 0
    buffer_load_dwordx4 v[108:111], v202, s[24:27], s63 offen offset:2048 sc1
    s_mov_b32 exec_hi, -1
    s_branch S_pw
S_poll:
    s_mov_b64 exec, s[58:59]
    s_cbranch_execz S_r0
    buffer_load_dwordx4 v[100:103], v202, s[24:27], s63 offen offset:0 sc1
S_r0:
    s_mov_b64 exec, s[64:65]
    s_cbranch_execz S_r1
    buffer_load_dwordx4 v[104:107], v202, s[24:27], s63 offen offset:1024 sc1
S_r1:
    s_mov_b64 exec, s[66:67]
    s_cbranch_execz S_r2
    buffer_load_dwordx4 v[108:111], v202, s[24:27], s63 offen offset:2048 sc1
S_r2:
    s_mov_b64 exec, -1
S_pw:
    s_waitcnt vmcnt(0)
    v_cmp_ne_u32 s[58:59], s54, v103
    v_cmp_ne_u32 s[64:65], s54, v107
    v_cmp_ne_u32 s[66:67], s54, v111
    s_or_b64 vcc, s[58:59], s[64:65]
    s_or_b64 vcc, vcc, s[66:67]
    s_cbranch_scc0 S_got
    s_sub_u32 s3, s3, 1
    s_cbranch_scc0 S_poll
    s_mov_b32 s3, 0
S_got:
    v_add_f32 v12, v100, v104
    v_add_f32 v13, v101, v105
    v_add_f32 v14, v102, v106
    v_add_f32 v12, v12, v108
    v_add_f32 v13, v13, v109
    v_add_f32 v14, v14, v110
    v_mov_b32 v17, v12
    v_mov_b32 v18, v13
    v_mov_b32 v19, v14
    v_permlane32_swap_b32 v17, v12
    v_permlane32_swap_b32 v18, v13
    v_permlane32_swap_b32 v19, v14
    v_add_f32 v12, v12, v17
    v_add_f32 v13, v13, v18
    v_add_f32 v14, v14, v19
    v_mov_b32 v17, v12
    v_mov_b32 v18, v13
    v_mov_b32 v19, v14
    v_permlane16_swap_b32 v17, v12
    v_permlane16_swap_b32 v18, v13
    v_permlane16_swap_b32 v19, v14
    v_add_f32 v12, v12, v17
    v_add_f32 v13, v13, v18
    v_add_f32 v14, v14, v19
    v_mul_f32 v12, 0x3acccccd, v12
    v_mul_f32 v13, 0x3acccccd, v13
    v_fma_f32 v13, -v12, v12, v13
    v_max_f32 v13, 0, v13
    v_cvt_pk_bf16_f32 v13, v13, v13
    v_and_b32 v13, 0xffff0000, v13
    v_add_f32 v13, 0x3727c5ac, v13
    v_cvt_pk_bf16_f32 v13, v13, v13
    v_and_b32 v13, 0xffff0000, v13
    v_sqrt_f32 v13, v13
    v_cvt_pk_bf16_f32 v12, v12, v12
    v_and_b32 v12, 0xffff0000, v12
    v_cvt_pk_bf16_f32 v13, v13, v13
    v_and_b32 v13, 0xffff0000, v13
    v_rcp_f32 v13, v13
    v_fma_f32 v14, -v12, v248, v14
    v_mul_f32 v14, v14, v13
    v_ashrrev_i32 v6, 31, v14
    v_or_b32 v6, 0x80000000, v6
    v_xor_b32 v6, v6, v14
    v_and_b32 v6, 0xfffff000, v6
    v_or_b32 v6, v6, v226
    s_and_b64 exec, s[4:5], 0xffff
    ds_max_u32 v251, v6 offset:12
    s_cmp_lg_u32 s51, 0
    s_cbranch_scc1 S_nk
    s_mov_b64 exec, 1
    ds_add_rtn_u32 v5, v251, v5 offset:20
    s_mov_b64 exec, 0xffff
    ds_read_b32 v10, v251 offset:12
    s_waitcnt lgkmcnt(0)
    v_readfirstlane_b32 s64, v5
    s_cmp_lg_u32 s64, 5
    s_cbranch_scc1 S_nk
    buffer_store_dwordx2 v[10:11], v7, s[24:27], s45 offen sc1
S_nk:
    s_mov_b64 exec, -1
    s_and_b64 s[68:69], s[68:69], s[4:5]
    s_cbranch_scc0 S_ne
    s_call_b64 s[98:99], S_ln
    s_mov_b64 exec, s[68:69]
    buffer_store_dwordx4 v[60:63], v225, s[40:43], 0 offen offset:0 sc1
    buffer_store_dwordx4 v[64:67], v225, s[40:43], 0 offen offset:64 sc1
    s_mov_b64 exec, -1
S_ne:
    s_waitcnt lgkmcnt(0)
    s_barrier
    ds_read_b32 v10, v251 offset:12
    s_waitcnt lgkmcnt(0)
S_nc:
    v_cmp_eq_u32 s[60:61], v10, v6
    s_cmp_lg_u64 s[68:69], 0
    s_cbranch_scc1 S_l2
    s_call_b64 s[98:99], S_ln
S_l2:
    s_and_b64 s[60:61], s[60:61], s[4:5]
    s_cbranch_scc0 S_out
    s_andn2_b64 exec, s[60:61], s[68:69]
    s_cbranch_execz S_l3
    buffer_store_dwordx4 v[60:63], v225, s[40:43], 0 offen offset:0 sc1
    buffer_store_dwordx4 v[64:67], v225, s[40:43], 0 offen offset:64 sc1
S_l3:
    s_mov_b64 exec, s[60:61]
    ds_write_b128 v228, v[52:55] offset:0
    ds_write_b128 v228, v[56:59] offset:16
    s_mov_b64 exec, -1
    ds_read_b64 v[8:9], v252
    v_and_b32 v10, 0xfff, v10
    v_add_u32 v10, s54, v10
    s_mov_b64 exec, 0xffff
    s_waitcnt vmcnt(0) lgkmcnt(0)
    buffer_store_dwordx3 v[8:10], v224, s[24:27], s44 offen sc1
S_out:
    s_nor_b64 exec, s[60:61], s[68:69]
    buffer_store_dwordx4 v[60:63], v225, s[40:43], 0 offen offset:0 sc1
    buffer_store_dwordx4 v[64:67], v225, s[40:43], 0 offen offset:64 sc1
    s_mov_b64 exec, -1
    s_branch L_fin
S_ln:
    v_pk_add_f32 v[20:21], v[36:37], v[12:13] op_sel_hi:[1,0] neg_lo:[0,1] neg_hi:[0,1]
    v_pk_add_f32 v[22:23], v[38:39], v[12:13] op_sel_hi:[1,0] neg_lo:[0,1] neg_hi:[0,1]
    v_pk_add_f32 v[24:25], v[40:41], v[12:13] op_sel_hi:[1,0] neg_lo:[0,1] neg_hi:[0,1]
    v_pk_add_f32 v[26:27], v[42:43], v[12:13] op_sel_hi:[1,0] neg_lo:[0,1] neg_hi:[0,1]
    v_pk_add_f32 v[28:29], v[44:45], v[12:13] op_sel_hi:[1,0] neg_lo:[0,1] neg_hi:[0,1]
    v_pk_add_f32 v[30:31], v[46:47], v[12:13] op_sel_hi:[1,0] neg_lo:[0,1] neg_hi:[0,1]
    v_pk_add_f32 v[32:33], v[48:49], v[12:13] op_sel_hi:[1,0] neg_lo:[0,1] neg_hi:[0,1]
    v_pk_add_f32 v[34:35], v[50:51], v[12:13] op_sel_hi:[1,0] neg_lo:[0,1] neg_hi:[0,1]
    v_cvt_pk_bf16_f32 v60, v20, v21
    v_cvt_pk_bf16_f32 v61, v22, v23
    v_cvt_pk_bf16_f32 v62, v24, v25
    v_cvt_pk_bf16_f32 v63, v26, v27
    v_cvt_pk_bf16_f32 v64, v28, v29
    v_cvt_pk_bf16_f32 v65, v30, v31
    v_cvt_pk_bf16_f32 v66, v32, v33
    v_cvt_pk_bf16_f32 v67, v34, v35
    v_lshlrev_b32 v20, 16, v60
    v_and_b32 v21, s47, v60
    v_lshlrev_b32 v22, 16, v61
    v_and_b32 v23, s47, v61
    v_lshlrev_b32 v24, 16, v62
    v_and_b32 v25, s47, v62
    v_lshlrev_b32 v26, 16, v63
    v_and_b32 v27, s47, v63
    v_lshlrev_b32 v28, 16, v64
    v_and_b32 v29, s47, v64
    v_lshlrev_b32 v30, 16, v65
    v_and_b32 v31, s47, v65
    v_lshlrev_b32 v32, 16, v66
    v_and_b32 v33, s47, v66
    v_lshlrev_b32 v34, 16, v67
    v_and_b32 v35, s47, v67
    v_pk_mul_f32 v[20:21], v[20:21], v[12:13] op_sel:[0,1]
    v_pk_mul_f32 v[22:23], v[22:23], v[12:13] op_sel:[0,1]
    v_pk_mul_f32 v[24:25], v[24:25], v[12:13] op_sel:[0,1]
    v_pk_mul_f32 v[26:27], v[26:27], v[12:13] op_sel:[0,1]
    v_pk_mul_f32 v[28:29], v[28:29], v[12:13] op_sel:[0,1]
    v_pk_mul_f32 v[30:31], v[30:31], v[12:13] op_sel:[0,1]
    v_pk_mul_f32 v[32:33], v[32:33], v[12:13] op_sel:[0,1]
    v_pk_mul_f32 v[34:35], v[34:35], v[12:13] op_sel:[0,1]
    v_cvt_pk_bf16_f32 v60, v20, v21
    v_cvt_pk_bf16_f32 v61, v22, v23
    v_cvt_pk_bf16_f32 v62, v24, v25
    v_cvt_pk_bf16_f32 v63, v26, v27
    v_cvt_pk_bf16_f32 v64, v28, v29
    v_cvt_pk_bf16_f32 v65, v30, v31
    v_cvt_pk_bf16_f32 v66, v32, v33
    v_cvt_pk_bf16_f32 v67, v34, v35
    v_lshlrev_b32 v20, 16, v60
    v_and_b32 v21, s47, v60
    v_lshlrev_b32 v22, 16, v61
    v_and_b32 v23, s47, v61
    v_lshlrev_b32 v24, 16, v62
    v_and_b32 v25, s47, v62
    v_lshlrev_b32 v26, 16, v63
    v_and_b32 v27, s47, v63
    v_lshlrev_b32 v28, 16, v64
    v_and_b32 v29, s47, v64
    v_lshlrev_b32 v30, 16, v65
    v_and_b32 v31, s47, v65
    v_lshlrev_b32 v32, 16, v66
    v_and_b32 v33, s47, v66
    v_lshlrev_b32 v34, 16, v67
    v_and_b32 v35, s47, v67
    v_pk_add_f32 v[20:21], v[20:21], v[36:37]
    v_pk_add_f32 v[22:23], v[22:23], v[38:39]
    v_pk_add_f32 v[24:25], v[24:25], v[40:41]
    v_pk_add_f32 v[26:27], v[26:27], v[42:43]
    v_pk_add_f32 v[28:29], v[28:29], v[44:45]
    v_pk_add_f32 v[30:31], v[30:31], v[46:47]
    v_pk_add_f32 v[32:33], v[32:33], v[48:49]
    v_pk_add_f32 v[34:35], v[34:35], v[50:51]
    v_cvt_pk_bf16_f32 v60, v20, v21
    v_cvt_pk_bf16_f32 v61, v22, v23
    v_cvt_pk_bf16_f32 v62, v24, v25
    v_cvt_pk_bf16_f32 v63, v26, v27
    v_cvt_pk_bf16_f32 v64, v28, v29
    v_cvt_pk_bf16_f32 v65, v30, v31
    v_cvt_pk_bf16_f32 v66, v32, v33
    v_cvt_pk_bf16_f32 v67, v34, v35
    v_permlane16_swap_b32 v60, v62
    v_permlane16_swap_b32 v61, v63
    v_permlane16_swap_b32 v64, v66
    v_permlane16_swap_b32 v65, v67
    s_setpc_b64 s[98:99]
L_fin:
L_end:
    s_endpgm
AT_mask:
    v_mov_b32 v17, 0xf149f2ca
    v_cmp_le_i32 vcc, 8, v212
    s_nop 1
    v_cndmask_b32 v60, v17, v60, vcc
    v_cmp_le_i32 vcc, 7, v212
    s_nop 1
    v_cndmask_b32 v61, v17, v61, vcc
    v_cmp_le_i32 vcc, 6, v212
    s_nop 1
    v_cndmask_b32 v62, v17, v62, vcc
    v_cmp_le_i32 vcc, 5, v212
    s_nop 1
    v_cndmask_b32 v63, v17, v63, vcc
    v_cmp_le_i32 vcc, 4, v212
    s_nop 1
    v_cndmask_b32 v64, v17, v64, vcc
    v_cmp_le_i32 vcc, 3, v212
    s_nop 1
    v_cndmask_b32 v65, v17, v65, vcc
    v_cmp_le_i32 vcc, 2, v212
    s_nop 1
    v_cndmask_b32 v66, v17, v66, vcc
    v_cmp_le_i32 vcc, 1, v212
    s_nop 1
    v_cndmask_b32 v67, v17, v67, vcc
    v_cmp_le_i32 vcc, 0, v212
    s_nop 1
    v_cndmask_b32 v68, v17, v68, vcc
    v_cmp_le_i32 vcc, -1, v212
    s_nop 1
    v_cndmask_b32 v69, v17, v69, vcc
    v_cmp_le_i32 vcc, -2, v212
    s_nop 1
    v_cndmask_b32 v70, v17, v70, vcc
    v_cmp_le_i32 vcc, -3, v212
    s_nop 1
    v_cndmask_b32 v71, v17, v71, vcc
    s_branch AT_nomask
sts_1:
    buffer_store_dwordx4 v[80:83], v213, s[24:27], s12 offen offset:0 sc1
    buffer_store_dwordx4 v[84:87], v213, s[24:27], s12 offen offset:512 sc1
    s_branch std_2
AT_vs:
    ds_read_b32 v17, v251 offset:8
    s_sub_u32 s3, s3, 1
    s_cbranch_scc0 AT_vc
    s_mov_b32 s3, 0
    s_branch AT_vg
sts_3:
    buffer_store_dwordx4 v[204:207], v249, s[24:27], s22 offen offset:0 sc1
    buffer_store_dwordx4 v[208:211], v249, s[24:27], s22 offen offset:1024 sc1
    s_branch std_4
sts_5:
    buffer_store_short_d16_hi v20, v164, s[24:27], s65 offen sc1
    s_branch std_6
sts_7:
    buffer_store_dword v79, v203, s[24:27], s23 offen sc1
    s_branch std_8
B_ew:
    s_sleep 1
    ds_read_b32 v10, v251 offset:4
    s_sub_u32 s3, s3, 1
    s_cbranch_scc0 B_epi
    s_mov_b32 s3, 0
    s_waitcnt lgkmcnt(0)
    s_branch B_eg
sts_9:
    buffer_store_dwordx4 v[12:15], v202, s[24:27], s64 offen sc1
    s_branch std_10
LD_cont:
    v_and_b32 v0, 63, v0
    s_mov_b32 s3, 0x40000
    s_mov_b32 s47, 0xffff0000
    s_mov_b32 s26, 7340032
    s_mov_b32 s27, 0x00020000
    s_mov_b32 s38, 819200
    s_mov_b32 s39, 0x00020000
    s_mov_b32 s42, 2621440
    s_mov_b32 s43, 0x00020000
    s_sub_u32 s52, s51, 5
    s_cselect_b32 s52, s51, s52
    s_buffer_load_dword s54, s[24:27], 0
    v_lshl_add_u32 v4, s60, 3, v1
    v_mul_u32_u24 v5, 1280, v4
    v_lshlrev_b32 v7, 1, v2
    v_bitop3_b32 v7, v0, 7, v7 bitop3:0x6a
    v_lshl_add_u32 v5, v7, 4, v5
    v_lshl_add_u32 v16, s51, 7, v5
    s_lshl_b32 s46, s53, 11
    s_add_u32 s46, s46, 81920
    s_mul_i32 s62, s60, 24
    v_add_u32 v17, s62, v0
    v_lshlrev_b32 v18, 4, v17
    v_cmp_gt_u32 vcc, 24, v0
    v_add_u32 v19, 72, v0
    v_lshlrev_b32 v19, 4, v19
    v_cndmask_b32 v18, v19, v18, vcc
    s_lshl_b32 s62, s51, 2
    s_add_u32 s62, s62, s60
    s_lshl_b32 s62, s62, 8
    s_sub_u32 s62, s62, s46
    s_add_u32 s62, s62, 1243488
    v_add_u32 v19, s62, v19
    v_cmp_lt_u32 vcc, 33, v0
    s_nop 1
    v_cndmask_b32 v18, v18, v19, vcc
    v_cmp_lt_u32 vcc, 49, v0
    s_nop 1
    v_cndmask_b32 v18, v18, 2.0, vcc
    s_cmp_eq_u32 s60, 0
    s_cselect_b32 s62, 24, 0
    v_cmp_gt_u32 vcc, s62, v0
    s_nop 1
    v_cndmask_b32 v10, v10, 2.0, vcc
    v_mov_b32 v28, 0
    v_mov_b32 v29, 0
    v_mov_b32 v30, 0
    v_mov_b32 v31, 0
    s_lshl_b32 s62, s60, 6
    v_add_u32 v4, s62, v0
    v_lshlrev_b32 v35, 4, v4
    v_add_u32 v35, 135168, v35
    ds_write_b128 v35, v[28:31] offset:0
    ds_write_b128 v35, v[28:31] offset:4096
    ds_write_b128 v35, v[28:31] offset:8192
    ds_write_b128 v35, v[28:31] offset:12288
    ds_write_b128 v35, v[28:31] offset:16384
    ds_write_b128 v35, v[28:31] offset:20480
    v_lshrrev_b32 v5, 1, v4
    v_min_u32 v5, 61, v5
    v_mul_u32_u24 v5, 400, v5
    v_and_b32 v6, 1, v4
    v_lshl_add_u32 v5, v6, 4, v5
    v_add_u32 v5, 110624, v5
    ds_write_b128 v5, v[28:31]
    v_mov_b32 v6, 159776
    ds_write_b64 v6, v[28:29]
    v_and_b32 v4, 31, v0
    v_lshlrev_b32 v5, 7, v4
    s_lshl_b32 s62, s51, 11
    v_add_u32 v6, s62, v5
    s_lshl_b32 s62, s51, 8
    s_add_u32 s62, s62, 17408
    v_add_u32 v7, s62, v5
    v_cmp_lt_u32 vcc, 23, v4
    s_nop 1
    v_cndmask_b32 v6, v6, v7, vcc
    v_and_b32 v7, 128, v5
    v_add_u32 v7, 23040, v7
    v_cmp_lt_u32 vcc, 25, v4
    s_nop 1
    v_cndmask_b32 v6, v6, v7, vcc
    v_lshrrev_b32 v7, 5, v0
    v_mul_u32_u24 v7, 24320, v7
    v_add_u32 v36, v6, v7
    s_mov_b32 vcc_hi, 0xfcff0000
    s_cmp_eq_u32 s60, 0
    s_cselect_b32 vcc_lo, 0xf0ff5555, vcc_hi
    v_cndmask_b32 v36, v36, 2.0, vcc
    s_waitcnt lgkmcnt(0)
    s_add_u32 s54, s54, 2654435761
    s_lshl_b32 s62, s60, 10
    s_add_u32 s62, s62, 36864
    s_add_u32 s63, s51, 3
    s_sub_u32 s61, s63, 10
    s_cselect_b32 s63, s63, s61
    s_mul_i32 s63, s63, 81920
    s_call_b64 s[98:99], S_late
    s_call_b64 s[98:99], LD_issue
    s_waitcnt vmcnt(9)
    s_barrier
    s_bitcmp0_b32 s60, 0
    s_cselect_b32 s16, s14, s16
    s_cselect_b32 s17, s15, s17
    s_mov_b64 s[14:15], s[18:19]
    s_and_b32 s17, s17, 0xffff
    s_mov_b32 s18, 1966080
    s_mov_b32 s19, 0x00020000
    s_lshr_b32 s58, s60, 1
    s_lshl1_add_u32 s58, s2, s58
    s_mul_i32 s61, s58, 21846
    s_lshr_b32 s61, s61, 16
    s_mul_i32 s67, s61, 3
    s_sub_u32 s58, s58, s67
    s_mul_i32 s61, s61, 3072
    s_lshl_b32 s58, s58, 10
    s_add_u32 s58, s58, s61
    s_cmp_lt_u32 s61, 73728
    s_cselect_b32 s58, 2.0, s58
    s_buffer_load_dword s59, s[16:19], s58 offset:384
    s_buffer_load_dword s59, s[16:19], s58 offset:448
    s_buffer_load_dword s59, s[16:19], s58 offset:491904
    s_buffer_load_dword s59, s[16:19], s58 offset:491968
    s_add_u32 s58, s58, 983040
    s_call_b64 s[98:99], LD_issue
    s_waitcnt vmcnt(9)
    s_barrier
    s_buffer_load_dword s59, s[16:19], s58 offset:384
    s_buffer_load_dword s59, s[16:19], s58 offset:448
    s_buffer_load_dword s59, s[16:19], s58 offset:491904
    s_buffer_load_dword s59, s[16:19], s58 offset:491968
    s_lshl2_add_u32 s58, s53, s60
    s_mul_i32 s61, s58, 86
    s_lshr_b32 s61, s61, 8
    s_mul_i32 s67, s61, 3
    s_sub_u32 s58, s58, s67
    s_mul_i32 s58, s58, 1280
    s_mul_i32 s61, s61, 7680
    s_add_u32 s58, s58, s61
    s_mul_i32 s61, s51, 245888
    s_add_u32 s58, s58, s61
    s_call_b64 s[98:99], LD_issue
    s_call_b64 s[98:99], S_late2
    s_waitcnt vmcnt(9)
    s_barrier
    s_buffer_load_dword s59, s[32:35], s58 offset:0
    s_buffer_load_dword s59, s[32:35], s58 offset:64
    s_buffer_load_dword s59, s[32:35], s58 offset:3840
    s_buffer_load_dword s59, s[32:35], s58 offset:3904
    s_mul_i32 s58, s60, 61440
    s_add_u32 s58, s58, s44
    s_call_b64 s[98:99], LD_issue
    s_call_b64 s[98:99], S_late3
    s_call_b64 s[98:99], S_late4
    s_waitcnt vmcnt(9)
    s_barrier
    s_buffer_load_dword s59, s[24:27], s58 offset:0
    s_buffer_load_dword s59, s[24:27], s58 offset:64
    s_buffer_load_dword s59, s[24:27], s58 offset:128
    s_buffer_load_dword s59, s[24:27], s58 offset:192
    s_lshl_b32 s58, s60, 6
    s_add_u32 s58, s58, s44
    s_sub_u32 s58, s58, 131072
    s_call_b64 s[98:99], LD_issue
    s_waitcnt vmcnt(9)
    s_barrier
    s_buffer_load_dword s59, s[24:27], s58
    s_call_b64 s[98:99], LD_issue
    s_waitcnt vmcnt(9)
    s_barrier
    s_call_b64 s[98:99], LD_issue
    s_waitcnt vmcnt(9)
    s_barrier
    s_call_b64 s[98:99], LD_issue
    s_waitcnt vmcnt(9)
    s_barrier
    buffer_load_dwordx4 v[20:23], v18, s[24:27], s46 offen sc1
    s_mov_b32 s66, s51
    s_movk_i32 s71, 99
    s_call_b64 s[98:99], LD_issue
    s_waitcnt vmcnt(9)
    s_barrier
    v_mov_b32 v24, 163072
    ds_read_b32 v24, v24
    s_mov_b32 m0, s62
    s_add_u32 s62, s62, 4096
    buffer_load_dwordx4 v16, s[36:39], s63 offen lds
    s_add_u32 s63, s63, 40960
    s_mov_b32 m0, s62
    s_add_u32 s62, s62, 4096
    buffer_load_dwordx4 v16, s[36:39], s63 offen lds
    s_add_u32 s63, s63, 40960
    s_cmp_eq_u32 s63, 819200
    s_cselect_b32 s63, 0, s63
    s_mov_b32 m0, s62
    s_add_u32 s62, s62, 4096
    buffer_load_dwordx4 v16, s[36:39], s63 offen lds
    s_add_u32 s63, s63, 40960
    s_mov_b32 m0, s62
    s_add_u32 s62, s62, 4096
    buffer_load_dwordx4 v16, s[36:39], s63 offen lds
    s_add_u32 s63, s63, 40960
    s_cmp_eq_u32 s63, 819200
    s_cselect_b32 s63, 0, s63
    s_mov_b32 m0, s62
    s_add_u32 s62, s62, 4096
    buffer_load_dwordx4 v16, s[36:39], s63 offen lds
    s_add_u32 s63, s63, 40960
    s_mov_b32 m0, s62
    s_add_u32 s62, s62, 4096
    buffer_load_dwordx4 v16, s[36:39], s63 offen lds
    s_add_u32 s63, s63, 40960
    s_cmp_eq_u32 s63, 819200
    s_cselect_b32 s63, 0, s63
    s_mov_b32 m0, s62
    s_add_u32 s62, s62, 4096
    buffer_load_dwordx4 v16, s[36:39], s63 offen lds
    s_add_u32 s63, s63, 40960
    s_mov_b32 exec_hi, 3
    v_cmp_ne_u32 vcc, s54, v22
    s_cbranch_vccz LD_rs
LD_rsp:
    buffer_load_dwordx4 v[20:23], v18, s[24:27], s46 offen sc1
    s_waitcnt vmcnt(0)
    v_cmp_ne_u32 vcc, s54, v22
    s_cbranch_vccz LD_rs
    s_sleep 1
    s_sub_u32 s3, s3, 1
    s_cbranch_scc0 LD_rsp
    s_mov_b32 s3, 0
LD_rs:
    s_getreg_b32 s61, hwreg(HW_REG_XCC_ID)
    v_cmp_ne_u32 vcc, s61, v20
    s_lshr_b64 vcc, vcc, 24
    s_cselect_b32 s49, 0, 1
    s_lshl_b32 s61, s60, 5
    s_add_u32 s61, s61, 160828
    s_mov_b32 exec_hi, 0x3fffc
    s_mov_b32 exec_lo, 0
    v_cmp_eq_u32 vcc, s54, v22
    v_lshl_add_u32 v4, v0, 1, s61
    s_waitcnt lgkmcnt(0)
    v_mul_f32 v24, 0xbacccccd, v24
    v_fmac_f32 v21, v20, v24
    v_cndmask_b32 v21, 0, v21, vcc
    ds_write_b16_d16_hi v4, v21
    s_mov_b32 exec_hi, 0
    s_mov_b32 exec_lo, 0xffffff
    v_lshlrev_b32 v4, 3, v17
    v_add_u32 v4, 159808, v4
    ds_write_b64 v4, v[20:21]
    v_mov_b32 v4, 160768
    v_mov_b32 v5, s49
    ds_write_b32 v4, v5
    ds_write_b64 v4, v[28:29] offset:8
    ds_write_b64 v4, v[28:29] offset:16
    ds_write_b64 v4, v[28:29] offset:24
    ds_write_b64 v4, v[28:29] offset:32
    s_mov_b64 exec, -1
    s_waitcnt vmcnt(7) lgkmcnt(0)
    s_barrier
    s_mov_b32 m0, s62
    s_add_u32 s62, s62, 4096
    buffer_load_dwordx4 v16, s[36:39], s63 offen lds
    s_add_u32 s63, s63, 40960
    s_cmp_eq_u32 s63, 819200
    s_cselect_b32 s63, 0, s63
    s_mov_b32 m0, s62
    s_add_u32 s62, s62, 4096
    buffer_load_dwordx4 v16, s[36:39], s63 offen lds
    s_add_u32 s63, s63, 40960
    s_mov_b32 m0, s62
    s_add_u32 s62, s62, 4096
    buffer_load_dwordx4 v16, s[36:39], s63 offen lds
    s_add_u32 s63, s63, 40960
    s_cmp_eq_u32 s63, 819200
    s_cselect_b32 s63, 0, s63
    s_mov_b32 m0, s62
    s_add_u32 s62, s62, 4096
    buffer_load_dwordx4 v16, s[36:39], s63 offen lds
    s_add_u32 s63, s63, 40960
    s_mov_b32 m0, s62
    s_add_u32 s62, s62, 4096
    buffer_load_dwordx4 v16, s[36:39], s63 offen lds
    s_add_u32 s63, s63, 40960
    s_cmp_eq_u32 s63, 819200
    s_cselect_b32 s63, 0, s63
    s_mov_b32 m0, s62
    s_add_u32 s62, s62, 4096
    buffer_load_dwordx4 v16, s[36:39], s63 offen lds
    s_add_u32 s63, s63, 40960
    s_mov_b32 m0, s62
    s_add_u32 s62, s62, 4096
    buffer_load_dwordx4 v16, s[36:39], s63 offen lds
    s_add_u32 s63, s63, 40960
    s_cmp_eq_u32 s63, 819200
    s_cselect_b32 s63, 0, s63
    s_cmp_eq_u32 s60, 3
    s_cbranch_scc1 pf_11
    s_mul_i32 s67, s53, 6
    s_lshl_b32 s68, s60, 1
    s_add_u32 s67, s67, s68
    s_mul_i32 s67, s67, 24320
    s_add_u32 s67, s67, 1310720
    buffer_load_dword v182, v36, s[24:27], s67 offen sc1
    s_mov_b64 exec, -1
    s_branch pf_12
pf_11:
    v_lshlrev_b32 v4, 7, v0
    s_mov_b64 exec, 7
    buffer_load_dword v182, v4, s[24:27], s57 offen sc1
    s_mov_b64 exec, -1
pf_12:
    s_cmp_lt_u32 s60, 2
    s_cbranch_scc1 LD_s10
    v_subrev_u32 v98, 20480, v16
    buffer_load_dwordx4 v[100:103], v16, s[36:39], s63 offen
    buffer_load_dwordx4 v[104:107], v98, s[36:39], s63 offen
    s_add_u32 s63, s63, 40960
    buffer_load_dwordx4 v[108:111], v16, s[36:39], s63 offen
    buffer_load_dwordx4 v[112:115], v98, s[36:39], s63 offen
    s_add_u32 s63, s63, 40960
    s_cmp_eq_u32 s63, 819200
    s_cselect_b32 s63, 0, s63
    buffer_load_dwordx4 v[116:119], v16, s[36:39], s63 offen
    buffer_load_dwordx4 v[120:123], v98, s[36:39], s63 offen
    s_add_u32 s63, s63, 40960
    buffer_load_dwordx4 v[124:127], v16, s[36:39], s63 offen
    buffer_load_dwordx4 v[128:131], v98, s[36:39], s63 offen
    s_add_u32 s63, s63, 40960
    s_cmp_eq_u32 s63, 819200
    s_cselect_b32 s63, 0, s63
    buffer_load_dwordx4 v[132:135], v16, s[36:39], s63 offen
    buffer_load_dwordx4 v[136:139], v98, s[36:39], s63 offen
    s_add_u32 s63, s63, 40960
    buffer_load_dwordx4 v[140:143], v16, s[36:39], s63 offen
    buffer_load_dwordx4 v[144:147], v98, s[36:39], s63 offen
    s_lshl_b32 s62, s60, 10
    s_add_u32 s62, s62, 10240
    v_lshl_add_u32 v99, v0, 4, s62
    s_barrier
    s_branch AT_67
LD_s10:
    v_mov_b32 v99, v16
    s_branch AT_start
F_start:
    v_and_b32 v0, 63, v0
    s_mov_b32 s3, 0x40000
    s_mov_b32 s47, 0xffff0000
    s_mov_b32 s26, 7340032
    s_mov_b32 s27, 0x00020000
    s_mov_b32 s38, 819200
    s_mov_b32 s39, 0x00020000
    s_mov_b32 s42, 2621440
    s_mov_b32 s43, 0x00020000
    s_and_b32 s49, s2, 7
    s_lshl_b32 s49, s49, 1
    s_add_u32 s49, s49, s56
    s_sub_u32 s49, s49, 30
    s_and_b32 s50, s48, 1
    s_lshr_b32 s51, s48, 1
    s_mul_i32 s52, s48, 6144
    s_mul_i32 s61, s49, 192
    v_mov_b32 v5, 128
    v_add_u32 v1, 0, v0
    v_mul_u32_u24 v2, 171, v1
    v_lshrrev_b32 v2, 11, v2
    v_mul_u32_u24 v3, 12, v2
    v_sub_u32 v3, v1, v3
    v_mul_u32_u24 v2, 3072, v2
    v_lshl_add_u32 v3, v3, 4, s61
    v_lshrrev_b32 v4, 8, v3
    v_cmp_eq_u32 vcc, 9, v4
    s_nop 1
    v_cndmask_b32 v4, 0, v5, vcc
    v_xad_u32 v210, v3, v4, v2
    v_add_u32 v1, 64, v0
    v_mul_u32_u24 v2, 171, v1
    v_lshrrev_b32 v2, 11, v2
    v_mul_u32_u24 v3, 12, v2
    v_sub_u32 v3, v1, v3
    v_mul_u32_u24 v2, 3072, v2
    v_lshl_add_u32 v3, v3, 4, s61
    v_lshrrev_b32 v4, 8, v3
    v_cmp_eq_u32 vcc, 9, v4
    s_nop 1
    v_cndmask_b32 v4, 0, v5, vcc
    v_xad_u32 v211, v3, v4, v2
    v_add_u32 v1, 128, v0
    v_mul_u32_u24 v2, 171, v1
    v_lshrrev_b32 v2, 11, v2
    v_mul_u32_u24 v3, 12, v2
    v_sub_u32 v3, v1, v3
    v_mul_u32_u24 v2, 3072, v2
    v_lshl_add_u32 v3, v3, 4, s61
    v_lshrrev_b32 v4, 8, v3
    v_cmp_eq_u32 vcc, 9, v4
    s_nop 1
    v_cndmask_b32 v4, 0, v5, vcc
    v_xad_u32 v212, v3, v4, v2
    s_mul_i32 s60, s51, 491520
    s_mov_b32 s30, 1966080
    s_mov_b32 s31, 0x00020000
    s_waitcnt lgkmcnt(0)
    s_cmp_eq_u32 s50, 0
    s_cselect_b32 s28, s14, s16
    s_cselect_b32 s29, s15, s17
    s_add_u32 m0, s52, 0
    s_add_u32 s62, s60, 0
    buffer_load_dwordx4 v210, s[28:31], s62 offen lds
    s_add_u32 m0, s52, 1024
    s_add_u32 s62, s60, 0
    buffer_load_dwordx4 v211, s[28:31], s62 offen lds
    s_add_u32 m0, s52, 2048
    s_add_u32 s62, s60, 0
    buffer_load_dwordx4 v212, s[28:31], s62 offen lds
    s_add_u32 m0, s52, 3072
    s_add_u32 s62, s60, 49152
    buffer_load_dwordx4 v210, s[28:31], s62 offen lds
    s_add_u32 m0, s52, 4096
    s_add_u32 s62, s60, 49152
    buffer_load_dwordx4 v211, s[28:31], s62 offen lds
    s_add_u32 m0, s52, 5120
    s_add_u32 s62, s60, 49152
    buffer_load_dwordx4 v212, s[28:31], s62 offen lds
    s_load_dword s54, s[24:25], 0
    s_mov_b32 s4, s12
    s_and_b32 s5, s13, 0xffff
    s_mov_b32 s6, 1280
    s_mov_b32 s7, 0x00020000
    s_mov_b32 s32, s18
    s_and_b32 s33, s19, 0xffff
    s_mov_b32 s34, 1966080
    s_mov_b32 s35, 0x00020000
    s_cmp_lg_u32 s48, 7
    s_cbranch_scc1 F_ntlb
    s_lshr_b32 s63, 25945, s49
    s_bitcmp0_b32 s63, 0
    s_cbranch_scc1 F_ntlb
    v_lshlrev_b32 v7, 16, v0
    buffer_load_dword v219, v7, s[40:43], 0 offen sc1
    buffer_load_dword v219, v7, s[36:39], 0 offen
    v_lshlrev_b32 v7, 17, v0
    buffer_load_dword v219, v7, s[24:27], 64 offen sc1
F_ntlb:
    s_barrier
    s_add_u32 m0, s52, 49152
    s_add_u32 s62, s60, 98304
    buffer_load_dwordx4 v210, s[28:31], s62 offen lds
    s_add_u32 m0, s52, 50176
    s_add_u32 s62, s60, 98304
    buffer_load_dwordx4 v211, s[28:31], s62 offen lds
    s_add_u32 m0, s52, 51200
    s_add_u32 s62, s60, 98304
    buffer_load_dwordx4 v212, s[28:31], s62 offen lds
    s_add_u32 m0, s52, 52224
    s_add_u32 s62, s60, 147456
    buffer_load_dwordx4 v210, s[28:31], s62 offen lds
    s_add_u32 m0, s52, 53248
    s_add_u32 s62, s60, 147456
    buffer_load_dwordx4 v211, s[28:31], s62 offen lds
    s_add_u32 m0, s52, 54272
    s_add_u32 s62, s60, 147456
    buffer_load_dwordx4 v212, s[28:31], s62 offen lds
    s_mul_i32 s53, s48, 5120
    s_mul_i32 s61, s49, 122880
    s_add_u32 s61, s61, s53
    s_and_b32 s63, s48, 2
    s_lshl_b32 s63, s63, 2
    v_add_u32 v1, 0, v0
    v_mul_u32_u24 v2, 205, v1
    v_lshrrev_b32 v2, 14, v2
    v_lshl_or_b32 v2, v2, 1, s63
    v_xor_b32 v1, v1, v2
    v_lshlrev_b32 v213, 4, v1
    v_add_u32 v1, 64, v0
    v_mul_u32_u24 v2, 205, v1
    v_lshrrev_b32 v2, 14, v2
    v_lshl_or_b32 v2, v2, 1, s63
    v_xor_b32 v1, v1, v2
    v_lshlrev_b32 v214, 4, v1
    v_add_u32 v1, 128, v0
    v_mul_u32_u24 v2, 205, v1
    v_lshrrev_b32 v2, 14, v2
    v_lshl_or_b32 v2, v2, 1, s63
    v_xor_b32 v1, v1, v2
    v_lshlrev_b32 v215, 4, v1
    v_add_u32 v1, 192, v0
    v_mul_u32_u24 v2, 205, v1
    v_lshrrev_b32 v2, 14, v2
    v_lshl_or_b32 v2, v2, 1, s63
    v_xor_b32 v1, v1, v2
    v_lshlrev_b32 v216, 4, v1
    v_add_u32 v1, 256, v0
    v_mul_u32_u24 v2, 205, v1
    v_lshrrev_b32 v2, 14, v2
    v_lshl_or_b32 v2, v2, 1, s63
    v_xor_b32 v1, v1, v2
    v_lshlrev_b32 v217, 4, v1
    v_lshrrev_b32 v2, 4, v0
    v_bfe_u32 v1, v0, 2, 2
    v_lshl_add_u32 v3, v2, 3, v1
    v_and_b32 v4, 3, v0
    v_lshlrev_b32 v4, 3, v4
    v_mul_u32_u24 v5, 192, v3
    s_and_b32 s63, s48, 5
    s_mul_i32 s63, s63, 6144
    s_and_b32 s66, s51, 1
    s_mul_i32 s64, s66, 96
    s_add_u32 s63, s63, s64
    v_add3_u32 v218, v5, v4, s63
    v_and_b32 v6, 1, v2
    v_lshl_or_b32 v6, v6, 2, v1
    v_lshlrev_b32 v6, 5, v6
    v_mul_u32_u24 v3, 1280, v3
    s_mul_i32 s63, s48, 160
    s_add_u32 s64, s63, 0
    v_add_u32 v7, s64, v4
    v_xor_b32 v7, v7, v6
    v_add_u32 v200, v7, v3
    v_add_u32 v205, 98304, v200
    s_add_u32 s64, s63, 32
    v_add_u32 v7, s64, v4
    v_xor_b32 v7, v7, v6
    v_add_u32 v201, v7, v3
    v_add_u32 v206, 98304, v201
    s_add_u32 s64, s63, 64
    v_add_u32 v7, s64, v4
    v_xor_b32 v7, v7, v6
    v_add_u32 v202, v7, v3
    v_add_u32 v207, 98304, v202
    s_add_u32 s64, s63, 96
    v_add_u32 v7, s64, v4
    v_xor_b32 v7, v7, v6
    v_add_u32 v203, v7, v3
    v_add_u32 v208, 98304, v203
    s_add_u32 s64, s63, 128
    v_add_u32 v7, s64, v4
    v_xor_b32 v7, v7, v6
    v_add_u32 v204, v7, v3
    v_add_u32 v209, 98304, v204
    s_waitcnt lgkmcnt(0)
    s_add_u32 s54, s54, 2654435761
    s_mov_b32 s67, 0x3f803f80
    v_mov_b32 v220, s67
    v_mov_b32 v221, s67
    v_mov_b32 v222, s67
    v_mov_b32 v223, s67
    v_mov_b64 v[232:233], 0
    v_mov_b64 v[234:235], 0
    v_mov_b64 v[236:237], 0
    v_mov_b64 v[238:239], 0
    v_mov_b64 v[240:241], 0
    v_mov_b64 v[242:243], 0
    v_lshlrev_b32 v16, 3, v0
    buffer_load_dwordx2 v[10:11], v16, s[4:7], 0 offen offset:0
    buffer_load_dwordx2 v[12:13], v16, s[4:7], 0 offen offset:512
    buffer_load_dwordx2 v[14:15], v16, s[4:7], 0 offen offset:1024
    v_lshlrev_b32 v1, 4, v0
    v_lshlrev_b32 v7, 6, v0
    s_lshl_b32 s15, s49, 11
    s_add_u32 s15, s15, 196608
    s_add_u32 s70, s15, 32768
    s_cmp_eq_u32 s48, 7
    s_cselect_b32 s65, s70, 2.0
    s_mov_b64 exec, 0xffffff
    buffer_load_dword v219, v7, s[24:27], s65 offen sc1
    s_mov_b64 exec, -1
    v_mov_b32 v8, 155648
    v_mov_b32 v224, 0
    v_mov_b32 v225, 0
    v_mov_b32 v226, 0
    v_mov_b32 v227, 0
    ds_write_b128 v8, v[224:227] offset:0
    ds_write_b128 v8, v[224:227] offset:16
    ds_write_b128 v8, v[224:227] offset:32
    ds_write_b128 v8, v[224:227] offset:3648
    ds_write_b128 v8, v[224:227] offset:3664
    ds_write_b128 v8, v[224:227] offset:3776
    ds_write_b128 v8, v[224:227] offset:3792
    s_mul_i32 s65, s48, 1344
    s_add_u32 s45, s65, 16384
    v_lshl_add_u32 v16, v0, 2, s45
    v_and_b32 v19, 15, v0
    v_bfe_u32 v5, v0, 1, 1
    v_mov_b32 v6, 0x44444444
    v_mov_b32 v9, 0xeeeeeeee
    v_cmp_eq_u32 vcc, 1, v5
    s_nop 1
    v_cndmask_b32 v252, v6, v9, vcc
    v_lshlrev_b32 v6, 4, v2
    v_lshl_add_u32 v6, v5, 7, v6
    v_add_u32 v6, v6, v8
    v_bfe_u32 v3, v0, 2, 2
    v_and_b32 v4, 1, v0
    v_lshl_add_u32 v3, v3, 1, v4
    v_mul_u32_u24 v9, 1344, v3
    v_mul_u32_u24 v5, 672, v5
    v_add_u32 v9, v9, v5
    v_lshrrev_b32 v3, 1, v2
    v_mul_u32_u24 v3, 160, v3
    v_and_b32 v4, 1, v2
    v_lshl_add_u32 v3, v4, 4, v3
    s_lshr_b32 s65, s48, 2
    s_mul_i32 s63, s65, 320
    v_add3_u32 v9, v9, v3, s63
    s_lshl1_add_u32 s65, s65, s50
    s_mul_i32 s65, s65, 768
    s_mul_i32 s66, s66, 384
    s_add_u32 s65, s65, s66
    v_lshl_add_u32 v3, v19, 3, s65
    v_add_u32 v230, 155904, v3
    v_mul_u32_u24 v4, 3328, v2
    v_add_u32 v3, v3, v4
    s_mul_i32 s65, s48, 48
    v_add_u32 v4, s65, v0
    v_bfe_u32 v5, v4, 1, 1
    v_lshlrev_b32 v5, 7, v5
    v_and_b32 v17, 1, v4
    v_lshl_add_u32 v5, v17, 1, v5
    v_and_b32 v17, 0xfc, v4
    v_add_u32 v5, v5, v17
    v_lshrrev_b32 v17, 6, v4
    v_lshl_add_u32 v5, v17, 5, v5
    v_add_u32 v5, v5, v8
    v_lshlrev_b32 v4, 3, v4
    v_and_b32 v17, 7, v0
    v_lshlrev_b32 v18, 4, v17
    v_lshl_add_u32 v18, v2, 11, v18
    v_lshrrev_b32 v19, 3, v19
    v_lshl_add_u32 v229, v19, 12, v18
    s_lshl_b32 s8, s48, 13
    s_lshl_b32 s65, s49, 7
    s_add_u32 s8, s8, s65
    s_add_u32 s8, s8, 16384
    s_sub_u32 s44, s48, 2
    s_lshl_b32 s14, s49, 12
    s_lshl_b32 s65, s44, 11
    s_add_u32 s14, s14, s65
    s_add_u32 s14, s14, 16384
    s_lshr_b32 s65, s49, 1
    s_lshl_b32 s65, s65, 6
    s_lshl3_add_u32 s65, s49, s65
    s_and_b32 s66, s44, 1
    s_movk_i32 s19, 0xff
    s_cselect_b32 s18, s19, 0x00ff00ff
    s_mul_i32 s66, s66, 48
    s_add_u32 s65, s65, s66
    v_and_b32 v18, 1, v2
    v_lshrrev_b32 v19, 1, v2
    v_lshl_or_b32 v18, v18, 1, v19
    v_min_u32 v18, 2, v18
    v_lshl_add_u32 v18, v18, 4, v17
    v_add_u32 v18, s65, v18
    v_bfe_u32 v19, v18, 1, 1
    v_mul_u32_u24 v19, 672, v19
    v_and_b32 v17, 1, v18
    v_lshl_add_u32 v19, v17, 1, v19
    v_and_b32 v17, 0xffc, v18
    v_add_u32 v19, v19, v17
    v_lshlrev_b32 v18, 1, v18
    v_mov_b32 v17, v229
    s_sub_u32 s65, s54, 1
    v_mov_b32 v227, s65
    s_mov_b32 exec_hi, 0
    buffer_store_dwordx4 v[224:227], v17, s[24:27], s8 offen sc1
    s_mov_b32 exec_hi, -1
    s_lshr_b32 s68, s48, 1
    s_mul_i32 s68, s68, 3328
    s_lshl2_add_u32 s68, s50, s68
    s_lshr_b32 s16, s49, 2
    s_mul_i32 s16, s16, 61440
    s_add_u32 s16, s16, 262144
    s_mov_b32 s17, 0
    s_mov_b32 s20, 16
    v_add_u32 v228, 155904, v4
    s_lshl_b32 s65, s48, 2
    v_add_u32 v231, s65, v8
    s_mov_b64 exec, 0
    s_cmp_eq_u32 s48, 0
    s_cbranch_scc1 HF0_0
    s_cmp_eq_u32 s48, 1
    s_cbranch_scc1 HF1_0
    s_cmp_eq_u32 s48, 2
    s_cbranch_scc1 HF2_0
    s_cmp_eq_u32 s48, 3
    s_cbranch_scc1 HF3_0
    s_cmp_eq_u32 s48, 4
    s_cbranch_scc1 HF4_0
    s_cmp_eq_u32 s48, 5
    s_cbranch_scc1 HF5_0
HF_ret:
    s_mov_b64 exec, -1
    s_add_u32 m0, s52, 98304
    s_add_u32 s62, s60, 196608
    buffer_load_dwordx4 v210, s[28:31], s62 offen lds
    s_add_u32 m0, s52, 99328
    s_add_u32 s62, s60, 196608
    buffer_load_dwordx4 v211, s[28:31], s62 offen lds
    s_add_u32 m0, s52, 100352
    s_add_u32 s62, s60, 196608
    buffer_load_dwordx4 v212, s[28:31], s62 offen lds
    s_add_u32 m0, s52, 101376
    s_add_u32 s62, s60, 245760
    buffer_load_dwordx4 v210, s[28:31], s62 offen lds
    s_add_u32 m0, s52, 102400
    s_add_u32 s62, s60, 245760
    buffer_load_dwordx4 v211, s[28:31], s62 offen lds
    s_add_u32 m0, s52, 103424
    s_add_u32 s62, s60, 245760
    buffer_load_dwordx4 v212, s[28:31], s62 offen lds
    s_waitcnt vmcnt(17)
    s_barrier
    ds_read_b64_tr_b16 v[20:21], v218 offset:0
    ds_read_b64_tr_b16 v[22:23], v218 offset:768
    ds_read_b64_tr_b16 v[24:25], v218 offset:12288
    ds_read_b64_tr_b16 v[26:27], v218 offset:13056
    ds_read_b64_tr_b16 v[28:29], v218 offset:32
    ds_read_b64_tr_b16 v[30:31], v218 offset:800
    ds_read_b64_tr_b16 v[32:33], v218 offset:12320
    ds_read_b64_tr_b16 v[34:35], v218 offset:13088
    ds_read_b64_tr_b16 v[36:37], v218 offset:64
    ds_read_b64_tr_b16 v[38:39], v218 offset:832
    ds_read_b64_tr_b16 v[40:41], v218 offset:12352
    ds_read_b64_tr_b16 v[42:43], v218 offset:13120
    s_waitcnt lgkmcnt(0)
    s_barrier
    s_add_u32 m0, s52, 0
    s_add_u32 s62, s60, 294912
    buffer_load_dwordx4 v210, s[28:31], s62 offen lds
    s_add_u32 m0, s52, 1024
    s_add_u32 s62, s60, 294912
    buffer_load_dwordx4 v211, s[28:31], s62 offen lds
    s_add_u32 m0, s52, 2048
    s_add_u32 s62, s60, 294912
    buffer_load_dwordx4 v212, s[28:31], s62 offen lds
    s_add_u32 m0, s52, 3072
    s_add_u32 s62, s60, 344064
    buffer_load_dwordx4 v210, s[28:31], s62 offen lds
    s_add_u32 m0, s52, 4096
    s_add_u32 s62, s60, 344064
    buffer_load_dwordx4 v211, s[28:31], s62 offen lds
    s_add_u32 m0, s52, 5120
    s_add_u32 s62, s60, 344064
    buffer_load_dwordx4 v212, s[28:31], s62 offen lds
    v_smfmac_f32_16x16x64_bf16 v[232:235], v[220:223], v[20:27], v252
    v_smfmac_f32_16x16x64_bf16 v[236:239], v[220:223], v[28:35], v252
    v_smfmac_f32_16x16x64_bf16 v[240:243], v[220:223], v[36:43], v252
    s_waitcnt vmcnt(17)
    s_barrier
    ds_read_b64_tr_b16 v[44:45], v218 offset:49152
    ds_read_b64_tr_b16 v[46:47], v218 offset:49920
    ds_read_b64_tr_b16 v[48:49], v218 offset:61440
    ds_read_b64_tr_b16 v[50:51], v218 offset:62208
    ds_read_b64_tr_b16 v[52:53], v218 offset:49184
    ds_read_b64_tr_b16 v[54:55], v218 offset:49952
    ds_read_b64_tr_b16 v[56:57], v218 offset:61472
    ds_read_b64_tr_b16 v[58:59], v218 offset:62240
    ds_read_b64_tr_b16 v[60:61], v218 offset:49216
    ds_read_b64_tr_b16 v[62:63], v218 offset:49984
    ds_read_b64_tr_b16 v[64:65], v218 offset:61504
    ds_read_b64_tr_b16 v[66:67], v218 offset:62272
    s_waitcnt lgkmcnt(0)
    s_barrier
    s_add_u32 m0, s52, 49152
    s_add_u32 s62, s60, 393216
    buffer_load_dwordx4 v210, s[28:31], s62 offen lds
    s_add_u32 m0, s52, 50176
    s_add_u32 s62, s60, 393216
    buffer_load_dwordx4 v211, s[28:31], s62 offen lds
    s_add_u32 m0, s52, 51200
    s_add_u32 s62, s60, 393216
    buffer_load_dwordx4 v212, s[28:31], s62 offen lds
    s_add_u32 m0, s52, 52224
    s_add_u32 s62, s60, 442368
    buffer_load_dwordx4 v210, s[28:31], s62 offen lds
    s_add_u32 m0, s52, 53248
    s_add_u32 s62, s60, 442368
    buffer_load_dwordx4 v211, s[28:31], s62 offen lds
    s_add_u32 m0, s52, 54272
    s_add_u32 s62, s60, 442368
    buffer_load_dwordx4 v212, s[28:31], s62 offen lds
    v_smfmac_f32_16x16x64_bf16 v[232:235], v[220:223], v[44:51], v252
    v_smfmac_f32_16x16x64_bf16 v[236:239], v[220:223], v[52:59], v252
    v_smfmac_f32_16x16x64_bf16 v[240:243], v[220:223], v[60:67], v252
    s_waitcnt vmcnt(12)
    s_barrier
    v_add_u32 v229, 98304, v218
    ds_read_b64_tr_b16 v[68:69], v229 offset:0
    ds_read_b64_tr_b16 v[70:71], v229 offset:768
    ds_read_b64_tr_b16 v[72:73], v229 offset:12288
    ds_read_b64_tr_b16 v[74:75], v229 offset:13056
    ds_read_b64_tr_b16 v[76:77], v229 offset:32
    ds_read_b64_tr_b16 v[78:79], v229 offset:800
    ds_read_b64_tr_b16 v[80:81], v229 offset:12320
    ds_read_b64_tr_b16 v[82:83], v229 offset:13088
    ds_read_b64_tr_b16 v[84:85], v229 offset:64
    ds_read_b64_tr_b16 v[86:87], v229 offset:832
    ds_read_b64_tr_b16 v[88:89], v229 offset:12352
    ds_read_b64_tr_b16 v[90:91], v229 offset:13120
    s_waitcnt lgkmcnt(0)
    s_barrier
    s_mul_i32 s62, s49, 3
    s_add_u32 s62, s62, 0
    s_lshr_b32 s63, s62, 2
    s_cmp_eq_u32 s63, 9
    s_cselect_b32 s63, 2, 0
    s_xor_b32 s62, s62, s63
    s_mul_i32 s62, s62, 40960
    s_add_u32 s62, s62, s53
    s_add_u32 m0, s53, 98304
    s_nop 0
    buffer_load_dwordx4 v213, s[32:35], s62 offen lds
    s_add_u32 m0, s53, 99328
    s_nop 0
    buffer_load_dwordx4 v214, s[32:35], s62 offen lds
    s_add_u32 m0, s53, 100352
    s_nop 0
    buffer_load_dwordx4 v215, s[32:35], s62 offen lds
    s_add_u32 m0, s53, 101376
    s_nop 0
    buffer_load_dwordx4 v216, s[32:35], s62 offen lds
    s_add_u32 m0, s53, 102400
    s_nop 0
    buffer_load_dwordx4 v217, s[32:35], s62 offen lds
    v_smfmac_f32_16x16x64_bf16 v[232:235], v[220:223], v[68:75], v252
    v_smfmac_f32_16x16x64_bf16 v[236:239], v[220:223], v[76:83], v252
    v_smfmac_f32_16x16x64_bf16 v[240:243], v[220:223], v[84:91], v252
    v_dot2_f32_bf16 v226, v10, s67, 0
    v_dot2_f32_bf16 v226, v11, s67, v226
    v_dot2_f32_bf16 v226, v12, s67, v226
    v_dot2_f32_bf16 v226, v13, s67, v226
    v_dot2_f32_bf16 v226, v14, s67, v226
    v_dot2_f32_bf16 v226, v15, s67, v226
    s_nop 2
    v_add_f32_dpp v226, v226, v226 row_ror:1 row_mask:0xf bank_mask:0xf
    s_nop 1
    v_add_f32_dpp v226, v226, v226 row_ror:2 row_mask:0xf bank_mask:0xf
    s_nop 1
    v_add_f32_dpp v226, v226, v226 row_ror:4 row_mask:0xf bank_mask:0xf
    s_nop 1
    v_add_f32_dpp v226, v226, v226 row_ror:8 row_mask:0xf bank_mask:0xf
    v_mov_b32 v229, v226
    s_nop 1
    v_permlane32_swap_b32 v226, v229
    v_add_f32 v226, v226, v229
    v_mov_b32 v229, v226
    s_nop 1
    v_permlane16_swap_b32 v226, v229
    v_add_f32 v226, v226, v229
    s_nop 0
    v_readfirstlane_b32 s55, v226
    s_waitcnt vmcnt(11)
    s_barrier
    ds_read_b64_tr_b16 v[92:93], v218 offset:0
    ds_read_b64_tr_b16 v[94:95], v218 offset:768
    ds_read_b64_tr_b16 v[96:97], v218 offset:12288
    ds_read_b64_tr_b16 v[98:99], v218 offset:13056
    ds_read_b64_tr_b16 v[100:101], v218 offset:32
    ds_read_b64_tr_b16 v[102:103], v218 offset:800
    ds_read_b64_tr_b16 v[104:105], v218 offset:12320
    ds_read_b64_tr_b16 v[106:107], v218 offset:13088
    ds_read_b64_tr_b16 v[108:109], v218 offset:64
    ds_read_b64_tr_b16 v[110:111], v218 offset:832
    ds_read_b64_tr_b16 v[112:113], v218 offset:12352
    ds_read_b64_tr_b16 v[114:115], v218 offset:13120
    s_waitcnt lgkmcnt(0)
    s_barrier
    s_mul_i32 s62, s49, 3
    s_add_u32 s62, s62, 1
    s_lshr_b32 s63, s62, 2
    s_cmp_eq_u32 s63, 9
    s_cselect_b32 s63, 2, 0
    s_xor_b32 s62, s62, s63
    s_mul_i32 s62, s62, 40960
    s_add_u32 s62, s62, s53
    s_add_u32 m0, s53, 0
    s_nop 0
    buffer_load_dwordx4 v213, s[32:35], s62 offen lds
    s_add_u32 m0, s53, 1024
    s_nop 0
    buffer_load_dwordx4 v214, s[32:35], s62 offen lds
    s_add_u32 m0, s53, 2048
    s_nop 0
    buffer_load_dwordx4 v215, s[32:35], s62 offen lds
    s_add_u32 m0, s53, 3072
    s_nop 0
    buffer_load_dwordx4 v216, s[32:35], s62 offen lds
    s_add_u32 m0, s53, 4096
    s_nop 0
    buffer_load_dwordx4 v217, s[32:35], s62 offen lds
    v_smfmac_f32_16x16x64_bf16 v[232:235], v[220:223], v[92:99], v252
    v_smfmac_f32_16x16x64_bf16 v[236:239], v[220:223], v[100:107], v252
    v_smfmac_f32_16x16x64_bf16 v[240:243], v[220:223], v[108:115], v252
    s_waitcnt vmcnt(10)
    s_barrier
    ds_read_b64_tr_b16 v[116:117], v218 offset:49152
    ds_read_b64_tr_b16 v[118:119], v218 offset:49920
    ds_read_b64_tr_b16 v[120:121], v218 offset:61440
    ds_read_b64_tr_b16 v[122:123], v218 offset:62208
    ds_read_b64_tr_b16 v[124:125], v218 offset:49184
    ds_read_b64_tr_b16 v[126:127], v218 offset:49952
    ds_read_b64_tr_b16 v[128:129], v218 offset:61472
    ds_read_b64_tr_b16 v[130:131], v218 offset:62240
    ds_read_b64_tr_b16 v[132:133], v218 offset:49216
    ds_read_b64_tr_b16 v[134:135], v218 offset:49984
    ds_read_b64_tr_b16 v[136:137], v218 offset:61504
    ds_read_b64_tr_b16 v[138:139], v218 offset:62272
    s_waitcnt lgkmcnt(0)
    s_barrier
    s_mul_i32 s62, s49, 3
    s_add_u32 s62, s62, 2
    s_lshr_b32 s63, s62, 2
    s_cmp_eq_u32 s63, 9
    s_cselect_b32 s63, 2, 0
    s_xor_b32 s62, s62, s63
    s_mul_i32 s62, s62, 40960
    s_add_u32 s62, s62, s53
    s_add_u32 m0, s53, 49152
    s_nop 0
    buffer_load_dwordx4 v213, s[32:35], s62 offen lds
    s_add_u32 m0, s53, 50176
    s_nop 0
    buffer_load_dwordx4 v214, s[32:35], s62 offen lds
    s_add_u32 m0, s53, 51200
    s_nop 0
    buffer_load_dwordx4 v215, s[32:35], s62 offen lds
    s_add_u32 m0, s53, 52224
    s_nop 0
    buffer_load_dwordx4 v216, s[32:35], s62 offen lds
    s_add_u32 m0, s53, 53248
    s_nop 0
    buffer_load_dwordx4 v217, s[32:35], s62 offen lds
    s_cmp_eq_u32 s48, 0
    s_cselect_b32 s65, s15, 2.0
    s_mov_b64 exec, 0xffffff
    buffer_load_dwordx2 v[224:225], v7, s[24:27], s65 offen sc1
    s_mov_b64 exec, -1
    v_smfmac_f32_16x16x64_bf16 v[232:235], v[220:223], v[116:123], v252
    v_smfmac_f32_16x16x64_bf16 v[236:239], v[220:223], v[124:131], v252
    v_smfmac_f32_16x16x64_bf16 v[240:243], v[220:223], v[132:139], v252
    s_mov_b64 exec, 0xffff
    s_nop 8
    v_pk_add_f32 v[232:233], v[232:233], v[234:235]
    ds_write_b64 v230, v[232:233] offset:0
    v_pk_add_f32 v[236:237], v[236:237], v[238:239]
    ds_write_b64 v230, v[236:237] offset:128
    v_pk_add_f32 v[240:241], v[240:241], v[242:243]
    ds_write_b64 v230, v[240:241] offset:256
    s_mov_b64 exec, -1
    s_waitcnt lgkmcnt(0)
    s_waitcnt vmcnt(6)
    s_barrier
    ds_read2st64_b32 v[232:233], v228 offset0:0 offset1:3
    ds_read2st64_b32 v[234:235], v228 offset0:6 offset1:9
    ds_read_b64_tr_b16 v[140:141], v205 offset:0
    ds_read_b64_tr_b16 v[142:143], v205 offset:5120
    ds_read_b64_tr_b16 v[152:153], v206 offset:0
    ds_read_b64_tr_b16 v[154:155], v206 offset:5120
    ds_read_b64_tr_b16 v[164:165], v207 offset:0
    ds_read_b64_tr_b16 v[166:167], v207 offset:5120
    ds_read_b64_tr_b16 v[176:177], v208 offset:0
    ds_read_b64_tr_b16 v[178:179], v208 offset:5120
    ds_read_b64_tr_b16 v[188:189], v209 offset:0
    ds_read_b64_tr_b16 v[190:191], v209 offset:5120
    ds_read_b64_tr_b16 v[144:145], v200 offset:0
    ds_read_b64_tr_b16 v[146:147], v200 offset:5120
    ds_read_b64_tr_b16 v[156:157], v201 offset:0
    ds_read_b64_tr_b16 v[158:159], v201 offset:5120
    ds_read_b64_tr_b16 v[168:169], v202 offset:0
    ds_read_b64_tr_b16 v[170:171], v202 offset:5120
    ds_read_b64_tr_b16 v[180:181], v203 offset:0
    ds_read_b64_tr_b16 v[182:183], v203 offset:5120
    ds_read_b64_tr_b16 v[192:193], v204 offset:0
    ds_read_b64_tr_b16 v[194:195], v204 offset:5120
    s_waitcnt lgkmcnt(0)
    v_add_f32 v0, v232, v234
    v_add_f32 v2, v233, v235
    s_waitcnt vmcnt(1)
    s_barrier
    ds_read_b64_tr_b16 v[148:149], v200 offset:49152
    ds_read_b64_tr_b16 v[150:151], v200 offset:54272
    ds_read_b64_tr_b16 v[160:161], v201 offset:49152
    ds_read_b64_tr_b16 v[162:163], v201 offset:54272
    ds_read_b64_tr_b16 v[172:173], v202 offset:49152
    ds_read_b64_tr_b16 v[174:175], v202 offset:54272
    ds_read_b64_tr_b16 v[184:185], v203 offset:49152
    ds_read_b64_tr_b16 v[186:187], v203 offset:54272
    ds_read_b64_tr_b16 v[196:197], v204 offset:49152
    ds_read_b64_tr_b16 v[198:199], v204 offset:54272
    s_waitcnt lgkmcnt(0)
F_rdy:
HF0_0:
    s_cbranch_execz HF0_1
    s_cmp_lg_u32 s48, 0
    s_cbranch_scc1 F_wait
    s_mov_b64 exec, 0xffffff
    s_branch F_pw
F_poll:
    buffer_load_dwordx2 v[224:225], v7, s[24:27], s15 offen sc1
F_pw:
    s_waitcnt vmcnt(0)
    v_cmp_ne_u32 vcc, s54, v225
    s_cbranch_vccz F_got
    s_sleep 1
    s_sub_u32 s3, s3, 1
    s_cbranch_scc0 F_poll
    s_mov_b32 s3, 0
F_got:
    s_mov_b64 exec, -1
    v_max_u32_dpp v226, v224, v224 row_ror:1 row_mask:0xf bank_mask:0xf
    s_nop 1
    v_max_u32_dpp v226, v226, v226 row_ror:2 row_mask:0xf bank_mask:0xf
    s_nop 1
    v_max_u32_dpp v226, v226, v226 row_ror:4 row_mask:0xf bank_mask:0xf
    s_nop 1
    v_max_u32_dpp v226, v226, v226 row_ror:8 row_mask:0xf bank_mask:0xf
    s_nop 0
    v_readlane_b32 s60, v226, 0
    v_readlane_b32 s62, v226, 16
    s_max_u32 s60, s60, s62
    s_max_u32 s60, s60, 1376257
    s_sub_u32 s60, s60, 1376256
    v_cmp_le_u32 vcc, s60, v224
    s_nop 1
    v_mbcnt_lo_u32_b32 v226, vcc_lo, 0
HF0_1:
    s_cbranch_execz HF_ret
    v_cmp_gt_u32 s[62:63], 8, v226
    v_lshl_add_u32 v226, v226, 2, v8
    s_and_b64 exec, vcc, s[62:63]
    ds_write_b32 v226, v224 offset:0
    s_mov_b64 exec, -1
    s_waitcnt lgkmcnt(0)
F_wait:
    s_waitcnt vmcnt(0)
    s_barrier
    ds_read_b32 v224, v231 offset:0
    s_waitcnt lgkmcnt(0)
    v_readfirstlane_b32 s60, v224
F_redo:
    v_mov_b64 v[232:233], 0
    v_mov_b64 v[234:235], 0
    v_mov_b64 v[236:237], 0
    v_mov_b64 v[238:239], 0
    v_mov_b64 v[240:241], 0
    v_mov_b64 v[242:243], 0
    s_and_b32 s61, s60, 0xfff
    s_cbranch_scc0 F_b1
    s_lshr_b32 s62, s61, 4
    s_mul_i32 s62, s62, 171
    s_lshr_b32 s62, s62, 10
    s_mul_i32 s62, s62, 2560
    s_add_u32 s62, s62, s16
    s_add_u32 s63, s54, s61
    v_mov_b64 v[228:229], 0
    v_mov_b32 v230, s63
    buffer_load_dwordx3 v[220:222], v1, s[24:27], s62 offen offset:0 sc1
    buffer_load_dwordx3 v[224:226], v1, s[24:27], s62 offen offset:1024 sc1
    s_mov_b32 exec_hi, 0
    buffer_load_dwordx3 v[228:230], v1, s[24:27], s62 offen offset:2048 sc1
    s_mov_b32 exec_hi, -1
    s_branch F_rw
F_row:
    s_mov_b64 exec, s[58:59]
    s_cbranch_execz F_r0
    buffer_load_dwordx3 v[220:222], v1, s[24:27], s62 offen offset:0 sc1
F_r0:
    s_mov_b64 exec, s[64:65]
    s_cbranch_execz F_r1
    buffer_load_dwordx3 v[224:226], v1, s[24:27], s62 offen offset:1024 sc1
F_r1:
    s_mov_b64 exec, s[10:11]
    s_cbranch_execz F_r2
    buffer_load_dwordx3 v[228:230], v1, s[24:27], s62 offen offset:2048 sc1
F_r2:
    s_mov_b64 exec, -1
F_rw:
    s_waitcnt vmcnt(0)
    ds_write2_b32 v16, v220, v221 offset0:0 offset1:168
    ds_write2_b32 v16, v224, v225 offset0:64 offset1:232
    s_mov_b32 exec_hi, 0
    ds_write_b32 v16, v228 offset:512
    ds_write_b32 v16, v229 offset:1184
    s_mov_b32 exec_hi, -1
HF1_0:
    s_cbranch_execz HF1_1
    v_cmp_ne_u32 s[58:59], s63, v222
    v_cmp_ne_u32 s[64:65], s63, v226
    v_cmp_ne_u32 s[10:11], s63, v230
    s_or_b64 vcc, s[58:59], s[64:65]
    s_or_b64 vcc, vcc, s[10:11]
    s_cbranch_scc0 F_ok
    s_sub_u32 s20, s20, 1
    s_cbranch_scc0 F_row
F_b1:
    s_waitcnt lgkmcnt(0)
    s_barrier
    s_cmp_lg_u32 s48, 6
    s_cbranch_scc1 F_nwb
    s_bitcmp1_b32 s49, 0
    s_cbranch_scc1 F_nwb
    buffer_wbl2 sc1
F_nwb:
    ds_read_b128 v[200:203], v9 offset:16384
    ds_read_b128 v[204:207], v9 offset:16416
    ds_read_b128 v[208:211], v9 offset:16448
    ds_read_b128 v[212:215], v9 offset:16480
    ds_read_b128 v[216:219], v9 offset:16512
    s_waitcnt lgkmcnt(4)
    v_smfmac_f32_16x16x64_bf16 v[232:235], v[200:203], v[20:27], v252
    v_smfmac_f32_16x16x64_bf16 v[236:239], v[200:203], v[28:35], v252
    v_smfmac_f32_16x16x64_bf16 v[240:243], v[200:203], v[36:43], v252
    s_waitcnt lgkmcnt(3)
    v_smfmac_f32_16x16x64_bf16 v[232:235], v[204:207], v[44:51], v252
    v_smfmac_f32_16x16x64_bf16 v[236:239], v[204:207], v[52:59], v252
    v_smfmac_f32_16x16x64_bf16 v[240:243], v[204:207], v[60:67], v252
    s_waitcnt lgkmcnt(2)
    v_smfmac_f32_16x16x64_bf16 v[232:235], v[208:211], v[68:75], v252
    v_smfmac_f32_16x16x64_bf16 v[236:239], v[208:211], v[76:83], v252
    v_smfmac_f32_16x16x64_bf16 v[240:243], v[208:211], v[84:91], v252
    s_waitcnt lgkmcnt(1)
    v_smfmac_f32_16x16x64_bf16 v[232:235], v[212:215], v[92:99], v252
    v_smfmac_f32_16x16x64_bf16 v[236:239], v[212:215], v[100:107], v252
    v_smfmac_f32_16x16x64_bf16 v[240:243], v[212:215], v[108:115], v252
    s_waitcnt lgkmcnt(0)
    v_smfmac_f32_16x16x64_bf16 v[232:235], v[216:219], v[116:123], v252
HF1_1:
    s_cbranch_execz HF_ret
    v_smfmac_f32_16x16x64_bf16 v[236:239], v[216:219], v[124:131], v252
    v_smfmac_f32_16x16x64_bf16 v[240:243], v[216:219], v[132:139], v252
    s_nop 8
    s_branch F_pw2
F_ok:
    v_dot2_f32_bf16 v222, v220, s67, 0
    v_dot2_f32_bf16 v223, v220, v220, 0
    v_dot2_f32_bf16 v226, v220, v10, 0
    v_dot2_f32_bf16 v222, v221, s67, v222
    v_dot2_f32_bf16 v223, v221, v221, v223
    v_dot2_f32_bf16 v226, v221, v11, v226
    v_dot2_f32_bf16 v222, v224, s67, v222
    v_dot2_f32_bf16 v223, v224, v224, v223
    v_dot2_f32_bf16 v226, v224, v12, v226
    v_dot2_f32_bf16 v222, v225, s67, v222
    v_dot2_f32_bf16 v223, v225, v225, v223
    v_dot2_f32_bf16 v226, v225, v13, v226
    v_dot2_f32_bf16 v222, v228, s67, v222
    v_dot2_f32_bf16 v223, v228, v228, v223
    v_dot2_f32_bf16 v226, v228, v14, v226
    v_dot2_f32_bf16 v222, v229, s67, v222
    v_dot2_f32_bf16 v223, v229, v229, v223
    v_dot2_f32_bf16 v226, v229, v15, v226
    s_waitcnt lgkmcnt(0)
    s_barrier
    ds_read_b128 v[200:203], v9 offset:16384
    ds_read_b128 v[204:207], v9 offset:16416
    ds_read_b128 v[208:211], v9 offset:16448
    ds_read_b128 v[212:215], v9 offset:16480
    ds_read_b128 v[216:219], v9 offset:16512
    v_mov_b32 v227, v226
    v_permlane32_swap_b32 v222, v223
    s_nop 0
    v_permlane32_swap_b32 v226, v227
    v_add_f32 v222, v222, v223
    v_add_f32 v226, v226, v227
    v_mov_b32 v224, s68
    v_mov_b32 v223, s45
HF2_0:
    s_cbranch_execz HF2_1
    v_permlane16_swap_b32 v222, v226
    v_add_f32 v222, v222, v226
    s_waitcnt lgkmcnt(4)
    v_smfmac_f32_16x16x64_bf16 v[232:235], v[200:203], v[20:27], v252
    v_add_f32_dpp v222, v222, v222 row_ror:1 row_mask:0xf bank_mask:0xf
    s_nop 1
    v_add_f32_dpp v222, v222, v222 row_ror:2 row_mask:0xf bank_mask:0xf
    v_smfmac_f32_16x16x64_bf16 v[236:239], v[200:203], v[28:35], v252
    s_nop 0
    v_add_f32_dpp v222, v222, v222 row_ror:4 row_mask:0xf bank_mask:0xf
    s_nop 1
    v_add_f32_dpp v222, v222, v222 row_ror:8 row_mask:0xf bank_mask:0xf
    v_smfmac_f32_16x16x64_bf16 v[240:243], v[200:203], v[36:43], v252
    v_readlane_b32 s64, v222, 32
    v_readlane_b32 s65, v222, 16
    s_waitcnt lgkmcnt(3)
    v_smfmac_f32_16x16x64_bf16 v[232:235], v[204:207], v[44:51], v252
    v_mov_b32 v220, v222
    v_mov_b32 v221, s64
    v_smfmac_f32_16x16x64_bf16 v[236:239], v[204:207], v[52:59], v252
    v_mul_f32 v220, 0x3acccccd, v220
    v_mul_f32 v221, 0x3acccccd, v221
    v_smfmac_f32_16x16x64_bf16 v[240:243], v[204:207], v[60:67], v252
    v_fma_f32 v221, -v220, v220, v221
    v_max_f32 v221, 0, v221
    s_waitcnt lgkmcnt(2)
    v_smfmac_f32_16x16x64_bf16 v[232:235], v[208:211], v[68:75], v252
    v_cvt_pk_bf16_f32 v221, v221, v221
    v_and_b32 v221, 0xffff0000, v221
    v_smfmac_f32_16x16x64_bf16 v[236:239], v[208:211], v[76:83], v252
    v_add_f32 v221, 0x3727c5ac, v221
    v_cvt_pk_bf16_f32 v221, v221, v221
    v_smfmac_f32_16x16x64_bf16 v[240:243], v[208:211], v[84:91], v252
    v_and_b32 v221, 0xffff0000, v221
    v_sqrt_f32 v221, v221
    s_waitcnt lgkmcnt(1)
    v_smfmac_f32_16x16x64_bf16 v[232:235], v[212:215], v[92:99], v252
    v_cvt_pk_bf16_f32 v220, v220, v220
HF2_1:
    s_cbranch_execz HF_ret
    v_and_b32 v220, 0xffff0000, v220
    v_smfmac_f32_16x16x64_bf16 v[236:239], v[212:215], v[100:107], v252
    v_cvt_pk_bf16_f32 v221, v221, v221
    v_and_b32 v221, 0xffff0000, v221
    v_smfmac_f32_16x16x64_bf16 v[240:243], v[212:215], v[108:115], v252
    v_rcp_f32 v221, v221
    v_mul_f32 v222, s55, v220
    s_waitcnt lgkmcnt(0)
    v_smfmac_f32_16x16x64_bf16 v[232:235], v[216:219], v[116:123], v252
    v_sub_f32 v222, s65, v222
    v_mul_f32 v222, v222, v221
    v_smfmac_f32_16x16x64_bf16 v[236:239], v[216:219], v[124:131], v252
    v_ashrrev_i32 v225, 31, v222
    v_or_b32 v225, 0x80000000, v225
    v_smfmac_f32_16x16x64_bf16 v[240:243], v[216:219], v[132:139], v252
    v_xor_b32 v225, v225, v222
    v_and_b32 v225, 0xfffff000, v225
    v_or_b32 v225, s61, v225
    s_mov_b64 exec, 1
    ds_write2_b32 v224, v220, v221 offset0:0 offset1:2
    ds_write2_b32 v224, v222, v223 offset0:4 offset1:6
    ds_max_u64 v8, v[224:225] offset:32
    s_mov_b64 exec, -1
F_pw2:
    v_pk_add_f32 v[232:233], v[232:233], v[234:235]
    ds_write_b64 v3, v[232:233] offset:256
    v_pk_add_f32 v[236:237], v[236:237], v[238:239]
    ds_write_b64 v3, v[236:237] offset:384
    v_pk_add_f32 v[240:241], v[240:241], v[242:243]
    ds_write_b64 v3, v[240:241] offset:512
    s_cmp_ge_u32 s48, 2
    v_mov_b64 v[244:245], 0
    v_mov_b64 v[246:247], 0
    v_mov_b64 v[248:249], 0
    v_mov_b64 v[250:251], 0
    s_waitcnt lgkmcnt(0)
    s_barrier
    ds_read_b64 v[224:225], v8 offset:32
    v_mov_b64 v[232:233], 0
    v_mov_b64 v[234:235], 0
    v_mov_b64 v[236:237], 0
    v_mov_b64 v[238:239], 0
    v_mov_b64 v[240:241], 0
    v_mov_b64 v[242:243], 0
HF3_0:
    s_cbranch_execz HF3_1
    s_waitcnt lgkmcnt(0)
    s_cbranch_scc1 F_gu
    v_add_u32 v227, v224, v4
    ds_read2_b32 v[228:229], v224 offset0:0 offset1:2
    ds_read2st64_b32 v[208:209], v227 offset0:1 offset1:4
    ds_read2st64_b32 v[210:211], v227 offset0:7 offset1:10
    s_waitcnt lgkmcnt(1)
    v_fma_f32 v208, -v228, v0, v208
    v_fma_f32 v209, -v228, v2, v209
    s_waitcnt lgkmcnt(0)
    v_add_f32 v208, v208, v210
    v_add_f32 v209, v209, v211
    v_mul_f32 v208, v208, v229
    v_mul_f32 v209, v209, v229
    v_cvt_pk_bf16_f32 v209, v208, v209
    v_lshlrev_b32 v208, 16, v209
    v_mul_f32 v210, 0xbfb8aa3b, v208
    v_exp_f32 v210, v210
    v_and_b32 v209, s47, v209
    v_add_f32 v210, 1.0, v210
    v_rcp_f32 v210, v210
    s_mov_b32 exec_hi, 0xffff
    v_mul_f32 v208, v208, v210
    v_cvt_pk_bf16_f32 v208, v208, v208
    v_and_b32 v208, 0xffff0000, v208
    v_mul_f32 v208, v208, v209
    v_cvt_pk_bf16_f32 v208, v208, v208
    ds_write_b16 v5, v208 offset:3584
    s_mov_b64 exec, -1
    s_waitcnt lgkmcnt(0)
F_gu:
    s_barrier
    ds_read_b128 v[200:203], v6 offset:3584
    ds_read_b128 v[204:207], v6 offset:3648
    v_readfirstlane_b32 s61, v225
    v_mov_b32 v220, 0
    s_and_b32 s61, s61, 0xfff
    s_add_u32 s63, s54, s61
    v_mov_b32 v215, s63
    s_waitcnt lgkmcnt(1)
    v_smfmac_f32_16x16x64_bf16 v[232:235], v[200:203], v[140:147], v252
    v_smfmac_f32_16x16x64_bf16 v[236:239], v[200:203], v[152:159], v252
    v_smfmac_f32_16x16x64_bf16 v[240:243], v[200:203], v[164:171], v252
    v_smfmac_f32_16x16x64_bf16 v[244:247], v[200:203], v[176:183], v252
    v_smfmac_f32_16x16x64_bf16 v[248:251], v[200:203], v[188:195], v252
HF3_1:
    s_cbranch_execz HF_ret
    s_cmp_lg_u32 s48, 7
    s_cbranch_scc1 F_n7
    s_mov_b64 exec, 0xffffff
    buffer_load_dwordx2 v[220:221], v7, s[24:27], s70 offen sc1
    s_mov_b64 exec, -1
F_n7:
    s_waitcnt lgkmcnt(0)
    v_smfmac_f32_16x16x64_bf16 v[232:235], v[204:207], v[144:151], v252
    v_smfmac_f32_16x16x64_bf16 v[236:239], v[204:207], v[156:163], v252
    v_smfmac_f32_16x16x64_bf16 v[240:243], v[204:207], v[168:175], v252
    v_smfmac_f32_16x16x64_bf16 v[244:247], v[204:207], v[180:187], v252
    v_smfmac_f32_16x16x64_bf16 v[248:251], v[204:207], v[192:199], v252
    s_nop 7
    v_add_f32 v212, v232, v234
    v_add_f32 v213, v236, v238
    v_add_f32 v214, v240, v242
    s_mov_b32 exec_lo, s47
    v_add_f32 v212, v244, v246
    v_add_f32 v213, v248, v250
    s_mov_b32 exec_lo, -1
    s_mov_b32 exec_hi, 0
    buffer_store_dwordx4 v[212:215], v17, s[24:27], s8 offen sc1
    s_mov_b32 exec_hi, -1
    s_cmp_lt_u32 s44, 2
    s_cbranch_scc0 F_rest
    ds_read2_b32 v[228:229], v224 offset0:0 offset1:2
    ds_read2_b32 v[230:231], v224 offset0:4 offset1:6
    s_lshr_b32 s65, s61, 4
    s_mul_i32 s65, s65, 171
    s_lshr_b32 s65, s65, 10
    s_mul_i32 s64, s65, 2560
    s_add_u32 s64, s64, 131072
    s_mul_i32 s71, s65, 96
    s_sub_u32 s66, s61, s71
    s_lshr_b32 s71, s65, 1
    s_mul_i32 s71, s71, 86
    s_add_u32 s66, s66, s71
    s_sub_u32 s66, s66, 10
    s_lshl_b32 s66, s66, 1
    s_and_b32 s65, s65, 1
    s_add_u32 s66, s66, s65
    s_mul_i32 s66, s66, 1280
    v_lshrrev_b32 v223, 3, v18
    v_lshlrev_b32 v223, 4, v223
    s_waitcnt lgkmcnt(0)
    v_add_u32 v226, v231, v19
    v_and_b32 v226, 0xfffe, v226
HF4_0:
    s_cbranch_execz HF4_1
    ds_read_u16 v226, v226
    v_cvt_pk_bf16_f32 v231, v230, v230
    v_and_b32 v231, 0xffff0000, v231
    v_mul_f32 v231, 0xbfb8aa3b, v231
    v_exp_f32 v231, v231
    s_nop 0
    v_add_f32 v231, 1.0, v231
    v_rcp_f32 v231, v231
    s_waitcnt lgkmcnt(0)
    v_lshlrev_b32 v226, 16, v226
    v_cvt_pk_bf16_f32 v231, v231, v231
    v_and_b32 v231, 0xffff0000, v231
    v_sub_f32 v227, v226, v228
    v_cvt_pk_bf16_f32 v227, v227, v227
    v_and_b32 v227, 0xffff0000, v227
    v_mul_f32 v227, v227, v229
    v_cvt_pk_bf16_f32 v227, v227, v227
    v_and_b32 v227, 0xffff0000, v227
    s_waitcnt vmcnt(0)
F_yp:
    buffer_load_dwordx4 v[200:203], v1, s[24:27], s14 offen sc1
    buffer_load_dwordx4 v[204:207], v1, s[24:27], s14 offen offset:1024 sc1
    s_mov_b64 exec, s[18:19]
    buffer_load_dword v222, v223, s[24:27], s64 offen offset:8 sc1
    s_mov_b64 exec, -1
    s_waitcnt vmcnt(1)
    ds_read_b32 v224, v8 offset:40
    v_cmp_ne_u32 vcc, s63, v203
    v_cmp_ne_u32 s[58:59], s63, v207
    v_add_f32 v200, v200, v204
    v_add_f32 v201, v201, v205
    v_add_f32 v202, v202, v206
    s_or_b64 vcc, vcc, s[58:59]
    s_cbranch_scc1 F_chk
    v_mov_b32 v203, v202
    v_permlane32_swap_b32 v200, v201
    s_nop 0
    v_permlane32_swap_b32 v202, v203
    v_add_f32 v200, v200, v201
    v_add_f32 v202, v202, v203
    s_nop 1
    v_permlane16_swap_b32 v200, v202
    v_add_f32 v200, v200, v202
    s_nop 1
    v_add_f32_dpp v200, v200, v200 row_ror:8 row_mask:0xf bank_mask:0xf
    v_cvt_pk_bf16_f32 v200, v200, v200
HF4_1:
    s_cbranch_execz HF_ret
    v_and_b32 v200, 0xffff0000, v200
    v_mul_f32 v200, v200, v231
    v_cvt_pk_bf16_f32 v200, v200, v200
    v_and_b32 v200, 0xffff0000, v200
    v_add_f32 v200, v200, v227
    v_cvt_pk_bf16_f32 v200, v200, v200
    v_and_b32 v200, 0xffff0000, v200
    v_add_f32 v200, v200, v226
    v_cvt_pk_bf16_f32 v200, v200, v200
F_vf:
    s_mov_b64 exec, s[18:19]
    s_waitcnt vmcnt(0) lgkmcnt(0)
    v_readfirstlane_b32 s60, v224
    v_cmp_ne_u32 vcc, s63, v222
    s_and_b32 s62, s60, 0xfff
    s_cmp_lg_u32 s62, s61
    s_cbranch_scc1 F_vw
    s_cbranch_vccnz F_vl
    buffer_store_short v200, v18, s[40:43], s66 offen
    s_or_b32 s65, s49, s44
    s_cbranch_scc1 L_fin
    s_mov_b64 exec, 1
    v_mov_b32 v9, 0
    v_mov_b32 v10, s54
    buffer_store_dword v10, v9, s[24:27], 0 offen
    s_branch L_fin
F_vw:
    s_cmp_lg_u32 s62, 0
    s_cbranch_scc1 F_vx
    s_cbranch_vccz F_vn
F_vl:
    buffer_load_dword v222, v223, s[24:27], s64 offen offset:8 sc1
F_vn:
    ds_read_b32 v224, v8 offset:40
    s_sub_u32 s3, s3, 1
    s_cbranch_scc0 F_vf
    s_mov_b32 s3, 0
    s_branch L_fin
F_vx:
    s_cmp_eq_u32 s17, 0
    s_cbranch_scc1 F_again
    s_branch L_fin
F_chk:
    s_waitcnt lgkmcnt(0)
    v_readfirstlane_b32 s60, v224
    s_and_b32 s62, s60, 0xfff
    s_cselect_b32 s62, s62, s61
    s_cmp_lg_u32 s62, s61
    s_cbranch_scc1 F_vx
    s_sub_u32 s3, s3, 1
    s_cbranch_scc0 F_yp
    s_mov_b32 s3, 0
    s_branch L_fin
F_rest:
    s_cmp_lg_u32 s17, 0
    s_cbranch_scc1 L_fin
    s_cmp_lg_u32 s48, 7
    s_cbranch_scc1 F_tw
HF5_0:
    s_cbranch_execz HF5_1
    s_mov_b64 exec, 0xffffff
    s_waitcnt vmcnt(1)
    s_branch F_tc
F_tp:
    buffer_load_dwordx2 v[220:221], v7, s[24:27], s70 offen sc1
    s_waitcnt vmcnt(0)
F_tc:
    v_cmp_ne_u32 vcc, s54, v221
    s_cbranch_vccz F_tg
    s_sub_u32 s3, s3, 1
    s_cbranch_scc0 F_tp
    s_mov_b32 s3, 0
F_tg:
    s_mov_b64 exec, -1
    v_max_u32_dpp v222, v220, v220 row_ror:1 row_mask:0xf bank_mask:0xf
    s_nop 1
    v_max_u32_dpp v222, v222, v222 row_ror:2 row_mask:0xf bank_mask:0xf
    s_nop 1
    v_max_u32_dpp v222, v222, v222 row_ror:4 row_mask:0xf bank_mask:0xf
    s_nop 1
    v_max_u32_dpp v222, v222, v222 row_ror:8 row_mask:0xf bank_mask:0xf
    s_nop 0
    v_readlane_b32 s60, v222, 0
    v_readlane_b32 s62, v222, 16
    s_max_u32 s60, s60, s62
    s_and_b32 s62, s60, 0xfff
    s_cselect_b32 s60, s60, 1
    v_mov_b32 v220, s60
    ds_write_b32 v8, v220 offset:40
F_tw:
    ds_read_b32 v224, v8 offset:40
    s_waitcnt lgkmcnt(0)
    v_readfirstlane_b32 s60, v224
    s_and_b32 s62, s60, 0xfff
    s_cbranch_scc1 F_tk
    s_sleep 2
    s_sub_u32 s3, s3, 1
    s_cbranch_scc0 F_tw
    s_mov_b32 s3, 0
    s_branch L_fin
F_tk:
    s_cmp_eq_u32 s62, s61
    s_cbranch_scc1 L_fin
F_again:
    s_mov_b64 exec, -1
    s_waitcnt vmcnt(0)
    s_mov_b32 s17, 1
    s_mov_b32 s16, 131072
    s_mov_b32 s20, 0x40000
    v_mov_b64 v[224:225], 0
    s_cmp_eq_u32 s48, 0
    s_cselect_b32 s60, s60, 0
    s_cbranch_scc0 F_redo
    ds_write_b64 v8, v[224:225] offset:32
HF5_1:
    s_cbranch_execz HF_ret
    s_branch F_redo
L_last:
.section .rodata,"a"
.p2align 6
.amdhsa_kernel sequential_preLN__sliding_local_dilated__moe_arch_mod__prompt_kernel
  .amdhsa_next_free_vgpr 256
  .amdhsa_next_free_sgpr 102
  .amdhsa_accum_offset 256
  .amdhsa_group_segment_fixed_size 0
  .amdhsa_kernarg_size 88
  .amdhsa_user_sgpr_count 2
  .amdhsa_user_sgpr_kernarg_segment_ptr 1
  .amdhsa_system_sgpr_workgroup_id_x 1
  .amdhsa_float_denorm_mode_32 3
  .amdhsa_float_denorm_mode_16_64 3
.end_amdhsa_kernel
```

```asm
; @launch grid=(256,1,1) block=(512,1,1) lds=163840
.amdgcn_target "amdgcn-amd-amdhsa--gfx950"
.text
.globl sequential_preLN__sliding_local_dilated__moe_arch_mod__prompt_kernel
.p2align 8
.type sequential_preLN__sliding_local_dilated__moe_arch_mod__prompt_kernel,@function
sequential_preLN__sliding_local_dilated__moe_arch_mod__prompt_kernel:
    s_load_dwordx2 s[28:29], s[0:1], 0
    s_load_dwordx2 s[32:33], s[0:1], 8
    v_readfirstlane_b32 s48, v0
    s_load_dwordx2 s[24:25], s[0:1], 80
    s_load_dwordx2 s[36:37], s[0:1], 16
    s_load_dwordx2 s[40:41], s[0:1], 64
    s_load_dwordx8 s[12:19], s[0:1], 32
    s_lshr_b32 s56, s2, 3
    s_lshr_b32 s48, s48, 6
    s_cmp_ge_u32 s2, 240
    s_cbranch_scc1 F_pre
    s_mul_i32 s51, s56, 86
    s_lshr_b32 s51, s51, 8
    s_and_b32 s66, s2, 7
    s_sub_u32 s53, s66, s51
    s_mul_i32 s53, s53, 3
    s_add_u32 s53, s53, s56
    s_lshr_b32 s55, s53, 1
    s_and_b32 s50, s53, 1
    s_mul_i32 s55, s55, 86
    s_sub_u32 s55, s55, 10
    s_mov_b32 s30, 2621440
    s_mov_b32 s31, 0x00020000
    s_sub_u32 s60, s48, 4
    s_cbranch_scc1 C_pre
    s_lshl_b32 s62, s60, 2
    s_and_b32 s62, s62, 4
    v_bfe_u32 v1, v0, 3, 3
    v_bfe_u32 v2, v0, 4, 2
    v_bitop3_b32 v3, v0, 7, s62 bitop3:0x6a
    s_mul_i32 s62, s60, 24
    s_add_u32 s62, s62, s55
    s_lshl1_add_u32 s62, s62, s50
    s_mul_i32 s62, s62, 1280
    v_xor_b32 v4, v3, v2
    v_mul_u32_u24 v5, 2560, v1
    v_lshl_add_u32 v4, v4, 4, s62
    s_movk_i32 s63, 20480
    v_add_u32 v10, v4, v5
    v_bitop3_b32 v6, v1, 2, v3 bitop3:0x6a
    v_xad_u32 v11, v10, 64, s63
    v_add_u32 v12, 40960, v10
    s_mul_i32 s62, s60, 30720
    s_lshl_b32 s63, s51, 7
    s_add_u32 s62, s62, s63
    v_mul_u32_u24 v5, 3840, v1
    v_lshl_add_u32 v6, v6, 4, s62
    s_mov_b32 s71, s51
    v_add_u32 v13, v5, v6
    s_mul_i32 s65, s60, 3072
    v_add_u32 v14, 256, v13
    v_add_u32 v15, 512, v13
    s_mov_b32 s34, 2457600
    s_mov_b32 s35, 0x00020000
    s_mov_b32 s64, s65
    s_add_u32 s70, s65, 110592
    s_waitcnt lgkmcnt(0)
    s_call_b64 s[98:99], LD_issue
    s_branch LD_cont
LD_issue:
    s_cmp_ge_u32 s66, s71
    s_addc_u32 s68, s66, 0
    s_mov_b32 m0, s65
    s_lshl_b32 s67, s68, 7
    buffer_load_dwordx4 v10, s[28:31], s67 offen lds
    s_add_u32 m0, s65, 1024
    s_mul_i32 s68, s68, 245760
    buffer_load_dwordx4 v11, s[28:31], s67 offen lds
    s_add_u32 m0, s65, 2048
    s_add_u32 s69, s68, 122880
    buffer_load_dwordx4 v12, s[28:31], s67 offen lds
    s_add_u32 m0, s65, 12288
    s_add_u32 s66, s66, 1
    buffer_load_dwordx4 v13, s[32:35], s68 offen offset:0 lds
    buffer_load_dwordx4 v14, s[32:35], s68 offen offset:1024 lds
    buffer_load_dwordx4 v15, s[32:35], s68 offen offset:2048 lds
    s_add_u32 m0, s65, 24576
    s_cmp_eq_u32 s66, 9
    s_cselect_b32 s66, 0, s66
    buffer_load_dwordx4 v13, s[32:35], s69 offen offset:0 lds
    buffer_load_dwordx4 v14, s[32:35], s69 offen offset:1024 lds
    buffer_load_dwordx4 v15, s[32:35], s69 offen offset:2048 lds
    s_add_u32 s65, s65, 36864
    s_cmp_eq_u32 s65, s70
    s_cselect_b32 s65, s64, s65
    s_setpc_b64 s[98:99]
F_pre:
    s_cmp_ge_u32 s2, 256
    s_cbranch_scc1 L_end
    s_getpc_b64 s[58:59]
P_main:
    v_lshlrev_b32 v2, 7, v0
    v_cmp_gt_u32 vcc, L_last-P_main, v2
    s_nop 1
    v_cndmask_b32 v2, 0, v2, vcc
    global_load_dword v219, v2, s[58:59]
    s_branch F_start
C_pre:
    v_and_b32 v0, 63, v0
    s_mov_b32 s3, 0x40000
    s_mov_b32 s47, 0xffff0000
    s_mov_b32 s26, 7340032
    s_mov_b32 s27, 0x00020000
    s_mov_b32 s38, 819200
    s_mov_b32 s39, 0x00020000
    s_mov_b32 s42, 2621440
    s_mov_b32 s43, 0x00020000
    s_sub_u32 s52, s51, 5
    s_cselect_b32 s52, s51, s52
    v_and_b32 v1, 15, v0
    v_lshrrev_b32 v2, 4, v0
    s_mov_b32 s64, 0x21698350
    s_movk_i32 s65, 0x74
    s_lshl_b32 s62, s51, 2
    s_lshr_b64 s[64:65], s[64:65], s62
    s_and_b32 s64, s64, 15
    s_mul_i32 s60, s64, 12
    s_lshl_b32 s61, s48, 2
    s_add_u32 s60, s60, s61
    v_add_u32 v10, s60, v2
    v_add_u32 v11, s55, v10
    v_cmp_gt_i32 vcc, 0, v11
    v_lshl_add_u32 v11, v11, 1, s50
    v_mul_u32_u24 v11, 1280, v11
    v_lshl_add_u32 v11, v1, 4, v11
    v_cndmask_b32 v11, v11, 2.0, vcc
    s_mov_b32 s34, 1280
    s_mov_b32 s35, 0x00020000
    s_lshl_b32 s62, s53, 1
    s_add_u32 s62, s62, s64
    s_mul_i32 s62, s62, 4
    s_add_u32 s62, s62, s61
    s_sub_u32 s62, s62, 32
    s_cmp_lt_u32 s48, 1
    s_cselect_b32 s62, s62, 640
    s_mul_i32 s63, s64, 24
    s_add_u32 s63, s63, s53
    s_add_u32 s63, s63, 192
    s_cmp_lt_u32 s64, 8
    s_cselect_b32 s65, 3, 0
    s_cselect_b32 s62, s63, s62
    s_cselect_b32 s63, 192, 1
    v_lshlrev_b32 v58, 4, v0
    v_lshlrev_b32 v59, 2, v0
    s_waitcnt lgkmcnt(0)
    s_buffer_load_dword s54, s[24:27], 0
    s_mov_b64 s[32:33], s[12:13]
    s_cmp_lt_u32 s48, s65
    s_cbranch_scc0 A_nors
    buffer_load_dwordx4 v[20:23], v11, s[28:31], 0 offen offset:0
    buffer_load_dwordx4 v[24:27], v11, s[28:31], 0 offen offset:256
    buffer_load_dwordx4 v[28:31], v11, s[28:31], 0 offen offset:512
    buffer_load_dwordx4 v[32:35], v11, s[28:31], 0 offen offset:768
    buffer_load_dwordx4 v[36:39], v11, s[28:31], 0 offen offset:1024
    s_branch A_cons
A_nors:
    s_cmp_lg_u32 s48, 3
    s_cbranch_scc1 A_nowr
    buffer_load_dwordx4 v[48:51], v58, s[32:35], 0 offen
    buffer_load_dword v52, v59, s[32:35], 0 offen offset:1024
A_nowr:
    s_cmp_ge_u32 s62, 640
    s_cbranch_scc1 A_cons
    v_mul_u32_u24 v10, s63, v2
    v_add_u32 v10, s62, v10
    v_lshlrev_b32 v12, 4, v1
    v_mul_u32_u24 v11, 1280, v10
    v_add_u32 v11, v11, v12
    buffer_load_dwordx4 v[76:79], v12, s[32:35], 0 offen offset:0
    buffer_load_dwordx4 v[80:83], v12, s[32:35], 0 offen offset:256
    buffer_load_dwordx4 v[84:87], v12, s[32:35], 0 offen offset:512
    buffer_load_dwordx4 v[88:91], v12, s[32:35], 0 offen offset:768
    buffer_load_dwordx4 v[92:95], v12, s[32:35], 0 offen offset:1024
    buffer_load_dwordx4 v[20:23], v11, s[36:39], 0 offen offset:0
    buffer_load_dwordx4 v[24:27], v11, s[36:39], 0 offen offset:256
    buffer_load_dwordx4 v[28:31], v11, s[36:39], 0 offen offset:512
    buffer_load_dwordx4 v[32:35], v11, s[36:39], 0 offen offset:768
    buffer_load_dwordx4 v[36:39], v11, s[36:39], 0 offen offset:1024
A_cons:
    v_mov_b32 v99, 2.0
    v_lshrrev_b32 v3, 1, v1
    v_xor_b32 v3, v3, v2
    v_lshlrev_b32 v3, 4, v3
    v_lshl_add_u32 v4, v1, 7, v3
    v_xor_b32 v5, 64, v4
    v_cmp_eq_u32 vcc, 0, v1
    v_mov_b32 v3, 159744
    s_nop 0
    v_cndmask_b32 v6, v4, v3, vcc
    v_cndmask_b32 v7, v5, v3, vcc
    v_cndmask_b32 v8, 1, 0, vcc
    v_bfe_u32 v14, v0, 2, 2
    v_and_b32 v15, 3, v0
    v_lshrrev_b32 v16, 1, v14
    v_and_b32 v17, 1, v2
    v_lshl_or_b32 v16, v17, 1, v16
    v_xor_b32 v16, s48, v16
    v_lshlrev_b32 v16, 5, v16
    v_lshl_add_u32 v16, v15, 3, v16
    v_lshl_add_u32 v16, v14, 7, v16
    v_mul_u32_u24 v17, 3072, v2
    v_add_u32 v9, v16, v17
    v_mov_b32 v16, 0x3f803f80
    v_mov_b32 v17, v16
    v_mov_b32 v18, v16
    v_mov_b32 v19, v16
    ds_write_b128 v3, v[16:19]
    v_mov_b64 v[100:101], 0
    v_mov_b64 v[102:103], 0
    v_mov_b64 v[104:105], 0
    v_mov_b64 v[106:107], 0
    v_mov_b64 v[108:109], 0
    v_mov_b64 v[110:111], 0
    v_mov_b64 v[112:113], 0
    v_mov_b64 v[114:115], 0
    v_mov_b64 v[116:117], 0
    v_mov_b64 v[118:119], 0
    v_mov_b64 v[120:121], 0
    v_mov_b64 v[122:123], 0
    v_mov_b64 v[124:125], 0
    v_mov_b64 v[126:127], 0
    v_mov_b64 v[128:129], 0
    v_mov_b64 v[130:131], 0
    v_mov_b64 v[132:133], 0
    v_mov_b64 v[134:135], 0
    v_mov_b64 v[136:137], 0
    v_mov_b64 v[138:139], 0
    v_mov_b64 v[140:141], 0
    v_mov_b64 v[142:143], 0
    v_mov_b64 v[144:145], 0
    v_mov_b64 v[146:147], 0
    v_mov_b64 v[148:149], 0
    v_mov_b64 v[150:151], 0
    v_mov_b64 v[152:153], 0
    v_mov_b64 v[154:155], 0
    v_mov_b64 v[156:157], 0
    v_mov_b64 v[158:159], 0
    v_mov_b64 v[160:161], 0
    v_mov_b64 v[162:163], 0
    v_mov_b64 v[164:165], 0
    v_mov_b64 v[166:167], 0
    v_mov_b64 v[168:169], 0
    v_mov_b64 v[170:171], 0
    s_call_b64 s[98:99], S_late
    s_call_b64 s[98:99], S_late2
    s_call_b64 s[98:99], S_late3
    s_call_b64 s[98:99], S_late4
    s_branch A_c2
S_late:
    v_and_b32 v200, 15, v0
    v_lshrrev_b32 v201, 4, v0
    v_lshlrev_b32 v202, 4, v0
    v_lshlrev_b32 v203, 2, v0
    v_lshrrev_b32 v64, 5, v0
    v_and_b32 v65, 12, v200
    s_lshl_b32 s4, s52, 3
    s_sub_u32 s4, 96768, s4
    s_min_u32 s5, s48, 5
    s_lshl_b32 s6, s5, 4
    v_add_u32 v67, s6, v200
    v_mul_u32_u24 v68, 400, v67
    v_mad_u32_u24 v66, v201, 40, s4
    v_add_u32 v71, v68, v66
    v_subrev_u32 v205, 3072, v71
    v_mul_u32_u24 v72, 5, v201
    v_subrev_u32 v72, s52, v72
    v_mov_b32 v73, 159776
    v_add_u32 v74, 0, v72
    v_cmp_gt_u32 vcc, 16, v74
    v_add_u32 v74, 0, v71
    s_nop 0
    v_cndmask_b32 v204, v73, v74, vcc
    v_add_u32 v74, 1, v72
    v_cmp_gt_u32 vcc, 16, v74
    v_add_u32 v74, 8, v71
    s_nop 0
    v_cndmask_b32 v229, v73, v74, vcc
    v_add_u32 v74, 2, v72
    v_cmp_gt_u32 vcc, 16, v74
    v_add_u32 v74, 16, v71
    s_nop 0
    v_cndmask_b32 v230, v73, v74, vcc
    v_add_u32 v74, 3, v72
    v_cmp_gt_u32 vcc, 16, v74
    v_add_u32 v74, 24, v71
    s_nop 0
    v_cndmask_b32 v231, v73, v74, vcc
    v_add_u32 v74, 4, v72
    v_cmp_gt_u32 vcc, 16, v74
    v_add_u32 v74, 32, v71
    s_nop 0
    v_cndmask_b32 v255, v73, v74, vcc
    v_lshlrev_b32 v208, 3, v67
    v_add_u32 v208, 159808, v208
    v_add_u32 v69, s6, v65
    v_lshlrev_b32 v209, 3, v69
    v_add_u32 v209, 159748, v209
    v_and_b32 v70, 3, v0
    v_cmp_gt_u32 vcc, 1, v70
    v_mov_b32 v73, s47
    s_nop 0
    v_cndmask_b32 v207, 0, v73, vcc
    v_cmp_gt_u32 vcc, 3, v70
    s_nop 1
    v_cndmask_b32 v211, 0, v73, vcc
    v_cmp_gt_u32 vcc, 2, v70
    s_nop 1
    v_cndmask_b32 v211, v211, -1, vcc
    s_setpc_b64 s[98:99]
S_late2:
    s_lshl_b32 s7, s5, 12
    s_add_u32 s7, s7, 135184
    v_lshl_add_u32 v66, v0, 6, s7
    v_lshl_add_u32 v210, v65, 1, v66
    s_add_u32 s13, s6, s55
    v_add_u32 v212, s13, v65
    s_mul_i32 s8, s53, 6
    s_mul_i32 s9, s8, 24320
    s_add_u32 s9, s9, 1310720
    s_mul_i32 s0, s48, 24320
    s_add_u32 s0, s0, s9
    v_lshlrev_b32 v206, 4, v200
    v_lshl_add_u32 v206, v64, 8, v206
    v_xor_b32 v213, 256, v206
    v_lshl_add_u32 v213, v64, 12, v213
    s_cmp_lg_u32 s52, 0
    s_cselect_b32 s20, 0x0000ffff, 0
    s_cmp_lg_u32 s52, 4
    s_cselect_b32 s21, s47, 0
    s_cmp_eq_u32 s48, 0
    s_cselect_b32 s7, 0xff00ff00, -1
    s_and_b32 s20, s20, s7
    s_and_b32 s21, s21, s7
    s_lshl_b32 s7, s51, 11
    s_add_u32 s22, s0, s7
    s_sub_u32 s12, s22, 2048
    s_add_u32 s100, s9, 23040
    s_lshr_b32 s7, s51, 1
    s_mul_i32 s7, s7, 23552
    s_mul_i32 s57, s51, 384
    s_add_u32 s7, s7, s57
    s_add_u32 s7, s7, 23552
    s_add_u32 s57, s7, s9
    s_mul_i32 s7, s48, 10
    s_add_u32 s7, s7, s51
    s_lshl_b32 s7, s7, 2
    s_add_u32 s23, s100, s7
    s_sub_u32 s56, s48, 2
    s_cmp_lt_u32 s48, 6
    s_cselect_b32 s101, 0, 1
    s_cselect_b32 s56, s48, s56
    s_mul_i32 s1, s56, 24320
    s_add_u32 s1, s1, s9
    s_add_u32 s8, s8, s56
    s_mul_i32 s44, s53, 2560
    s_lshl_b32 s7, s51, 8
    s_add_u32 s44, s44, s7
    s_add_u32 s44, s44, 262144
    s_lshl_b32 s45, s53, 6
    s_add_u32 s45, s45, 196608
    s_setpc_b64 s[98:99]
S_late3:
    v_bfe_u32 v68, v0, 2, 2
    v_and_b32 v69, 3, v0
    v_lshl_add_u32 v70, v201, 3, v68
    s_lshl_b32 s7, s48, 4
    s_sub_u32 s7, s7, 16
    v_add_u32 v71, s7, v70
    v_and_b32 v72, 15, v71
    v_max_i32 v71, v71, v72
    v_mul_u32_u24 v71, 400, v71
    v_lshl_add_u32 v71, v69, 3, v71
    v_add_u32 v214, 97024, v71
    v_and_b32 v72, 1, v201
    s_cmp_eq_u32 s48, 0
    s_cselect_b32 s7, 8, 0
    v_cmp_gt_u32 vcc, s7, v200
    s_nop 1
    v_cndmask_b32 v249, v202, 2.0, vcc
    v_lshrrev_b32 v71, 1, v68
    v_lshl_or_b32 v71, v72, 1, v71
    v_lshl_add_u32 v70, v201, 2, v68
    v_lshlrev_b32 v70, 7, v70
    v_lshl_add_u32 v70, v69, 3, v70
    s_mul_i32 s7, s101, 40960
    s_add_u32 s7, s7, 12288
    v_add_u32 v70, s7, v70
    s_mul_i32 s7, s101, 36864
    s_sub_u32 s7, 40960, s7
    v_xor_b32 v73, 0, v71
    v_lshl_add_u32 v216, v73, 5, v70
    v_add_u32 v220, s7, v216
    v_xor_b32 v73, 1, v71
    v_lshl_add_u32 v217, v73, 5, v70
    v_add_u32 v221, s7, v217
    v_xor_b32 v73, 2, v71
    v_lshl_add_u32 v218, v73, 5, v70
    v_add_u32 v222, s7, v218
    v_xor_b32 v73, 3, v71
    v_lshl_add_u32 v219, v73, 5, v70
    v_add_u32 v223, s7, v219
    s_setpc_b64 s[98:99]
S_late4:
    s_lshl_b32 s7, s56, 4
    v_add_u32 v73, s7, v200
    v_cmp_gt_u32 vcc, 10, v73
    v_add_u32 v73, s55, v73
    v_lshl_add_u32 v73, v73, 1, s50
    v_mul_u32_u24 v74, 1280, v73
    s_lshl_b32 s7, s51, 7
    v_lshl_add_u32 v75, v201, 3, s7
    v_add_u32 v74, v74, v75
    v_cndmask_b32 v253, v74, 2.0, vcc
    v_cndmask_b32 v254, v73, -1, vcc
    v_add_u32 v227, 161792, v75
    v_mul_u32_u24 v224, 61440, v201
    v_lshl_add_u32 v224, v200, 4, v224
    s_mov_b32 s7, 161024
    v_lshl_add_u32 v228, v201, 5, s7
    v_lshl_add_u32 v252, v69, 5, s7
    v_lshl_add_u32 v252, v68, 3, v252
    v_mul_u32_u24 v225, 24, v72
    v_add_u32 v225, v225, v253
    v_lshl_add_u32 v226, s8, 4, v200
    s_cmp_eq_u32 s101, 1
    s_cselect_b64 vcc, -1, 0
    v_lshrrev_b32 v73, 1, v200
    v_lshrrev_b32 v74, 1, v201
    v_xor_b32 v73, v73, v74
    v_lshlrev_b32 v73, 4, v73
    v_lshl_add_u32 v73, v72, 3, v73
    v_lshl_add_u32 v73, v200, 7, v73
    v_lshl_add_u32 v250, s56, 11, v73
    v_mov_b32 v251, 160784
    s_add_u32 s7, s52, 5
    s_cmp_lt_u32 s51, 5
    s_cselect_b32 s7, s7, s52
    s_lshl_b32 s7, s7, 11
    s_add_u32 s16, s7, s1
    s_lshl_b32 s7, s51, 11
    s_add_u32 s14, s7, s1
    s_add_u32 s15, s1, 20480
    s_cmp_eq_u32 s101, 1
    s_cselect_b32 s14, s16, s14
    s_cselect_b32 s18, 0x3e0, 62
    s_lshl_b32 s7, s101, 10
    s_add_u32 s16, s16, s7
    s_cmp_lt_u32 s48, 4
    s_cselect_b32 s18, 0x3fe, s18
    s_lshl_b32 s18, s18, s51
    s_lshr_b32 s7, s18, 10
    s_or_b32 s18, s18, s7
    s_and_b32 s18, s18, 0x3ff
    s_mov_b32 s19, 0
    s_mul_i32 s17, s56, 40
    s_add_u32 s17, s17, s100
    s_lshl_b32 s7, s48, 12
    s_add_u32 s7, s7, 135168
    v_lshl_add_u32 v73, v200, 6, s7
    v_lshl_add_u32 v73, v201, 4, v73
    v_add_u32 v74, s52, v201
    s_add_u32 s69, s52, 0
    s_mul_i32 s69, s69, 52
    s_lshr_b32 s69, s69, 8
    v_lshl_add_u32 v172, s69, 10, v73
    s_add_u32 s69, s52, 3
    s_mul_i32 s69, s69, 52
    s_lshr_b32 s69, s69, 8
    v_lshl_add_u32 v173, s69, 10, v73
    s_mul_i32 s69, s69, 5
    s_sub_u32 s69, s69, 0
    v_cmp_le_i32 s[4:5], s69, v74
    s_add_u32 s69, s52, 4
    s_mul_i32 s69, s69, 52
    s_lshr_b32 s69, s69, 8
    v_lshl_add_u32 v174, s69, 10, v73
    s_add_u32 s69, s52, 7
    s_mul_i32 s69, s69, 52
    s_lshr_b32 s69, s69, 8
    v_lshl_add_u32 v175, s69, 10, v73
    s_mul_i32 s69, s69, 5
    s_sub_u32 s69, s69, 4
    v_cmp_le_i32 s[6:7], s69, v74
    s_add_u32 s69, s52, 8
    s_mul_i32 s69, s69, 52
    s_lshr_b32 s69, s69, 8
    v_lshl_add_u32 v176, s69, 10, v73
    s_add_u32 s69, s52, 11
    s_mul_i32 s69, s69, 52
    s_lshr_b32 s69, s69, 8
    v_lshl_add_u32 v177, s69, 10, v73
    s_mul_i32 s69, s69, 5
    s_sub_u32 s69, s69, 8
    v_cmp_le_i32 s[8:9], s69, v74
    s_add_u32 s69, s52, 12
    s_mul_i32 s69, s69, 52
    s_lshr_b32 s69, s69, 8
    v_lshl_add_u32 v178, s69, 10, v73
    s_add_u32 s69, s52, 15
    s_mul_i32 s69, s69, 52
    s_lshr_b32 s69, s69, 8
    v_lshl_add_u32 v179, s69, 10, v73
    s_mul_i32 s69, s69, 5
    s_sub_u32 s69, s69, 12
    v_cmp_le_i32 s[10:11], s69, v74
    s_setpc_b64 s[98:99]
A_c2:
    s_waitcnt lgkmcnt(0)
    s_add_u32 s54, s54, 2654435761
    s_lshl_b32 s63, s53, 11
    s_add_u32 s63, s63, 81920
    v_mov_b32 v42, s54
    v_lshlrev_b32 v10, 4, v10
    s_cmp_lt_u32 s48, s65
    s_cbranch_scc0 A_nos
    s_waitcnt vmcnt(4)
    v_dot2_f32_bf16 v40, v20, v16, 0
    v_dot2_f32_bf16 v41, v20, v20, 0
    v_dot2_f32_bf16 v44, v21, v16, 0
    v_dot2_f32_bf16 v45, v21, v21, 0
    v_dot2_f32_bf16 v40, v22, v16, v40
    v_dot2_f32_bf16 v41, v22, v22, v41
    v_dot2_f32_bf16 v44, v23, v16, v44
    v_dot2_f32_bf16 v45, v23, v23, v45
    s_waitcnt vmcnt(3)
    v_dot2_f32_bf16 v40, v24, v16, v40
    v_dot2_f32_bf16 v41, v24, v24, v41
    v_dot2_f32_bf16 v44, v25, v16, v44
    v_dot2_f32_bf16 v45, v25, v25, v45
    v_dot2_f32_bf16 v40, v26, v16, v40
    v_dot2_f32_bf16 v41, v26, v26, v41
    v_dot2_f32_bf16 v44, v27, v16, v44
    v_dot2_f32_bf16 v45, v27, v27, v45
    s_waitcnt vmcnt(2)
    v_dot2_f32_bf16 v40, v28, v16, v40
    v_dot2_f32_bf16 v41, v28, v28, v41
    v_dot2_f32_bf16 v44, v29, v16, v44
    v_dot2_f32_bf16 v45, v29, v29, v45
    v_dot2_f32_bf16 v40, v30, v16, v40
    v_dot2_f32_bf16 v41, v30, v30, v41
    v_dot2_f32_bf16 v44, v31, v16, v44
    v_dot2_f32_bf16 v45, v31, v31, v45
    s_waitcnt vmcnt(1)
    v_dot2_f32_bf16 v40, v32, v16, v40
    v_dot2_f32_bf16 v41, v32, v32, v41
    v_dot2_f32_bf16 v44, v33, v16, v44
    v_dot2_f32_bf16 v45, v33, v33, v45
    v_dot2_f32_bf16 v40, v34, v16, v40
    v_dot2_f32_bf16 v41, v34, v34, v41
    v_dot2_f32_bf16 v44, v35, v16, v44
    v_dot2_f32_bf16 v45, v35, v35, v45
    s_waitcnt vmcnt(0)
    v_dot2_f32_bf16 v40, v36, v16, v40
    v_dot2_f32_bf16 v41, v36, v36, v41
    v_dot2_f32_bf16 v44, v37, v16, v44
    v_dot2_f32_bf16 v45, v37, v37, v45
    v_dot2_f32_bf16 v40, v38, v16, v40
    v_dot2_f32_bf16 v41, v38, v38, v41
    v_dot2_f32_bf16 v44, v39, v16, v44
    v_dot2_f32_bf16 v45, v39, v39, v45
A_red:
    s_nop 1
    v_add_f32 v40, v40, v44
    v_add_f32 v41, v41, v45
    s_nop 0
    v_add_f32_dpp v40, v40, v40 row_ror:1 row_mask:0xf bank_mask:0xf
    v_add_f32_dpp v41, v41, v41 row_ror:1 row_mask:0xf bank_mask:0xf
    s_nop 0
    v_add_f32_dpp v40, v40, v40 row_ror:2 row_mask:0xf bank_mask:0xf
    v_add_f32_dpp v41, v41, v41 row_ror:2 row_mask:0xf bank_mask:0xf
    s_nop 0
    v_add_f32_dpp v40, v40, v40 row_ror:4 row_mask:0xf bank_mask:0xf
    v_add_f32_dpp v41, v41, v41 row_ror:4 row_mask:0xf bank_mask:0xf
    s_nop 0
    v_add_f32_dpp v40, v40, v40 row_ror:8 row_mask:0xf bank_mask:0xf
    v_add_f32_dpp v41, v41, v41 row_ror:8 row_mask:0xf bank_mask:0xf
    s_cselect_b32 s64, s63, 1245184
    s_cbranch_scc0 A_nln
    v_mul_f32 v40, 0x3acccccd, v40
    v_mul_f32 v41, 0x3acccccd, v41
    v_fma_f32 v41, -v40, v40, v41
    v_max_f32 v41, 0, v41
    v_cvt_pk_bf16_f32 v41, v41, v41
    v_and_b32 v41, 0xffff0000, v41
    v_add_f32 v41, 0x3727c5ac, v41
    v_cvt_pk_bf16_f32 v41, v41, v41
    v_and_b32 v41, 0xffff0000, v41
    v_sqrt_f32 v41, v41
    v_cvt_pk_bf16_f32 v40, v40, v40
    v_and_b32 v40, 0xffff0000, v40
    v_cvt_pk_bf16_f32 v41, v41, v41
    v_and_b32 v41, 0xffff0000, v41
    v_rcp_f32 v41, v41
A_nln:
    s_mov_b32 exec_lo, 0x00010001
    s_mov_b32 exec_hi, 0x00010001
    buffer_store_dwordx3 v[40:42], v10, s[24:27], s64 offen sc1
    s_mov_b64 exec, -1
A_w3:
    s_cmp_lg_u32 s48, 3
    s_cbranch_scc1 A_go
    s_getreg_b32 s61, hwreg(HW_REG_XCC_ID)
    s_lshl_b32 s64, s51, 4
    s_add_u32 s64, s64, 1536
    v_mov_b32 v44, s61
    v_mov_b32 v43, s64
    v_mov_b32 v46, s54
    s_mov_b64 exec, 1
    buffer_store_dwordx3 v[44:46], v43, s[24:27], s63 offen sc1
    s_mov_b64 exec, -1
    v_add_u32 v58, 161792, v58
    v_add_u32 v59, 161792, v59
    s_cmp_lt_u32 s62, 640
    s_cbranch_scc1 A_w3l
    s_waitcnt vmcnt(1)
A_w3l:
    ds_write_b128 v58, v[48:51]
    ds_write_b32 v59, v52 offset:1024
    v_dot2_f32_bf16 v25, v48, v16, 0
    v_dot2_f32_bf16 v25, v49, v16, v25
    v_dot2_f32_bf16 v25, v50, v16, v25
    v_dot2_f32_bf16 v25, v51, v16, v25
    v_dot2_f32_bf16 v25, v52, v16, v25
    s_nop 2
    v_add_f32_dpp v25, v25, v25 row_ror:1 row_mask:0xf bank_mask:0xf
    s_nop 1
    v_add_f32_dpp v25, v25, v25 row_ror:2 row_mask:0xf bank_mask:0xf
    s_nop 1
    v_add_f32_dpp v25, v25, v25 row_ror:4 row_mask:0xf bank_mask:0xf
    s_nop 1
    v_add_f32_dpp v25, v25, v25 row_ror:8 row_mask:0xf bank_mask:0xf
    v_mov_b32 v26, v25
    s_nop 1
    v_permlane32_swap_b32 v25, v26
    v_add_f32 v25, v25, v26
    v_mov_b32 v26, v25
    s_nop 1
    v_permlane16_swap_b32 v25, v26
    v_add_f32 v25, v25, v26
    v_mov_b32 v58, 161792
    ds_write_b32 v58, v25 offset:1280
    s_waitcnt lgkmcnt(0)
    s_branch A_go
A_nos:
    s_cmp_ge_u32 s62, 640
    s_cbranch_scc1 A_w3
    s_waitcnt vmcnt(4)
    v_dot2_f32_bf16 v40, v20, v16, 0
    v_dot2_f32_bf16 v41, v20, v76, 0
    v_dot2_f32_bf16 v44, v21, v16, 0
    v_dot2_f32_bf16 v45, v21, v77, 0
    v_dot2_f32_bf16 v40, v22, v16, v40
    v_dot2_f32_bf16 v41, v22, v78, v41
    v_dot2_f32_bf16 v44, v23, v16, v44
    v_dot2_f32_bf16 v45, v23, v79, v45
    s_waitcnt vmcnt(3)
    v_dot2_f32_bf16 v40, v24, v16, v40
    v_dot2_f32_bf16 v41, v24, v80, v41
    v_dot2_f32_bf16 v44, v25, v16, v44
    v_dot2_f32_bf16 v45, v25, v81, v45
    v_dot2_f32_bf16 v40, v26, v16, v40
    v_dot2_f32_bf16 v41, v26, v82, v41
    v_dot2_f32_bf16 v44, v27, v16, v44
    v_dot2_f32_bf16 v45, v27, v83, v45
    s_waitcnt vmcnt(2)
    v_dot2_f32_bf16 v40, v28, v16, v40
    v_dot2_f32_bf16 v41, v28, v84, v41
    v_dot2_f32_bf16 v44, v29, v16, v44
    v_dot2_f32_bf16 v45, v29, v85, v45
    v_dot2_f32_bf16 v40, v30, v16, v40
    v_dot2_f32_bf16 v41, v30, v86, v41
    v_dot2_f32_bf16 v44, v31, v16, v44
    v_dot2_f32_bf16 v45, v31, v87, v45
    s_waitcnt vmcnt(1)
    v_dot2_f32_bf16 v40, v32, v16, v40
    v_dot2_f32_bf16 v41, v32, v88, v41
    v_dot2_f32_bf16 v44, v33, v16, v44
    v_dot2_f32_bf16 v45, v33, v89, v45
    v_dot2_f32_bf16 v40, v34, v16, v40
    v_dot2_f32_bf16 v41, v34, v90, v41
    v_dot2_f32_bf16 v44, v35, v16, v44
    v_dot2_f32_bf16 v45, v35, v91, v45
    s_waitcnt vmcnt(0)
    v_dot2_f32_bf16 v40, v36, v16, v40
    v_dot2_f32_bf16 v41, v36, v92, v41
    v_dot2_f32_bf16 v44, v37, v16, v44
    v_dot2_f32_bf16 v45, v37, v93, v45
    v_dot2_f32_bf16 v40, v38, v16, v40
    v_dot2_f32_bf16 v41, v38, v94, v41
    v_dot2_f32_bf16 v44, v39, v16, v44
    v_dot2_f32_bf16 v45, v39, v95, v45
    s_branch A_red
A_go:
    v_lshlrev_b32 v18, 3, v1
    v_add_u32 v18, 159808, v18
    v_mul_u32_u24 v3, 400, v1
    v_lshl_add_u32 v3, v2, 3, v3
    s_lshl_b32 s60, s48, 5
    s_add_u32 s60, s60, 96768
    v_add_u32 v3, s60, v3
    v_mov_b32 v17, 160768
    s_mov_b32 s60, 0
    v_add_u32 v14, s60, v9
    v_mad_u32_u24 v10, v8, s60, v6
    v_add_u32 v12, s60, v4
    v_mad_u32_u24 v11, v8, s60, v7
    v_add_u32 v13, s60, v5
    s_mov_b32 s61, 0
    s_barrier
    ds_read_b64_tr_b16 v[44:45], v14 offset:12288
    ds_read_b64_tr_b16 v[46:47], v14 offset:12800
    ds_read_b64_tr_b16 v[48:49], v14 offset:13312
    ds_read_b64_tr_b16 v[50:51], v14 offset:13824
    ds_read_b64_tr_b16 v[52:53], v14 offset:14336
    ds_read_b64_tr_b16 v[54:55], v14 offset:14848
    ds_read_b128 v[20:23], v10
    ds_read_b128 v[24:27], v12 offset:2048
    ds_read_b128 v[28:31], v12 offset:4096
    ds_read_b128 v[32:35], v12 offset:6144
    ds_read_b128 v[36:39], v12 offset:8192
    ds_read_b128 v[40:43], v12 offset:10240
A_loop:
    s_waitcnt lgkmcnt(0)
    v_mfma_f32_16x16x32_bf16 v[100:103], v[44:47], v[20:23], v[100:103]
    ds_read_b64_tr_b16 v[80:81], v14 offset:24576
    v_mfma_f32_16x16x32_bf16 v[104:107], v[48:51], v[20:23], v[104:107]
    ds_read_b64_tr_b16 v[82:83], v14 offset:25088
    v_mfma_f32_16x16x32_bf16 v[108:111], v[52:55], v[20:23], v[108:111]
    ds_read_b64_tr_b16 v[84:85], v14 offset:25600
    v_mfma_f32_16x16x32_bf16 v[120:123], v[52:55], v[24:27], v[120:123]
    ds_read_b64_tr_b16 v[86:87], v14 offset:26112
    v_mfma_f32_16x16x32_bf16 v[116:119], v[48:51], v[24:27], v[116:119]
    ds_read_b64_tr_b16 v[88:89], v14 offset:26624
    v_mfma_f32_16x16x32_bf16 v[112:115], v[44:47], v[24:27], v[112:115]
    ds_read_b64_tr_b16 v[90:91], v14 offset:27136
    v_mfma_f32_16x16x32_bf16 v[124:127], v[44:47], v[28:31], v[124:127]
    ds_read_b128 v[56:59], v11
    v_mfma_f32_16x16x32_bf16 v[128:131], v[48:51], v[28:31], v[128:131]
    ds_read_b128 v[60:63], v13 offset:2048
    v_mfma_f32_16x16x32_bf16 v[132:135], v[52:55], v[28:31], v[132:135]
    ds_read_b128 v[64:67], v13 offset:4096
    v_mfma_f32_16x16x32_bf16 v[144:147], v[52:55], v[32:35], v[144:147]
    ds_read_b128 v[68:71], v13 offset:6144
    v_mfma_f32_16x16x32_bf16 v[140:143], v[48:51], v[32:35], v[140:143]
    ds_read_b128 v[72:75], v13 offset:8192
    v_mfma_f32_16x16x32_bf16 v[136:139], v[44:47], v[32:35], v[136:139]
    ds_read_b128 v[76:79], v13 offset:10240
    v_mfma_f32_16x16x32_bf16 v[148:151], v[44:47], v[36:39], v[148:151]
    s_add_u32 s60, s60, 36864
    v_mfma_f32_16x16x32_bf16 v[152:155], v[48:51], v[36:39], v[152:155]
    s_add_u32 s61, s61, 1
    v_mfma_f32_16x16x32_bf16 v[156:159], v[52:55], v[36:39], v[156:159]
    s_cmp_eq_u32 s60, 110592
    v_mfma_f32_16x16x32_bf16 v[168:171], v[52:55], v[40:43], v[168:171]
    s_cselect_b32 s60, 0, s60
    v_mfma_f32_16x16x32_bf16 v[164:167], v[48:51], v[40:43], v[164:167]
    s_cmp_lt_u32 s61, 9
    v_mfma_f32_16x16x32_bf16 v[160:163], v[44:47], v[40:43], v[160:163]
    s_waitcnt lgkmcnt(0)
    v_mfma_f32_16x16x32_bf16 v[100:103], v[80:83], v[56:59], v[100:103]
    v_add_u32 v14, s60, v9
    v_mfma_f32_16x16x32_bf16 v[104:107], v[84:87], v[56:59], v[104:107]
    v_mad_u32_u24 v10, v8, s60, v6
    v_mfma_f32_16x16x32_bf16 v[108:111], v[88:91], v[56:59], v[108:111]
    v_add_u32 v12, s60, v4
    v_mfma_f32_16x16x32_bf16 v[120:123], v[88:91], v[60:63], v[120:123]
    v_mad_u32_u24 v11, v8, s60, v7
    v_mfma_f32_16x16x32_bf16 v[116:119], v[84:87], v[60:63], v[116:119]
    v_add_u32 v13, s60, v5
    v_mfma_f32_16x16x32_bf16 v[112:115], v[80:83], v[60:63], v[112:115]
    s_barrier
    v_mfma_f32_16x16x32_bf16 v[124:127], v[80:83], v[64:67], v[124:127]
    ds_read_b64_tr_b16 v[44:45], v14 offset:12288
    ds_read_b64_tr_b16 v[46:47], v14 offset:12800
    v_mfma_f32_16x16x32_bf16 v[128:131], v[84:87], v[64:67], v[128:131]
    ds_read_b64_tr_b16 v[48:49], v14 offset:13312
    ds_read_b64_tr_b16 v[50:51], v14 offset:13824
    v_mfma_f32_16x16x32_bf16 v[132:135], v[88:91], v[64:67], v[132:135]
    ds_read_b64_tr_b16 v[52:53], v14 offset:14336
    ds_read_b64_tr_b16 v[54:55], v14 offset:14848
    v_mfma_f32_16x16x32_bf16 v[144:147], v[88:91], v[68:71], v[144:147]
    ds_read_b128 v[20:23], v10
    ds_read_b128 v[24:27], v12 offset:2048
    v_mfma_f32_16x16x32_bf16 v[140:143], v[84:87], v[68:71], v[140:143]
    ds_read_b128 v[28:31], v12 offset:4096
    ds_read_b128 v[32:35], v12 offset:6144
    v_mfma_f32_16x16x32_bf16 v[136:139], v[80:83], v[68:71], v[136:139]
    ds_read_b128 v[36:39], v12 offset:8192
    ds_read_b128 v[40:43], v12 offset:10240
    v_mfma_f32_16x16x32_bf16 v[148:151], v[80:83], v[72:75], v[148:151]
    v_mfma_f32_16x16x32_bf16 v[152:155], v[84:87], v[72:75], v[152:155]
    v_mfma_f32_16x16x32_bf16 v[156:159], v[88:91], v[72:75], v[156:159]
    v_mfma_f32_16x16x32_bf16 v[168:171], v[88:91], v[76:79], v[168:171]
    v_mfma_f32_16x16x32_bf16 v[164:167], v[84:87], v[76:79], v[164:167]
    v_mfma_f32_16x16x32_bf16 v[160:163], v[80:83], v[76:79], v[160:163]
    s_cbranch_scc1 A_loop
A_tail:
    s_waitcnt lgkmcnt(0)
    v_mfma_f32_16x16x32_bf16 v[108:111], v[52:55], v[20:23], v[108:111]
    ds_read_b64_tr_b16 v[80:81], v14 offset:24576
    ds_read_b64_tr_b16 v[82:83], v14 offset:25088
    v_mfma_f32_16x16x32_bf16 v[120:123], v[52:55], v[24:27], v[120:123]
    ds_read_b64_tr_b16 v[84:85], v14 offset:25600
    ds_read_b64_tr_b16 v[86:87], v14 offset:26112
    v_mfma_f32_16x16x32_bf16 v[132:135], v[52:55], v[28:31], v[132:135]
    ds_read_b128 v[56:59], v11
    ds_read_b128 v[60:63], v13 offset:2048
    v_mfma_f32_16x16x32_bf16 v[144:147], v[52:55], v[32:35], v[144:147]
    ds_read_b64 v[184:185], v18 offset:0
    ds_read_b64 v[186:187], v18 offset:128
    v_mfma_f32_16x16x32_bf16 v[156:159], v[52:55], v[36:39], v[156:159]
    ds_read_b128 v[64:67], v13 offset:4096
    ds_read_b128 v[68:71], v13 offset:6144
    v_mfma_f32_16x16x32_bf16 v[168:171], v[52:55], v[40:43], v[168:171]
    ds_read_b128 v[72:75], v13 offset:8192
    ds_read_b128 v[76:79], v13 offset:10240
    v_mfma_f32_16x16x32_bf16 v[100:103], v[44:47], v[20:23], v[100:103]
    ds_read_b64_tr_b16 v[88:89], v14 offset:26624
    ds_read_b64_tr_b16 v[90:91], v14 offset:27136
    v_mfma_f32_16x16x32_bf16 v[104:107], v[48:51], v[20:23], v[104:107]
    ds_read_b64 v[188:189], v18 offset:256
    ds_read_b64 v[190:191], v18 offset:384
    v_mfma_f32_16x16x32_bf16 v[112:115], v[44:47], v[24:27], v[112:115]
    ds_read_b64 v[192:193], v18 offset:512
    ds_read_b64 v[194:195], v18 offset:640
    v_mfma_f32_16x16x32_bf16 v[116:119], v[48:51], v[24:27], v[116:119]
    ds_read_b32 v17, v17
    s_waitcnt lgkmcnt(11)
    v_mfma_f32_16x16x32_bf16 v[100:103], v[80:83], v[56:59], v[100:103]
    ds_read_b32 v16, v208 offset:4
    ds_read2_b32 v[4:5], v209 offset0:0 offset1:2
    v_mfma_f32_16x16x32_bf16 v[104:107], v[84:87], v[56:59], v[104:107]
    ds_read2_b32 v[6:7], v209 offset0:4 offset1:6
    ds_read2_b32 v[8:9], v209 offset0:8 offset1:10
    v_mfma_f32_16x16x32_bf16 v[112:115], v[80:83], v[60:63], v[112:115]
    ds_read2_b32 v[10:11], v209 offset0:12 offset1:14
    ds_read2_b32 v[12:13], v209 offset0:16 offset1:18
    v_mfma_f32_16x16x32_bf16 v[116:119], v[84:87], v[60:63], v[116:119]
    ds_read2_b32 v[14:15], v209 offset0:20 offset1:22
    s_waitcnt lgkmcnt(7)
    v_mfma_f32_16x16x32_bf16 v[124:127], v[44:47], v[28:31], v[124:127]
    v_mov_b32_dpp v20, v100 row_newbcast:0 row_mask:0xf bank_mask:0xf
    v_mov_b32_dpp v21, v101 row_newbcast:0 row_mask:0xf bank_mask:0xf
    v_mov_b32_dpp v22, v102 row_newbcast:0 row_mask:0xf bank_mask:0xf
    v_mfma_f32_16x16x32_bf16 v[128:131], v[48:51], v[28:31], v[128:131]
    v_mov_b32_dpp v23, v103 row_newbcast:0 row_mask:0xf bank_mask:0xf
    v_mov_b32_dpp v24, v104 row_newbcast:0 row_mask:0xf bank_mask:0xf
    v_mov_b32_dpp v25, v105 row_newbcast:0 row_mask:0xf bank_mask:0xf
    v_mfma_f32_16x16x32_bf16 v[124:127], v[80:83], v[64:67], v[124:127]
    v_mov_b32_dpp v26, v106 row_newbcast:0 row_mask:0xf bank_mask:0xf
    v_mov_b32_dpp v27, v107 row_newbcast:0 row_mask:0xf bank_mask:0xf
    v_pk_fma_f32 v[100:101], v[184:185], v[20:21], v[100:101] op_sel_hi:[0,1,1] neg_lo:[1,0,0] neg_hi:[1,0,0]
    v_mfma_f32_16x16x32_bf16 v[128:131], v[84:87], v[64:67], v[128:131]
    v_pk_fma_f32 v[102:103], v[184:185], v[22:23], v[102:103] op_sel_hi:[0,1,1] neg_lo:[1,0,0] neg_hi:[1,0,0]
    v_pk_fma_f32 v[104:105], v[184:185], v[24:25], v[104:105] op_sel_hi:[0,1,1] neg_lo:[1,0,0] neg_hi:[1,0,0]
    v_pk_fma_f32 v[106:107], v[184:185], v[26:27], v[106:107] op_sel_hi:[0,1,1] neg_lo:[1,0,0] neg_hi:[1,0,0]
    v_mfma_f32_16x16x32_bf16 v[136:139], v[44:47], v[32:35], v[136:139]
    v_cvt_pk_bf16_f32 v100, v100, v101
    v_cvt_pk_bf16_f32 v101, v102, v103
    ds_write_b64 v3, v[100:101] offset:0
    v_mfma_f32_16x16x32_bf16 v[140:143], v[48:51], v[32:35], v[140:143]
    v_cvt_pk_bf16_f32 v104, v104, v105
    v_cvt_pk_bf16_f32 v105, v106, v107
    ds_write_b64 v3, v[104:105] offset:128
    v_mfma_f32_16x16x32_bf16 v[136:139], v[80:83], v[68:71], v[136:139]
    v_pk_fma_f32 v[112:113], v[186:187], v[20:21], v[112:113] op_sel_hi:[0,1,1] neg_lo:[1,0,0] neg_hi:[1,0,0]
    v_pk_fma_f32 v[114:115], v[186:187], v[22:23], v[114:115] op_sel_hi:[0,1,1] neg_lo:[1,0,0] neg_hi:[1,0,0]
    v_pk_fma_f32 v[116:117], v[186:187], v[24:25], v[116:117] op_sel_hi:[0,1,1] neg_lo:[1,0,0] neg_hi:[1,0,0]
    v_mfma_f32_16x16x32_bf16 v[140:143], v[84:87], v[68:71], v[140:143]
    v_pk_fma_f32 v[118:119], v[186:187], v[26:27], v[118:119] op_sel_hi:[0,1,1] neg_lo:[1,0,0] neg_hi:[1,0,0]
    v_cvt_pk_bf16_f32 v112, v112, v113
    v_cvt_pk_bf16_f32 v113, v114, v115
    v_mfma_f32_16x16x32_bf16 v[148:151], v[44:47], v[36:39], v[148:151]
    ds_write_b64 v3, v[112:113] offset:6400
    v_cvt_pk_bf16_f32 v116, v116, v117
    v_cvt_pk_bf16_f32 v117, v118, v119
    v_mfma_f32_16x16x32_bf16 v[152:155], v[48:51], v[36:39], v[152:155]
    ds_write_b64 v3, v[116:117] offset:6528
    v_readfirstlane_b32 s49, v17
    s_mov_b32 s60, 0x07060503
    v_mfma_f32_16x16x32_bf16 v[148:151], v[80:83], v[72:75], v[148:151]
    s_mov_b32 s61, 0x07060502
    s_mov_b32 s62, 0x07060501
    s_mov_b32 s63, 0x04000c0c
    v_mfma_f32_16x16x32_bf16 v[152:155], v[84:87], v[72:75], v[152:155]
    v_pk_fma_f32 v[124:125], v[188:189], v[20:21], v[124:125] op_sel_hi:[0,1,1] neg_lo:[1,0,0] neg_hi:[1,0,0]
    v_pk_fma_f32 v[126:127], v[188:189], v[22:23], v[126:127] op_sel_hi:[0,1,1] neg_lo:[1,0,0] neg_hi:[1,0,0]
    v_pk_fma_f32 v[128:129], v[188:189], v[24:25], v[128:129] op_sel_hi:[0,1,1] neg_lo:[1,0,0] neg_hi:[1,0,0]
    v_mfma_f32_16x16x32_bf16 v[160:163], v[44:47], v[40:43], v[160:163]
    v_pk_fma_f32 v[130:131], v[188:189], v[26:27], v[130:131] op_sel_hi:[0,1,1] neg_lo:[1,0,0] neg_hi:[1,0,0]
    v_cvt_pk_bf16_f32 v124, v124, v125
    v_cvt_pk_bf16_f32 v125, v126, v127
    v_mfma_f32_16x16x32_bf16 v[164:167], v[48:51], v[40:43], v[164:167]
    ds_write_b64 v3, v[124:125] offset:12800
    v_cvt_pk_bf16_f32 v128, v128, v129
    v_cvt_pk_bf16_f32 v129, v130, v131
    v_mfma_f32_16x16x32_bf16 v[160:163], v[80:83], v[76:79], v[160:163]
    ds_write_b64 v3, v[128:129] offset:12928
    s_mov_b32 s64, 0x0706000c
    s_mov_b32 s66, 0x11111111
    v_mfma_f32_16x16x32_bf16 v[164:167], v[84:87], v[76:79], v[164:167]
    s_mov_b32 s67, s66
    s_mov_b32 s68, 0x33333333
    v_pk_fma_f32 v[136:137], v[190:191], v[20:21], v[136:137] op_sel_hi:[0,1,1] neg_lo:[1,0,0] neg_hi:[1,0,0]
    v_mfma_f32_16x16x32_bf16 v[108:111], v[88:91], v[56:59], v[108:111]
    v_pk_fma_f32 v[138:139], v[190:191], v[22:23], v[138:139] op_sel_hi:[0,1,1] neg_lo:[1,0,0] neg_hi:[1,0,0]
    v_pk_fma_f32 v[140:141], v[190:191], v[24:25], v[140:141] op_sel_hi:[0,1,1] neg_lo:[1,0,0] neg_hi:[1,0,0]
    v_pk_fma_f32 v[142:143], v[190:191], v[26:27], v[142:143] op_sel_hi:[0,1,1] neg_lo:[1,0,0] neg_hi:[1,0,0]
    v_mfma_f32_16x16x32_bf16 v[120:123], v[88:91], v[60:63], v[120:123]
    v_cvt_pk_bf16_f32 v136, v136, v137
    v_cvt_pk_bf16_f32 v137, v138, v139
    ds_write_b64 v3, v[136:137] offset:19200
    v_mfma_f32_16x16x32_bf16 v[132:135], v[88:91], v[64:67], v[132:135]
    v_cvt_pk_bf16_f32 v140, v140, v141
    v_cvt_pk_bf16_f32 v141, v142, v143
    ds_write_b64 v3, v[140:141] offset:19328
    v_mfma_f32_16x16x32_bf16 v[144:147], v[88:91], v[68:71], v[144:147]
    s_mov_b32 s69, s68
    s_mov_b32 s70, 0x77777777
    s_mov_b32 s71, s70
    v_mfma_f32_16x16x32_bf16 v[156:159], v[88:91], v[72:75], v[156:159]
    v_pk_fma_f32 v[148:149], v[192:193], v[20:21], v[148:149] op_sel_hi:[0,1,1] neg_lo:[1,0,0] neg_hi:[1,0,0]
    v_pk_fma_f32 v[150:151], v[192:193], v[22:23], v[150:151] op_sel_hi:[0,1,1] neg_lo:[1,0,0] neg_hi:[1,0,0]
    v_pk_fma_f32 v[152:153], v[192:193], v[24:25], v[152:153] op_sel_hi:[0,1,1] neg_lo:[1,0,0] neg_hi:[1,0,0]
    v_mfma_f32_16x16x32_bf16 v[168:171], v[88:91], v[76:79], v[168:171]
    v_pk_fma_f32 v[154:155], v[192:193], v[26:27], v[154:155] op_sel_hi:[0,1,1] neg_lo:[1,0,0] neg_hi:[1,0,0]
    v_cvt_pk_bf16_f32 v148, v148, v149
    v_cvt_pk_bf16_f32 v149, v150, v151
    ds_write_b64 v3, v[148:149] offset:25600
    v_cvt_pk_bf16_f32 v152, v152, v153
    v_cvt_pk_bf16_f32 v153, v154, v155
    ds_write_b64 v3, v[152:153] offset:25728
    v_pk_fma_f32 v[160:161], v[194:195], v[20:21], v[160:161] op_sel_hi:[0,1,1] neg_lo:[1,0,0] neg_hi:[1,0,0]
    v_pk_fma_f32 v[162:163], v[194:195], v[22:23], v[162:163] op_sel_hi:[0,1,1] neg_lo:[1,0,0] neg_hi:[1,0,0]
    v_pk_fma_f32 v[164:165], v[194:195], v[24:25], v[164:165] op_sel_hi:[0,1,1] neg_lo:[1,0,0] neg_hi:[1,0,0]
    v_pk_fma_f32 v[166:167], v[194:195], v[26:27], v[166:167] op_sel_hi:[0,1,1] neg_lo:[1,0,0] neg_hi:[1,0,0]
    v_cvt_pk_bf16_f32 v160, v160, v161
    v_cvt_pk_bf16_f32 v161, v162, v163
    ds_write_b64 v3, v[160:161] offset:32000
    v_cvt_pk_bf16_f32 v164, v164, v165
    v_cvt_pk_bf16_f32 v165, v166, v167
    ds_write_b64 v3, v[164:165] offset:32128
    s_setprio 2
    s_branch AT_e2
AT_start:
    s_setprio 3
    ds_read_b32 v16, v208 offset:4
    ds_read2_b32 v[4:5], v209 offset0:0 offset1:2
    ds_read2_b32 v[6:7], v209 offset0:4 offset1:6
    ds_read2_b32 v[8:9], v209 offset0:8 offset1:10
    ds_read2_b32 v[10:11], v209 offset0:12 offset1:14
    ds_read2_b32 v[12:13], v209 offset0:16 offset1:18
    ds_read2_b32 v[14:15], v209 offset0:20 offset1:22
    s_mov_b32 s60, 0x07060503
    s_mov_b32 s61, 0x07060502
    s_mov_b32 s62, 0x07060501
    s_mov_b32 s63, 0x04000c0c
    s_mov_b32 s64, 0x0706000c
    s_mov_b32 s66, 0x11111111
    s_mov_b32 s67, s66
    s_mov_b32 s68, 0x33333333
    s_mov_b32 s69, s68
    s_mov_b32 s70, 0x77777777
    s_mov_b32 s71, s70
    v_mov_b32 v3, 0
AT_e2:
    s_waitcnt lgkmcnt(0)
    s_barrier
    s_branch AT_qk
AT_67:
    s_waitcnt vmcnt(11)
    ds_write_b128 v99, v[100:103] offset:2048
    s_waitcnt vmcnt(10)
    ds_write_b128 v99, v[104:107] offset:0
    s_waitcnt vmcnt(9)
    ds_write_b128 v99, v[108:111] offset:6144
    s_waitcnt vmcnt(8)
    ds_write_b128 v99, v[112:115] offset:4096
    s_waitcnt vmcnt(7)
    ds_write_b128 v99, v[116:119] offset:10240
    s_waitcnt vmcnt(6)
    ds_write_b128 v99, v[120:123] offset:8192
    s_waitcnt vmcnt(5)
    ds_write_b128 v99, v[124:127] offset:14336
    s_waitcnt vmcnt(4)
    ds_write_b128 v99, v[128:131] offset:12288
    s_waitcnt vmcnt(3)
    ds_write_b128 v99, v[132:135] offset:18432
    s_waitcnt vmcnt(2)
    ds_write_b128 v99, v[136:139] offset:16384
    s_waitcnt vmcnt(1)
    ds_write_b128 v99, v[140:143] offset:22528
    s_waitcnt vmcnt(0)
    ds_write_b128 v99, v[144:147] offset:20480
    v_mov_b32 v19, 1
    s_mov_b64 exec, 1
    ds_add_u32 v251, v19
    s_mov_b64 exec, -1
    s_mov_b32 s62, 1
    s_waitcnt vmcnt(0)
    s_branch B_start
AT_qk:
    ds_read_b64 v[20:21], v204
    ds_read_b64 v[30:31], v205 offset:0
    ds_read_b64 v[40:41], v205 offset:1600
    ds_read_b64 v[50:51], v205 offset:3200
    ds_read_b64 v[22:23], v229
    ds_read_b64 v[32:33], v205 offset:8
    ds_read_b64 v[42:43], v205 offset:1608
    ds_read_b64 v[52:53], v205 offset:3208
    ds_read_b64 v[24:25], v230
    ds_read_b64 v[34:35], v205 offset:16
    ds_read_b64 v[44:45], v205 offset:1616
    ds_read_b64 v[54:55], v205 offset:3216
    ds_read_b64 v[26:27], v231
    ds_read_b64 v[36:37], v205 offset:24
    ds_read_b64 v[46:47], v205 offset:1624
    ds_read_b64 v[56:57], v205 offset:3224
    ds_read_b64 v[28:29], v255
    ds_read_b64 v[38:39], v205 offset:32
    ds_read_b64 v[48:49], v205 offset:1632
    ds_read_b64 v[58:59], v205 offset:3232
    v_cndmask_b32 v13, v13, v5, s[66:67]
    v_cndmask_b32 v14, v14, v6, s[68:69]
    v_cndmask_b32 v15, v15, v7, s[70:71]
    v_mov_b32 v79, s54
    v_mov_b32 v83, s54
    v_mov_b32 v87, s54
    v_mov_b64 v[88:89], 0
    v_mov_b64 v[90:91], 0
    v_mov_b64 v[92:93], 0
    v_mov_b64 v[94:95], 0
    v_mul_f32 v16, 0x3ea52b5c, v16
    v_mul_f32 v148, v16, v8
    v_mul_f32 v149, v16, v9
    v_mul_f32 v150, v16, v10
    v_mul_f32 v151, v16, v11
    v_mul_f32 v152, v16, v12
    v_mul_f32 v153, v16, v13
    v_mul_f32 v154, v16, v14
    v_mul_f32 v155, v16, v15
    s_waitcnt lgkmcnt(15)
    v_mfma_f32_4x4x4_16b_bf16 v[60:63], v[30:31], v[20:21], 0
    v_mfma_f32_4x4x4_16b_bf16 v[64:67], v[40:41], v[20:21], 0
    v_mfma_f32_4x4x4_16b_bf16 v[68:71], v[50:51], v[20:21], 0
    s_waitcnt lgkmcnt(12)
    v_mfma_f32_4x4x4_16b_bf16 v[60:63], v[32:33], v[22:23], v[60:63]
    v_mfma_f32_4x4x4_16b_bf16 v[64:67], v[42:43], v[22:23], v[64:67]
    v_mfma_f32_4x4x4_16b_bf16 v[68:71], v[52:53], v[22:23], v[68:71]
    s_waitcnt lgkmcnt(8)
    v_mfma_f32_4x4x4_16b_bf16 v[60:63], v[34:35], v[24:25], v[60:63]
    v_mfma_f32_4x4x4_16b_bf16 v[64:67], v[44:45], v[24:25], v[64:67]
    v_mfma_f32_4x4x4_16b_bf16 v[68:71], v[54:55], v[24:25], v[68:71]
    s_waitcnt lgkmcnt(4)
    v_mfma_f32_4x4x4_16b_bf16 v[60:63], v[36:37], v[26:27], v[60:63]
    v_mfma_f32_4x4x4_16b_bf16 v[64:67], v[46:47], v[26:27], v[64:67]
    v_mfma_f32_4x4x4_16b_bf16 v[68:71], v[56:57], v[26:27], v[68:71]
    s_waitcnt lgkmcnt(0)
    v_mfma_f32_4x4x4_16b_bf16 v[60:63], v[38:39], v[28:29], v[60:63]
    v_mfma_f32_4x4x4_16b_bf16 v[64:67], v[48:49], v[28:29], v[64:67]
    v_mfma_f32_4x4x4_16b_bf16 v[68:71], v[58:59], v[28:29], v[68:71]
    s_cmp_lt_i32 s13, 8
    s_cbranch_scc1 AT_mask
AT_nomask:
    s_nop 2
    v_cndmask_b32 v69, v69, v61, s[66:67]
    v_cndmask_b32 v70, v70, v62, s[68:69]
    v_cndmask_b32 v71, v71, v63, s[70:71]
    v_pk_mul_f32 v[64:65], v[64:65], v[148:149]
    v_pk_mul_f32 v[66:67], v[66:67], v[150:151]
    v_pk_mul_f32 v[68:69], v[68:69], v[152:153]
    v_pk_mul_f32 v[70:71], v[70:71], v[154:155]
    v_perm_b32 v80, v64, v67, s60
    v_perm_b32 v81, v65, v67, s61
    v_perm_b32 v82, v66, v67, s62
    v_perm_b32 v84, v68, v71, s60
    v_perm_b32 v85, v69, v71, s61
    v_perm_b32 v86, v70, v71, s62
    s_mov_b64 exec, s[20:21]
    s_cmp_eq_u32 s49, 0
    s_cbranch_scc1 sts_1
    buffer_store_dwordx4 v[80:83], v213, s[24:27], s12 offen offset:0
    buffer_store_dwordx4 v[84:87], v213, s[24:27], s12 offen offset:512
std_2:
    s_mov_b64 exec, -1
    s_cmp_ge_u32 s48, 4
    s_cbranch_scc1 AT_vw
    v_mov_b32_dpp v196, v108 row_newbcast:0 row_mask:0xf bank_mask:0xf
    v_mov_b32_dpp v197, v109 row_newbcast:0 row_mask:0xf bank_mask:0xf
    v_mov_b32_dpp v198, v110 row_newbcast:0 row_mask:0xf bank_mask:0xf
    v_mov_b32_dpp v199, v111 row_newbcast:0 row_mask:0xf bank_mask:0xf
    v_pk_fma_f32 v[108:109], v[184:185], v[196:197], v[108:109] op_sel_hi:[0,1,1] neg_lo:[1,0,0] neg_hi:[1,0,0]
    v_pk_fma_f32 v[120:121], v[186:187], v[196:197], v[120:121] op_sel_hi:[0,1,1] neg_lo:[1,0,0] neg_hi:[1,0,0]
    v_pk_fma_f32 v[132:133], v[188:189], v[196:197], v[132:133] op_sel_hi:[0,1,1] neg_lo:[1,0,0] neg_hi:[1,0,0]
    v_pk_fma_f32 v[110:111], v[184:185], v[198:199], v[110:111] op_sel_hi:[0,1,1] neg_lo:[1,0,0] neg_hi:[1,0,0]
    v_pk_fma_f32 v[122:123], v[186:187], v[198:199], v[122:123] op_sel_hi:[0,1,1] neg_lo:[1,0,0] neg_hi:[1,0,0]
    v_pk_fma_f32 v[134:135], v[188:189], v[198:199], v[134:135] op_sel_hi:[0,1,1] neg_lo:[1,0,0] neg_hi:[1,0,0]
    v_cvt_pk_bf16_f32 v108, v108, v109
    v_cvt_pk_bf16_f32 v120, v120, v121
    v_cvt_pk_bf16_f32 v132, v132, v133
    v_cvt_pk_bf16_f32 v109, v110, v111
    v_cvt_pk_bf16_f32 v121, v122, v123
    v_cvt_pk_bf16_f32 v133, v134, v135
    ds_write_b64 v3, v[108:109] offset:256
    ds_write_b64 v3, v[120:121] offset:6656
    ds_write_b64 v3, v[132:133] offset:13056
    v_pk_fma_f32 v[144:145], v[190:191], v[196:197], v[144:145] op_sel_hi:[0,1,1] neg_lo:[1,0,0] neg_hi:[1,0,0]
    v_pk_fma_f32 v[156:157], v[192:193], v[196:197], v[156:157] op_sel_hi:[0,1,1] neg_lo:[1,0,0] neg_hi:[1,0,0]
    v_pk_fma_f32 v[168:169], v[194:195], v[196:197], v[168:169] op_sel_hi:[0,1,1] neg_lo:[1,0,0] neg_hi:[1,0,0]
    v_pk_fma_f32 v[146:147], v[190:191], v[198:199], v[146:147] op_sel_hi:[0,1,1] neg_lo:[1,0,0] neg_hi:[1,0,0]
    v_pk_fma_f32 v[158:159], v[192:193], v[198:199], v[158:159] op_sel_hi:[0,1,1] neg_lo:[1,0,0] neg_hi:[1,0,0]
    v_pk_fma_f32 v[170:171], v[194:195], v[198:199], v[170:171] op_sel_hi:[0,1,1] neg_lo:[1,0,0] neg_hi:[1,0,0]
    v_cvt_pk_bf16_f32 v144, v144, v145
    v_cvt_pk_bf16_f32 v156, v156, v157
    v_cvt_pk_bf16_f32 v168, v168, v169
    v_cvt_pk_bf16_f32 v145, v146, v147
    v_cvt_pk_bf16_f32 v157, v158, v159
    v_cvt_pk_bf16_f32 v169, v170, v171
    ds_write_b64 v3, v[144:145] offset:19456
    ds_write_b64 v3, v[156:157] offset:25856
    ds_write_b64 v3, v[168:169] offset:32256
    v_mov_b32 v19, 1
    s_mov_b64 exec, 1
    ds_add_u32 v251, v19 offset:8
    s_mov_b64 exec, -1
AT_vw:
    v_lshl_add_u32 v17, v201, 3, v251
    ds_read2_b64 v[156:159], v17 offset0:14 offset1:18
    ds_read2_b64 v[160:163], v17 offset0:22 offset1:26
    v_and_b32 v164, 2, v201
    v_lshl_add_u32 v164, v200, 2, v164
    s_lshl_b32 s65, s48, 6
    s_add_u32 s65, s65, s57
    s_mov_b64 exec, s[20:21]
AT_poll:
    buffer_load_dwordx4 v[88:91], v206, s[24:27], s22 offen offset:0 sc1
    buffer_load_dwordx4 v[92:95], v206, s[24:27], s22 offen offset:512 sc1
AT_pw:
    s_waitcnt vmcnt(0)
    v_cmp_ne_u32 vcc, s54, v91
    v_cmp_ne_u32 s[58:59], s54, v95
    s_or_b64 vcc, vcc, s[58:59]
    s_cbranch_vccz AT_got
    s_sub_u32 s3, s3, 1
    s_cbranch_scc0 AT_poll
    s_mov_b32 s3, 0
AT_got:
    s_mov_b64 exec, -1
    ds_read_b32 v17, v251 offset:8
    s_cmp_lt_u32 s48, 4
    s_cbranch_scc1 AT_w0
    v_mov_b32 v19, 1
    s_mov_b64 exec, 1
    ds_add_u32 v251, v19
    s_mov_b64 exec, -1
AT_w0:
    v_perm_b32 v91, v88, v89, s63
    v_perm_b32 v95, v92, v93, s63
    v_perm_b32 v91, v91, v90, s64
    v_perm_b32 v95, v95, v94, s64
    v_pk_add_f32 v[64:65], v[64:65], v[88:89]
    v_pk_add_f32 v[68:69], v[68:69], v[92:93]
    v_pk_add_f32 v[66:67], v[66:67], v[90:91]
    v_pk_add_f32 v[70:71], v[70:71], v[94:95]
    v_max3_f32 v18, v64, v65, v66
    v_max3_f32 v19, v67, v68, v69
    v_max3_f32 v18, v18, v70, v71
    v_max_f32 v18, v18, v19
    v_pk_add_f32 v[64:65], v[64:65], v[18:19] op_sel_hi:[1,0] neg_lo:[0,1] neg_hi:[0,1]
    v_pk_add_f32 v[66:67], v[66:67], v[18:19] op_sel_hi:[1,0] neg_lo:[0,1] neg_hi:[0,1]
    v_pk_add_f32 v[68:69], v[68:69], v[18:19] op_sel_hi:[1,0] neg_lo:[0,1] neg_hi:[0,1]
    v_pk_add_f32 v[70:71], v[70:71], v[18:19] op_sel_hi:[1,0] neg_lo:[0,1] neg_hi:[0,1]
AT_vc:
    s_waitcnt lgkmcnt(0)
    v_cmp_ne_u32 vcc, 4, v17
    s_cbranch_vccnz AT_vs
AT_vg:
    ds_read_b64_tr_b16 v[100:101], v214 offset:0
    ds_read_b64_tr_b16 v[102:103], v214 offset:1600
    ds_read_b64_tr_b16 v[104:105], v214 offset:32
    ds_read_b64_tr_b16 v[106:107], v214 offset:1632
    ds_read_b64_tr_b16 v[108:109], v214 offset:64
    ds_read_b64_tr_b16 v[110:111], v214 offset:1664
    ds_read_b64_tr_b16 v[112:113], v214 offset:96
    ds_read_b64_tr_b16 v[114:115], v214 offset:1696
    v_exp_f32 v64, v64
    v_exp_f32 v65, v65
    v_exp_f32 v66, v66
    v_exp_f32 v67, v67
    v_exp_f32 v68, v68
    v_exp_f32 v69, v69
    v_exp_f32 v70, v70
    v_exp_f32 v71, v71
    v_pk_add_f32 v[20:21], v[64:65], v[66:67]
    v_pk_add_f32 v[22:23], v[68:69], v[70:71]
    v_pk_add_f32 v[20:21], v[20:21], v[22:23]
    v_add_f32 v20, v20, v21
    v_rcp_f32 v20, v20
    v_pk_mul_f32 v[64:65], v[64:65], v[8:9]
    v_pk_mul_f32 v[66:67], v[66:67], v[10:11]
    v_pk_mul_f32 v[68:69], v[68:69], v[12:13]
    v_pk_mul_f32 v[70:71], v[70:71], v[14:15]
    v_pk_mul_f32 v[64:65], v[64:65], v[20:21] op_sel_hi:[1,0]
    v_pk_mul_f32 v[66:67], v[66:67], v[20:21] op_sel_hi:[1,0]
    v_pk_mul_f32 v[68:69], v[68:69], v[20:21] op_sel_hi:[1,0]
    v_pk_mul_f32 v[70:71], v[70:71], v[20:21] op_sel_hi:[1,0]
    v_cvt_pk_bf16_f32 v24, v64, v65
    v_cvt_pk_bf16_f32 v25, v66, v67
    v_cvt_pk_bf16_f32 v26, v68, v69
    v_cvt_pk_bf16_f32 v27, v70, v71
    ds_write_b64 v210, v[24:25] offset:8
    v_and_b32 v28, v26, v207
    v_and_b32 v29, v27, v211
    ds_write_b64 v210, v[28:29]
    v_xor_b32 v26, v26, v28
    v_xor_b32 v27, v27, v29
    ds_write_b64 v210, v[26:27] offset:16
    ds_read_b128 v[116:119], v172
    ds_read_b128 v[120:123], v173
    ds_read_b128 v[124:127], v174
    ds_read_b128 v[128:131], v175
    ds_read_b128 v[132:135], v176
    ds_read_b128 v[136:139], v177
    ds_read_b128 v[140:143], v178
    ds_read_b128 v[144:147], v179
    s_cmp_lt_u32 s48, 4
    s_cbranch_scc1 AT_pv
    s_lshl_b32 s58, s48, 2
    s_add_u32 s58, s58, 160760
    v_mov_b32 v18, s58
    v_mov_b32 v19, 1
    ds_write_b32 v18, v19
AT_pv:
    s_waitcnt lgkmcnt(6)
    v_mfma_f32_16x16x32_bf16 v[20:23], v[100:103], v[116:119], 0
    v_mfma_f32_16x16x32_bf16 v[24:27], v[100:103], v[120:123], 0
    s_waitcnt lgkmcnt(4)
    v_mfma_f32_16x16x32_bf16 v[28:31], v[104:107], v[124:127], 0
    v_mfma_f32_16x16x32_bf16 v[32:35], v[104:107], v[128:131], 0
    s_waitcnt lgkmcnt(2)
    v_mfma_f32_16x16x32_bf16 v[36:39], v[108:111], v[132:135], 0
    v_mfma_f32_16x16x32_bf16 v[40:43], v[108:111], v[136:139], 0
    s_waitcnt lgkmcnt(0)
    v_mfma_f32_16x16x32_bf16 v[44:47], v[112:115], v[140:143], 0
    v_mfma_f32_16x16x32_bf16 v[48:51], v[112:115], v[144:147], 0
    v_cndmask_b32 v20, v20, v24, s[4:5]
    v_cndmask_b32 v21, v21, v25, s[4:5]
    v_cndmask_b32 v22, v22, v26, s[4:5]
    v_cndmask_b32 v23, v23, v27, s[4:5]
    v_cvt_pk_bf16_f32 v204, v20, v21
    v_cvt_pk_bf16_f32 v205, v22, v23
    v_cndmask_b32 v28, v28, v32, s[6:7]
    v_cndmask_b32 v29, v29, v33, s[6:7]
    v_cndmask_b32 v30, v30, v34, s[6:7]
    v_cndmask_b32 v31, v31, v35, s[6:7]
    v_cvt_pk_bf16_f32 v206, v28, v29
    v_cvt_pk_bf16_f32 v207, v30, v31
    v_cndmask_b32 v36, v36, v40, s[8:9]
    v_cndmask_b32 v37, v37, v41, s[8:9]
    v_cndmask_b32 v38, v38, v42, s[8:9]
    v_cndmask_b32 v39, v39, v43, s[8:9]
    v_cvt_pk_bf16_f32 v208, v36, v37
    v_cvt_pk_bf16_f32 v209, v38, v39
    v_cndmask_b32 v44, v44, v48, s[10:11]
    v_cndmask_b32 v45, v45, v49, s[10:11]
    v_cndmask_b32 v46, v46, v50, s[10:11]
    v_cndmask_b32 v47, v47, v51, s[10:11]
    v_cvt_pk_bf16_f32 v210, v44, v45
    v_cvt_pk_bf16_f32 v211, v46, v47
    s_cmp_eq_u32 s49, 0
    s_cbranch_scc1 sts_3
    buffer_store_dwordx4 v[204:207], v249, s[24:27], s22 offen offset:0
    buffer_store_dwordx4 v[208:211], v249, s[24:27], s22 offen offset:1024
std_4:
    s_mov_b64 exec, s[18:19]
    buffer_load_dword v18, v203, s[24:27], s17 offen sc1
    s_mov_b64 exec, -1
    v_dot2_f32_bf16 v20, v204, v156, 0
    v_dot2_f32_bf16 v21, v204, v204, 0
    v_dot2_f32_bf16 v20, v205, v157, v20
    v_dot2_f32_bf16 v21, v205, v205, v21
    v_dot2_f32_bf16 v20, v206, v158, v20
    v_dot2_f32_bf16 v21, v206, v206, v21
    v_dot2_f32_bf16 v20, v207, v159, v20
    v_dot2_f32_bf16 v21, v207, v207, v21
    v_dot2_f32_bf16 v20, v208, v160, v20
    v_dot2_f32_bf16 v21, v208, v208, v21
    v_dot2_f32_bf16 v20, v209, v161, v20
    v_dot2_f32_bf16 v21, v209, v209, v21
    v_dot2_f32_bf16 v20, v210, v162, v20
    v_dot2_f32_bf16 v21, v210, v210, v21
    v_dot2_f32_bf16 v20, v211, v163, v20
    v_dot2_f32_bf16 v21, v211, v211, v21
    s_nop 2
    v_permlane32_swap_b32 v20, v21
    v_add_f32 v20, v20, v21
    v_mov_b32 v21, v20
    s_nop 1
    v_permlane16_swap_b32 v20, v21
    s_mov_b32 exec_lo, 0xffff
    s_mov_b32 exec_hi, 0xffff
    v_add_f32 v20, v20, v21
    s_cmp_eq_u32 s49, 0
    s_cbranch_scc1 sts_5
    buffer_store_short_d16_hi v20, v164, s[24:27], s65 offen
std_6:
    s_mov_b64 exec, -1
    s_waitcnt vmcnt(2)
    s_mov_b64 exec, 1
    s_cmp_eq_u32 s49, 0
    s_cbranch_scc1 sts_7
    buffer_store_dword v79, v203, s[24:27], s23 offen
std_8:
    s_mov_b64 exec, -1
    s_waitcnt vmcnt(2)
    v_cmp_ne_u32 vcc, s54, v18
    s_and_b32 s62, vcc_lo, s18
    s_cbranch_scc1 B_st0
    s_add_u32 s14, s14, 2048
    s_cmp_eq_u32 s14, s15
    s_cselect_b32 s14, s1, s14
    buffer_load_dwordx4 v[168:171], v249, s[24:27], s14 offen offset:0 sc1
    buffer_load_dwordx4 v[172:175], v249, s[24:27], s14 offen offset:1024 sc1
    s_add_u32 s14, s14, 2048
    s_cmp_eq_u32 s14, s15
    s_cselect_b32 s14, s1, s14
    buffer_load_dwordx4 v[176:179], v249, s[24:27], s14 offen offset:0 sc1
    buffer_load_dwordx4 v[180:183], v249, s[24:27], s14 offen offset:1024 sc1
    s_add_u32 s14, s14, 2048
    s_cmp_eq_u32 s14, s15
    s_cselect_b32 s14, s1, s14
    buffer_load_dwordx4 v[212:215], v249, s[24:27], s14 offen offset:0 sc1
    buffer_load_dwordx4 v[12:15], v249, s[24:27], s14 offen offset:1024 sc1
B_st0:
B_start:
    ds_read_b32 v19, v251
    ds_read2_b64 v[240:243], v227 offset0:0 offset1:4
    ds_read2_b64 v[244:247], v227 offset0:8 offset1:12
    ds_read_b32 v248, v251 offset:2288
    ds_read_b64 v[232:233], v250
    v_xor_b32 v4, 32, v250
    ds_read_b64 v[234:235], v4
    v_xor_b32 v5, 64, v250
    ds_read_b64 v[236:237], v5
    v_xor_b32 v6, 96, v250
    ds_read_b64 v[238:239], v6
    v_cmp_gt_u32 vcc, 2048, v254
    s_mov_b64 s[4:5], vcc
    s_branch B_wc
B_ww:
    ds_read_b32 v19, v251
B_wc:
    s_waitcnt lgkmcnt(0)
    v_cmp_ne_u32 vcc, 4, v19
    s_cbranch_vccz B_wd
    s_sleep 1
    s_sub_u32 s3, s3, 1
    s_cbranch_scc0 B_ww
    s_mov_b32 s3, 0
B_wd:
    s_mov_b32 exec_lo, 0x00010001
    s_mov_b32 exec_hi, 0x00010001
    v_mov_b32 v240, 0x3f803f80
    v_mov_b32 v241, 0x3f803f80
    v_mov_b32 v242, 0x3f803f80
    v_mov_b32 v243, 0x3f803f80
    v_mov_b32 v244, 0x3f803f80
    v_mov_b32 v245, 0x3f803f80
    v_mov_b32 v246, 0x3f803f80
    v_mov_b32 v247, 0x3f803f80
    s_mov_b64 exec, -1
    s_setprio 0
    s_cmp_ge_u32 s48, 6
    s_cbranch_scc1 B_r2
    ds_read_b64_tr_b16 v[20:21], v216 offset:0
    ds_read_b64_tr_b16 v[22:23], v216 offset:2048
    ds_read_b64_tr_b16 v[24:25], v217 offset:0
    ds_read_b64_tr_b16 v[26:27], v217 offset:2048
    ds_read_b64_tr_b16 v[28:29], v218 offset:0
    ds_read_b64_tr_b16 v[30:31], v218 offset:2048
    ds_read_b64_tr_b16 v[32:33], v219 offset:0
    ds_read_b64_tr_b16 v[34:35], v219 offset:2048
    ds_read_b64_tr_b16 v[36:37], v216 offset:4096
    ds_read_b64_tr_b16 v[38:39], v216 offset:6144
    ds_read_b64_tr_b16 v[40:41], v217 offset:4096
    ds_read_b64_tr_b16 v[42:43], v217 offset:6144
    ds_read_b64_tr_b16 v[44:45], v218 offset:4096
    ds_read_b64_tr_b16 v[46:47], v218 offset:6144
    ds_read_b64_tr_b16 v[48:49], v219 offset:4096
    ds_read_b64_tr_b16 v[50:51], v219 offset:6144
B_r2:
    ds_read_b64_tr_b16 v[52:53], v216 offset:8192
    ds_read_b64_tr_b16 v[54:55], v216 offset:10240
    ds_read_b64_tr_b16 v[56:57], v217 offset:8192
    ds_read_b64_tr_b16 v[58:59], v217 offset:10240
    ds_read_b64_tr_b16 v[60:61], v218 offset:8192
    ds_read_b64_tr_b16 v[62:63], v218 offset:10240
    ds_read_b64_tr_b16 v[64:65], v219 offset:8192
    ds_read_b64_tr_b16 v[66:67], v219 offset:10240
    ds_read_b64_tr_b16 v[68:69], v216 offset:12288
    ds_read_b64_tr_b16 v[70:71], v216 offset:14336
    ds_read_b64_tr_b16 v[72:73], v217 offset:12288
    ds_read_b64_tr_b16 v[74:75], v217 offset:14336
    ds_read_b64_tr_b16 v[76:77], v218 offset:12288
    ds_read_b64_tr_b16 v[78:79], v218 offset:14336
    ds_read_b64_tr_b16 v[80:81], v219 offset:12288
    ds_read_b64_tr_b16 v[82:83], v219 offset:14336
    s_cmp_eq_u32 s62, 0
    s_cbranch_scc1 B_nap
    s_mov_b64 exec, s[18:19]
    buffer_load_dword v18, v203, s[24:27], s17 offen sc1
    s_mov_b64 exec, -1
B_nap:
    ds_read_b64_tr_b16 v[84:85], v216 offset:16384
    ds_read_b64_tr_b16 v[86:87], v216 offset:18432
    ds_read_b64_tr_b16 v[88:89], v217 offset:16384
    ds_read_b64_tr_b16 v[90:91], v217 offset:18432
    ds_read_b64_tr_b16 v[92:93], v218 offset:16384
    ds_read_b64_tr_b16 v[94:95], v218 offset:18432
    ds_read_b64_tr_b16 v[96:97], v219 offset:16384
    ds_read_b64_tr_b16 v[98:99], v219 offset:18432
    ds_read_b64_tr_b16 v[100:101], v216 offset:20480
    ds_read_b64_tr_b16 v[102:103], v216 offset:22528
    ds_read_b64_tr_b16 v[104:105], v217 offset:20480
    ds_read_b64_tr_b16 v[106:107], v217 offset:22528
    ds_read_b64_tr_b16 v[108:109], v218 offset:20480
    ds_read_b64_tr_b16 v[110:111], v218 offset:22528
    ds_read_b64_tr_b16 v[112:113], v219 offset:20480
    ds_read_b64_tr_b16 v[114:115], v219 offset:22528
    ds_read_b64_tr_b16 v[116:117], v216 offset:24576
    ds_read_b64_tr_b16 v[118:119], v216 offset:26624
    ds_read_b64_tr_b16 v[120:121], v217 offset:24576
    ds_read_b64_tr_b16 v[122:123], v217 offset:26624
    ds_read_b64_tr_b16 v[124:125], v218 offset:24576
    ds_read_b64_tr_b16 v[126:127], v218 offset:26624
    ds_read_b64_tr_b16 v[128:129], v219 offset:24576
    ds_read_b64_tr_b16 v[130:131], v219 offset:26624
    s_cmp_ge_u32 s48, 6
    s_cbranch_scc1 B_no
    v_lshlrev_b32 v184, 16, v232
    v_and_b32 v185, s47, v232
    v_lshlrev_b32 v186, 16, v233
    v_and_b32 v187, s47, v233
    v_lshlrev_b32 v188, 16, v234
    v_and_b32 v189, s47, v234
    v_lshlrev_b32 v190, 16, v235
    v_and_b32 v191, s47, v235
    v_lshlrev_b32 v192, 16, v236
    v_and_b32 v193, s47, v236
    v_lshlrev_b32 v194, 16, v237
    v_and_b32 v195, s47, v237
    v_lshlrev_b32 v196, 16, v238
    v_and_b32 v197, s47, v238
    v_lshlrev_b32 v198, 16, v239
    v_and_b32 v199, s47, v239
    s_waitcnt lgkmcnt(0)
    v_mfma_f32_16x16x32_bf16 v[184:187], v[20:23], v[204:207], v[184:187]
    v_mfma_f32_16x16x32_bf16 v[188:191], v[24:27], v[204:207], v[188:191]
    v_mfma_f32_16x16x32_bf16 v[192:195], v[28:31], v[204:207], v[192:195]
    v_mfma_f32_16x16x32_bf16 v[196:199], v[32:35], v[204:207], v[196:199]
    s_waitcnt lgkmcnt(0)
    v_mfma_f32_16x16x32_bf16 v[184:187], v[36:39], v[208:211], v[184:187]
    v_mfma_f32_16x16x32_bf16 v[188:191], v[40:43], v[208:211], v[188:191]
    v_mfma_f32_16x16x32_bf16 v[192:195], v[44:47], v[208:211], v[192:195]
    v_mfma_f32_16x16x32_bf16 v[196:199], v[48:51], v[208:211], v[196:199]
    s_branch B_n2
B_rds:
    ds_read_b64_tr_b16 v[132:133], v216 offset:28672
    ds_read_b64_tr_b16 v[134:135], v216 offset:30720
    ds_read_b64_tr_b16 v[136:137], v217 offset:28672
    ds_read_b64_tr_b16 v[138:139], v217 offset:30720
    ds_read_b64_tr_b16 v[140:141], v218 offset:28672
    ds_read_b64_tr_b16 v[142:143], v218 offset:30720
    ds_read_b64_tr_b16 v[144:145], v219 offset:28672
    ds_read_b64_tr_b16 v[146:147], v219 offset:30720
    ds_read_b64_tr_b16 v[148:149], v216 offset:32768
    ds_read_b64_tr_b16 v[150:151], v216 offset:34816
    ds_read_b64_tr_b16 v[152:153], v217 offset:32768
    ds_read_b64_tr_b16 v[154:155], v217 offset:34816
    ds_read_b64_tr_b16 v[156:157], v218 offset:32768
    ds_read_b64_tr_b16 v[158:159], v218 offset:34816
    ds_read_b64_tr_b16 v[160:161], v219 offset:32768
    ds_read_b64_tr_b16 v[162:163], v219 offset:34816
    ds_read_b64_tr_b16 v[20:21], v216 offset:36864
    ds_read_b64_tr_b16 v[22:23], v216 offset:38912
    ds_read_b64_tr_b16 v[24:25], v217 offset:36864
    ds_read_b64_tr_b16 v[26:27], v217 offset:38912
    ds_read_b64_tr_b16 v[28:29], v218 offset:36864
    ds_read_b64_tr_b16 v[30:31], v218 offset:38912
    ds_read_b64_tr_b16 v[32:33], v219 offset:36864
    ds_read_b64_tr_b16 v[34:35], v219 offset:38912
    ds_read_b64_tr_b16 v[36:37], v220 offset:0
    ds_read_b64_tr_b16 v[38:39], v220 offset:2048
    ds_read_b64_tr_b16 v[40:41], v221 offset:0
    ds_read_b64_tr_b16 v[42:43], v221 offset:2048
    ds_read_b64_tr_b16 v[44:45], v222 offset:0
    ds_read_b64_tr_b16 v[46:47], v222 offset:2048
    ds_read_b64_tr_b16 v[48:49], v223 offset:0
    ds_read_b64_tr_b16 v[50:51], v223 offset:2048
    s_setpc_b64 s[98:99]
B_no:
    v_mov_b64 v[184:185], 0
    v_mov_b64 v[186:187], 0
    v_mov_b64 v[188:189], 0
    v_mov_b64 v[190:191], 0
    v_mov_b64 v[192:193], 0
    v_mov_b64 v[194:195], 0
    v_mov_b64 v[196:197], 0
    v_mov_b64 v[198:199], 0
    s_call_b64 s[98:99], B_rds
    v_mul_u32_u24 v4, 12, v0
    s_add_u32 s58, s100, 512
    s_add_u32 s59, s100, 24832
    s_add_u32 s60, s100, 49152
    s_add_u32 s12, s100, 73472
    s_add_u32 s13, s100, 97792
    v_and_b32 v5, 31, v0
    v_mul_u32_u24 v5, 3, v5
    s_mul_i32 s64, s53, 96
    s_sub_u32 s65, 1014, s55
    v_mov_b32 v6, 0xfffff000
    v_add_u32 v7, -10, v5
    v_cmp_gt_u32 vcc, s65, v7
    v_add3_u32 v7, v5, s64, 0
    s_nop 0
    v_cndmask_b32 v8, 0, v7, vcc
    v_cndmask_b32 v204, 0, v6, vcc
    v_add_u32 v7, -9, v5
    v_cmp_gt_u32 vcc, s65, v7
    v_add3_u32 v7, v5, s64, 1
    s_nop 0
    v_cndmask_b32 v9, 0, v7, vcc
    v_cndmask_b32 v205, 0, v6, vcc
    v_add_u32 v7, -8, v5
    v_cmp_gt_u32 vcc, s65, v7
    v_add3_u32 v7, v5, s64, 2
    s_nop 0
    v_cndmask_b32 v10, 0, v7, vcc
    v_cndmask_b32 v206, 0, v6, vcc
    v_mov_b32 v7, s54
    v_lshlrev_b32 v11, 11, v200
    s_setprio 2
B_n2:
    s_cmp_eq_u32 s62, 0
    s_cbranch_scc1 B_run
    s_mov_b64 exec, s[18:19]
    s_branch B_pw
B_poll:
    buffer_load_dword v18, v203, s[24:27], s17 offen sc1
B_pw:
    s_waitcnt vmcnt(0)
    v_cmp_ne_u32 vcc, s54, v18
    s_cbranch_vccz B_go
    s_sub_u32 s3, s3, 1
    s_cbranch_scc0 B_poll
    s_mov_b32 s3, 0
B_go:
    s_mov_b64 exec, -1
    s_add_u32 s14, s14, 2048
    s_cmp_eq_u32 s14, s15
    s_cselect_b32 s14, s1, s14
    buffer_load_dwordx4 v[168:171], v249, s[24:27], s14 offen offset:0 sc1
    buffer_load_dwordx4 v[172:175], v249, s[24:27], s14 offen offset:1024 sc1
    s_add_u32 s14, s14, 2048
    s_cmp_eq_u32 s14, s15
    s_cselect_b32 s14, s1, s14
    buffer_load_dwordx4 v[176:179], v249, s[24:27], s14 offen offset:0 sc1
    buffer_load_dwordx4 v[180:183], v249, s[24:27], s14 offen offset:1024 sc1
    s_add_u32 s14, s14, 2048
    s_cmp_eq_u32 s14, s15
    s_cselect_b32 s14, s1, s14
    buffer_load_dwordx4 v[212:215], v249, s[24:27], s14 offen offset:0 sc1
    buffer_load_dwordx4 v[12:15], v249, s[24:27], s14 offen offset:1024 sc1
B_run:
    s_cmp_ge_u32 s48, 6
    s_cbranch_scc1 B_half
    s_call_b64 s[98:99], B_rds
    s_cmp_ge_u32 s48, 4
    s_cbranch_scc1 B_half
    s_setprio 1
    s_waitcnt vmcnt(5) lgkmcnt(15)
    v_mfma_f32_16x16x32_bf16 v[184:187], v[52:55], v[168:171], v[184:187]
    v_mfma_f32_16x16x32_bf16 v[188:191], v[56:59], v[168:171], v[188:191]
    ds_read_b64_tr_b16 v[52:53], v220 offset:4096
    v_mfma_f32_16x16x32_bf16 v[192:195], v[60:63], v[168:171], v[192:195]
    ds_read_b64_tr_b16 v[54:55], v220 offset:6144
    v_mfma_f32_16x16x32_bf16 v[196:199], v[64:67], v[168:171], v[196:199]
    s_add_u32 s14, s14, 2048
    s_cmp_eq_u32 s14, s15
    s_cselect_b32 s14, s1, s14
    buffer_load_dwordx4 v[164:167], v249, s[24:27], s14 offen offset:0 sc1
    ds_read_b64_tr_b16 v[56:57], v221 offset:4096
    s_waitcnt vmcnt(5) lgkmcnt(15)
    v_mfma_f32_16x16x32_bf16 v[184:187], v[68:71], v[172:175], v[184:187]
    ds_read_b64_tr_b16 v[58:59], v221 offset:6144
    ds_read_b64_tr_b16 v[60:61], v222 offset:4096
    v_mfma_f32_16x16x32_bf16 v[188:191], v[72:75], v[172:175], v[188:191]
    ds_read_b64_tr_b16 v[62:63], v222 offset:6144
    v_mfma_f32_16x16x32_bf16 v[192:195], v[76:79], v[172:175], v[192:195]
    ds_read_b64_tr_b16 v[64:65], v223 offset:4096
    v_mfma_f32_16x16x32_bf16 v[196:199], v[80:83], v[172:175], v[196:199]
    buffer_load_dwordx4 v[232:235], v249, s[24:27], s14 offen offset:1024 sc1
    ds_read_b64_tr_b16 v[66:67], v223 offset:6144
    s_waitcnt vmcnt(5) lgkmcnt(15)
    v_mfma_f32_16x16x32_bf16 v[184:187], v[84:87], v[176:179], v[184:187]
    ds_read_b64_tr_b16 v[68:69], v220 offset:8192
    ds_read_b64_tr_b16 v[70:71], v220 offset:10240
    v_mfma_f32_16x16x32_bf16 v[188:191], v[88:91], v[176:179], v[188:191]
    ds_read_b64_tr_b16 v[72:73], v221 offset:8192
    v_mfma_f32_16x16x32_bf16 v[192:195], v[92:95], v[176:179], v[192:195]
    ds_read_b64_tr_b16 v[74:75], v221 offset:10240
    v_mfma_f32_16x16x32_bf16 v[196:199], v[96:99], v[176:179], v[196:199]
    s_mov_b32 s14, s16
    buffer_load_dwordx4 v[236:239], v249, s[24:27], s14 offen offset:0 sc1
    ds_read_b64_tr_b16 v[76:77], v222 offset:8192
    s_waitcnt vmcnt(5) lgkmcnt(15)
    v_mfma_f32_16x16x32_bf16 v[184:187], v[100:103], v[180:183], v[184:187]
    ds_read_b64_tr_b16 v[78:79], v222 offset:10240
    ds_read_b64_tr_b16 v[80:81], v223 offset:8192
    v_mfma_f32_16x16x32_bf16 v[188:191], v[104:107], v[180:183], v[188:191]
    ds_read_b64_tr_b16 v[82:83], v223 offset:10240
    v_mfma_f32_16x16x32_bf16 v[192:195], v[108:111], v[180:183], v[192:195]
    ds_read_b64_tr_b16 v[84:85], v220 offset:12288
    v_mfma_f32_16x16x32_bf16 v[196:199], v[112:115], v[180:183], v[196:199]
    buffer_load_dwordx4 v[168:171], v249, s[24:27], s14 offen offset:1024 sc1
    ds_read_b64_tr_b16 v[86:87], v220 offset:14336
    s_waitcnt vmcnt(5) lgkmcnt(15)
    v_mfma_f32_16x16x32_bf16 v[184:187], v[116:119], v[212:215], v[184:187]
    ds_read_b64_tr_b16 v[88:89], v221 offset:12288
    ds_read_b64_tr_b16 v[90:91], v221 offset:14336
    v_mfma_f32_16x16x32_bf16 v[188:191], v[120:123], v[212:215], v[188:191]
    ds_read_b64_tr_b16 v[92:93], v222 offset:12288
    v_mfma_f32_16x16x32_bf16 v[192:195], v[124:127], v[212:215], v[192:195]
    ds_read_b64_tr_b16 v[94:95], v222 offset:14336
    v_mfma_f32_16x16x32_bf16 v[196:199], v[128:131], v[212:215], v[196:199]
    s_add_u32 s14, s14, 2048
    s_cmp_eq_u32 s14, s15
    s_cselect_b32 s14, s1, s14
    buffer_load_dwordx4 v[172:175], v249, s[24:27], s14 offen offset:0 sc1
    ds_read_b64_tr_b16 v[96:97], v223 offset:12288
    s_waitcnt vmcnt(5) lgkmcnt(15)
    v_mfma_f32_16x16x32_bf16 v[184:187], v[132:135], v[12:15], v[184:187]
    ds_read_b64_tr_b16 v[98:99], v223 offset:14336
    ds_read_b64_tr_b16 v[100:101], v220 offset:16384
    v_mfma_f32_16x16x32_bf16 v[188:191], v[136:139], v[12:15], v[188:191]
    ds_read_b64_tr_b16 v[102:103], v220 offset:18432
    v_mfma_f32_16x16x32_bf16 v[192:195], v[140:143], v[12:15], v[192:195]
    ds_read_b64_tr_b16 v[104:105], v221 offset:16384
    v_mfma_f32_16x16x32_bf16 v[196:199], v[144:147], v[12:15], v[196:199]
    buffer_load_dwordx4 v[176:179], v249, s[24:27], s14 offen offset:1024 sc1
    ds_read_b64_tr_b16 v[106:107], v221 offset:18432
    s_waitcnt vmcnt(5) lgkmcnt(15)
    v_mfma_f32_16x16x32_bf16 v[184:187], v[148:151], v[164:167], v[184:187]
    ds_read_b64_tr_b16 v[108:109], v222 offset:16384
    ds_read_b64_tr_b16 v[110:111], v222 offset:18432
    v_mfma_f32_16x16x32_bf16 v[188:191], v[152:155], v[164:167], v[188:191]
    ds_read_b64_tr_b16 v[112:113], v223 offset:16384
    v_mfma_f32_16x16x32_bf16 v[192:195], v[156:159], v[164:167], v[192:195]
    ds_read_b64_tr_b16 v[114:115], v223 offset:18432
    v_mfma_f32_16x16x32_bf16 v[196:199], v[160:163], v[164:167], v[196:199]
    s_add_u32 s14, s14, 2048
    s_cmp_eq_u32 s14, s15
    s_cselect_b32 s14, s1, s14
    buffer_load_dwordx4 v[180:183], v249, s[24:27], s14 offen offset:0 sc1
    ds_read_b64_tr_b16 v[116:117], v220 offset:20480
    s_waitcnt vmcnt(5) lgkmcnt(15)
    v_mfma_f32_16x16x32_bf16 v[184:187], v[20:23], v[232:235], v[184:187]
    ds_read_b64_tr_b16 v[118:119], v220 offset:22528
    ds_read_b64_tr_b16 v[120:121], v221 offset:20480
    v_mfma_f32_16x16x32_bf16 v[188:191], v[24:27], v[232:235], v[188:191]
    ds_read_b64_tr_b16 v[122:123], v221 offset:22528
    v_mfma_f32_16x16x32_bf16 v[192:195], v[28:31], v[232:235], v[192:195]
    ds_read_b64_tr_b16 v[124:125], v222 offset:20480
    v_mfma_f32_16x16x32_bf16 v[196:199], v[32:35], v[232:235], v[196:199]
    buffer_load_dwordx4 v[212:215], v249, s[24:27], s14 offen offset:1024 sc1
    ds_read_b64_tr_b16 v[126:127], v222 offset:22528
    s_waitcnt vmcnt(5) lgkmcnt(15)
    v_mfma_f32_16x16x32_bf16 v[184:187], v[36:39], v[236:239], v[184:187]
    ds_read_b64_tr_b16 v[128:129], v223 offset:20480
    ds_read_b64_tr_b16 v[130:131], v223 offset:22528
    v_mfma_f32_16x16x32_bf16 v[188:191], v[40:43], v[236:239], v[188:191]
    ds_read_b64_tr_b16 v[132:133], v220 offset:24576
    v_mfma_f32_16x16x32_bf16 v[192:195], v[44:47], v[236:239], v[192:195]
    ds_read_b64_tr_b16 v[134:135], v220 offset:26624
    v_mfma_f32_16x16x32_bf16 v[196:199], v[48:51], v[236:239], v[196:199]
    s_add_u32 s14, s14, 2048
    s_cmp_eq_u32 s14, s15
    s_cselect_b32 s14, s1, s14
    buffer_load_dwordx4 v[12:15], v249, s[24:27], s14 offen offset:0 sc1
    ds_read_b64_tr_b16 v[136:137], v221 offset:24576
    s_waitcnt vmcnt(5) lgkmcnt(15)
    v_mfma_f32_16x16x32_bf16 v[184:187], v[52:55], v[168:171], v[184:187]
    ds_read_b64_tr_b16 v[138:139], v221 offset:26624
    ds_read_b64_tr_b16 v[140:141], v222 offset:24576
    v_mfma_f32_16x16x32_bf16 v[188:191], v[56:59], v[168:171], v[188:191]
    ds_read_b64_tr_b16 v[142:143], v222 offset:26624
    v_mfma_f32_16x16x32_bf16 v[192:195], v[60:63], v[168:171], v[192:195]
    ds_read_b64_tr_b16 v[144:145], v223 offset:24576
    v_mfma_f32_16x16x32_bf16 v[196:199], v[64:67], v[168:171], v[196:199]
    buffer_load_dwordx4 v[164:167], v249, s[24:27], s14 offen offset:1024 sc1
    ds_read_b64_tr_b16 v[146:147], v223 offset:26624
    s_waitcnt vmcnt(5) lgkmcnt(15)
    v_mfma_f32_16x16x32_bf16 v[184:187], v[68:71], v[172:175], v[184:187]
    ds_read_b64_tr_b16 v[148:149], v220 offset:28672
    ds_read_b64_tr_b16 v[150:151], v220 offset:30720
    v_mfma_f32_16x16x32_bf16 v[188:191], v[72:75], v[172:175], v[188:191]
    ds_read_b64_tr_b16 v[152:153], v221 offset:28672
    v_mfma_f32_16x16x32_bf16 v[192:195], v[76:79], v[172:175], v[192:195]
    ds_read_b64_tr_b16 v[154:155], v221 offset:30720
    v_mfma_f32_16x16x32_bf16 v[196:199], v[80:83], v[172:175], v[196:199]
    s_add_u32 s14, s14, 2048
    s_cmp_eq_u32 s14, s15
    s_cselect_b32 s14, s1, s14
    buffer_load_dwordx4 v[232:235], v249, s[24:27], s14 offen offset:0 sc1
    ds_read_b64_tr_b16 v[156:157], v222 offset:28672
    s_waitcnt vmcnt(5) lgkmcnt(15)
    v_mfma_f32_16x16x32_bf16 v[184:187], v[84:87], v[176:179], v[184:187]
    ds_read_b64_tr_b16 v[158:159], v222 offset:30720
    ds_read_b64_tr_b16 v[160:161], v223 offset:28672
    v_mfma_f32_16x16x32_bf16 v[188:191], v[88:91], v[176:179], v[188:191]
    ds_read_b64_tr_b16 v[162:163], v223 offset:30720
    v_mfma_f32_16x16x32_bf16 v[192:195], v[92:95], v[176:179], v[192:195]
    ds_read_b64_tr_b16 v[20:21], v220 offset:32768
    v_mfma_f32_16x16x32_bf16 v[196:199], v[96:99], v[176:179], v[196:199]
    buffer_load_dwordx4 v[236:239], v249, s[24:27], s14 offen offset:1024 sc1
    ds_read_b64_tr_b16 v[22:23], v220 offset:34816
    s_waitcnt vmcnt(5) lgkmcnt(15)
    v_mfma_f32_16x16x32_bf16 v[184:187], v[100:103], v[180:183], v[184:187]
    ds_read_b64_tr_b16 v[24:25], v221 offset:32768
    ds_read_b64_tr_b16 v[26:27], v221 offset:34816
    v_mfma_f32_16x16x32_bf16 v[188:191], v[104:107], v[180:183], v[188:191]
    ds_read_b64_tr_b16 v[28:29], v222 offset:32768
    v_mfma_f32_16x16x32_bf16 v[192:195], v[108:111], v[180:183], v[192:195]
    ds_read_b64_tr_b16 v[30:31], v222 offset:34816
    v_mfma_f32_16x16x32_bf16 v[196:199], v[112:115], v[180:183], v[196:199]
    ds_read_b64_tr_b16 v[32:33], v223 offset:32768
    s_waitcnt vmcnt(4) lgkmcnt(15)
    v_mfma_f32_16x16x32_bf16 v[184:187], v[116:119], v[212:215], v[184:187]
    ds_read_b64_tr_b16 v[34:35], v223 offset:34816
    ds_read_b64_tr_b16 v[36:37], v220 offset:36864
    v_mfma_f32_16x16x32_bf16 v[188:191], v[120:123], v[212:215], v[188:191]
    ds_read_b64_tr_b16 v[38:39], v220 offset:38912
    v_mfma_f32_16x16x32_bf16 v[192:195], v[124:127], v[212:215], v[192:195]
    ds_read_b64_tr_b16 v[40:41], v221 offset:36864
    v_mfma_f32_16x16x32_bf16 v[196:199], v[128:131], v[212:215], v[196:199]
    ds_read_b64_tr_b16 v[42:43], v221 offset:38912
    s_waitcnt vmcnt(3) lgkmcnt(15)
    v_mfma_f32_16x16x32_bf16 v[184:187], v[132:135], v[12:15], v[184:187]
    ds_read_b64_tr_b16 v[44:45], v222 offset:36864
    ds_read_b64_tr_b16 v[46:47], v222 offset:38912
    v_mfma_f32_16x16x32_bf16 v[188:191], v[136:139], v[12:15], v[188:191]
    ds_read_b64_tr_b16 v[48:49], v223 offset:36864
    v_mfma_f32_16x16x32_bf16 v[192:195], v[140:143], v[12:15], v[192:195]
    ds_read_b64_tr_b16 v[50:51], v223 offset:38912
    v_mfma_f32_16x16x32_bf16 v[196:199], v[144:147], v[12:15], v[196:199]
    s_waitcnt vmcnt(2) lgkmcnt(15)
    v_mfma_f32_16x16x32_bf16 v[184:187], v[148:151], v[164:167], v[184:187]
    v_mfma_f32_16x16x32_bf16 v[188:191], v[152:155], v[164:167], v[188:191]
    v_mfma_f32_16x16x32_bf16 v[192:195], v[156:159], v[164:167], v[192:195]
    v_mfma_f32_16x16x32_bf16 v[196:199], v[160:163], v[164:167], v[196:199]
    ds_read_b32 v10, v251 offset:4
    s_waitcnt vmcnt(1) lgkmcnt(9)
    v_mfma_f32_16x16x32_bf16 v[184:187], v[20:23], v[232:235], v[184:187]
    v_mfma_f32_16x16x32_bf16 v[188:191], v[24:27], v[232:235], v[188:191]
    v_mfma_f32_16x16x32_bf16 v[192:195], v[28:31], v[232:235], v[192:195]
    v_mfma_f32_16x16x32_bf16 v[196:199], v[32:35], v[232:235], v[196:199]
    s_waitcnt vmcnt(0) lgkmcnt(1)
    v_mfma_f32_16x16x32_bf16 v[184:187], v[36:39], v[236:239], v[184:187]
    v_mfma_f32_16x16x32_bf16 v[188:191], v[40:43], v[236:239], v[188:191]
    v_mfma_f32_16x16x32_bf16 v[192:195], v[44:47], v[236:239], v[192:195]
    v_mfma_f32_16x16x32_bf16 v[196:199], v[48:51], v[236:239], v[196:199]
    s_branch B_epi
B_half:
    s_add_u32 s14, s14, 2048
    s_cmp_eq_u32 s14, s15
    s_cselect_b32 s14, s1, s14
    buffer_load_dwordx4 v[164:167], v249, s[24:27], s14 offen offset:0 sc1
    buffer_load_dwordx4 v[232:235], v249, s[24:27], s14 offen offset:1024 sc1
    s_mov_b32 s14, s16
    buffer_load_dwordx4 v[236:239], v249, s[24:27], s14 offen offset:0 sc1
    s_cmp_lg_u32 s48, 6
    s_cbranch_scc1 E_end
    s_setprio 3
E_poll:
    s_mov_b32 exec_hi, 0x0fffffff
    buffer_load_dword v17, v203, s[24:27], s100 offen sc1
    s_mov_b32 exec_hi, -1
    buffer_load_dwordx3 v[224:226], v4, s[24:27], s58 offen sc1
    buffer_load_dwordx3 v[228:230], v4, s[24:27], s59 offen sc1
    buffer_load_dwordx3 v[240:242], v4, s[24:27], s60 offen sc1
    buffer_load_dwordx3 v[244:246], v4, s[24:27], s12 offen sc1
    buffer_load_dwordx3 v[208:210], v4, s[24:27], s13 offen sc1
E_chk:
    s_waitcnt vmcnt(5)
    v_cmp_ne_u32 vcc, s54, v17
    s_lshl_b64 vcc, vcc, 4
    s_cbranch_scc0 E_go
    s_sleep 1
    s_sub_u32 s3, s3, 1
    s_cbranch_scc0 E_poll
    s_mov_b32 s3, 0
E_go:
    s_waitcnt vmcnt(4)
    s_waitcnt vmcnt(3)
    v_add_f32 v252, v224, v228
    v_add_f32 v253, v225, v229
    v_add_f32 v254, v226, v230
    v_lshlrev_b32 v224, 16, v224
    v_lshlrev_b32 v225, 16, v225
    v_lshlrev_b32 v226, 16, v226
    v_lshlrev_b32 v228, 16, v228
    v_lshlrev_b32 v229, 16, v229
    v_lshlrev_b32 v230, 16, v230
    v_add_f32 v224, v224, v228
    v_add_f32 v225, v225, v229
    v_add_f32 v226, v226, v230
    s_waitcnt vmcnt(2)
    v_add_f32 v252, v252, v240
    v_add_f32 v253, v253, v241
    v_add_f32 v254, v254, v242
    v_lshlrev_b32 v240, 16, v240
    v_lshlrev_b32 v241, 16, v241
    v_lshlrev_b32 v242, 16, v242
    v_add_f32 v224, v224, v240
    v_add_f32 v225, v225, v241
    v_add_f32 v226, v226, v242
    s_waitcnt vmcnt(1)
    v_add_f32 v252, v252, v244
    v_add_f32 v253, v253, v245
    v_add_f32 v254, v254, v246
    v_lshlrev_b32 v244, 16, v244
    v_lshlrev_b32 v245, 16, v245
    v_lshlrev_b32 v246, 16, v246
    v_add_f32 v224, v224, v244
    v_add_f32 v225, v225, v245
    v_add_f32 v226, v226, v246
    s_waitcnt vmcnt(0)
    v_add_f32 v252, v252, v208
    v_add_f32 v253, v253, v209
    v_add_f32 v254, v254, v210
    v_lshlrev_b32 v208, 16, v208
    v_lshlrev_b32 v209, 16, v209
    v_lshlrev_b32 v210, 16, v210
    v_add_f32 v224, v224, v208
    v_add_f32 v225, v225, v209
    v_add_f32 v226, v226, v210
    v_permlane32_swap_b32 v224, v252
    v_permlane32_swap_b32 v225, v253
    v_permlane32_swap_b32 v226, v254
    v_add_f32 v224, v224, v252
    v_add_f32 v225, v225, v253
    v_add_f32 v226, v226, v254
    v_rsq_f32 v252, v224
    v_rsq_f32 v253, v225
    v_rsq_f32 v254, v226
    v_permlane32_swap_b32 v252, v228
    v_permlane32_swap_b32 v253, v229
    v_permlane32_swap_b32 v254, v230
    v_mul_f32 v224, v224, v228
    v_mul_f32 v225, v225, v229
    v_mul_f32 v226, v226, v230
    v_and_or_b32 v252, v224, v204, v8
    v_and_or_b32 v253, v225, v205, v9
    v_and_or_b32 v254, v226, v206, v10
    v_max3_i32 v6, v252, v253, v254
    s_nop 1
    v_max_i32_dpp v6, v6, v6 row_ror:1 row_mask:0xf bank_mask:0xf
    s_nop 1
    v_max_i32_dpp v6, v6, v6 row_ror:2 row_mask:0xf bank_mask:0xf
    s_nop 1
    v_max_i32_dpp v6, v6, v6 row_ror:4 row_mask:0xf bank_mask:0xf
    s_nop 1
    v_max_i32_dpp v6, v6, v6 row_ror:8 row_mask:0xf bank_mask:0xf
    v_mov_b32 v5, v6
    s_nop 1
    v_permlane16_swap_b32 v6, v5
    s_mov_b64 exec, 0xffff
    s_cmp_lg_u32 s51, 0
    v_max3_i32 v6, v6, v5, 1
    s_cbranch_scc1 E_np
    buffer_store_dwordx2 v[6:7], v11, s[24:27], s45 offen sc1
E_np:
    ds_write_b32 v251, v6 offset:4
    s_mov_b64 exec, -1
E_end:
    s_waitcnt vmcnt(8) lgkmcnt(15)
    v_mfma_f32_16x16x32_bf16 v[184:187], v[52:55], v[168:171], v[184:187]
    v_mfma_f32_16x16x32_bf16 v[188:191], v[56:59], v[168:171], v[188:191]
    v_mfma_f32_16x16x32_bf16 v[192:195], v[60:63], v[168:171], v[192:195]
    v_mfma_f32_16x16x32_bf16 v[196:199], v[64:67], v[168:171], v[196:199]
    s_waitcnt vmcnt(7) lgkmcnt(15)
    v_mfma_f32_16x16x32_bf16 v[184:187], v[68:71], v[172:175], v[184:187]
    v_mfma_f32_16x16x32_bf16 v[188:191], v[72:75], v[172:175], v[188:191]
    v_mfma_f32_16x16x32_bf16 v[192:195], v[76:79], v[172:175], v[192:195]
    v_mfma_f32_16x16x32_bf16 v[196:199], v[80:83], v[172:175], v[196:199]
    ds_read_b32 v10, v251 offset:4
    s_waitcnt vmcnt(6) lgkmcnt(15)
    v_mfma_f32_16x16x32_bf16 v[184:187], v[84:87], v[176:179], v[184:187]
    v_mfma_f32_16x16x32_bf16 v[188:191], v[88:91], v[176:179], v[188:191]
    v_mfma_f32_16x16x32_bf16 v[192:195], v[92:95], v[176:179], v[192:195]
    v_mfma_f32_16x16x32_bf16 v[196:199], v[96:99], v[176:179], v[196:199]
    s_waitcnt lgkmcnt(0)
    v_and_b32 v9, 0xfff, v10
    s_nop 0
    v_readfirstlane_b32 s64, v9
    s_lshr_b32 s64, s64, 4
    s_mul_i32 s65, s53, 6
    s_add_u32 s65, s65, s56
    s_cmp_lg_u32 s64, s65
    s_cbranch_scc1 B_nb
    s_setprio 3
B_nb:
    s_waitcnt vmcnt(5) lgkmcnt(15)
    v_mfma_f32_16x16x32_bf16 v[184:187], v[100:103], v[180:183], v[184:187]
    v_mfma_f32_16x16x32_bf16 v[188:191], v[104:107], v[180:183], v[188:191]
    v_mfma_f32_16x16x32_bf16 v[192:195], v[108:111], v[180:183], v[192:195]
    v_mfma_f32_16x16x32_bf16 v[196:199], v[112:115], v[180:183], v[196:199]
    s_waitcnt vmcnt(4) lgkmcnt(15)
    v_mfma_f32_16x16x32_bf16 v[184:187], v[116:119], v[212:215], v[184:187]
    v_mfma_f32_16x16x32_bf16 v[188:191], v[120:123], v[212:215], v[188:191]
    v_mfma_f32_16x16x32_bf16 v[192:195], v[124:127], v[212:215], v[192:195]
    v_mfma_f32_16x16x32_bf16 v[196:199], v[128:131], v[212:215], v[196:199]
    s_waitcnt vmcnt(3) lgkmcnt(15)
    v_mfma_f32_16x16x32_bf16 v[184:187], v[132:135], v[12:15], v[184:187]
    v_mfma_f32_16x16x32_bf16 v[188:191], v[136:139], v[12:15], v[188:191]
    v_mfma_f32_16x16x32_bf16 v[192:195], v[140:143], v[12:15], v[192:195]
    v_mfma_f32_16x16x32_bf16 v[196:199], v[144:147], v[12:15], v[196:199]
    s_waitcnt vmcnt(2) lgkmcnt(15)
    v_mfma_f32_16x16x32_bf16 v[184:187], v[148:151], v[164:167], v[184:187]
    v_mfma_f32_16x16x32_bf16 v[188:191], v[152:155], v[164:167], v[188:191]
    v_mfma_f32_16x16x32_bf16 v[192:195], v[156:159], v[164:167], v[192:195]
    v_mfma_f32_16x16x32_bf16 v[196:199], v[160:163], v[164:167], v[196:199]
    s_waitcnt vmcnt(1) lgkmcnt(9)
    v_mfma_f32_16x16x32_bf16 v[184:187], v[20:23], v[232:235], v[184:187]
    v_mfma_f32_16x16x32_bf16 v[188:191], v[24:27], v[232:235], v[188:191]
    v_mfma_f32_16x16x32_bf16 v[192:195], v[28:31], v[232:235], v[192:195]
    v_mfma_f32_16x16x32_bf16 v[196:199], v[32:35], v[232:235], v[196:199]
    s_cmp_eq_u32 s48, 6
    s_cbranch_scc1 B_w6
    s_waitcnt vmcnt(0)
B_w6:
    s_waitcnt lgkmcnt(1)
    v_mfma_f32_16x16x32_bf16 v[184:187], v[36:39], v[236:239], v[184:187]
    v_mfma_f32_16x16x32_bf16 v[188:191], v[40:43], v[236:239], v[188:191]
    v_mfma_f32_16x16x32_bf16 v[192:195], v[44:47], v[236:239], v[192:195]
    v_mfma_f32_16x16x32_bf16 v[196:199], v[48:51], v[236:239], v[196:199]
    s_lshl_b32 s61, s56, 12
    s_add_u32 s61, s61, 135168
    v_add_u32 v16, s61, v202
    s_lshl_b32 s61, s56, 2
    s_add_u32 s61, s61, 160760
    v_mov_b32 v18, s61
    s_cmp_eq_u32 s101, 0
    s_cbranch_scc1 B_rx0
B_pf:
    ds_read_b32 v19, v18
    s_waitcnt lgkmcnt(0)
    v_cmp_eq_u32 vcc, 0, v19
    s_cbranch_vccz B_pg
    s_sleep 1
    s_sub_u32 s3, s3, 1
    s_cbranch_scc0 B_pf
    s_mov_b32 s3, 0
B_pg:
    ds_write_b128 v16, v[184:187] offset:0
    ds_write_b128 v16, v[188:191] offset:1024
    ds_write_b128 v16, v[192:195] offset:2048
    ds_write_b128 v16, v[196:199] offset:3072
    v_mov_b32 v19, 2
    s_waitcnt lgkmcnt(0)
    ds_write_b32 v18, v19
    s_branch L_fin
B_rx0:
B_rx:
    ds_read_b32 v19, v18
    s_waitcnt lgkmcnt(0)
    v_cmp_ne_u32 vcc, 2, v19
    s_cbranch_vccz B_rd
    s_sub_u32 s3, s3, 1
    s_cbranch_scc0 B_rx
    s_mov_b32 s3, 0
B_rd:
    ds_read_b32 v10, v251 offset:4
    ds_read_b128 v[100:103], v16 offset:0
    ds_read_b128 v[104:107], v16 offset:1024
    ds_read_b128 v[108:111], v16 offset:2048
    ds_read_b128 v[112:115], v16 offset:3072
    s_waitcnt lgkmcnt(0)
    v_add_f32 v184, v184, v100
    v_add_f32 v185, v185, v101
    v_add_f32 v186, v186, v102
    v_add_f32 v187, v187, v103
    v_add_f32 v188, v188, v104
    v_add_f32 v189, v189, v105
    v_add_f32 v190, v190, v106
    v_add_f32 v191, v191, v107
    v_add_f32 v192, v192, v108
    v_add_f32 v193, v193, v109
    v_add_f32 v194, v194, v110
    v_add_f32 v195, v195, v111
    v_add_f32 v196, v196, v112
    v_add_f32 v197, v197, v113
    v_add_f32 v198, v198, v114
    v_add_f32 v199, v199, v115
B_epi:
    s_waitcnt lgkmcnt(0)
    v_cmp_eq_u32 vcc, 0, v10
    v_and_b32 v10, 0xfff, v10
    s_cbranch_vccnz B_ew
B_eg:
    v_cmp_eq_u32 s[68:69], v10, v226
    v_add_u32 v10, s54, v10
    v_mov_b32 v16, 0x3f803f80
    v_mov_b32 v15, s54
    s_add_u32 s63, s1, 20480
    s_lshl_b32 s64, s51, 8
    s_add_u32 s64, s64, s63
    v_cvt_pk_bf16_f32 v52, v184, v185
    v_cvt_pk_bf16_f32 v53, v186, v187
    v_cvt_pk_bf16_f32 v54, v188, v189
    v_cvt_pk_bf16_f32 v55, v190, v191
    v_cvt_pk_bf16_f32 v56, v192, v193
    v_cvt_pk_bf16_f32 v57, v194, v195
    v_cvt_pk_bf16_f32 v58, v196, v197
    v_cvt_pk_bf16_f32 v59, v198, v199
    s_cmp_eq_u64 s[68:69], 0
    s_cbranch_scc1 B_np2
    s_mov_b64 exec, s[68:69]
    ds_write_b128 v228, v[52:55] offset:0
    ds_write_b128 v228, v[56:59] offset:16
    s_mov_b64 exec, -1
    ds_read_b64 v[8:9], v252
    s_waitcnt lgkmcnt(0)
    buffer_store_dwordx3 v[8:10], v224, s[24:27], s44 offen sc1
B_np2:
    v_mfma_f32_16x16x32_bf16 v[12:15], v[240:243], v[52:55], 0
    v_mfma_f32_16x16x32_bf16 v[12:15], v[244:247], v[56:59], v[12:15]
    v_dot2_f32_bf16 v16, v52, v52, 0
    v_dot2_f32_bf16 v17, v53, v53, 0
    v_dot2_f32_bf16 v16, v54, v54, v16
    v_dot2_f32_bf16 v17, v55, v55, v17
    v_dot2_f32_bf16 v16, v56, v56, v16
    v_dot2_f32_bf16 v17, v57, v57, v17
    v_dot2_f32_bf16 v16, v58, v58, v16
    v_dot2_f32_bf16 v17, v59, v59, v17
    s_nop 2
    v_add_f32 v16, v16, v17
    v_mov_b32 v17, v16
    s_nop 1
    v_permlane32_swap_b32 v16, v17
    v_add_f32 v16, v16, v17
    v_mov_b32 v17, v16
    v_mov_b32 v15, s54
    s_nop 0
    v_permlane16_swap_b32 v16, v17
    v_add_f32 v13, v16, v17
    s_mov_b64 exec, 0xffff
    s_cmp_eq_u32 s49, 0
    s_cbranch_scc1 sts_9
    buffer_store_dwordx4 v[12:15], v202, s[24:27], s64 offen
std_10:
    s_mov_b64 exec, -1
    v_lshlrev_b32 v36, 16, v52
    v_and_b32 v37, s47, v52
    v_lshlrev_b32 v38, 16, v53
    v_and_b32 v39, s47, v53
    v_lshlrev_b32 v40, 16, v54
    v_and_b32 v41, s47, v54
    v_lshlrev_b32 v42, 16, v55
    v_and_b32 v43, s47, v55
    v_lshlrev_b32 v44, 16, v56
    v_and_b32 v45, s47, v56
    v_lshlrev_b32 v46, 16, v57
    v_and_b32 v47, s47, v57
    v_lshlrev_b32 v48, 16, v58
    v_and_b32 v49, s47, v58
    v_lshlrev_b32 v50, 16, v59
    v_and_b32 v51, s47, v59
    v_mov_b32 v108, 0
    v_mov_b32 v109, 0
    v_mov_b32 v110, 0
    v_mov_b32 v111, s54
    v_mov_b32 v11, s54
    v_mov_b32 v5, 1
    v_lshlrev_b32 v7, 11, v200
    s_add_u32 s45, s45, 32768
    s_sub_u32 s44, s44, 131072
    buffer_load_dwordx4 v[100:103], v202, s[24:27], s63 offen offset:0 sc1
    buffer_load_dwordx4 v[104:107], v202, s[24:27], s63 offen offset:1024 sc1
    s_mov_b32 exec_hi, 0
    buffer_load_dwordx4 v[108:111], v202, s[24:27], s63 offen offset:2048 sc1
    s_mov_b32 exec_hi, -1
    s_branch S_pw
S_poll:
    s_mov_b64 exec, s[58:59]
    s_cbranch_execz S_r0
    buffer_load_dwordx4 v[100:103], v202, s[24:27], s63 offen offset:0 sc1
S_r0:
    s_mov_b64 exec, s[64:65]
    s_cbranch_execz S_r1
    buffer_load_dwordx4 v[104:107], v202, s[24:27], s63 offen offset:1024 sc1
S_r1:
    s_mov_b64 exec, s[66:67]
    s_cbranch_execz S_r2
    buffer_load_dwordx4 v[108:111], v202, s[24:27], s63 offen offset:2048 sc1
S_r2:
    s_mov_b64 exec, -1
S_pw:
    s_waitcnt vmcnt(0)
    v_cmp_ne_u32 s[58:59], s54, v103
    v_cmp_ne_u32 s[64:65], s54, v107
    v_cmp_ne_u32 s[66:67], s54, v111
    s_or_b64 vcc, s[58:59], s[64:65]
    s_or_b64 vcc, vcc, s[66:67]
    s_cbranch_scc0 S_got
    s_sub_u32 s3, s3, 1
    s_cbranch_scc0 S_poll
    s_mov_b32 s3, 0
S_got:
    v_add_f32 v12, v100, v104
    v_add_f32 v13, v101, v105
    v_add_f32 v14, v102, v106
    v_add_f32 v12, v12, v108
    v_add_f32 v13, v13, v109
    v_add_f32 v14, v14, v110
    v_mov_b32 v17, v12
    v_mov_b32 v18, v13
    v_mov_b32 v19, v14
    v_permlane32_swap_b32 v17, v12
    v_permlane32_swap_b32 v18, v13
    v_permlane32_swap_b32 v19, v14
    v_add_f32 v12, v12, v17
    v_add_f32 v13, v13, v18
    v_add_f32 v14, v14, v19
    v_mov_b32 v17, v12
    v_mov_b32 v18, v13
    v_mov_b32 v19, v14
    v_permlane16_swap_b32 v17, v12
    v_permlane16_swap_b32 v18, v13
    v_permlane16_swap_b32 v19, v14
    v_add_f32 v12, v12, v17
    v_add_f32 v13, v13, v18
    v_add_f32 v14, v14, v19
    v_mul_f32 v12, 0x3acccccd, v12
    v_mul_f32 v13, 0x3acccccd, v13
    v_fma_f32 v13, -v12, v12, v13
    v_max_f32 v13, 0, v13
    v_cvt_pk_bf16_f32 v13, v13, v13
    v_and_b32 v13, 0xffff0000, v13
    v_add_f32 v13, 0x3727c5ac, v13
    v_cvt_pk_bf16_f32 v13, v13, v13
    v_and_b32 v13, 0xffff0000, v13
    v_sqrt_f32 v13, v13
    v_cvt_pk_bf16_f32 v12, v12, v12
    v_and_b32 v12, 0xffff0000, v12
    v_cvt_pk_bf16_f32 v13, v13, v13
    v_and_b32 v13, 0xffff0000, v13
    v_rcp_f32 v13, v13
    v_fma_f32 v14, -v12, v248, v14
    v_mul_f32 v14, v14, v13
    v_ashrrev_i32 v6, 31, v14
    v_or_b32 v6, 0x80000000, v6
    v_xor_b32 v6, v6, v14
    v_and_b32 v6, 0xfffff000, v6
    v_or_b32 v6, v6, v226
    s_and_b64 exec, s[4:5], 0xffff
    ds_max_u32 v251, v6 offset:12
    s_cmp_lg_u32 s51, 0
    s_cbranch_scc1 S_nk
    s_mov_b64 exec, 1
    ds_add_rtn_u32 v5, v251, v5 offset:20
    s_mov_b64 exec, 0xffff
    ds_read_b32 v10, v251 offset:12
    s_waitcnt lgkmcnt(0)
    v_readfirstlane_b32 s64, v5
    s_cmp_lg_u32 s64, 5
    s_cbranch_scc1 S_nk
    buffer_store_dwordx2 v[10:11], v7, s[24:27], s45 offen sc1
S_nk:
    s_mov_b64 exec, -1
    s_and_b64 s[68:69], s[68:69], s[4:5]
    s_cbranch_scc0 S_ne
    s_call_b64 s[98:99], S_ln
    s_mov_b64 exec, s[68:69]
    buffer_store_dwordx4 v[60:63], v225, s[40:43], 0 offen offset:0 sc1
    buffer_store_dwordx4 v[64:67], v225, s[40:43], 0 offen offset:64 sc1
    s_mov_b64 exec, -1
S_ne:
    s_waitcnt lgkmcnt(0)
    s_barrier
    ds_read_b32 v10, v251 offset:12
    s_waitcnt lgkmcnt(0)
S_nc:
    v_cmp_eq_u32 s[60:61], v10, v6
    s_cmp_lg_u64 s[68:69], 0
    s_cbranch_scc1 S_l2
    s_call_b64 s[98:99], S_ln
S_l2:
    s_and_b64 s[60:61], s[60:61], s[4:5]
    s_cbranch_scc0 S_out
    s_andn2_b64 exec, s[60:61], s[68:69]
    s_cbranch_execz S_l3
    buffer_store_dwordx4 v[60:63], v225, s[40:43], 0 offen offset:0 sc1
    buffer_store_dwordx4 v[64:67], v225, s[40:43], 0 offen offset:64 sc1
S_l3:
    s_mov_b64 exec, s[60:61]
    ds_write_b128 v228, v[52:55] offset:0
    ds_write_b128 v228, v[56:59] offset:16
    s_mov_b64 exec, -1
    ds_read_b64 v[8:9], v252
    v_and_b32 v10, 0xfff, v10
    v_add_u32 v10, s54, v10
    s_mov_b64 exec, 0xffff
    s_waitcnt vmcnt(0) lgkmcnt(0)
    buffer_store_dwordx3 v[8:10], v224, s[24:27], s44 offen sc1
S_out:
    s_nor_b64 exec, s[60:61], s[68:69]
    buffer_store_dwordx4 v[60:63], v225, s[40:43], 0 offen offset:0 sc1
    buffer_store_dwordx4 v[64:67], v225, s[40:43], 0 offen offset:64 sc1
    s_mov_b64 exec, -1
    s_branch L_fin
S_ln:
    v_pk_add_f32 v[20:21], v[36:37], v[12:13] op_sel_hi:[1,0] neg_lo:[0,1] neg_hi:[0,1]
    v_pk_add_f32 v[22:23], v[38:39], v[12:13] op_sel_hi:[1,0] neg_lo:[0,1] neg_hi:[0,1]
    v_pk_add_f32 v[24:25], v[40:41], v[12:13] op_sel_hi:[1,0] neg_lo:[0,1] neg_hi:[0,1]
    v_pk_add_f32 v[26:27], v[42:43], v[12:13] op_sel_hi:[1,0] neg_lo:[0,1] neg_hi:[0,1]
    v_pk_add_f32 v[28:29], v[44:45], v[12:13] op_sel_hi:[1,0] neg_lo:[0,1] neg_hi:[0,1]
    v_pk_add_f32 v[30:31], v[46:47], v[12:13] op_sel_hi:[1,0] neg_lo:[0,1] neg_hi:[0,1]
    v_pk_add_f32 v[32:33], v[48:49], v[12:13] op_sel_hi:[1,0] neg_lo:[0,1] neg_hi:[0,1]
    v_pk_add_f32 v[34:35], v[50:51], v[12:13] op_sel_hi:[1,0] neg_lo:[0,1] neg_hi:[0,1]
    v_cvt_pk_bf16_f32 v60, v20, v21
    v_cvt_pk_bf16_f32 v61, v22, v23
    v_cvt_pk_bf16_f32 v62, v24, v25
    v_cvt_pk_bf16_f32 v63, v26, v27
    v_cvt_pk_bf16_f32 v64, v28, v29
    v_cvt_pk_bf16_f32 v65, v30, v31
    v_cvt_pk_bf16_f32 v66, v32, v33
    v_cvt_pk_bf16_f32 v67, v34, v35
    v_lshlrev_b32 v20, 16, v60
    v_and_b32 v21, s47, v60
    v_lshlrev_b32 v22, 16, v61
    v_and_b32 v23, s47, v61
    v_lshlrev_b32 v24, 16, v62
    v_and_b32 v25, s47, v62
    v_lshlrev_b32 v26, 16, v63
    v_and_b32 v27, s47, v63
    v_lshlrev_b32 v28, 16, v64
    v_and_b32 v29, s47, v64
    v_lshlrev_b32 v30, 16, v65
    v_and_b32 v31, s47, v65
    v_lshlrev_b32 v32, 16, v66
    v_and_b32 v33, s47, v66
    v_lshlrev_b32 v34, 16, v67
    v_and_b32 v35, s47, v67
    v_pk_mul_f32 v[20:21], v[20:21], v[12:13] op_sel:[0,1]
    v_pk_mul_f32 v[22:23], v[22:23], v[12:13] op_sel:[0,1]
    v_pk_mul_f32 v[24:25], v[24:25], v[12:13] op_sel:[0,1]
    v_pk_mul_f32 v[26:27], v[26:27], v[12:13] op_sel:[0,1]
    v_pk_mul_f32 v[28:29], v[28:29], v[12:13] op_sel:[0,1]
    v_pk_mul_f32 v[30:31], v[30:31], v[12:13] op_sel:[0,1]
    v_pk_mul_f32 v[32:33], v[32:33], v[12:13] op_sel:[0,1]
    v_pk_mul_f32 v[34:35], v[34:35], v[12:13] op_sel:[0,1]
    v_cvt_pk_bf16_f32 v60, v20, v21
    v_cvt_pk_bf16_f32 v61, v22, v23
    v_cvt_pk_bf16_f32 v62, v24, v25
    v_cvt_pk_bf16_f32 v63, v26, v27
    v_cvt_pk_bf16_f32 v64, v28, v29
    v_cvt_pk_bf16_f32 v65, v30, v31
    v_cvt_pk_bf16_f32 v66, v32, v33
    v_cvt_pk_bf16_f32 v67, v34, v35
    v_lshlrev_b32 v20, 16, v60
    v_and_b32 v21, s47, v60
    v_lshlrev_b32 v22, 16, v61
    v_and_b32 v23, s47, v61
    v_lshlrev_b32 v24, 16, v62
    v_and_b32 v25, s47, v62
    v_lshlrev_b32 v26, 16, v63
    v_and_b32 v27, s47, v63
    v_lshlrev_b32 v28, 16, v64
    v_and_b32 v29, s47, v64
    v_lshlrev_b32 v30, 16, v65
    v_and_b32 v31, s47, v65
    v_lshlrev_b32 v32, 16, v66
    v_and_b32 v33, s47, v66
    v_lshlrev_b32 v34, 16, v67
    v_and_b32 v35, s47, v67
    v_pk_add_f32 v[20:21], v[20:21], v[36:37]
    v_pk_add_f32 v[22:23], v[22:23], v[38:39]
    v_pk_add_f32 v[24:25], v[24:25], v[40:41]
    v_pk_add_f32 v[26:27], v[26:27], v[42:43]
    v_pk_add_f32 v[28:29], v[28:29], v[44:45]
    v_pk_add_f32 v[30:31], v[30:31], v[46:47]
    v_pk_add_f32 v[32:33], v[32:33], v[48:49]
    v_pk_add_f32 v[34:35], v[34:35], v[50:51]
    v_cvt_pk_bf16_f32 v60, v20, v21
    v_cvt_pk_bf16_f32 v61, v22, v23
    v_cvt_pk_bf16_f32 v62, v24, v25
    v_cvt_pk_bf16_f32 v63, v26, v27
    v_cvt_pk_bf16_f32 v64, v28, v29
    v_cvt_pk_bf16_f32 v65, v30, v31
    v_cvt_pk_bf16_f32 v66, v32, v33
    v_cvt_pk_bf16_f32 v67, v34, v35
    v_permlane16_swap_b32 v60, v62
    v_permlane16_swap_b32 v61, v63
    v_permlane16_swap_b32 v64, v66
    v_permlane16_swap_b32 v65, v67
    s_setpc_b64 s[98:99]
L_fin:
L_end:
    s_endpgm
AT_mask:
    v_mov_b32 v17, 0xf149f2ca
    v_cmp_le_i32 vcc, 8, v212
    s_nop 1
    v_cndmask_b32 v60, v17, v60, vcc
    v_cmp_le_i32 vcc, 7, v212
    s_nop 1
    v_cndmask_b32 v61, v17, v61, vcc
    v_cmp_le_i32 vcc, 6, v212
    s_nop 1
    v_cndmask_b32 v62, v17, v62, vcc
    v_cmp_le_i32 vcc, 5, v212
    s_nop 1
    v_cndmask_b32 v63, v17, v63, vcc
    v_cmp_le_i32 vcc, 4, v212
    s_nop 1
    v_cndmask_b32 v64, v17, v64, vcc
    v_cmp_le_i32 vcc, 3, v212
    s_nop 1
    v_cndmask_b32 v65, v17, v65, vcc
    v_cmp_le_i32 vcc, 2, v212
    s_nop 1
    v_cndmask_b32 v66, v17, v66, vcc
    v_cmp_le_i32 vcc, 1, v212
    s_nop 1
    v_cndmask_b32 v67, v17, v67, vcc
    v_cmp_le_i32 vcc, 0, v212
    s_nop 1
    v_cndmask_b32 v68, v17, v68, vcc
    v_cmp_le_i32 vcc, -1, v212
    s_nop 1
    v_cndmask_b32 v69, v17, v69, vcc
    v_cmp_le_i32 vcc, -2, v212
    s_nop 1
    v_cndmask_b32 v70, v17, v70, vcc
    v_cmp_le_i32 vcc, -3, v212
    s_nop 1
    v_cndmask_b32 v71, v17, v71, vcc
    s_branch AT_nomask
sts_1:
    buffer_store_dwordx4 v[80:83], v213, s[24:27], s12 offen offset:0 sc1
    buffer_store_dwordx4 v[84:87], v213, s[24:27], s12 offen offset:512 sc1
    s_branch std_2
AT_vs:
    ds_read_b32 v17, v251 offset:8
    s_sub_u32 s3, s3, 1
    s_cbranch_scc0 AT_vc
    s_mov_b32 s3, 0
    s_branch AT_vg
sts_3:
    buffer_store_dwordx4 v[204:207], v249, s[24:27], s22 offen offset:0 sc1
    buffer_store_dwordx4 v[208:211], v249, s[24:27], s22 offen offset:1024 sc1
    s_branch std_4
sts_5:
    buffer_store_short_d16_hi v20, v164, s[24:27], s65 offen sc1
    s_branch std_6
sts_7:
    buffer_store_dword v79, v203, s[24:27], s23 offen sc1
    s_branch std_8
B_ew:
    s_sleep 1
    ds_read_b32 v10, v251 offset:4
    s_sub_u32 s3, s3, 1
    s_cbranch_scc0 B_epi
    s_mov_b32 s3, 0
    s_waitcnt lgkmcnt(0)
    s_branch B_eg
sts_9:
    buffer_store_dwordx4 v[12:15], v202, s[24:27], s64 offen sc1
    s_branch std_10
LD_cont:
    v_and_b32 v0, 63, v0
    s_mov_b32 s3, 0x40000
    s_mov_b32 s47, 0xffff0000
    s_mov_b32 s26, 7340032
    s_mov_b32 s27, 0x00020000
    s_mov_b32 s38, 819200
    s_mov_b32 s39, 0x00020000
    s_mov_b32 s42, 2621440
    s_mov_b32 s43, 0x00020000
    s_sub_u32 s52, s51, 5
    s_cselect_b32 s52, s51, s52
    s_buffer_load_dword s54, s[24:27], 0
    v_lshl_add_u32 v4, s60, 3, v1
    v_mul_u32_u24 v5, 1280, v4
    v_lshlrev_b32 v7, 1, v2
    v_bitop3_b32 v7, v0, 7, v7 bitop3:0x6a
    v_lshl_add_u32 v5, v7, 4, v5
    v_lshl_add_u32 v16, s51, 7, v5
    s_lshl_b32 s46, s53, 11
    s_add_u32 s46, s46, 81920
    s_mul_i32 s62, s60, 24
    v_add_u32 v17, s62, v0
    v_lshlrev_b32 v18, 4, v17
    v_cmp_gt_u32 vcc, 24, v0
    v_add_u32 v19, 72, v0
    v_lshlrev_b32 v19, 4, v19
    v_cndmask_b32 v18, v19, v18, vcc
    s_lshl_b32 s62, s51, 2
    s_add_u32 s62, s62, s60
    s_lshl_b32 s62, s62, 8
    s_sub_u32 s62, s62, s46
    s_add_u32 s62, s62, 1243488
    v_add_u32 v19, s62, v19
    v_cmp_lt_u32 vcc, 33, v0
    s_nop 1
    v_cndmask_b32 v18, v18, v19, vcc
    v_cmp_lt_u32 vcc, 49, v0
    s_nop 1
    v_cndmask_b32 v18, v18, 2.0, vcc
    s_cmp_eq_u32 s60, 0
    s_cselect_b32 s62, 24, 0
    v_cmp_gt_u32 vcc, s62, v0
    s_nop 1
    v_cndmask_b32 v10, v10, 2.0, vcc
    v_mov_b32 v28, 0
    v_mov_b32 v29, 0
    v_mov_b32 v30, 0
    v_mov_b32 v31, 0
    s_lshl_b32 s62, s60, 6
    v_add_u32 v4, s62, v0
    v_lshlrev_b32 v35, 4, v4
    v_add_u32 v35, 135168, v35
    ds_write_b128 v35, v[28:31] offset:0
    ds_write_b128 v35, v[28:31] offset:4096
    ds_write_b128 v35, v[28:31] offset:8192
    ds_write_b128 v35, v[28:31] offset:12288
    ds_write_b128 v35, v[28:31] offset:16384
    ds_write_b128 v35, v[28:31] offset:20480
    v_lshrrev_b32 v5, 1, v4
    v_min_u32 v5, 61, v5
    v_mul_u32_u24 v5, 400, v5
    v_and_b32 v6, 1, v4
    v_lshl_add_u32 v5, v6, 4, v5
    v_add_u32 v5, 110624, v5
    ds_write_b128 v5, v[28:31]
    v_mov_b32 v6, 159776
    ds_write_b64 v6, v[28:29]
    v_and_b32 v4, 31, v0
    v_lshlrev_b32 v5, 7, v4
    s_lshl_b32 s62, s51, 11
    v_add_u32 v6, s62, v5
    s_lshl_b32 s62, s51, 8
    s_add_u32 s62, s62, 17408
    v_add_u32 v7, s62, v5
    v_cmp_lt_u32 vcc, 23, v4
    s_nop 1
    v_cndmask_b32 v6, v6, v7, vcc
    v_and_b32 v7, 128, v5
    v_add_u32 v7, 23040, v7
    v_cmp_lt_u32 vcc, 25, v4
    s_nop 1
    v_cndmask_b32 v6, v6, v7, vcc
    v_lshrrev_b32 v7, 5, v0
    v_mul_u32_u24 v7, 24320, v7
    v_add_u32 v36, v6, v7
    s_mov_b32 vcc_hi, 0xfcff0000
    s_cmp_eq_u32 s60, 0
    s_cselect_b32 vcc_lo, 0xf0ff5555, vcc_hi
    v_cndmask_b32 v36, v36, 2.0, vcc
    s_waitcnt lgkmcnt(0)
    s_add_u32 s54, s54, 2654435761
    s_lshl_b32 s62, s60, 10
    s_add_u32 s62, s62, 36864
    s_add_u32 s63, s51, 3
    s_sub_u32 s61, s63, 10
    s_cselect_b32 s63, s63, s61
    s_mul_i32 s63, s63, 81920
    s_call_b64 s[98:99], S_late
    s_call_b64 s[98:99], LD_issue
    s_waitcnt vmcnt(9)
    s_barrier
    s_bitcmp0_b32 s60, 0
    s_cselect_b32 s16, s14, s16
    s_cselect_b32 s17, s15, s17
    s_mov_b64 s[14:15], s[18:19]
    s_and_b32 s17, s17, 0xffff
    s_mov_b32 s18, 1966080
    s_mov_b32 s19, 0x00020000
    s_lshr_b32 s58, s60, 1
    s_lshl1_add_u32 s58, s2, s58
    s_mul_i32 s61, s58, 21846
    s_lshr_b32 s61, s61, 16
    s_mul_i32 s67, s61, 3
    s_sub_u32 s58, s58, s67
    s_mul_i32 s61, s61, 3072
    s_lshl_b32 s58, s58, 10
    s_add_u32 s58, s58, s61
    s_cmp_lt_u32 s61, 73728
    s_cselect_b32 s58, 2.0, s58
    s_buffer_load_dword s59, s[16:19], s58 offset:384
    s_buffer_load_dword s59, s[16:19], s58 offset:448
    s_buffer_load_dword s59, s[16:19], s58 offset:491904
    s_buffer_load_dword s59, s[16:19], s58 offset:491968
    s_add_u32 s58, s58, 983040
    s_call_b64 s[98:99], LD_issue
    s_waitcnt vmcnt(9)
    s_barrier
    s_buffer_load_dword s59, s[16:19], s58 offset:384
    s_buffer_load_dword s59, s[16:19], s58 offset:448
    s_buffer_load_dword s59, s[16:19], s58 offset:491904
    s_buffer_load_dword s59, s[16:19], s58 offset:491968
    s_lshl2_add_u32 s58, s53, s60
    s_mul_i32 s61, s58, 86
    s_lshr_b32 s61, s61, 8
    s_mul_i32 s67, s61, 3
    s_sub_u32 s58, s58, s67
    s_mul_i32 s58, s58, 1280
    s_mul_i32 s61, s61, 7680
    s_add_u32 s58, s58, s61
    s_mul_i32 s61, s51, 245888
    s_add_u32 s58, s58, s61
    s_call_b64 s[98:99], LD_issue
    s_call_b64 s[98:99], S_late2
    s_waitcnt vmcnt(9)
    s_barrier
    s_buffer_load_dword s59, s[32:35], s58 offset:0
    s_buffer_load_dword s59, s[32:35], s58 offset:64
    s_buffer_load_dword s59, s[32:35], s58 offset:3840
    s_buffer_load_dword s59, s[32:35], s58 offset:3904
    s_mul_i32 s58, s60, 61440
    s_add_u32 s58, s58, s44
    s_call_b64 s[98:99], LD_issue
    s_call_b64 s[98:99], S_late3
    s_call_b64 s[98:99], S_late4
    s_waitcnt vmcnt(9)
    s_barrier
    s_buffer_load_dword s59, s[24:27], s58 offset:0
    s_buffer_load_dword s59, s[24:27], s58 offset:64
    s_buffer_load_dword s59, s[24:27], s58 offset:128
    s_buffer_load_dword s59, s[24:27], s58 offset:192
    s_lshl_b32 s58, s60, 6
    s_add_u32 s58, s58, s44
    s_sub_u32 s58, s58, 131072
    s_call_b64 s[98:99], LD_issue
    s_waitcnt vmcnt(9)
    s_barrier
    s_buffer_load_dword s59, s[24:27], s58
    s_call_b64 s[98:99], LD_issue
    s_waitcnt vmcnt(9)
    s_barrier
    s_call_b64 s[98:99], LD_issue
    s_waitcnt vmcnt(9)
    s_barrier
    s_call_b64 s[98:99], LD_issue
    s_waitcnt vmcnt(9)
    s_barrier
    buffer_load_dwordx4 v[20:23], v18, s[24:27], s46 offen sc1
    s_mov_b32 s66, s51
    s_movk_i32 s71, 99
    s_call_b64 s[98:99], LD_issue
    s_waitcnt vmcnt(9)
    s_barrier
    v_mov_b32 v24, 163072
    ds_read_b32 v24, v24
    s_mov_b32 m0, s62
    s_add_u32 s62, s62, 4096
    buffer_load_dwordx4 v16, s[36:39], s63 offen lds
    s_add_u32 s63, s63, 40960
    s_mov_b32 m0, s62
    s_add_u32 s62, s62, 4096
    buffer_load_dwordx4 v16, s[36:39], s63 offen lds
    s_add_u32 s63, s63, 40960
    s_cmp_eq_u32 s63, 819200
    s_cselect_b32 s63, 0, s63
    s_mov_b32 m0, s62
    s_add_u32 s62, s62, 4096
    buffer_load_dwordx4 v16, s[36:39], s63 offen lds
    s_add_u32 s63, s63, 40960
    s_mov_b32 m0, s62
    s_add_u32 s62, s62, 4096
    buffer_load_dwordx4 v16, s[36:39], s63 offen lds
    s_add_u32 s63, s63, 40960
    s_cmp_eq_u32 s63, 819200
    s_cselect_b32 s63, 0, s63
    s_mov_b32 m0, s62
    s_add_u32 s62, s62, 4096
    buffer_load_dwordx4 v16, s[36:39], s63 offen lds
    s_add_u32 s63, s63, 40960
    s_mov_b32 m0, s62
    s_add_u32 s62, s62, 4096
    buffer_load_dwordx4 v16, s[36:39], s63 offen lds
    s_add_u32 s63, s63, 40960
    s_cmp_eq_u32 s63, 819200
    s_cselect_b32 s63, 0, s63
    s_mov_b32 m0, s62
    s_add_u32 s62, s62, 4096
    buffer_load_dwordx4 v16, s[36:39], s63 offen lds
    s_add_u32 s63, s63, 40960
    s_mov_b32 exec_hi, 3
    v_cmp_ne_u32 vcc, s54, v22
    s_cbranch_vccz LD_rs
LD_rsp:
    buffer_load_dwordx4 v[20:23], v18, s[24:27], s46 offen sc1
    s_waitcnt vmcnt(0)
    v_cmp_ne_u32 vcc, s54, v22
    s_cbranch_vccz LD_rs
    s_sleep 1
    s_sub_u32 s3, s3, 1
    s_cbranch_scc0 LD_rsp
    s_mov_b32 s3, 0
LD_rs:
    s_getreg_b32 s61, hwreg(HW_REG_XCC_ID)
    v_cmp_ne_u32 vcc, s61, v20
    s_lshr_b64 vcc, vcc, 24
    s_cselect_b32 s49, 0, 1
    s_lshl_b32 s61, s60, 5
    s_add_u32 s61, s61, 160828
    s_mov_b32 exec_hi, 0x3fffc
    s_mov_b32 exec_lo, 0
    v_cmp_eq_u32 vcc, s54, v22
    v_lshl_add_u32 v4, v0, 1, s61
    s_waitcnt lgkmcnt(0)
    v_mul_f32 v24, 0xbacccccd, v24
    v_fmac_f32 v21, v20, v24
    v_cndmask_b32 v21, 0, v21, vcc
    ds_write_b16_d16_hi v4, v21
    s_mov_b32 exec_hi, 0
    s_mov_b32 exec_lo, 0xffffff
    v_lshlrev_b32 v4, 3, v17
    v_add_u32 v4, 159808, v4
    ds_write_b64 v4, v[20:21]
    v_mov_b32 v4, 160768
    v_mov_b32 v5, s49
    ds_write_b32 v4, v5
    ds_write_b64 v4, v[28:29] offset:8
    ds_write_b64 v4, v[28:29] offset:16
    ds_write_b64 v4, v[28:29] offset:24
    ds_write_b64 v4, v[28:29] offset:32
    s_mov_b64 exec, -1
    s_waitcnt vmcnt(7) lgkmcnt(0)
    s_barrier
    s_mov_b32 m0, s62
    s_add_u32 s62, s62, 4096
    buffer_load_dwordx4 v16, s[36:39], s63 offen lds
    s_add_u32 s63, s63, 40960
    s_cmp_eq_u32 s63, 819200
    s_cselect_b32 s63, 0, s63
    s_mov_b32 m0, s62
    s_add_u32 s62, s62, 4096
    buffer_load_dwordx4 v16, s[36:39], s63 offen lds
    s_add_u32 s63, s63, 40960
    s_mov_b32 m0, s62
    s_add_u32 s62, s62, 4096
    buffer_load_dwordx4 v16, s[36:39], s63 offen lds
    s_add_u32 s63, s63, 40960
    s_cmp_eq_u32 s63, 819200
    s_cselect_b32 s63, 0, s63
    s_mov_b32 m0, s62
    s_add_u32 s62, s62, 4096
    buffer_load_dwordx4 v16, s[36:39], s63 offen lds
    s_add_u32 s63, s63, 40960
    s_mov_b32 m0, s62
    s_add_u32 s62, s62, 4096
    buffer_load_dwordx4 v16, s[36:39], s63 offen lds
    s_add_u32 s63, s63, 40960
    s_cmp_eq_u32 s63, 819200
    s_cselect_b32 s63, 0, s63
    s_mov_b32 m0, s62
    s_add_u32 s62, s62, 4096
    buffer_load_dwordx4 v16, s[36:39], s63 offen lds
    s_add_u32 s63, s63, 40960
    s_mov_b32 m0, s62
    s_add_u32 s62, s62, 4096
    buffer_load_dwordx4 v16, s[36:39], s63 offen lds
    s_add_u32 s63, s63, 40960
    s_cmp_eq_u32 s63, 819200
    s_cselect_b32 s63, 0, s63
    s_cmp_eq_u32 s60, 3
    s_cbranch_scc1 pf_11
    s_mul_i32 s67, s53, 6
    s_lshl_b32 s68, s60, 1
    s_add_u32 s67, s67, s68
    s_mul_i32 s67, s67, 24320
    s_add_u32 s67, s67, 1310720
    buffer_load_dword v182, v36, s[24:27], s67 offen sc1
    s_mov_b64 exec, -1
    s_branch pf_12
pf_11:
    v_lshlrev_b32 v4, 7, v0
    s_mov_b64 exec, 7
    buffer_load_dword v182, v4, s[24:27], s57 offen sc1
    s_mov_b64 exec, -1
pf_12:
    s_cmp_lt_u32 s60, 2
    s_cbranch_scc1 LD_s10
    v_subrev_u32 v98, 20480, v16
    s_add_u32 s61, s51, 0
    s_sub_u32 s67, s61, 10
    s_cselect_b32 s61, s61, s67
    s_mul_i32 s61, s61, 81920
    buffer_load_dwordx4 v[100:103], v16, s[36:39], s61 offen
    buffer_load_dwordx4 v[104:107], v98, s[36:39], s61 offen
    s_add_u32 s61, s61, 40960
    buffer_load_dwordx4 v[108:111], v16, s[36:39], s61 offen
    buffer_load_dwordx4 v[112:115], v98, s[36:39], s61 offen
    s_add_u32 s61, s51, 1
    s_sub_u32 s67, s61, 10
    s_cselect_b32 s61, s61, s67
    s_mul_i32 s61, s61, 81920
    buffer_load_dwordx4 v[116:119], v16, s[36:39], s61 offen
    buffer_load_dwordx4 v[120:123], v98, s[36:39], s61 offen
    s_add_u32 s61, s61, 40960
    buffer_load_dwordx4 v[124:127], v16, s[36:39], s61 offen
    buffer_load_dwordx4 v[128:131], v98, s[36:39], s61 offen
    s_add_u32 s61, s51, 2
    s_sub_u32 s67, s61, 10
    s_cselect_b32 s61, s61, s67
    s_mul_i32 s61, s61, 81920
    buffer_load_dwordx4 v[132:135], v16, s[36:39], s61 offen
    buffer_load_dwordx4 v[136:139], v98, s[36:39], s61 offen
    s_add_u32 s61, s61, 40960
    buffer_load_dwordx4 v[140:143], v16, s[36:39], s61 offen
    buffer_load_dwordx4 v[144:147], v98, s[36:39], s61 offen
    s_lshl_b32 s62, s60, 10
    s_add_u32 s62, s62, 10240
    v_lshl_add_u32 v99, v0, 4, s62
    s_barrier
    s_branch AT_67
LD_s10:
    v_mov_b32 v99, v16
    s_branch AT_start
F_start:
    v_and_b32 v0, 63, v0
    s_mov_b32 s3, 0x40000
    s_mov_b32 s47, 0xffff0000
    s_mov_b32 s26, 7340032
    s_mov_b32 s27, 0x00020000
    s_mov_b32 s38, 819200
    s_mov_b32 s39, 0x00020000
    s_mov_b32 s42, 2621440
    s_mov_b32 s43, 0x00020000
    s_and_b32 s49, s2, 7
    s_lshl_b32 s49, s49, 1
    s_add_u32 s49, s49, s56
    s_sub_u32 s49, s49, 30
    s_and_b32 s50, s48, 1
    s_lshr_b32 s51, s48, 1
    s_mul_i32 s52, s48, 6144
    s_mul_i32 s61, s49, 192
    v_mov_b32 v5, 128
    v_add_u32 v1, 0, v0
    v_mul_u32_u24 v2, 171, v1
    v_lshrrev_b32 v2, 11, v2
    v_mul_u32_u24 v3, 12, v2
    v_sub_u32 v3, v1, v3
    v_mul_u32_u24 v2, 3072, v2
    v_lshl_add_u32 v3, v3, 4, s61
    v_lshrrev_b32 v4, 8, v3
    v_cmp_eq_u32 vcc, 9, v4
    s_nop 1
    v_cndmask_b32 v4, 0, v5, vcc
    v_xad_u32 v210, v3, v4, v2
    v_add_u32 v1, 64, v0
    v_mul_u32_u24 v2, 171, v1
    v_lshrrev_b32 v2, 11, v2
    v_mul_u32_u24 v3, 12, v2
    v_sub_u32 v3, v1, v3
    v_mul_u32_u24 v2, 3072, v2
    v_lshl_add_u32 v3, v3, 4, s61
    v_lshrrev_b32 v4, 8, v3
    v_cmp_eq_u32 vcc, 9, v4
    s_nop 1
    v_cndmask_b32 v4, 0, v5, vcc
    v_xad_u32 v211, v3, v4, v2
    v_add_u32 v1, 128, v0
    v_mul_u32_u24 v2, 171, v1
    v_lshrrev_b32 v2, 11, v2
    v_mul_u32_u24 v3, 12, v2
    v_sub_u32 v3, v1, v3
    v_mul_u32_u24 v2, 3072, v2
    v_lshl_add_u32 v3, v3, 4, s61
    v_lshrrev_b32 v4, 8, v3
    v_cmp_eq_u32 vcc, 9, v4
    s_nop 1
    v_cndmask_b32 v4, 0, v5, vcc
    v_xad_u32 v212, v3, v4, v2
    s_mul_i32 s60, s51, 491520
    s_mov_b32 s30, 1966080
    s_mov_b32 s31, 0x00020000
    s_waitcnt lgkmcnt(0)
    s_cmp_eq_u32 s50, 0
    s_cselect_b32 s28, s14, s16
    s_cselect_b32 s29, s15, s17
    s_add_u32 m0, s52, 0
    s_add_u32 s62, s60, 0
    buffer_load_dwordx4 v210, s[28:31], s62 offen lds
    s_add_u32 m0, s52, 1024
    s_add_u32 s62, s60, 0
    buffer_load_dwordx4 v211, s[28:31], s62 offen lds
    s_add_u32 m0, s52, 2048
    s_add_u32 s62, s60, 0
    buffer_load_dwordx4 v212, s[28:31], s62 offen lds
    s_add_u32 m0, s52, 3072
    s_add_u32 s62, s60, 49152
    buffer_load_dwordx4 v210, s[28:31], s62 offen lds
    s_add_u32 m0, s52, 4096
    s_add_u32 s62, s60, 49152
    buffer_load_dwordx4 v211, s[28:31], s62 offen lds
    s_add_u32 m0, s52, 5120
    s_add_u32 s62, s60, 49152
    buffer_load_dwordx4 v212, s[28:31], s62 offen lds
    s_load_dword s54, s[24:25], 0
    s_mov_b32 s4, s12
    s_and_b32 s5, s13, 0xffff
    s_mov_b32 s6, 1280
    s_mov_b32 s7, 0x00020000
    s_mov_b32 s32, s18
    s_and_b32 s33, s19, 0xffff
    s_mov_b32 s34, 1966080
    s_mov_b32 s35, 0x00020000
    s_cmp_lg_u32 s48, 7
    s_cbranch_scc1 F_ntlb
    s_lshr_b32 s63, 25945, s49
    s_bitcmp0_b32 s63, 0
    s_cbranch_scc1 F_ntlb
    v_lshlrev_b32 v7, 16, v0
    buffer_load_dword v219, v7, s[40:43], 0 offen sc1
    buffer_load_dword v219, v7, s[36:39], 0 offen
    v_lshlrev_b32 v7, 17, v0
    buffer_load_dword v219, v7, s[24:27], 64 offen sc1
F_ntlb:
    s_barrier
    s_add_u32 m0, s52, 49152
    s_add_u32 s62, s60, 98304
    buffer_load_dwordx4 v210, s[28:31], s62 offen lds
    s_add_u32 m0, s52, 50176
    s_add_u32 s62, s60, 98304
    buffer_load_dwordx4 v211, s[28:31], s62 offen lds
    s_add_u32 m0, s52, 51200
    s_add_u32 s62, s60, 98304
    buffer_load_dwordx4 v212, s[28:31], s62 offen lds
    s_add_u32 m0, s52, 52224
    s_add_u32 s62, s60, 147456
    buffer_load_dwordx4 v210, s[28:31], s62 offen lds
    s_add_u32 m0, s52, 53248
    s_add_u32 s62, s60, 147456
    buffer_load_dwordx4 v211, s[28:31], s62 offen lds
    s_add_u32 m0, s52, 54272
    s_add_u32 s62, s60, 147456
    buffer_load_dwordx4 v212, s[28:31], s62 offen lds
    s_mul_i32 s53, s48, 5120
    s_mul_i32 s61, s49, 122880
    s_add_u32 s61, s61, s53
    s_and_b32 s63, s48, 2
    s_lshl_b32 s63, s63, 2
    v_add_u32 v1, 0, v0
    v_mul_u32_u24 v2, 205, v1
    v_lshrrev_b32 v2, 14, v2
    v_lshl_or_b32 v2, v2, 1, s63
    v_xor_b32 v1, v1, v2
    v_lshlrev_b32 v213, 4, v1
    v_add_u32 v1, 64, v0
    v_mul_u32_u24 v2, 205, v1
    v_lshrrev_b32 v2, 14, v2
    v_lshl_or_b32 v2, v2, 1, s63
    v_xor_b32 v1, v1, v2
    v_lshlrev_b32 v214, 4, v1
    v_add_u32 v1, 128, v0
    v_mul_u32_u24 v2, 205, v1
    v_lshrrev_b32 v2, 14, v2
    v_lshl_or_b32 v2, v2, 1, s63
    v_xor_b32 v1, v1, v2
    v_lshlrev_b32 v215, 4, v1
    v_add_u32 v1, 192, v0
    v_mul_u32_u24 v2, 205, v1
    v_lshrrev_b32 v2, 14, v2
    v_lshl_or_b32 v2, v2, 1, s63
    v_xor_b32 v1, v1, v2
    v_lshlrev_b32 v216, 4, v1
    v_add_u32 v1, 256, v0
    v_mul_u32_u24 v2, 205, v1
    v_lshrrev_b32 v2, 14, v2
    v_lshl_or_b32 v2, v2, 1, s63
    v_xor_b32 v1, v1, v2
    v_lshlrev_b32 v217, 4, v1
    v_lshrrev_b32 v2, 4, v0
    v_bfe_u32 v1, v0, 2, 2
    v_lshl_add_u32 v3, v2, 3, v1
    v_and_b32 v4, 3, v0
    v_lshlrev_b32 v4, 3, v4
    v_mul_u32_u24 v5, 192, v3
    s_and_b32 s63, s48, 5
    s_mul_i32 s63, s63, 6144
    s_and_b32 s66, s51, 1
    s_mul_i32 s64, s66, 96
    s_add_u32 s63, s63, s64
    v_add3_u32 v218, v5, v4, s63
    v_and_b32 v6, 1, v2
    v_lshl_or_b32 v6, v6, 2, v1
    v_lshlrev_b32 v6, 5, v6
    v_mul_u32_u24 v3, 1280, v3
    s_mul_i32 s63, s48, 160
    s_add_u32 s64, s63, 0
    v_add_u32 v7, s64, v4
    v_xor_b32 v7, v7, v6
    v_add_u32 v200, v7, v3
    v_add_u32 v205, 98304, v200
    s_add_u32 s64, s63, 32
    v_add_u32 v7, s64, v4
    v_xor_b32 v7, v7, v6
    v_add_u32 v201, v7, v3
    v_add_u32 v206, 98304, v201
    s_add_u32 s64, s63, 64
    v_add_u32 v7, s64, v4
    v_xor_b32 v7, v7, v6
    v_add_u32 v202, v7, v3
    v_add_u32 v207, 98304, v202
    s_add_u32 s64, s63, 96
    v_add_u32 v7, s64, v4
    v_xor_b32 v7, v7, v6
    v_add_u32 v203, v7, v3
    v_add_u32 v208, 98304, v203
    s_add_u32 s64, s63, 128
    v_add_u32 v7, s64, v4
    v_xor_b32 v7, v7, v6
    v_add_u32 v204, v7, v3
    v_add_u32 v209, 98304, v204
    s_waitcnt lgkmcnt(0)
    s_add_u32 s54, s54, 2654435761
    s_mov_b32 s67, 0x3f803f80
    v_mov_b32 v220, s67
    v_mov_b32 v221, s67
    v_mov_b32 v222, s67
    v_mov_b32 v223, s67
    v_mov_b64 v[232:233], 0
    v_mov_b64 v[234:235], 0
    v_mov_b64 v[236:237], 0
    v_mov_b64 v[238:239], 0
    v_mov_b64 v[240:241], 0
    v_mov_b64 v[242:243], 0
    v_lshlrev_b32 v16, 3, v0
    buffer_load_dwordx2 v[10:11], v16, s[4:7], 0 offen offset:0
    buffer_load_dwordx2 v[12:13], v16, s[4:7], 0 offen offset:512
    buffer_load_dwordx2 v[14:15], v16, s[4:7], 0 offen offset:1024
    v_lshlrev_b32 v1, 4, v0
    v_lshlrev_b32 v7, 6, v0
    s_lshl_b32 s15, s49, 11
    s_add_u32 s15, s15, 196608
    s_add_u32 s70, s15, 32768
    s_cmp_eq_u32 s48, 7
    s_cselect_b32 s65, s70, 2.0
    s_mov_b64 exec, 0xffffff
    buffer_load_dword v219, v7, s[24:27], s65 offen sc1
    s_mov_b64 exec, -1
    v_mov_b32 v8, 155648
    v_mov_b32 v224, 0
    v_mov_b32 v225, 0
    v_mov_b32 v226, 0
    v_mov_b32 v227, 0
    ds_write_b128 v8, v[224:227] offset:0
    ds_write_b128 v8, v[224:227] offset:16
    ds_write_b128 v8, v[224:227] offset:32
    ds_write_b128 v8, v[224:227] offset:3648
    ds_write_b128 v8, v[224:227] offset:3664
    ds_write_b128 v8, v[224:227] offset:3776
    ds_write_b128 v8, v[224:227] offset:3792
    s_mul_i32 s65, s48, 1344
    s_add_u32 s45, s65, 16384
    v_lshl_add_u32 v16, v0, 2, s45
    v_and_b32 v19, 15, v0
    v_bfe_u32 v5, v0, 1, 1
    v_mov_b32 v6, 0x44444444
    v_mov_b32 v9, 0xeeeeeeee
    v_cmp_eq_u32 vcc, 1, v5
    s_nop 1
    v_cndmask_b32 v252, v6, v9, vcc
    v_lshlrev_b32 v6, 4, v2
    v_lshl_add_u32 v6, v5, 7, v6
    v_add_u32 v6, v6, v8
    v_bfe_u32 v3, v0, 2, 2
    v_and_b32 v4, 1, v0
    v_lshl_add_u32 v3, v3, 1, v4
    v_mul_u32_u24 v9, 1344, v3
    v_mul_u32_u24 v5, 672, v5
    v_add_u32 v9, v9, v5
    v_lshrrev_b32 v3, 1, v2
    v_mul_u32_u24 v3, 160, v3
    v_and_b32 v4, 1, v2
    v_lshl_add_u32 v3, v4, 4, v3
    s_lshr_b32 s65, s48, 2
    s_mul_i32 s63, s65, 320
    v_add3_u32 v9, v9, v3, s63
    s_lshl1_add_u32 s65, s65, s50
    s_mul_i32 s65, s65, 768
    s_mul_i32 s66, s66, 384
    s_add_u32 s65, s65, s66
    v_lshl_add_u32 v3, v19, 3, s65
    v_add_u32 v230, 155904, v3
    v_mul_u32_u24 v4, 3328, v2
    v_add_u32 v3, v3, v4
    s_mul_i32 s65, s48, 48
    v_add_u32 v4, s65, v0
    v_bfe_u32 v5, v4, 1, 1
    v_lshlrev_b32 v5, 7, v5
    v_and_b32 v17, 1, v4
    v_lshl_add_u32 v5, v17, 1, v5
    v_and_b32 v17, 0xfc, v4
    v_add_u32 v5, v5, v17
    v_lshrrev_b32 v17, 6, v4
    v_lshl_add_u32 v5, v17, 5, v5
    v_add_u32 v5, v5, v8
    v_lshlrev_b32 v4, 3, v4
    v_and_b32 v17, 7, v0
    v_lshlrev_b32 v18, 4, v17
    v_lshl_add_u32 v18, v2, 11, v18
    v_lshrrev_b32 v19, 3, v19
    v_lshl_add_u32 v229, v19, 12, v18
    s_lshl_b32 s8, s48, 13
    s_lshl_b32 s65, s49, 7
    s_add_u32 s8, s8, s65
    s_add_u32 s8, s8, 16384
    s_sub_u32 s44, s48, 2
    s_lshl_b32 s14, s49, 12
    s_lshl_b32 s65, s44, 11
    s_add_u32 s14, s14, s65
    s_add_u32 s14, s14, 16384
    s_lshr_b32 s65, s49, 1
    s_lshl_b32 s65, s65, 6
    s_lshl3_add_u32 s65, s49, s65
    s_and_b32 s66, s44, 1
    s_movk_i32 s19, 0xff
    s_cselect_b32 s18, s19, 0x00ff00ff
    s_mul_i32 s66, s66, 48
    s_add_u32 s65, s65, s66
    v_and_b32 v18, 1, v2
    v_lshrrev_b32 v19, 1, v2
    v_lshl_or_b32 v18, v18, 1, v19
    v_min_u32 v18, 2, v18
    v_lshl_add_u32 v18, v18, 4, v17
    v_add_u32 v18, s65, v18
    v_bfe_u32 v19, v18, 1, 1
    v_mul_u32_u24 v19, 672, v19
    v_and_b32 v17, 1, v18
    v_lshl_add_u32 v19, v17, 1, v19
    v_and_b32 v17, 0xffc, v18
    v_add_u32 v19, v19, v17
    v_lshlrev_b32 v18, 1, v18
    v_mov_b32 v17, v229
    s_sub_u32 s65, s54, 1
    v_mov_b32 v227, s65
    s_mov_b32 exec_hi, 0
    buffer_store_dwordx4 v[224:227], v17, s[24:27], s8 offen sc1
    s_mov_b32 exec_hi, -1
    s_lshr_b32 s68, s48, 1
    s_mul_i32 s68, s68, 3328
    s_lshl2_add_u32 s68, s50, s68
    s_lshr_b32 s16, s49, 2
    s_mul_i32 s16, s16, 61440
    s_add_u32 s16, s16, 262144
    s_mov_b32 s17, 0
    s_mov_b32 s20, 16
    s_and_b32 s9, s49, 1
    s_lshl3_add_u32 s9, s9, s48
    s_cmp_eq_u32 s9, 6
    s_cselect_b32 s9, 0, 2
    v_add_u32 v228, 155904, v4
    s_lshl_b32 s65, s48, 2
    v_add_u32 v231, s65, v8
    s_mov_b64 exec, 0
    s_cmp_eq_u32 s48, 0
    s_cbranch_scc1 HF0_0
    s_cmp_eq_u32 s48, 1
    s_cbranch_scc1 HF1_0
    s_cmp_eq_u32 s48, 2
    s_cbranch_scc1 HF2_0
    s_cmp_eq_u32 s48, 3
    s_cbranch_scc1 HF3_0
    s_cmp_eq_u32 s48, 4
    s_cbranch_scc1 HF4_0
    s_cmp_eq_u32 s48, 5
    s_cbranch_scc1 HF5_0
HF_ret:
    s_mov_b64 exec, -1
    s_add_u32 m0, s52, 98304
    s_add_u32 s62, s60, 196608
    buffer_load_dwordx4 v210, s[28:31], s62 offen lds
    s_add_u32 m0, s52, 99328
    s_add_u32 s62, s60, 196608
    buffer_load_dwordx4 v211, s[28:31], s62 offen lds
    s_add_u32 m0, s52, 100352
    s_add_u32 s62, s60, 196608
    buffer_load_dwordx4 v212, s[28:31], s62 offen lds
    s_add_u32 m0, s52, 101376
    s_add_u32 s62, s60, 245760
    buffer_load_dwordx4 v210, s[28:31], s62 offen lds
    s_add_u32 m0, s52, 102400
    s_add_u32 s62, s60, 245760
    buffer_load_dwordx4 v211, s[28:31], s62 offen lds
    s_add_u32 m0, s52, 103424
    s_add_u32 s62, s60, 245760
    buffer_load_dwordx4 v212, s[28:31], s62 offen lds
    s_waitcnt vmcnt(17)
    s_barrier
    ds_read_b64_tr_b16 v[20:21], v218 offset:0
    ds_read_b64_tr_b16 v[22:23], v218 offset:768
    ds_read_b64_tr_b16 v[24:25], v218 offset:12288
    ds_read_b64_tr_b16 v[26:27], v218 offset:13056
    ds_read_b64_tr_b16 v[28:29], v218 offset:32
    ds_read_b64_tr_b16 v[30:31], v218 offset:800
    ds_read_b64_tr_b16 v[32:33], v218 offset:12320
    ds_read_b64_tr_b16 v[34:35], v218 offset:13088
    ds_read_b64_tr_b16 v[36:37], v218 offset:64
    ds_read_b64_tr_b16 v[38:39], v218 offset:832
    ds_read_b64_tr_b16 v[40:41], v218 offset:12352
    ds_read_b64_tr_b16 v[42:43], v218 offset:13120
    s_waitcnt lgkmcnt(0)
    s_barrier
    s_add_u32 m0, s52, 0
    s_add_u32 s62, s60, 294912
    buffer_load_dwordx4 v210, s[28:31], s62 offen lds
    s_add_u32 m0, s52, 1024
    s_add_u32 s62, s60, 294912
    buffer_load_dwordx4 v211, s[28:31], s62 offen lds
    s_add_u32 m0, s52, 2048
    s_add_u32 s62, s60, 294912
    buffer_load_dwordx4 v212, s[28:31], s62 offen lds
    s_add_u32 m0, s52, 3072
    s_add_u32 s62, s60, 344064
    buffer_load_dwordx4 v210, s[28:31], s62 offen lds
    s_add_u32 m0, s52, 4096
    s_add_u32 s62, s60, 344064
    buffer_load_dwordx4 v211, s[28:31], s62 offen lds
    s_add_u32 m0, s52, 5120
    s_add_u32 s62, s60, 344064
    buffer_load_dwordx4 v212, s[28:31], s62 offen lds
    v_smfmac_f32_16x16x64_bf16 v[232:235], v[220:223], v[20:27], v252
    v_smfmac_f32_16x16x64_bf16 v[236:239], v[220:223], v[28:35], v252
    v_smfmac_f32_16x16x64_bf16 v[240:243], v[220:223], v[36:43], v252
    s_waitcnt vmcnt(17)
    s_barrier
    ds_read_b64_tr_b16 v[44:45], v218 offset:49152
    ds_read_b64_tr_b16 v[46:47], v218 offset:49920
    ds_read_b64_tr_b16 v[48:49], v218 offset:61440
    ds_read_b64_tr_b16 v[50:51], v218 offset:62208
    ds_read_b64_tr_b16 v[52:53], v218 offset:49184
    ds_read_b64_tr_b16 v[54:55], v218 offset:49952
    ds_read_b64_tr_b16 v[56:57], v218 offset:61472
    ds_read_b64_tr_b16 v[58:59], v218 offset:62240
    ds_read_b64_tr_b16 v[60:61], v218 offset:49216
    ds_read_b64_tr_b16 v[62:63], v218 offset:49984
    ds_read_b64_tr_b16 v[64:65], v218 offset:61504
    ds_read_b64_tr_b16 v[66:67], v218 offset:62272
    s_waitcnt lgkmcnt(0)
    s_barrier
    s_add_u32 m0, s52, 49152
    s_add_u32 s62, s60, 393216
    buffer_load_dwordx4 v210, s[28:31], s62 offen lds
    s_add_u32 m0, s52, 50176
    s_add_u32 s62, s60, 393216
    buffer_load_dwordx4 v211, s[28:31], s62 offen lds
    s_add_u32 m0, s52, 51200
    s_add_u32 s62, s60, 393216
    buffer_load_dwordx4 v212, s[28:31], s62 offen lds
    s_add_u32 m0, s52, 52224
    s_add_u32 s62, s60, 442368
    buffer_load_dwordx4 v210, s[28:31], s62 offen lds
    s_add_u32 m0, s52, 53248
    s_add_u32 s62, s60, 442368
    buffer_load_dwordx4 v211, s[28:31], s62 offen lds
    s_add_u32 m0, s52, 54272
    s_add_u32 s62, s60, 442368
    buffer_load_dwordx4 v212, s[28:31], s62 offen lds
    v_smfmac_f32_16x16x64_bf16 v[232:235], v[220:223], v[44:51], v252
    v_smfmac_f32_16x16x64_bf16 v[236:239], v[220:223], v[52:59], v252
    v_smfmac_f32_16x16x64_bf16 v[240:243], v[220:223], v[60:67], v252
    s_waitcnt vmcnt(12)
    s_barrier
    v_add_u32 v229, 98304, v218
    ds_read_b64_tr_b16 v[68:69], v229 offset:0
    ds_read_b64_tr_b16 v[70:71], v229 offset:768
    ds_read_b64_tr_b16 v[72:73], v229 offset:12288
    ds_read_b64_tr_b16 v[74:75], v229 offset:13056
    ds_read_b64_tr_b16 v[76:77], v229 offset:32
    ds_read_b64_tr_b16 v[78:79], v229 offset:800
    ds_read_b64_tr_b16 v[80:81], v229 offset:12320
    ds_read_b64_tr_b16 v[82:83], v229 offset:13088
    ds_read_b64_tr_b16 v[84:85], v229 offset:64
    ds_read_b64_tr_b16 v[86:87], v229 offset:832
    ds_read_b64_tr_b16 v[88:89], v229 offset:12352
    ds_read_b64_tr_b16 v[90:91], v229 offset:13120
    s_waitcnt lgkmcnt(0)
    s_barrier
    s_mul_i32 s62, s49, 3
    s_add_u32 s62, s62, 0
    s_lshr_b32 s63, s62, 2
    s_cmp_eq_u32 s63, 9
    s_cselect_b32 s63, 2, 0
    s_xor_b32 s62, s62, s63
    s_mul_i32 s62, s62, 40960
    s_add_u32 s62, s62, s53
    s_add_u32 m0, s53, 98304
    s_nop 0
    buffer_load_dwordx4 v213, s[32:35], s62 offen lds
    s_add_u32 m0, s53, 99328
    s_nop 0
    buffer_load_dwordx4 v214, s[32:35], s62 offen lds
    s_add_u32 m0, s53, 100352
    s_nop 0
    buffer_load_dwordx4 v215, s[32:35], s62 offen lds
    s_add_u32 m0, s53, 101376
    s_nop 0
    buffer_load_dwordx4 v216, s[32:35], s62 offen lds
    s_add_u32 m0, s53, 102400
    s_nop 0
    buffer_load_dwordx4 v217, s[32:35], s62 offen lds
    v_smfmac_f32_16x16x64_bf16 v[232:235], v[220:223], v[68:75], v252
    v_smfmac_f32_16x16x64_bf16 v[236:239], v[220:223], v[76:83], v252
    v_smfmac_f32_16x16x64_bf16 v[240:243], v[220:223], v[84:91], v252
    v_dot2_f32_bf16 v226, v10, s67, 0
    v_dot2_f32_bf16 v226, v11, s67, v226
    v_dot2_f32_bf16 v226, v12, s67, v226
    v_dot2_f32_bf16 v226, v13, s67, v226
    v_dot2_f32_bf16 v226, v14, s67, v226
    v_dot2_f32_bf16 v226, v15, s67, v226
    s_nop 2
    v_add_f32_dpp v226, v226, v226 row_ror:1 row_mask:0xf bank_mask:0xf
    s_nop 1
    v_add_f32_dpp v226, v226, v226 row_ror:2 row_mask:0xf bank_mask:0xf
    s_nop 1
    v_add_f32_dpp v226, v226, v226 row_ror:4 row_mask:0xf bank_mask:0xf
    s_nop 1
    v_add_f32_dpp v226, v226, v226 row_ror:8 row_mask:0xf bank_mask:0xf
    v_mov_b32 v229, v226
    s_nop 1
    v_permlane32_swap_b32 v226, v229
    v_add_f32 v226, v226, v229
    v_mov_b32 v229, v226
    s_nop 1
    v_permlane16_swap_b32 v226, v229
    v_add_f32 v226, v226, v229
    s_nop 0
    v_readfirstlane_b32 s55, v226
    s_waitcnt vmcnt(11)
    s_barrier
    ds_read_b64_tr_b16 v[92:93], v218 offset:0
    ds_read_b64_tr_b16 v[94:95], v218 offset:768
    ds_read_b64_tr_b16 v[96:97], v218 offset:12288
    ds_read_b64_tr_b16 v[98:99], v218 offset:13056
    ds_read_b64_tr_b16 v[100:101], v218 offset:32
    ds_read_b64_tr_b16 v[102:103], v218 offset:800
    ds_read_b64_tr_b16 v[104:105], v218 offset:12320
    ds_read_b64_tr_b16 v[106:107], v218 offset:13088
    ds_read_b64_tr_b16 v[108:109], v218 offset:64
    ds_read_b64_tr_b16 v[110:111], v218 offset:832
    ds_read_b64_tr_b16 v[112:113], v218 offset:12352
    ds_read_b64_tr_b16 v[114:115], v218 offset:13120
    s_waitcnt lgkmcnt(0)
    s_barrier
    s_mul_i32 s62, s49, 3
    s_add_u32 s62, s62, 1
    s_lshr_b32 s63, s62, 2
    s_cmp_eq_u32 s63, 9
    s_cselect_b32 s63, 2, 0
    s_xor_b32 s62, s62, s63
    s_mul_i32 s62, s62, 40960
    s_add_u32 s62, s62, s53
    s_add_u32 m0, s53, 0
    s_nop 0
    buffer_load_dwordx4 v213, s[32:35], s62 offen lds
    s_add_u32 m0, s53, 1024
    s_nop 0
    buffer_load_dwordx4 v214, s[32:35], s62 offen lds
    s_add_u32 m0, s53, 2048
    s_nop 0
    buffer_load_dwordx4 v215, s[32:35], s62 offen lds
    s_add_u32 m0, s53, 3072
    s_nop 0
    buffer_load_dwordx4 v216, s[32:35], s62 offen lds
    s_add_u32 m0, s53, 4096
    s_nop 0
    buffer_load_dwordx4 v217, s[32:35], s62 offen lds
    v_smfmac_f32_16x16x64_bf16 v[232:235], v[220:223], v[92:99], v252
    v_smfmac_f32_16x16x64_bf16 v[236:239], v[220:223], v[100:107], v252
    v_smfmac_f32_16x16x64_bf16 v[240:243], v[220:223], v[108:115], v252
    s_waitcnt vmcnt(10)
    s_barrier
    ds_read_b64_tr_b16 v[116:117], v218 offset:49152
    ds_read_b64_tr_b16 v[118:119], v218 offset:49920
    ds_read_b64_tr_b16 v[120:121], v218 offset:61440
    ds_read_b64_tr_b16 v[122:123], v218 offset:62208
    ds_read_b64_tr_b16 v[124:125], v218 offset:49184
    ds_read_b64_tr_b16 v[126:127], v218 offset:49952
    ds_read_b64_tr_b16 v[128:129], v218 offset:61472
    ds_read_b64_tr_b16 v[130:131], v218 offset:62240
    ds_read_b64_tr_b16 v[132:133], v218 offset:49216
    ds_read_b64_tr_b16 v[134:135], v218 offset:49984
    ds_read_b64_tr_b16 v[136:137], v218 offset:61504
    ds_read_b64_tr_b16 v[138:139], v218 offset:62272
    s_waitcnt lgkmcnt(0)
    s_barrier
    s_mul_i32 s62, s49, 3
    s_add_u32 s62, s62, 2
    s_lshr_b32 s63, s62, 2
    s_cmp_eq_u32 s63, 9
    s_cselect_b32 s63, 2, 0
    s_xor_b32 s62, s62, s63
    s_mul_i32 s62, s62, 40960
    s_add_u32 s62, s62, s53
    s_add_u32 m0, s53, 49152
    s_nop 0
    buffer_load_dwordx4 v213, s[32:35], s62 offen lds
    s_add_u32 m0, s53, 50176
    s_nop 0
    buffer_load_dwordx4 v214, s[32:35], s62 offen lds
    s_add_u32 m0, s53, 51200
    s_nop 0
    buffer_load_dwordx4 v215, s[32:35], s62 offen lds
    s_add_u32 m0, s53, 52224
    s_nop 0
    buffer_load_dwordx4 v216, s[32:35], s62 offen lds
    s_add_u32 m0, s53, 53248
    s_nop 0
    buffer_load_dwordx4 v217, s[32:35], s62 offen lds
    s_cmp_eq_u32 s48, 0
    s_cselect_b32 s65, s15, 2.0
    s_mov_b64 exec, 0xffffff
    buffer_load_dwordx2 v[224:225], v7, s[24:27], s65 offen sc1
    s_mov_b64 exec, -1
    v_smfmac_f32_16x16x64_bf16 v[232:235], v[220:223], v[116:123], v252
    v_smfmac_f32_16x16x64_bf16 v[236:239], v[220:223], v[124:131], v252
    v_smfmac_f32_16x16x64_bf16 v[240:243], v[220:223], v[132:139], v252
    s_mov_b64 exec, 0xffff
    s_nop 8
    v_pk_add_f32 v[232:233], v[232:233], v[234:235]
    ds_write_b64 v230, v[232:233] offset:0
    v_pk_add_f32 v[236:237], v[236:237], v[238:239]
    ds_write_b64 v230, v[236:237] offset:128
    v_pk_add_f32 v[240:241], v[240:241], v[242:243]
    ds_write_b64 v230, v[240:241] offset:256
    s_mov_b64 exec, -1
    s_waitcnt lgkmcnt(0)
    s_waitcnt vmcnt(6)
    s_barrier
    ds_read2st64_b32 v[232:233], v228 offset0:0 offset1:3
    ds_read2st64_b32 v[234:235], v228 offset0:6 offset1:9
    ds_read_b64_tr_b16 v[140:141], v205 offset:0
    ds_read_b64_tr_b16 v[142:143], v205 offset:5120
    ds_read_b64_tr_b16 v[152:153], v206 offset:0
    ds_read_b64_tr_b16 v[154:155], v206 offset:5120
    ds_read_b64_tr_b16 v[164:165], v207 offset:0
    ds_read_b64_tr_b16 v[166:167], v207 offset:5120
    ds_read_b64_tr_b16 v[176:177], v208 offset:0
    ds_read_b64_tr_b16 v[178:179], v208 offset:5120
    ds_read_b64_tr_b16 v[188:189], v209 offset:0
    ds_read_b64_tr_b16 v[190:191], v209 offset:5120
    ds_read_b64_tr_b16 v[144:145], v200 offset:0
    ds_read_b64_tr_b16 v[146:147], v200 offset:5120
    ds_read_b64_tr_b16 v[156:157], v201 offset:0
    ds_read_b64_tr_b16 v[158:159], v201 offset:5120
    ds_read_b64_tr_b16 v[168:169], v202 offset:0
    ds_read_b64_tr_b16 v[170:171], v202 offset:5120
    ds_read_b64_tr_b16 v[180:181], v203 offset:0
    ds_read_b64_tr_b16 v[182:183], v203 offset:5120
    ds_read_b64_tr_b16 v[192:193], v204 offset:0
    ds_read_b64_tr_b16 v[194:195], v204 offset:5120
    s_waitcnt lgkmcnt(0)
    v_add_f32 v0, v232, v234
    v_add_f32 v2, v233, v235
    s_waitcnt vmcnt(1)
    s_barrier
    ds_read_b64_tr_b16 v[148:149], v200 offset:49152
    ds_read_b64_tr_b16 v[150:151], v200 offset:54272
    ds_read_b64_tr_b16 v[160:161], v201 offset:49152
    ds_read_b64_tr_b16 v[162:163], v201 offset:54272
    ds_read_b64_tr_b16 v[172:173], v202 offset:49152
    ds_read_b64_tr_b16 v[174:175], v202 offset:54272
    ds_read_b64_tr_b16 v[184:185], v203 offset:49152
    ds_read_b64_tr_b16 v[186:187], v203 offset:54272
    ds_read_b64_tr_b16 v[196:197], v204 offset:49152
    ds_read_b64_tr_b16 v[198:199], v204 offset:54272
    s_waitcnt lgkmcnt(0)
F_rdy:
HF0_0:
    s_cbranch_execz HF0_1
    s_cmp_lg_u32 s48, 0
    s_cbranch_scc1 F_wait
    s_mov_b64 exec, 0xffffff
    s_branch F_pw
F_poll:
    buffer_load_dwordx2 v[224:225], v7, s[24:27], s15 offen sc1
F_pw:
    s_waitcnt vmcnt(0)
    v_cmp_ne_u32 vcc, s54, v225
    s_cbranch_vccz F_got
    s_sleep 1
    s_sub_u32 s3, s3, 1
    s_cbranch_scc0 F_poll
    s_mov_b32 s3, 0
F_got:
    s_mov_b64 exec, -1
    v_max_u32_dpp v226, v224, v224 row_ror:1 row_mask:0xf bank_mask:0xf
    s_nop 1
    v_max_u32_dpp v226, v226, v226 row_ror:2 row_mask:0xf bank_mask:0xf
    s_nop 1
    v_max_u32_dpp v226, v226, v226 row_ror:4 row_mask:0xf bank_mask:0xf
    s_nop 1
    v_max_u32_dpp v226, v226, v226 row_ror:8 row_mask:0xf bank_mask:0xf
    s_nop 0
    v_readlane_b32 s60, v226, 0
    v_readlane_b32 s62, v226, 16
HF0_1:
    s_cbranch_execz HF_ret
    s_max_u32 s60, s60, s62
    s_max_u32 s60, s60, 1572865
    s_sub_u32 s60, s60, 1572864
F_thr:
    v_cmp_le_u32 vcc, s60, v224
    s_add_u32 s60, s60, 196608
    s_cbranch_scc1 F_thd
    s_bcnt1_i32_b32 s62, vcc_lo
    s_cmp_gt_u32 s62, 8
    s_cbranch_scc1 F_thr
F_thd:
    v_mbcnt_lo_u32_b32 v226, vcc_lo, 0
    v_cmp_gt_u32 s[62:63], 8, v226
    v_lshl_add_u32 v226, v226, 2, v8
    s_and_b64 exec, vcc, s[62:63]
    ds_write_b32 v226, v224 offset:0
    s_mov_b64 exec, -1
    s_waitcnt lgkmcnt(0)
F_wait:
    s_waitcnt vmcnt(0)
    s_barrier
    ds_read_b32 v224, v231 offset:0
    s_waitcnt lgkmcnt(0)
    v_readfirstlane_b32 s60, v224
F_redo:
    v_mov_b64 v[232:233], 0
    v_mov_b64 v[234:235], 0
    v_mov_b64 v[236:237], 0
    v_mov_b64 v[238:239], 0
    v_mov_b64 v[240:241], 0
    v_mov_b64 v[242:243], 0
    s_and_b32 s61, s60, 0xfff
    s_cbranch_scc0 F_b1
    s_lshr_b32 s62, s61, 4
    s_mul_i32 s62, s62, 171
    s_lshr_b32 s62, s62, 10
    s_mul_i32 s62, s62, 2560
    s_add_u32 s62, s62, s16
    s_add_u32 s63, s54, s61
    v_mov_b64 v[228:229], 0
    v_mov_b32 v230, s63
    buffer_load_dwordx3 v[220:222], v1, s[24:27], s62 offen offset:0 sc1
    buffer_load_dwordx3 v[224:226], v1, s[24:27], s62 offen offset:1024 sc1
    s_mov_b32 exec_hi, 0
    buffer_load_dwordx3 v[228:230], v1, s[24:27], s62 offen offset:2048 sc1
    s_mov_b32 exec_hi, -1
    s_branch F_rw
F_row:
    s_mov_b64 exec, s[58:59]
    s_cbranch_execz F_r0
    buffer_load_dwordx3 v[220:222], v1, s[24:27], s62 offen offset:0 sc1
F_r0:
    s_mov_b64 exec, s[64:65]
    s_cbranch_execz F_r1
    buffer_load_dwordx3 v[224:226], v1, s[24:27], s62 offen offset:1024 sc1
F_r1:
    s_mov_b64 exec, s[10:11]
    s_cbranch_execz F_r2
    buffer_load_dwordx3 v[228:230], v1, s[24:27], s62 offen offset:2048 sc1
F_r2:
    s_mov_b64 exec, -1
F_rw:
HF1_0:
    s_cbranch_execz HF1_1
    s_waitcnt vmcnt(0)
    ds_write2_b32 v16, v220, v221 offset0:0 offset1:168
    ds_write2_b32 v16, v224, v225 offset0:64 offset1:232
    s_mov_b32 exec_hi, 0
    ds_write_b32 v16, v228 offset:512
    ds_write_b32 v16, v229 offset:1184
    s_mov_b32 exec_hi, -1
    v_cmp_ne_u32 s[58:59], s63, v222
    v_cmp_ne_u32 s[64:65], s63, v226
    v_cmp_ne_u32 s[10:11], s63, v230
    s_or_b64 vcc, s[58:59], s[64:65]
    s_or_b64 vcc, vcc, s[10:11]
    s_cbranch_scc0 F_ok
    s_sub_u32 s20, s20, 1
    s_cbranch_scc0 F_row
F_b1:
    s_waitcnt lgkmcnt(0)
    s_barrier
    s_cmp_lg_u32 s9, s17
    s_cbranch_scc1 F_nwb
    buffer_wbl2 sc1
F_nwb:
    ds_read_b128 v[200:203], v9 offset:16384
    ds_read_b128 v[204:207], v9 offset:16416
    ds_read_b128 v[208:211], v9 offset:16448
    ds_read_b128 v[212:215], v9 offset:16480
    ds_read_b128 v[216:219], v9 offset:16512
    s_waitcnt lgkmcnt(4)
    v_smfmac_f32_16x16x64_bf16 v[232:235], v[200:203], v[20:27], v252
    v_smfmac_f32_16x16x64_bf16 v[236:239], v[200:203], v[28:35], v252
    v_smfmac_f32_16x16x64_bf16 v[240:243], v[200:203], v[36:43], v252
    s_waitcnt lgkmcnt(3)
    v_smfmac_f32_16x16x64_bf16 v[232:235], v[204:207], v[44:51], v252
    v_smfmac_f32_16x16x64_bf16 v[236:239], v[204:207], v[52:59], v252
    v_smfmac_f32_16x16x64_bf16 v[240:243], v[204:207], v[60:67], v252
    s_waitcnt lgkmcnt(2)
    v_smfmac_f32_16x16x64_bf16 v[232:235], v[208:211], v[68:75], v252
    v_smfmac_f32_16x16x64_bf16 v[236:239], v[208:211], v[76:83], v252
HF1_1:
    s_cbranch_execz HF_ret
    v_smfmac_f32_16x16x64_bf16 v[240:243], v[208:211], v[84:91], v252
    s_waitcnt lgkmcnt(1)
    v_smfmac_f32_16x16x64_bf16 v[232:235], v[212:215], v[92:99], v252
    v_smfmac_f32_16x16x64_bf16 v[236:239], v[212:215], v[100:107], v252
    v_smfmac_f32_16x16x64_bf16 v[240:243], v[212:215], v[108:115], v252
    s_waitcnt lgkmcnt(0)
    v_smfmac_f32_16x16x64_bf16 v[232:235], v[216:219], v[116:123], v252
    v_smfmac_f32_16x16x64_bf16 v[236:239], v[216:219], v[124:131], v252
    v_smfmac_f32_16x16x64_bf16 v[240:243], v[216:219], v[132:139], v252
    s_nop 8
    s_branch F_pw2
F_ok:
    v_dot2_f32_bf16 v222, v220, s67, 0
    v_dot2_f32_bf16 v223, v220, v220, 0
    v_dot2_f32_bf16 v226, v220, v10, 0
    v_dot2_f32_bf16 v222, v221, s67, v222
    v_dot2_f32_bf16 v223, v221, v221, v223
    v_dot2_f32_bf16 v226, v221, v11, v226
    v_dot2_f32_bf16 v222, v224, s67, v222
    v_dot2_f32_bf16 v223, v224, v224, v223
    v_dot2_f32_bf16 v226, v224, v12, v226
    v_dot2_f32_bf16 v222, v225, s67, v222
    v_dot2_f32_bf16 v223, v225, v225, v223
    v_dot2_f32_bf16 v226, v225, v13, v226
    v_dot2_f32_bf16 v222, v228, s67, v222
    v_dot2_f32_bf16 v223, v228, v228, v223
    v_dot2_f32_bf16 v226, v228, v14, v226
    v_dot2_f32_bf16 v222, v229, s67, v222
    v_dot2_f32_bf16 v223, v229, v229, v223
    v_dot2_f32_bf16 v226, v229, v15, v226
    s_waitcnt lgkmcnt(0)
    s_barrier
    s_cmp_lg_u32 s9, s17
    s_cbranch_scc1 F_nwc
    buffer_wbl2 sc1
F_nwc:
    ds_read_b128 v[200:203], v9 offset:16384
HF2_0:
    s_cbranch_execz HF2_1
    ds_read_b128 v[204:207], v9 offset:16416
    ds_read_b128 v[208:211], v9 offset:16448
    ds_read_b128 v[212:215], v9 offset:16480
    ds_read_b128 v[216:219], v9 offset:16512
    v_mov_b32 v227, v226
    v_permlane32_swap_b32 v222, v223
    s_nop 0
    v_permlane32_swap_b32 v226, v227
    v_add_f32 v222, v222, v223
    v_add_f32 v226, v226, v227
    v_mov_b32 v224, s68
    v_mov_b32 v223, s45
    v_permlane16_swap_b32 v222, v226
    v_add_f32 v222, v222, v226
    s_waitcnt lgkmcnt(4)
    v_smfmac_f32_16x16x64_bf16 v[232:235], v[200:203], v[20:27], v252
    v_add_f32_dpp v222, v222, v222 row_ror:1 row_mask:0xf bank_mask:0xf
    s_nop 1
    v_add_f32_dpp v222, v222, v222 row_ror:2 row_mask:0xf bank_mask:0xf
    v_smfmac_f32_16x16x64_bf16 v[236:239], v[200:203], v[28:35], v252
    s_nop 0
    v_add_f32_dpp v222, v222, v222 row_ror:4 row_mask:0xf bank_mask:0xf
    s_nop 1
    v_add_f32_dpp v222, v222, v222 row_ror:8 row_mask:0xf bank_mask:0xf
    v_smfmac_f32_16x16x64_bf16 v[240:243], v[200:203], v[36:43], v252
    v_readlane_b32 s64, v222, 32
    v_readlane_b32 s65, v222, 16
    s_waitcnt lgkmcnt(3)
    v_smfmac_f32_16x16x64_bf16 v[232:235], v[204:207], v[44:51], v252
    v_mov_b32 v220, v222
    v_mov_b32 v221, s64
    v_smfmac_f32_16x16x64_bf16 v[236:239], v[204:207], v[52:59], v252
    v_mul_f32 v220, 0x3acccccd, v220
    v_mul_f32 v221, 0x3acccccd, v221
    v_smfmac_f32_16x16x64_bf16 v[240:243], v[204:207], v[60:67], v252
    v_fma_f32 v221, -v220, v220, v221
    v_max_f32 v221, 0, v221
    s_waitcnt lgkmcnt(2)
    v_smfmac_f32_16x16x64_bf16 v[232:235], v[208:211], v[68:75], v252
    v_cvt_pk_bf16_f32 v221, v221, v221
    v_and_b32 v221, 0xffff0000, v221
HF2_1:
    s_cbranch_execz HF_ret
    v_smfmac_f32_16x16x64_bf16 v[236:239], v[208:211], v[76:83], v252
    v_add_f32 v221, 0x3727c5ac, v221
    v_cvt_pk_bf16_f32 v221, v221, v221
    v_smfmac_f32_16x16x64_bf16 v[240:243], v[208:211], v[84:91], v252
    v_and_b32 v221, 0xffff0000, v221
    v_sqrt_f32 v221, v221
    s_waitcnt lgkmcnt(1)
    v_smfmac_f32_16x16x64_bf16 v[232:235], v[212:215], v[92:99], v252
    v_cvt_pk_bf16_f32 v220, v220, v220
    v_and_b32 v220, 0xffff0000, v220
    v_smfmac_f32_16x16x64_bf16 v[236:239], v[212:215], v[100:107], v252
    v_cvt_pk_bf16_f32 v221, v221, v221
    v_and_b32 v221, 0xffff0000, v221
    v_smfmac_f32_16x16x64_bf16 v[240:243], v[212:215], v[108:115], v252
    v_rcp_f32 v221, v221
    v_mul_f32 v222, s55, v220
    s_waitcnt lgkmcnt(0)
    v_smfmac_f32_16x16x64_bf16 v[232:235], v[216:219], v[116:123], v252
    v_sub_f32 v222, s65, v222
    v_mul_f32 v222, v222, v221
    v_smfmac_f32_16x16x64_bf16 v[236:239], v[216:219], v[124:131], v252
    v_ashrrev_i32 v225, 31, v222
    v_or_b32 v225, 0x80000000, v225
    v_smfmac_f32_16x16x64_bf16 v[240:243], v[216:219], v[132:139], v252
    v_xor_b32 v225, v225, v222
    v_and_b32 v225, 0xfffff000, v225
    v_or_b32 v225, s61, v225
    s_mov_b64 exec, 1
    ds_write2_b32 v224, v220, v221 offset0:0 offset1:2
    ds_write2_b32 v224, v222, v223 offset0:4 offset1:6
    ds_max_u64 v8, v[224:225] offset:32
    s_mov_b64 exec, -1
F_pw2:
    v_pk_add_f32 v[232:233], v[232:233], v[234:235]
    ds_write_b64 v3, v[232:233] offset:256
    v_pk_add_f32 v[236:237], v[236:237], v[238:239]
    ds_write_b64 v3, v[236:237] offset:384
    v_pk_add_f32 v[240:241], v[240:241], v[242:243]
    ds_write_b64 v3, v[240:241] offset:512
HF3_0:
    s_cbranch_execz HF3_1
    s_cmp_ge_u32 s48, 2
    v_mov_b64 v[244:245], 0
    v_mov_b64 v[246:247], 0
    v_mov_b64 v[248:249], 0
    v_mov_b64 v[250:251], 0
    s_waitcnt lgkmcnt(0)
    s_barrier
    ds_read_b64 v[224:225], v8 offset:32
    v_mov_b64 v[232:233], 0
    v_mov_b64 v[234:235], 0
    v_mov_b64 v[236:237], 0
    v_mov_b64 v[238:239], 0
    v_mov_b64 v[240:241], 0
    v_mov_b64 v[242:243], 0
    s_waitcnt lgkmcnt(0)
    s_cbranch_scc1 F_gu
    v_add_u32 v227, v224, v4
    ds_read2_b32 v[228:229], v224 offset0:0 offset1:2
    ds_read2st64_b32 v[208:209], v227 offset0:1 offset1:4
    ds_read2st64_b32 v[210:211], v227 offset0:7 offset1:10
    s_waitcnt lgkmcnt(1)
    v_fma_f32 v208, -v228, v0, v208
    v_fma_f32 v209, -v228, v2, v209
    s_waitcnt lgkmcnt(0)
    v_add_f32 v208, v208, v210
    v_add_f32 v209, v209, v211
    v_mul_f32 v208, v208, v229
    v_mul_f32 v209, v209, v229
    v_cvt_pk_bf16_f32 v209, v208, v209
    v_lshlrev_b32 v208, 16, v209
    v_mul_f32 v210, 0xbfb8aa3b, v208
    v_exp_f32 v210, v210
    v_and_b32 v209, s47, v209
    v_add_f32 v210, 1.0, v210
    v_rcp_f32 v210, v210
    s_mov_b32 exec_hi, 0xffff
    v_mul_f32 v208, v208, v210
    v_cvt_pk_bf16_f32 v208, v208, v208
    v_and_b32 v208, 0xffff0000, v208
    v_mul_f32 v208, v208, v209
    v_cvt_pk_bf16_f32 v208, v208, v208
    ds_write_b16 v5, v208 offset:3584
    s_mov_b64 exec, -1
    s_waitcnt lgkmcnt(0)
F_gu:
    s_barrier
    ds_read_b128 v[200:203], v6 offset:3584
    ds_read_b128 v[204:207], v6 offset:3648
HF3_1:
    s_cbranch_execz HF_ret
    v_readfirstlane_b32 s61, v225
    v_mov_b32 v220, 0
    s_and_b32 s61, s61, 0xfff
    s_add_u32 s63, s54, s61
    v_mov_b32 v215, s63
    s_waitcnt lgkmcnt(1)
    v_smfmac_f32_16x16x64_bf16 v[232:235], v[200:203], v[140:147], v252
    v_smfmac_f32_16x16x64_bf16 v[236:239], v[200:203], v[152:159], v252
    v_smfmac_f32_16x16x64_bf16 v[240:243], v[200:203], v[164:171], v252
    v_smfmac_f32_16x16x64_bf16 v[244:247], v[200:203], v[176:183], v252
    v_smfmac_f32_16x16x64_bf16 v[248:251], v[200:203], v[188:195], v252
    s_cmp_lg_u32 s48, 7
    s_cbranch_scc1 F_n7
    s_mov_b64 exec, 0xffffff
    buffer_load_dwordx2 v[220:221], v7, s[24:27], s70 offen sc1
    s_mov_b64 exec, -1
F_n7:
    s_waitcnt lgkmcnt(0)
    v_smfmac_f32_16x16x64_bf16 v[232:235], v[204:207], v[144:151], v252
    v_smfmac_f32_16x16x64_bf16 v[236:239], v[204:207], v[156:163], v252
    v_smfmac_f32_16x16x64_bf16 v[240:243], v[204:207], v[168:175], v252
    v_smfmac_f32_16x16x64_bf16 v[244:247], v[204:207], v[180:187], v252
    v_smfmac_f32_16x16x64_bf16 v[248:251], v[204:207], v[192:199], v252
    s_nop 7
    v_add_f32 v212, v232, v234
    v_add_f32 v213, v236, v238
    v_add_f32 v214, v240, v242
    s_mov_b32 exec_lo, s47
    v_add_f32 v212, v244, v246
    v_add_f32 v213, v248, v250
    s_mov_b32 exec_lo, -1
    s_mov_b32 exec_hi, 0
    buffer_store_dwordx4 v[212:215], v17, s[24:27], s8 offen sc1
    s_mov_b32 exec_hi, -1
    s_cmp_lt_u32 s44, 2
    s_cbranch_scc0 F_rest
    ds_read2_b32 v[228:229], v224 offset0:0 offset1:2
    ds_read2_b32 v[230:231], v224 offset0:4 offset1:6
    s_lshr_b32 s65, s61, 4
    s_mul_i32 s65, s65, 171
    s_lshr_b32 s65, s65, 10
    s_mul_i32 s64, s65, 2560
    s_add_u32 s64, s64, 131072
    s_mul_i32 s71, s65, 96
HF4_0:
    s_cbranch_execz HF4_1
    s_sub_u32 s66, s61, s71
    s_lshr_b32 s71, s65, 1
    s_mul_i32 s71, s71, 86
    s_add_u32 s66, s66, s71
    s_sub_u32 s66, s66, 10
    s_lshl_b32 s66, s66, 1
    s_and_b32 s65, s65, 1
    s_add_u32 s66, s66, s65
    s_mul_i32 s66, s66, 1280
    v_lshrrev_b32 v223, 3, v18
    v_lshlrev_b32 v223, 4, v223
    s_waitcnt lgkmcnt(0)
    v_add_u32 v226, v231, v19
    v_and_b32 v226, 0xfffe, v226
    ds_read_u16 v226, v226
    v_cvt_pk_bf16_f32 v231, v230, v230
    v_and_b32 v231, 0xffff0000, v231
    v_mul_f32 v231, 0xbfb8aa3b, v231
    v_exp_f32 v231, v231
    s_nop 0
    v_add_f32 v231, 1.0, v231
    v_rcp_f32 v231, v231
    s_waitcnt lgkmcnt(0)
    v_lshlrev_b32 v226, 16, v226
    v_cvt_pk_bf16_f32 v231, v231, v231
    v_and_b32 v231, 0xffff0000, v231
    v_sub_f32 v227, v226, v228
    v_cvt_pk_bf16_f32 v227, v227, v227
    v_and_b32 v227, 0xffff0000, v227
    v_mul_f32 v227, v227, v229
    v_cvt_pk_bf16_f32 v227, v227, v227
    v_and_b32 v227, 0xffff0000, v227
    s_waitcnt vmcnt(0)
F_yp:
    buffer_load_dwordx4 v[200:203], v1, s[24:27], s14 offen sc1
    buffer_load_dwordx4 v[204:207], v1, s[24:27], s14 offen offset:1024 sc1
    s_mov_b64 exec, s[18:19]
    buffer_load_dword v222, v223, s[24:27], s64 offen offset:8 sc1
    s_mov_b64 exec, -1
    s_waitcnt vmcnt(1)
    ds_read_b32 v224, v8 offset:40
    v_cmp_ne_u32 vcc, s63, v203
    v_cmp_ne_u32 s[58:59], s63, v207
    v_add_f32 v200, v200, v204
    v_add_f32 v201, v201, v205
    v_add_f32 v202, v202, v206
HF4_1:
    s_cbranch_execz HF_ret
    s_or_b64 vcc, vcc, s[58:59]
    s_cbranch_scc1 F_chk
    v_mov_b32 v203, v202
    v_permlane32_swap_b32 v200, v201
    s_nop 0
    v_permlane32_swap_b32 v202, v203
    v_add_f32 v200, v200, v201
    v_add_f32 v202, v202, v203
    s_nop 1
    v_permlane16_swap_b32 v200, v202
    v_add_f32 v200, v200, v202
    s_nop 1
    v_add_f32_dpp v200, v200, v200 row_ror:8 row_mask:0xf bank_mask:0xf
    v_cvt_pk_bf16_f32 v200, v200, v200
    v_and_b32 v200, 0xffff0000, v200
    v_mul_f32 v200, v200, v231
    v_cvt_pk_bf16_f32 v200, v200, v200
    v_and_b32 v200, 0xffff0000, v200
    v_add_f32 v200, v200, v227
    v_cvt_pk_bf16_f32 v200, v200, v200
    v_and_b32 v200, 0xffff0000, v200
    v_add_f32 v200, v200, v226
    v_cvt_pk_bf16_f32 v200, v200, v200
F_vf:
    s_mov_b64 exec, s[18:19]
    s_waitcnt vmcnt(0) lgkmcnt(0)
    v_readfirstlane_b32 s60, v224
    v_cmp_ne_u32 vcc, s63, v222
    s_and_b32 s62, s60, 0xfff
    s_cmp_lg_u32 s62, s61
    s_cbranch_scc1 F_vw
    s_cbranch_vccnz F_vl
    buffer_store_short v200, v18, s[40:43], s66 offen
    s_or_b32 s65, s49, s44
    s_cbranch_scc1 L_fin
    s_mov_b64 exec, 1
    v_mov_b32 v9, 0
    v_mov_b32 v10, s54
    buffer_store_dword v10, v9, s[24:27], 0 offen
    s_branch L_fin
F_vw:
    s_cmp_lg_u32 s62, 0
    s_cbranch_scc1 F_vx
    s_cbranch_vccz F_vn
F_vl:
    buffer_load_dword v222, v223, s[24:27], s64 offen offset:8 sc1
F_vn:
    ds_read_b32 v224, v8 offset:40
    s_sub_u32 s3, s3, 1
    s_cbranch_scc0 F_vf
    s_mov_b32 s3, 0
    s_branch L_fin
F_vx:
    s_cmp_eq_u32 s17, 0
    s_cbranch_scc1 F_again
HF5_0:
    s_cbranch_execz HF5_1
    s_branch L_fin
F_chk:
    s_waitcnt lgkmcnt(0)
    v_readfirstlane_b32 s60, v224
    s_and_b32 s62, s60, 0xfff
    s_cselect_b32 s62, s62, s61
    s_cmp_lg_u32 s62, s61
    s_cbranch_scc1 F_vx
    s_sub_u32 s3, s3, 1
    s_cbranch_scc0 F_yp
    s_mov_b32 s3, 0
    s_branch L_fin
F_rest:
    s_cmp_lg_u32 s17, 0
    s_cbranch_scc1 L_fin
    s_cmp_lg_u32 s48, 7
    s_cbranch_scc1 F_tw
    s_mov_b64 exec, 0xffffff
    s_waitcnt vmcnt(1)
    s_branch F_tc
F_tp:
    buffer_load_dwordx2 v[220:221], v7, s[24:27], s70 offen sc1
    s_waitcnt vmcnt(0)
F_tc:
    v_cmp_ne_u32 vcc, s54, v221
    s_cbranch_vccz F_tg
    s_sub_u32 s3, s3, 1
    s_cbranch_scc0 F_tp
    s_mov_b32 s3, 0
F_tg:
    s_mov_b64 exec, -1
    v_max_u32_dpp v222, v220, v220 row_ror:1 row_mask:0xf bank_mask:0xf
    s_nop 1
    v_max_u32_dpp v222, v222, v222 row_ror:2 row_mask:0xf bank_mask:0xf
    s_nop 1
    v_max_u32_dpp v222, v222, v222 row_ror:4 row_mask:0xf bank_mask:0xf
    s_nop 1
    v_max_u32_dpp v222, v222, v222 row_ror:8 row_mask:0xf bank_mask:0xf
    s_nop 0
    v_readlane_b32 s60, v222, 0
    v_readlane_b32 s62, v222, 16
    s_max_u32 s60, s60, s62
    s_and_b32 s62, s60, 0xfff
    s_cselect_b32 s60, s60, 1
    v_mov_b32 v220, s60
    ds_write_b32 v8, v220 offset:40
F_tw:
    ds_read_b32 v224, v8 offset:40
    s_waitcnt lgkmcnt(0)
    v_readfirstlane_b32 s60, v224
    s_and_b32 s62, s60, 0xfff
    s_cbranch_scc1 F_tk
    s_sleep 2
    s_sub_u32 s3, s3, 1
    s_cbranch_scc0 F_tw
    s_mov_b32 s3, 0
HF5_1:
    s_cbranch_execz HF_ret
    s_branch L_fin
F_tk:
    s_cmp_eq_u32 s62, s61
    s_cbranch_scc1 L_fin
F_again:
    s_mov_b64 exec, -1
    s_waitcnt vmcnt(0)
    s_mov_b32 s17, 1
    s_mov_b32 s16, 131072
    s_mov_b32 s20, 0x40000
    v_mov_b64 v[224:225], 0
    s_cmp_eq_u32 s48, 0
    s_cselect_b32 s60, s60, 0
    s_cbranch_scc0 F_redo
    ds_write_b64 v8, v[224:225] offset:32
    s_branch F_redo
L_last:
.section .rodata,"a"
.p2align 6
.amdhsa_kernel sequential_preLN__sliding_local_dilated__moe_arch_mod__prompt_kernel
  .amdhsa_next_free_vgpr 256
  .amdhsa_next_free_sgpr 102
  .amdhsa_accum_offset 256
  .amdhsa_group_segment_fixed_size 0
  .amdhsa_kernarg_size 88
  .amdhsa_user_sgpr_count 2
  .amdhsa_user_sgpr_kernarg_segment_ptr 1
  .amdhsa_system_sgpr_workgroup_id_x 1
  .amdhsa_float_denorm_mode_32 3
  .amdhsa_float_denorm_mode_16_64 3
.end_amdhsa_kernel
```

```asm
; @launch grid=(256,1,1) block=(512,1,1) lds=163840
.amdgcn_target "amdgcn-amd-amdhsa--gfx950"
.text
.globl sequential_preLN__sliding_local_dilated__moe_arch_mod__prompt_kernel
.p2align 8
.type sequential_preLN__sliding_local_dilated__moe_arch_mod__prompt_kernel,@function
sequential_preLN__sliding_local_dilated__moe_arch_mod__prompt_kernel:
    s_load_dwordx2 s[28:29], s[0:1], 0
    s_load_dwordx2 s[32:33], s[0:1], 8
    v_readfirstlane_b32 s48, v0
    s_load_dwordx2 s[24:25], s[0:1], 80
    s_load_dwordx2 s[36:37], s[0:1], 16
    s_load_dwordx2 s[40:41], s[0:1], 64
    s_load_dwordx8 s[12:19], s[0:1], 32
    s_lshr_b32 s56, s2, 3
    s_lshr_b32 s48, s48, 6
    s_cmp_ge_u32 s2, 240
    s_cbranch_scc1 F_pre
    s_mul_i32 s51, s56, 86
    s_lshr_b32 s51, s51, 8
    s_and_b32 s66, s2, 7
    s_sub_u32 s53, s66, s51
    s_mul_i32 s53, s53, 3
    s_add_u32 s53, s53, s56
    s_lshr_b32 s55, s53, 1
    s_and_b32 s50, s53, 1
    s_mul_i32 s55, s55, 86
    s_sub_u32 s55, s55, 10
    s_mov_b32 s30, 2621440
    s_mov_b32 s31, 0x00020000
    s_sub_u32 s60, s48, 4
    s_cbranch_scc1 C_pre
    s_lshl_b32 s62, s60, 2
    s_and_b32 s62, s62, 4
    v_bfe_u32 v1, v0, 3, 3
    v_bfe_u32 v2, v0, 4, 2
    v_bitop3_b32 v3, v0, 7, s62 bitop3:0x6a
    s_mul_i32 s62, s60, 24
    s_add_u32 s62, s62, s55
    s_lshl1_add_u32 s62, s62, s50
    s_mul_i32 s62, s62, 1280
    v_xor_b32 v4, v3, v2
    v_mul_u32_u24 v5, 2560, v1
    v_lshl_add_u32 v4, v4, 4, s62
    s_movk_i32 s63, 20480
    v_add_u32 v10, v4, v5
    v_bitop3_b32 v6, v1, 2, v3 bitop3:0x6a
    v_xad_u32 v11, v10, 64, s63
    v_add_u32 v12, 40960, v10
    s_mul_i32 s62, s60, 30720
    s_lshl_b32 s63, s51, 7
    s_add_u32 s62, s62, s63
    v_mul_u32_u24 v5, 3840, v1
    v_lshl_add_u32 v6, v6, 4, s62
    s_mov_b32 s71, s51
    v_add_u32 v13, v5, v6
    s_mul_i32 s65, s60, 3072
    v_add_u32 v14, 256, v13
    v_add_u32 v15, 512, v13
    s_mov_b32 s34, 2457600
    s_mov_b32 s35, 0x00020000
    s_mov_b32 s64, s65
    s_add_u32 s70, s65, 110592
    s_waitcnt lgkmcnt(0)
    s_call_b64 s[98:99], LD_issue
    s_branch LD_cont
LD_issue:
    s_cmp_ge_u32 s66, s71
    s_addc_u32 s68, s66, 0
    s_mov_b32 m0, s65
    s_lshl_b32 s67, s68, 7
    buffer_load_dwordx4 v10, s[28:31], s67 offen lds
    s_add_u32 m0, s65, 1024
    s_mul_i32 s68, s68, 245760
    buffer_load_dwordx4 v11, s[28:31], s67 offen lds
    s_add_u32 m0, s65, 2048
    s_add_u32 s69, s68, 122880
    buffer_load_dwordx4 v12, s[28:31], s67 offen lds
    s_add_u32 m0, s65, 12288
    s_add_u32 s66, s66, 1
    buffer_load_dwordx4 v13, s[32:35], s68 offen offset:0 lds
    buffer_load_dwordx4 v14, s[32:35], s68 offen offset:1024 lds
    buffer_load_dwordx4 v15, s[32:35], s68 offen offset:2048 lds
    s_add_u32 m0, s65, 24576
    s_cmp_eq_u32 s66, 9
    s_cselect_b32 s66, 0, s66
    buffer_load_dwordx4 v13, s[32:35], s69 offen offset:0 lds
    buffer_load_dwordx4 v14, s[32:35], s69 offen offset:1024 lds
    buffer_load_dwordx4 v15, s[32:35], s69 offen offset:2048 lds
    s_add_u32 s65, s65, 36864
    s_cmp_eq_u32 s65, s70
    s_cselect_b32 s65, s64, s65
    s_setpc_b64 s[98:99]
F_pre:
    s_cmp_ge_u32 s2, 256
    s_cbranch_scc1 L_end
    s_getpc_b64 s[58:59]
P_main:
    v_lshlrev_b32 v2, 7, v0
    v_cmp_gt_u32 vcc, L_last-P_main, v2
    s_nop 1
    v_cndmask_b32 v2, 0, v2, vcc
    global_load_dword v219, v2, s[58:59]
    s_branch F_start
C_pre:
    v_and_b32 v0, 63, v0
    s_mov_b32 s3, 0x40000
    s_mov_b32 s47, 0xffff0000
    s_mov_b32 s26, 7340032
    s_mov_b32 s27, 0x00020000
    s_mov_b32 s38, 819200
    s_mov_b32 s39, 0x00020000
    s_mov_b32 s42, 2621440
    s_mov_b32 s43, 0x00020000
    s_sub_u32 s52, s51, 5
    s_cselect_b32 s52, s51, s52
    v_and_b32 v1, 15, v0
    v_lshrrev_b32 v2, 4, v0
    s_mov_b32 s64, 0x21698350
    s_movk_i32 s65, 0x74
    s_lshl_b32 s62, s51, 2
    s_lshr_b64 s[64:65], s[64:65], s62
    s_and_b32 s64, s64, 15
    s_mul_i32 s60, s64, 12
    s_lshl_b32 s61, s48, 2
    s_add_u32 s60, s60, s61
    v_add_u32 v10, s60, v2
    v_add_u32 v11, s55, v10
    v_cmp_gt_i32 vcc, 0, v11
    v_lshl_add_u32 v11, v11, 1, s50
    v_mul_u32_u24 v11, 1280, v11
    v_lshl_add_u32 v11, v1, 4, v11
    v_cndmask_b32 v11, v11, 2.0, vcc
    s_mov_b32 s34, 1280
    s_mov_b32 s35, 0x00020000
    s_lshl_b32 s62, s53, 1
    s_add_u32 s62, s62, s64
    s_mul_i32 s62, s62, 4
    s_add_u32 s62, s62, s61
    s_sub_u32 s62, s62, 32
    s_cmp_lt_u32 s48, 1
    s_cselect_b32 s62, s62, 640
    s_mul_i32 s63, s64, 24
    s_add_u32 s63, s63, s53
    s_add_u32 s63, s63, 192
    s_cmp_lt_u32 s64, 8
    s_cselect_b32 s65, 3, 0
    s_cselect_b32 s62, s63, s62
    s_cselect_b32 s63, 192, 1
    v_lshlrev_b32 v58, 4, v0
    v_lshlrev_b32 v59, 2, v0
    s_waitcnt lgkmcnt(0)
    s_buffer_load_dword s54, s[24:27], 0
    s_mov_b64 s[32:33], s[12:13]
    s_cmp_lt_u32 s48, s65
    s_cbranch_scc0 A_nors
    buffer_load_dwordx4 v[20:23], v11, s[28:31], 0 offen offset:0
    buffer_load_dwordx4 v[24:27], v11, s[28:31], 0 offen offset:256
    buffer_load_dwordx4 v[28:31], v11, s[28:31], 0 offen offset:512
    buffer_load_dwordx4 v[32:35], v11, s[28:31], 0 offen offset:768
    buffer_load_dwordx4 v[36:39], v11, s[28:31], 0 offen offset:1024
    s_branch A_cons
A_nors:
    s_cmp_lg_u32 s48, 3
    s_cbranch_scc1 A_nowr
    buffer_load_dwordx4 v[48:51], v58, s[32:35], 0 offen
    buffer_load_dword v52, v59, s[32:35], 0 offen offset:1024
A_nowr:
    s_cmp_ge_u32 s62, 640
    s_cbranch_scc1 A_cons
    v_mul_u32_u24 v10, s63, v2
    v_add_u32 v10, s62, v10
    v_lshlrev_b32 v12, 4, v1
    v_mul_u32_u24 v11, 1280, v10
    v_add_u32 v11, v11, v12
    buffer_load_dwordx4 v[76:79], v12, s[32:35], 0 offen offset:0
    buffer_load_dwordx4 v[80:83], v12, s[32:35], 0 offen offset:256
    buffer_load_dwordx4 v[84:87], v12, s[32:35], 0 offen offset:512
    buffer_load_dwordx4 v[88:91], v12, s[32:35], 0 offen offset:768
    buffer_load_dwordx4 v[92:95], v12, s[32:35], 0 offen offset:1024
    buffer_load_dwordx4 v[20:23], v11, s[36:39], 0 offen offset:0
    buffer_load_dwordx4 v[24:27], v11, s[36:39], 0 offen offset:256
    buffer_load_dwordx4 v[28:31], v11, s[36:39], 0 offen offset:512
    buffer_load_dwordx4 v[32:35], v11, s[36:39], 0 offen offset:768
    buffer_load_dwordx4 v[36:39], v11, s[36:39], 0 offen offset:1024
A_cons:
    v_mov_b32 v99, 2.0
    v_lshrrev_b32 v3, 1, v1
    v_xor_b32 v3, v3, v2
    v_lshlrev_b32 v3, 4, v3
    v_lshl_add_u32 v4, v1, 7, v3
    v_xor_b32 v5, 64, v4
    v_cmp_eq_u32 vcc, 0, v1
    v_mov_b32 v3, 159744
    s_nop 0
    v_cndmask_b32 v6, v4, v3, vcc
    v_cndmask_b32 v7, v5, v3, vcc
    v_cndmask_b32 v8, 1, 0, vcc
    v_bfe_u32 v14, v0, 2, 2
    v_and_b32 v15, 3, v0
    v_lshrrev_b32 v16, 1, v14
    v_and_b32 v17, 1, v2
    v_lshl_or_b32 v16, v17, 1, v16
    v_xor_b32 v16, s48, v16
    v_lshlrev_b32 v16, 5, v16
    v_lshl_add_u32 v16, v15, 3, v16
    v_lshl_add_u32 v16, v14, 7, v16
    v_mul_u32_u24 v17, 3072, v2
    v_add_u32 v9, v16, v17
    v_mov_b32 v16, 0x3f803f80
    v_mov_b32 v17, v16
    v_mov_b32 v18, v16
    v_mov_b32 v19, v16
    ds_write_b128 v3, v[16:19]
    v_mov_b64 v[100:101], 0
    v_mov_b64 v[102:103], 0
    v_mov_b64 v[104:105], 0
    v_mov_b64 v[106:107], 0
    v_mov_b64 v[108:109], 0
    v_mov_b64 v[110:111], 0
    v_mov_b64 v[112:113], 0
    v_mov_b64 v[114:115], 0
    v_mov_b64 v[116:117], 0
    v_mov_b64 v[118:119], 0
    v_mov_b64 v[120:121], 0
    v_mov_b64 v[122:123], 0
    v_mov_b64 v[124:125], 0
    v_mov_b64 v[126:127], 0
    v_mov_b64 v[128:129], 0
    v_mov_b64 v[130:131], 0
    v_mov_b64 v[132:133], 0
    v_mov_b64 v[134:135], 0
    v_mov_b64 v[136:137], 0
    v_mov_b64 v[138:139], 0
    v_mov_b64 v[140:141], 0
    v_mov_b64 v[142:143], 0
    v_mov_b64 v[144:145], 0
    v_mov_b64 v[146:147], 0
    v_mov_b64 v[148:149], 0
    v_mov_b64 v[150:151], 0
    v_mov_b64 v[152:153], 0
    v_mov_b64 v[154:155], 0
    v_mov_b64 v[156:157], 0
    v_mov_b64 v[158:159], 0
    v_mov_b64 v[160:161], 0
    v_mov_b64 v[162:163], 0
    v_mov_b64 v[164:165], 0
    v_mov_b64 v[166:167], 0
    v_mov_b64 v[168:169], 0
    v_mov_b64 v[170:171], 0
    s_call_b64 s[98:99], S_late
    s_call_b64 s[98:99], S_late2
    s_call_b64 s[98:99], S_late3
    s_call_b64 s[98:99], S_late4
    s_branch A_c2
S_late:
    v_and_b32 v200, 15, v0
    v_lshrrev_b32 v201, 4, v0
    v_lshlrev_b32 v202, 4, v0
    v_lshlrev_b32 v203, 2, v0
    v_lshrrev_b32 v64, 5, v0
    v_and_b32 v65, 12, v200
    s_lshl_b32 s4, s52, 3
    s_sub_u32 s4, 96768, s4
    s_min_u32 s5, s48, 5
    s_lshl_b32 s6, s5, 4
    v_add_u32 v67, s6, v200
    v_mul_u32_u24 v68, 400, v67
    v_mad_u32_u24 v66, v201, 40, s4
    v_add_u32 v71, v68, v66
    v_subrev_u32 v205, 3072, v71
    v_mul_u32_u24 v72, 5, v201
    v_subrev_u32 v72, s52, v72
    v_mov_b32 v73, 159776
    v_add_u32 v74, 0, v72
    v_cmp_gt_u32 vcc, 16, v74
    v_add_u32 v74, 0, v71
    s_nop 0
    v_cndmask_b32 v204, v73, v74, vcc
    v_add_u32 v74, 1, v72
    v_cmp_gt_u32 vcc, 16, v74
    v_add_u32 v74, 8, v71
    s_nop 0
    v_cndmask_b32 v229, v73, v74, vcc
    v_add_u32 v74, 2, v72
    v_cmp_gt_u32 vcc, 16, v74
    v_add_u32 v74, 16, v71
    s_nop 0
    v_cndmask_b32 v230, v73, v74, vcc
    v_add_u32 v74, 3, v72
    v_cmp_gt_u32 vcc, 16, v74
    v_add_u32 v74, 24, v71
    s_nop 0
    v_cndmask_b32 v231, v73, v74, vcc
    v_add_u32 v74, 4, v72
    v_cmp_gt_u32 vcc, 16, v74
    v_add_u32 v74, 32, v71
    s_nop 0
    v_cndmask_b32 v255, v73, v74, vcc
    v_lshlrev_b32 v208, 3, v67
    v_add_u32 v208, 159808, v208
    v_add_u32 v69, s6, v65
    v_lshlrev_b32 v209, 3, v69
    v_add_u32 v209, 159748, v209
    v_and_b32 v70, 3, v0
    v_cmp_gt_u32 vcc, 1, v70
    v_mov_b32 v73, s47
    s_nop 0
    v_cndmask_b32 v207, 0, v73, vcc
    v_cmp_gt_u32 vcc, 3, v70
    s_nop 1
    v_cndmask_b32 v211, 0, v73, vcc
    v_cmp_gt_u32 vcc, 2, v70
    s_nop 1
    v_cndmask_b32 v211, v211, -1, vcc
    s_setpc_b64 s[98:99]
S_late2:
    s_lshl_b32 s7, s5, 12
    s_add_u32 s7, s7, 135184
    v_lshl_add_u32 v66, v0, 6, s7
    v_lshl_add_u32 v210, v65, 1, v66
    s_add_u32 s13, s6, s55
    v_add_u32 v212, s13, v65
    s_mul_i32 s8, s53, 6
    s_mul_i32 s9, s8, 24320
    s_add_u32 s9, s9, 1310720
    s_mul_i32 s0, s48, 24320
    s_add_u32 s0, s0, s9
    v_lshlrev_b32 v206, 4, v200
    v_lshl_add_u32 v206, v64, 8, v206
    v_xor_b32 v213, 256, v206
    v_lshl_add_u32 v213, v64, 12, v213
    s_cmp_lg_u32 s52, 0
    s_cselect_b32 s20, 0x0000ffff, 0
    s_cmp_lg_u32 s52, 4
    s_cselect_b32 s21, s47, 0
    s_cmp_eq_u32 s48, 0
    s_cselect_b32 s7, 0xff00ff00, -1
    s_and_b32 s20, s20, s7
    s_and_b32 s21, s21, s7
    s_lshl_b32 s7, s51, 11
    s_add_u32 s22, s0, s7
    s_sub_u32 s12, s22, 2048
    s_add_u32 s100, s9, 23040
    s_lshr_b32 s7, s51, 1
    s_mul_i32 s7, s7, 23552
    s_mul_i32 s57, s51, 384
    s_add_u32 s7, s7, s57
    s_add_u32 s7, s7, 23552
    s_add_u32 s57, s7, s9
    s_mul_i32 s7, s48, 10
    s_add_u32 s7, s7, s51
    s_lshl_b32 s7, s7, 2
    s_add_u32 s23, s100, s7
    s_sub_u32 s56, s48, 2
    s_cmp_lt_u32 s48, 6
    s_cselect_b32 s101, 0, 1
    s_cselect_b32 s56, s48, s56
    s_mul_i32 s1, s56, 24320
    s_add_u32 s1, s1, s9
    s_add_u32 s8, s8, s56
    s_mul_i32 s44, s53, 2560
    s_lshl_b32 s7, s51, 8
    s_add_u32 s44, s44, s7
    s_add_u32 s44, s44, 262144
    s_lshl_b32 s45, s53, 6
    s_add_u32 s45, s45, 196608
    s_setpc_b64 s[98:99]
S_late3:
    v_bfe_u32 v68, v0, 2, 2
    v_and_b32 v69, 3, v0
    v_lshl_add_u32 v70, v201, 3, v68
    s_lshl_b32 s7, s48, 4
    s_sub_u32 s7, s7, 16
    v_add_u32 v71, s7, v70
    v_and_b32 v72, 15, v71
    v_max_i32 v71, v71, v72
    v_mul_u32_u24 v71, 400, v71
    v_lshl_add_u32 v71, v69, 3, v71
    v_add_u32 v214, 97024, v71
    v_and_b32 v72, 1, v201
    s_cmp_eq_u32 s48, 0
    s_cselect_b32 s7, 8, 0
    v_cmp_gt_u32 vcc, s7, v200
    s_nop 1
    v_cndmask_b32 v249, v202, 2.0, vcc
    v_lshrrev_b32 v71, 1, v68
    v_lshl_or_b32 v71, v72, 1, v71
    v_lshl_add_u32 v70, v201, 2, v68
    v_lshlrev_b32 v70, 7, v70
    v_lshl_add_u32 v70, v69, 3, v70
    s_mul_i32 s7, s101, 40960
    s_add_u32 s7, s7, 12288
    v_add_u32 v70, s7, v70
    s_mul_i32 s7, s101, 36864
    s_sub_u32 s7, 40960, s7
    v_xor_b32 v73, 0, v71
    v_lshl_add_u32 v216, v73, 5, v70
    v_add_u32 v220, s7, v216
    v_xor_b32 v73, 1, v71
    v_lshl_add_u32 v217, v73, 5, v70
    v_add_u32 v221, s7, v217
    v_xor_b32 v73, 2, v71
    v_lshl_add_u32 v218, v73, 5, v70
    v_add_u32 v222, s7, v218
    v_xor_b32 v73, 3, v71
    v_lshl_add_u32 v219, v73, 5, v70
    v_add_u32 v223, s7, v219
    s_setpc_b64 s[98:99]
S_late4:
    s_lshl_b32 s7, s56, 4
    v_add_u32 v73, s7, v200
    v_cmp_gt_u32 vcc, 10, v73
    v_add_u32 v73, s55, v73
    v_lshl_add_u32 v73, v73, 1, s50
    v_mul_u32_u24 v74, 1280, v73
    s_lshl_b32 s7, s51, 7
    v_lshl_add_u32 v75, v201, 3, s7
    v_add_u32 v74, v74, v75
    v_cndmask_b32 v253, v74, 2.0, vcc
    v_cndmask_b32 v254, v73, -1, vcc
    v_add_u32 v227, 161792, v75
    v_mul_u32_u24 v224, 61440, v201
    v_lshl_add_u32 v224, v200, 4, v224
    s_mov_b32 s7, 161024
    v_lshl_add_u32 v228, v201, 5, s7
    v_lshl_add_u32 v252, v69, 5, s7
    v_lshl_add_u32 v252, v68, 3, v252
    v_mul_u32_u24 v225, 24, v72
    v_add_u32 v225, v225, v253
    v_lshl_add_u32 v226, s8, 4, v200
    s_cmp_eq_u32 s101, 1
    s_cselect_b64 vcc, -1, 0
    v_lshrrev_b32 v73, 1, v200
    v_lshrrev_b32 v74, 1, v201
    v_xor_b32 v73, v73, v74
    v_lshlrev_b32 v73, 4, v73
    v_lshl_add_u32 v73, v72, 3, v73
    v_lshl_add_u32 v73, v200, 7, v73
    v_lshl_add_u32 v250, s56, 11, v73
    v_mov_b32 v251, 160784
    s_add_u32 s7, s52, 5
    s_cmp_lt_u32 s51, 5
    s_cselect_b32 s7, s7, s52
    s_lshl_b32 s7, s7, 11
    s_add_u32 s16, s7, s1
    s_lshl_b32 s7, s51, 11
    s_add_u32 s14, s7, s1
    s_add_u32 s15, s1, 20480
    s_cmp_eq_u32 s101, 1
    s_cselect_b32 s14, s16, s14
    s_cselect_b32 s18, 0x3e0, 62
    s_lshl_b32 s7, s101, 10
    s_add_u32 s16, s16, s7
    s_cmp_lt_u32 s48, 4
    s_cselect_b32 s18, 0x3fe, s18
    s_lshl_b32 s18, s18, s51
    s_lshr_b32 s7, s18, 10
    s_or_b32 s18, s18, s7
    s_and_b32 s18, s18, 0x3ff
    s_mov_b32 s19, 0
    s_mul_i32 s17, s56, 40
    s_add_u32 s17, s17, s100
    s_lshl_b32 s7, s48, 12
    s_add_u32 s7, s7, 135168
    v_lshl_add_u32 v73, v200, 6, s7
    v_lshl_add_u32 v73, v201, 4, v73
    v_add_u32 v74, s52, v201
    s_add_u32 s69, s52, 0
    s_mul_i32 s69, s69, 52
    s_lshr_b32 s69, s69, 8
    v_lshl_add_u32 v172, s69, 10, v73
    s_add_u32 s69, s52, 3
    s_mul_i32 s69, s69, 52
    s_lshr_b32 s69, s69, 8
    v_lshl_add_u32 v173, s69, 10, v73
    s_mul_i32 s69, s69, 5
    s_sub_u32 s69, s69, 0
    v_cmp_le_i32 s[4:5], s69, v74
    s_add_u32 s69, s52, 4
    s_mul_i32 s69, s69, 52
    s_lshr_b32 s69, s69, 8
    v_lshl_add_u32 v174, s69, 10, v73
    s_add_u32 s69, s52, 7
    s_mul_i32 s69, s69, 52
    s_lshr_b32 s69, s69, 8
    v_lshl_add_u32 v175, s69, 10, v73
    s_mul_i32 s69, s69, 5
    s_sub_u32 s69, s69, 4
    v_cmp_le_i32 s[6:7], s69, v74
    s_add_u32 s69, s52, 8
    s_mul_i32 s69, s69, 52
    s_lshr_b32 s69, s69, 8
    v_lshl_add_u32 v176, s69, 10, v73
    s_add_u32 s69, s52, 11
    s_mul_i32 s69, s69, 52
    s_lshr_b32 s69, s69, 8
    v_lshl_add_u32 v177, s69, 10, v73
    s_mul_i32 s69, s69, 5
    s_sub_u32 s69, s69, 8
    v_cmp_le_i32 s[8:9], s69, v74
    s_add_u32 s69, s52, 12
    s_mul_i32 s69, s69, 52
    s_lshr_b32 s69, s69, 8
    v_lshl_add_u32 v178, s69, 10, v73
    s_add_u32 s69, s52, 15
    s_mul_i32 s69, s69, 52
    s_lshr_b32 s69, s69, 8
    v_lshl_add_u32 v179, s69, 10, v73
    s_mul_i32 s69, s69, 5
    s_sub_u32 s69, s69, 12
    v_cmp_le_i32 s[10:11], s69, v74
    s_setpc_b64 s[98:99]
A_c2:
    s_waitcnt lgkmcnt(0)
    s_add_u32 s54, s54, 2654435761
    s_lshl_b32 s63, s53, 11
    s_add_u32 s63, s63, 81920
    v_mov_b32 v42, s54
    v_lshlrev_b32 v10, 4, v10
    s_cmp_lt_u32 s48, s65
    s_cbranch_scc0 A_nos
    s_waitcnt vmcnt(4)
    v_dot2_f32_bf16 v40, v20, v16, 0
    v_dot2_f32_bf16 v41, v20, v20, 0
    v_dot2_f32_bf16 v44, v21, v16, 0
    v_dot2_f32_bf16 v45, v21, v21, 0
    v_dot2_f32_bf16 v40, v22, v16, v40
    v_dot2_f32_bf16 v41, v22, v22, v41
    v_dot2_f32_bf16 v44, v23, v16, v44
    v_dot2_f32_bf16 v45, v23, v23, v45
    s_waitcnt vmcnt(3)
    v_dot2_f32_bf16 v40, v24, v16, v40
    v_dot2_f32_bf16 v41, v24, v24, v41
    v_dot2_f32_bf16 v44, v25, v16, v44
    v_dot2_f32_bf16 v45, v25, v25, v45
    v_dot2_f32_bf16 v40, v26, v16, v40
    v_dot2_f32_bf16 v41, v26, v26, v41
    v_dot2_f32_bf16 v44, v27, v16, v44
    v_dot2_f32_bf16 v45, v27, v27, v45
    s_waitcnt vmcnt(2)
    v_dot2_f32_bf16 v40, v28, v16, v40
    v_dot2_f32_bf16 v41, v28, v28, v41
    v_dot2_f32_bf16 v44, v29, v16, v44
    v_dot2_f32_bf16 v45, v29, v29, v45
    v_dot2_f32_bf16 v40, v30, v16, v40
    v_dot2_f32_bf16 v41, v30, v30, v41
    v_dot2_f32_bf16 v44, v31, v16, v44
    v_dot2_f32_bf16 v45, v31, v31, v45
    s_waitcnt vmcnt(1)
    v_dot2_f32_bf16 v40, v32, v16, v40
    v_dot2_f32_bf16 v41, v32, v32, v41
    v_dot2_f32_bf16 v44, v33, v16, v44
    v_dot2_f32_bf16 v45, v33, v33, v45
    v_dot2_f32_bf16 v40, v34, v16, v40
    v_dot2_f32_bf16 v41, v34, v34, v41
    v_dot2_f32_bf16 v44, v35, v16, v44
    v_dot2_f32_bf16 v45, v35, v35, v45
    s_waitcnt vmcnt(0)
    v_dot2_f32_bf16 v40, v36, v16, v40
    v_dot2_f32_bf16 v41, v36, v36, v41
    v_dot2_f32_bf16 v44, v37, v16, v44
    v_dot2_f32_bf16 v45, v37, v37, v45
    v_dot2_f32_bf16 v40, v38, v16, v40
    v_dot2_f32_bf16 v41, v38, v38, v41
    v_dot2_f32_bf16 v44, v39, v16, v44
    v_dot2_f32_bf16 v45, v39, v39, v45
A_red:
    s_nop 1
    v_add_f32 v40, v40, v44
    v_add_f32 v41, v41, v45
    s_nop 0
    v_add_f32_dpp v40, v40, v40 row_ror:1 row_mask:0xf bank_mask:0xf
    v_add_f32_dpp v41, v41, v41 row_ror:1 row_mask:0xf bank_mask:0xf
    s_nop 0
    v_add_f32_dpp v40, v40, v40 row_ror:2 row_mask:0xf bank_mask:0xf
    v_add_f32_dpp v41, v41, v41 row_ror:2 row_mask:0xf bank_mask:0xf
    s_nop 0
    v_add_f32_dpp v40, v40, v40 row_ror:4 row_mask:0xf bank_mask:0xf
    v_add_f32_dpp v41, v41, v41 row_ror:4 row_mask:0xf bank_mask:0xf
    s_nop 0
    v_add_f32_dpp v40, v40, v40 row_ror:8 row_mask:0xf bank_mask:0xf
    v_add_f32_dpp v41, v41, v41 row_ror:8 row_mask:0xf bank_mask:0xf
    s_cselect_b32 s64, s63, 1245184
    s_cbranch_scc0 A_nln
    v_mul_f32 v40, 0x3acccccd, v40
    v_mul_f32 v41, 0x3acccccd, v41
    v_fma_f32 v41, -v40, v40, v41
    v_max_f32 v41, 0, v41
    v_cvt_pk_bf16_f32 v41, v41, v41
    v_and_b32 v41, 0xffff0000, v41
    v_add_f32 v41, 0x3727c5ac, v41
    v_cvt_pk_bf16_f32 v41, v41, v41
    v_and_b32 v41, 0xffff0000, v41
    v_sqrt_f32 v41, v41
    v_cvt_pk_bf16_f32 v40, v40, v40
    v_and_b32 v40, 0xffff0000, v40
    v_cvt_pk_bf16_f32 v41, v41, v41
    v_and_b32 v41, 0xffff0000, v41
    v_rcp_f32 v41, v41
A_nln:
    s_mov_b32 exec_lo, 0x00010001
    s_mov_b32 exec_hi, 0x00010001
    buffer_store_dwordx3 v[40:42], v10, s[24:27], s64 offen sc1
    s_mov_b64 exec, -1
A_w3:
    s_cmp_lg_u32 s48, 3
    s_cbranch_scc1 A_go
    s_getreg_b32 s61, hwreg(HW_REG_XCC_ID)
    s_lshl_b32 s64, s51, 4
    s_add_u32 s64, s64, 1536
    v_mov_b32 v44, s61
    v_mov_b32 v43, s64
    v_mov_b32 v46, s54
    s_mov_b64 exec, 1
    buffer_store_dwordx3 v[44:46], v43, s[24:27], s63 offen sc1
    s_mov_b64 exec, -1
    v_add_u32 v58, 161792, v58
    v_add_u32 v59, 161792, v59
    s_cmp_lt_u32 s62, 640
    s_cbranch_scc1 A_w3l
    s_waitcnt vmcnt(1)
A_w3l:
    ds_write_b128 v58, v[48:51]
    ds_write_b32 v59, v52 offset:1024
    v_dot2_f32_bf16 v25, v48, v16, 0
    v_dot2_f32_bf16 v25, v49, v16, v25
    v_dot2_f32_bf16 v25, v50, v16, v25
    v_dot2_f32_bf16 v25, v51, v16, v25
    v_dot2_f32_bf16 v25, v52, v16, v25
    s_nop 2
    v_add_f32_dpp v25, v25, v25 row_ror:1 row_mask:0xf bank_mask:0xf
    s_nop 1
    v_add_f32_dpp v25, v25, v25 row_ror:2 row_mask:0xf bank_mask:0xf
    s_nop 1
    v_add_f32_dpp v25, v25, v25 row_ror:4 row_mask:0xf bank_mask:0xf
    s_nop 1
    v_add_f32_dpp v25, v25, v25 row_ror:8 row_mask:0xf bank_mask:0xf
    v_mov_b32 v26, v25
    s_nop 1
    v_permlane32_swap_b32 v25, v26
    v_add_f32 v25, v25, v26
    v_mov_b32 v26, v25
    s_nop 1
    v_permlane16_swap_b32 v25, v26
    v_add_f32 v25, v25, v26
    v_mov_b32 v58, 161792
    ds_write_b32 v58, v25 offset:1280
    s_waitcnt lgkmcnt(0)
    s_branch A_go
A_nos:
    s_cmp_ge_u32 s62, 640
    s_cbranch_scc1 A_w3
    s_waitcnt vmcnt(4)
    v_dot2_f32_bf16 v40, v20, v16, 0
    v_dot2_f32_bf16 v41, v20, v76, 0
    v_dot2_f32_bf16 v44, v21, v16, 0
    v_dot2_f32_bf16 v45, v21, v77, 0
    v_dot2_f32_bf16 v40, v22, v16, v40
    v_dot2_f32_bf16 v41, v22, v78, v41
    v_dot2_f32_bf16 v44, v23, v16, v44
    v_dot2_f32_bf16 v45, v23, v79, v45
    s_waitcnt vmcnt(3)
    v_dot2_f32_bf16 v40, v24, v16, v40
    v_dot2_f32_bf16 v41, v24, v80, v41
    v_dot2_f32_bf16 v44, v25, v16, v44
    v_dot2_f32_bf16 v45, v25, v81, v45
    v_dot2_f32_bf16 v40, v26, v16, v40
    v_dot2_f32_bf16 v41, v26, v82, v41
    v_dot2_f32_bf16 v44, v27, v16, v44
    v_dot2_f32_bf16 v45, v27, v83, v45
    s_waitcnt vmcnt(2)
    v_dot2_f32_bf16 v40, v28, v16, v40
    v_dot2_f32_bf16 v41, v28, v84, v41
    v_dot2_f32_bf16 v44, v29, v16, v44
    v_dot2_f32_bf16 v45, v29, v85, v45
    v_dot2_f32_bf16 v40, v30, v16, v40
    v_dot2_f32_bf16 v41, v30, v86, v41
    v_dot2_f32_bf16 v44, v31, v16, v44
    v_dot2_f32_bf16 v45, v31, v87, v45
    s_waitcnt vmcnt(1)
    v_dot2_f32_bf16 v40, v32, v16, v40
    v_dot2_f32_bf16 v41, v32, v88, v41
    v_dot2_f32_bf16 v44, v33, v16, v44
    v_dot2_f32_bf16 v45, v33, v89, v45
    v_dot2_f32_bf16 v40, v34, v16, v40
    v_dot2_f32_bf16 v41, v34, v90, v41
    v_dot2_f32_bf16 v44, v35, v16, v44
    v_dot2_f32_bf16 v45, v35, v91, v45
    s_waitcnt vmcnt(0)
    v_dot2_f32_bf16 v40, v36, v16, v40
    v_dot2_f32_bf16 v41, v36, v92, v41
    v_dot2_f32_bf16 v44, v37, v16, v44
    v_dot2_f32_bf16 v45, v37, v93, v45
    v_dot2_f32_bf16 v40, v38, v16, v40
    v_dot2_f32_bf16 v41, v38, v94, v41
    v_dot2_f32_bf16 v44, v39, v16, v44
    v_dot2_f32_bf16 v45, v39, v95, v45
    s_branch A_red
A_go:
    v_lshlrev_b32 v18, 3, v1
    v_add_u32 v18, 159808, v18
    v_mul_u32_u24 v3, 400, v1
    v_lshl_add_u32 v3, v2, 3, v3
    s_lshl_b32 s60, s48, 5
    s_add_u32 s60, s60, 96768
    v_add_u32 v3, s60, v3
    v_mov_b32 v17, 160768
    s_mov_b32 s60, 0
    v_add_u32 v14, s60, v9
    v_mad_u32_u24 v10, v8, s60, v6
    v_add_u32 v12, s60, v4
    v_mad_u32_u24 v11, v8, s60, v7
    v_add_u32 v13, s60, v5
    s_mov_b32 s61, 0
    s_barrier
    ds_read_b64_tr_b16 v[44:45], v14 offset:12288
    ds_read_b64_tr_b16 v[46:47], v14 offset:12800
    ds_read_b64_tr_b16 v[48:49], v14 offset:13312
    ds_read_b64_tr_b16 v[50:51], v14 offset:13824
    ds_read_b64_tr_b16 v[52:53], v14 offset:14336
    ds_read_b64_tr_b16 v[54:55], v14 offset:14848
    ds_read_b128 v[20:23], v10
    ds_read_b128 v[24:27], v12 offset:2048
    ds_read_b128 v[28:31], v12 offset:4096
    ds_read_b128 v[32:35], v12 offset:6144
    ds_read_b128 v[36:39], v12 offset:8192
    ds_read_b128 v[40:43], v12 offset:10240
A_loop:
    s_waitcnt lgkmcnt(0)
    v_mfma_f32_16x16x32_bf16 v[100:103], v[44:47], v[20:23], v[100:103]
    ds_read_b64_tr_b16 v[80:81], v14 offset:24576
    v_mfma_f32_16x16x32_bf16 v[104:107], v[48:51], v[20:23], v[104:107]
    ds_read_b64_tr_b16 v[82:83], v14 offset:25088
    v_mfma_f32_16x16x32_bf16 v[108:111], v[52:55], v[20:23], v[108:111]
    ds_read_b64_tr_b16 v[84:85], v14 offset:25600
    v_mfma_f32_16x16x32_bf16 v[120:123], v[52:55], v[24:27], v[120:123]
    ds_read_b64_tr_b16 v[86:87], v14 offset:26112
    v_mfma_f32_16x16x32_bf16 v[116:119], v[48:51], v[24:27], v[116:119]
    ds_read_b64_tr_b16 v[88:89], v14 offset:26624
    v_mfma_f32_16x16x32_bf16 v[112:115], v[44:47], v[24:27], v[112:115]
    ds_read_b64_tr_b16 v[90:91], v14 offset:27136
    v_mfma_f32_16x16x32_bf16 v[124:127], v[44:47], v[28:31], v[124:127]
    ds_read_b128 v[56:59], v11
    v_mfma_f32_16x16x32_bf16 v[128:131], v[48:51], v[28:31], v[128:131]
    ds_read_b128 v[60:63], v13 offset:2048
    v_mfma_f32_16x16x32_bf16 v[132:135], v[52:55], v[28:31], v[132:135]
    ds_read_b128 v[64:67], v13 offset:4096
    v_mfma_f32_16x16x32_bf16 v[144:147], v[52:55], v[32:35], v[144:147]
    ds_read_b128 v[68:71], v13 offset:6144
    v_mfma_f32_16x16x32_bf16 v[140:143], v[48:51], v[32:35], v[140:143]
    ds_read_b128 v[72:75], v13 offset:8192
    v_mfma_f32_16x16x32_bf16 v[136:139], v[44:47], v[32:35], v[136:139]
    ds_read_b128 v[76:79], v13 offset:10240
    v_mfma_f32_16x16x32_bf16 v[148:151], v[44:47], v[36:39], v[148:151]
    s_add_u32 s60, s60, 36864
    v_mfma_f32_16x16x32_bf16 v[152:155], v[48:51], v[36:39], v[152:155]
    s_add_u32 s61, s61, 1
    v_mfma_f32_16x16x32_bf16 v[156:159], v[52:55], v[36:39], v[156:159]
    s_cmp_eq_u32 s60, 110592
    v_mfma_f32_16x16x32_bf16 v[168:171], v[52:55], v[40:43], v[168:171]
    s_cselect_b32 s60, 0, s60
    v_mfma_f32_16x16x32_bf16 v[164:167], v[48:51], v[40:43], v[164:167]
    s_cmp_lt_u32 s61, 9
    v_mfma_f32_16x16x32_bf16 v[160:163], v[44:47], v[40:43], v[160:163]
    s_waitcnt lgkmcnt(0)
    v_mfma_f32_16x16x32_bf16 v[100:103], v[80:83], v[56:59], v[100:103]
    v_add_u32 v14, s60, v9
    v_mfma_f32_16x16x32_bf16 v[104:107], v[84:87], v[56:59], v[104:107]
    v_mad_u32_u24 v10, v8, s60, v6
    v_mfma_f32_16x16x32_bf16 v[108:111], v[88:91], v[56:59], v[108:111]
    v_add_u32 v12, s60, v4
    v_mfma_f32_16x16x32_bf16 v[120:123], v[88:91], v[60:63], v[120:123]
    v_mad_u32_u24 v11, v8, s60, v7
    v_mfma_f32_16x16x32_bf16 v[116:119], v[84:87], v[60:63], v[116:119]
    v_add_u32 v13, s60, v5
    v_mfma_f32_16x16x32_bf16 v[112:115], v[80:83], v[60:63], v[112:115]
    s_barrier
    v_mfma_f32_16x16x32_bf16 v[124:127], v[80:83], v[64:67], v[124:127]
    ds_read_b64_tr_b16 v[44:45], v14 offset:12288
    ds_read_b64_tr_b16 v[46:47], v14 offset:12800
    v_mfma_f32_16x16x32_bf16 v[128:131], v[84:87], v[64:67], v[128:131]
    ds_read_b64_tr_b16 v[48:49], v14 offset:13312
    ds_read_b64_tr_b16 v[50:51], v14 offset:13824
    v_mfma_f32_16x16x32_bf16 v[132:135], v[88:91], v[64:67], v[132:135]
    ds_read_b64_tr_b16 v[52:53], v14 offset:14336
    ds_read_b64_tr_b16 v[54:55], v14 offset:14848
    v_mfma_f32_16x16x32_bf16 v[144:147], v[88:91], v[68:71], v[144:147]
    ds_read_b128 v[20:23], v10
    ds_read_b128 v[24:27], v12 offset:2048
    v_mfma_f32_16x16x32_bf16 v[140:143], v[84:87], v[68:71], v[140:143]
    ds_read_b128 v[28:31], v12 offset:4096
    ds_read_b128 v[32:35], v12 offset:6144
    v_mfma_f32_16x16x32_bf16 v[136:139], v[80:83], v[68:71], v[136:139]
    ds_read_b128 v[36:39], v12 offset:8192
    ds_read_b128 v[40:43], v12 offset:10240
    v_mfma_f32_16x16x32_bf16 v[148:151], v[80:83], v[72:75], v[148:151]
    v_mfma_f32_16x16x32_bf16 v[152:155], v[84:87], v[72:75], v[152:155]
    v_mfma_f32_16x16x32_bf16 v[156:159], v[88:91], v[72:75], v[156:159]
    v_mfma_f32_16x16x32_bf16 v[168:171], v[88:91], v[76:79], v[168:171]
    v_mfma_f32_16x16x32_bf16 v[164:167], v[84:87], v[76:79], v[164:167]
    v_mfma_f32_16x16x32_bf16 v[160:163], v[80:83], v[76:79], v[160:163]
    s_cbranch_scc1 A_loop
A_tail:
    s_waitcnt lgkmcnt(0)
    v_mfma_f32_16x16x32_bf16 v[108:111], v[52:55], v[20:23], v[108:111]
    ds_read_b64_tr_b16 v[80:81], v14 offset:24576
    ds_read_b64_tr_b16 v[82:83], v14 offset:25088
    v_mfma_f32_16x16x32_bf16 v[120:123], v[52:55], v[24:27], v[120:123]
    ds_read_b64_tr_b16 v[84:85], v14 offset:25600
    ds_read_b64_tr_b16 v[86:87], v14 offset:26112
    v_mfma_f32_16x16x32_bf16 v[132:135], v[52:55], v[28:31], v[132:135]
    ds_read_b128 v[56:59], v11
    ds_read_b128 v[60:63], v13 offset:2048
    v_mfma_f32_16x16x32_bf16 v[144:147], v[52:55], v[32:35], v[144:147]
    ds_read_b64 v[184:185], v18 offset:0
    ds_read_b64 v[186:187], v18 offset:128
    v_mfma_f32_16x16x32_bf16 v[156:159], v[52:55], v[36:39], v[156:159]
    ds_read_b128 v[64:67], v13 offset:4096
    ds_read_b128 v[68:71], v13 offset:6144
    v_mfma_f32_16x16x32_bf16 v[168:171], v[52:55], v[40:43], v[168:171]
    ds_read_b128 v[72:75], v13 offset:8192
    ds_read_b128 v[76:79], v13 offset:10240
    v_mfma_f32_16x16x32_bf16 v[100:103], v[44:47], v[20:23], v[100:103]
    ds_read_b64_tr_b16 v[88:89], v14 offset:26624
    ds_read_b64_tr_b16 v[90:91], v14 offset:27136
    v_mfma_f32_16x16x32_bf16 v[104:107], v[48:51], v[20:23], v[104:107]
    ds_read_b64 v[188:189], v18 offset:256
    ds_read_b64 v[190:191], v18 offset:384
    v_mfma_f32_16x16x32_bf16 v[112:115], v[44:47], v[24:27], v[112:115]
    ds_read_b64 v[192:193], v18 offset:512
    ds_read_b64 v[194:195], v18 offset:640
    v_mfma_f32_16x16x32_bf16 v[116:119], v[48:51], v[24:27], v[116:119]
    ds_read_b32 v17, v17
    s_waitcnt lgkmcnt(11)
    v_mfma_f32_16x16x32_bf16 v[100:103], v[80:83], v[56:59], v[100:103]
    ds_read_b32 v16, v208 offset:4
    ds_read2_b32 v[4:5], v209 offset0:0 offset1:2
    v_mfma_f32_16x16x32_bf16 v[104:107], v[84:87], v[56:59], v[104:107]
    ds_read2_b32 v[6:7], v209 offset0:4 offset1:6
    ds_read2_b32 v[8:9], v209 offset0:8 offset1:10
    v_mfma_f32_16x16x32_bf16 v[112:115], v[80:83], v[60:63], v[112:115]
    ds_read2_b32 v[10:11], v209 offset0:12 offset1:14
    ds_read2_b32 v[12:13], v209 offset0:16 offset1:18
    v_mfma_f32_16x16x32_bf16 v[116:119], v[84:87], v[60:63], v[116:119]
    ds_read2_b32 v[14:15], v209 offset0:20 offset1:22
    s_waitcnt lgkmcnt(7)
    v_mfma_f32_16x16x32_bf16 v[124:127], v[44:47], v[28:31], v[124:127]
    v_mov_b32_dpp v20, v100 row_newbcast:0 row_mask:0xf bank_mask:0xf
    v_mov_b32_dpp v21, v101 row_newbcast:0 row_mask:0xf bank_mask:0xf
    v_mov_b32_dpp v22, v102 row_newbcast:0 row_mask:0xf bank_mask:0xf
    v_mfma_f32_16x16x32_bf16 v[128:131], v[48:51], v[28:31], v[128:131]
    v_mov_b32_dpp v23, v103 row_newbcast:0 row_mask:0xf bank_mask:0xf
    v_mov_b32_dpp v24, v104 row_newbcast:0 row_mask:0xf bank_mask:0xf
    v_mov_b32_dpp v25, v105 row_newbcast:0 row_mask:0xf bank_mask:0xf
    v_mfma_f32_16x16x32_bf16 v[124:127], v[80:83], v[64:67], v[124:127]
    v_mov_b32_dpp v26, v106 row_newbcast:0 row_mask:0xf bank_mask:0xf
    v_mov_b32_dpp v27, v107 row_newbcast:0 row_mask:0xf bank_mask:0xf
    v_pk_fma_f32 v[100:101], v[184:185], v[20:21], v[100:101] op_sel_hi:[0,1,1] neg_lo:[1,0,0] neg_hi:[1,0,0]
    v_mfma_f32_16x16x32_bf16 v[128:131], v[84:87], v[64:67], v[128:131]
    v_pk_fma_f32 v[102:103], v[184:185], v[22:23], v[102:103] op_sel_hi:[0,1,1] neg_lo:[1,0,0] neg_hi:[1,0,0]
    v_pk_fma_f32 v[104:105], v[184:185], v[24:25], v[104:105] op_sel_hi:[0,1,1] neg_lo:[1,0,0] neg_hi:[1,0,0]
    v_pk_fma_f32 v[106:107], v[184:185], v[26:27], v[106:107] op_sel_hi:[0,1,1] neg_lo:[1,0,0] neg_hi:[1,0,0]
    v_mfma_f32_16x16x32_bf16 v[136:139], v[44:47], v[32:35], v[136:139]
    v_cvt_pk_bf16_f32 v100, v100, v101
    v_cvt_pk_bf16_f32 v101, v102, v103
    ds_write_b64 v3, v[100:101] offset:0
    v_mfma_f32_16x16x32_bf16 v[140:143], v[48:51], v[32:35], v[140:143]
    v_cvt_pk_bf16_f32 v104, v104, v105
    v_cvt_pk_bf16_f32 v105, v106, v107
    ds_write_b64 v3, v[104:105] offset:128
    v_mfma_f32_16x16x32_bf16 v[136:139], v[80:83], v[68:71], v[136:139]
    v_pk_fma_f32 v[112:113], v[186:187], v[20:21], v[112:113] op_sel_hi:[0,1,1] neg_lo:[1,0,0] neg_hi:[1,0,0]
    v_pk_fma_f32 v[114:115], v[186:187], v[22:23], v[114:115] op_sel_hi:[0,1,1] neg_lo:[1,0,0] neg_hi:[1,0,0]
    v_pk_fma_f32 v[116:117], v[186:187], v[24:25], v[116:117] op_sel_hi:[0,1,1] neg_lo:[1,0,0] neg_hi:[1,0,0]
    v_mfma_f32_16x16x32_bf16 v[140:143], v[84:87], v[68:71], v[140:143]
    v_pk_fma_f32 v[118:119], v[186:187], v[26:27], v[118:119] op_sel_hi:[0,1,1] neg_lo:[1,0,0] neg_hi:[1,0,0]
    v_cvt_pk_bf16_f32 v112, v112, v113
    v_cvt_pk_bf16_f32 v113, v114, v115
    v_mfma_f32_16x16x32_bf16 v[148:151], v[44:47], v[36:39], v[148:151]
    ds_write_b64 v3, v[112:113] offset:6400
    v_cvt_pk_bf16_f32 v116, v116, v117
    v_cvt_pk_bf16_f32 v117, v118, v119
    v_mfma_f32_16x16x32_bf16 v[152:155], v[48:51], v[36:39], v[152:155]
    ds_write_b64 v3, v[116:117] offset:6528
    v_readfirstlane_b32 s49, v17
    s_mov_b32 s60, 0x07060503
    v_mfma_f32_16x16x32_bf16 v[148:151], v[80:83], v[72:75], v[148:151]
    s_mov_b32 s61, 0x07060502
    s_mov_b32 s62, 0x07060501
    s_mov_b32 s63, 0x04000c0c
    v_mfma_f32_16x16x32_bf16 v[152:155], v[84:87], v[72:75], v[152:155]
    v_pk_fma_f32 v[124:125], v[188:189], v[20:21], v[124:125] op_sel_hi:[0,1,1] neg_lo:[1,0,0] neg_hi:[1,0,0]
    v_pk_fma_f32 v[126:127], v[188:189], v[22:23], v[126:127] op_sel_hi:[0,1,1] neg_lo:[1,0,0] neg_hi:[1,0,0]
    v_pk_fma_f32 v[128:129], v[188:189], v[24:25], v[128:129] op_sel_hi:[0,1,1] neg_lo:[1,0,0] neg_hi:[1,0,0]
    v_mfma_f32_16x16x32_bf16 v[160:163], v[44:47], v[40:43], v[160:163]
    v_pk_fma_f32 v[130:131], v[188:189], v[26:27], v[130:131] op_sel_hi:[0,1,1] neg_lo:[1,0,0] neg_hi:[1,0,0]
    v_cvt_pk_bf16_f32 v124, v124, v125
    v_cvt_pk_bf16_f32 v125, v126, v127
    v_mfma_f32_16x16x32_bf16 v[164:167], v[48:51], v[40:43], v[164:167]
    ds_write_b64 v3, v[124:125] offset:12800
    v_cvt_pk_bf16_f32 v128, v128, v129
    v_cvt_pk_bf16_f32 v129, v130, v131
    v_mfma_f32_16x16x32_bf16 v[160:163], v[80:83], v[76:79], v[160:163]
    ds_write_b64 v3, v[128:129] offset:12928
    s_mov_b32 s64, 0x0706000c
    s_mov_b32 s66, 0x11111111
    v_mfma_f32_16x16x32_bf16 v[164:167], v[84:87], v[76:79], v[164:167]
    s_mov_b32 s67, s66
    s_mov_b32 s68, 0x33333333
    v_pk_fma_f32 v[136:137], v[190:191], v[20:21], v[136:137] op_sel_hi:[0,1,1] neg_lo:[1,0,0] neg_hi:[1,0,0]
    v_mfma_f32_16x16x32_bf16 v[108:111], v[88:91], v[56:59], v[108:111]
    v_pk_fma_f32 v[138:139], v[190:191], v[22:23], v[138:139] op_sel_hi:[0,1,1] neg_lo:[1,0,0] neg_hi:[1,0,0]
    v_pk_fma_f32 v[140:141], v[190:191], v[24:25], v[140:141] op_sel_hi:[0,1,1] neg_lo:[1,0,0] neg_hi:[1,0,0]
    v_pk_fma_f32 v[142:143], v[190:191], v[26:27], v[142:143] op_sel_hi:[0,1,1] neg_lo:[1,0,0] neg_hi:[1,0,0]
    v_mfma_f32_16x16x32_bf16 v[120:123], v[88:91], v[60:63], v[120:123]
    v_cvt_pk_bf16_f32 v136, v136, v137
    v_cvt_pk_bf16_f32 v137, v138, v139
    ds_write_b64 v3, v[136:137] offset:19200
    v_mfma_f32_16x16x32_bf16 v[132:135], v[88:91], v[64:67], v[132:135]
    v_cvt_pk_bf16_f32 v140, v140, v141
    v_cvt_pk_bf16_f32 v141, v142, v143
    ds_write_b64 v3, v[140:141] offset:19328
    v_mfma_f32_16x16x32_bf16 v[144:147], v[88:91], v[68:71], v[144:147]
    s_mov_b32 s69, s68
    s_mov_b32 s70, 0x77777777
    s_mov_b32 s71, s70
    v_mfma_f32_16x16x32_bf16 v[156:159], v[88:91], v[72:75], v[156:159]
    v_pk_fma_f32 v[148:149], v[192:193], v[20:21], v[148:149] op_sel_hi:[0,1,1] neg_lo:[1,0,0] neg_hi:[1,0,0]
    v_pk_fma_f32 v[150:151], v[192:193], v[22:23], v[150:151] op_sel_hi:[0,1,1] neg_lo:[1,0,0] neg_hi:[1,0,0]
    v_pk_fma_f32 v[152:153], v[192:193], v[24:25], v[152:153] op_sel_hi:[0,1,1] neg_lo:[1,0,0] neg_hi:[1,0,0]
    v_mfma_f32_16x16x32_bf16 v[168:171], v[88:91], v[76:79], v[168:171]
    v_pk_fma_f32 v[154:155], v[192:193], v[26:27], v[154:155] op_sel_hi:[0,1,1] neg_lo:[1,0,0] neg_hi:[1,0,0]
    v_cvt_pk_bf16_f32 v148, v148, v149
    v_cvt_pk_bf16_f32 v149, v150, v151
    ds_write_b64 v3, v[148:149] offset:25600
    v_cvt_pk_bf16_f32 v152, v152, v153
    v_cvt_pk_bf16_f32 v153, v154, v155
    ds_write_b64 v3, v[152:153] offset:25728
    v_pk_fma_f32 v[160:161], v[194:195], v[20:21], v[160:161] op_sel_hi:[0,1,1] neg_lo:[1,0,0] neg_hi:[1,0,0]
    v_pk_fma_f32 v[162:163], v[194:195], v[22:23], v[162:163] op_sel_hi:[0,1,1] neg_lo:[1,0,0] neg_hi:[1,0,0]
    v_pk_fma_f32 v[164:165], v[194:195], v[24:25], v[164:165] op_sel_hi:[0,1,1] neg_lo:[1,0,0] neg_hi:[1,0,0]
    v_pk_fma_f32 v[166:167], v[194:195], v[26:27], v[166:167] op_sel_hi:[0,1,1] neg_lo:[1,0,0] neg_hi:[1,0,0]
    v_cvt_pk_bf16_f32 v160, v160, v161
    v_cvt_pk_bf16_f32 v161, v162, v163
    ds_write_b64 v3, v[160:161] offset:32000
    v_cvt_pk_bf16_f32 v164, v164, v165
    v_cvt_pk_bf16_f32 v165, v166, v167
    ds_write_b64 v3, v[164:165] offset:32128
    s_setprio 2
    s_branch AT_e2
AT_start:
    s_setprio 3
    ds_read_b32 v16, v208 offset:4
    ds_read2_b32 v[4:5], v209 offset0:0 offset1:2
    ds_read2_b32 v[6:7], v209 offset0:4 offset1:6
    ds_read2_b32 v[8:9], v209 offset0:8 offset1:10
    ds_read2_b32 v[10:11], v209 offset0:12 offset1:14
    ds_read2_b32 v[12:13], v209 offset0:16 offset1:18
    ds_read2_b32 v[14:15], v209 offset0:20 offset1:22
    s_mov_b32 s60, 0x07060503
    s_mov_b32 s61, 0x07060502
    s_mov_b32 s62, 0x07060501
    s_mov_b32 s63, 0x04000c0c
    s_mov_b32 s64, 0x0706000c
    s_mov_b32 s66, 0x11111111
    s_mov_b32 s67, s66
    s_mov_b32 s68, 0x33333333
    s_mov_b32 s69, s68
    s_mov_b32 s70, 0x77777777
    s_mov_b32 s71, s70
    v_mov_b32 v3, 0
AT_e2:
    s_waitcnt lgkmcnt(0)
    s_barrier
    s_branch AT_qk
AT_67:
    s_waitcnt vmcnt(11)
    ds_write_b128 v99, v[100:103] offset:2048
    s_waitcnt vmcnt(10)
    ds_write_b128 v99, v[104:107] offset:0
    s_waitcnt vmcnt(9)
    ds_write_b128 v99, v[108:111] offset:6144
    s_waitcnt vmcnt(8)
    ds_write_b128 v99, v[112:115] offset:4096
    s_waitcnt vmcnt(7)
    ds_write_b128 v99, v[116:119] offset:10240
    s_waitcnt vmcnt(6)
    ds_write_b128 v99, v[120:123] offset:8192
    s_waitcnt vmcnt(5)
    ds_write_b128 v99, v[124:127] offset:14336
    s_waitcnt vmcnt(4)
    ds_write_b128 v99, v[128:131] offset:12288
    s_waitcnt vmcnt(3)
    ds_write_b128 v99, v[132:135] offset:18432
    s_waitcnt vmcnt(2)
    ds_write_b128 v99, v[136:139] offset:16384
    s_waitcnt vmcnt(1)
    ds_write_b128 v99, v[140:143] offset:22528
    s_waitcnt vmcnt(0)
    ds_write_b128 v99, v[144:147] offset:20480
    v_mov_b32 v19, 1
    s_mov_b64 exec, 1
    ds_add_u32 v251, v19
    s_mov_b64 exec, -1
    s_mov_b32 s62, 1
    s_waitcnt vmcnt(0)
    s_branch B_ww
AT_qk:
    ds_read_b64 v[20:21], v204
    ds_read_b64 v[30:31], v205 offset:0
    ds_read_b64 v[40:41], v205 offset:1600
    ds_read_b64 v[50:51], v205 offset:3200
    ds_read_b64 v[22:23], v229
    ds_read_b64 v[32:33], v205 offset:8
    ds_read_b64 v[42:43], v205 offset:1608
    ds_read_b64 v[52:53], v205 offset:3208
    ds_read_b64 v[24:25], v230
    ds_read_b64 v[34:35], v205 offset:16
    ds_read_b64 v[44:45], v205 offset:1616
    ds_read_b64 v[54:55], v205 offset:3216
    ds_read_b64 v[26:27], v231
    ds_read_b64 v[36:37], v205 offset:24
    ds_read_b64 v[46:47], v205 offset:1624
    ds_read_b64 v[56:57], v205 offset:3224
    ds_read_b64 v[28:29], v255
    ds_read_b64 v[38:39], v205 offset:32
    ds_read_b64 v[48:49], v205 offset:1632
    ds_read_b64 v[58:59], v205 offset:3232
    v_cndmask_b32 v13, v13, v5, s[66:67]
    v_cndmask_b32 v14, v14, v6, s[68:69]
    v_cndmask_b32 v15, v15, v7, s[70:71]
    v_mov_b32 v79, s54
    v_mov_b32 v83, s54
    v_mov_b32 v87, s54
    v_mov_b64 v[88:89], 0
    v_mov_b64 v[90:91], 0
    v_mov_b64 v[92:93], 0
    v_mov_b64 v[94:95], 0
    v_mul_f32 v16, 0x3ea52b5c, v16
    v_mul_f32 v148, v16, v8
    v_mul_f32 v149, v16, v9
    v_mul_f32 v150, v16, v10
    v_mul_f32 v151, v16, v11
    v_mul_f32 v152, v16, v12
    v_mul_f32 v153, v16, v13
    v_mul_f32 v154, v16, v14
    v_mul_f32 v155, v16, v15
    s_waitcnt lgkmcnt(15)
    v_mfma_f32_4x4x4_16b_bf16 v[60:63], v[30:31], v[20:21], 0
    v_mfma_f32_4x4x4_16b_bf16 v[64:67], v[40:41], v[20:21], 0
    v_mfma_f32_4x4x4_16b_bf16 v[68:71], v[50:51], v[20:21], 0
    s_waitcnt lgkmcnt(12)
    v_mfma_f32_4x4x4_16b_bf16 v[60:63], v[32:33], v[22:23], v[60:63]
    v_mfma_f32_4x4x4_16b_bf16 v[64:67], v[42:43], v[22:23], v[64:67]
    v_mfma_f32_4x4x4_16b_bf16 v[68:71], v[52:53], v[22:23], v[68:71]
    s_waitcnt lgkmcnt(8)
    v_mfma_f32_4x4x4_16b_bf16 v[60:63], v[34:35], v[24:25], v[60:63]
    v_mfma_f32_4x4x4_16b_bf16 v[64:67], v[44:45], v[24:25], v[64:67]
    v_mfma_f32_4x4x4_16b_bf16 v[68:71], v[54:55], v[24:25], v[68:71]
    s_waitcnt lgkmcnt(4)
    v_mfma_f32_4x4x4_16b_bf16 v[60:63], v[36:37], v[26:27], v[60:63]
    v_mfma_f32_4x4x4_16b_bf16 v[64:67], v[46:47], v[26:27], v[64:67]
    v_mfma_f32_4x4x4_16b_bf16 v[68:71], v[56:57], v[26:27], v[68:71]
    s_waitcnt lgkmcnt(0)
    v_mfma_f32_4x4x4_16b_bf16 v[60:63], v[38:39], v[28:29], v[60:63]
    v_mfma_f32_4x4x4_16b_bf16 v[64:67], v[48:49], v[28:29], v[64:67]
    v_mfma_f32_4x4x4_16b_bf16 v[68:71], v[58:59], v[28:29], v[68:71]
    s_cmp_lt_i32 s13, 8
    s_cbranch_scc1 AT_mask
AT_nomask:
    s_nop 2
    v_cndmask_b32 v69, v69, v61, s[66:67]
    v_cndmask_b32 v70, v70, v62, s[68:69]
    v_cndmask_b32 v71, v71, v63, s[70:71]
    v_pk_mul_f32 v[64:65], v[64:65], v[148:149]
    v_pk_mul_f32 v[66:67], v[66:67], v[150:151]
    v_pk_mul_f32 v[68:69], v[68:69], v[152:153]
    v_pk_mul_f32 v[70:71], v[70:71], v[154:155]
    v_perm_b32 v80, v64, v67, s60
    v_perm_b32 v81, v65, v67, s61
    v_perm_b32 v82, v66, v67, s62
    v_perm_b32 v84, v68, v71, s60
    v_perm_b32 v85, v69, v71, s61
    v_perm_b32 v86, v70, v71, s62
    s_mov_b64 exec, s[20:21]
    s_cmp_eq_u32 s49, 0
    s_cbranch_scc1 sts_1
    buffer_store_dwordx4 v[80:83], v213, s[24:27], s12 offen offset:0
    buffer_store_dwordx4 v[84:87], v213, s[24:27], s12 offen offset:512
std_2:
    s_mov_b64 exec, -1
    s_cmp_ge_u32 s48, 4
    s_cbranch_scc1 AT_vw
    v_mov_b32_dpp v196, v108 row_newbcast:0 row_mask:0xf bank_mask:0xf
    v_mov_b32_dpp v197, v109 row_newbcast:0 row_mask:0xf bank_mask:0xf
    v_mov_b32_dpp v198, v110 row_newbcast:0 row_mask:0xf bank_mask:0xf
    v_mov_b32_dpp v199, v111 row_newbcast:0 row_mask:0xf bank_mask:0xf
    v_pk_fma_f32 v[108:109], v[184:185], v[196:197], v[108:109] op_sel_hi:[0,1,1] neg_lo:[1,0,0] neg_hi:[1,0,0]
    v_pk_fma_f32 v[120:121], v[186:187], v[196:197], v[120:121] op_sel_hi:[0,1,1] neg_lo:[1,0,0] neg_hi:[1,0,0]
    v_pk_fma_f32 v[132:133], v[188:189], v[196:197], v[132:133] op_sel_hi:[0,1,1] neg_lo:[1,0,0] neg_hi:[1,0,0]
    v_pk_fma_f32 v[110:111], v[184:185], v[198:199], v[110:111] op_sel_hi:[0,1,1] neg_lo:[1,0,0] neg_hi:[1,0,0]
    v_pk_fma_f32 v[122:123], v[186:187], v[198:199], v[122:123] op_sel_hi:[0,1,1] neg_lo:[1,0,0] neg_hi:[1,0,0]
    v_pk_fma_f32 v[134:135], v[188:189], v[198:199], v[134:135] op_sel_hi:[0,1,1] neg_lo:[1,0,0] neg_hi:[1,0,0]
    v_cvt_pk_bf16_f32 v108, v108, v109
    v_cvt_pk_bf16_f32 v120, v120, v121
    v_cvt_pk_bf16_f32 v132, v132, v133
    v_cvt_pk_bf16_f32 v109, v110, v111
    v_cvt_pk_bf16_f32 v121, v122, v123
    v_cvt_pk_bf16_f32 v133, v134, v135
    ds_write_b64 v3, v[108:109] offset:256
    ds_write_b64 v3, v[120:121] offset:6656
    ds_write_b64 v3, v[132:133] offset:13056
    v_pk_fma_f32 v[144:145], v[190:191], v[196:197], v[144:145] op_sel_hi:[0,1,1] neg_lo:[1,0,0] neg_hi:[1,0,0]
    v_pk_fma_f32 v[156:157], v[192:193], v[196:197], v[156:157] op_sel_hi:[0,1,1] neg_lo:[1,0,0] neg_hi:[1,0,0]
    v_pk_fma_f32 v[168:169], v[194:195], v[196:197], v[168:169] op_sel_hi:[0,1,1] neg_lo:[1,0,0] neg_hi:[1,0,0]
    v_pk_fma_f32 v[146:147], v[190:191], v[198:199], v[146:147] op_sel_hi:[0,1,1] neg_lo:[1,0,0] neg_hi:[1,0,0]
    v_pk_fma_f32 v[158:159], v[192:193], v[198:199], v[158:159] op_sel_hi:[0,1,1] neg_lo:[1,0,0] neg_hi:[1,0,0]
    v_pk_fma_f32 v[170:171], v[194:195], v[198:199], v[170:171] op_sel_hi:[0,1,1] neg_lo:[1,0,0] neg_hi:[1,0,0]
    v_cvt_pk_bf16_f32 v144, v144, v145
    v_cvt_pk_bf16_f32 v156, v156, v157
    v_cvt_pk_bf16_f32 v168, v168, v169
    v_cvt_pk_bf16_f32 v145, v146, v147
    v_cvt_pk_bf16_f32 v157, v158, v159
    v_cvt_pk_bf16_f32 v169, v170, v171
    ds_write_b64 v3, v[144:145] offset:19456
    ds_write_b64 v3, v[156:157] offset:25856
    ds_write_b64 v3, v[168:169] offset:32256
    v_mov_b32 v19, 1
    s_mov_b64 exec, 1
    ds_add_u32 v251, v19 offset:8
    s_mov_b64 exec, -1
AT_vw:
    v_lshl_add_u32 v17, v201, 3, v251
    ds_read2_b64 v[156:159], v17 offset0:14 offset1:18
    ds_read2_b64 v[160:163], v17 offset0:22 offset1:26
    v_and_b32 v164, 2, v201
    v_lshl_add_u32 v164, v200, 2, v164
    s_lshl_b32 s65, s48, 6
    s_add_u32 s65, s65, s57
    s_mov_b64 exec, s[20:21]
AT_poll:
    buffer_load_dwordx4 v[88:91], v206, s[24:27], s22 offen offset:0 sc1
    buffer_load_dwordx4 v[92:95], v206, s[24:27], s22 offen offset:512 sc1
AT_pw:
    s_waitcnt vmcnt(0)
    v_cmp_ne_u32 vcc, s54, v91
    v_cmp_ne_u32 s[58:59], s54, v95
    s_or_b64 vcc, vcc, s[58:59]
    s_cbranch_vccz AT_got
    s_sub_u32 s3, s3, 1
    s_cbranch_scc0 AT_poll
    s_mov_b32 s3, 0
AT_got:
    s_mov_b64 exec, -1
    ds_read_b32 v17, v251 offset:8
    s_cmp_lt_u32 s48, 4
    s_cbranch_scc1 AT_w0
    v_mov_b32 v19, 1
    s_mov_b64 exec, 1
    ds_add_u32 v251, v19
    s_mov_b64 exec, -1
AT_w0:
    v_perm_b32 v91, v88, v89, s63
    v_perm_b32 v95, v92, v93, s63
    v_perm_b32 v91, v91, v90, s64
    v_perm_b32 v95, v95, v94, s64
    v_pk_add_f32 v[64:65], v[64:65], v[88:89]
    v_pk_add_f32 v[68:69], v[68:69], v[92:93]
    v_pk_add_f32 v[66:67], v[66:67], v[90:91]
    v_pk_add_f32 v[70:71], v[70:71], v[94:95]
    v_max3_f32 v18, v64, v65, v66
    v_max3_f32 v19, v67, v68, v69
    v_max3_f32 v18, v18, v70, v71
    v_max_f32 v18, v18, v19
    v_pk_add_f32 v[64:65], v[64:65], v[18:19] op_sel_hi:[1,0] neg_lo:[0,1] neg_hi:[0,1]
    v_pk_add_f32 v[66:67], v[66:67], v[18:19] op_sel_hi:[1,0] neg_lo:[0,1] neg_hi:[0,1]
    v_pk_add_f32 v[68:69], v[68:69], v[18:19] op_sel_hi:[1,0] neg_lo:[0,1] neg_hi:[0,1]
    v_pk_add_f32 v[70:71], v[70:71], v[18:19] op_sel_hi:[1,0] neg_lo:[0,1] neg_hi:[0,1]
AT_vc:
    s_waitcnt lgkmcnt(0)
    v_cmp_ne_u32 vcc, 4, v17
    s_cbranch_vccnz AT_vs
AT_vg:
    ds_read_b64_tr_b16 v[100:101], v214 offset:0
    ds_read_b64_tr_b16 v[102:103], v214 offset:1600
    ds_read_b64_tr_b16 v[104:105], v214 offset:32
    ds_read_b64_tr_b16 v[106:107], v214 offset:1632
    ds_read_b64_tr_b16 v[108:109], v214 offset:64
    ds_read_b64_tr_b16 v[110:111], v214 offset:1664
    ds_read_b64_tr_b16 v[112:113], v214 offset:96
    ds_read_b64_tr_b16 v[114:115], v214 offset:1696
    v_exp_f32 v64, v64
    v_exp_f32 v65, v65
    v_exp_f32 v66, v66
    v_exp_f32 v67, v67
    v_exp_f32 v68, v68
    v_exp_f32 v69, v69
    v_exp_f32 v70, v70
    v_exp_f32 v71, v71
    v_pk_add_f32 v[20:21], v[64:65], v[66:67]
    v_pk_add_f32 v[22:23], v[68:69], v[70:71]
    v_pk_add_f32 v[20:21], v[20:21], v[22:23]
    v_add_f32 v20, v20, v21
    v_rcp_f32 v20, v20
    v_pk_mul_f32 v[64:65], v[64:65], v[8:9]
    v_pk_mul_f32 v[66:67], v[66:67], v[10:11]
    v_pk_mul_f32 v[68:69], v[68:69], v[12:13]
    v_pk_mul_f32 v[70:71], v[70:71], v[14:15]
    v_pk_mul_f32 v[64:65], v[64:65], v[20:21] op_sel_hi:[1,0]
    v_pk_mul_f32 v[66:67], v[66:67], v[20:21] op_sel_hi:[1,0]
    v_pk_mul_f32 v[68:69], v[68:69], v[20:21] op_sel_hi:[1,0]
    v_pk_mul_f32 v[70:71], v[70:71], v[20:21] op_sel_hi:[1,0]
    v_cvt_pk_bf16_f32 v24, v64, v65
    v_cvt_pk_bf16_f32 v25, v66, v67
    v_cvt_pk_bf16_f32 v26, v68, v69
    v_cvt_pk_bf16_f32 v27, v70, v71
    ds_write_b64 v210, v[24:25] offset:8
    v_and_b32 v28, v26, v207
    v_and_b32 v29, v27, v211
    ds_write_b64 v210, v[28:29]
    v_xor_b32 v26, v26, v28
    v_xor_b32 v27, v27, v29
    ds_write_b64 v210, v[26:27] offset:16
    ds_read_b128 v[116:119], v172
    ds_read_b128 v[120:123], v173
    ds_read_b128 v[124:127], v174
    ds_read_b128 v[128:131], v175
    ds_read_b128 v[132:135], v176
    ds_read_b128 v[136:139], v177
    ds_read_b128 v[140:143], v178
    ds_read_b128 v[144:147], v179
    s_cmp_lt_u32 s48, 4
    s_cbranch_scc1 AT_pv
    s_lshl_b32 s58, s48, 2
    s_add_u32 s58, s58, 160760
    v_mov_b32 v18, s58
    v_mov_b32 v19, 1
    ds_write_b32 v18, v19
AT_pv:
    s_waitcnt lgkmcnt(6)
    v_mfma_f32_16x16x32_bf16 v[20:23], v[100:103], v[116:119], 0
    v_mfma_f32_16x16x32_bf16 v[24:27], v[100:103], v[120:123], 0
    s_waitcnt lgkmcnt(4)
    v_mfma_f32_16x16x32_bf16 v[28:31], v[104:107], v[124:127], 0
    v_mfma_f32_16x16x32_bf16 v[32:35], v[104:107], v[128:131], 0
    s_waitcnt lgkmcnt(2)
    v_mfma_f32_16x16x32_bf16 v[36:39], v[108:111], v[132:135], 0
    v_mfma_f32_16x16x32_bf16 v[40:43], v[108:111], v[136:139], 0
    s_waitcnt lgkmcnt(0)
    v_mfma_f32_16x16x32_bf16 v[44:47], v[112:115], v[140:143], 0
    v_mfma_f32_16x16x32_bf16 v[48:51], v[112:115], v[144:147], 0
    v_cndmask_b32 v20, v20, v24, s[4:5]
    v_cndmask_b32 v21, v21, v25, s[4:5]
    v_cndmask_b32 v22, v22, v26, s[4:5]
    v_cndmask_b32 v23, v23, v27, s[4:5]
    v_cvt_pk_bf16_f32 v204, v20, v21
    v_cvt_pk_bf16_f32 v205, v22, v23
    v_cndmask_b32 v28, v28, v32, s[6:7]
    v_cndmask_b32 v29, v29, v33, s[6:7]
    v_cndmask_b32 v30, v30, v34, s[6:7]
    v_cndmask_b32 v31, v31, v35, s[6:7]
    v_cvt_pk_bf16_f32 v206, v28, v29
    v_cvt_pk_bf16_f32 v207, v30, v31
    v_cndmask_b32 v36, v36, v40, s[8:9]
    v_cndmask_b32 v37, v37, v41, s[8:9]
    v_cndmask_b32 v38, v38, v42, s[8:9]
    v_cndmask_b32 v39, v39, v43, s[8:9]
    v_cvt_pk_bf16_f32 v208, v36, v37
    v_cvt_pk_bf16_f32 v209, v38, v39
    v_cndmask_b32 v44, v44, v48, s[10:11]
    v_cndmask_b32 v45, v45, v49, s[10:11]
    v_cndmask_b32 v46, v46, v50, s[10:11]
    v_cndmask_b32 v47, v47, v51, s[10:11]
    v_cvt_pk_bf16_f32 v210, v44, v45
    v_cvt_pk_bf16_f32 v211, v46, v47
    s_cmp_eq_u32 s49, 0
    s_cbranch_scc1 sts_3
    buffer_store_dwordx4 v[204:207], v249, s[24:27], s22 offen offset:0
    buffer_store_dwordx4 v[208:211], v249, s[24:27], s22 offen offset:1024
std_4:
    s_mov_b64 exec, s[18:19]
    buffer_load_dword v18, v203, s[24:27], s17 offen sc1
    s_mov_b64 exec, -1
    v_dot2_f32_bf16 v20, v204, v156, 0
    v_dot2_f32_bf16 v21, v204, v204, 0
    v_dot2_f32_bf16 v20, v205, v157, v20
    v_dot2_f32_bf16 v21, v205, v205, v21
    v_dot2_f32_bf16 v20, v206, v158, v20
    v_dot2_f32_bf16 v21, v206, v206, v21
    v_dot2_f32_bf16 v20, v207, v159, v20
    v_dot2_f32_bf16 v21, v207, v207, v21
    v_dot2_f32_bf16 v20, v208, v160, v20
    v_dot2_f32_bf16 v21, v208, v208, v21
    v_dot2_f32_bf16 v20, v209, v161, v20
    v_dot2_f32_bf16 v21, v209, v209, v21
    v_dot2_f32_bf16 v20, v210, v162, v20
    v_dot2_f32_bf16 v21, v210, v210, v21
    v_dot2_f32_bf16 v20, v211, v163, v20
    v_dot2_f32_bf16 v21, v211, v211, v21
    s_nop 2
    v_permlane32_swap_b32 v20, v21
    v_add_f32 v20, v20, v21
    v_mov_b32 v21, v20
    s_nop 1
    v_permlane16_swap_b32 v20, v21
    s_mov_b32 exec_lo, 0xffff
    s_mov_b32 exec_hi, 0xffff
    v_add_f32 v20, v20, v21
    s_cmp_eq_u32 s49, 0
    s_cbranch_scc1 sts_5
    buffer_store_short_d16_hi v20, v164, s[24:27], s65 offen
std_6:
    s_mov_b64 exec, -1
    ds_read_b32 v19, v251
    ds_read2_b64 v[240:243], v227 offset0:0 offset1:4
    ds_read2_b64 v[244:247], v227 offset0:8 offset1:12
    ds_read_b32 v248, v251 offset:2288
    ds_read_b64 v[232:233], v250
    v_xor_b32 v4, 32, v250
    ds_read_b64 v[234:235], v4
    v_xor_b32 v5, 64, v250
    ds_read_b64 v[236:237], v5
    v_xor_b32 v6, 96, v250
    ds_read_b64 v[238:239], v6
    v_cmp_gt_u32 vcc, 2048, v254
    s_mov_b64 s[4:5], vcc
    s_waitcnt vmcnt(2)
    s_mov_b64 exec, 1
    s_cmp_eq_u32 s49, 0
    s_cbranch_scc1 sts_7
    buffer_store_dword v79, v203, s[24:27], s23 offen
std_8:
    s_mov_b64 exec, -1
    s_waitcnt vmcnt(2)
    v_cmp_ne_u32 vcc, s54, v18
    s_and_b32 s62, vcc_lo, s18
    s_cbranch_scc1 B_st0
    s_add_u32 s14, s14, 2048
    s_cmp_eq_u32 s14, s15
    s_cselect_b32 s14, s1, s14
    buffer_load_dwordx4 v[168:171], v249, s[24:27], s14 offen offset:0 sc1
    buffer_load_dwordx4 v[172:175], v249, s[24:27], s14 offen offset:1024 sc1
    s_add_u32 s14, s14, 2048
    s_cmp_eq_u32 s14, s15
    s_cselect_b32 s14, s1, s14
    buffer_load_dwordx4 v[176:179], v249, s[24:27], s14 offen offset:0 sc1
    buffer_load_dwordx4 v[180:183], v249, s[24:27], s14 offen offset:1024 sc1
    s_add_u32 s14, s14, 2048
    s_cmp_eq_u32 s14, s15
    s_cselect_b32 s14, s1, s14
    buffer_load_dwordx4 v[212:215], v249, s[24:27], s14 offen offset:0 sc1
    buffer_load_dwordx4 v[12:15], v249, s[24:27], s14 offen offset:1024 sc1
B_st0:
B_start:
    s_branch B_wc
B_ww:
    ds_read_b32 v19, v251
B_wc:
    s_waitcnt lgkmcnt(0)
    v_cmp_ne_u32 vcc, 4, v19
    s_cbranch_vccz B_wd
    s_sleep 1
    s_sub_u32 s3, s3, 1
    s_cbranch_scc0 B_ww
    s_mov_b32 s3, 0
B_wd:
    s_mov_b32 exec_lo, 0x00010001
    s_mov_b32 exec_hi, 0x00010001
    v_mov_b32 v240, 0x3f803f80
    v_mov_b32 v241, 0x3f803f80
    v_mov_b32 v242, 0x3f803f80
    v_mov_b32 v243, 0x3f803f80
    v_mov_b32 v244, 0x3f803f80
    v_mov_b32 v245, 0x3f803f80
    v_mov_b32 v246, 0x3f803f80
    v_mov_b32 v247, 0x3f803f80
    s_mov_b64 exec, -1
    s_setprio 0
    s_cmp_ge_u32 s48, 6
    s_cbranch_scc1 B_r2
    ds_read_b64_tr_b16 v[20:21], v216 offset:0
    ds_read_b64_tr_b16 v[22:23], v216 offset:2048
    ds_read_b64_tr_b16 v[24:25], v217 offset:0
    ds_read_b64_tr_b16 v[26:27], v217 offset:2048
    ds_read_b64_tr_b16 v[28:29], v218 offset:0
    ds_read_b64_tr_b16 v[30:31], v218 offset:2048
    ds_read_b64_tr_b16 v[32:33], v219 offset:0
    ds_read_b64_tr_b16 v[34:35], v219 offset:2048
    ds_read_b64_tr_b16 v[36:37], v216 offset:4096
    ds_read_b64_tr_b16 v[38:39], v216 offset:6144
    ds_read_b64_tr_b16 v[40:41], v217 offset:4096
    ds_read_b64_tr_b16 v[42:43], v217 offset:6144
    ds_read_b64_tr_b16 v[44:45], v218 offset:4096
    ds_read_b64_tr_b16 v[46:47], v218 offset:6144
    ds_read_b64_tr_b16 v[48:49], v219 offset:4096
    ds_read_b64_tr_b16 v[50:51], v219 offset:6144
B_r2:
    ds_read_b64_tr_b16 v[52:53], v216 offset:8192
    ds_read_b64_tr_b16 v[54:55], v216 offset:10240
    ds_read_b64_tr_b16 v[56:57], v217 offset:8192
    ds_read_b64_tr_b16 v[58:59], v217 offset:10240
    ds_read_b64_tr_b16 v[60:61], v218 offset:8192
    ds_read_b64_tr_b16 v[62:63], v218 offset:10240
    ds_read_b64_tr_b16 v[64:65], v219 offset:8192
    ds_read_b64_tr_b16 v[66:67], v219 offset:10240
    ds_read_b64_tr_b16 v[68:69], v216 offset:12288
    ds_read_b64_tr_b16 v[70:71], v216 offset:14336
    ds_read_b64_tr_b16 v[72:73], v217 offset:12288
    ds_read_b64_tr_b16 v[74:75], v217 offset:14336
    ds_read_b64_tr_b16 v[76:77], v218 offset:12288
    ds_read_b64_tr_b16 v[78:79], v218 offset:14336
    ds_read_b64_tr_b16 v[80:81], v219 offset:12288
    ds_read_b64_tr_b16 v[82:83], v219 offset:14336
    s_cmp_eq_u32 s62, 0
    s_cbranch_scc1 B_nap
    s_mov_b64 exec, s[18:19]
    buffer_load_dword v18, v203, s[24:27], s17 offen sc1
    s_mov_b64 exec, -1
B_nap:
    ds_read_b64_tr_b16 v[84:85], v216 offset:16384
    ds_read_b64_tr_b16 v[86:87], v216 offset:18432
    ds_read_b64_tr_b16 v[88:89], v217 offset:16384
    ds_read_b64_tr_b16 v[90:91], v217 offset:18432
    ds_read_b64_tr_b16 v[92:93], v218 offset:16384
    ds_read_b64_tr_b16 v[94:95], v218 offset:18432
    ds_read_b64_tr_b16 v[96:97], v219 offset:16384
    ds_read_b64_tr_b16 v[98:99], v219 offset:18432
    ds_read_b64_tr_b16 v[100:101], v216 offset:20480
    ds_read_b64_tr_b16 v[102:103], v216 offset:22528
    ds_read_b64_tr_b16 v[104:105], v217 offset:20480
    ds_read_b64_tr_b16 v[106:107], v217 offset:22528
    ds_read_b64_tr_b16 v[108:109], v218 offset:20480
    ds_read_b64_tr_b16 v[110:111], v218 offset:22528
    ds_read_b64_tr_b16 v[112:113], v219 offset:20480
    ds_read_b64_tr_b16 v[114:115], v219 offset:22528
    ds_read_b64_tr_b16 v[116:117], v216 offset:24576
    ds_read_b64_tr_b16 v[118:119], v216 offset:26624
    ds_read_b64_tr_b16 v[120:121], v217 offset:24576
    ds_read_b64_tr_b16 v[122:123], v217 offset:26624
    ds_read_b64_tr_b16 v[124:125], v218 offset:24576
    ds_read_b64_tr_b16 v[126:127], v218 offset:26624
    ds_read_b64_tr_b16 v[128:129], v219 offset:24576
    ds_read_b64_tr_b16 v[130:131], v219 offset:26624
    s_cmp_ge_u32 s48, 6
    s_cbranch_scc1 B_no
    v_lshlrev_b32 v184, 16, v232
    v_and_b32 v185, s47, v232
    v_lshlrev_b32 v186, 16, v233
    v_and_b32 v187, s47, v233
    v_lshlrev_b32 v188, 16, v234
    v_and_b32 v189, s47, v234
    v_lshlrev_b32 v190, 16, v235
    v_and_b32 v191, s47, v235
    v_lshlrev_b32 v192, 16, v236
    v_and_b32 v193, s47, v236
    v_lshlrev_b32 v194, 16, v237
    v_and_b32 v195, s47, v237
    v_lshlrev_b32 v196, 16, v238
    v_and_b32 v197, s47, v238
    v_lshlrev_b32 v198, 16, v239
    v_and_b32 v199, s47, v239
    s_waitcnt lgkmcnt(0)
    v_mfma_f32_16x16x32_bf16 v[184:187], v[20:23], v[204:207], v[184:187]
    v_mfma_f32_16x16x32_bf16 v[188:191], v[24:27], v[204:207], v[188:191]
    v_mfma_f32_16x16x32_bf16 v[192:195], v[28:31], v[204:207], v[192:195]
    v_mfma_f32_16x16x32_bf16 v[196:199], v[32:35], v[204:207], v[196:199]
    s_waitcnt lgkmcnt(0)
    v_mfma_f32_16x16x32_bf16 v[184:187], v[36:39], v[208:211], v[184:187]
    v_mfma_f32_16x16x32_bf16 v[188:191], v[40:43], v[208:211], v[188:191]
    v_mfma_f32_16x16x32_bf16 v[192:195], v[44:47], v[208:211], v[192:195]
    v_mfma_f32_16x16x32_bf16 v[196:199], v[48:51], v[208:211], v[196:199]
    s_branch B_n2
B_rds:
    ds_read_b64_tr_b16 v[132:133], v216 offset:28672
    ds_read_b64_tr_b16 v[134:135], v216 offset:30720
    ds_read_b64_tr_b16 v[136:137], v217 offset:28672
    ds_read_b64_tr_b16 v[138:139], v217 offset:30720
    ds_read_b64_tr_b16 v[140:141], v218 offset:28672
    ds_read_b64_tr_b16 v[142:143], v218 offset:30720
    ds_read_b64_tr_b16 v[144:145], v219 offset:28672
    ds_read_b64_tr_b16 v[146:147], v219 offset:30720
    ds_read_b64_tr_b16 v[148:149], v216 offset:32768
    ds_read_b64_tr_b16 v[150:151], v216 offset:34816
    ds_read_b64_tr_b16 v[152:153], v217 offset:32768
    ds_read_b64_tr_b16 v[154:155], v217 offset:34816
    ds_read_b64_tr_b16 v[156:157], v218 offset:32768
    ds_read_b64_tr_b16 v[158:159], v218 offset:34816
    ds_read_b64_tr_b16 v[160:161], v219 offset:32768
    ds_read_b64_tr_b16 v[162:163], v219 offset:34816
    ds_read_b64_tr_b16 v[20:21], v216 offset:36864
    ds_read_b64_tr_b16 v[22:23], v216 offset:38912
    ds_read_b64_tr_b16 v[24:25], v217 offset:36864
    ds_read_b64_tr_b16 v[26:27], v217 offset:38912
    ds_read_b64_tr_b16 v[28:29], v218 offset:36864
    ds_read_b64_tr_b16 v[30:31], v218 offset:38912
    ds_read_b64_tr_b16 v[32:33], v219 offset:36864
    ds_read_b64_tr_b16 v[34:35], v219 offset:38912
    ds_read_b64_tr_b16 v[36:37], v220 offset:0
    ds_read_b64_tr_b16 v[38:39], v220 offset:2048
    ds_read_b64_tr_b16 v[40:41], v221 offset:0
    ds_read_b64_tr_b16 v[42:43], v221 offset:2048
    ds_read_b64_tr_b16 v[44:45], v222 offset:0
    ds_read_b64_tr_b16 v[46:47], v222 offset:2048
    ds_read_b64_tr_b16 v[48:49], v223 offset:0
    ds_read_b64_tr_b16 v[50:51], v223 offset:2048
    s_setpc_b64 s[98:99]
B_no:
    v_mov_b64 v[184:185], 0
    v_mov_b64 v[186:187], 0
    v_mov_b64 v[188:189], 0
    v_mov_b64 v[190:191], 0
    v_mov_b64 v[192:193], 0
    v_mov_b64 v[194:195], 0
    v_mov_b64 v[196:197], 0
    v_mov_b64 v[198:199], 0
    s_call_b64 s[98:99], B_rds
    v_mul_u32_u24 v4, 12, v0
    s_add_u32 s58, s100, 512
    s_add_u32 s59, s100, 24832
    s_add_u32 s60, s100, 49152
    s_add_u32 s12, s100, 73472
    s_add_u32 s13, s100, 97792
    v_and_b32 v5, 31, v0
    v_mul_u32_u24 v5, 3, v5
    s_mul_i32 s64, s53, 96
    s_sub_u32 s65, 1014, s55
    v_mov_b32 v6, 0xfffff000
    v_add_u32 v7, -10, v5
    v_cmp_gt_u32 vcc, s65, v7
    v_add3_u32 v7, v5, s64, 0
    s_nop 0
    v_cndmask_b32 v8, 0, v7, vcc
    v_cndmask_b32 v204, 0, v6, vcc
    v_add_u32 v7, -9, v5
    v_cmp_gt_u32 vcc, s65, v7
    v_add3_u32 v7, v5, s64, 1
    s_nop 0
    v_cndmask_b32 v9, 0, v7, vcc
    v_cndmask_b32 v205, 0, v6, vcc
    v_add_u32 v7, -8, v5
    v_cmp_gt_u32 vcc, s65, v7
    v_add3_u32 v7, v5, s64, 2
    s_nop 0
    v_cndmask_b32 v10, 0, v7, vcc
    v_cndmask_b32 v206, 0, v6, vcc
    v_mov_b32 v7, s54
    v_lshlrev_b32 v11, 11, v200
    s_setprio 2
B_n2:
    s_cmp_eq_u32 s62, 0
    s_cbranch_scc1 B_run
    s_mov_b64 exec, s[18:19]
    s_branch B_pw
B_poll:
    buffer_load_dword v18, v203, s[24:27], s17 offen sc1
B_pw:
    s_waitcnt vmcnt(0)
    v_cmp_ne_u32 vcc, s54, v18
    s_cbranch_vccz B_go
    s_sub_u32 s3, s3, 1
    s_cbranch_scc0 B_poll
    s_mov_b32 s3, 0
B_go:
    s_mov_b64 exec, -1
    s_add_u32 s14, s14, 2048
    s_cmp_eq_u32 s14, s15
    s_cselect_b32 s14, s1, s14
    buffer_load_dwordx4 v[168:171], v249, s[24:27], s14 offen offset:0 sc1
    buffer_load_dwordx4 v[172:175], v249, s[24:27], s14 offen offset:1024 sc1
    s_add_u32 s14, s14, 2048
    s_cmp_eq_u32 s14, s15
    s_cselect_b32 s14, s1, s14
    buffer_load_dwordx4 v[176:179], v249, s[24:27], s14 offen offset:0 sc1
    buffer_load_dwordx4 v[180:183], v249, s[24:27], s14 offen offset:1024 sc1
    s_add_u32 s14, s14, 2048
    s_cmp_eq_u32 s14, s15
    s_cselect_b32 s14, s1, s14
    buffer_load_dwordx4 v[212:215], v249, s[24:27], s14 offen offset:0 sc1
    buffer_load_dwordx4 v[12:15], v249, s[24:27], s14 offen offset:1024 sc1
B_run:
    s_cmp_ge_u32 s48, 6
    s_cbranch_scc1 B_half
    s_call_b64 s[98:99], B_rds
    s_cmp_ge_u32 s48, 4
    s_cbranch_scc1 B_half
    s_setprio 1
    s_waitcnt vmcnt(5) lgkmcnt(15)
    v_mfma_f32_16x16x32_bf16 v[184:187], v[52:55], v[168:171], v[184:187]
    v_mfma_f32_16x16x32_bf16 v[188:191], v[56:59], v[168:171], v[188:191]
    ds_read_b64_tr_b16 v[52:53], v220 offset:4096
    v_mfma_f32_16x16x32_bf16 v[192:195], v[60:63], v[168:171], v[192:195]
    ds_read_b64_tr_b16 v[54:55], v220 offset:6144
    v_mfma_f32_16x16x32_bf16 v[196:199], v[64:67], v[168:171], v[196:199]
    s_add_u32 s14, s14, 2048
    s_cmp_eq_u32 s14, s15
    s_cselect_b32 s14, s1, s14
    buffer_load_dwordx4 v[164:167], v249, s[24:27], s14 offen offset:0 sc1
    ds_read_b64_tr_b16 v[56:57], v221 offset:4096
    s_waitcnt vmcnt(5) lgkmcnt(15)
    v_mfma_f32_16x16x32_bf16 v[184:187], v[68:71], v[172:175], v[184:187]
    ds_read_b64_tr_b16 v[58:59], v221 offset:6144
    ds_read_b64_tr_b16 v[60:61], v222 offset:4096
    v_mfma_f32_16x16x32_bf16 v[188:191], v[72:75], v[172:175], v[188:191]
    ds_read_b64_tr_b16 v[62:63], v222 offset:6144
    v_mfma_f32_16x16x32_bf16 v[192:195], v[76:79], v[172:175], v[192:195]
    ds_read_b64_tr_b16 v[64:65], v223 offset:4096
    v_mfma_f32_16x16x32_bf16 v[196:199], v[80:83], v[172:175], v[196:199]
    buffer_load_dwordx4 v[232:235], v249, s[24:27], s14 offen offset:1024 sc1
    ds_read_b64_tr_b16 v[66:67], v223 offset:6144
    s_waitcnt vmcnt(5) lgkmcnt(15)
    v_mfma_f32_16x16x32_bf16 v[184:187], v[84:87], v[176:179], v[184:187]
    ds_read_b64_tr_b16 v[68:69], v220 offset:8192
    ds_read_b64_tr_b16 v[70:71], v220 offset:10240
    v_mfma_f32_16x16x32_bf16 v[188:191], v[88:91], v[176:179], v[188:191]
    ds_read_b64_tr_b16 v[72:73], v221 offset:8192
    v_mfma_f32_16x16x32_bf16 v[192:195], v[92:95], v[176:179], v[192:195]
    ds_read_b64_tr_b16 v[74:75], v221 offset:10240
    v_mfma_f32_16x16x32_bf16 v[196:199], v[96:99], v[176:179], v[196:199]
    s_mov_b32 s14, s16
    buffer_load_dwordx4 v[236:239], v249, s[24:27], s14 offen offset:0 sc1
    ds_read_b64_tr_b16 v[76:77], v222 offset:8192
    s_waitcnt vmcnt(5) lgkmcnt(15)
    v_mfma_f32_16x16x32_bf16 v[184:187], v[100:103], v[180:183], v[184:187]
    ds_read_b64_tr_b16 v[78:79], v222 offset:10240
    ds_read_b64_tr_b16 v[80:81], v223 offset:8192
    v_mfma_f32_16x16x32_bf16 v[188:191], v[104:107], v[180:183], v[188:191]
    ds_read_b64_tr_b16 v[82:83], v223 offset:10240
    v_mfma_f32_16x16x32_bf16 v[192:195], v[108:111], v[180:183], v[192:195]
    ds_read_b64_tr_b16 v[84:85], v220 offset:12288
    v_mfma_f32_16x16x32_bf16 v[196:199], v[112:115], v[180:183], v[196:199]
    buffer_load_dwordx4 v[168:171], v249, s[24:27], s14 offen offset:1024 sc1
    ds_read_b64_tr_b16 v[86:87], v220 offset:14336
    s_waitcnt vmcnt(5) lgkmcnt(15)
    v_mfma_f32_16x16x32_bf16 v[184:187], v[116:119], v[212:215], v[184:187]
    ds_read_b64_tr_b16 v[88:89], v221 offset:12288
    ds_read_b64_tr_b16 v[90:91], v221 offset:14336
    v_mfma_f32_16x16x32_bf16 v[188:191], v[120:123], v[212:215], v[188:191]
    ds_read_b64_tr_b16 v[92:93], v222 offset:12288
    v_mfma_f32_16x16x32_bf16 v[192:195], v[124:127], v[212:215], v[192:195]
    ds_read_b64_tr_b16 v[94:95], v222 offset:14336
    v_mfma_f32_16x16x32_bf16 v[196:199], v[128:131], v[212:215], v[196:199]
    s_add_u32 s14, s14, 2048
    s_cmp_eq_u32 s14, s15
    s_cselect_b32 s14, s1, s14
    buffer_load_dwordx4 v[172:175], v249, s[24:27], s14 offen offset:0 sc1
    ds_read_b64_tr_b16 v[96:97], v223 offset:12288
    s_waitcnt vmcnt(5) lgkmcnt(15)
    v_mfma_f32_16x16x32_bf16 v[184:187], v[132:135], v[12:15], v[184:187]
    ds_read_b64_tr_b16 v[98:99], v223 offset:14336
    ds_read_b64_tr_b16 v[100:101], v220 offset:16384
    v_mfma_f32_16x16x32_bf16 v[188:191], v[136:139], v[12:15], v[188:191]
    ds_read_b64_tr_b16 v[102:103], v220 offset:18432
    v_mfma_f32_16x16x32_bf16 v[192:195], v[140:143], v[12:15], v[192:195]
    ds_read_b64_tr_b16 v[104:105], v221 offset:16384
    v_mfma_f32_16x16x32_bf16 v[196:199], v[144:147], v[12:15], v[196:199]
    buffer_load_dwordx4 v[176:179], v249, s[24:27], s14 offen offset:1024 sc1
    ds_read_b64_tr_b16 v[106:107], v221 offset:18432
    s_waitcnt vmcnt(5) lgkmcnt(15)
    v_mfma_f32_16x16x32_bf16 v[184:187], v[148:151], v[164:167], v[184:187]
    ds_read_b64_tr_b16 v[108:109], v222 offset:16384
    ds_read_b64_tr_b16 v[110:111], v222 offset:18432
    v_mfma_f32_16x16x32_bf16 v[188:191], v[152:155], v[164:167], v[188:191]
    ds_read_b64_tr_b16 v[112:113], v223 offset:16384
    v_mfma_f32_16x16x32_bf16 v[192:195], v[156:159], v[164:167], v[192:195]
    ds_read_b64_tr_b16 v[114:115], v223 offset:18432
    v_mfma_f32_16x16x32_bf16 v[196:199], v[160:163], v[164:167], v[196:199]
    s_add_u32 s14, s14, 2048
    s_cmp_eq_u32 s14, s15
    s_cselect_b32 s14, s1, s14
    buffer_load_dwordx4 v[180:183], v249, s[24:27], s14 offen offset:0 sc1
    ds_read_b64_tr_b16 v[116:117], v220 offset:20480
    s_waitcnt vmcnt(5) lgkmcnt(15)
    v_mfma_f32_16x16x32_bf16 v[184:187], v[20:23], v[232:235], v[184:187]
    ds_read_b64_tr_b16 v[118:119], v220 offset:22528
    ds_read_b64_tr_b16 v[120:121], v221 offset:20480
    v_mfma_f32_16x16x32_bf16 v[188:191], v[24:27], v[232:235], v[188:191]
    ds_read_b64_tr_b16 v[122:123], v221 offset:22528
    v_mfma_f32_16x16x32_bf16 v[192:195], v[28:31], v[232:235], v[192:195]
    ds_read_b64_tr_b16 v[124:125], v222 offset:20480
    v_mfma_f32_16x16x32_bf16 v[196:199], v[32:35], v[232:235], v[196:199]
    buffer_load_dwordx4 v[212:215], v249, s[24:27], s14 offen offset:1024 sc1
    ds_read_b64_tr_b16 v[126:127], v222 offset:22528
    s_waitcnt vmcnt(5) lgkmcnt(15)
    v_mfma_f32_16x16x32_bf16 v[184:187], v[36:39], v[236:239], v[184:187]
    ds_read_b64_tr_b16 v[128:129], v223 offset:20480
    ds_read_b64_tr_b16 v[130:131], v223 offset:22528
    v_mfma_f32_16x16x32_bf16 v[188:191], v[40:43], v[236:239], v[188:191]
    ds_read_b64_tr_b16 v[132:133], v220 offset:24576
    v_mfma_f32_16x16x32_bf16 v[192:195], v[44:47], v[236:239], v[192:195]
    ds_read_b64_tr_b16 v[134:135], v220 offset:26624
    v_mfma_f32_16x16x32_bf16 v[196:199], v[48:51], v[236:239], v[196:199]
    s_add_u32 s14, s14, 2048
    s_cmp_eq_u32 s14, s15
    s_cselect_b32 s14, s1, s14
    buffer_load_dwordx4 v[12:15], v249, s[24:27], s14 offen offset:0 sc1
    ds_read_b64_tr_b16 v[136:137], v221 offset:24576
    s_waitcnt vmcnt(5) lgkmcnt(15)
    v_mfma_f32_16x16x32_bf16 v[184:187], v[52:55], v[168:171], v[184:187]
    ds_read_b64_tr_b16 v[138:139], v221 offset:26624
    ds_read_b64_tr_b16 v[140:141], v222 offset:24576
    v_mfma_f32_16x16x32_bf16 v[188:191], v[56:59], v[168:171], v[188:191]
    ds_read_b64_tr_b16 v[142:143], v222 offset:26624
    v_mfma_f32_16x16x32_bf16 v[192:195], v[60:63], v[168:171], v[192:195]
    ds_read_b64_tr_b16 v[144:145], v223 offset:24576
    v_mfma_f32_16x16x32_bf16 v[196:199], v[64:67], v[168:171], v[196:199]
    buffer_load_dwordx4 v[164:167], v249, s[24:27], s14 offen offset:1024 sc1
    ds_read_b64_tr_b16 v[146:147], v223 offset:26624
    s_waitcnt vmcnt(5) lgkmcnt(15)
    v_mfma_f32_16x16x32_bf16 v[184:187], v[68:71], v[172:175], v[184:187]
    ds_read_b64_tr_b16 v[148:149], v220 offset:28672
    ds_read_b64_tr_b16 v[150:151], v220 offset:30720
    v_mfma_f32_16x16x32_bf16 v[188:191], v[72:75], v[172:175], v[188:191]
    ds_read_b64_tr_b16 v[152:153], v221 offset:28672
    v_mfma_f32_16x16x32_bf16 v[192:195], v[76:79], v[172:175], v[192:195]
    ds_read_b64_tr_b16 v[154:155], v221 offset:30720
    v_mfma_f32_16x16x32_bf16 v[196:199], v[80:83], v[172:175], v[196:199]
    s_add_u32 s14, s14, 2048
    s_cmp_eq_u32 s14, s15
    s_cselect_b32 s14, s1, s14
    buffer_load_dwordx4 v[232:235], v249, s[24:27], s14 offen offset:0 sc1
    ds_read_b64_tr_b16 v[156:157], v222 offset:28672
    s_waitcnt vmcnt(5) lgkmcnt(15)
    v_mfma_f32_16x16x32_bf16 v[184:187], v[84:87], v[176:179], v[184:187]
    ds_read_b64_tr_b16 v[158:159], v222 offset:30720
    ds_read_b64_tr_b16 v[160:161], v223 offset:28672
    v_mfma_f32_16x16x32_bf16 v[188:191], v[88:91], v[176:179], v[188:191]
    ds_read_b64_tr_b16 v[162:163], v223 offset:30720
    v_mfma_f32_16x16x32_bf16 v[192:195], v[92:95], v[176:179], v[192:195]
    ds_read_b64_tr_b16 v[20:21], v220 offset:32768
    v_mfma_f32_16x16x32_bf16 v[196:199], v[96:99], v[176:179], v[196:199]
    buffer_load_dwordx4 v[236:239], v249, s[24:27], s14 offen offset:1024 sc1
    ds_read_b64_tr_b16 v[22:23], v220 offset:34816
    s_waitcnt vmcnt(5) lgkmcnt(15)
    v_mfma_f32_16x16x32_bf16 v[184:187], v[100:103], v[180:183], v[184:187]
    ds_read_b64_tr_b16 v[24:25], v221 offset:32768
    ds_read_b64_tr_b16 v[26:27], v221 offset:34816
    v_mfma_f32_16x16x32_bf16 v[188:191], v[104:107], v[180:183], v[188:191]
    ds_read_b64_tr_b16 v[28:29], v222 offset:32768
    v_mfma_f32_16x16x32_bf16 v[192:195], v[108:111], v[180:183], v[192:195]
    ds_read_b64_tr_b16 v[30:31], v222 offset:34816
    v_mfma_f32_16x16x32_bf16 v[196:199], v[112:115], v[180:183], v[196:199]
    ds_read_b64_tr_b16 v[32:33], v223 offset:32768
    s_waitcnt vmcnt(4) lgkmcnt(15)
    v_mfma_f32_16x16x32_bf16 v[184:187], v[116:119], v[212:215], v[184:187]
    ds_read_b64_tr_b16 v[34:35], v223 offset:34816
    ds_read_b64_tr_b16 v[36:37], v220 offset:36864
    v_mfma_f32_16x16x32_bf16 v[188:191], v[120:123], v[212:215], v[188:191]
    ds_read_b64_tr_b16 v[38:39], v220 offset:38912
    v_mfma_f32_16x16x32_bf16 v[192:195], v[124:127], v[212:215], v[192:195]
    ds_read_b64_tr_b16 v[40:41], v221 offset:36864
    v_mfma_f32_16x16x32_bf16 v[196:199], v[128:131], v[212:215], v[196:199]
    ds_read_b64_tr_b16 v[42:43], v221 offset:38912
    s_waitcnt vmcnt(3) lgkmcnt(15)
    v_mfma_f32_16x16x32_bf16 v[184:187], v[132:135], v[12:15], v[184:187]
    ds_read_b64_tr_b16 v[44:45], v222 offset:36864
    ds_read_b64_tr_b16 v[46:47], v222 offset:38912
    v_mfma_f32_16x16x32_bf16 v[188:191], v[136:139], v[12:15], v[188:191]
    ds_read_b64_tr_b16 v[48:49], v223 offset:36864
    v_mfma_f32_16x16x32_bf16 v[192:195], v[140:143], v[12:15], v[192:195]
    ds_read_b64_tr_b16 v[50:51], v223 offset:38912
    v_mfma_f32_16x16x32_bf16 v[196:199], v[144:147], v[12:15], v[196:199]
    s_waitcnt vmcnt(2) lgkmcnt(15)
    v_mfma_f32_16x16x32_bf16 v[184:187], v[148:151], v[164:167], v[184:187]
    v_mfma_f32_16x16x32_bf16 v[188:191], v[152:155], v[164:167], v[188:191]
    v_mfma_f32_16x16x32_bf16 v[192:195], v[156:159], v[164:167], v[192:195]
    v_mfma_f32_16x16x32_bf16 v[196:199], v[160:163], v[164:167], v[196:199]
    ds_read_b32 v10, v251 offset:4
    s_waitcnt vmcnt(1) lgkmcnt(9)
    v_mfma_f32_16x16x32_bf16 v[184:187], v[20:23], v[232:235], v[184:187]
    v_mfma_f32_16x16x32_bf16 v[188:191], v[24:27], v[232:235], v[188:191]
    v_mfma_f32_16x16x32_bf16 v[192:195], v[28:31], v[232:235], v[192:195]
    v_mfma_f32_16x16x32_bf16 v[196:199], v[32:35], v[232:235], v[196:199]
    s_waitcnt vmcnt(0) lgkmcnt(1)
    v_mfma_f32_16x16x32_bf16 v[184:187], v[36:39], v[236:239], v[184:187]
    v_mfma_f32_16x16x32_bf16 v[188:191], v[40:43], v[236:239], v[188:191]
    v_mfma_f32_16x16x32_bf16 v[192:195], v[44:47], v[236:239], v[192:195]
    v_mfma_f32_16x16x32_bf16 v[196:199], v[48:51], v[236:239], v[196:199]
    s_branch B_epi
B_half:
    s_add_u32 s14, s14, 2048
    s_cmp_eq_u32 s14, s15
    s_cselect_b32 s14, s1, s14
    buffer_load_dwordx4 v[164:167], v249, s[24:27], s14 offen offset:0 sc1
    buffer_load_dwordx4 v[232:235], v249, s[24:27], s14 offen offset:1024 sc1
    s_mov_b32 s14, s16
    buffer_load_dwordx4 v[236:239], v249, s[24:27], s14 offen offset:0 sc1
    s_cmp_lg_u32 s48, 6
    s_cbranch_scc1 E_end
    s_setprio 3
E_poll:
    s_mov_b32 exec_hi, 0x0fffffff
    buffer_load_dword v17, v203, s[24:27], s100 offen sc1
    s_mov_b32 exec_hi, -1
    buffer_load_dwordx3 v[224:226], v4, s[24:27], s58 offen sc1
    buffer_load_dwordx3 v[228:230], v4, s[24:27], s59 offen sc1
    buffer_load_dwordx3 v[240:242], v4, s[24:27], s60 offen sc1
    buffer_load_dwordx3 v[244:246], v4, s[24:27], s12 offen sc1
    buffer_load_dwordx3 v[208:210], v4, s[24:27], s13 offen sc1
E_chk:
    s_waitcnt vmcnt(5)
    v_cmp_ne_u32 vcc, s54, v17
    s_lshl_b64 vcc, vcc, 4
    s_cbranch_scc0 E_go
    s_sleep 1
    s_sub_u32 s3, s3, 1
    s_cbranch_scc0 E_poll
    s_mov_b32 s3, 0
E_go:
    s_waitcnt vmcnt(4)
    s_waitcnt vmcnt(3)
    v_add_f32 v252, v224, v228
    v_add_f32 v253, v225, v229
    v_add_f32 v254, v226, v230
    v_lshlrev_b32 v224, 16, v224
    v_lshlrev_b32 v225, 16, v225
    v_lshlrev_b32 v226, 16, v226
    v_lshlrev_b32 v228, 16, v228
    v_lshlrev_b32 v229, 16, v229
    v_lshlrev_b32 v230, 16, v230
    v_add_f32 v224, v224, v228
    v_add_f32 v225, v225, v229
    v_add_f32 v226, v226, v230
    s_waitcnt vmcnt(2)
    v_add_f32 v252, v252, v240
    v_add_f32 v253, v253, v241
    v_add_f32 v254, v254, v242
    v_lshlrev_b32 v240, 16, v240
    v_lshlrev_b32 v241, 16, v241
    v_lshlrev_b32 v242, 16, v242
    v_add_f32 v224, v224, v240
    v_add_f32 v225, v225, v241
    v_add_f32 v226, v226, v242
    s_waitcnt vmcnt(1)
    v_add_f32 v252, v252, v244
    v_add_f32 v253, v253, v245
    v_add_f32 v254, v254, v246
    v_lshlrev_b32 v244, 16, v244
    v_lshlrev_b32 v245, 16, v245
    v_lshlrev_b32 v246, 16, v246
    v_add_f32 v224, v224, v244
    v_add_f32 v225, v225, v245
    v_add_f32 v226, v226, v246
    s_waitcnt vmcnt(0)
    v_add_f32 v252, v252, v208
    v_add_f32 v253, v253, v209
    v_add_f32 v254, v254, v210
    v_lshlrev_b32 v208, 16, v208
    v_lshlrev_b32 v209, 16, v209
    v_lshlrev_b32 v210, 16, v210
    v_add_f32 v224, v224, v208
    v_add_f32 v225, v225, v209
    v_add_f32 v226, v226, v210
    v_permlane32_swap_b32 v224, v252
    v_permlane32_swap_b32 v225, v253
    v_permlane32_swap_b32 v226, v254
    v_add_f32 v224, v224, v252
    v_add_f32 v225, v225, v253
    v_add_f32 v226, v226, v254
    v_rsq_f32 v252, v224
    v_rsq_f32 v253, v225
    v_rsq_f32 v254, v226
    v_permlane32_swap_b32 v252, v228
    v_permlane32_swap_b32 v253, v229
    v_permlane32_swap_b32 v254, v230
    v_mul_f32 v224, v224, v228
    v_mul_f32 v225, v225, v229
    v_mul_f32 v226, v226, v230
    v_and_or_b32 v252, v224, v204, v8
    v_and_or_b32 v253, v225, v205, v9
    v_and_or_b32 v254, v226, v206, v10
    v_max3_i32 v6, v252, v253, v254
    s_nop 1
    v_max_i32_dpp v6, v6, v6 row_ror:1 row_mask:0xf bank_mask:0xf
    s_nop 1
    v_max_i32_dpp v6, v6, v6 row_ror:2 row_mask:0xf bank_mask:0xf
    s_nop 1
    v_max_i32_dpp v6, v6, v6 row_ror:4 row_mask:0xf bank_mask:0xf
    s_nop 1
    v_max_i32_dpp v6, v6, v6 row_ror:8 row_mask:0xf bank_mask:0xf
    v_mov_b32 v5, v6
    s_nop 1
    v_permlane16_swap_b32 v6, v5
    s_mov_b64 exec, 0xffff
    s_lshr_b32 s64, 1, s51
    s_bitcmp0_b32 s64, 0
    v_max3_i32 v6, v6, v5, 1
    s_cbranch_scc1 E_np
    buffer_store_dwordx2 v[6:7], v11, s[24:27], s45 offen sc1
E_np:
    ds_write_b32 v251, v6 offset:4
    s_mov_b64 exec, -1
E_end:
    s_waitcnt vmcnt(8) lgkmcnt(15)
    v_mfma_f32_16x16x32_bf16 v[184:187], v[52:55], v[168:171], v[184:187]
    v_mfma_f32_16x16x32_bf16 v[188:191], v[56:59], v[168:171], v[188:191]
    v_mfma_f32_16x16x32_bf16 v[192:195], v[60:63], v[168:171], v[192:195]
    v_mfma_f32_16x16x32_bf16 v[196:199], v[64:67], v[168:171], v[196:199]
    s_waitcnt vmcnt(7) lgkmcnt(15)
    v_mfma_f32_16x16x32_bf16 v[184:187], v[68:71], v[172:175], v[184:187]
    v_mfma_f32_16x16x32_bf16 v[188:191], v[72:75], v[172:175], v[188:191]
    v_mfma_f32_16x16x32_bf16 v[192:195], v[76:79], v[172:175], v[192:195]
    v_mfma_f32_16x16x32_bf16 v[196:199], v[80:83], v[172:175], v[196:199]
    ds_read_b32 v10, v251 offset:4
    s_waitcnt vmcnt(6) lgkmcnt(15)
    v_mfma_f32_16x16x32_bf16 v[184:187], v[84:87], v[176:179], v[184:187]
    v_mfma_f32_16x16x32_bf16 v[188:191], v[88:91], v[176:179], v[188:191]
    v_mfma_f32_16x16x32_bf16 v[192:195], v[92:95], v[176:179], v[192:195]
    v_mfma_f32_16x16x32_bf16 v[196:199], v[96:99], v[176:179], v[196:199]
    s_waitcnt lgkmcnt(0)
    v_and_b32 v9, 0xfff, v10
    s_nop 0
    v_readfirstlane_b32 s64, v9
    s_lshr_b32 s64, s64, 4
    s_mul_i32 s65, s53, 6
    s_add_u32 s65, s65, s56
    s_cmp_lg_u32 s64, s65
    s_cbranch_scc1 B_nb
    s_setprio 3
B_nb:
    s_waitcnt vmcnt(5) lgkmcnt(15)
    v_mfma_f32_16x16x32_bf16 v[184:187], v[100:103], v[180:183], v[184:187]
    v_mfma_f32_16x16x32_bf16 v[188:191], v[104:107], v[180:183], v[188:191]
    v_mfma_f32_16x16x32_bf16 v[192:195], v[108:111], v[180:183], v[192:195]
    v_mfma_f32_16x16x32_bf16 v[196:199], v[112:115], v[180:183], v[196:199]
    s_waitcnt vmcnt(4) lgkmcnt(15)
    v_mfma_f32_16x16x32_bf16 v[184:187], v[116:119], v[212:215], v[184:187]
    v_mfma_f32_16x16x32_bf16 v[188:191], v[120:123], v[212:215], v[188:191]
    v_mfma_f32_16x16x32_bf16 v[192:195], v[124:127], v[212:215], v[192:195]
    v_mfma_f32_16x16x32_bf16 v[196:199], v[128:131], v[212:215], v[196:199]
    s_waitcnt vmcnt(3) lgkmcnt(15)
    v_mfma_f32_16x16x32_bf16 v[184:187], v[132:135], v[12:15], v[184:187]
    v_mfma_f32_16x16x32_bf16 v[188:191], v[136:139], v[12:15], v[188:191]
    v_mfma_f32_16x16x32_bf16 v[192:195], v[140:143], v[12:15], v[192:195]
    v_mfma_f32_16x16x32_bf16 v[196:199], v[144:147], v[12:15], v[196:199]
    s_waitcnt vmcnt(2) lgkmcnt(15)
    v_mfma_f32_16x16x32_bf16 v[184:187], v[148:151], v[164:167], v[184:187]
    v_mfma_f32_16x16x32_bf16 v[188:191], v[152:155], v[164:167], v[188:191]
    v_mfma_f32_16x16x32_bf16 v[192:195], v[156:159], v[164:167], v[192:195]
    v_mfma_f32_16x16x32_bf16 v[196:199], v[160:163], v[164:167], v[196:199]
    s_waitcnt vmcnt(1) lgkmcnt(9)
    v_mfma_f32_16x16x32_bf16 v[184:187], v[20:23], v[232:235], v[184:187]
    v_mfma_f32_16x16x32_bf16 v[188:191], v[24:27], v[232:235], v[188:191]
    v_mfma_f32_16x16x32_bf16 v[192:195], v[28:31], v[232:235], v[192:195]
    v_mfma_f32_16x16x32_bf16 v[196:199], v[32:35], v[232:235], v[196:199]
    s_cmp_eq_u32 s48, 6
    s_cbranch_scc1 B_w6
    s_waitcnt vmcnt(0)
B_w6:
    s_waitcnt lgkmcnt(1)
    v_mfma_f32_16x16x32_bf16 v[184:187], v[36:39], v[236:239], v[184:187]
    v_mfma_f32_16x16x32_bf16 v[188:191], v[40:43], v[236:239], v[188:191]
    v_mfma_f32_16x16x32_bf16 v[192:195], v[44:47], v[236:239], v[192:195]
    v_mfma_f32_16x16x32_bf16 v[196:199], v[48:51], v[236:239], v[196:199]
    s_lshl_b32 s61, s56, 12
    s_add_u32 s61, s61, 135168
    v_add_u32 v16, s61, v202
    s_lshl_b32 s61, s56, 2
    s_add_u32 s61, s61, 160760
    v_mov_b32 v18, s61
    s_cmp_eq_u32 s101, 0
    s_cbranch_scc1 B_rx0
B_pf:
    ds_read_b32 v19, v18
    s_waitcnt lgkmcnt(0)
    v_cmp_eq_u32 vcc, 0, v19
    s_cbranch_vccz B_pg
    s_sleep 1
    s_sub_u32 s3, s3, 1
    s_cbranch_scc0 B_pf
    s_mov_b32 s3, 0
B_pg:
    ds_write_b128 v16, v[184:187] offset:0
    ds_write_b128 v16, v[188:191] offset:1024
    ds_write_b128 v16, v[192:195] offset:2048
    ds_write_b128 v16, v[196:199] offset:3072
    v_mov_b32 v19, 2
    s_waitcnt lgkmcnt(0)
    ds_write_b32 v18, v19
    s_branch L_fin
B_rx0:
B_rx:
    ds_read_b32 v19, v18
    s_waitcnt lgkmcnt(0)
    v_cmp_ne_u32 vcc, 2, v19
    s_cbranch_vccz B_rd
    s_sub_u32 s3, s3, 1
    s_cbranch_scc0 B_rx
    s_mov_b32 s3, 0
B_rd:
    ds_read_b32 v10, v251 offset:4
    ds_read_b128 v[100:103], v16 offset:0
    ds_read_b128 v[104:107], v16 offset:1024
    ds_read_b128 v[108:111], v16 offset:2048
    ds_read_b128 v[112:115], v16 offset:3072
    s_waitcnt lgkmcnt(0)
    v_add_f32 v184, v184, v100
    v_add_f32 v185, v185, v101
    v_add_f32 v186, v186, v102
    v_add_f32 v187, v187, v103
    v_add_f32 v188, v188, v104
    v_add_f32 v189, v189, v105
    v_add_f32 v190, v190, v106
    v_add_f32 v191, v191, v107
    v_add_f32 v192, v192, v108
    v_add_f32 v193, v193, v109
    v_add_f32 v194, v194, v110
    v_add_f32 v195, v195, v111
    v_add_f32 v196, v196, v112
    v_add_f32 v197, v197, v113
    v_add_f32 v198, v198, v114
    v_add_f32 v199, v199, v115
B_epi:
    s_waitcnt lgkmcnt(0)
    v_cmp_eq_u32 vcc, 0, v10
    v_and_b32 v10, 0xfff, v10
    s_cbranch_vccnz B_ew
B_eg:
    v_cmp_eq_u32 s[68:69], v10, v226
    v_add_u32 v10, s54, v10
    v_mov_b32 v16, 0x3f803f80
    v_mov_b32 v15, s54
    s_add_u32 s63, s1, 20480
    s_lshl_b32 s64, s51, 8
    s_add_u32 s64, s64, s63
    v_cvt_pk_bf16_f32 v52, v184, v185
    v_cvt_pk_bf16_f32 v53, v186, v187
    v_cvt_pk_bf16_f32 v54, v188, v189
    v_cvt_pk_bf16_f32 v55, v190, v191
    v_cvt_pk_bf16_f32 v56, v192, v193
    v_cvt_pk_bf16_f32 v57, v194, v195
    v_cvt_pk_bf16_f32 v58, v196, v197
    v_cvt_pk_bf16_f32 v59, v198, v199
    s_cmp_eq_u64 s[68:69], 0
    s_cbranch_scc1 B_np2
    s_mov_b64 exec, s[68:69]
    ds_write_b128 v228, v[52:55] offset:0
    ds_write_b128 v228, v[56:59] offset:16
    s_mov_b64 exec, -1
    ds_read_b64 v[8:9], v252
    s_waitcnt lgkmcnt(0)
    buffer_store_dwordx3 v[8:10], v224, s[24:27], s44 offen sc1
B_np2:
    v_mfma_f32_16x16x32_bf16 v[12:15], v[240:243], v[52:55], 0
    v_mfma_f32_16x16x32_bf16 v[12:15], v[244:247], v[56:59], v[12:15]
    v_dot2_f32_bf16 v16, v52, v52, 0
    v_dot2_f32_bf16 v17, v53, v53, 0
    v_dot2_f32_bf16 v16, v54, v54, v16
    v_dot2_f32_bf16 v17, v55, v55, v17
    v_dot2_f32_bf16 v16, v56, v56, v16
    v_dot2_f32_bf16 v17, v57, v57, v17
    v_dot2_f32_bf16 v16, v58, v58, v16
    v_dot2_f32_bf16 v17, v59, v59, v17
    s_nop 2
    v_add_f32 v16, v16, v17
    v_mov_b32 v17, v16
    s_nop 1
    v_permlane32_swap_b32 v16, v17
    v_add_f32 v16, v16, v17
    v_mov_b32 v17, v16
    v_mov_b32 v15, s54
    s_nop 0
    v_permlane16_swap_b32 v16, v17
    v_add_f32 v13, v16, v17
    s_mov_b64 exec, 0xffff
    s_cmp_eq_u32 s49, 0
    s_cbranch_scc1 sts_9
    buffer_store_dwordx4 v[12:15], v202, s[24:27], s64 offen
std_10:
    s_mov_b64 exec, -1
    v_lshlrev_b32 v36, 16, v52
    v_and_b32 v37, s47, v52
    v_lshlrev_b32 v38, 16, v53
    v_and_b32 v39, s47, v53
    v_lshlrev_b32 v40, 16, v54
    v_and_b32 v41, s47, v54
    v_lshlrev_b32 v42, 16, v55
    v_and_b32 v43, s47, v55
    v_lshlrev_b32 v44, 16, v56
    v_and_b32 v45, s47, v56
    v_lshlrev_b32 v46, 16, v57
    v_and_b32 v47, s47, v57
    v_lshlrev_b32 v48, 16, v58
    v_and_b32 v49, s47, v58
    v_lshlrev_b32 v50, 16, v59
    v_and_b32 v51, s47, v59
    v_mov_b32 v108, 0
    v_mov_b32 v109, 0
    v_mov_b32 v110, 0
    v_mov_b32 v111, s54
    v_mov_b32 v11, s54
    v_mov_b32 v5, 1
    v_lshlrev_b32 v7, 11, v200
    s_add_u32 s45, s45, 32768
    s_sub_u32 s44, s44, 131072
    buffer_load_dwordx4 v[100:103], v202, s[24:27], s63 offen offset:0 sc1
    buffer_load_dwordx4 v[104:107], v202, s[24:27], s63 offen offset:1024 sc1
    s_mov_b32 exec_hi, 0
    buffer_load_dwordx4 v[108:111], v202, s[24:27], s63 offen offset:2048 sc1
    s_mov_b32 exec_hi, -1
    s_branch S_pw
S_poll:
    s_mov_b64 exec, s[58:59]
    s_cbranch_execz S_r0
    buffer_load_dwordx4 v[100:103], v202, s[24:27], s63 offen offset:0 sc1
S_r0:
    s_mov_b64 exec, s[64:65]
    s_cbranch_execz S_r1
    buffer_load_dwordx4 v[104:107], v202, s[24:27], s63 offen offset:1024 sc1
S_r1:
    s_mov_b64 exec, s[66:67]
    s_cbranch_execz S_r2
    buffer_load_dwordx4 v[108:111], v202, s[24:27], s63 offen offset:2048 sc1
S_r2:
    s_mov_b64 exec, -1
S_pw:
    s_waitcnt vmcnt(0)
    v_cmp_ne_u32 s[58:59], s54, v103
    v_cmp_ne_u32 s[64:65], s54, v107
    v_cmp_ne_u32 s[66:67], s54, v111
    s_or_b64 vcc, s[58:59], s[64:65]
    s_or_b64 vcc, vcc, s[66:67]
    s_cbranch_scc0 S_got
    s_sub_u32 s3, s3, 1
    s_cbranch_scc0 S_poll
    s_mov_b32 s3, 0
S_got:
    v_add_f32 v12, v100, v104
    v_add_f32 v13, v101, v105
    v_add_f32 v14, v102, v106
    v_add_f32 v12, v12, v108
    v_add_f32 v13, v13, v109
    v_add_f32 v14, v14, v110
    v_mov_b32 v17, v12
    v_mov_b32 v18, v13
    v_mov_b32 v19, v14
    v_permlane32_swap_b32 v17, v12
    v_permlane32_swap_b32 v18, v13
    v_permlane32_swap_b32 v19, v14
    v_add_f32 v12, v12, v17
    v_add_f32 v13, v13, v18
    v_add_f32 v14, v14, v19
    v_mov_b32 v17, v12
    v_mov_b32 v18, v13
    v_mov_b32 v19, v14
    v_permlane16_swap_b32 v17, v12
    v_permlane16_swap_b32 v18, v13
    v_permlane16_swap_b32 v19, v14
    v_add_f32 v12, v12, v17
    v_add_f32 v13, v13, v18
    v_add_f32 v14, v14, v19
    v_mul_f32 v12, 0x3acccccd, v12
    v_mul_f32 v13, 0x3acccccd, v13
    v_fma_f32 v13, -v12, v12, v13
    v_max_f32 v13, 0, v13
    v_cvt_pk_bf16_f32 v13, v13, v13
    v_and_b32 v13, 0xffff0000, v13
    v_add_f32 v13, 0x3727c5ac, v13
    v_cvt_pk_bf16_f32 v13, v13, v13
    v_and_b32 v13, 0xffff0000, v13
    v_sqrt_f32 v13, v13
    v_cvt_pk_bf16_f32 v12, v12, v12
    v_and_b32 v12, 0xffff0000, v12
    v_cvt_pk_bf16_f32 v13, v13, v13
    v_and_b32 v13, 0xffff0000, v13
    v_rcp_f32 v13, v13
    v_fma_f32 v14, -v12, v248, v14
    v_mul_f32 v14, v14, v13
    v_ashrrev_i32 v6, 31, v14
    v_or_b32 v6, 0x80000000, v6
    v_xor_b32 v6, v6, v14
    v_and_b32 v6, 0xfffff000, v6
    v_or_b32 v6, v6, v226
    s_and_b64 exec, s[4:5], 0xffff
    ds_max_u32 v251, v6 offset:12
    s_lshr_b32 s64, 1, s51
    s_bitcmp0_b32 s64, 0
    s_cbranch_scc1 S_nk
    s_mov_b64 exec, 1
    ds_add_rtn_u32 v5, v251, v5 offset:20
    s_mov_b64 exec, 0xffff
    ds_read_b32 v10, v251 offset:12
    s_waitcnt lgkmcnt(0)
    v_readfirstlane_b32 s64, v5
    s_cmp_lg_u32 s64, 5
    s_cbranch_scc1 S_nk
    buffer_store_dwordx2 v[10:11], v7, s[24:27], s45 offen sc1
S_nk:
    s_mov_b64 exec, -1
    s_and_b64 s[68:69], s[68:69], s[4:5]
    s_cbranch_scc0 S_ne
    s_call_b64 s[98:99], S_ln
    s_mov_b64 exec, s[68:69]
    buffer_store_dwordx4 v[60:63], v225, s[40:43], 0 offen offset:0 sc1
    buffer_store_dwordx4 v[64:67], v225, s[40:43], 0 offen offset:64 sc1
    s_mov_b64 exec, -1
S_ne:
    s_waitcnt lgkmcnt(0)
    s_barrier
    ds_read_b32 v10, v251 offset:12
    s_waitcnt lgkmcnt(0)
S_nc:
    v_cmp_eq_u32 s[60:61], v10, v6
    s_cmp_lg_u64 s[68:69], 0
    s_cbranch_scc1 S_l2
    s_call_b64 s[98:99], S_ln
S_l2:
    s_and_b64 s[60:61], s[60:61], s[4:5]
    s_cbranch_scc0 S_out
    s_andn2_b64 exec, s[60:61], s[68:69]
    s_cbranch_execz S_l3
    buffer_store_dwordx4 v[60:63], v225, s[40:43], 0 offen offset:0 sc1
    buffer_store_dwordx4 v[64:67], v225, s[40:43], 0 offen offset:64 sc1
S_l3:
    s_mov_b64 exec, s[60:61]
    ds_write_b128 v228, v[52:55] offset:0
    ds_write_b128 v228, v[56:59] offset:16
    s_mov_b64 exec, -1
    ds_read_b64 v[8:9], v252
    v_and_b32 v10, 0xfff, v10
    v_add_u32 v10, s54, v10
    s_mov_b64 exec, 0xffff
    s_waitcnt vmcnt(0) lgkmcnt(0)
    buffer_store_dwordx3 v[8:10], v224, s[24:27], s44 offen sc1
S_out:
    s_nor_b64 exec, s[60:61], s[68:69]
    buffer_store_dwordx4 v[60:63], v225, s[40:43], 0 offen offset:0 sc1
    buffer_store_dwordx4 v[64:67], v225, s[40:43], 0 offen offset:64 sc1
    s_mov_b64 exec, -1
    s_branch L_fin
S_ln:
    v_pk_add_f32 v[20:21], v[36:37], v[12:13] op_sel_hi:[1,0] neg_lo:[0,1] neg_hi:[0,1]
    v_pk_add_f32 v[22:23], v[38:39], v[12:13] op_sel_hi:[1,0] neg_lo:[0,1] neg_hi:[0,1]
    v_pk_add_f32 v[24:25], v[40:41], v[12:13] op_sel_hi:[1,0] neg_lo:[0,1] neg_hi:[0,1]
    v_pk_add_f32 v[26:27], v[42:43], v[12:13] op_sel_hi:[1,0] neg_lo:[0,1] neg_hi:[0,1]
    v_pk_add_f32 v[28:29], v[44:45], v[12:13] op_sel_hi:[1,0] neg_lo:[0,1] neg_hi:[0,1]
    v_pk_add_f32 v[30:31], v[46:47], v[12:13] op_sel_hi:[1,0] neg_lo:[0,1] neg_hi:[0,1]
    v_pk_add_f32 v[32:33], v[48:49], v[12:13] op_sel_hi:[1,0] neg_lo:[0,1] neg_hi:[0,1]
    v_pk_add_f32 v[34:35], v[50:51], v[12:13] op_sel_hi:[1,0] neg_lo:[0,1] neg_hi:[0,1]
    v_cvt_pk_bf16_f32 v60, v20, v21
    v_cvt_pk_bf16_f32 v61, v22, v23
    v_cvt_pk_bf16_f32 v62, v24, v25
    v_cvt_pk_bf16_f32 v63, v26, v27
    v_cvt_pk_bf16_f32 v64, v28, v29
    v_cvt_pk_bf16_f32 v65, v30, v31
    v_cvt_pk_bf16_f32 v66, v32, v33
    v_cvt_pk_bf16_f32 v67, v34, v35
    v_lshlrev_b32 v20, 16, v60
    v_and_b32 v21, s47, v60
    v_lshlrev_b32 v22, 16, v61
    v_and_b32 v23, s47, v61
    v_lshlrev_b32 v24, 16, v62
    v_and_b32 v25, s47, v62
    v_lshlrev_b32 v26, 16, v63
    v_and_b32 v27, s47, v63
    v_lshlrev_b32 v28, 16, v64
    v_and_b32 v29, s47, v64
    v_lshlrev_b32 v30, 16, v65
    v_and_b32 v31, s47, v65
    v_lshlrev_b32 v32, 16, v66
    v_and_b32 v33, s47, v66
    v_lshlrev_b32 v34, 16, v67
    v_and_b32 v35, s47, v67
    v_pk_mul_f32 v[20:21], v[20:21], v[12:13] op_sel:[0,1]
    v_pk_mul_f32 v[22:23], v[22:23], v[12:13] op_sel:[0,1]
    v_pk_mul_f32 v[24:25], v[24:25], v[12:13] op_sel:[0,1]
    v_pk_mul_f32 v[26:27], v[26:27], v[12:13] op_sel:[0,1]
    v_pk_mul_f32 v[28:29], v[28:29], v[12:13] op_sel:[0,1]
    v_pk_mul_f32 v[30:31], v[30:31], v[12:13] op_sel:[0,1]
    v_pk_mul_f32 v[32:33], v[32:33], v[12:13] op_sel:[0,1]
    v_pk_mul_f32 v[34:35], v[34:35], v[12:13] op_sel:[0,1]
    v_cvt_pk_bf16_f32 v60, v20, v21
    v_cvt_pk_bf16_f32 v61, v22, v23
    v_cvt_pk_bf16_f32 v62, v24, v25
    v_cvt_pk_bf16_f32 v63, v26, v27
    v_cvt_pk_bf16_f32 v64, v28, v29
    v_cvt_pk_bf16_f32 v65, v30, v31
    v_cvt_pk_bf16_f32 v66, v32, v33
    v_cvt_pk_bf16_f32 v67, v34, v35
    v_lshlrev_b32 v20, 16, v60
    v_and_b32 v21, s47, v60
    v_lshlrev_b32 v22, 16, v61
    v_and_b32 v23, s47, v61
    v_lshlrev_b32 v24, 16, v62
    v_and_b32 v25, s47, v62
    v_lshlrev_b32 v26, 16, v63
    v_and_b32 v27, s47, v63
    v_lshlrev_b32 v28, 16, v64
    v_and_b32 v29, s47, v64
    v_lshlrev_b32 v30, 16, v65
    v_and_b32 v31, s47, v65
    v_lshlrev_b32 v32, 16, v66
    v_and_b32 v33, s47, v66
    v_lshlrev_b32 v34, 16, v67
    v_and_b32 v35, s47, v67
    v_pk_add_f32 v[20:21], v[20:21], v[36:37]
    v_pk_add_f32 v[22:23], v[22:23], v[38:39]
    v_pk_add_f32 v[24:25], v[24:25], v[40:41]
    v_pk_add_f32 v[26:27], v[26:27], v[42:43]
    v_pk_add_f32 v[28:29], v[28:29], v[44:45]
    v_pk_add_f32 v[30:31], v[30:31], v[46:47]
    v_pk_add_f32 v[32:33], v[32:33], v[48:49]
    v_pk_add_f32 v[34:35], v[34:35], v[50:51]
    v_cvt_pk_bf16_f32 v60, v20, v21
    v_cvt_pk_bf16_f32 v61, v22, v23
    v_cvt_pk_bf16_f32 v62, v24, v25
    v_cvt_pk_bf16_f32 v63, v26, v27
    v_cvt_pk_bf16_f32 v64, v28, v29
    v_cvt_pk_bf16_f32 v65, v30, v31
    v_cvt_pk_bf16_f32 v66, v32, v33
    v_cvt_pk_bf16_f32 v67, v34, v35
    v_permlane16_swap_b32 v60, v62
    v_permlane16_swap_b32 v61, v63
    v_permlane16_swap_b32 v64, v66
    v_permlane16_swap_b32 v65, v67
    s_setpc_b64 s[98:99]
L_fin:
L_end:
    s_endpgm
AT_mask:
    v_mov_b32 v17, 0xf149f2ca
    v_cmp_le_i32 vcc, 8, v212
    s_nop 1
    v_cndmask_b32 v60, v17, v60, vcc
    v_cmp_le_i32 vcc, 7, v212
    s_nop 1
    v_cndmask_b32 v61, v17, v61, vcc
    v_cmp_le_i32 vcc, 6, v212
    s_nop 1
    v_cndmask_b32 v62, v17, v62, vcc
    v_cmp_le_i32 vcc, 5, v212
    s_nop 1
    v_cndmask_b32 v63, v17, v63, vcc
    v_cmp_le_i32 vcc, 4, v212
    s_nop 1
    v_cndmask_b32 v64, v17, v64, vcc
    v_cmp_le_i32 vcc, 3, v212
    s_nop 1
    v_cndmask_b32 v65, v17, v65, vcc
    v_cmp_le_i32 vcc, 2, v212
    s_nop 1
    v_cndmask_b32 v66, v17, v66, vcc
    v_cmp_le_i32 vcc, 1, v212
    s_nop 1
    v_cndmask_b32 v67, v17, v67, vcc
    v_cmp_le_i32 vcc, 0, v212
    s_nop 1
    v_cndmask_b32 v68, v17, v68, vcc
    v_cmp_le_i32 vcc, -1, v212
    s_nop 1
    v_cndmask_b32 v69, v17, v69, vcc
    v_cmp_le_i32 vcc, -2, v212
    s_nop 1
    v_cndmask_b32 v70, v17, v70, vcc
    v_cmp_le_i32 vcc, -3, v212
    s_nop 1
    v_cndmask_b32 v71, v17, v71, vcc
    s_branch AT_nomask
sts_1:
    buffer_store_dwordx4 v[80:83], v213, s[24:27], s12 offen offset:0 sc1
    buffer_store_dwordx4 v[84:87], v213, s[24:27], s12 offen offset:512 sc1
    s_branch std_2
AT_vs:
    ds_read_b32 v17, v251 offset:8
    s_sub_u32 s3, s3, 1
    s_cbranch_scc0 AT_vc
    s_mov_b32 s3, 0
    s_branch AT_vg
sts_3:
    buffer_store_dwordx4 v[204:207], v249, s[24:27], s22 offen offset:0 sc1
    buffer_store_dwordx4 v[208:211], v249, s[24:27], s22 offen offset:1024 sc1
    s_branch std_4
sts_5:
    buffer_store_short_d16_hi v20, v164, s[24:27], s65 offen sc1
    s_branch std_6
sts_7:
    buffer_store_dword v79, v203, s[24:27], s23 offen sc1
    s_branch std_8
B_ew:
    s_sleep 1
    ds_read_b32 v10, v251 offset:4
    s_sub_u32 s3, s3, 1
    s_cbranch_scc0 B_epi
    s_mov_b32 s3, 0
    s_waitcnt lgkmcnt(0)
    s_branch B_eg
sts_9:
    buffer_store_dwordx4 v[12:15], v202, s[24:27], s64 offen sc1
    s_branch std_10
LD_cont:
    v_and_b32 v0, 63, v0
    s_mov_b32 s3, 0x40000
    s_mov_b32 s47, 0xffff0000
    s_mov_b32 s26, 7340032
    s_mov_b32 s27, 0x00020000
    s_mov_b32 s38, 819200
    s_mov_b32 s39, 0x00020000
    s_mov_b32 s42, 2621440
    s_mov_b32 s43, 0x00020000
    s_sub_u32 s52, s51, 5
    s_cselect_b32 s52, s51, s52
    s_buffer_load_dword s54, s[24:27], 0
    v_lshl_add_u32 v4, s60, 3, v1
    v_mul_u32_u24 v5, 1280, v4
    v_lshlrev_b32 v7, 1, v2
    v_bitop3_b32 v7, v0, 7, v7 bitop3:0x6a
    v_lshl_add_u32 v5, v7, 4, v5
    v_lshl_add_u32 v16, s51, 7, v5
    s_lshl_b32 s46, s53, 11
    s_add_u32 s46, s46, 81920
    s_mul_i32 s62, s60, 24
    v_add_u32 v17, s62, v0
    v_lshlrev_b32 v18, 4, v17
    v_cmp_gt_u32 vcc, 24, v0
    v_add_u32 v19, 72, v0
    v_lshlrev_b32 v19, 4, v19
    v_cndmask_b32 v18, v19, v18, vcc
    s_lshl_b32 s62, s51, 2
    s_add_u32 s62, s62, s60
    s_lshl_b32 s62, s62, 8
    s_sub_u32 s62, s62, s46
    s_add_u32 s62, s62, 1243488
    v_add_u32 v19, s62, v19
    v_cmp_lt_u32 vcc, 33, v0
    s_nop 1
    v_cndmask_b32 v18, v18, v19, vcc
    v_cmp_lt_u32 vcc, 49, v0
    s_nop 1
    v_cndmask_b32 v18, v18, 2.0, vcc
    s_cmp_eq_u32 s60, 0
    s_cselect_b32 s62, 24, 0
    v_cmp_gt_u32 vcc, s62, v0
    s_nop 1
    v_cndmask_b32 v10, v10, 2.0, vcc
    v_mov_b32 v28, 0
    v_mov_b32 v29, 0
    v_mov_b32 v30, 0
    v_mov_b32 v31, 0
    s_lshl_b32 s62, s60, 6
    v_add_u32 v4, s62, v0
    v_lshlrev_b32 v35, 4, v4
    v_add_u32 v35, 135168, v35
    ds_write_b128 v35, v[28:31] offset:0
    ds_write_b128 v35, v[28:31] offset:4096
    ds_write_b128 v35, v[28:31] offset:8192
    ds_write_b128 v35, v[28:31] offset:12288
    ds_write_b128 v35, v[28:31] offset:16384
    ds_write_b128 v35, v[28:31] offset:20480
    v_lshrrev_b32 v5, 1, v4
    v_min_u32 v5, 61, v5
    v_mul_u32_u24 v5, 400, v5
    v_and_b32 v6, 1, v4
    v_lshl_add_u32 v5, v6, 4, v5
    v_add_u32 v5, 110624, v5
    ds_write_b128 v5, v[28:31]
    v_mov_b32 v6, 159776
    ds_write_b64 v6, v[28:29]
    v_and_b32 v4, 31, v0
    v_lshlrev_b32 v5, 7, v4
    s_lshl_b32 s62, s51, 11
    v_add_u32 v6, s62, v5
    s_lshl_b32 s62, s51, 8
    s_add_u32 s62, s62, 17408
    v_add_u32 v7, s62, v5
    v_cmp_lt_u32 vcc, 23, v4
    s_nop 1
    v_cndmask_b32 v6, v6, v7, vcc
    v_and_b32 v7, 128, v5
    v_add_u32 v7, 23040, v7
    v_cmp_lt_u32 vcc, 25, v4
    s_nop 1
    v_cndmask_b32 v6, v6, v7, vcc
    v_lshrrev_b32 v7, 5, v0
    v_mul_u32_u24 v7, 24320, v7
    v_add_u32 v36, v6, v7
    s_mov_b32 vcc_hi, 0xfcff0000
    s_cmp_eq_u32 s60, 0
    s_cselect_b32 vcc_lo, 0xf0ff5555, vcc_hi
    v_cndmask_b32 v36, v36, 2.0, vcc
    s_waitcnt lgkmcnt(0)
    s_add_u32 s54, s54, 2654435761
    s_lshl_b32 s62, s60, 10
    s_add_u32 s62, s62, 36864
    s_add_u32 s63, s51, 3
    s_sub_u32 s61, s63, 10
    s_cselect_b32 s63, s63, s61
    s_mul_i32 s63, s63, 81920
    s_call_b64 s[98:99], S_late
    s_call_b64 s[98:99], LD_issue
    s_waitcnt vmcnt(9)
    s_barrier
    s_bitcmp0_b32 s60, 0
    s_cselect_b32 s16, s14, s16
    s_cselect_b32 s17, s15, s17
    s_mov_b64 s[14:15], s[18:19]
    s_and_b32 s17, s17, 0xffff
    s_mov_b32 s18, 1966080
    s_mov_b32 s19, 0x00020000
    s_lshr_b32 s58, s60, 1
    s_lshl1_add_u32 s58, s2, s58
    s_mul_i32 s61, s58, 21846
    s_lshr_b32 s61, s61, 16
    s_mul_i32 s67, s61, 3
    s_sub_u32 s58, s58, s67
    s_mul_i32 s61, s61, 3072
    s_lshl_b32 s58, s58, 10
    s_add_u32 s58, s58, s61
    s_cmp_lt_u32 s61, 73728
    s_cselect_b32 s58, 2.0, s58
    s_buffer_load_dword s59, s[16:19], s58 offset:384
    s_buffer_load_dword s59, s[16:19], s58 offset:448
    s_buffer_load_dword s59, s[16:19], s58 offset:491904
    s_buffer_load_dword s59, s[16:19], s58 offset:491968
    s_add_u32 s58, s58, 983040
    s_call_b64 s[98:99], LD_issue
    s_waitcnt vmcnt(9)
    s_barrier
    s_buffer_load_dword s59, s[16:19], s58 offset:384
    s_buffer_load_dword s59, s[16:19], s58 offset:448
    s_buffer_load_dword s59, s[16:19], s58 offset:491904
    s_buffer_load_dword s59, s[16:19], s58 offset:491968
    s_lshl2_add_u32 s58, s53, s60
    s_mul_i32 s61, s58, 86
    s_lshr_b32 s61, s61, 8
    s_mul_i32 s67, s61, 3
    s_sub_u32 s58, s58, s67
    s_mul_i32 s58, s58, 1280
    s_mul_i32 s61, s61, 7680
    s_add_u32 s58, s58, s61
    s_mul_i32 s61, s51, 245888
    s_add_u32 s58, s58, s61
    s_call_b64 s[98:99], LD_issue
    s_call_b64 s[98:99], S_late2
    s_waitcnt vmcnt(9)
    s_barrier
    s_buffer_load_dword s59, s[32:35], s58 offset:0
    s_buffer_load_dword s59, s[32:35], s58 offset:64
    s_buffer_load_dword s59, s[32:35], s58 offset:3840
    s_buffer_load_dword s59, s[32:35], s58 offset:3904
    s_mul_i32 s58, s60, 61440
    s_add_u32 s58, s58, s44
    s_call_b64 s[98:99], LD_issue
    s_call_b64 s[98:99], S_late3
    s_call_b64 s[98:99], S_late4
    s_waitcnt vmcnt(9)
    s_barrier
    s_buffer_load_dword s59, s[24:27], s58 offset:0
    s_buffer_load_dword s59, s[24:27], s58 offset:64
    s_buffer_load_dword s59, s[24:27], s58 offset:128
    s_buffer_load_dword s59, s[24:27], s58 offset:192
    s_lshl_b32 s58, s60, 6
    s_add_u32 s58, s58, s44
    s_sub_u32 s58, s58, 131072
    s_call_b64 s[98:99], LD_issue
    s_waitcnt vmcnt(9)
    s_barrier
    s_buffer_load_dword s59, s[24:27], s58
    s_call_b64 s[98:99], LD_issue
    s_waitcnt vmcnt(9)
    s_barrier
    s_call_b64 s[98:99], LD_issue
    s_waitcnt vmcnt(9)
    s_barrier
    s_call_b64 s[98:99], LD_issue
    s_waitcnt vmcnt(9)
    s_barrier
    buffer_load_dwordx4 v[20:23], v18, s[24:27], s46 offen sc1
    s_mov_b32 s66, s51
    s_movk_i32 s71, 99
    s_call_b64 s[98:99], LD_issue
    s_waitcnt vmcnt(9)
    s_barrier
    v_mov_b32 v24, 163072
    ds_read_b32 v24, v24
    s_mov_b32 m0, s62
    s_add_u32 s62, s62, 4096
    buffer_load_dwordx4 v16, s[36:39], s63 offen lds
    s_add_u32 s63, s63, 40960
    s_mov_b32 m0, s62
    s_add_u32 s62, s62, 4096
    buffer_load_dwordx4 v16, s[36:39], s63 offen lds
    s_add_u32 s63, s63, 40960
    s_cmp_eq_u32 s63, 819200
    s_cselect_b32 s63, 0, s63
    s_mov_b32 m0, s62
    s_add_u32 s62, s62, 4096
    buffer_load_dwordx4 v16, s[36:39], s63 offen lds
    s_add_u32 s63, s63, 40960
    s_mov_b32 m0, s62
    s_add_u32 s62, s62, 4096
    buffer_load_dwordx4 v16, s[36:39], s63 offen lds
    s_add_u32 s63, s63, 40960
    s_cmp_eq_u32 s63, 819200
    s_cselect_b32 s63, 0, s63
    s_mov_b32 m0, s62
    s_add_u32 s62, s62, 4096
    buffer_load_dwordx4 v16, s[36:39], s63 offen lds
    s_add_u32 s63, s63, 40960
    s_mov_b32 m0, s62
    s_add_u32 s62, s62, 4096
    buffer_load_dwordx4 v16, s[36:39], s63 offen lds
    s_add_u32 s63, s63, 40960
    s_cmp_eq_u32 s63, 819200
    s_cselect_b32 s63, 0, s63
    s_mov_b32 m0, s62
    s_add_u32 s62, s62, 4096
    buffer_load_dwordx4 v16, s[36:39], s63 offen lds
    s_add_u32 s63, s63, 40960
    s_mov_b32 exec_hi, 3
    v_cmp_ne_u32 vcc, s54, v22
    s_cbranch_vccz LD_rs
LD_rsp:
    buffer_load_dwordx4 v[20:23], v18, s[24:27], s46 offen sc1
    s_waitcnt vmcnt(0)
    v_cmp_ne_u32 vcc, s54, v22
    s_cbranch_vccz LD_rs
    s_sleep 1
    s_sub_u32 s3, s3, 1
    s_cbranch_scc0 LD_rsp
    s_mov_b32 s3, 0
LD_rs:
    s_getreg_b32 s61, hwreg(HW_REG_XCC_ID)
    v_cmp_ne_u32 vcc, s61, v20
    s_lshr_b64 vcc, vcc, 24
    s_cselect_b32 s49, 0, 1
    s_lshl_b32 s61, s60, 5
    s_add_u32 s61, s61, 160828
    s_mov_b32 exec_hi, 0x3fffc
    s_mov_b32 exec_lo, 0
    v_cmp_eq_u32 vcc, s54, v22
    v_lshl_add_u32 v4, v0, 1, s61
    s_waitcnt lgkmcnt(0)
    v_mul_f32 v24, 0xbacccccd, v24
    v_fmac_f32 v21, v20, v24
    v_cndmask_b32 v21, 0, v21, vcc
    ds_write_b16_d16_hi v4, v21
    s_mov_b32 exec_hi, 0
    s_mov_b32 exec_lo, 0xffffff
    v_lshlrev_b32 v4, 3, v17
    v_add_u32 v4, 159808, v4
    ds_write_b64 v4, v[20:21]
    v_mov_b32 v4, 160768
    v_mov_b32 v5, s49
    ds_write_b32 v4, v5
    ds_write_b64 v4, v[28:29] offset:8
    ds_write_b64 v4, v[28:29] offset:16
    ds_write_b64 v4, v[28:29] offset:24
    ds_write_b64 v4, v[28:29] offset:32
    s_mov_b64 exec, -1
    s_waitcnt vmcnt(7) lgkmcnt(0)
    s_barrier
    s_mov_b32 m0, s62
    s_add_u32 s62, s62, 4096
    buffer_load_dwordx4 v16, s[36:39], s63 offen lds
    s_add_u32 s63, s63, 40960
    s_cmp_eq_u32 s63, 819200
    s_cselect_b32 s63, 0, s63
    s_mov_b32 m0, s62
    s_add_u32 s62, s62, 4096
    buffer_load_dwordx4 v16, s[36:39], s63 offen lds
    s_add_u32 s63, s63, 40960
    s_mov_b32 m0, s62
    s_add_u32 s62, s62, 4096
    buffer_load_dwordx4 v16, s[36:39], s63 offen lds
    s_add_u32 s63, s63, 40960
    s_cmp_eq_u32 s63, 819200
    s_cselect_b32 s63, 0, s63
    s_mov_b32 m0, s62
    s_add_u32 s62, s62, 4096
    buffer_load_dwordx4 v16, s[36:39], s63 offen lds
    s_add_u32 s63, s63, 40960
    s_mov_b32 m0, s62
    s_add_u32 s62, s62, 4096
    buffer_load_dwordx4 v16, s[36:39], s63 offen lds
    s_add_u32 s63, s63, 40960
    s_cmp_eq_u32 s63, 819200
    s_cselect_b32 s63, 0, s63
    s_mov_b32 m0, s62
    s_add_u32 s62, s62, 4096
    buffer_load_dwordx4 v16, s[36:39], s63 offen lds
    s_add_u32 s63, s63, 40960
    s_mov_b32 m0, s62
    s_add_u32 s62, s62, 4096
    buffer_load_dwordx4 v16, s[36:39], s63 offen lds
    s_add_u32 s63, s63, 40960
    s_cmp_eq_u32 s63, 819200
    s_cselect_b32 s63, 0, s63
    s_cmp_eq_u32 s60, 3
    s_cbranch_scc1 pf_11
    s_mul_i32 s67, s53, 6
    s_lshl_b32 s68, s60, 1
    s_add_u32 s67, s67, s68
    s_mul_i32 s67, s67, 24320
    s_add_u32 s67, s67, 1310720
    buffer_load_dword v182, v36, s[24:27], s67 offen sc1
    s_mov_b64 exec, -1
    s_branch pf_12
pf_11:
    v_lshlrev_b32 v4, 7, v0
    s_mov_b64 exec, 7
    buffer_load_dword v182, v4, s[24:27], s57 offen sc1
    s_mov_b64 exec, -1
pf_12:
    s_cmp_lt_u32 s60, 2
    s_cbranch_scc1 LD_s10
    v_subrev_u32 v98, 20480, v16
    s_add_u32 s61, s51, 0
    s_sub_u32 s67, s61, 10
    s_cselect_b32 s61, s61, s67
    s_mul_i32 s61, s61, 81920
    buffer_load_dwordx4 v[100:103], v16, s[36:39], s61 offen
    buffer_load_dwordx4 v[104:107], v98, s[36:39], s61 offen
    s_add_u32 s61, s61, 40960
    buffer_load_dwordx4 v[108:111], v16, s[36:39], s61 offen
    buffer_load_dwordx4 v[112:115], v98, s[36:39], s61 offen
    s_add_u32 s61, s51, 1
    s_sub_u32 s67, s61, 10
    s_cselect_b32 s61, s61, s67
    s_mul_i32 s61, s61, 81920
    buffer_load_dwordx4 v[116:119], v16, s[36:39], s61 offen
    buffer_load_dwordx4 v[120:123], v98, s[36:39], s61 offen
    s_add_u32 s61, s61, 40960
    buffer_load_dwordx4 v[124:127], v16, s[36:39], s61 offen
    buffer_load_dwordx4 v[128:131], v98, s[36:39], s61 offen
    s_add_u32 s61, s51, 2
    s_sub_u32 s67, s61, 10
    s_cselect_b32 s61, s61, s67
    s_mul_i32 s61, s61, 81920
    buffer_load_dwordx4 v[132:135], v16, s[36:39], s61 offen
    buffer_load_dwordx4 v[136:139], v98, s[36:39], s61 offen
    s_add_u32 s61, s61, 40960
    buffer_load_dwordx4 v[140:143], v16, s[36:39], s61 offen
    buffer_load_dwordx4 v[144:147], v98, s[36:39], s61 offen
    s_lshl_b32 s62, s60, 10
    s_add_u32 s62, s62, 10240
    v_lshl_add_u32 v99, v0, 4, s62
    s_barrier
    s_branch AT_67
LD_s10:
    v_mov_b32 v99, v16
    s_branch AT_start
F_start:
    v_and_b32 v0, 63, v0
    s_mov_b32 s3, 0x40000
    s_mov_b32 s47, 0xffff0000
    s_mov_b32 s26, 7340032
    s_mov_b32 s27, 0x00020000
    s_mov_b32 s38, 819200
    s_mov_b32 s39, 0x00020000
    s_mov_b32 s42, 2621440
    s_mov_b32 s43, 0x00020000
    s_and_b32 s49, s2, 7
    s_lshl_b32 s49, s49, 1
    s_add_u32 s49, s49, s56
    s_sub_u32 s49, s49, 30
    s_and_b32 s50, s48, 1
    s_lshr_b32 s51, s48, 1
    s_mul_i32 s52, s48, 6144
    s_mul_i32 s61, s49, 192
    v_mov_b32 v5, 128
    v_add_u32 v1, 0, v0
    v_mul_u32_u24 v2, 171, v1
    v_lshrrev_b32 v2, 11, v2
    v_mul_u32_u24 v3, 12, v2
    v_sub_u32 v3, v1, v3
    v_mul_u32_u24 v2, 3072, v2
    v_lshl_add_u32 v3, v3, 4, s61
    v_lshrrev_b32 v4, 8, v3
    v_cmp_eq_u32 vcc, 9, v4
    s_nop 1
    v_cndmask_b32 v4, 0, v5, vcc
    v_xad_u32 v210, v3, v4, v2
    v_add_u32 v1, 64, v0
    v_mul_u32_u24 v2, 171, v1
    v_lshrrev_b32 v2, 11, v2
    v_mul_u32_u24 v3, 12, v2
    v_sub_u32 v3, v1, v3
    v_mul_u32_u24 v2, 3072, v2
    v_lshl_add_u32 v3, v3, 4, s61
    v_lshrrev_b32 v4, 8, v3
    v_cmp_eq_u32 vcc, 9, v4
    s_nop 1
    v_cndmask_b32 v4, 0, v5, vcc
    v_xad_u32 v211, v3, v4, v2
    v_add_u32 v1, 128, v0
    v_mul_u32_u24 v2, 171, v1
    v_lshrrev_b32 v2, 11, v2
    v_mul_u32_u24 v3, 12, v2
    v_sub_u32 v3, v1, v3
    v_mul_u32_u24 v2, 3072, v2
    v_lshl_add_u32 v3, v3, 4, s61
    v_lshrrev_b32 v4, 8, v3
    v_cmp_eq_u32 vcc, 9, v4
    s_nop 1
    v_cndmask_b32 v4, 0, v5, vcc
    v_xad_u32 v212, v3, v4, v2
    s_mul_i32 s60, s51, 491520
    s_mov_b32 s30, 1966080
    s_mov_b32 s31, 0x00020000
    s_waitcnt lgkmcnt(0)
    s_cmp_eq_u32 s50, 0
    s_cselect_b32 s28, s14, s16
    s_cselect_b32 s29, s15, s17
    s_add_u32 m0, s52, 0
    s_add_u32 s62, s60, 0
    buffer_load_dwordx4 v210, s[28:31], s62 offen lds
    s_add_u32 m0, s52, 1024
    s_add_u32 s62, s60, 0
    buffer_load_dwordx4 v211, s[28:31], s62 offen lds
    s_add_u32 m0, s52, 2048
    s_add_u32 s62, s60, 0
    buffer_load_dwordx4 v212, s[28:31], s62 offen lds
    s_add_u32 m0, s52, 3072
    s_add_u32 s62, s60, 49152
    buffer_load_dwordx4 v210, s[28:31], s62 offen lds
    s_add_u32 m0, s52, 4096
    s_add_u32 s62, s60, 49152
    buffer_load_dwordx4 v211, s[28:31], s62 offen lds
    s_add_u32 m0, s52, 5120
    s_add_u32 s62, s60, 49152
    buffer_load_dwordx4 v212, s[28:31], s62 offen lds
    s_load_dword s54, s[24:25], 0
    s_mov_b32 s4, s12
    s_and_b32 s5, s13, 0xffff
    s_mov_b32 s6, 1280
    s_mov_b32 s7, 0x00020000
    s_mov_b32 s32, s18
    s_and_b32 s33, s19, 0xffff
    s_mov_b32 s34, 1966080
    s_mov_b32 s35, 0x00020000
    s_barrier
    s_add_u32 m0, s52, 49152
    s_add_u32 s62, s60, 98304
    buffer_load_dwordx4 v210, s[28:31], s62 offen lds
    s_add_u32 m0, s52, 50176
    s_add_u32 s62, s60, 98304
    buffer_load_dwordx4 v211, s[28:31], s62 offen lds
    s_add_u32 m0, s52, 51200
    s_add_u32 s62, s60, 98304
    buffer_load_dwordx4 v212, s[28:31], s62 offen lds
    s_add_u32 m0, s52, 52224
    s_add_u32 s62, s60, 147456
    buffer_load_dwordx4 v210, s[28:31], s62 offen lds
    s_add_u32 m0, s52, 53248
    s_add_u32 s62, s60, 147456
    buffer_load_dwordx4 v211, s[28:31], s62 offen lds
    s_add_u32 m0, s52, 54272
    s_add_u32 s62, s60, 147456
    buffer_load_dwordx4 v212, s[28:31], s62 offen lds
    s_mul_i32 s53, s48, 5120
    s_mul_i32 s61, s49, 122880
    s_add_u32 s61, s61, s53
    s_and_b32 s63, s48, 2
    s_lshl_b32 s63, s63, 2
    v_add_u32 v1, 0, v0
    v_mul_u32_u24 v2, 205, v1
    v_lshrrev_b32 v2, 14, v2
    v_lshl_or_b32 v2, v2, 1, s63
    v_xor_b32 v1, v1, v2
    v_lshlrev_b32 v213, 4, v1
    v_add_u32 v1, 64, v0
    v_mul_u32_u24 v2, 205, v1
    v_lshrrev_b32 v2, 14, v2
    v_lshl_or_b32 v2, v2, 1, s63
    v_xor_b32 v1, v1, v2
    v_lshlrev_b32 v214, 4, v1
    v_add_u32 v1, 128, v0
    v_mul_u32_u24 v2, 205, v1
    v_lshrrev_b32 v2, 14, v2
    v_lshl_or_b32 v2, v2, 1, s63
    v_xor_b32 v1, v1, v2
    v_lshlrev_b32 v215, 4, v1
    v_add_u32 v1, 192, v0
    v_mul_u32_u24 v2, 205, v1
    v_lshrrev_b32 v2, 14, v2
    v_lshl_or_b32 v2, v2, 1, s63
    v_xor_b32 v1, v1, v2
    v_lshlrev_b32 v216, 4, v1
    v_add_u32 v1, 256, v0
    v_mul_u32_u24 v2, 205, v1
    v_lshrrev_b32 v2, 14, v2
    v_lshl_or_b32 v2, v2, 1, s63
    v_xor_b32 v1, v1, v2
    v_lshlrev_b32 v217, 4, v1
    v_lshrrev_b32 v2, 4, v0
    v_bfe_u32 v1, v0, 2, 2
    v_lshl_add_u32 v3, v2, 3, v1
    v_and_b32 v4, 3, v0
    v_lshlrev_b32 v4, 3, v4
    v_mul_u32_u24 v5, 192, v3
    s_and_b32 s63, s48, 5
    s_mul_i32 s63, s63, 6144
    s_and_b32 s66, s51, 1
    s_mul_i32 s64, s66, 96
    s_add_u32 s63, s63, s64
    v_add3_u32 v218, v5, v4, s63
    v_and_b32 v6, 1, v2
    v_lshl_or_b32 v6, v6, 2, v1
    v_lshlrev_b32 v6, 5, v6
    v_mul_u32_u24 v3, 1280, v3
    s_mul_i32 s63, s48, 160
    s_add_u32 s64, s63, 0
    v_add_u32 v7, s64, v4
    v_xor_b32 v7, v7, v6
    v_add_u32 v200, v7, v3
    v_add_u32 v205, 98304, v200
    s_add_u32 s64, s63, 32
    v_add_u32 v7, s64, v4
    v_xor_b32 v7, v7, v6
    v_add_u32 v201, v7, v3
    v_add_u32 v206, 98304, v201
    s_add_u32 s64, s63, 64
    v_add_u32 v7, s64, v4
    v_xor_b32 v7, v7, v6
    v_add_u32 v202, v7, v3
    v_add_u32 v207, 98304, v202
    s_add_u32 s64, s63, 96
    v_add_u32 v7, s64, v4
    v_xor_b32 v7, v7, v6
    v_add_u32 v203, v7, v3
    v_add_u32 v208, 98304, v203
    s_add_u32 s64, s63, 128
    v_add_u32 v7, s64, v4
    v_xor_b32 v7, v7, v6
    v_add_u32 v204, v7, v3
    v_add_u32 v209, 98304, v204
    s_waitcnt lgkmcnt(0)
    s_add_u32 s54, s54, 2654435761
    s_mov_b32 s67, 0x3f803f80
    v_mov_b32 v220, s67
    v_mov_b32 v221, s67
    v_mov_b32 v222, s67
    v_mov_b32 v223, s67
    v_mov_b64 v[232:233], 0
    v_mov_b64 v[234:235], 0
    v_mov_b64 v[236:237], 0
    v_mov_b64 v[238:239], 0
    v_mov_b64 v[240:241], 0
    v_mov_b64 v[242:243], 0
    v_lshlrev_b32 v16, 3, v0
    buffer_load_dwordx2 v[10:11], v16, s[4:7], 0 offen offset:0
    buffer_load_dwordx2 v[12:13], v16, s[4:7], 0 offen offset:512
    buffer_load_dwordx2 v[14:15], v16, s[4:7], 0 offen offset:1024
    v_lshlrev_b32 v1, 4, v0
    v_lshlrev_b32 v7, 6, v0
    s_lshl_b32 s15, s49, 11
    s_add_u32 s15, s15, 196608
    s_add_u32 s70, s15, 32768
    s_cmp_eq_u32 s48, 7
    s_cselect_b32 s65, s70, 2.0
    s_mov_b64 exec, 0xffffff
    buffer_load_dword v219, v7, s[24:27], s65 offen sc1
    s_mov_b64 exec, -1
    v_mov_b32 v8, 155648
    v_mov_b32 v224, 0
    v_mov_b32 v225, 0
    v_mov_b32 v226, 0
    v_mov_b32 v227, 0
    ds_write_b128 v8, v[224:227] offset:0
    ds_write_b128 v8, v[224:227] offset:16
    ds_write_b128 v8, v[224:227] offset:32
    ds_write_b128 v8, v[224:227] offset:3648
    ds_write_b128 v8, v[224:227] offset:3664
    ds_write_b128 v8, v[224:227] offset:3776
    ds_write_b128 v8, v[224:227] offset:3792
    s_mul_i32 s65, s48, 1344
    s_add_u32 s45, s65, 16384
    v_lshl_add_u32 v16, v0, 2, s45
    v_and_b32 v19, 15, v0
    v_bfe_u32 v5, v0, 1, 1
    v_mov_b32 v6, 0x44444444
    v_mov_b32 v9, 0xeeeeeeee
    v_cmp_eq_u32 vcc, 1, v5
    s_nop 1
    v_cndmask_b32 v252, v6, v9, vcc
    v_lshlrev_b32 v6, 4, v2
    v_lshl_add_u32 v6, v5, 7, v6
    v_add_u32 v6, v6, v8
    v_bfe_u32 v3, v0, 2, 2
    v_and_b32 v4, 1, v0
    v_lshl_add_u32 v3, v3, 1, v4
    v_mul_u32_u24 v9, 1344, v3
    v_mul_u32_u24 v5, 672, v5
    v_add_u32 v9, v9, v5
    v_lshrrev_b32 v3, 1, v2
    v_mul_u32_u24 v3, 160, v3
    v_and_b32 v4, 1, v2
    v_lshl_add_u32 v3, v4, 4, v3
    s_lshr_b32 s65, s48, 2
    s_mul_i32 s63, s65, 320
    v_add3_u32 v9, v9, v3, s63
    s_lshl1_add_u32 s65, s65, s50
    s_mul_i32 s65, s65, 768
    s_mul_i32 s66, s66, 384
    s_add_u32 s65, s65, s66
    v_lshl_add_u32 v3, v19, 3, s65
    v_add_u32 v230, 155904, v3
    v_mul_u32_u24 v4, 3328, v2
    v_add_u32 v3, v3, v4
    s_mul_i32 s65, s48, 48
    v_add_u32 v4, s65, v0
    v_bfe_u32 v5, v4, 1, 1
    v_lshlrev_b32 v5, 7, v5
    v_and_b32 v17, 1, v4
    v_lshl_add_u32 v5, v17, 1, v5
    v_and_b32 v17, 0xfc, v4
    v_add_u32 v5, v5, v17
    v_lshrrev_b32 v17, 6, v4
    v_lshl_add_u32 v5, v17, 5, v5
    v_add_u32 v5, v5, v8
    v_lshlrev_b32 v4, 3, v4
    v_and_b32 v17, 7, v0
    v_lshlrev_b32 v18, 4, v17
    v_lshl_add_u32 v18, v2, 11, v18
    v_lshrrev_b32 v19, 3, v19
    v_lshl_add_u32 v229, v19, 12, v18
    s_lshl_b32 s8, s48, 13
    s_lshl_b32 s65, s49, 7
    s_add_u32 s8, s8, s65
    s_add_u32 s8, s8, 16384
    s_sub_u32 s44, s48, 2
    s_lshl_b32 s14, s49, 12
    s_lshl_b32 s65, s44, 11
    s_add_u32 s14, s14, s65
    s_add_u32 s14, s14, 16384
    s_lshr_b32 s65, s49, 1
    s_lshl_b32 s65, s65, 6
    s_lshl3_add_u32 s65, s49, s65
    s_and_b32 s66, s44, 1
    s_movk_i32 s19, 0xff
    s_cselect_b32 s18, s19, 0x00ff00ff
    s_mul_i32 s66, s66, 48
    s_add_u32 s65, s65, s66
    v_and_b32 v18, 1, v2
    v_lshrrev_b32 v19, 1, v2
    v_lshl_or_b32 v18, v18, 1, v19
    v_min_u32 v18, 2, v18
    v_lshl_add_u32 v18, v18, 4, v17
    v_add_u32 v18, s65, v18
    v_bfe_u32 v19, v18, 1, 1
    v_mul_u32_u24 v19, 672, v19
    v_and_b32 v17, 1, v18
    v_lshl_add_u32 v19, v17, 1, v19
    v_and_b32 v17, 0xffc, v18
    v_add_u32 v19, v19, v17
    v_lshlrev_b32 v18, 1, v18
    v_mov_b32 v17, v229
    s_sub_u32 s65, s54, 1
    v_mov_b32 v227, s65
    s_mov_b32 exec_hi, 0
    buffer_store_dwordx4 v[224:227], v17, s[24:27], s8 offen sc1
    s_mov_b32 exec_hi, -1
    s_lshr_b32 s68, s48, 1
    s_mul_i32 s68, s68, 3328
    s_lshl2_add_u32 s68, s50, s68
    s_lshr_b32 s16, s49, 2
    s_mul_i32 s16, s16, 61440
    s_add_u32 s16, s16, 262144
    s_mov_b32 s17, 0
    s_mov_b32 s20, 16
    s_and_b32 s9, s49, 1
    s_lshl3_add_u32 s9, s9, s48
    s_cmp_eq_u32 s9, 6
    s_cselect_b32 s9, 0, 2
    v_add_u32 v228, 155904, v4
    s_lshl_b32 s65, s48, 2
    v_add_u32 v231, s65, v8
    s_mov_b64 exec, 0
    s_cmp_eq_u32 s48, 0
    s_cbranch_scc1 HF0_0
    s_cmp_eq_u32 s48, 1
    s_cbranch_scc1 HF1_0
    s_cmp_eq_u32 s48, 2
    s_cbranch_scc1 HF2_0
    s_cmp_eq_u32 s48, 3
    s_cbranch_scc1 HF3_0
    s_cmp_eq_u32 s48, 4
    s_cbranch_scc1 HF4_0
    s_cmp_eq_u32 s48, 5
    s_cbranch_scc1 HF5_0
HF_ret:
    s_mov_b64 exec, -1
    s_add_u32 m0, s52, 98304
    s_add_u32 s62, s60, 196608
    buffer_load_dwordx4 v210, s[28:31], s62 offen lds
    s_add_u32 m0, s52, 99328
    s_add_u32 s62, s60, 196608
    buffer_load_dwordx4 v211, s[28:31], s62 offen lds
    s_add_u32 m0, s52, 100352
    s_add_u32 s62, s60, 196608
    buffer_load_dwordx4 v212, s[28:31], s62 offen lds
    s_add_u32 m0, s52, 101376
    s_add_u32 s62, s60, 245760
    buffer_load_dwordx4 v210, s[28:31], s62 offen lds
    s_add_u32 m0, s52, 102400
    s_add_u32 s62, s60, 245760
    buffer_load_dwordx4 v211, s[28:31], s62 offen lds
    s_add_u32 m0, s52, 103424
    s_add_u32 s62, s60, 245760
    buffer_load_dwordx4 v212, s[28:31], s62 offen lds
    s_waitcnt vmcnt(17)
    s_barrier
    ds_read_b64_tr_b16 v[20:21], v218 offset:0
    ds_read_b64_tr_b16 v[22:23], v218 offset:768
    ds_read_b64_tr_b16 v[24:25], v218 offset:12288
    ds_read_b64_tr_b16 v[26:27], v218 offset:13056
    ds_read_b64_tr_b16 v[28:29], v218 offset:32
    ds_read_b64_tr_b16 v[30:31], v218 offset:800
    ds_read_b64_tr_b16 v[32:33], v218 offset:12320
    ds_read_b64_tr_b16 v[34:35], v218 offset:13088
    ds_read_b64_tr_b16 v[36:37], v218 offset:64
    ds_read_b64_tr_b16 v[38:39], v218 offset:832
    ds_read_b64_tr_b16 v[40:41], v218 offset:12352
    ds_read_b64_tr_b16 v[42:43], v218 offset:13120
    s_waitcnt lgkmcnt(0)
    s_barrier
    s_add_u32 m0, s52, 0
    s_add_u32 s62, s60, 294912
    buffer_load_dwordx4 v210, s[28:31], s62 offen lds
    s_add_u32 m0, s52, 1024
    s_add_u32 s62, s60, 294912
    buffer_load_dwordx4 v211, s[28:31], s62 offen lds
    s_add_u32 m0, s52, 2048
    s_add_u32 s62, s60, 294912
    buffer_load_dwordx4 v212, s[28:31], s62 offen lds
    s_add_u32 m0, s52, 3072
    s_add_u32 s62, s60, 344064
    buffer_load_dwordx4 v210, s[28:31], s62 offen lds
    s_add_u32 m0, s52, 4096
    s_add_u32 s62, s60, 344064
    buffer_load_dwordx4 v211, s[28:31], s62 offen lds
    s_add_u32 m0, s52, 5120
    s_add_u32 s62, s60, 344064
    buffer_load_dwordx4 v212, s[28:31], s62 offen lds
    v_smfmac_f32_16x16x64_bf16 v[232:235], v[220:223], v[20:27], v252
    v_smfmac_f32_16x16x64_bf16 v[236:239], v[220:223], v[28:35], v252
    v_smfmac_f32_16x16x64_bf16 v[240:243], v[220:223], v[36:43], v252
    s_waitcnt vmcnt(17)
    s_barrier
    ds_read_b64_tr_b16 v[44:45], v218 offset:49152
    ds_read_b64_tr_b16 v[46:47], v218 offset:49920
    ds_read_b64_tr_b16 v[48:49], v218 offset:61440
    ds_read_b64_tr_b16 v[50:51], v218 offset:62208
    ds_read_b64_tr_b16 v[52:53], v218 offset:49184
    ds_read_b64_tr_b16 v[54:55], v218 offset:49952
    ds_read_b64_tr_b16 v[56:57], v218 offset:61472
    ds_read_b64_tr_b16 v[58:59], v218 offset:62240
    ds_read_b64_tr_b16 v[60:61], v218 offset:49216
    ds_read_b64_tr_b16 v[62:63], v218 offset:49984
    ds_read_b64_tr_b16 v[64:65], v218 offset:61504
    ds_read_b64_tr_b16 v[66:67], v218 offset:62272
    s_waitcnt lgkmcnt(0)
    s_barrier
    s_add_u32 m0, s52, 49152
    s_add_u32 s62, s60, 393216
    buffer_load_dwordx4 v210, s[28:31], s62 offen lds
    s_add_u32 m0, s52, 50176
    s_add_u32 s62, s60, 393216
    buffer_load_dwordx4 v211, s[28:31], s62 offen lds
    s_add_u32 m0, s52, 51200
    s_add_u32 s62, s60, 393216
    buffer_load_dwordx4 v212, s[28:31], s62 offen lds
    s_add_u32 m0, s52, 52224
    s_add_u32 s62, s60, 442368
    buffer_load_dwordx4 v210, s[28:31], s62 offen lds
    s_add_u32 m0, s52, 53248
    s_add_u32 s62, s60, 442368
    buffer_load_dwordx4 v211, s[28:31], s62 offen lds
    s_add_u32 m0, s52, 54272
    s_add_u32 s62, s60, 442368
    buffer_load_dwordx4 v212, s[28:31], s62 offen lds
    v_smfmac_f32_16x16x64_bf16 v[232:235], v[220:223], v[44:51], v252
    v_smfmac_f32_16x16x64_bf16 v[236:239], v[220:223], v[52:59], v252
    v_smfmac_f32_16x16x64_bf16 v[240:243], v[220:223], v[60:67], v252
    s_waitcnt vmcnt(12)
    s_barrier
    v_add_u32 v229, 98304, v218
    ds_read_b64_tr_b16 v[68:69], v229 offset:0
    ds_read_b64_tr_b16 v[70:71], v229 offset:768
    ds_read_b64_tr_b16 v[72:73], v229 offset:12288
    ds_read_b64_tr_b16 v[74:75], v229 offset:13056
    ds_read_b64_tr_b16 v[76:77], v229 offset:32
    ds_read_b64_tr_b16 v[78:79], v229 offset:800
    ds_read_b64_tr_b16 v[80:81], v229 offset:12320
    ds_read_b64_tr_b16 v[82:83], v229 offset:13088
    ds_read_b64_tr_b16 v[84:85], v229 offset:64
    ds_read_b64_tr_b16 v[86:87], v229 offset:832
    ds_read_b64_tr_b16 v[88:89], v229 offset:12352
    ds_read_b64_tr_b16 v[90:91], v229 offset:13120
    s_waitcnt lgkmcnt(0)
    s_barrier
    s_mul_i32 s62, s49, 3
    s_add_u32 s62, s62, 0
    s_lshr_b32 s63, s62, 2
    s_cmp_eq_u32 s63, 9
    s_cselect_b32 s63, 2, 0
    s_xor_b32 s62, s62, s63
    s_mul_i32 s62, s62, 40960
    s_add_u32 s62, s62, s53
    s_add_u32 m0, s53, 98304
    s_nop 0
    buffer_load_dwordx4 v213, s[32:35], s62 offen lds
    s_add_u32 m0, s53, 99328
    s_nop 0
    buffer_load_dwordx4 v214, s[32:35], s62 offen lds
    s_add_u32 m0, s53, 100352
    s_nop 0
    buffer_load_dwordx4 v215, s[32:35], s62 offen lds
    s_add_u32 m0, s53, 101376
    s_nop 0
    buffer_load_dwordx4 v216, s[32:35], s62 offen lds
    s_add_u32 m0, s53, 102400
    s_nop 0
    buffer_load_dwordx4 v217, s[32:35], s62 offen lds
    v_smfmac_f32_16x16x64_bf16 v[232:235], v[220:223], v[68:75], v252
    v_smfmac_f32_16x16x64_bf16 v[236:239], v[220:223], v[76:83], v252
    v_smfmac_f32_16x16x64_bf16 v[240:243], v[220:223], v[84:91], v252
    v_dot2_f32_bf16 v226, v10, s67, 0
    v_dot2_f32_bf16 v226, v11, s67, v226
    v_dot2_f32_bf16 v226, v12, s67, v226
    v_dot2_f32_bf16 v226, v13, s67, v226
    v_dot2_f32_bf16 v226, v14, s67, v226
    v_dot2_f32_bf16 v226, v15, s67, v226
    s_nop 2
    v_add_f32_dpp v226, v226, v226 row_ror:1 row_mask:0xf bank_mask:0xf
    s_nop 1
    v_add_f32_dpp v226, v226, v226 row_ror:2 row_mask:0xf bank_mask:0xf
    s_nop 1
    v_add_f32_dpp v226, v226, v226 row_ror:4 row_mask:0xf bank_mask:0xf
    s_nop 1
    v_add_f32_dpp v226, v226, v226 row_ror:8 row_mask:0xf bank_mask:0xf
    v_mov_b32 v229, v226
    s_nop 1
    v_permlane32_swap_b32 v226, v229
    v_add_f32 v226, v226, v229
    v_mov_b32 v229, v226
    s_nop 1
    v_permlane16_swap_b32 v226, v229
    v_add_f32 v226, v226, v229
    s_nop 0
    v_readfirstlane_b32 s55, v226
    s_waitcnt vmcnt(11)
    s_barrier
    ds_read_b64_tr_b16 v[92:93], v218 offset:0
    ds_read_b64_tr_b16 v[94:95], v218 offset:768
    ds_read_b64_tr_b16 v[96:97], v218 offset:12288
    ds_read_b64_tr_b16 v[98:99], v218 offset:13056
    ds_read_b64_tr_b16 v[100:101], v218 offset:32
    ds_read_b64_tr_b16 v[102:103], v218 offset:800
    ds_read_b64_tr_b16 v[104:105], v218 offset:12320
    ds_read_b64_tr_b16 v[106:107], v218 offset:13088
    ds_read_b64_tr_b16 v[108:109], v218 offset:64
    ds_read_b64_tr_b16 v[110:111], v218 offset:832
    ds_read_b64_tr_b16 v[112:113], v218 offset:12352
    ds_read_b64_tr_b16 v[114:115], v218 offset:13120
    s_waitcnt lgkmcnt(0)
    s_barrier
    s_mul_i32 s62, s49, 3
    s_add_u32 s62, s62, 1
    s_lshr_b32 s63, s62, 2
    s_cmp_eq_u32 s63, 9
    s_cselect_b32 s63, 2, 0
    s_xor_b32 s62, s62, s63
    s_mul_i32 s62, s62, 40960
    s_add_u32 s62, s62, s53
    s_add_u32 m0, s53, 0
    s_nop 0
    buffer_load_dwordx4 v213, s[32:35], s62 offen lds
    s_add_u32 m0, s53, 1024
    s_nop 0
    buffer_load_dwordx4 v214, s[32:35], s62 offen lds
    s_add_u32 m0, s53, 2048
    s_nop 0
    buffer_load_dwordx4 v215, s[32:35], s62 offen lds
    s_add_u32 m0, s53, 3072
    s_nop 0
    buffer_load_dwordx4 v216, s[32:35], s62 offen lds
    s_add_u32 m0, s53, 4096
    s_nop 0
    buffer_load_dwordx4 v217, s[32:35], s62 offen lds
    v_smfmac_f32_16x16x64_bf16 v[232:235], v[220:223], v[92:99], v252
    v_smfmac_f32_16x16x64_bf16 v[236:239], v[220:223], v[100:107], v252
    v_smfmac_f32_16x16x64_bf16 v[240:243], v[220:223], v[108:115], v252
    s_waitcnt vmcnt(10)
    s_barrier
    ds_read_b64_tr_b16 v[116:117], v218 offset:49152
    ds_read_b64_tr_b16 v[118:119], v218 offset:49920
    ds_read_b64_tr_b16 v[120:121], v218 offset:61440
    ds_read_b64_tr_b16 v[122:123], v218 offset:62208
    ds_read_b64_tr_b16 v[124:125], v218 offset:49184
    ds_read_b64_tr_b16 v[126:127], v218 offset:49952
    ds_read_b64_tr_b16 v[128:129], v218 offset:61472
    ds_read_b64_tr_b16 v[130:131], v218 offset:62240
    ds_read_b64_tr_b16 v[132:133], v218 offset:49216
    ds_read_b64_tr_b16 v[134:135], v218 offset:49984
    ds_read_b64_tr_b16 v[136:137], v218 offset:61504
    ds_read_b64_tr_b16 v[138:139], v218 offset:62272
    s_waitcnt lgkmcnt(0)
    s_barrier
    s_mul_i32 s62, s49, 3
    s_add_u32 s62, s62, 2
    s_lshr_b32 s63, s62, 2
    s_cmp_eq_u32 s63, 9
    s_cselect_b32 s63, 2, 0
    s_xor_b32 s62, s62, s63
    s_mul_i32 s62, s62, 40960
    s_add_u32 s62, s62, s53
    s_add_u32 m0, s53, 49152
    s_nop 0
    buffer_load_dwordx4 v213, s[32:35], s62 offen lds
    s_add_u32 m0, s53, 50176
    s_nop 0
    buffer_load_dwordx4 v214, s[32:35], s62 offen lds
    s_add_u32 m0, s53, 51200
    s_nop 0
    buffer_load_dwordx4 v215, s[32:35], s62 offen lds
    s_add_u32 m0, s53, 52224
    s_nop 0
    buffer_load_dwordx4 v216, s[32:35], s62 offen lds
    s_add_u32 m0, s53, 53248
    s_nop 0
    buffer_load_dwordx4 v217, s[32:35], s62 offen lds
    s_cmp_eq_u32 s48, 0
    s_cselect_b32 s65, s15, 2.0
    s_mov_b64 exec, 0xffffff
    buffer_load_dwordx2 v[224:225], v7, s[24:27], s65 offen sc1
    s_mov_b64 exec, -1
    v_smfmac_f32_16x16x64_bf16 v[232:235], v[220:223], v[116:123], v252
    v_smfmac_f32_16x16x64_bf16 v[236:239], v[220:223], v[124:131], v252
    v_smfmac_f32_16x16x64_bf16 v[240:243], v[220:223], v[132:139], v252
    s_mov_b64 exec, 0xffff
    s_nop 8
    v_pk_add_f32 v[232:233], v[232:233], v[234:235]
    ds_write_b64 v230, v[232:233] offset:0
    v_pk_add_f32 v[236:237], v[236:237], v[238:239]
    ds_write_b64 v230, v[236:237] offset:128
    v_pk_add_f32 v[240:241], v[240:241], v[242:243]
    ds_write_b64 v230, v[240:241] offset:256
    s_mov_b64 exec, -1
    s_waitcnt lgkmcnt(0)
    s_waitcnt vmcnt(6)
    s_barrier
    ds_read2st64_b32 v[232:233], v228 offset0:0 offset1:3
    ds_read2st64_b32 v[234:235], v228 offset0:6 offset1:9
    ds_read_b64_tr_b16 v[140:141], v205 offset:0
    ds_read_b64_tr_b16 v[142:143], v205 offset:5120
    ds_read_b64_tr_b16 v[152:153], v206 offset:0
    ds_read_b64_tr_b16 v[154:155], v206 offset:5120
    ds_read_b64_tr_b16 v[164:165], v207 offset:0
    ds_read_b64_tr_b16 v[166:167], v207 offset:5120
    ds_read_b64_tr_b16 v[176:177], v208 offset:0
    ds_read_b64_tr_b16 v[178:179], v208 offset:5120
    ds_read_b64_tr_b16 v[188:189], v209 offset:0
    ds_read_b64_tr_b16 v[190:191], v209 offset:5120
    ds_read_b64_tr_b16 v[144:145], v200 offset:0
    ds_read_b64_tr_b16 v[146:147], v200 offset:5120
    ds_read_b64_tr_b16 v[156:157], v201 offset:0
    ds_read_b64_tr_b16 v[158:159], v201 offset:5120
    ds_read_b64_tr_b16 v[168:169], v202 offset:0
    ds_read_b64_tr_b16 v[170:171], v202 offset:5120
    ds_read_b64_tr_b16 v[180:181], v203 offset:0
    ds_read_b64_tr_b16 v[182:183], v203 offset:5120
    ds_read_b64_tr_b16 v[192:193], v204 offset:0
    ds_read_b64_tr_b16 v[194:195], v204 offset:5120
    s_waitcnt lgkmcnt(0)
    v_add_f32 v0, v232, v234
    v_add_f32 v2, v233, v235
    s_waitcnt vmcnt(1)
    s_barrier
    ds_read_b64_tr_b16 v[148:149], v200 offset:49152
    ds_read_b64_tr_b16 v[150:151], v200 offset:54272
    ds_read_b64_tr_b16 v[160:161], v201 offset:49152
    ds_read_b64_tr_b16 v[162:163], v201 offset:54272
    ds_read_b64_tr_b16 v[172:173], v202 offset:49152
    ds_read_b64_tr_b16 v[174:175], v202 offset:54272
    ds_read_b64_tr_b16 v[184:185], v203 offset:49152
    ds_read_b64_tr_b16 v[186:187], v203 offset:54272
    ds_read_b64_tr_b16 v[196:197], v204 offset:49152
    ds_read_b64_tr_b16 v[198:199], v204 offset:54272
    s_waitcnt lgkmcnt(0)
F_rdy:
HF0_0:
    s_cbranch_execz HF0_1
    s_cmp_lg_u32 s48, 0
    s_cbranch_scc1 F_wait
    s_mov_b64 exec, 0xffffff
    s_branch F_pw
F_poll:
    buffer_load_dwordx2 v[224:225], v7, s[24:27], s15 offen sc1
F_pw:
    s_waitcnt vmcnt(0)
    v_cmp_ne_u32 vcc, s54, v225
    s_cbranch_vccz F_got
    s_sleep 1
    s_sub_u32 s3, s3, 1
    s_cbranch_scc0 F_poll
    s_mov_b32 s3, 0
F_got:
    s_mov_b64 exec, -1
    v_max_u32_dpp v226, v224, v224 row_ror:1 row_mask:0xf bank_mask:0xf
    s_nop 1
    v_max_u32_dpp v226, v226, v226 row_ror:2 row_mask:0xf bank_mask:0xf
    s_nop 1
    v_max_u32_dpp v226, v226, v226 row_ror:4 row_mask:0xf bank_mask:0xf
    s_nop 1
    v_max_u32_dpp v226, v226, v226 row_ror:8 row_mask:0xf bank_mask:0xf
    s_nop 0
    v_readlane_b32 s60, v226, 0
    v_readlane_b32 s62, v226, 16
    s_max_u32 s60, s60, s62
    s_max_u32 s60, s60, 1572865
    s_sub_u32 s60, s60, 1572864
F_thr:
    v_cmp_le_u32 vcc, s60, v224
    s_add_u32 s60, s60, 196608
    s_cbranch_scc1 F_thd
    s_bcnt1_i32_b32 s62, vcc_lo
    s_cmp_gt_u32 s62, 8
    s_cbranch_scc1 F_thr
F_thd:
HF0_1:
    s_cbranch_execz HF_ret
    v_mbcnt_lo_u32_b32 v226, vcc_lo, 0
    v_cmp_gt_u32 s[62:63], 8, v226
    v_lshl_add_u32 v226, v226, 2, v8
    s_and_b64 exec, vcc, s[62:63]
    ds_write_b32 v226, v224 offset:0
    s_mov_b64 exec, -1
    s_waitcnt lgkmcnt(0)
F_wait:
    s_waitcnt vmcnt(0)
    s_barrier
    ds_read_b32 v224, v231 offset:0
    s_waitcnt lgkmcnt(0)
    v_readfirstlane_b32 s60, v224
F_redo:
    v_mov_b64 v[232:233], 0
    v_mov_b64 v[234:235], 0
    v_mov_b64 v[236:237], 0
    v_mov_b64 v[238:239], 0
    v_mov_b64 v[240:241], 0
    v_mov_b64 v[242:243], 0
    s_and_b32 s61, s60, 0xfff
    s_cbranch_scc0 F_b1
    s_lshr_b32 s62, s61, 4
    s_mul_i32 s62, s62, 171
    s_lshr_b32 s62, s62, 10
    s_mul_i32 s62, s62, 2560
    s_add_u32 s62, s62, s16
    s_add_u32 s63, s54, s61
    v_mov_b64 v[228:229], 0
    v_mov_b32 v230, s63
    buffer_load_dwordx3 v[220:222], v1, s[24:27], s62 offen offset:0 sc1
    buffer_load_dwordx3 v[224:226], v1, s[24:27], s62 offen offset:1024 sc1
    s_mov_b32 exec_hi, 0
    buffer_load_dwordx3 v[228:230], v1, s[24:27], s62 offen offset:2048 sc1
    s_mov_b32 exec_hi, -1
    s_branch F_rw
F_row:
    s_mov_b64 exec, s[58:59]
    s_cbranch_execz F_r0
    buffer_load_dwordx3 v[220:222], v1, s[24:27], s62 offen offset:0 sc1
F_r0:
    s_mov_b64 exec, s[64:65]
    s_cbranch_execz F_r1
    buffer_load_dwordx3 v[224:226], v1, s[24:27], s62 offen offset:1024 sc1
F_r1:
    s_mov_b64 exec, s[10:11]
    s_cbranch_execz F_r2
    buffer_load_dwordx3 v[228:230], v1, s[24:27], s62 offen offset:2048 sc1
F_r2:
    s_mov_b64 exec, -1
F_rw:
    s_waitcnt vmcnt(0)
    ds_write2_b32 v16, v220, v221 offset0:0 offset1:168
    ds_write2_b32 v16, v224, v225 offset0:64 offset1:232
HF1_0:
    s_cbranch_execz HF1_1
    s_mov_b32 exec_hi, 0
    ds_write_b32 v16, v228 offset:512
    ds_write_b32 v16, v229 offset:1184
    s_mov_b32 exec_hi, -1
    v_cmp_ne_u32 s[58:59], s63, v222
    v_cmp_ne_u32 s[64:65], s63, v226
    v_cmp_ne_u32 s[10:11], s63, v230
    s_or_b64 vcc, s[58:59], s[64:65]
    s_or_b64 vcc, vcc, s[10:11]
    s_cbranch_scc0 F_ok
    s_sub_u32 s20, s20, 1
    s_cbranch_scc0 F_row
F_b1:
    s_waitcnt lgkmcnt(0)
    s_barrier
    s_cmp_lg_u32 s9, s17
    s_cbranch_scc1 F_nwb
    buffer_wbl2 sc1
F_nwb:
    ds_read_b128 v[200:203], v9 offset:16384
    ds_read_b128 v[204:207], v9 offset:16416
    ds_read_b128 v[208:211], v9 offset:16448
    ds_read_b128 v[212:215], v9 offset:16480
    ds_read_b128 v[216:219], v9 offset:16512
    s_waitcnt lgkmcnt(4)
    v_smfmac_f32_16x16x64_bf16 v[232:235], v[200:203], v[20:27], v252
    v_smfmac_f32_16x16x64_bf16 v[236:239], v[200:203], v[28:35], v252
    v_smfmac_f32_16x16x64_bf16 v[240:243], v[200:203], v[36:43], v252
    s_waitcnt lgkmcnt(3)
    v_smfmac_f32_16x16x64_bf16 v[232:235], v[204:207], v[44:51], v252
    v_smfmac_f32_16x16x64_bf16 v[236:239], v[204:207], v[52:59], v252
    v_smfmac_f32_16x16x64_bf16 v[240:243], v[204:207], v[60:67], v252
    s_waitcnt lgkmcnt(2)
    v_smfmac_f32_16x16x64_bf16 v[232:235], v[208:211], v[68:75], v252
    v_smfmac_f32_16x16x64_bf16 v[236:239], v[208:211], v[76:83], v252
    v_smfmac_f32_16x16x64_bf16 v[240:243], v[208:211], v[84:91], v252
    s_waitcnt lgkmcnt(1)
    v_smfmac_f32_16x16x64_bf16 v[232:235], v[212:215], v[92:99], v252
    v_smfmac_f32_16x16x64_bf16 v[236:239], v[212:215], v[100:107], v252
    v_smfmac_f32_16x16x64_bf16 v[240:243], v[212:215], v[108:115], v252
    s_waitcnt lgkmcnt(0)
    v_smfmac_f32_16x16x64_bf16 v[232:235], v[216:219], v[116:123], v252
HF1_1:
    s_cbranch_execz HF_ret
    v_smfmac_f32_16x16x64_bf16 v[236:239], v[216:219], v[124:131], v252
    v_smfmac_f32_16x16x64_bf16 v[240:243], v[216:219], v[132:139], v252
    s_nop 8
    s_branch F_pw2
F_ok:
    v_dot2_f32_bf16 v222, v220, s67, 0
    v_dot2_f32_bf16 v223, v220, v220, 0
    v_dot2_f32_bf16 v226, v220, v10, 0
    v_dot2_f32_bf16 v222, v221, s67, v222
    v_dot2_f32_bf16 v223, v221, v221, v223
    v_dot2_f32_bf16 v226, v221, v11, v226
    v_dot2_f32_bf16 v222, v224, s67, v222
    v_dot2_f32_bf16 v223, v224, v224, v223
    v_dot2_f32_bf16 v226, v224, v12, v226
    v_dot2_f32_bf16 v222, v225, s67, v222
    v_dot2_f32_bf16 v223, v225, v225, v223
    v_dot2_f32_bf16 v226, v225, v13, v226
    v_dot2_f32_bf16 v222, v228, s67, v222
    v_dot2_f32_bf16 v223, v228, v228, v223
    v_dot2_f32_bf16 v226, v228, v14, v226
    v_dot2_f32_bf16 v222, v229, s67, v222
    v_dot2_f32_bf16 v223, v229, v229, v223
    v_dot2_f32_bf16 v226, v229, v15, v226
    s_waitcnt lgkmcnt(0)
    s_barrier
    s_cmp_lg_u32 s9, s17
    s_cbranch_scc1 F_nwc
    buffer_wbl2 sc1
F_nwc:
    ds_read_b128 v[200:203], v9 offset:16384
    ds_read_b128 v[204:207], v9 offset:16416
    ds_read_b128 v[208:211], v9 offset:16448
    ds_read_b128 v[212:215], v9 offset:16480
    ds_read_b128 v[216:219], v9 offset:16512
    v_mov_b32 v227, v226
    v_permlane32_swap_b32 v222, v223
    s_nop 0
    v_permlane32_swap_b32 v226, v227
HF2_0:
    s_cbranch_execz HF2_1
    v_add_f32 v222, v222, v223
    v_add_f32 v226, v226, v227
    v_mov_b32 v224, s68
    v_mov_b32 v223, s45
    v_permlane16_swap_b32 v222, v226
    v_add_f32 v222, v222, v226
    s_waitcnt lgkmcnt(4)
    v_smfmac_f32_16x16x64_bf16 v[232:235], v[200:203], v[20:27], v252
    v_add_f32_dpp v222, v222, v222 row_ror:1 row_mask:0xf bank_mask:0xf
    s_nop 1
    v_add_f32_dpp v222, v222, v222 row_ror:2 row_mask:0xf bank_mask:0xf
    v_smfmac_f32_16x16x64_bf16 v[236:239], v[200:203], v[28:35], v252
    s_nop 0
    v_add_f32_dpp v222, v222, v222 row_ror:4 row_mask:0xf bank_mask:0xf
    s_nop 1
    v_add_f32_dpp v222, v222, v222 row_ror:8 row_mask:0xf bank_mask:0xf
    v_smfmac_f32_16x16x64_bf16 v[240:243], v[200:203], v[36:43], v252
    v_readlane_b32 s64, v222, 32
    v_readlane_b32 s65, v222, 16
    s_waitcnt lgkmcnt(3)
    v_smfmac_f32_16x16x64_bf16 v[232:235], v[204:207], v[44:51], v252
    v_mov_b32 v220, v222
    v_mov_b32 v221, s64
    v_smfmac_f32_16x16x64_bf16 v[236:239], v[204:207], v[52:59], v252
    v_mul_f32 v220, 0x3acccccd, v220
    v_mul_f32 v221, 0x3acccccd, v221
    v_smfmac_f32_16x16x64_bf16 v[240:243], v[204:207], v[60:67], v252
    v_fma_f32 v221, -v220, v220, v221
    v_max_f32 v221, 0, v221
    s_waitcnt lgkmcnt(2)
    v_smfmac_f32_16x16x64_bf16 v[232:235], v[208:211], v[68:75], v252
    v_cvt_pk_bf16_f32 v221, v221, v221
    v_and_b32 v221, 0xffff0000, v221
    v_smfmac_f32_16x16x64_bf16 v[236:239], v[208:211], v[76:83], v252
    v_add_f32 v221, 0x3727c5ac, v221
    v_cvt_pk_bf16_f32 v221, v221, v221
    v_smfmac_f32_16x16x64_bf16 v[240:243], v[208:211], v[84:91], v252
    v_and_b32 v221, 0xffff0000, v221
    v_sqrt_f32 v221, v221
    s_waitcnt lgkmcnt(1)
HF2_1:
    s_cbranch_execz HF_ret
    v_smfmac_f32_16x16x64_bf16 v[232:235], v[212:215], v[92:99], v252
    v_cvt_pk_bf16_f32 v220, v220, v220
    v_and_b32 v220, 0xffff0000, v220
    v_smfmac_f32_16x16x64_bf16 v[236:239], v[212:215], v[100:107], v252
    v_cvt_pk_bf16_f32 v221, v221, v221
    v_and_b32 v221, 0xffff0000, v221
    v_smfmac_f32_16x16x64_bf16 v[240:243], v[212:215], v[108:115], v252
    v_rcp_f32 v221, v221
    v_mul_f32 v222, s55, v220
    s_waitcnt lgkmcnt(0)
    v_smfmac_f32_16x16x64_bf16 v[232:235], v[216:219], v[116:123], v252
    v_sub_f32 v222, s65, v222
    v_mul_f32 v222, v222, v221
    v_smfmac_f32_16x16x64_bf16 v[236:239], v[216:219], v[124:131], v252
    v_ashrrev_i32 v225, 31, v222
    v_or_b32 v225, 0x80000000, v225
    v_smfmac_f32_16x16x64_bf16 v[240:243], v[216:219], v[132:139], v252
    v_xor_b32 v225, v225, v222
    v_and_b32 v225, 0xfffff000, v225
    v_or_b32 v225, s61, v225
    s_mov_b64 exec, 1
    ds_write2_b32 v224, v220, v221 offset0:0 offset1:2
    ds_write2_b32 v224, v222, v223 offset0:4 offset1:6
    ds_max_u64 v8, v[224:225] offset:32
    s_mov_b64 exec, -1
F_pw2:
    v_pk_add_f32 v[232:233], v[232:233], v[234:235]
    ds_write_b64 v3, v[232:233] offset:256
    v_pk_add_f32 v[236:237], v[236:237], v[238:239]
    ds_write_b64 v3, v[236:237] offset:384
    v_pk_add_f32 v[240:241], v[240:241], v[242:243]
    ds_write_b64 v3, v[240:241] offset:512
    s_cmp_ge_u32 s48, 2
    v_mov_b64 v[244:245], 0
    v_mov_b64 v[246:247], 0
    v_mov_b64 v[248:249], 0
    v_mov_b64 v[250:251], 0
    s_waitcnt lgkmcnt(0)
    s_barrier
    ds_read_b64 v[224:225], v8 offset:32
    v_mov_b64 v[232:233], 0
    v_mov_b64 v[234:235], 0
HF3_0:
    s_cbranch_execz HF3_1
    v_mov_b64 v[236:237], 0
    v_mov_b64 v[238:239], 0
    v_mov_b64 v[240:241], 0
    v_mov_b64 v[242:243], 0
    s_waitcnt lgkmcnt(0)
    s_cbranch_scc1 F_gu
    v_add_u32 v227, v224, v4
    ds_read2_b32 v[228:229], v224 offset0:0 offset1:2
    ds_read2st64_b32 v[208:209], v227 offset0:1 offset1:4
    ds_read2st64_b32 v[210:211], v227 offset0:7 offset1:10
    s_waitcnt lgkmcnt(1)
    v_fma_f32 v208, -v228, v0, v208
    v_fma_f32 v209, -v228, v2, v209
    s_waitcnt lgkmcnt(0)
    v_add_f32 v208, v208, v210
    v_add_f32 v209, v209, v211
    v_mul_f32 v208, v208, v229
    v_mul_f32 v209, v209, v229
    v_cvt_pk_bf16_f32 v209, v208, v209
    v_lshlrev_b32 v208, 16, v209
    v_mul_f32 v210, 0xbfb8aa3b, v208
    v_exp_f32 v210, v210
    v_and_b32 v209, s47, v209
    v_add_f32 v210, 1.0, v210
    v_rcp_f32 v210, v210
    s_mov_b32 exec_hi, 0xffff
    v_mul_f32 v208, v208, v210
    v_cvt_pk_bf16_f32 v208, v208, v208
    v_and_b32 v208, 0xffff0000, v208
    v_mul_f32 v208, v208, v209
    v_cvt_pk_bf16_f32 v208, v208, v208
    ds_write_b16 v5, v208 offset:3584
    s_mov_b64 exec, -1
    s_waitcnt lgkmcnt(0)
F_gu:
    s_barrier
    ds_read_b128 v[200:203], v6 offset:3584
    ds_read_b128 v[204:207], v6 offset:3648
    v_readfirstlane_b32 s61, v225
    v_mov_b32 v220, 0
    s_and_b32 s61, s61, 0xfff
    s_add_u32 s63, s54, s61
    v_mov_b32 v215, s63
    s_waitcnt lgkmcnt(1)
    v_smfmac_f32_16x16x64_bf16 v[232:235], v[200:203], v[140:147], v252
    v_smfmac_f32_16x16x64_bf16 v[236:239], v[200:203], v[152:159], v252
    v_smfmac_f32_16x16x64_bf16 v[240:243], v[200:203], v[164:171], v252
HF3_1:
    s_cbranch_execz HF_ret
    v_smfmac_f32_16x16x64_bf16 v[244:247], v[200:203], v[176:183], v252
    v_smfmac_f32_16x16x64_bf16 v[248:251], v[200:203], v[188:195], v252
    s_cmp_lg_u32 s48, 7
    s_cbranch_scc1 F_n7
    s_mov_b64 exec, 0xffffff
    buffer_load_dwordx2 v[220:221], v7, s[24:27], s70 offen sc1
    s_mov_b64 exec, -1
F_n7:
    s_waitcnt lgkmcnt(0)
    v_smfmac_f32_16x16x64_bf16 v[232:235], v[204:207], v[144:151], v252
    v_smfmac_f32_16x16x64_bf16 v[236:239], v[204:207], v[156:163], v252
    v_smfmac_f32_16x16x64_bf16 v[240:243], v[204:207], v[168:175], v252
    v_smfmac_f32_16x16x64_bf16 v[244:247], v[204:207], v[180:187], v252
    v_smfmac_f32_16x16x64_bf16 v[248:251], v[204:207], v[192:199], v252
    s_nop 7
    v_add_f32 v212, v232, v234
    v_add_f32 v213, v236, v238
    v_add_f32 v214, v240, v242
    s_mov_b32 exec_lo, s47
    v_add_f32 v212, v244, v246
    v_add_f32 v213, v248, v250
    s_mov_b32 exec_lo, -1
    s_mov_b32 exec_hi, 0
    buffer_store_dwordx4 v[212:215], v17, s[24:27], s8 offen sc1
    s_mov_b32 exec_hi, -1
    s_cmp_lt_u32 s44, 2
    s_cbranch_scc0 F_rest
    ds_read2_b32 v[228:229], v224 offset0:0 offset1:2
    ds_read2_b32 v[230:231], v224 offset0:4 offset1:6
    s_lshr_b32 s65, s61, 4
    s_mul_i32 s65, s65, 171
    s_lshr_b32 s65, s65, 10
    s_mul_i32 s64, s65, 2560
    s_add_u32 s64, s64, 131072
    s_mul_i32 s71, s65, 96
    s_sub_u32 s66, s61, s71
    s_lshr_b32 s71, s65, 1
    s_mul_i32 s71, s71, 86
    s_add_u32 s66, s66, s71
    s_sub_u32 s66, s66, 10
    s_lshl_b32 s66, s66, 1
    s_and_b32 s65, s65, 1
    s_add_u32 s66, s66, s65
    s_mul_i32 s66, s66, 1280
    v_lshrrev_b32 v223, 3, v18
HF4_0:
    s_cbranch_execz HF4_1
    v_lshlrev_b32 v223, 4, v223
    s_waitcnt lgkmcnt(0)
    v_add_u32 v226, v231, v19
    v_and_b32 v226, 0xfffe, v226
    ds_read_u16 v226, v226
    v_cvt_pk_bf16_f32 v231, v230, v230
    v_and_b32 v231, 0xffff0000, v231
    v_mul_f32 v231, 0xbfb8aa3b, v231
    v_exp_f32 v231, v231
    s_nop 0
    v_add_f32 v231, 1.0, v231
    v_rcp_f32 v231, v231
    s_waitcnt lgkmcnt(0)
    v_lshlrev_b32 v226, 16, v226
    v_cvt_pk_bf16_f32 v231, v231, v231
    v_and_b32 v231, 0xffff0000, v231
    v_sub_f32 v227, v226, v228
    v_cvt_pk_bf16_f32 v227, v227, v227
    v_and_b32 v227, 0xffff0000, v227
    v_mul_f32 v227, v227, v229
    v_cvt_pk_bf16_f32 v227, v227, v227
    v_and_b32 v227, 0xffff0000, v227
    s_waitcnt vmcnt(0)
F_yp:
    buffer_load_dwordx4 v[200:203], v1, s[24:27], s14 offen sc1
    buffer_load_dwordx4 v[204:207], v1, s[24:27], s14 offen offset:1024 sc1
    s_mov_b64 exec, s[18:19]
    buffer_load_dword v222, v223, s[24:27], s64 offen offset:8 sc1
    s_mov_b64 exec, -1
    s_waitcnt vmcnt(1)
    ds_read_b32 v224, v8 offset:40
    v_cmp_ne_u32 vcc, s63, v203
    v_cmp_ne_u32 s[58:59], s63, v207
    v_add_f32 v200, v200, v204
    v_add_f32 v201, v201, v205
    v_add_f32 v202, v202, v206
    s_or_b64 vcc, vcc, s[58:59]
    s_cbranch_scc1 F_chk
    v_mov_b32 v203, v202
    v_permlane32_swap_b32 v200, v201
    s_nop 0
    v_permlane32_swap_b32 v202, v203
    v_add_f32 v200, v200, v201
    v_add_f32 v202, v202, v203
    s_nop 1
    v_permlane16_swap_b32 v200, v202
    v_add_f32 v200, v200, v202
    s_nop 1
HF4_1:
    s_cbranch_execz HF_ret
    v_add_f32_dpp v200, v200, v200 row_ror:8 row_mask:0xf bank_mask:0xf
    v_cvt_pk_bf16_f32 v200, v200, v200
    v_and_b32 v200, 0xffff0000, v200
    v_mul_f32 v200, v200, v231
    v_cvt_pk_bf16_f32 v200, v200, v200
    v_and_b32 v200, 0xffff0000, v200
    v_add_f32 v200, v200, v227
    v_cvt_pk_bf16_f32 v200, v200, v200
    v_and_b32 v200, 0xffff0000, v200
    v_add_f32 v200, v200, v226
    v_cvt_pk_bf16_f32 v200, v200, v200
F_vf:
    s_mov_b64 exec, s[18:19]
    s_waitcnt vmcnt(0) lgkmcnt(0)
    v_readfirstlane_b32 s60, v224
    v_cmp_ne_u32 vcc, s63, v222
    s_and_b32 s62, s60, 0xfff
    s_cmp_lg_u32 s62, s61
    s_cbranch_scc1 F_vw
    s_cbranch_vccnz F_vl
    buffer_store_short v200, v18, s[40:43], s66 offen
    s_or_b32 s65, s49, s44
    s_cbranch_scc1 L_fin
    s_mov_b64 exec, 1
    v_mov_b32 v9, 0
    v_mov_b32 v10, s54
    buffer_store_dword v10, v9, s[24:27], 0 offen
    s_branch L_fin
F_vw:
    s_cmp_lg_u32 s62, 0
    s_cbranch_scc1 F_vx
    s_cbranch_vccz F_vn
F_vl:
    buffer_load_dword v222, v223, s[24:27], s64 offen offset:8 sc1
F_vn:
    ds_read_b32 v224, v8 offset:40
    s_sub_u32 s3, s3, 1
    s_cbranch_scc0 F_vf
    s_mov_b32 s3, 0
    s_branch L_fin
F_vx:
    s_cmp_eq_u32 s17, 0
    s_cbranch_scc1 F_again
    s_branch L_fin
F_chk:
    s_waitcnt lgkmcnt(0)
    v_readfirstlane_b32 s60, v224
    s_and_b32 s62, s60, 0xfff
    s_cselect_b32 s62, s62, s61
    s_cmp_lg_u32 s62, s61
    s_cbranch_scc1 F_vx
    s_sub_u32 s3, s3, 1
    s_cbranch_scc0 F_yp
    s_mov_b32 s3, 0
    s_branch L_fin
F_rest:
HF5_0:
    s_cbranch_execz HF5_1
    s_cmp_lg_u32 s17, 0
    s_cbranch_scc1 L_fin
    s_cmp_lg_u32 s48, 7
    s_cbranch_scc1 F_tw
    s_mov_b64 exec, 0xffffff
    s_waitcnt vmcnt(1)
    s_branch F_tc
F_tp:
    buffer_load_dwordx2 v[220:221], v7, s[24:27], s70 offen sc1
    s_waitcnt vmcnt(0)
F_tc:
    v_cmp_ne_u32 vcc, s54, v221
    s_cbranch_vccz F_tg
    s_sub_u32 s3, s3, 1
    s_cbranch_scc0 F_tp
    s_mov_b32 s3, 0
F_tg:
    s_mov_b64 exec, -1
    v_max_u32_dpp v222, v220, v220 row_ror:1 row_mask:0xf bank_mask:0xf
    s_nop 1
    v_max_u32_dpp v222, v222, v222 row_ror:2 row_mask:0xf bank_mask:0xf
    s_nop 1
    v_max_u32_dpp v222, v222, v222 row_ror:4 row_mask:0xf bank_mask:0xf
    s_nop 1
    v_max_u32_dpp v222, v222, v222 row_ror:8 row_mask:0xf bank_mask:0xf
    s_nop 0
    v_readlane_b32 s60, v222, 0
    v_readlane_b32 s62, v222, 16
    s_max_u32 s60, s60, s62
    s_and_b32 s62, s60, 0xfff
    s_cselect_b32 s60, s60, 1
    v_mov_b32 v220, s60
    ds_write_b32 v8, v220 offset:40
F_tw:
    ds_read_b32 v224, v8 offset:40
    s_waitcnt lgkmcnt(0)
    v_readfirstlane_b32 s60, v224
    s_and_b32 s62, s60, 0xfff
    s_cbranch_scc1 F_tk
    s_sleep 2
    s_sub_u32 s3, s3, 1
    s_cbranch_scc0 F_tw
    s_mov_b32 s3, 0
    s_branch L_fin
F_tk:
    s_cmp_eq_u32 s62, s61
    s_cbranch_scc1 L_fin
F_again:
    s_mov_b64 exec, -1
    s_waitcnt vmcnt(0)
    s_mov_b32 s17, 1
    s_mov_b32 s16, 131072
    s_mov_b32 s20, 0x40000
    v_mov_b64 v[224:225], 0
    s_cmp_eq_u32 s48, 0
HF5_1:
    s_cbranch_execz HF_ret
    s_cselect_b32 s60, s60, 0
    s_cbranch_scc0 F_redo
    ds_write_b64 v8, v[224:225] offset:32
    s_branch F_redo
L_last:
.section .rodata,"a"
.p2align 6
.amdhsa_kernel sequential_preLN__sliding_local_dilated__moe_arch_mod__prompt_kernel
  .amdhsa_next_free_vgpr 256
  .amdhsa_next_free_sgpr 102
  .amdhsa_accum_offset 256
  .amdhsa_group_segment_fixed_size 0
  .amdhsa_kernarg_size 88
  .amdhsa_user_sgpr_count 2
  .amdhsa_user_sgpr_kernarg_segment_ptr 1
  .amdhsa_system_sgpr_workgroup_id_x 1
  .amdhsa_float_denorm_mode_32 3
  .amdhsa_float_denorm_mode_16_64 3
.end_amdhsa_kernel
```

```asm
; @launch grid=(256,1,1) block=(512,1,1) lds=163840
.amdgcn_target "amdgcn-amd-amdhsa--gfx950"
.text
.globl sequential_preLN__sliding_local_dilated__moe_arch_mod__prompt_kernel
.p2align 8
.type sequential_preLN__sliding_local_dilated__moe_arch_mod__prompt_kernel,@function
sequential_preLN__sliding_local_dilated__moe_arch_mod__prompt_kernel:
    s_load_dwordx2 s[28:29], s[0:1], 0
    s_load_dwordx2 s[32:33], s[0:1], 8
    v_readfirstlane_b32 s48, v0
    s_load_dwordx2 s[24:25], s[0:1], 80
    s_load_dwordx2 s[36:37], s[0:1], 16
    s_load_dwordx2 s[40:41], s[0:1], 64
    s_load_dwordx8 s[12:19], s[0:1], 32
    s_lshr_b32 s56, s2, 3
    s_lshr_b32 s48, s48, 6
    s_cmp_ge_u32 s2, 240
    s_cbranch_scc1 F_pre
    s_mul_i32 s51, s56, 86
    s_lshr_b32 s51, s51, 8
    s_and_b32 s66, s2, 7
    s_sub_u32 s53, s66, s51
    s_mul_i32 s53, s53, 3
    s_add_u32 s53, s53, s56
    s_lshr_b32 s55, s53, 1
    s_and_b32 s50, s53, 1
    s_mul_i32 s55, s55, 86
    s_sub_u32 s55, s55, 10
    s_mov_b32 s30, 2621440
    s_mov_b32 s31, 0x00020000
    s_sub_u32 s60, s48, 4
    s_cbranch_scc1 C_pre
    s_lshl_b32 s62, s60, 2
    s_and_b32 s62, s62, 4
    v_bfe_u32 v1, v0, 3, 3
    v_bfe_u32 v2, v0, 4, 2
    v_bitop3_b32 v3, v0, 7, s62 bitop3:0x6a
    s_mul_i32 s62, s60, 24
    s_add_u32 s62, s62, s55
    s_lshl1_add_u32 s62, s62, s50
    s_mul_i32 s62, s62, 1280
    v_xor_b32 v4, v3, v2
    v_mul_u32_u24 v5, 2560, v1
    v_lshl_add_u32 v4, v4, 4, s62
    s_movk_i32 s63, 20480
    v_add_u32 v10, v4, v5
    v_bitop3_b32 v6, v1, 2, v3 bitop3:0x6a
    v_xad_u32 v11, v10, 64, s63
    v_add_u32 v12, 40960, v10
    s_mul_i32 s62, s60, 30720
    s_lshl_b32 s63, s51, 7
    s_add_u32 s62, s62, s63
    v_mul_u32_u24 v5, 3840, v1
    v_lshl_add_u32 v6, v6, 4, s62
    s_mov_b32 s71, s51
    v_add_u32 v13, v5, v6
    s_mul_i32 s65, s60, 3072
    v_add_u32 v14, 256, v13
    v_add_u32 v15, 512, v13
    s_mov_b32 s34, 2457600
    s_mov_b32 s35, 0x00020000
    s_mov_b32 s64, s65
    s_add_u32 s70, s65, 110592
    s_mov_b32 s63, 0
    s_waitcnt lgkmcnt(0)
    s_call_b64 s[98:99], LD_issue
    s_branch LD_cont
LD_issue:
    s_cmp_ge_u32 s66, s71
    s_addc_u32 s68, s66, 0
    s_mov_b32 m0, s65
    s_lshl_b32 s67, s68, 7
    buffer_load_dwordx4 v10, s[28:31], s67 offen lds
    s_add_u32 m0, s65, 1024
    s_mul_i32 s68, s68, 245760
    buffer_load_dwordx4 v11, s[28:31], s67 offen lds
    s_add_u32 m0, s65, 2048
    s_add_u32 s69, s68, 122880
    buffer_load_dwordx4 v12, s[28:31], s67 offen lds
    s_add_u32 m0, s65, 12288
    s_and_b32 s61, s63, 15
    s_lshr_b32 s63, s63, 4
    s_add_u32 s66, s66, s61
    buffer_load_dwordx4 v13, s[32:35], s68 offen offset:0 lds
    buffer_load_dwordx4 v14, s[32:35], s68 offen offset:1024 lds
    buffer_load_dwordx4 v15, s[32:35], s68 offen offset:2048 lds
    s_add_u32 m0, s65, 24576
    s_sub_u32 s61, s66, 9
    s_cselect_b32 s66, s66, s61
    buffer_load_dwordx4 v13, s[32:35], s69 offen offset:0 lds
    buffer_load_dwordx4 v14, s[32:35], s69 offen offset:1024 lds
    buffer_load_dwordx4 v15, s[32:35], s69 offen offset:2048 lds
    s_add_u32 s65, s65, 36864
    s_cmp_eq_u32 s65, s70
    s_cselect_b32 s65, s64, s65
    s_setpc_b64 s[98:99]
F_pre:
    s_cmp_ge_u32 s2, 256
    s_cbranch_scc1 L_end
    s_getpc_b64 s[58:59]
P_main:
    v_lshlrev_b32 v2, 7, v0
    v_cmp_gt_u32 vcc, L_last-P_main, v2
    s_nop 1
    v_cndmask_b32 v2, 0, v2, vcc
    global_load_dword v219, v2, s[58:59]
    s_branch F_start
C_pre:
    v_and_b32 v0, 63, v0
    s_mov_b32 s3, 0x40000
    s_mov_b32 s47, 0xffff0000
    s_mov_b32 s26, 7340032
    s_mov_b32 s27, 0x00020000
    s_mov_b32 s38, 819200
    s_mov_b32 s39, 0x00020000
    s_mov_b32 s42, 2621440
    s_mov_b32 s43, 0x00020000
    s_sub_u32 s52, s51, 5
    s_cselect_b32 s52, s51, s52
    v_and_b32 v1, 15, v0
    v_lshrrev_b32 v2, 4, v0
    s_mov_b32 s64, 0x21698350
    s_movk_i32 s65, 0x74
    s_lshl_b32 s62, s51, 2
    s_lshr_b64 s[64:65], s[64:65], s62
    s_and_b32 s64, s64, 15
    s_mul_i32 s60, s64, 12
    s_lshl_b32 s61, s48, 2
    s_add_u32 s60, s60, s61
    v_add_u32 v10, s60, v2
    v_add_u32 v11, s55, v10
    v_cmp_gt_i32 vcc, 0, v11
    v_lshl_add_u32 v11, v11, 1, s50
    v_mul_u32_u24 v11, 1280, v11
    v_lshl_add_u32 v11, v1, 4, v11
    v_cndmask_b32 v11, v11, 2.0, vcc
    s_mov_b32 s34, 1280
    s_mov_b32 s35, 0x00020000
    s_lshl_b32 s62, s53, 1
    s_add_u32 s62, s62, s64
    s_mul_i32 s62, s62, 4
    s_add_u32 s62, s62, s61
    s_sub_u32 s62, s62, 32
    s_cmp_lt_u32 s48, 1
    s_cselect_b32 s62, s62, 640
    s_mul_i32 s63, s64, 24
    s_add_u32 s63, s63, s53
    s_add_u32 s63, s63, 192
    s_cmp_lt_u32 s64, 8
    s_cselect_b32 s65, 3, 0
    s_cselect_b32 s62, s63, s62
    s_cselect_b32 s63, 192, 1
    v_lshlrev_b32 v58, 4, v0
    v_lshlrev_b32 v59, 2, v0
    s_waitcnt lgkmcnt(0)
    s_buffer_load_dword s54, s[24:27], 0
    s_mov_b64 s[32:33], s[12:13]
    s_cmp_lt_u32 s48, s65
    s_cbranch_scc0 A_nors
    buffer_load_dwordx4 v[20:23], v11, s[28:31], 0 offen offset:0
    buffer_load_dwordx4 v[24:27], v11, s[28:31], 0 offen offset:256
    buffer_load_dwordx4 v[28:31], v11, s[28:31], 0 offen offset:512
    buffer_load_dwordx4 v[32:35], v11, s[28:31], 0 offen offset:768
    buffer_load_dwordx4 v[36:39], v11, s[28:31], 0 offen offset:1024
    s_branch A_cons
A_nors:
    s_cmp_lg_u32 s48, 3
    s_cbranch_scc1 A_nowr
    buffer_load_dwordx4 v[48:51], v58, s[32:35], 0 offen
    buffer_load_dword v52, v59, s[32:35], 0 offen offset:1024
A_nowr:
    s_cmp_ge_u32 s62, 640
    s_cbranch_scc1 A_cons
    v_mul_u32_u24 v10, s63, v2
    v_add_u32 v10, s62, v10
    v_lshlrev_b32 v12, 4, v1
    v_mul_u32_u24 v11, 1280, v10
    v_add_u32 v11, v11, v12
    buffer_load_dwordx4 v[76:79], v12, s[32:35], 0 offen offset:0
    buffer_load_dwordx4 v[80:83], v12, s[32:35], 0 offen offset:256
    buffer_load_dwordx4 v[84:87], v12, s[32:35], 0 offen offset:512
    buffer_load_dwordx4 v[88:91], v12, s[32:35], 0 offen offset:768
    buffer_load_dwordx4 v[92:95], v12, s[32:35], 0 offen offset:1024
    buffer_load_dwordx4 v[20:23], v11, s[36:39], 0 offen offset:0
    buffer_load_dwordx4 v[24:27], v11, s[36:39], 0 offen offset:256
    buffer_load_dwordx4 v[28:31], v11, s[36:39], 0 offen offset:512
    buffer_load_dwordx4 v[32:35], v11, s[36:39], 0 offen offset:768
    buffer_load_dwordx4 v[36:39], v11, s[36:39], 0 offen offset:1024
A_cons:
    v_mov_b32 v99, 2.0
    v_lshrrev_b32 v3, 1, v1
    v_xor_b32 v3, v3, v2
    v_lshlrev_b32 v3, 4, v3
    v_lshl_add_u32 v4, v1, 7, v3
    v_xor_b32 v5, 64, v4
    v_cmp_eq_u32 vcc, 0, v1
    v_mov_b32 v3, 159744
    s_nop 0
    v_cndmask_b32 v6, v4, v3, vcc
    v_cndmask_b32 v7, v5, v3, vcc
    v_cndmask_b32 v8, 1, 0, vcc
    v_bfe_u32 v14, v0, 2, 2
    v_and_b32 v15, 3, v0
    v_lshrrev_b32 v16, 1, v14
    v_and_b32 v17, 1, v2
    v_lshl_or_b32 v16, v17, 1, v16
    v_xor_b32 v16, s48, v16
    v_lshlrev_b32 v16, 5, v16
    v_lshl_add_u32 v16, v15, 3, v16
    v_lshl_add_u32 v16, v14, 7, v16
    v_mul_u32_u24 v17, 3072, v2
    v_add_u32 v9, v16, v17
    v_mov_b32 v16, 0x3f803f80
    v_mov_b32 v17, v16
    v_mov_b32 v18, v16
    v_mov_b32 v19, v16
    ds_write_b128 v3, v[16:19]
    v_mov_b64 v[100:101], 0
    v_mov_b64 v[102:103], 0
    v_mov_b64 v[104:105], 0
    v_mov_b64 v[106:107], 0
    v_mov_b64 v[108:109], 0
    v_mov_b64 v[110:111], 0
    v_mov_b64 v[112:113], 0
    v_mov_b64 v[114:115], 0
    v_mov_b64 v[116:117], 0
    v_mov_b64 v[118:119], 0
    v_mov_b64 v[120:121], 0
    v_mov_b64 v[122:123], 0
    v_mov_b64 v[124:125], 0
    v_mov_b64 v[126:127], 0
    v_mov_b64 v[128:129], 0
    v_mov_b64 v[130:131], 0
    v_mov_b64 v[132:133], 0
    v_mov_b64 v[134:135], 0
    v_mov_b64 v[136:137], 0
    v_mov_b64 v[138:139], 0
    v_mov_b64 v[140:141], 0
    v_mov_b64 v[142:143], 0
    v_mov_b64 v[144:145], 0
    v_mov_b64 v[146:147], 0
    v_mov_b64 v[148:149], 0
    v_mov_b64 v[150:151], 0
    v_mov_b64 v[152:153], 0
    v_mov_b64 v[154:155], 0
    v_mov_b64 v[156:157], 0
    v_mov_b64 v[158:159], 0
    v_mov_b64 v[160:161], 0
    v_mov_b64 v[162:163], 0
    v_mov_b64 v[164:165], 0
    v_mov_b64 v[166:167], 0
    v_mov_b64 v[168:169], 0
    v_mov_b64 v[170:171], 0
    s_call_b64 s[98:99], S_late
    s_call_b64 s[98:99], S_late2
    s_call_b64 s[98:99], S_late3
    s_call_b64 s[98:99], S_late4
    s_branch A_c2
S_late:
    v_and_b32 v200, 15, v0
    v_lshrrev_b32 v201, 4, v0
    v_lshlrev_b32 v202, 4, v0
    v_lshlrev_b32 v203, 2, v0
    v_lshrrev_b32 v64, 5, v0
    v_and_b32 v65, 12, v200
    s_lshl_b32 s4, s52, 3
    s_sub_u32 s4, 96768, s4
    s_min_u32 s5, s48, 5
    s_lshl_b32 s6, s5, 4
    v_add_u32 v67, s6, v200
    v_mul_u32_u24 v68, 400, v67
    v_mad_u32_u24 v66, v201, 40, s4
    v_add_u32 v71, v68, v66
    v_subrev_u32 v205, 3072, v71
    v_mul_u32_u24 v72, 5, v201
    v_subrev_u32 v72, s52, v72
    v_mov_b32 v73, 159776
    v_add_u32 v74, 0, v72
    v_cmp_gt_u32 vcc, 16, v74
    v_add_u32 v74, 0, v71
    s_nop 0
    v_cndmask_b32 v204, v73, v74, vcc
    v_add_u32 v74, 1, v72
    v_cmp_gt_u32 vcc, 16, v74
    v_add_u32 v74, 8, v71
    s_nop 0
    v_cndmask_b32 v229, v73, v74, vcc
    v_add_u32 v74, 2, v72
    v_cmp_gt_u32 vcc, 16, v74
    v_add_u32 v74, 16, v71
    s_nop 0
    v_cndmask_b32 v230, v73, v74, vcc
    v_add_u32 v74, 3, v72
    v_cmp_gt_u32 vcc, 16, v74
    v_add_u32 v74, 24, v71
    s_nop 0
    v_cndmask_b32 v231, v73, v74, vcc
    v_add_u32 v74, 4, v72
    v_cmp_gt_u32 vcc, 16, v74
    v_add_u32 v74, 32, v71
    s_nop 0
    v_cndmask_b32 v255, v73, v74, vcc
    v_lshlrev_b32 v208, 3, v67
    v_add_u32 v208, 159808, v208
    v_add_u32 v69, s6, v65
    v_lshlrev_b32 v209, 3, v69
    v_add_u32 v209, 159748, v209
    v_and_b32 v70, 3, v0
    v_cmp_gt_u32 vcc, 1, v70
    v_mov_b32 v73, s47
    s_nop 0
    v_cndmask_b32 v207, 0, v73, vcc
    v_cmp_gt_u32 vcc, 3, v70
    s_nop 1
    v_cndmask_b32 v211, 0, v73, vcc
    v_cmp_gt_u32 vcc, 2, v70
    s_nop 1
    v_cndmask_b32 v211, v211, -1, vcc
    s_setpc_b64 s[98:99]
S_late2:
    s_lshl_b32 s7, s5, 12
    s_add_u32 s7, s7, 135184
    v_lshl_add_u32 v66, v0, 6, s7
    v_lshl_add_u32 v210, v65, 1, v66
    s_add_u32 s13, s6, s55
    v_add_u32 v212, s13, v65
    s_mul_i32 s8, s53, 6
    s_mul_i32 s9, s8, 24320
    s_add_u32 s9, s9, 1310720
    s_mul_i32 s0, s48, 24320
    s_add_u32 s0, s0, s9
    v_lshlrev_b32 v206, 4, v200
    v_lshl_add_u32 v206, v64, 8, v206
    v_xor_b32 v213, 256, v206
    v_lshl_add_u32 v213, v64, 12, v213
    s_cmp_lg_u32 s52, 0
    s_cselect_b32 s20, 0x0000ffff, 0
    s_cmp_lg_u32 s52, 4
    s_cselect_b32 s21, s47, 0
    s_cmp_eq_u32 s48, 0
    s_cselect_b32 s7, 0xff00ff00, -1
    s_and_b32 s20, s20, s7
    s_and_b32 s21, s21, s7
    s_lshl_b32 s7, s51, 11
    s_add_u32 s22, s0, s7
    s_sub_u32 s12, s22, 2048
    s_add_u32 s100, s9, 23040
    s_lshr_b32 s7, s51, 1
    s_mul_i32 s7, s7, 23552
    s_mul_i32 s57, s51, 384
    s_add_u32 s7, s7, s57
    s_add_u32 s7, s7, 23552
    s_add_u32 s57, s7, s9
    s_mul_i32 s7, s48, 10
    s_add_u32 s7, s7, s51
    s_lshl_b32 s7, s7, 2
    s_add_u32 s23, s100, s7
    s_sub_u32 s56, s48, 2
    s_cmp_lt_u32 s48, 6
    s_cselect_b32 s101, 0, 1
    s_cselect_b32 s56, s48, s56
    s_mul_i32 s1, s56, 24320
    s_add_u32 s1, s1, s9
    s_add_u32 s8, s8, s56
    s_mul_i32 s44, s53, 2560
    s_lshl_b32 s7, s51, 8
    s_add_u32 s44, s44, s7
    s_add_u32 s44, s44, 262144
    s_lshl_b32 s45, s53, 6
    s_add_u32 s45, s45, 196608
    s_setpc_b64 s[98:99]
S_late3:
    v_bfe_u32 v68, v0, 2, 2
    v_and_b32 v69, 3, v0
    v_lshl_add_u32 v70, v201, 3, v68
    s_lshl_b32 s7, s48, 4
    s_sub_u32 s7, s7, 16
    v_add_u32 v71, s7, v70
    v_and_b32 v72, 15, v71
    v_max_i32 v71, v71, v72
    v_mul_u32_u24 v71, 400, v71
    v_lshl_add_u32 v71, v69, 3, v71
    v_add_u32 v214, 97024, v71
    v_and_b32 v72, 1, v201
    s_cmp_eq_u32 s48, 0
    s_cselect_b32 s7, 8, 0
    v_cmp_gt_u32 vcc, s7, v200
    s_nop 1
    v_cndmask_b32 v249, v202, 2.0, vcc
    v_lshrrev_b32 v71, 1, v68
    v_lshl_or_b32 v71, v72, 1, v71
    v_lshl_add_u32 v70, v201, 2, v68
    v_lshlrev_b32 v70, 7, v70
    v_lshl_add_u32 v70, v69, 3, v70
    s_mul_i32 s7, s101, 40960
    s_add_u32 s7, s7, 12288
    v_add_u32 v70, s7, v70
    s_mul_i32 s7, s101, 36864
    s_sub_u32 s7, 40960, s7
    v_xor_b32 v73, 0, v71
    v_lshl_add_u32 v216, v73, 5, v70
    v_add_u32 v220, s7, v216
    v_xor_b32 v73, 1, v71
    v_lshl_add_u32 v217, v73, 5, v70
    v_add_u32 v221, s7, v217
    v_xor_b32 v73, 2, v71
    v_lshl_add_u32 v218, v73, 5, v70
    v_add_u32 v222, s7, v218
    v_xor_b32 v73, 3, v71
    v_lshl_add_u32 v219, v73, 5, v70
    v_add_u32 v223, s7, v219
    s_setpc_b64 s[98:99]
S_late4:
    s_lshl_b32 s7, s56, 4
    v_add_u32 v73, s7, v200
    v_cmp_gt_u32 vcc, 10, v73
    v_add_u32 v73, s55, v73
    v_lshl_add_u32 v73, v73, 1, s50
    v_mul_u32_u24 v74, 1280, v73
    s_lshl_b32 s7, s51, 7
    v_lshl_add_u32 v75, v201, 3, s7
    v_add_u32 v74, v74, v75
    v_cndmask_b32 v253, v74, 2.0, vcc
    v_cndmask_b32 v254, v73, -1, vcc
    v_add_u32 v227, 161792, v75
    v_mul_u32_u24 v224, 61440, v201
    v_lshl_add_u32 v224, v200, 4, v224
    s_mov_b32 s7, 161024
    v_lshl_add_u32 v228, v201, 5, s7
    v_lshl_add_u32 v252, v69, 5, s7
    v_lshl_add_u32 v252, v68, 3, v252
    v_mul_u32_u24 v225, 24, v72
    v_add_u32 v225, v225, v253
    v_lshl_add_u32 v226, s8, 4, v200
    s_cmp_eq_u32 s101, 1
    s_cselect_b64 vcc, -1, 0
    v_lshrrev_b32 v73, 1, v200
    v_lshrrev_b32 v74, 1, v201
    v_xor_b32 v73, v73, v74
    v_lshlrev_b32 v73, 4, v73
    v_lshl_add_u32 v73, v72, 3, v73
    v_lshl_add_u32 v73, v200, 7, v73
    v_lshl_add_u32 v250, s56, 11, v73
    v_mov_b32 v251, 160784
    s_add_u32 s7, s52, 5
    s_cmp_lt_u32 s51, 5
    s_cselect_b32 s7, s7, s52
    s_lshl_b32 s7, s7, 11
    s_add_u32 s16, s7, s1
    s_lshl_b32 s7, s51, 11
    s_add_u32 s14, s7, s1
    s_add_u32 s15, s1, 20480
    s_cmp_eq_u32 s101, 1
    s_cselect_b32 s14, s16, s14
    s_cselect_b32 s18, 0x3e0, 62
    s_lshl_b32 s7, s101, 10
    s_add_u32 s16, s16, s7
    s_cmp_lt_u32 s48, 4
    s_cselect_b32 s18, 0x3fe, s18
    s_lshl_b32 s18, s18, s51
    s_lshr_b32 s7, s18, 10
    s_or_b32 s18, s18, s7
    s_and_b32 s18, s18, 0x3ff
    s_mov_b32 s19, 0
    s_mul_i32 s17, s56, 40
    s_add_u32 s17, s17, s100
    s_lshl_b32 s7, s48, 12
    s_add_u32 s7, s7, 135168
    v_lshl_add_u32 v73, v200, 6, s7
    v_lshl_add_u32 v73, v201, 4, v73
    v_add_u32 v74, s52, v201
    s_add_u32 s69, s52, 0
    s_mul_i32 s69, s69, 52
    s_lshr_b32 s69, s69, 8
    v_lshl_add_u32 v172, s69, 10, v73
    s_add_u32 s69, s52, 3
    s_mul_i32 s69, s69, 52
    s_lshr_b32 s69, s69, 8
    v_lshl_add_u32 v173, s69, 10, v73
    s_mul_i32 s69, s69, 5
    s_sub_u32 s69, s69, 0
    v_cmp_le_i32 s[4:5], s69, v74
    s_add_u32 s69, s52, 4
    s_mul_i32 s69, s69, 52
    s_lshr_b32 s69, s69, 8
    v_lshl_add_u32 v174, s69, 10, v73
    s_add_u32 s69, s52, 7
    s_mul_i32 s69, s69, 52
    s_lshr_b32 s69, s69, 8
    v_lshl_add_u32 v175, s69, 10, v73
    s_mul_i32 s69, s69, 5
    s_sub_u32 s69, s69, 4
    v_cmp_le_i32 s[6:7], s69, v74
    s_add_u32 s69, s52, 8
    s_mul_i32 s69, s69, 52
    s_lshr_b32 s69, s69, 8
    v_lshl_add_u32 v176, s69, 10, v73
    s_add_u32 s69, s52, 11
    s_mul_i32 s69, s69, 52
    s_lshr_b32 s69, s69, 8
    v_lshl_add_u32 v177, s69, 10, v73
    s_mul_i32 s69, s69, 5
    s_sub_u32 s69, s69, 8
    v_cmp_le_i32 s[8:9], s69, v74
    s_add_u32 s69, s52, 12
    s_mul_i32 s69, s69, 52
    s_lshr_b32 s69, s69, 8
    v_lshl_add_u32 v178, s69, 10, v73
    s_add_u32 s69, s52, 15
    s_mul_i32 s69, s69, 52
    s_lshr_b32 s69, s69, 8
    v_lshl_add_u32 v179, s69, 10, v73
    s_mul_i32 s69, s69, 5
    s_sub_u32 s69, s69, 12
    v_cmp_le_i32 s[10:11], s69, v74
    s_setpc_b64 s[98:99]
A_c2:
    s_waitcnt lgkmcnt(0)
    s_add_u32 s54, s54, 2654435761
    s_lshl_b32 s63, s53, 11
    s_add_u32 s63, s63, 81920
    v_mov_b32 v42, s54
    v_lshlrev_b32 v10, 4, v10
    s_cmp_lt_u32 s48, s65
    s_cbranch_scc0 A_nos
    s_waitcnt vmcnt(4)
    v_dot2_f32_bf16 v40, v20, v16, 0
    v_dot2_f32_bf16 v41, v20, v20, 0
    v_dot2_f32_bf16 v44, v21, v16, 0
    v_dot2_f32_bf16 v45, v21, v21, 0
    v_dot2_f32_bf16 v40, v22, v16, v40
    v_dot2_f32_bf16 v41, v22, v22, v41
    v_dot2_f32_bf16 v44, v23, v16, v44
    v_dot2_f32_bf16 v45, v23, v23, v45
    s_waitcnt vmcnt(3)
    v_dot2_f32_bf16 v40, v24, v16, v40
    v_dot2_f32_bf16 v41, v24, v24, v41
    v_dot2_f32_bf16 v44, v25, v16, v44
    v_dot2_f32_bf16 v45, v25, v25, v45
    v_dot2_f32_bf16 v40, v26, v16, v40
    v_dot2_f32_bf16 v41, v26, v26, v41
    v_dot2_f32_bf16 v44, v27, v16, v44
    v_dot2_f32_bf16 v45, v27, v27, v45
    s_waitcnt vmcnt(2)
    v_dot2_f32_bf16 v40, v28, v16, v40
    v_dot2_f32_bf16 v41, v28, v28, v41
    v_dot2_f32_bf16 v44, v29, v16, v44
    v_dot2_f32_bf16 v45, v29, v29, v45
    v_dot2_f32_bf16 v40, v30, v16, v40
    v_dot2_f32_bf16 v41, v30, v30, v41
    v_dot2_f32_bf16 v44, v31, v16, v44
    v_dot2_f32_bf16 v45, v31, v31, v45
    s_waitcnt vmcnt(1)
    v_dot2_f32_bf16 v40, v32, v16, v40
    v_dot2_f32_bf16 v41, v32, v32, v41
    v_dot2_f32_bf16 v44, v33, v16, v44
    v_dot2_f32_bf16 v45, v33, v33, v45
    v_dot2_f32_bf16 v40, v34, v16, v40
    v_dot2_f32_bf16 v41, v34, v34, v41
    v_dot2_f32_bf16 v44, v35, v16, v44
    v_dot2_f32_bf16 v45, v35, v35, v45
    s_waitcnt vmcnt(0)
    v_dot2_f32_bf16 v40, v36, v16, v40
    v_dot2_f32_bf16 v41, v36, v36, v41
    v_dot2_f32_bf16 v44, v37, v16, v44
    v_dot2_f32_bf16 v45, v37, v37, v45
    v_dot2_f32_bf16 v40, v38, v16, v40
    v_dot2_f32_bf16 v41, v38, v38, v41
    v_dot2_f32_bf16 v44, v39, v16, v44
    v_dot2_f32_bf16 v45, v39, v39, v45
A_red:
    s_nop 1
    v_add_f32 v40, v40, v44
    v_add_f32 v41, v41, v45
    s_nop 0
    v_add_f32_dpp v40, v40, v40 row_ror:1 row_mask:0xf bank_mask:0xf
    v_add_f32_dpp v41, v41, v41 row_ror:1 row_mask:0xf bank_mask:0xf
    s_nop 0
    v_add_f32_dpp v40, v40, v40 row_ror:2 row_mask:0xf bank_mask:0xf
    v_add_f32_dpp v41, v41, v41 row_ror:2 row_mask:0xf bank_mask:0xf
    s_nop 0
    v_add_f32_dpp v40, v40, v40 row_ror:4 row_mask:0xf bank_mask:0xf
    v_add_f32_dpp v41, v41, v41 row_ror:4 row_mask:0xf bank_mask:0xf
    s_nop 0
    v_add_f32_dpp v40, v40, v40 row_ror:8 row_mask:0xf bank_mask:0xf
    v_add_f32_dpp v41, v41, v41 row_ror:8 row_mask:0xf bank_mask:0xf
    s_cselect_b32 s64, s63, 1245184
    s_cbranch_scc0 A_nln
    v_mul_f32 v40, 0x3acccccd, v40
    v_mul_f32 v41, 0x3acccccd, v41
    v_fma_f32 v41, -v40, v40, v41
    v_max_f32 v41, 0, v41
    v_cvt_pk_bf16_f32 v41, v41, v41
    v_and_b32 v41, 0xffff0000, v41
    v_add_f32 v41, 0x3727c5ac, v41
    v_cvt_pk_bf16_f32 v41, v41, v41
    v_and_b32 v41, 0xffff0000, v41
    v_sqrt_f32 v41, v41
    v_cvt_pk_bf16_f32 v40, v40, v40
    v_and_b32 v40, 0xffff0000, v40
    v_cvt_pk_bf16_f32 v41, v41, v41
    v_and_b32 v41, 0xffff0000, v41
    v_rcp_f32 v41, v41
A_nln:
    s_mov_b32 exec_lo, 0x00010001
    s_mov_b32 exec_hi, 0x00010001
    buffer_store_dwordx3 v[40:42], v10, s[24:27], s64 offen sc1
    s_mov_b64 exec, -1
A_w3:
    s_cmp_lg_u32 s48, 3
    s_cbranch_scc1 A_go
    s_getreg_b32 s61, hwreg(HW_REG_XCC_ID)
    s_lshl_b32 s64, s51, 4
    s_add_u32 s64, s64, 1536
    v_mov_b32 v44, s61
    v_mov_b32 v43, s64
    v_mov_b32 v46, s54
    s_mov_b64 exec, 1
    buffer_store_dwordx3 v[44:46], v43, s[24:27], s63 offen sc1
    s_mov_b64 exec, -1
    v_add_u32 v58, 161792, v58
    v_add_u32 v59, 161792, v59
    s_cmp_lt_u32 s62, 640
    s_cbranch_scc1 A_w3l
    s_waitcnt vmcnt(1)
A_w3l:
    ds_write_b128 v58, v[48:51]
    ds_write_b32 v59, v52 offset:1024
    v_dot2_f32_bf16 v25, v48, v16, 0
    v_dot2_f32_bf16 v25, v49, v16, v25
    v_dot2_f32_bf16 v25, v50, v16, v25
    v_dot2_f32_bf16 v25, v51, v16, v25
    v_dot2_f32_bf16 v25, v52, v16, v25
    s_nop 2
    v_add_f32_dpp v25, v25, v25 row_ror:1 row_mask:0xf bank_mask:0xf
    s_nop 1
    v_add_f32_dpp v25, v25, v25 row_ror:2 row_mask:0xf bank_mask:0xf
    s_nop 1
    v_add_f32_dpp v25, v25, v25 row_ror:4 row_mask:0xf bank_mask:0xf
    s_nop 1
    v_add_f32_dpp v25, v25, v25 row_ror:8 row_mask:0xf bank_mask:0xf
    v_mov_b32 v26, v25
    s_nop 1
    v_permlane32_swap_b32 v25, v26
    v_add_f32 v25, v25, v26
    v_mov_b32 v26, v25
    s_nop 1
    v_permlane16_swap_b32 v25, v26
    v_add_f32 v25, v25, v26
    v_mov_b32 v58, 161792
    ds_write_b32 v58, v25 offset:1280
    s_waitcnt lgkmcnt(0)
    s_branch A_go
A_nos:
    s_cmp_ge_u32 s62, 640
    s_cbranch_scc1 A_w3
    s_waitcnt vmcnt(4)
    v_dot2_f32_bf16 v40, v20, v16, 0
    v_dot2_f32_bf16 v41, v20, v76, 0
    v_dot2_f32_bf16 v44, v21, v16, 0
    v_dot2_f32_bf16 v45, v21, v77, 0
    v_dot2_f32_bf16 v40, v22, v16, v40
    v_dot2_f32_bf16 v41, v22, v78, v41
    v_dot2_f32_bf16 v44, v23, v16, v44
    v_dot2_f32_bf16 v45, v23, v79, v45
    s_waitcnt vmcnt(3)
    v_dot2_f32_bf16 v40, v24, v16, v40
    v_dot2_f32_bf16 v41, v24, v80, v41
    v_dot2_f32_bf16 v44, v25, v16, v44
    v_dot2_f32_bf16 v45, v25, v81, v45
    v_dot2_f32_bf16 v40, v26, v16, v40
    v_dot2_f32_bf16 v41, v26, v82, v41
    v_dot2_f32_bf16 v44, v27, v16, v44
    v_dot2_f32_bf16 v45, v27, v83, v45
    s_waitcnt vmcnt(2)
    v_dot2_f32_bf16 v40, v28, v16, v40
    v_dot2_f32_bf16 v41, v28, v84, v41
    v_dot2_f32_bf16 v44, v29, v16, v44
    v_dot2_f32_bf16 v45, v29, v85, v45
    v_dot2_f32_bf16 v40, v30, v16, v40
    v_dot2_f32_bf16 v41, v30, v86, v41
    v_dot2_f32_bf16 v44, v31, v16, v44
    v_dot2_f32_bf16 v45, v31, v87, v45
    s_waitcnt vmcnt(1)
    v_dot2_f32_bf16 v40, v32, v16, v40
    v_dot2_f32_bf16 v41, v32, v88, v41
    v_dot2_f32_bf16 v44, v33, v16, v44
    v_dot2_f32_bf16 v45, v33, v89, v45
    v_dot2_f32_bf16 v40, v34, v16, v40
    v_dot2_f32_bf16 v41, v34, v90, v41
    v_dot2_f32_bf16 v44, v35, v16, v44
    v_dot2_f32_bf16 v45, v35, v91, v45
    s_waitcnt vmcnt(0)
    v_dot2_f32_bf16 v40, v36, v16, v40
    v_dot2_f32_bf16 v41, v36, v92, v41
    v_dot2_f32_bf16 v44, v37, v16, v44
    v_dot2_f32_bf16 v45, v37, v93, v45
    v_dot2_f32_bf16 v40, v38, v16, v40
    v_dot2_f32_bf16 v41, v38, v94, v41
    v_dot2_f32_bf16 v44, v39, v16, v44
    v_dot2_f32_bf16 v45, v39, v95, v45
    s_branch A_red
A_go:
    v_lshlrev_b32 v18, 3, v1
    v_add_u32 v18, 159808, v18
    v_mul_u32_u24 v3, 400, v1
    v_lshl_add_u32 v3, v2, 3, v3
    s_lshl_b32 s60, s48, 5
    s_add_u32 s60, s60, 96768
    v_add_u32 v3, s60, v3
    v_mov_b32 v17, 160768
    s_mov_b32 s60, 0
    v_add_u32 v14, s60, v9
    v_mad_u32_u24 v10, v8, s60, v6
    v_add_u32 v12, s60, v4
    v_mad_u32_u24 v11, v8, s60, v7
    v_add_u32 v13, s60, v5
    s_mov_b32 s61, 0
    s_barrier
    ds_read_b64_tr_b16 v[44:45], v14 offset:12288
    ds_read_b64_tr_b16 v[46:47], v14 offset:12800
    ds_read_b64_tr_b16 v[48:49], v14 offset:13312
    ds_read_b64_tr_b16 v[50:51], v14 offset:13824
    ds_read_b64_tr_b16 v[52:53], v14 offset:14336
    ds_read_b64_tr_b16 v[54:55], v14 offset:14848
    ds_read_b128 v[20:23], v10
    ds_read_b128 v[24:27], v12 offset:2048
    ds_read_b128 v[28:31], v12 offset:4096
    ds_read_b128 v[32:35], v12 offset:6144
    ds_read_b128 v[36:39], v12 offset:8192
    ds_read_b128 v[40:43], v12 offset:10240
A_loop:
    s_waitcnt lgkmcnt(0)
    v_mfma_f32_16x16x32_bf16 v[100:103], v[44:47], v[20:23], v[100:103]
    ds_read_b64_tr_b16 v[80:81], v14 offset:24576
    v_mfma_f32_16x16x32_bf16 v[104:107], v[48:51], v[20:23], v[104:107]
    ds_read_b64_tr_b16 v[82:83], v14 offset:25088
    v_mfma_f32_16x16x32_bf16 v[108:111], v[52:55], v[20:23], v[108:111]
    ds_read_b64_tr_b16 v[84:85], v14 offset:25600
    v_mfma_f32_16x16x32_bf16 v[120:123], v[52:55], v[24:27], v[120:123]
    ds_read_b64_tr_b16 v[86:87], v14 offset:26112
    v_mfma_f32_16x16x32_bf16 v[116:119], v[48:51], v[24:27], v[116:119]
    ds_read_b64_tr_b16 v[88:89], v14 offset:26624
    v_mfma_f32_16x16x32_bf16 v[112:115], v[44:47], v[24:27], v[112:115]
    ds_read_b64_tr_b16 v[90:91], v14 offset:27136
    v_mfma_f32_16x16x32_bf16 v[124:127], v[44:47], v[28:31], v[124:127]
    ds_read_b128 v[56:59], v11
    v_mfma_f32_16x16x32_bf16 v[128:131], v[48:51], v[28:31], v[128:131]
    ds_read_b128 v[60:63], v13 offset:2048
    v_mfma_f32_16x16x32_bf16 v[132:135], v[52:55], v[28:31], v[132:135]
    ds_read_b128 v[64:67], v13 offset:4096
    v_mfma_f32_16x16x32_bf16 v[144:147], v[52:55], v[32:35], v[144:147]
    ds_read_b128 v[68:71], v13 offset:6144
    v_mfma_f32_16x16x32_bf16 v[140:143], v[48:51], v[32:35], v[140:143]
    ds_read_b128 v[72:75], v13 offset:8192
    v_mfma_f32_16x16x32_bf16 v[136:139], v[44:47], v[32:35], v[136:139]
    ds_read_b128 v[76:79], v13 offset:10240
    v_mfma_f32_16x16x32_bf16 v[148:151], v[44:47], v[36:39], v[148:151]
    s_add_u32 s60, s60, 36864
    v_mfma_f32_16x16x32_bf16 v[152:155], v[48:51], v[36:39], v[152:155]
    s_add_u32 s61, s61, 1
    v_mfma_f32_16x16x32_bf16 v[156:159], v[52:55], v[36:39], v[156:159]
    s_cmp_eq_u32 s60, 110592
    v_mfma_f32_16x16x32_bf16 v[168:171], v[52:55], v[40:43], v[168:171]
    s_cselect_b32 s60, 0, s60
    v_mfma_f32_16x16x32_bf16 v[164:167], v[48:51], v[40:43], v[164:167]
    s_cmp_lt_u32 s61, 9
    v_mfma_f32_16x16x32_bf16 v[160:163], v[44:47], v[40:43], v[160:163]
    s_waitcnt lgkmcnt(0)
    v_mfma_f32_16x16x32_bf16 v[100:103], v[80:83], v[56:59], v[100:103]
    v_add_u32 v14, s60, v9
    v_mfma_f32_16x16x32_bf16 v[104:107], v[84:87], v[56:59], v[104:107]
    v_mad_u32_u24 v10, v8, s60, v6
    v_mfma_f32_16x16x32_bf16 v[108:111], v[88:91], v[56:59], v[108:111]
    v_add_u32 v12, s60, v4
    v_mfma_f32_16x16x32_bf16 v[120:123], v[88:91], v[60:63], v[120:123]
    v_mad_u32_u24 v11, v8, s60, v7
    v_mfma_f32_16x16x32_bf16 v[116:119], v[84:87], v[60:63], v[116:119]
    v_add_u32 v13, s60, v5
    v_mfma_f32_16x16x32_bf16 v[112:115], v[80:83], v[60:63], v[112:115]
    s_barrier
    v_mfma_f32_16x16x32_bf16 v[124:127], v[80:83], v[64:67], v[124:127]
    ds_read_b64_tr_b16 v[44:45], v14 offset:12288
    ds_read_b64_tr_b16 v[46:47], v14 offset:12800
    v_mfma_f32_16x16x32_bf16 v[128:131], v[84:87], v[64:67], v[128:131]
    ds_read_b64_tr_b16 v[48:49], v14 offset:13312
    ds_read_b64_tr_b16 v[50:51], v14 offset:13824
    v_mfma_f32_16x16x32_bf16 v[132:135], v[88:91], v[64:67], v[132:135]
    ds_read_b64_tr_b16 v[52:53], v14 offset:14336
    ds_read_b64_tr_b16 v[54:55], v14 offset:14848
    v_mfma_f32_16x16x32_bf16 v[144:147], v[88:91], v[68:71], v[144:147]
    ds_read_b128 v[20:23], v10
    ds_read_b128 v[24:27], v12 offset:2048
    v_mfma_f32_16x16x32_bf16 v[140:143], v[84:87], v[68:71], v[140:143]
    ds_read_b128 v[28:31], v12 offset:4096
    ds_read_b128 v[32:35], v12 offset:6144
    v_mfma_f32_16x16x32_bf16 v[136:139], v[80:83], v[68:71], v[136:139]
    ds_read_b128 v[36:39], v12 offset:8192
    ds_read_b128 v[40:43], v12 offset:10240
    v_mfma_f32_16x16x32_bf16 v[148:151], v[80:83], v[72:75], v[148:151]
    v_mfma_f32_16x16x32_bf16 v[152:155], v[84:87], v[72:75], v[152:155]
    v_mfma_f32_16x16x32_bf16 v[156:159], v[88:91], v[72:75], v[156:159]
    v_mfma_f32_16x16x32_bf16 v[168:171], v[88:91], v[76:79], v[168:171]
    v_mfma_f32_16x16x32_bf16 v[164:167], v[84:87], v[76:79], v[164:167]
    v_mfma_f32_16x16x32_bf16 v[160:163], v[80:83], v[76:79], v[160:163]
    s_cbranch_scc1 A_loop
A_tail:
    s_waitcnt lgkmcnt(0)
    v_mfma_f32_16x16x32_bf16 v[108:111], v[52:55], v[20:23], v[108:111]
    ds_read_b64_tr_b16 v[80:81], v14 offset:24576
    ds_read_b64_tr_b16 v[82:83], v14 offset:25088
    v_mfma_f32_16x16x32_bf16 v[120:123], v[52:55], v[24:27], v[120:123]
    ds_read_b64_tr_b16 v[84:85], v14 offset:25600
    ds_read_b64_tr_b16 v[86:87], v14 offset:26112
    v_mfma_f32_16x16x32_bf16 v[132:135], v[52:55], v[28:31], v[132:135]
    ds_read_b128 v[56:59], v11
    ds_read_b128 v[60:63], v13 offset:2048
    v_mfma_f32_16x16x32_bf16 v[144:147], v[52:55], v[32:35], v[144:147]
    ds_read_b64 v[184:185], v18 offset:0
    ds_read_b64 v[186:187], v18 offset:128
    v_mfma_f32_16x16x32_bf16 v[156:159], v[52:55], v[36:39], v[156:159]
    ds_read_b128 v[64:67], v13 offset:4096
    ds_read_b128 v[68:71], v13 offset:6144
    v_mfma_f32_16x16x32_bf16 v[168:171], v[52:55], v[40:43], v[168:171]
    ds_read_b128 v[72:75], v13 offset:8192
    ds_read_b128 v[76:79], v13 offset:10240
    v_mfma_f32_16x16x32_bf16 v[100:103], v[44:47], v[20:23], v[100:103]
    ds_read_b64_tr_b16 v[88:89], v14 offset:26624
    ds_read_b64_tr_b16 v[90:91], v14 offset:27136
    v_mfma_f32_16x16x32_bf16 v[104:107], v[48:51], v[20:23], v[104:107]
    ds_read_b64 v[188:189], v18 offset:256
    ds_read_b64 v[190:191], v18 offset:384
    v_mfma_f32_16x16x32_bf16 v[112:115], v[44:47], v[24:27], v[112:115]
    ds_read_b64 v[192:193], v18 offset:512
    ds_read_b64 v[194:195], v18 offset:640
    v_mfma_f32_16x16x32_bf16 v[116:119], v[48:51], v[24:27], v[116:119]
    ds_read_b32 v17, v17
    s_waitcnt lgkmcnt(11)
    v_mfma_f32_16x16x32_bf16 v[100:103], v[80:83], v[56:59], v[100:103]
    ds_read_b32 v16, v208 offset:4
    ds_read2_b32 v[4:5], v209 offset0:0 offset1:2
    v_mfma_f32_16x16x32_bf16 v[104:107], v[84:87], v[56:59], v[104:107]
    ds_read2_b32 v[6:7], v209 offset0:4 offset1:6
    ds_read2_b32 v[8:9], v209 offset0:8 offset1:10
    v_mfma_f32_16x16x32_bf16 v[112:115], v[80:83], v[60:63], v[112:115]
    ds_read2_b32 v[10:11], v209 offset0:12 offset1:14
    ds_read2_b32 v[12:13], v209 offset0:16 offset1:18
    v_mfma_f32_16x16x32_bf16 v[116:119], v[84:87], v[60:63], v[116:119]
    ds_read2_b32 v[14:15], v209 offset0:20 offset1:22
    s_waitcnt lgkmcnt(7)
    v_mfma_f32_16x16x32_bf16 v[124:127], v[44:47], v[28:31], v[124:127]
    v_mov_b32_dpp v20, v100 row_newbcast:0 row_mask:0xf bank_mask:0xf
    v_mov_b32_dpp v21, v101 row_newbcast:0 row_mask:0xf bank_mask:0xf
    v_mov_b32_dpp v22, v102 row_newbcast:0 row_mask:0xf bank_mask:0xf
    v_mfma_f32_16x16x32_bf16 v[128:131], v[48:51], v[28:31], v[128:131]
    v_mov_b32_dpp v23, v103 row_newbcast:0 row_mask:0xf bank_mask:0xf
    v_mov_b32_dpp v24, v104 row_newbcast:0 row_mask:0xf bank_mask:0xf
    v_mov_b32_dpp v25, v105 row_newbcast:0 row_mask:0xf bank_mask:0xf
    v_mfma_f32_16x16x32_bf16 v[124:127], v[80:83], v[64:67], v[124:127]
    v_mov_b32_dpp v26, v106 row_newbcast:0 row_mask:0xf bank_mask:0xf
    v_mov_b32_dpp v27, v107 row_newbcast:0 row_mask:0xf bank_mask:0xf
    v_pk_fma_f32 v[100:101], v[184:185], v[20:21], v[100:101] op_sel_hi:[0,1,1] neg_lo:[1,0,0] neg_hi:[1,0,0]
    v_mfma_f32_16x16x32_bf16 v[128:131], v[84:87], v[64:67], v[128:131]
    v_pk_fma_f32 v[102:103], v[184:185], v[22:23], v[102:103] op_sel_hi:[0,1,1] neg_lo:[1,0,0] neg_hi:[1,0,0]
    v_pk_fma_f32 v[104:105], v[184:185], v[24:25], v[104:105] op_sel_hi:[0,1,1] neg_lo:[1,0,0] neg_hi:[1,0,0]
    v_pk_fma_f32 v[106:107], v[184:185], v[26:27], v[106:107] op_sel_hi:[0,1,1] neg_lo:[1,0,0] neg_hi:[1,0,0]
    v_mfma_f32_16x16x32_bf16 v[136:139], v[44:47], v[32:35], v[136:139]
    v_cvt_pk_bf16_f32 v100, v100, v101
    v_cvt_pk_bf16_f32 v101, v102, v103
    ds_write_b64 v3, v[100:101] offset:0
    v_mfma_f32_16x16x32_bf16 v[140:143], v[48:51], v[32:35], v[140:143]
    v_cvt_pk_bf16_f32 v104, v104, v105
    v_cvt_pk_bf16_f32 v105, v106, v107
    ds_write_b64 v3, v[104:105] offset:128
    v_mfma_f32_16x16x32_bf16 v[136:139], v[80:83], v[68:71], v[136:139]
    v_pk_fma_f32 v[112:113], v[186:187], v[20:21], v[112:113] op_sel_hi:[0,1,1] neg_lo:[1,0,0] neg_hi:[1,0,0]
    v_pk_fma_f32 v[114:115], v[186:187], v[22:23], v[114:115] op_sel_hi:[0,1,1] neg_lo:[1,0,0] neg_hi:[1,0,0]
    v_pk_fma_f32 v[116:117], v[186:187], v[24:25], v[116:117] op_sel_hi:[0,1,1] neg_lo:[1,0,0] neg_hi:[1,0,0]
    v_mfma_f32_16x16x32_bf16 v[140:143], v[84:87], v[68:71], v[140:143]
    v_pk_fma_f32 v[118:119], v[186:187], v[26:27], v[118:119] op_sel_hi:[0,1,1] neg_lo:[1,0,0] neg_hi:[1,0,0]
    v_cvt_pk_bf16_f32 v112, v112, v113
    v_cvt_pk_bf16_f32 v113, v114, v115
    v_mfma_f32_16x16x32_bf16 v[148:151], v[44:47], v[36:39], v[148:151]
    ds_write_b64 v3, v[112:113] offset:6400
    v_cvt_pk_bf16_f32 v116, v116, v117
    v_cvt_pk_bf16_f32 v117, v118, v119
    v_mfma_f32_16x16x32_bf16 v[152:155], v[48:51], v[36:39], v[152:155]
    ds_write_b64 v3, v[116:117] offset:6528
    v_readfirstlane_b32 s49, v17
    s_mov_b32 s60, 0x07060503
    v_mfma_f32_16x16x32_bf16 v[148:151], v[80:83], v[72:75], v[148:151]
    s_mov_b32 s61, 0x07060502
    s_mov_b32 s62, 0x07060501
    s_mov_b32 s63, 0x04000c0c
    v_mfma_f32_16x16x32_bf16 v[152:155], v[84:87], v[72:75], v[152:155]
    v_pk_fma_f32 v[124:125], v[188:189], v[20:21], v[124:125] op_sel_hi:[0,1,1] neg_lo:[1,0,0] neg_hi:[1,0,0]
    v_pk_fma_f32 v[126:127], v[188:189], v[22:23], v[126:127] op_sel_hi:[0,1,1] neg_lo:[1,0,0] neg_hi:[1,0,0]
    v_pk_fma_f32 v[128:129], v[188:189], v[24:25], v[128:129] op_sel_hi:[0,1,1] neg_lo:[1,0,0] neg_hi:[1,0,0]
    v_mfma_f32_16x16x32_bf16 v[160:163], v[44:47], v[40:43], v[160:163]
    v_pk_fma_f32 v[130:131], v[188:189], v[26:27], v[130:131] op_sel_hi:[0,1,1] neg_lo:[1,0,0] neg_hi:[1,0,0]
    v_cvt_pk_bf16_f32 v124, v124, v125
    v_cvt_pk_bf16_f32 v125, v126, v127
    v_mfma_f32_16x16x32_bf16 v[164:167], v[48:51], v[40:43], v[164:167]
    ds_write_b64 v3, v[124:125] offset:12800
    v_cvt_pk_bf16_f32 v128, v128, v129
    v_cvt_pk_bf16_f32 v129, v130, v131
    v_mfma_f32_16x16x32_bf16 v[160:163], v[80:83], v[76:79], v[160:163]
    ds_write_b64 v3, v[128:129] offset:12928
    s_mov_b32 s64, 0x0706000c
    s_mov_b32 s66, 0x11111111
    v_mfma_f32_16x16x32_bf16 v[164:167], v[84:87], v[76:79], v[164:167]
    s_mov_b32 s67, s66
    s_mov_b32 s68, 0x33333333
    v_pk_fma_f32 v[136:137], v[190:191], v[20:21], v[136:137] op_sel_hi:[0,1,1] neg_lo:[1,0,0] neg_hi:[1,0,0]
    v_mfma_f32_16x16x32_bf16 v[108:111], v[88:91], v[56:59], v[108:111]
    v_pk_fma_f32 v[138:139], v[190:191], v[22:23], v[138:139] op_sel_hi:[0,1,1] neg_lo:[1,0,0] neg_hi:[1,0,0]
    v_pk_fma_f32 v[140:141], v[190:191], v[24:25], v[140:141] op_sel_hi:[0,1,1] neg_lo:[1,0,0] neg_hi:[1,0,0]
    v_pk_fma_f32 v[142:143], v[190:191], v[26:27], v[142:143] op_sel_hi:[0,1,1] neg_lo:[1,0,0] neg_hi:[1,0,0]
    v_mfma_f32_16x16x32_bf16 v[120:123], v[88:91], v[60:63], v[120:123]
    v_cvt_pk_bf16_f32 v136, v136, v137
    v_cvt_pk_bf16_f32 v137, v138, v139
    ds_write_b64 v3, v[136:137] offset:19200
    v_mfma_f32_16x16x32_bf16 v[132:135], v[88:91], v[64:67], v[132:135]
    v_cvt_pk_bf16_f32 v140, v140, v141
    v_cvt_pk_bf16_f32 v141, v142, v143
    ds_write_b64 v3, v[140:141] offset:19328
    v_mfma_f32_16x16x32_bf16 v[144:147], v[88:91], v[68:71], v[144:147]
    s_mov_b32 s69, s68
    s_mov_b32 s70, 0x77777777
    s_mov_b32 s71, s70
    v_mfma_f32_16x16x32_bf16 v[156:159], v[88:91], v[72:75], v[156:159]
    v_pk_fma_f32 v[148:149], v[192:193], v[20:21], v[148:149] op_sel_hi:[0,1,1] neg_lo:[1,0,0] neg_hi:[1,0,0]
    v_pk_fma_f32 v[150:151], v[192:193], v[22:23], v[150:151] op_sel_hi:[0,1,1] neg_lo:[1,0,0] neg_hi:[1,0,0]
    v_pk_fma_f32 v[152:153], v[192:193], v[24:25], v[152:153] op_sel_hi:[0,1,1] neg_lo:[1,0,0] neg_hi:[1,0,0]
    v_mfma_f32_16x16x32_bf16 v[168:171], v[88:91], v[76:79], v[168:171]
    v_pk_fma_f32 v[154:155], v[192:193], v[26:27], v[154:155] op_sel_hi:[0,1,1] neg_lo:[1,0,0] neg_hi:[1,0,0]
    v_cvt_pk_bf16_f32 v148, v148, v149
    v_cvt_pk_bf16_f32 v149, v150, v151
    ds_write_b64 v3, v[148:149] offset:25600
    v_cvt_pk_bf16_f32 v152, v152, v153
    v_cvt_pk_bf16_f32 v153, v154, v155
    ds_write_b64 v3, v[152:153] offset:25728
    v_pk_fma_f32 v[160:161], v[194:195], v[20:21], v[160:161] op_sel_hi:[0,1,1] neg_lo:[1,0,0] neg_hi:[1,0,0]
    v_pk_fma_f32 v[162:163], v[194:195], v[22:23], v[162:163] op_sel_hi:[0,1,1] neg_lo:[1,0,0] neg_hi:[1,0,0]
    v_pk_fma_f32 v[164:165], v[194:195], v[24:25], v[164:165] op_sel_hi:[0,1,1] neg_lo:[1,0,0] neg_hi:[1,0,0]
    v_pk_fma_f32 v[166:167], v[194:195], v[26:27], v[166:167] op_sel_hi:[0,1,1] neg_lo:[1,0,0] neg_hi:[1,0,0]
    v_cvt_pk_bf16_f32 v160, v160, v161
    v_cvt_pk_bf16_f32 v161, v162, v163
    ds_write_b64 v3, v[160:161] offset:32000
    v_cvt_pk_bf16_f32 v164, v164, v165
    v_cvt_pk_bf16_f32 v165, v166, v167
    ds_write_b64 v3, v[164:165] offset:32128
    s_setprio 2
    s_branch AT_e2
AT_start:
    s_setprio 3
    ds_read_b32 v16, v208 offset:4
    ds_read2_b32 v[4:5], v209 offset0:0 offset1:2
    ds_read2_b32 v[6:7], v209 offset0:4 offset1:6
    ds_read2_b32 v[8:9], v209 offset0:8 offset1:10
    ds_read2_b32 v[10:11], v209 offset0:12 offset1:14
    ds_read2_b32 v[12:13], v209 offset0:16 offset1:18
    ds_read2_b32 v[14:15], v209 offset0:20 offset1:22
    s_mov_b32 s60, 0x07060503
    s_mov_b32 s61, 0x07060502
    s_mov_b32 s62, 0x07060501
    s_mov_b32 s63, 0x04000c0c
    s_mov_b32 s64, 0x0706000c
    s_mov_b32 s66, 0x11111111
    s_mov_b32 s67, s66
    s_mov_b32 s68, 0x33333333
    s_mov_b32 s69, s68
    s_mov_b32 s70, 0x77777777
    s_mov_b32 s71, s70
    v_mov_b32 v3, 0
AT_e2:
    s_waitcnt lgkmcnt(0)
    s_barrier
    s_branch AT_qk
AT_67:
    s_waitcnt vmcnt(11)
    ds_write_b128 v99, v[100:103] offset:2048
    s_waitcnt vmcnt(10)
    ds_write_b128 v99, v[104:107] offset:0
    s_waitcnt vmcnt(9)
    ds_write_b128 v99, v[108:111] offset:6144
    s_waitcnt vmcnt(8)
    ds_write_b128 v99, v[112:115] offset:4096
    s_waitcnt vmcnt(7)
    ds_write_b128 v99, v[116:119] offset:10240
    s_waitcnt vmcnt(6)
    ds_write_b128 v99, v[120:123] offset:8192
    s_waitcnt vmcnt(5)
    ds_write_b128 v99, v[124:127] offset:14336
    s_waitcnt vmcnt(4)
    ds_write_b128 v99, v[128:131] offset:12288
    s_waitcnt vmcnt(3)
    ds_write_b128 v99, v[132:135] offset:18432
    s_waitcnt vmcnt(2)
    ds_write_b128 v99, v[136:139] offset:16384
    s_waitcnt vmcnt(1)
    ds_write_b128 v99, v[140:143] offset:22528
    s_waitcnt vmcnt(0)
    ds_write_b128 v99, v[144:147] offset:20480
    v_mov_b32 v19, 1
    s_mov_b64 exec, 1
    ds_add_u32 v251, v19
    s_mov_b64 exec, -1
    s_mov_b32 s62, 1
    s_waitcnt vmcnt(0)
    s_branch B_ww
AT_qk:
    ds_read_b64 v[20:21], v204
    ds_read_b64 v[30:31], v205 offset:0
    ds_read_b64 v[40:41], v205 offset:1600
    ds_read_b64 v[50:51], v205 offset:3200
    ds_read_b64 v[22:23], v229
    ds_read_b64 v[32:33], v205 offset:8
    ds_read_b64 v[42:43], v205 offset:1608
    ds_read_b64 v[52:53], v205 offset:3208
    ds_read_b64 v[24:25], v230
    ds_read_b64 v[34:35], v205 offset:16
    ds_read_b64 v[44:45], v205 offset:1616
    ds_read_b64 v[54:55], v205 offset:3216
    ds_read_b64 v[26:27], v231
    ds_read_b64 v[36:37], v205 offset:24
    ds_read_b64 v[46:47], v205 offset:1624
    ds_read_b64 v[56:57], v205 offset:3224
    ds_read_b64 v[28:29], v255
    ds_read_b64 v[38:39], v205 offset:32
    ds_read_b64 v[48:49], v205 offset:1632
    ds_read_b64 v[58:59], v205 offset:3232
    v_cndmask_b32 v13, v13, v5, s[66:67]
    v_cndmask_b32 v14, v14, v6, s[68:69]
    v_cndmask_b32 v15, v15, v7, s[70:71]
    v_mov_b32 v79, s54
    v_mov_b32 v83, s54
    v_mov_b32 v87, s54
    v_mov_b64 v[88:89], 0
    v_mov_b64 v[90:91], 0
    v_mov_b64 v[92:93], 0
    v_mov_b64 v[94:95], 0
    v_mul_f32 v16, 0x3ea52b5c, v16
    v_mul_f32 v148, v16, v8
    v_mul_f32 v149, v16, v9
    v_mul_f32 v150, v16, v10
    v_mul_f32 v151, v16, v11
    v_mul_f32 v152, v16, v12
    v_mul_f32 v153, v16, v13
    v_mul_f32 v154, v16, v14
    v_mul_f32 v155, v16, v15
    s_waitcnt lgkmcnt(15)
    v_mfma_f32_4x4x4_16b_bf16 v[60:63], v[30:31], v[20:21], 0
    v_mfma_f32_4x4x4_16b_bf16 v[64:67], v[40:41], v[20:21], 0
    v_mfma_f32_4x4x4_16b_bf16 v[68:71], v[50:51], v[20:21], 0
    s_waitcnt lgkmcnt(12)
    v_mfma_f32_4x4x4_16b_bf16 v[60:63], v[32:33], v[22:23], v[60:63]
    v_mfma_f32_4x4x4_16b_bf16 v[64:67], v[42:43], v[22:23], v[64:67]
    v_mfma_f32_4x4x4_16b_bf16 v[68:71], v[52:53], v[22:23], v[68:71]
    s_waitcnt lgkmcnt(8)
    v_mfma_f32_4x4x4_16b_bf16 v[60:63], v[34:35], v[24:25], v[60:63]
    v_mfma_f32_4x4x4_16b_bf16 v[64:67], v[44:45], v[24:25], v[64:67]
    v_mfma_f32_4x4x4_16b_bf16 v[68:71], v[54:55], v[24:25], v[68:71]
    s_waitcnt lgkmcnt(4)
    v_mfma_f32_4x4x4_16b_bf16 v[60:63], v[36:37], v[26:27], v[60:63]
    v_mfma_f32_4x4x4_16b_bf16 v[64:67], v[46:47], v[26:27], v[64:67]
    v_mfma_f32_4x4x4_16b_bf16 v[68:71], v[56:57], v[26:27], v[68:71]
    s_waitcnt lgkmcnt(0)
    v_mfma_f32_4x4x4_16b_bf16 v[60:63], v[38:39], v[28:29], v[60:63]
    v_mfma_f32_4x4x4_16b_bf16 v[64:67], v[48:49], v[28:29], v[64:67]
    v_mfma_f32_4x4x4_16b_bf16 v[68:71], v[58:59], v[28:29], v[68:71]
    s_cmp_lt_i32 s13, 8
    s_cbranch_scc1 AT_mask
AT_nomask:
    s_nop 2
    v_cndmask_b32 v69, v69, v61, s[66:67]
    v_cndmask_b32 v70, v70, v62, s[68:69]
    v_cndmask_b32 v71, v71, v63, s[70:71]
    v_pk_mul_f32 v[64:65], v[64:65], v[148:149]
    v_pk_mul_f32 v[66:67], v[66:67], v[150:151]
    v_pk_mul_f32 v[68:69], v[68:69], v[152:153]
    v_pk_mul_f32 v[70:71], v[70:71], v[154:155]
    v_perm_b32 v80, v64, v67, s60
    v_perm_b32 v81, v65, v67, s61
    v_perm_b32 v82, v66, v67, s62
    v_perm_b32 v84, v68, v71, s60
    v_perm_b32 v85, v69, v71, s61
    v_perm_b32 v86, v70, v71, s62
    s_mov_b64 exec, s[20:21]
    s_cmp_eq_u32 s49, 0
    s_cbranch_scc1 sts_1
    buffer_store_dwordx4 v[80:83], v213, s[24:27], s12 offen offset:0
    buffer_store_dwordx4 v[84:87], v213, s[24:27], s12 offen offset:512
std_2:
    s_mov_b64 exec, -1
    s_cmp_ge_u32 s48, 4
    s_cbranch_scc1 AT_vw
    v_mov_b32_dpp v196, v108 row_newbcast:0 row_mask:0xf bank_mask:0xf
    v_mov_b32_dpp v197, v109 row_newbcast:0 row_mask:0xf bank_mask:0xf
    v_mov_b32_dpp v198, v110 row_newbcast:0 row_mask:0xf bank_mask:0xf
    v_mov_b32_dpp v199, v111 row_newbcast:0 row_mask:0xf bank_mask:0xf
    v_pk_fma_f32 v[108:109], v[184:185], v[196:197], v[108:109] op_sel_hi:[0,1,1] neg_lo:[1,0,0] neg_hi:[1,0,0]
    v_pk_fma_f32 v[120:121], v[186:187], v[196:197], v[120:121] op_sel_hi:[0,1,1] neg_lo:[1,0,0] neg_hi:[1,0,0]
    v_pk_fma_f32 v[132:133], v[188:189], v[196:197], v[132:133] op_sel_hi:[0,1,1] neg_lo:[1,0,0] neg_hi:[1,0,0]
    v_pk_fma_f32 v[110:111], v[184:185], v[198:199], v[110:111] op_sel_hi:[0,1,1] neg_lo:[1,0,0] neg_hi:[1,0,0]
    v_pk_fma_f32 v[122:123], v[186:187], v[198:199], v[122:123] op_sel_hi:[0,1,1] neg_lo:[1,0,0] neg_hi:[1,0,0]
    v_pk_fma_f32 v[134:135], v[188:189], v[198:199], v[134:135] op_sel_hi:[0,1,1] neg_lo:[1,0,0] neg_hi:[1,0,0]
    v_cvt_pk_bf16_f32 v108, v108, v109
    v_cvt_pk_bf16_f32 v120, v120, v121
    v_cvt_pk_bf16_f32 v132, v132, v133
    v_cvt_pk_bf16_f32 v109, v110, v111
    v_cvt_pk_bf16_f32 v121, v122, v123
    v_cvt_pk_bf16_f32 v133, v134, v135
    ds_write_b64 v3, v[108:109] offset:256
    ds_write_b64 v3, v[120:121] offset:6656
    ds_write_b64 v3, v[132:133] offset:13056
    v_pk_fma_f32 v[144:145], v[190:191], v[196:197], v[144:145] op_sel_hi:[0,1,1] neg_lo:[1,0,0] neg_hi:[1,0,0]
    v_pk_fma_f32 v[156:157], v[192:193], v[196:197], v[156:157] op_sel_hi:[0,1,1] neg_lo:[1,0,0] neg_hi:[1,0,0]
    v_pk_fma_f32 v[168:169], v[194:195], v[196:197], v[168:169] op_sel_hi:[0,1,1] neg_lo:[1,0,0] neg_hi:[1,0,0]
    v_pk_fma_f32 v[146:147], v[190:191], v[198:199], v[146:147] op_sel_hi:[0,1,1] neg_lo:[1,0,0] neg_hi:[1,0,0]
    v_pk_fma_f32 v[158:159], v[192:193], v[198:199], v[158:159] op_sel_hi:[0,1,1] neg_lo:[1,0,0] neg_hi:[1,0,0]
    v_pk_fma_f32 v[170:171], v[194:195], v[198:199], v[170:171] op_sel_hi:[0,1,1] neg_lo:[1,0,0] neg_hi:[1,0,0]
    v_cvt_pk_bf16_f32 v144, v144, v145
    v_cvt_pk_bf16_f32 v156, v156, v157
    v_cvt_pk_bf16_f32 v168, v168, v169
    v_cvt_pk_bf16_f32 v145, v146, v147
    v_cvt_pk_bf16_f32 v157, v158, v159
    v_cvt_pk_bf16_f32 v169, v170, v171
    ds_write_b64 v3, v[144:145] offset:19456
    ds_write_b64 v3, v[156:157] offset:25856
    ds_write_b64 v3, v[168:169] offset:32256
    v_mov_b32 v19, 1
    s_mov_b64 exec, 1
    ds_add_u32 v251, v19 offset:8
    s_mov_b64 exec, -1
AT_vw:
    v_lshl_add_u32 v17, v201, 3, v251
    ds_read2_b64 v[156:159], v17 offset0:14 offset1:18
    ds_read2_b64 v[160:163], v17 offset0:22 offset1:26
    v_and_b32 v164, 2, v201
    v_lshl_add_u32 v164, v200, 2, v164
    s_lshl_b32 s65, s48, 6
    s_add_u32 s65, s65, s57
    s_mov_b64 exec, s[20:21]
AT_poll:
    buffer_load_dwordx4 v[88:91], v206, s[24:27], s22 offen offset:0 sc1
    buffer_load_dwordx4 v[92:95], v206, s[24:27], s22 offen offset:512 sc1
AT_pw:
    s_waitcnt vmcnt(0)
    v_cmp_ne_u32 vcc, s54, v91
    v_cmp_ne_u32 s[58:59], s54, v95
    s_or_b64 vcc, vcc, s[58:59]
    s_cbranch_vccz AT_got
    s_sub_u32 s3, s3, 1
    s_cbranch_scc0 AT_poll
    s_mov_b32 s3, 0
AT_got:
    s_mov_b64 exec, -1
    ds_read_b32 v17, v251 offset:8
    s_cmp_lt_u32 s48, 4
    s_cbranch_scc1 AT_w0
    v_mov_b32 v19, 1
    s_mov_b64 exec, 1
    ds_add_u32 v251, v19
    s_mov_b64 exec, -1
AT_w0:
    v_perm_b32 v91, v88, v89, s63
    v_perm_b32 v95, v92, v93, s63
    v_perm_b32 v91, v91, v90, s64
    v_perm_b32 v95, v95, v94, s64
    v_pk_add_f32 v[64:65], v[64:65], v[88:89]
    v_pk_add_f32 v[68:69], v[68:69], v[92:93]
    v_pk_add_f32 v[66:67], v[66:67], v[90:91]
    v_pk_add_f32 v[70:71], v[70:71], v[94:95]
    v_max3_f32 v18, v64, v65, v66
    v_max3_f32 v19, v67, v68, v69
    v_max3_f32 v18, v18, v70, v71
    v_max_f32 v18, v18, v19
    v_pk_add_f32 v[64:65], v[64:65], v[18:19] op_sel_hi:[1,0] neg_lo:[0,1] neg_hi:[0,1]
    v_pk_add_f32 v[66:67], v[66:67], v[18:19] op_sel_hi:[1,0] neg_lo:[0,1] neg_hi:[0,1]
    v_pk_add_f32 v[68:69], v[68:69], v[18:19] op_sel_hi:[1,0] neg_lo:[0,1] neg_hi:[0,1]
    v_pk_add_f32 v[70:71], v[70:71], v[18:19] op_sel_hi:[1,0] neg_lo:[0,1] neg_hi:[0,1]
AT_vc:
    s_waitcnt lgkmcnt(0)
    v_cmp_ne_u32 vcc, 4, v17
    s_cbranch_vccnz AT_vs
AT_vg:
    ds_read_b64_tr_b16 v[100:101], v214 offset:0
    ds_read_b64_tr_b16 v[102:103], v214 offset:1600
    ds_read_b64_tr_b16 v[104:105], v214 offset:32
    ds_read_b64_tr_b16 v[106:107], v214 offset:1632
    ds_read_b64_tr_b16 v[108:109], v214 offset:64
    ds_read_b64_tr_b16 v[110:111], v214 offset:1664
    ds_read_b64_tr_b16 v[112:113], v214 offset:96
    ds_read_b64_tr_b16 v[114:115], v214 offset:1696
    v_exp_f32 v64, v64
    v_exp_f32 v65, v65
    v_exp_f32 v66, v66
    v_exp_f32 v67, v67
    v_exp_f32 v68, v68
    v_exp_f32 v69, v69
    v_exp_f32 v70, v70
    v_exp_f32 v71, v71
    v_pk_add_f32 v[20:21], v[64:65], v[66:67]
    v_pk_add_f32 v[22:23], v[68:69], v[70:71]
    v_pk_add_f32 v[20:21], v[20:21], v[22:23]
    v_add_f32 v20, v20, v21
    v_rcp_f32 v20, v20
    v_pk_mul_f32 v[64:65], v[64:65], v[8:9]
    v_pk_mul_f32 v[66:67], v[66:67], v[10:11]
    v_pk_mul_f32 v[68:69], v[68:69], v[12:13]
    v_pk_mul_f32 v[70:71], v[70:71], v[14:15]
    v_pk_mul_f32 v[64:65], v[64:65], v[20:21] op_sel_hi:[1,0]
    v_pk_mul_f32 v[66:67], v[66:67], v[20:21] op_sel_hi:[1,0]
    v_pk_mul_f32 v[68:69], v[68:69], v[20:21] op_sel_hi:[1,0]
    v_pk_mul_f32 v[70:71], v[70:71], v[20:21] op_sel_hi:[1,0]
    v_cvt_pk_bf16_f32 v24, v64, v65
    v_cvt_pk_bf16_f32 v25, v66, v67
    v_cvt_pk_bf16_f32 v26, v68, v69
    v_cvt_pk_bf16_f32 v27, v70, v71
    ds_write_b64 v210, v[24:25] offset:8
    v_and_b32 v28, v26, v207
    v_and_b32 v29, v27, v211
    ds_write_b64 v210, v[28:29]
    v_xor_b32 v26, v26, v28
    v_xor_b32 v27, v27, v29
    ds_write_b64 v210, v[26:27] offset:16
    ds_read_b128 v[116:119], v172
    ds_read_b128 v[120:123], v173
    ds_read_b128 v[124:127], v174
    ds_read_b128 v[128:131], v175
    ds_read_b128 v[132:135], v176
    ds_read_b128 v[136:139], v177
    ds_read_b128 v[140:143], v178
    ds_read_b128 v[144:147], v179
    s_cmp_lt_u32 s48, 4
    s_cbranch_scc1 AT_pv
    s_lshl_b32 s58, s48, 2
    s_add_u32 s58, s58, 160760
    v_mov_b32 v18, s58
    v_mov_b32 v19, 1
    ds_write_b32 v18, v19
AT_pv:
    s_waitcnt lgkmcnt(6)
    v_mfma_f32_16x16x32_bf16 v[20:23], v[100:103], v[116:119], 0
    v_mfma_f32_16x16x32_bf16 v[24:27], v[100:103], v[120:123], 0
    s_waitcnt lgkmcnt(4)
    v_mfma_f32_16x16x32_bf16 v[28:31], v[104:107], v[124:127], 0
    v_mfma_f32_16x16x32_bf16 v[32:35], v[104:107], v[128:131], 0
    s_waitcnt lgkmcnt(2)
    v_mfma_f32_16x16x32_bf16 v[36:39], v[108:111], v[132:135], 0
    v_mfma_f32_16x16x32_bf16 v[40:43], v[108:111], v[136:139], 0
    s_waitcnt lgkmcnt(0)
    v_mfma_f32_16x16x32_bf16 v[44:47], v[112:115], v[140:143], 0
    v_mfma_f32_16x16x32_bf16 v[48:51], v[112:115], v[144:147], 0
    v_cndmask_b32 v20, v20, v24, s[4:5]
    v_cndmask_b32 v21, v21, v25, s[4:5]
    v_cndmask_b32 v22, v22, v26, s[4:5]
    v_cndmask_b32 v23, v23, v27, s[4:5]
    v_cvt_pk_bf16_f32 v204, v20, v21
    v_cvt_pk_bf16_f32 v205, v22, v23
    v_cndmask_b32 v28, v28, v32, s[6:7]
    v_cndmask_b32 v29, v29, v33, s[6:7]
    v_cndmask_b32 v30, v30, v34, s[6:7]
    v_cndmask_b32 v31, v31, v35, s[6:7]
    v_cvt_pk_bf16_f32 v206, v28, v29
    v_cvt_pk_bf16_f32 v207, v30, v31
    v_cndmask_b32 v36, v36, v40, s[8:9]
    v_cndmask_b32 v37, v37, v41, s[8:9]
    v_cndmask_b32 v38, v38, v42, s[8:9]
    v_cndmask_b32 v39, v39, v43, s[8:9]
    v_cvt_pk_bf16_f32 v208, v36, v37
    v_cvt_pk_bf16_f32 v209, v38, v39
    v_cndmask_b32 v44, v44, v48, s[10:11]
    v_cndmask_b32 v45, v45, v49, s[10:11]
    v_cndmask_b32 v46, v46, v50, s[10:11]
    v_cndmask_b32 v47, v47, v51, s[10:11]
    v_cvt_pk_bf16_f32 v210, v44, v45
    v_cvt_pk_bf16_f32 v211, v46, v47
    s_cmp_eq_u32 s49, 0
    s_cbranch_scc1 sts_3
    buffer_store_dwordx4 v[204:207], v249, s[24:27], s22 offen offset:0
    buffer_store_dwordx4 v[208:211], v249, s[24:27], s22 offen offset:1024
std_4:
    s_mov_b64 exec, s[18:19]
    buffer_load_dword v18, v203, s[24:27], s17 offen sc1
    s_mov_b64 exec, -1
    v_dot2_f32_bf16 v20, v204, v156, 0
    v_dot2_f32_bf16 v21, v204, v204, 0
    v_dot2_f32_bf16 v20, v205, v157, v20
    v_dot2_f32_bf16 v21, v205, v205, v21
    v_dot2_f32_bf16 v20, v206, v158, v20
    v_dot2_f32_bf16 v21, v206, v206, v21
    v_dot2_f32_bf16 v20, v207, v159, v20
    v_dot2_f32_bf16 v21, v207, v207, v21
    v_dot2_f32_bf16 v20, v208, v160, v20
    v_dot2_f32_bf16 v21, v208, v208, v21
    v_dot2_f32_bf16 v20, v209, v161, v20
    v_dot2_f32_bf16 v21, v209, v209, v21
    v_dot2_f32_bf16 v20, v210, v162, v20
    v_dot2_f32_bf16 v21, v210, v210, v21
    v_dot2_f32_bf16 v20, v211, v163, v20
    v_dot2_f32_bf16 v21, v211, v211, v21
    s_nop 2
    v_permlane32_swap_b32 v20, v21
    v_add_f32 v20, v20, v21
    v_mov_b32 v21, v20
    s_nop 1
    v_permlane16_swap_b32 v20, v21
    s_mov_b32 exec_lo, 0xffff
    s_mov_b32 exec_hi, 0xffff
    v_add_f32 v20, v20, v21
    s_cmp_eq_u32 s49, 0
    s_cbranch_scc1 sts_5
    buffer_store_short_d16_hi v20, v164, s[24:27], s65 offen
std_6:
    s_mov_b64 exec, -1
    ds_read_b32 v19, v251
    ds_read2_b64 v[240:243], v227 offset0:0 offset1:4
    ds_read2_b64 v[244:247], v227 offset0:8 offset1:12
    ds_read_b32 v248, v251 offset:2288
    ds_read_b64 v[232:233], v250
    v_xor_b32 v4, 32, v250
    ds_read_b64 v[234:235], v4
    v_xor_b32 v5, 64, v250
    ds_read_b64 v[236:237], v5
    v_xor_b32 v6, 96, v250
    ds_read_b64 v[238:239], v6
    v_cmp_gt_u32 vcc, 2048, v254
    s_mov_b64 s[4:5], vcc
    s_waitcnt vmcnt(2)
    s_mov_b64 exec, 1
    s_cmp_eq_u32 s49, 0
    s_cbranch_scc1 sts_7
    buffer_store_dword v79, v203, s[24:27], s23 offen
std_8:
    s_mov_b64 exec, -1
    s_waitcnt vmcnt(2)
    v_cmp_ne_u32 vcc, s54, v18
    s_and_b32 s62, vcc_lo, s18
    s_cbranch_scc1 B_st0
    s_add_u32 s14, s14, 2048
    s_cmp_eq_u32 s14, s15
    s_cselect_b32 s14, s1, s14
    buffer_load_dwordx4 v[168:171], v249, s[24:27], s14 offen offset:0 sc1
    buffer_load_dwordx4 v[172:175], v249, s[24:27], s14 offen offset:1024 sc1
    s_add_u32 s14, s14, 2048
    s_cmp_eq_u32 s14, s15
    s_cselect_b32 s14, s1, s14
    buffer_load_dwordx4 v[176:179], v249, s[24:27], s14 offen offset:0 sc1
    buffer_load_dwordx4 v[180:183], v249, s[24:27], s14 offen offset:1024 sc1
    s_add_u32 s14, s14, 2048
    s_cmp_eq_u32 s14, s15
    s_cselect_b32 s14, s1, s14
    buffer_load_dwordx4 v[212:215], v249, s[24:27], s14 offen offset:0 sc1
    buffer_load_dwordx4 v[12:15], v249, s[24:27], s14 offen offset:1024 sc1
B_st0:
B_start:
    s_branch B_wc
B_ww:
    ds_read_b32 v19, v251
B_wc:
    s_waitcnt lgkmcnt(0)
    v_cmp_ne_u32 vcc, 4, v19
    s_cbranch_vccz B_wd
    s_sleep 1
    s_sub_u32 s3, s3, 1
    s_cbranch_scc0 B_ww
    s_mov_b32 s3, 0
B_wd:
    s_mov_b32 exec_lo, 0x00010001
    s_mov_b32 exec_hi, 0x00010001
    v_mov_b32 v240, 0x3f803f80
    v_mov_b32 v241, 0x3f803f80
    v_mov_b32 v242, 0x3f803f80
    v_mov_b32 v243, 0x3f803f80
    v_mov_b32 v244, 0x3f803f80
    v_mov_b32 v245, 0x3f803f80
    v_mov_b32 v246, 0x3f803f80
    v_mov_b32 v247, 0x3f803f80
    s_mov_b64 exec, -1
    s_setprio 0
    s_cmp_ge_u32 s48, 6
    s_cbranch_scc1 B_r2
    ds_read_b64_tr_b16 v[20:21], v216 offset:0
    ds_read_b64_tr_b16 v[22:23], v216 offset:2048
    ds_read_b64_tr_b16 v[24:25], v217 offset:0
    ds_read_b64_tr_b16 v[26:27], v217 offset:2048
    ds_read_b64_tr_b16 v[28:29], v218 offset:0
    ds_read_b64_tr_b16 v[30:31], v218 offset:2048
    ds_read_b64_tr_b16 v[32:33], v219 offset:0
    ds_read_b64_tr_b16 v[34:35], v219 offset:2048
    ds_read_b64_tr_b16 v[36:37], v216 offset:4096
    ds_read_b64_tr_b16 v[38:39], v216 offset:6144
    ds_read_b64_tr_b16 v[40:41], v217 offset:4096
    ds_read_b64_tr_b16 v[42:43], v217 offset:6144
    ds_read_b64_tr_b16 v[44:45], v218 offset:4096
    ds_read_b64_tr_b16 v[46:47], v218 offset:6144
    ds_read_b64_tr_b16 v[48:49], v219 offset:4096
    ds_read_b64_tr_b16 v[50:51], v219 offset:6144
B_r2:
    ds_read_b64_tr_b16 v[52:53], v216 offset:8192
    ds_read_b64_tr_b16 v[54:55], v216 offset:10240
    ds_read_b64_tr_b16 v[56:57], v217 offset:8192
    ds_read_b64_tr_b16 v[58:59], v217 offset:10240
    ds_read_b64_tr_b16 v[60:61], v218 offset:8192
    ds_read_b64_tr_b16 v[62:63], v218 offset:10240
    ds_read_b64_tr_b16 v[64:65], v219 offset:8192
    ds_read_b64_tr_b16 v[66:67], v219 offset:10240
    ds_read_b64_tr_b16 v[68:69], v216 offset:12288
    ds_read_b64_tr_b16 v[70:71], v216 offset:14336
    ds_read_b64_tr_b16 v[72:73], v217 offset:12288
    ds_read_b64_tr_b16 v[74:75], v217 offset:14336
    ds_read_b64_tr_b16 v[76:77], v218 offset:12288
    ds_read_b64_tr_b16 v[78:79], v218 offset:14336
    ds_read_b64_tr_b16 v[80:81], v219 offset:12288
    ds_read_b64_tr_b16 v[82:83], v219 offset:14336
    s_cmp_eq_u32 s62, 0
    s_cbranch_scc1 B_nap
    s_mov_b64 exec, s[18:19]
    buffer_load_dword v18, v203, s[24:27], s17 offen sc1
    s_mov_b64 exec, -1
B_nap:
    ds_read_b64_tr_b16 v[84:85], v216 offset:16384
    ds_read_b64_tr_b16 v[86:87], v216 offset:18432
    ds_read_b64_tr_b16 v[88:89], v217 offset:16384
    ds_read_b64_tr_b16 v[90:91], v217 offset:18432
    ds_read_b64_tr_b16 v[92:93], v218 offset:16384
    ds_read_b64_tr_b16 v[94:95], v218 offset:18432
    ds_read_b64_tr_b16 v[96:97], v219 offset:16384
    ds_read_b64_tr_b16 v[98:99], v219 offset:18432
    ds_read_b64_tr_b16 v[100:101], v216 offset:20480
    ds_read_b64_tr_b16 v[102:103], v216 offset:22528
    ds_read_b64_tr_b16 v[104:105], v217 offset:20480
    ds_read_b64_tr_b16 v[106:107], v217 offset:22528
    ds_read_b64_tr_b16 v[108:109], v218 offset:20480
    ds_read_b64_tr_b16 v[110:111], v218 offset:22528
    ds_read_b64_tr_b16 v[112:113], v219 offset:20480
    ds_read_b64_tr_b16 v[114:115], v219 offset:22528
    ds_read_b64_tr_b16 v[116:117], v216 offset:24576
    ds_read_b64_tr_b16 v[118:119], v216 offset:26624
    ds_read_b64_tr_b16 v[120:121], v217 offset:24576
    ds_read_b64_tr_b16 v[122:123], v217 offset:26624
    ds_read_b64_tr_b16 v[124:125], v218 offset:24576
    ds_read_b64_tr_b16 v[126:127], v218 offset:26624
    ds_read_b64_tr_b16 v[128:129], v219 offset:24576
    ds_read_b64_tr_b16 v[130:131], v219 offset:26624
    s_cmp_ge_u32 s48, 6
    s_cbranch_scc1 B_no
    v_lshlrev_b32 v184, 16, v232
    v_and_b32 v185, s47, v232
    v_lshlrev_b32 v186, 16, v233
    v_and_b32 v187, s47, v233
    v_lshlrev_b32 v188, 16, v234
    v_and_b32 v189, s47, v234
    v_lshlrev_b32 v190, 16, v235
    v_and_b32 v191, s47, v235
    v_lshlrev_b32 v192, 16, v236
    v_and_b32 v193, s47, v236
    v_lshlrev_b32 v194, 16, v237
    v_and_b32 v195, s47, v237
    v_lshlrev_b32 v196, 16, v238
    v_and_b32 v197, s47, v238
    v_lshlrev_b32 v198, 16, v239
    v_and_b32 v199, s47, v239
    s_waitcnt lgkmcnt(0)
    v_mfma_f32_16x16x32_bf16 v[184:187], v[20:23], v[204:207], v[184:187]
    v_mfma_f32_16x16x32_bf16 v[188:191], v[24:27], v[204:207], v[188:191]
    v_mfma_f32_16x16x32_bf16 v[192:195], v[28:31], v[204:207], v[192:195]
    v_mfma_f32_16x16x32_bf16 v[196:199], v[32:35], v[204:207], v[196:199]
    s_waitcnt lgkmcnt(0)
    v_mfma_f32_16x16x32_bf16 v[184:187], v[36:39], v[208:211], v[184:187]
    v_mfma_f32_16x16x32_bf16 v[188:191], v[40:43], v[208:211], v[188:191]
    v_mfma_f32_16x16x32_bf16 v[192:195], v[44:47], v[208:211], v[192:195]
    v_mfma_f32_16x16x32_bf16 v[196:199], v[48:51], v[208:211], v[196:199]
    s_branch B_n2
B_rds:
    ds_read_b64_tr_b16 v[132:133], v216 offset:28672
    ds_read_b64_tr_b16 v[134:135], v216 offset:30720
    ds_read_b64_tr_b16 v[136:137], v217 offset:28672
    ds_read_b64_tr_b16 v[138:139], v217 offset:30720
    ds_read_b64_tr_b16 v[140:141], v218 offset:28672
    ds_read_b64_tr_b16 v[142:143], v218 offset:30720
    ds_read_b64_tr_b16 v[144:145], v219 offset:28672
    ds_read_b64_tr_b16 v[146:147], v219 offset:30720
    ds_read_b64_tr_b16 v[148:149], v216 offset:32768
    ds_read_b64_tr_b16 v[150:151], v216 offset:34816
    ds_read_b64_tr_b16 v[152:153], v217 offset:32768
    ds_read_b64_tr_b16 v[154:155], v217 offset:34816
    ds_read_b64_tr_b16 v[156:157], v218 offset:32768
    ds_read_b64_tr_b16 v[158:159], v218 offset:34816
    ds_read_b64_tr_b16 v[160:161], v219 offset:32768
    ds_read_b64_tr_b16 v[162:163], v219 offset:34816
    ds_read_b64_tr_b16 v[20:21], v216 offset:36864
    ds_read_b64_tr_b16 v[22:23], v216 offset:38912
    ds_read_b64_tr_b16 v[24:25], v217 offset:36864
    ds_read_b64_tr_b16 v[26:27], v217 offset:38912
    ds_read_b64_tr_b16 v[28:29], v218 offset:36864
    ds_read_b64_tr_b16 v[30:31], v218 offset:38912
    ds_read_b64_tr_b16 v[32:33], v219 offset:36864
    ds_read_b64_tr_b16 v[34:35], v219 offset:38912
    ds_read_b64_tr_b16 v[36:37], v220 offset:0
    ds_read_b64_tr_b16 v[38:39], v220 offset:2048
    ds_read_b64_tr_b16 v[40:41], v221 offset:0
    ds_read_b64_tr_b16 v[42:43], v221 offset:2048
    ds_read_b64_tr_b16 v[44:45], v222 offset:0
    ds_read_b64_tr_b16 v[46:47], v222 offset:2048
    ds_read_b64_tr_b16 v[48:49], v223 offset:0
    ds_read_b64_tr_b16 v[50:51], v223 offset:2048
    s_setpc_b64 s[98:99]
B_no:
    v_mov_b64 v[184:185], 0
    v_mov_b64 v[186:187], 0
    v_mov_b64 v[188:189], 0
    v_mov_b64 v[190:191], 0
    v_mov_b64 v[192:193], 0
    v_mov_b64 v[194:195], 0
    v_mov_b64 v[196:197], 0
    v_mov_b64 v[198:199], 0
    s_call_b64 s[98:99], B_rds
    v_mul_u32_u24 v4, 12, v0
    s_add_u32 s58, s100, 512
    s_add_u32 s59, s100, 24832
    s_add_u32 s60, s100, 49152
    s_add_u32 s12, s100, 73472
    s_add_u32 s13, s100, 97792
    v_and_b32 v5, 31, v0
    v_mul_u32_u24 v5, 3, v5
    s_mul_i32 s64, s53, 96
    s_sub_u32 s65, 1014, s55
    v_mov_b32 v6, 0xfffff000
    v_add_u32 v7, -10, v5
    v_cmp_gt_u32 vcc, s65, v7
    v_add3_u32 v7, v5, s64, 0
    s_nop 0
    v_cndmask_b32 v8, 0, v7, vcc
    v_cndmask_b32 v204, 0, v6, vcc
    v_add_u32 v7, -9, v5
    v_cmp_gt_u32 vcc, s65, v7
    v_add3_u32 v7, v5, s64, 1
    s_nop 0
    v_cndmask_b32 v9, 0, v7, vcc
    v_cndmask_b32 v205, 0, v6, vcc
    v_add_u32 v7, -8, v5
    v_cmp_gt_u32 vcc, s65, v7
    v_add3_u32 v7, v5, s64, 2
    s_nop 0
    v_cndmask_b32 v10, 0, v7, vcc
    v_cndmask_b32 v206, 0, v6, vcc
    v_mov_b32 v7, s54
    v_lshlrev_b32 v11, 11, v200
    s_setprio 2
B_n2:
    s_cmp_eq_u32 s62, 0
    s_cbranch_scc1 B_run
    s_mov_b64 exec, s[18:19]
    s_branch B_pw
B_poll:
    buffer_load_dword v18, v203, s[24:27], s17 offen sc1
B_pw:
    s_waitcnt vmcnt(0)
    v_cmp_ne_u32 vcc, s54, v18
    s_cbranch_vccz B_go
    s_sub_u32 s3, s3, 1
    s_cbranch_scc0 B_poll
    s_mov_b32 s3, 0
B_go:
    s_mov_b64 exec, -1
    s_add_u32 s14, s14, 2048
    s_cmp_eq_u32 s14, s15
    s_cselect_b32 s14, s1, s14
    buffer_load_dwordx4 v[168:171], v249, s[24:27], s14 offen offset:0 sc1
    buffer_load_dwordx4 v[172:175], v249, s[24:27], s14 offen offset:1024 sc1
    s_add_u32 s14, s14, 2048
    s_cmp_eq_u32 s14, s15
    s_cselect_b32 s14, s1, s14
    buffer_load_dwordx4 v[176:179], v249, s[24:27], s14 offen offset:0 sc1
    buffer_load_dwordx4 v[180:183], v249, s[24:27], s14 offen offset:1024 sc1
    s_add_u32 s14, s14, 2048
    s_cmp_eq_u32 s14, s15
    s_cselect_b32 s14, s1, s14
    buffer_load_dwordx4 v[212:215], v249, s[24:27], s14 offen offset:0 sc1
    buffer_load_dwordx4 v[12:15], v249, s[24:27], s14 offen offset:1024 sc1
B_run:
    s_cmp_ge_u32 s48, 6
    s_cbranch_scc1 B_half
    s_call_b64 s[98:99], B_rds
    s_cmp_ge_u32 s48, 4
    s_cbranch_scc1 B_half
    s_setprio 1
    s_waitcnt vmcnt(5) lgkmcnt(15)
    v_mfma_f32_16x16x32_bf16 v[184:187], v[52:55], v[168:171], v[184:187]
    v_mfma_f32_16x16x32_bf16 v[188:191], v[56:59], v[168:171], v[188:191]
    ds_read_b64_tr_b16 v[52:53], v220 offset:4096
    v_mfma_f32_16x16x32_bf16 v[192:195], v[60:63], v[168:171], v[192:195]
    ds_read_b64_tr_b16 v[54:55], v220 offset:6144
    v_mfma_f32_16x16x32_bf16 v[196:199], v[64:67], v[168:171], v[196:199]
    s_add_u32 s14, s14, 2048
    s_cmp_eq_u32 s14, s15
    s_cselect_b32 s14, s1, s14
    buffer_load_dwordx4 v[164:167], v249, s[24:27], s14 offen offset:0 sc1
    ds_read_b64_tr_b16 v[56:57], v221 offset:4096
    s_waitcnt vmcnt(5) lgkmcnt(15)
    v_mfma_f32_16x16x32_bf16 v[184:187], v[68:71], v[172:175], v[184:187]
    ds_read_b64_tr_b16 v[58:59], v221 offset:6144
    ds_read_b64_tr_b16 v[60:61], v222 offset:4096
    v_mfma_f32_16x16x32_bf16 v[188:191], v[72:75], v[172:175], v[188:191]
    ds_read_b64_tr_b16 v[62:63], v222 offset:6144
    v_mfma_f32_16x16x32_bf16 v[192:195], v[76:79], v[172:175], v[192:195]
    ds_read_b64_tr_b16 v[64:65], v223 offset:4096
    v_mfma_f32_16x16x32_bf16 v[196:199], v[80:83], v[172:175], v[196:199]
    buffer_load_dwordx4 v[232:235], v249, s[24:27], s14 offen offset:1024 sc1
    ds_read_b64_tr_b16 v[66:67], v223 offset:6144
    s_waitcnt vmcnt(5) lgkmcnt(15)
    v_mfma_f32_16x16x32_bf16 v[184:187], v[84:87], v[176:179], v[184:187]
    ds_read_b64_tr_b16 v[68:69], v220 offset:8192
    ds_read_b64_tr_b16 v[70:71], v220 offset:10240
    v_mfma_f32_16x16x32_bf16 v[188:191], v[88:91], v[176:179], v[188:191]
    ds_read_b64_tr_b16 v[72:73], v221 offset:8192
    v_mfma_f32_16x16x32_bf16 v[192:195], v[92:95], v[176:179], v[192:195]
    ds_read_b64_tr_b16 v[74:75], v221 offset:10240
    v_mfma_f32_16x16x32_bf16 v[196:199], v[96:99], v[176:179], v[196:199]
    s_mov_b32 s14, s16
    buffer_load_dwordx4 v[236:239], v249, s[24:27], s14 offen offset:0 sc1
    ds_read_b64_tr_b16 v[76:77], v222 offset:8192
    s_waitcnt vmcnt(5) lgkmcnt(15)
    v_mfma_f32_16x16x32_bf16 v[184:187], v[100:103], v[180:183], v[184:187]
    ds_read_b64_tr_b16 v[78:79], v222 offset:10240
    ds_read_b64_tr_b16 v[80:81], v223 offset:8192
    v_mfma_f32_16x16x32_bf16 v[188:191], v[104:107], v[180:183], v[188:191]
    ds_read_b64_tr_b16 v[82:83], v223 offset:10240
    v_mfma_f32_16x16x32_bf16 v[192:195], v[108:111], v[180:183], v[192:195]
    ds_read_b64_tr_b16 v[84:85], v220 offset:12288
    v_mfma_f32_16x16x32_bf16 v[196:199], v[112:115], v[180:183], v[196:199]
    buffer_load_dwordx4 v[168:171], v249, s[24:27], s14 offen offset:1024 sc1
    ds_read_b64_tr_b16 v[86:87], v220 offset:14336
    s_waitcnt vmcnt(5) lgkmcnt(15)
    v_mfma_f32_16x16x32_bf16 v[184:187], v[116:119], v[212:215], v[184:187]
    ds_read_b64_tr_b16 v[88:89], v221 offset:12288
    ds_read_b64_tr_b16 v[90:91], v221 offset:14336
    v_mfma_f32_16x16x32_bf16 v[188:191], v[120:123], v[212:215], v[188:191]
    ds_read_b64_tr_b16 v[92:93], v222 offset:12288
    v_mfma_f32_16x16x32_bf16 v[192:195], v[124:127], v[212:215], v[192:195]
    ds_read_b64_tr_b16 v[94:95], v222 offset:14336
    v_mfma_f32_16x16x32_bf16 v[196:199], v[128:131], v[212:215], v[196:199]
    s_add_u32 s14, s14, 2048
    s_cmp_eq_u32 s14, s15
    s_cselect_b32 s14, s1, s14
    buffer_load_dwordx4 v[172:175], v249, s[24:27], s14 offen offset:0 sc1
    ds_read_b64_tr_b16 v[96:97], v223 offset:12288
    s_waitcnt vmcnt(5) lgkmcnt(15)
    v_mfma_f32_16x16x32_bf16 v[184:187], v[132:135], v[12:15], v[184:187]
    ds_read_b64_tr_b16 v[98:99], v223 offset:14336
    ds_read_b64_tr_b16 v[100:101], v220 offset:16384
    v_mfma_f32_16x16x32_bf16 v[188:191], v[136:139], v[12:15], v[188:191]
    ds_read_b64_tr_b16 v[102:103], v220 offset:18432
    v_mfma_f32_16x16x32_bf16 v[192:195], v[140:143], v[12:15], v[192:195]
    ds_read_b64_tr_b16 v[104:105], v221 offset:16384
    v_mfma_f32_16x16x32_bf16 v[196:199], v[144:147], v[12:15], v[196:199]
    buffer_load_dwordx4 v[176:179], v249, s[24:27], s14 offen offset:1024 sc1
    ds_read_b64_tr_b16 v[106:107], v221 offset:18432
    s_waitcnt vmcnt(5) lgkmcnt(15)
    v_mfma_f32_16x16x32_bf16 v[184:187], v[148:151], v[164:167], v[184:187]
    ds_read_b64_tr_b16 v[108:109], v222 offset:16384
    ds_read_b64_tr_b16 v[110:111], v222 offset:18432
    v_mfma_f32_16x16x32_bf16 v[188:191], v[152:155], v[164:167], v[188:191]
    ds_read_b64_tr_b16 v[112:113], v223 offset:16384
    v_mfma_f32_16x16x32_bf16 v[192:195], v[156:159], v[164:167], v[192:195]
    ds_read_b64_tr_b16 v[114:115], v223 offset:18432
    v_mfma_f32_16x16x32_bf16 v[196:199], v[160:163], v[164:167], v[196:199]
    s_add_u32 s14, s14, 2048
    s_cmp_eq_u32 s14, s15
    s_cselect_b32 s14, s1, s14
    buffer_load_dwordx4 v[180:183], v249, s[24:27], s14 offen offset:0 sc1
    ds_read_b64_tr_b16 v[116:117], v220 offset:20480
    s_waitcnt vmcnt(5) lgkmcnt(15)
    v_mfma_f32_16x16x32_bf16 v[184:187], v[20:23], v[232:235], v[184:187]
    ds_read_b64_tr_b16 v[118:119], v220 offset:22528
    ds_read_b64_tr_b16 v[120:121], v221 offset:20480
    v_mfma_f32_16x16x32_bf16 v[188:191], v[24:27], v[232:235], v[188:191]
    ds_read_b64_tr_b16 v[122:123], v221 offset:22528
    v_mfma_f32_16x16x32_bf16 v[192:195], v[28:31], v[232:235], v[192:195]
    ds_read_b64_tr_b16 v[124:125], v222 offset:20480
    v_mfma_f32_16x16x32_bf16 v[196:199], v[32:35], v[232:235], v[196:199]
    buffer_load_dwordx4 v[212:215], v249, s[24:27], s14 offen offset:1024 sc1
    ds_read_b64_tr_b16 v[126:127], v222 offset:22528
    s_waitcnt vmcnt(5) lgkmcnt(15)
    v_mfma_f32_16x16x32_bf16 v[184:187], v[36:39], v[236:239], v[184:187]
    ds_read_b64_tr_b16 v[128:129], v223 offset:20480
    ds_read_b64_tr_b16 v[130:131], v223 offset:22528
    v_mfma_f32_16x16x32_bf16 v[188:191], v[40:43], v[236:239], v[188:191]
    ds_read_b64_tr_b16 v[132:133], v220 offset:24576
    v_mfma_f32_16x16x32_bf16 v[192:195], v[44:47], v[236:239], v[192:195]
    ds_read_b64_tr_b16 v[134:135], v220 offset:26624
    v_mfma_f32_16x16x32_bf16 v[196:199], v[48:51], v[236:239], v[196:199]
    s_add_u32 s14, s14, 2048
    s_cmp_eq_u32 s14, s15
    s_cselect_b32 s14, s1, s14
    buffer_load_dwordx4 v[12:15], v249, s[24:27], s14 offen offset:0 sc1
    ds_read_b64_tr_b16 v[136:137], v221 offset:24576
    s_waitcnt vmcnt(5) lgkmcnt(15)
    v_mfma_f32_16x16x32_bf16 v[184:187], v[52:55], v[168:171], v[184:187]
    ds_read_b64_tr_b16 v[138:139], v221 offset:26624
    ds_read_b64_tr_b16 v[140:141], v222 offset:24576
    v_mfma_f32_16x16x32_bf16 v[188:191], v[56:59], v[168:171], v[188:191]
    ds_read_b64_tr_b16 v[142:143], v222 offset:26624
    v_mfma_f32_16x16x32_bf16 v[192:195], v[60:63], v[168:171], v[192:195]
    ds_read_b64_tr_b16 v[144:145], v223 offset:24576
    v_mfma_f32_16x16x32_bf16 v[196:199], v[64:67], v[168:171], v[196:199]
    buffer_load_dwordx4 v[164:167], v249, s[24:27], s14 offen offset:1024 sc1
    ds_read_b64_tr_b16 v[146:147], v223 offset:26624
    s_waitcnt vmcnt(5) lgkmcnt(15)
    v_mfma_f32_16x16x32_bf16 v[184:187], v[68:71], v[172:175], v[184:187]
    ds_read_b64_tr_b16 v[148:149], v220 offset:28672
    ds_read_b64_tr_b16 v[150:151], v220 offset:30720
    v_mfma_f32_16x16x32_bf16 v[188:191], v[72:75], v[172:175], v[188:191]
    ds_read_b64_tr_b16 v[152:153], v221 offset:28672
    v_mfma_f32_16x16x32_bf16 v[192:195], v[76:79], v[172:175], v[192:195]
    ds_read_b64_tr_b16 v[154:155], v221 offset:30720
    v_mfma_f32_16x16x32_bf16 v[196:199], v[80:83], v[172:175], v[196:199]
    s_add_u32 s14, s14, 2048
    s_cmp_eq_u32 s14, s15
    s_cselect_b32 s14, s1, s14
    buffer_load_dwordx4 v[232:235], v249, s[24:27], s14 offen offset:0 sc1
    ds_read_b64_tr_b16 v[156:157], v222 offset:28672
    s_waitcnt vmcnt(5) lgkmcnt(15)
    v_mfma_f32_16x16x32_bf16 v[184:187], v[84:87], v[176:179], v[184:187]
    ds_read_b64_tr_b16 v[158:159], v222 offset:30720
    ds_read_b64_tr_b16 v[160:161], v223 offset:28672
    v_mfma_f32_16x16x32_bf16 v[188:191], v[88:91], v[176:179], v[188:191]
    ds_read_b64_tr_b16 v[162:163], v223 offset:30720
    v_mfma_f32_16x16x32_bf16 v[192:195], v[92:95], v[176:179], v[192:195]
    ds_read_b64_tr_b16 v[20:21], v220 offset:32768
    v_mfma_f32_16x16x32_bf16 v[196:199], v[96:99], v[176:179], v[196:199]
    buffer_load_dwordx4 v[236:239], v249, s[24:27], s14 offen offset:1024 sc1
    ds_read_b64_tr_b16 v[22:23], v220 offset:34816
    s_waitcnt vmcnt(5) lgkmcnt(15)
    v_mfma_f32_16x16x32_bf16 v[184:187], v[100:103], v[180:183], v[184:187]
    ds_read_b64_tr_b16 v[24:25], v221 offset:32768
    ds_read_b64_tr_b16 v[26:27], v221 offset:34816
    v_mfma_f32_16x16x32_bf16 v[188:191], v[104:107], v[180:183], v[188:191]
    ds_read_b64_tr_b16 v[28:29], v222 offset:32768
    v_mfma_f32_16x16x32_bf16 v[192:195], v[108:111], v[180:183], v[192:195]
    ds_read_b64_tr_b16 v[30:31], v222 offset:34816
    v_mfma_f32_16x16x32_bf16 v[196:199], v[112:115], v[180:183], v[196:199]
    ds_read_b64_tr_b16 v[32:33], v223 offset:32768
    s_waitcnt vmcnt(4) lgkmcnt(15)
    v_mfma_f32_16x16x32_bf16 v[184:187], v[116:119], v[212:215], v[184:187]
    ds_read_b64_tr_b16 v[34:35], v223 offset:34816
    ds_read_b64_tr_b16 v[36:37], v220 offset:36864
    v_mfma_f32_16x16x32_bf16 v[188:191], v[120:123], v[212:215], v[188:191]
    ds_read_b64_tr_b16 v[38:39], v220 offset:38912
    v_mfma_f32_16x16x32_bf16 v[192:195], v[124:127], v[212:215], v[192:195]
    ds_read_b64_tr_b16 v[40:41], v221 offset:36864
    v_mfma_f32_16x16x32_bf16 v[196:199], v[128:131], v[212:215], v[196:199]
    ds_read_b64_tr_b16 v[42:43], v221 offset:38912
    s_waitcnt vmcnt(3) lgkmcnt(15)
    v_mfma_f32_16x16x32_bf16 v[184:187], v[132:135], v[12:15], v[184:187]
    ds_read_b64_tr_b16 v[44:45], v222 offset:36864
    ds_read_b64_tr_b16 v[46:47], v222 offset:38912
    v_mfma_f32_16x16x32_bf16 v[188:191], v[136:139], v[12:15], v[188:191]
    ds_read_b64_tr_b16 v[48:49], v223 offset:36864
    v_mfma_f32_16x16x32_bf16 v[192:195], v[140:143], v[12:15], v[192:195]
    ds_read_b64_tr_b16 v[50:51], v223 offset:38912
    v_mfma_f32_16x16x32_bf16 v[196:199], v[144:147], v[12:15], v[196:199]
    s_waitcnt vmcnt(2) lgkmcnt(15)
    v_mfma_f32_16x16x32_bf16 v[184:187], v[148:151], v[164:167], v[184:187]
    v_mfma_f32_16x16x32_bf16 v[188:191], v[152:155], v[164:167], v[188:191]
    v_mfma_f32_16x16x32_bf16 v[192:195], v[156:159], v[164:167], v[192:195]
    v_mfma_f32_16x16x32_bf16 v[196:199], v[160:163], v[164:167], v[196:199]
    ds_read_b32 v10, v251 offset:4
    s_waitcnt vmcnt(1) lgkmcnt(9)
    v_mfma_f32_16x16x32_bf16 v[184:187], v[20:23], v[232:235], v[184:187]
    v_mfma_f32_16x16x32_bf16 v[188:191], v[24:27], v[232:235], v[188:191]
    v_mfma_f32_16x16x32_bf16 v[192:195], v[28:31], v[232:235], v[192:195]
    v_mfma_f32_16x16x32_bf16 v[196:199], v[32:35], v[232:235], v[196:199]
    s_waitcnt vmcnt(0) lgkmcnt(1)
    v_mfma_f32_16x16x32_bf16 v[184:187], v[36:39], v[236:239], v[184:187]
    v_mfma_f32_16x16x32_bf16 v[188:191], v[40:43], v[236:239], v[188:191]
    v_mfma_f32_16x16x32_bf16 v[192:195], v[44:47], v[236:239], v[192:195]
    v_mfma_f32_16x16x32_bf16 v[196:199], v[48:51], v[236:239], v[196:199]
    s_branch B_epi
B_half:
    s_add_u32 s14, s14, 2048
    s_cmp_eq_u32 s14, s15
    s_cselect_b32 s14, s1, s14
    buffer_load_dwordx4 v[164:167], v249, s[24:27], s14 offen offset:0 sc1
    buffer_load_dwordx4 v[232:235], v249, s[24:27], s14 offen offset:1024 sc1
    s_mov_b32 s14, s16
    buffer_load_dwordx4 v[236:239], v249, s[24:27], s14 offen offset:0 sc1
    s_cmp_lg_u32 s48, 6
    s_cbranch_scc1 E_end
    s_setprio 3
E_poll:
    s_mov_b32 exec_hi, 0x0fffffff
    buffer_load_dword v17, v203, s[24:27], s100 offen sc1
    s_mov_b32 exec_hi, -1
    buffer_load_dwordx3 v[224:226], v4, s[24:27], s58 offen sc1
    buffer_load_dwordx3 v[228:230], v4, s[24:27], s59 offen sc1
    buffer_load_dwordx3 v[240:242], v4, s[24:27], s60 offen sc1
    buffer_load_dwordx3 v[244:246], v4, s[24:27], s12 offen sc1
    buffer_load_dwordx3 v[208:210], v4, s[24:27], s13 offen sc1
E_chk:
    s_waitcnt vmcnt(5)
    v_cmp_ne_u32 vcc, s54, v17
    s_lshl_b64 vcc, vcc, 4
    s_cbranch_scc0 E_go
    s_sleep 1
    s_sub_u32 s3, s3, 1
    s_cbranch_scc0 E_poll
    s_mov_b32 s3, 0
E_go:
    s_waitcnt vmcnt(4)
    s_waitcnt vmcnt(3)
    v_add_f32 v252, v224, v228
    v_add_f32 v253, v225, v229
    v_add_f32 v254, v226, v230
    v_lshlrev_b32 v224, 16, v224
    v_lshlrev_b32 v225, 16, v225
    v_lshlrev_b32 v226, 16, v226
    v_lshlrev_b32 v228, 16, v228
    v_lshlrev_b32 v229, 16, v229
    v_lshlrev_b32 v230, 16, v230
    v_add_f32 v224, v224, v228
    v_add_f32 v225, v225, v229
    v_add_f32 v226, v226, v230
    s_waitcnt vmcnt(2)
    v_add_f32 v252, v252, v240
    v_add_f32 v253, v253, v241
    v_add_f32 v254, v254, v242
    v_lshlrev_b32 v240, 16, v240
    v_lshlrev_b32 v241, 16, v241
    v_lshlrev_b32 v242, 16, v242
    v_add_f32 v224, v224, v240
    v_add_f32 v225, v225, v241
    v_add_f32 v226, v226, v242
    s_waitcnt vmcnt(1)
    v_add_f32 v252, v252, v244
    v_add_f32 v253, v253, v245
    v_add_f32 v254, v254, v246
    v_lshlrev_b32 v244, 16, v244
    v_lshlrev_b32 v245, 16, v245
    v_lshlrev_b32 v246, 16, v246
    v_add_f32 v224, v224, v244
    v_add_f32 v225, v225, v245
    v_add_f32 v226, v226, v246
    s_waitcnt vmcnt(0)
    v_add_f32 v252, v252, v208
    v_add_f32 v253, v253, v209
    v_add_f32 v254, v254, v210
    v_lshlrev_b32 v208, 16, v208
    v_lshlrev_b32 v209, 16, v209
    v_lshlrev_b32 v210, 16, v210
    v_add_f32 v224, v224, v208
    v_add_f32 v225, v225, v209
    v_add_f32 v226, v226, v210
    v_permlane32_swap_b32 v224, v252
    v_permlane32_swap_b32 v225, v253
    v_permlane32_swap_b32 v226, v254
    v_add_f32 v224, v224, v252
    v_add_f32 v225, v225, v253
    v_add_f32 v226, v226, v254
    v_rsq_f32 v252, v224
    v_rsq_f32 v253, v225
    v_rsq_f32 v254, v226
    v_permlane32_swap_b32 v252, v228
    v_permlane32_swap_b32 v253, v229
    v_permlane32_swap_b32 v254, v230
    v_mul_f32 v224, v224, v228
    v_mul_f32 v225, v225, v229
    v_mul_f32 v226, v226, v230
    v_and_or_b32 v252, v224, v204, v8
    v_and_or_b32 v253, v225, v205, v9
    v_and_or_b32 v254, v226, v206, v10
    v_max3_i32 v6, v252, v253, v254
    s_nop 1
    v_max_i32_dpp v6, v6, v6 row_ror:1 row_mask:0xf bank_mask:0xf
    s_nop 1
    v_max_i32_dpp v6, v6, v6 row_ror:2 row_mask:0xf bank_mask:0xf
    s_nop 1
    v_max_i32_dpp v6, v6, v6 row_ror:4 row_mask:0xf bank_mask:0xf
    s_nop 1
    v_max_i32_dpp v6, v6, v6 row_ror:8 row_mask:0xf bank_mask:0xf
    v_mov_b32 v5, v6
    s_nop 1
    v_permlane16_swap_b32 v6, v5
    s_mov_b64 exec, 0xffff
    s_lshr_b32 s64, 1, s51
    s_bitcmp0_b32 s64, 0
    v_max3_i32 v6, v6, v5, 1
    s_cbranch_scc1 E_np
    buffer_store_dwordx2 v[6:7], v11, s[24:27], s45 offen sc1
E_np:
    ds_write_b32 v251, v6 offset:4
    s_mov_b64 exec, -1
E_end:
    s_waitcnt vmcnt(8) lgkmcnt(15)
    v_mfma_f32_16x16x32_bf16 v[184:187], v[52:55], v[168:171], v[184:187]
    v_mfma_f32_16x16x32_bf16 v[188:191], v[56:59], v[168:171], v[188:191]
    v_mfma_f32_16x16x32_bf16 v[192:195], v[60:63], v[168:171], v[192:195]
    v_mfma_f32_16x16x32_bf16 v[196:199], v[64:67], v[168:171], v[196:199]
    s_waitcnt vmcnt(7) lgkmcnt(15)
    v_mfma_f32_16x16x32_bf16 v[184:187], v[68:71], v[172:175], v[184:187]
    v_mfma_f32_16x16x32_bf16 v[188:191], v[72:75], v[172:175], v[188:191]
    v_mfma_f32_16x16x32_bf16 v[192:195], v[76:79], v[172:175], v[192:195]
    v_mfma_f32_16x16x32_bf16 v[196:199], v[80:83], v[172:175], v[196:199]
    ds_read_b32 v10, v251 offset:4
    s_waitcnt vmcnt(6) lgkmcnt(15)
    v_mfma_f32_16x16x32_bf16 v[184:187], v[84:87], v[176:179], v[184:187]
    v_mfma_f32_16x16x32_bf16 v[188:191], v[88:91], v[176:179], v[188:191]
    v_mfma_f32_16x16x32_bf16 v[192:195], v[92:95], v[176:179], v[192:195]
    v_mfma_f32_16x16x32_bf16 v[196:199], v[96:99], v[176:179], v[196:199]
    s_waitcnt lgkmcnt(0)
    v_and_b32 v9, 0xfff, v10
    s_nop 0
    v_readfirstlane_b32 s64, v9
    s_lshr_b32 s64, s64, 4
    s_mul_i32 s65, s53, 6
    s_add_u32 s65, s65, s56
    s_cmp_lg_u32 s64, s65
    s_cbranch_scc1 B_nb
    s_setprio 3
B_nb:
    s_waitcnt vmcnt(5) lgkmcnt(15)
    v_mfma_f32_16x16x32_bf16 v[184:187], v[100:103], v[180:183], v[184:187]
    v_mfma_f32_16x16x32_bf16 v[188:191], v[104:107], v[180:183], v[188:191]
    v_mfma_f32_16x16x32_bf16 v[192:195], v[108:111], v[180:183], v[192:195]
    v_mfma_f32_16x16x32_bf16 v[196:199], v[112:115], v[180:183], v[196:199]
    s_waitcnt vmcnt(4) lgkmcnt(15)
    v_mfma_f32_16x16x32_bf16 v[184:187], v[116:119], v[212:215], v[184:187]
    v_mfma_f32_16x16x32_bf16 v[188:191], v[120:123], v[212:215], v[188:191]
    v_mfma_f32_16x16x32_bf16 v[192:195], v[124:127], v[212:215], v[192:195]
    v_mfma_f32_16x16x32_bf16 v[196:199], v[128:131], v[212:215], v[196:199]
    s_waitcnt vmcnt(3) lgkmcnt(15)
    v_mfma_f32_16x16x32_bf16 v[184:187], v[132:135], v[12:15], v[184:187]
    v_mfma_f32_16x16x32_bf16 v[188:191], v[136:139], v[12:15], v[188:191]
    v_mfma_f32_16x16x32_bf16 v[192:195], v[140:143], v[12:15], v[192:195]
    v_mfma_f32_16x16x32_bf16 v[196:199], v[144:147], v[12:15], v[196:199]
    s_waitcnt vmcnt(2) lgkmcnt(15)
    v_mfma_f32_16x16x32_bf16 v[184:187], v[148:151], v[164:167], v[184:187]
    v_mfma_f32_16x16x32_bf16 v[188:191], v[152:155], v[164:167], v[188:191]
    v_mfma_f32_16x16x32_bf16 v[192:195], v[156:159], v[164:167], v[192:195]
    v_mfma_f32_16x16x32_bf16 v[196:199], v[160:163], v[164:167], v[196:199]
    s_waitcnt vmcnt(1) lgkmcnt(9)
    v_mfma_f32_16x16x32_bf16 v[184:187], v[20:23], v[232:235], v[184:187]
    v_mfma_f32_16x16x32_bf16 v[188:191], v[24:27], v[232:235], v[188:191]
    v_mfma_f32_16x16x32_bf16 v[192:195], v[28:31], v[232:235], v[192:195]
    v_mfma_f32_16x16x32_bf16 v[196:199], v[32:35], v[232:235], v[196:199]
    s_cmp_eq_u32 s48, 6
    s_cbranch_scc1 B_w6
    s_waitcnt vmcnt(0)
B_w6:
    s_waitcnt lgkmcnt(1)
    v_mfma_f32_16x16x32_bf16 v[184:187], v[36:39], v[236:239], v[184:187]
    v_mfma_f32_16x16x32_bf16 v[188:191], v[40:43], v[236:239], v[188:191]
    v_mfma_f32_16x16x32_bf16 v[192:195], v[44:47], v[236:239], v[192:195]
    v_mfma_f32_16x16x32_bf16 v[196:199], v[48:51], v[236:239], v[196:199]
    s_lshl_b32 s61, s56, 12
    s_add_u32 s61, s61, 135168
    v_add_u32 v16, s61, v202
    s_lshl_b32 s61, s56, 2
    s_add_u32 s61, s61, 160760
    v_mov_b32 v18, s61
    s_cmp_eq_u32 s101, 0
    s_cbranch_scc1 B_rx0
B_pf:
    ds_read_b32 v19, v18
    s_waitcnt lgkmcnt(0)
    v_cmp_eq_u32 vcc, 0, v19
    s_cbranch_vccz B_pg
    s_sleep 1
    s_sub_u32 s3, s3, 1
    s_cbranch_scc0 B_pf
    s_mov_b32 s3, 0
B_pg:
    ds_write_b128 v16, v[184:187] offset:0
    ds_write_b128 v16, v[188:191] offset:1024
    ds_write_b128 v16, v[192:195] offset:2048
    ds_write_b128 v16, v[196:199] offset:3072
    v_mov_b32 v19, 2
    s_waitcnt lgkmcnt(0)
    ds_write_b32 v18, v19
    s_branch L_fin
B_rx0:
B_rx:
    ds_read_b32 v19, v18
    s_waitcnt lgkmcnt(0)
    v_cmp_ne_u32 vcc, 2, v19
    s_cbranch_vccz B_rd
    s_sub_u32 s3, s3, 1
    s_cbranch_scc0 B_rx
    s_mov_b32 s3, 0
B_rd:
    ds_read_b32 v10, v251 offset:4
    ds_read_b128 v[100:103], v16 offset:0
    ds_read_b128 v[104:107], v16 offset:1024
    ds_read_b128 v[108:111], v16 offset:2048
    ds_read_b128 v[112:115], v16 offset:3072
    s_waitcnt lgkmcnt(0)
    v_add_f32 v184, v184, v100
    v_add_f32 v185, v185, v101
    v_add_f32 v186, v186, v102
    v_add_f32 v187, v187, v103
    v_add_f32 v188, v188, v104
    v_add_f32 v189, v189, v105
    v_add_f32 v190, v190, v106
    v_add_f32 v191, v191, v107
    v_add_f32 v192, v192, v108
    v_add_f32 v193, v193, v109
    v_add_f32 v194, v194, v110
    v_add_f32 v195, v195, v111
    v_add_f32 v196, v196, v112
    v_add_f32 v197, v197, v113
    v_add_f32 v198, v198, v114
    v_add_f32 v199, v199, v115
B_epi:
    s_waitcnt lgkmcnt(0)
    v_cmp_eq_u32 vcc, 0, v10
    v_and_b32 v10, 0xfff, v10
    s_cbranch_vccnz B_ew
B_eg:
    v_cmp_eq_u32 s[68:69], v10, v226
    v_add_u32 v10, s54, v10
    v_mov_b32 v16, 0x3f803f80
    v_mov_b32 v15, s54
    s_add_u32 s63, s1, 20480
    s_lshl_b32 s64, s51, 8
    s_add_u32 s64, s64, s63
    v_cvt_pk_bf16_f32 v52, v184, v185
    v_cvt_pk_bf16_f32 v53, v186, v187
    v_cvt_pk_bf16_f32 v54, v188, v189
    v_cvt_pk_bf16_f32 v55, v190, v191
    v_cvt_pk_bf16_f32 v56, v192, v193
    v_cvt_pk_bf16_f32 v57, v194, v195
    v_cvt_pk_bf16_f32 v58, v196, v197
    v_cvt_pk_bf16_f32 v59, v198, v199
    s_cmp_eq_u64 s[68:69], 0
    s_cbranch_scc1 B_np2
    s_mov_b64 exec, s[68:69]
    ds_write_b128 v228, v[52:55] offset:0
    ds_write_b128 v228, v[56:59] offset:16
    s_mov_b64 exec, -1
    ds_read_b64 v[8:9], v252
    s_waitcnt lgkmcnt(0)
    buffer_store_dwordx3 v[8:10], v224, s[24:27], s44 offen sc1
B_np2:
    v_mfma_f32_16x16x32_bf16 v[12:15], v[240:243], v[52:55], 0
    v_mfma_f32_16x16x32_bf16 v[12:15], v[244:247], v[56:59], v[12:15]
    v_dot2_f32_bf16 v16, v52, v52, 0
    v_dot2_f32_bf16 v17, v53, v53, 0
    v_dot2_f32_bf16 v16, v54, v54, v16
    v_dot2_f32_bf16 v17, v55, v55, v17
    v_dot2_f32_bf16 v16, v56, v56, v16
    v_dot2_f32_bf16 v17, v57, v57, v17
    v_dot2_f32_bf16 v16, v58, v58, v16
    v_dot2_f32_bf16 v17, v59, v59, v17
    s_nop 2
    v_add_f32 v16, v16, v17
    v_mov_b32 v17, v16
    s_nop 1
    v_permlane32_swap_b32 v16, v17
    v_add_f32 v16, v16, v17
    v_mov_b32 v17, v16
    v_mov_b32 v15, s54
    s_nop 0
    v_permlane16_swap_b32 v16, v17
    v_add_f32 v13, v16, v17
    s_mov_b64 exec, 0xffff
    s_cmp_eq_u32 s49, 0
    s_cbranch_scc1 sts_9
    buffer_store_dwordx4 v[12:15], v202, s[24:27], s64 offen
std_10:
    s_mov_b64 exec, -1
    v_lshlrev_b32 v36, 16, v52
    v_and_b32 v37, s47, v52
    v_lshlrev_b32 v38, 16, v53
    v_and_b32 v39, s47, v53
    v_lshlrev_b32 v40, 16, v54
    v_and_b32 v41, s47, v54
    v_lshlrev_b32 v42, 16, v55
    v_and_b32 v43, s47, v55
    v_lshlrev_b32 v44, 16, v56
    v_and_b32 v45, s47, v56
    v_lshlrev_b32 v46, 16, v57
    v_and_b32 v47, s47, v57
    v_lshlrev_b32 v48, 16, v58
    v_and_b32 v49, s47, v58
    v_lshlrev_b32 v50, 16, v59
    v_and_b32 v51, s47, v59
    v_mov_b32 v108, 0
    v_mov_b32 v109, 0
    v_mov_b32 v110, 0
    v_mov_b32 v111, s54
    v_mov_b32 v11, s54
    v_mov_b32 v5, 1
    v_lshlrev_b32 v7, 11, v200
    s_add_u32 s45, s45, 32768
    s_sub_u32 s44, s44, 131072
    buffer_load_dwordx4 v[100:103], v202, s[24:27], s63 offen offset:0 sc1
    buffer_load_dwordx4 v[104:107], v202, s[24:27], s63 offen offset:1024 sc1
    s_mov_b32 exec_hi, 0
    buffer_load_dwordx4 v[108:111], v202, s[24:27], s63 offen offset:2048 sc1
    s_mov_b32 exec_hi, -1
    s_branch S_pw
S_poll:
    s_mov_b64 exec, s[58:59]
    s_cbranch_execz S_r0
    buffer_load_dwordx4 v[100:103], v202, s[24:27], s63 offen offset:0 sc1
S_r0:
    s_mov_b64 exec, s[64:65]
    s_cbranch_execz S_r1
    buffer_load_dwordx4 v[104:107], v202, s[24:27], s63 offen offset:1024 sc1
S_r1:
    s_mov_b64 exec, s[66:67]
    s_cbranch_execz S_r2
    buffer_load_dwordx4 v[108:111], v202, s[24:27], s63 offen offset:2048 sc1
S_r2:
    s_mov_b64 exec, -1
S_pw:
    s_waitcnt vmcnt(0)
    v_cmp_ne_u32 s[58:59], s54, v103
    v_cmp_ne_u32 s[64:65], s54, v107
    v_cmp_ne_u32 s[66:67], s54, v111
    s_or_b64 vcc, s[58:59], s[64:65]
    s_or_b64 vcc, vcc, s[66:67]
    s_cbranch_scc0 S_got
    s_sub_u32 s3, s3, 1
    s_cbranch_scc0 S_poll
    s_mov_b32 s3, 0
S_got:
    v_add_f32 v12, v100, v104
    v_add_f32 v13, v101, v105
    v_add_f32 v14, v102, v106
    v_add_f32 v12, v12, v108
    v_add_f32 v13, v13, v109
    v_add_f32 v14, v14, v110
    v_mov_b32 v17, v12
    v_mov_b32 v18, v13
    v_mov_b32 v19, v14
    v_permlane32_swap_b32 v17, v12
    v_permlane32_swap_b32 v18, v13
    v_permlane32_swap_b32 v19, v14
    v_add_f32 v12, v12, v17
    v_add_f32 v13, v13, v18
    v_add_f32 v14, v14, v19
    v_mov_b32 v17, v12
    v_mov_b32 v18, v13
    v_mov_b32 v19, v14
    v_permlane16_swap_b32 v17, v12
    v_permlane16_swap_b32 v18, v13
    v_permlane16_swap_b32 v19, v14
    v_add_f32 v12, v12, v17
    v_add_f32 v13, v13, v18
    v_add_f32 v14, v14, v19
    v_mul_f32 v12, 0x3acccccd, v12
    v_mul_f32 v13, 0x3acccccd, v13
    v_fma_f32 v13, -v12, v12, v13
    v_max_f32 v13, 0, v13
    v_cvt_pk_bf16_f32 v13, v13, v13
    v_and_b32 v13, 0xffff0000, v13
    v_add_f32 v13, 0x3727c5ac, v13
    v_cvt_pk_bf16_f32 v13, v13, v13
    v_and_b32 v13, 0xffff0000, v13
    v_sqrt_f32 v13, v13
    v_cvt_pk_bf16_f32 v12, v12, v12
    v_and_b32 v12, 0xffff0000, v12
    v_cvt_pk_bf16_f32 v13, v13, v13
    v_and_b32 v13, 0xffff0000, v13
    v_rcp_f32 v13, v13
    v_fma_f32 v14, -v12, v248, v14
    v_mul_f32 v14, v14, v13
    v_ashrrev_i32 v6, 31, v14
    v_or_b32 v6, 0x80000000, v6
    v_xor_b32 v6, v6, v14
    v_and_b32 v6, 0xfffff000, v6
    v_or_b32 v6, v6, v226
    s_and_b64 exec, s[4:5], 0xffff
    ds_max_u32 v251, v6 offset:12
    s_lshr_b32 s64, 1, s51
    s_bitcmp0_b32 s64, 0
    s_cbranch_scc1 S_nk
    s_mov_b64 exec, 1
    ds_add_rtn_u32 v5, v251, v5 offset:20
    s_mov_b64 exec, 0xffff
    ds_read_b32 v10, v251 offset:12
    s_waitcnt lgkmcnt(0)
    v_readfirstlane_b32 s64, v5
    s_cmp_lg_u32 s64, 5
    s_cbranch_scc1 S_nk
    buffer_store_dwordx2 v[10:11], v7, s[24:27], s45 offen sc1
S_nk:
    s_mov_b64 exec, -1
    s_and_b64 s[68:69], s[68:69], s[4:5]
    s_cbranch_scc0 S_ne
    s_call_b64 s[98:99], S_ln
    s_mov_b64 exec, s[68:69]
    buffer_store_dwordx4 v[60:63], v225, s[40:43], 0 offen offset:0 sc1
    buffer_store_dwordx4 v[64:67], v225, s[40:43], 0 offen offset:64 sc1
    s_mov_b64 exec, -1
S_ne:
    s_waitcnt lgkmcnt(0)
    s_barrier
    ds_read_b32 v10, v251 offset:12
    s_waitcnt lgkmcnt(0)
S_nc:
    v_cmp_eq_u32 s[60:61], v10, v6
    s_cmp_lg_u64 s[68:69], 0
    s_cbranch_scc1 S_l2
    s_call_b64 s[98:99], S_ln
S_l2:
    s_and_b64 s[60:61], s[60:61], s[4:5]
    s_cbranch_scc0 S_out
    s_andn2_b64 exec, s[60:61], s[68:69]
    s_cbranch_execz S_l3
    buffer_store_dwordx4 v[60:63], v225, s[40:43], 0 offen offset:0 sc1
    buffer_store_dwordx4 v[64:67], v225, s[40:43], 0 offen offset:64 sc1
S_l3:
    s_mov_b64 exec, s[60:61]
    ds_write_b128 v228, v[52:55] offset:0
    ds_write_b128 v228, v[56:59] offset:16
    s_mov_b64 exec, -1
    ds_read_b64 v[8:9], v252
    v_and_b32 v10, 0xfff, v10
    v_add_u32 v10, s54, v10
    s_mov_b64 exec, 0xffff
    s_waitcnt vmcnt(0) lgkmcnt(0)
    buffer_store_dwordx3 v[8:10], v224, s[24:27], s44 offen sc1
S_out:
    s_nor_b64 exec, s[60:61], s[68:69]
    buffer_store_dwordx4 v[60:63], v225, s[40:43], 0 offen offset:0 sc1
    buffer_store_dwordx4 v[64:67], v225, s[40:43], 0 offen offset:64 sc1
    s_mov_b64 exec, -1
    s_branch L_fin
S_ln:
    v_pk_add_f32 v[20:21], v[36:37], v[12:13] op_sel_hi:[1,0] neg_lo:[0,1] neg_hi:[0,1]
    v_pk_add_f32 v[22:23], v[38:39], v[12:13] op_sel_hi:[1,0] neg_lo:[0,1] neg_hi:[0,1]
    v_pk_add_f32 v[24:25], v[40:41], v[12:13] op_sel_hi:[1,0] neg_lo:[0,1] neg_hi:[0,1]
    v_pk_add_f32 v[26:27], v[42:43], v[12:13] op_sel_hi:[1,0] neg_lo:[0,1] neg_hi:[0,1]
    v_pk_add_f32 v[28:29], v[44:45], v[12:13] op_sel_hi:[1,0] neg_lo:[0,1] neg_hi:[0,1]
    v_pk_add_f32 v[30:31], v[46:47], v[12:13] op_sel_hi:[1,0] neg_lo:[0,1] neg_hi:[0,1]
    v_pk_add_f32 v[32:33], v[48:49], v[12:13] op_sel_hi:[1,0] neg_lo:[0,1] neg_hi:[0,1]
    v_pk_add_f32 v[34:35], v[50:51], v[12:13] op_sel_hi:[1,0] neg_lo:[0,1] neg_hi:[0,1]
    v_cvt_pk_bf16_f32 v60, v20, v21
    v_cvt_pk_bf16_f32 v61, v22, v23
    v_cvt_pk_bf16_f32 v62, v24, v25
    v_cvt_pk_bf16_f32 v63, v26, v27
    v_cvt_pk_bf16_f32 v64, v28, v29
    v_cvt_pk_bf16_f32 v65, v30, v31
    v_cvt_pk_bf16_f32 v66, v32, v33
    v_cvt_pk_bf16_f32 v67, v34, v35
    v_lshlrev_b32 v20, 16, v60
    v_and_b32 v21, s47, v60
    v_lshlrev_b32 v22, 16, v61
    v_and_b32 v23, s47, v61
    v_lshlrev_b32 v24, 16, v62
    v_and_b32 v25, s47, v62
    v_lshlrev_b32 v26, 16, v63
    v_and_b32 v27, s47, v63
    v_lshlrev_b32 v28, 16, v64
    v_and_b32 v29, s47, v64
    v_lshlrev_b32 v30, 16, v65
    v_and_b32 v31, s47, v65
    v_lshlrev_b32 v32, 16, v66
    v_and_b32 v33, s47, v66
    v_lshlrev_b32 v34, 16, v67
    v_and_b32 v35, s47, v67
    v_pk_mul_f32 v[20:21], v[20:21], v[12:13] op_sel:[0,1]
    v_pk_mul_f32 v[22:23], v[22:23], v[12:13] op_sel:[0,1]
    v_pk_mul_f32 v[24:25], v[24:25], v[12:13] op_sel:[0,1]
    v_pk_mul_f32 v[26:27], v[26:27], v[12:13] op_sel:[0,1]
    v_pk_mul_f32 v[28:29], v[28:29], v[12:13] op_sel:[0,1]
    v_pk_mul_f32 v[30:31], v[30:31], v[12:13] op_sel:[0,1]
    v_pk_mul_f32 v[32:33], v[32:33], v[12:13] op_sel:[0,1]
    v_pk_mul_f32 v[34:35], v[34:35], v[12:13] op_sel:[0,1]
    v_cvt_pk_bf16_f32 v60, v20, v21
    v_cvt_pk_bf16_f32 v61, v22, v23
    v_cvt_pk_bf16_f32 v62, v24, v25
    v_cvt_pk_bf16_f32 v63, v26, v27
    v_cvt_pk_bf16_f32 v64, v28, v29
    v_cvt_pk_bf16_f32 v65, v30, v31
    v_cvt_pk_bf16_f32 v66, v32, v33
    v_cvt_pk_bf16_f32 v67, v34, v35
    v_lshlrev_b32 v20, 16, v60
    v_and_b32 v21, s47, v60
    v_lshlrev_b32 v22, 16, v61
    v_and_b32 v23, s47, v61
    v_lshlrev_b32 v24, 16, v62
    v_and_b32 v25, s47, v62
    v_lshlrev_b32 v26, 16, v63
    v_and_b32 v27, s47, v63
    v_lshlrev_b32 v28, 16, v64
    v_and_b32 v29, s47, v64
    v_lshlrev_b32 v30, 16, v65
    v_and_b32 v31, s47, v65
    v_lshlrev_b32 v32, 16, v66
    v_and_b32 v33, s47, v66
    v_lshlrev_b32 v34, 16, v67
    v_and_b32 v35, s47, v67
    v_pk_add_f32 v[20:21], v[20:21], v[36:37]
    v_pk_add_f32 v[22:23], v[22:23], v[38:39]
    v_pk_add_f32 v[24:25], v[24:25], v[40:41]
    v_pk_add_f32 v[26:27], v[26:27], v[42:43]
    v_pk_add_f32 v[28:29], v[28:29], v[44:45]
    v_pk_add_f32 v[30:31], v[30:31], v[46:47]
    v_pk_add_f32 v[32:33], v[32:33], v[48:49]
    v_pk_add_f32 v[34:35], v[34:35], v[50:51]
    v_cvt_pk_bf16_f32 v60, v20, v21
    v_cvt_pk_bf16_f32 v61, v22, v23
    v_cvt_pk_bf16_f32 v62, v24, v25
    v_cvt_pk_bf16_f32 v63, v26, v27
    v_cvt_pk_bf16_f32 v64, v28, v29
    v_cvt_pk_bf16_f32 v65, v30, v31
    v_cvt_pk_bf16_f32 v66, v32, v33
    v_cvt_pk_bf16_f32 v67, v34, v35
    v_permlane16_swap_b32 v60, v62
    v_permlane16_swap_b32 v61, v63
    v_permlane16_swap_b32 v64, v66
    v_permlane16_swap_b32 v65, v67
    s_setpc_b64 s[98:99]
L_fin:
L_end:
    s_endpgm
AT_mask:
    v_mov_b32 v17, 0xf149f2ca
    v_cmp_le_i32 vcc, 8, v212
    s_nop 1
    v_cndmask_b32 v60, v17, v60, vcc
    v_cmp_le_i32 vcc, 7, v212
    s_nop 1
    v_cndmask_b32 v61, v17, v61, vcc
    v_cmp_le_i32 vcc, 6, v212
    s_nop 1
    v_cndmask_b32 v62, v17, v62, vcc
    v_cmp_le_i32 vcc, 5, v212
    s_nop 1
    v_cndmask_b32 v63, v17, v63, vcc
    v_cmp_le_i32 vcc, 4, v212
    s_nop 1
    v_cndmask_b32 v64, v17, v64, vcc
    v_cmp_le_i32 vcc, 3, v212
    s_nop 1
    v_cndmask_b32 v65, v17, v65, vcc
    v_cmp_le_i32 vcc, 2, v212
    s_nop 1
    v_cndmask_b32 v66, v17, v66, vcc
    v_cmp_le_i32 vcc, 1, v212
    s_nop 1
    v_cndmask_b32 v67, v17, v67, vcc
    v_cmp_le_i32 vcc, 0, v212
    s_nop 1
    v_cndmask_b32 v68, v17, v68, vcc
    v_cmp_le_i32 vcc, -1, v212
    s_nop 1
    v_cndmask_b32 v69, v17, v69, vcc
    v_cmp_le_i32 vcc, -2, v212
    s_nop 1
    v_cndmask_b32 v70, v17, v70, vcc
    v_cmp_le_i32 vcc, -3, v212
    s_nop 1
    v_cndmask_b32 v71, v17, v71, vcc
    s_branch AT_nomask
sts_1:
    buffer_store_dwordx4 v[80:83], v213, s[24:27], s12 offen offset:0 sc1
    buffer_store_dwordx4 v[84:87], v213, s[24:27], s12 offen offset:512 sc1
    s_branch std_2
AT_vs:
    ds_read_b32 v17, v251 offset:8
    s_sub_u32 s3, s3, 1
    s_cbranch_scc0 AT_vc
    s_mov_b32 s3, 0
    s_branch AT_vg
sts_3:
    buffer_store_dwordx4 v[204:207], v249, s[24:27], s22 offen offset:0 sc1
    buffer_store_dwordx4 v[208:211], v249, s[24:27], s22 offen offset:1024 sc1
    s_branch std_4
sts_5:
    buffer_store_short_d16_hi v20, v164, s[24:27], s65 offen sc1
    s_branch std_6
sts_7:
    buffer_store_dword v79, v203, s[24:27], s23 offen sc1
    s_branch std_8
B_ew:
    s_sleep 1
    ds_read_b32 v10, v251 offset:4
    s_sub_u32 s3, s3, 1
    s_cbranch_scc0 B_epi
    s_mov_b32 s3, 0
    s_waitcnt lgkmcnt(0)
    s_branch B_eg
sts_9:
    buffer_store_dwordx4 v[12:15], v202, s[24:27], s64 offen sc1
    s_branch std_10
LD_cont:
    v_and_b32 v0, 63, v0
    s_mov_b32 s3, 0x40000
    s_mov_b32 s47, 0xffff0000
    s_mov_b32 s26, 7340032
    s_mov_b32 s27, 0x00020000
    s_mov_b32 s38, 819200
    s_mov_b32 s39, 0x00020000
    s_mov_b32 s42, 2621440
    s_mov_b32 s43, 0x00020000
    s_sub_u32 s52, s51, 5
    s_cselect_b32 s52, s51, s52
    s_buffer_load_dword s54, s[24:27], 0
    s_lshr_b32 s61, s2, 3
    s_mul_i32 s62, s61, 57
    s_lshr_b32 s62, s62, 9
    s_mul_i32 s62, s62, 9
    s_sub_u32 s61, s61, s62
    s_cmp_eq_u32 s61, 0
    s_cselect_b32 s63, 0x11112821, s63
    s_cmp_eq_u32 s61, 1
    s_cselect_b32 s63, 0x28471382, s63
    s_cmp_eq_u32 s61, 2
    s_cselect_b32 s63, 0x84737311, s63
    s_cmp_eq_u32 s61, 3
    s_cselect_b32 s63, 0x28471382, s63
    s_cmp_eq_u32 s61, 4
    s_cselect_b32 s63, 0x84737311, s63
    s_cmp_eq_u32 s61, 5
    s_cselect_b32 s63, 0x11112821, s63
    s_cmp_eq_u32 s61, 6
    s_cselect_b32 s63, 0x84737311, s63
    s_cmp_eq_u32 s61, 7
    s_cselect_b32 s63, 0x11112821, s63
    s_cmp_eq_u32 s61, 8
    s_cselect_b32 s63, 0x28471382, s63
    s_and_b32 s61, s63, 15
    s_lshr_b32 s63, s63, 4
    s_add_u32 s66, s66, s61
    s_sub_u32 s61, s66, 9
    s_cselect_b32 s66, s66, s61
    v_lshl_add_u32 v4, s60, 3, v1
    v_mul_u32_u24 v5, 1280, v4
    v_lshlrev_b32 v7, 1, v2
    v_bitop3_b32 v7, v0, 7, v7 bitop3:0x6a
    v_lshl_add_u32 v5, v7, 4, v5
    v_lshl_add_u32 v16, s51, 7, v5
    s_lshl_b32 s46, s53, 11
    s_add_u32 s46, s46, 81920
    s_mul_i32 s62, s60, 24
    v_add_u32 v17, s62, v0
    v_lshlrev_b32 v18, 4, v17
    v_cmp_gt_u32 vcc, 24, v0
    v_add_u32 v19, 72, v0
    v_lshlrev_b32 v19, 4, v19
    v_cndmask_b32 v18, v19, v18, vcc
    s_lshl_b32 s62, s51, 2
    s_add_u32 s62, s62, s60
    s_lshl_b32 s62, s62, 8
    s_sub_u32 s62, s62, s46
    s_add_u32 s62, s62, 1243488
    v_add_u32 v19, s62, v19
    v_cmp_lt_u32 vcc, 33, v0
    s_nop 1
    v_cndmask_b32 v18, v18, v19, vcc
    v_cmp_lt_u32 vcc, 49, v0
    s_nop 1
    v_cndmask_b32 v18, v18, 2.0, vcc
    s_cmp_eq_u32 s60, 0
    s_cselect_b32 s62, 24, 0
    v_cmp_gt_u32 vcc, s62, v0
    s_nop 1
    v_cndmask_b32 v10, v10, 2.0, vcc
    v_mov_b32 v28, 0
    v_mov_b32 v29, 0
    v_mov_b32 v30, 0
    v_mov_b32 v31, 0
    s_lshl_b32 s62, s60, 6
    v_add_u32 v4, s62, v0
    v_lshlrev_b32 v35, 4, v4
    v_add_u32 v35, 135168, v35
    ds_write_b128 v35, v[28:31] offset:0
    ds_write_b128 v35, v[28:31] offset:4096
    ds_write_b128 v35, v[28:31] offset:8192
    ds_write_b128 v35, v[28:31] offset:12288
    ds_write_b128 v35, v[28:31] offset:16384
    ds_write_b128 v35, v[28:31] offset:20480
    v_lshrrev_b32 v5, 1, v4
    v_min_u32 v5, 61, v5
    v_mul_u32_u24 v5, 400, v5
    v_and_b32 v6, 1, v4
    v_lshl_add_u32 v5, v6, 4, v5
    v_add_u32 v5, 110624, v5
    ds_write_b128 v5, v[28:31]
    v_mov_b32 v26, 160768
    ds_write_b64 v26, v[28:29] offset:8
    ds_write_b128 v26, v[28:31] offset:16
    ds_write_b64 v26, v[28:29] offset:32
    v_lshlrev_b32 v17, 3, v17
    v_add_u32 v17, 159808, v17
    s_mov_b32 s62, 160768
    v_writelane_b32 v17, s62, 24
    s_lshl_b32 s62, s60, 5
    s_add_u32 s62, s62, 160828
    v_lshl_add_u32 v25, v0, 1, s62
    s_getreg_b32 s49, hwreg(HW_REG_XCC_ID)
    v_mov_b32 v6, 159776
    ds_write_b64 v6, v[28:29]
    v_and_b32 v4, 31, v0
    v_lshlrev_b32 v5, 7, v4
    s_lshl_b32 s62, s51, 11
    v_add_u32 v6, s62, v5
    s_lshl_b32 s62, s51, 8
    s_add_u32 s62, s62, 17408
    v_add_u32 v7, s62, v5
    v_cmp_lt_u32 vcc, 23, v4
    s_nop 1
    v_cndmask_b32 v6, v6, v7, vcc
    v_and_b32 v7, 128, v5
    v_add_u32 v7, 23040, v7
    v_cmp_lt_u32 vcc, 25, v4
    s_nop 1
    v_cndmask_b32 v6, v6, v7, vcc
    v_lshrrev_b32 v7, 5, v0
    v_mul_u32_u24 v7, 24320, v7
    v_add_u32 v36, v6, v7
    s_mov_b32 vcc_hi, 0xfcff0000
    s_cmp_eq_u32 s60, 0
    s_cselect_b32 vcc_lo, 0xf0ff5555, vcc_hi
    v_cndmask_b32 v36, v36, 2.0, vcc
    s_waitcnt lgkmcnt(0)
    s_add_u32 s54, s54, 2654435761
    s_lshl_b32 s62, s60, 10
    s_add_u32 s62, s62, 36864
    s_call_b64 s[98:99], LD_issue
    s_waitcnt vmcnt(9)
    s_barrier
    s_bitcmp0_b32 s60, 0
    s_cselect_b32 s16, s14, s16
    s_cselect_b32 s17, s15, s17
    s_mov_b64 s[14:15], s[18:19]
    s_and_b32 s17, s17, 0xffff
    s_mov_b32 s18, 1966080
    s_mov_b32 s19, 0x00020000
    s_lshr_b32 s58, s60, 1
    s_lshl1_add_u32 s58, s2, s58
    s_mul_i32 s61, s58, 21846
    s_lshr_b32 s61, s61, 16
    s_mul_i32 s67, s61, 3
    s_sub_u32 s58, s58, s67
    s_mul_i32 s61, s61, 3072
    s_lshl_b32 s58, s58, 10
    s_add_u32 s58, s58, s61
    s_cmp_lt_u32 s61, 73728
    s_cselect_b32 s58, 2.0, s58
    s_buffer_load_dword s59, s[16:19], s58 offset:384
    s_buffer_load_dword s59, s[16:19], s58 offset:448
    s_buffer_load_dword s59, s[16:19], s58 offset:491904
    s_buffer_load_dword s59, s[16:19], s58 offset:491968
    s_call_b64 s[98:99], LD_issue
    s_call_b64 s[98:99], S_late
    s_waitcnt vmcnt(9)
    s_barrier
    s_add_u32 s58, s58, 983040
    s_buffer_load_dword s59, s[16:19], s58 offset:384
    s_buffer_load_dword s59, s[16:19], s58 offset:448
    s_buffer_load_dword s59, s[16:19], s58 offset:491904
    s_buffer_load_dword s59, s[16:19], s58 offset:491968
    s_call_b64 s[98:99], LD_issue
    s_call_b64 s[98:99], S_late2
    s_waitcnt vmcnt(9)
    s_barrier
    buffer_load_dwordx4 v[20:23], v18, s[24:27], s46 offen sc1
    s_call_b64 s[98:99], LD_issue
    s_call_b64 s[98:99], S_late3
    s_call_b64 s[98:99], S_late4
    ds_read_b32 v24, v26 offset:2304
    s_waitcnt vmcnt(9)
    s_barrier
    s_call_b64 s[98:99], LD_issue
    s_waitcnt lgkmcnt(0)
    s_mov_b32 exec_hi, 0x3ffff
    v_cmp_ne_u32 vcc, s54, v22
    s_cbranch_vccnz LD_rsp
LD_rs:
    s_mov_b32 exec_hi, 3
    v_cmp_ne_u32 vcc, s49, v20
    s_lshr_b64 vcc, vcc, 24
    s_cselect_b32 s49, 0, 1
    s_mov_b32 exec_hi, 0
    s_mov_b32 exec_lo, 0x1ffffff
    v_writelane_b32 v20, s49, 24
    ds_write_b64 v17, v[20:21]
    s_mov_b32 exec_hi, 0x3fffc
    s_mov_b32 exec_lo, 0
    v_mul_f32 v24, 0xbacccccd, v24
    v_fmac_f32 v21, v20, v24
    ds_write_b16_d16_hi v25, v21
    s_mov_b64 exec, -1
    s_waitcnt vmcnt(9)
    s_barrier
    s_lshl2_add_u32 s58, s53, s60
    s_mul_i32 s61, s58, 86
    s_lshr_b32 s61, s61, 8
    s_mul_i32 s67, s61, 3
    s_sub_u32 s58, s58, s67
    s_mul_i32 s58, s58, 1280
    s_mul_i32 s61, s61, 7680
    s_add_u32 s58, s58, s61
    s_mul_i32 s61, s51, 245888
    s_add_u32 s58, s58, s61
    s_buffer_load_dword s59, s[32:35], s58 offset:0
    s_buffer_load_dword s59, s[32:35], s58 offset:64
    s_buffer_load_dword s59, s[32:35], s58 offset:3840
    s_buffer_load_dword s59, s[32:35], s58 offset:3904
    s_call_b64 s[98:99], LD_issue
    s_waitcnt vmcnt(9)
    s_barrier
    s_mul_i32 s58, s60, 61440
    s_add_u32 s58, s58, s44
    s_buffer_load_dword s59, s[24:27], s58 offset:0
    s_buffer_load_dword s59, s[24:27], s58 offset:64
    s_buffer_load_dword s59, s[24:27], s58 offset:128
    s_buffer_load_dword s59, s[24:27], s58 offset:192
    s_lshl_b32 s58, s60, 6
    s_add_u32 s58, s58, s44
    s_sub_u32 s58, s58, 131072
    s_buffer_load_dword s59, s[24:27], s58
    s_call_b64 s[98:99], LD_issue
    s_waitcnt vmcnt(9)
    s_barrier
    s_call_b64 s[98:99], LD_issue
    s_waitcnt vmcnt(9)
    s_barrier
    s_mov_b32 s66, s51
    s_movk_i32 s71, 99
    s_call_b64 s[98:99], LD_issue
    s_waitcnt vmcnt(9)
    s_barrier
    s_add_u32 s63, s51, 3
    s_sub_u32 s61, s63, 10
    s_cselect_b32 s63, s63, s61
    s_mul_i32 s63, s63, 81920
    s_mov_b32 m0, s62
    s_add_u32 s62, s62, 4096
    buffer_load_dwordx4 v16, s[36:39], s63 offen lds
    s_add_u32 s63, s63, 40960
    s_mov_b32 m0, s62
    s_add_u32 s62, s62, 4096
    buffer_load_dwordx4 v16, s[36:39], s63 offen lds
    s_add_u32 s63, s63, 40960
    s_cmp_eq_u32 s63, 819200
    s_cselect_b32 s63, 0, s63
    s_mov_b32 m0, s62
    s_add_u32 s62, s62, 4096
    buffer_load_dwordx4 v16, s[36:39], s63 offen lds
    s_add_u32 s63, s63, 40960
    s_mov_b32 m0, s62
    s_add_u32 s62, s62, 4096
    buffer_load_dwordx4 v16, s[36:39], s63 offen lds
    s_add_u32 s63, s63, 40960
    s_cmp_eq_u32 s63, 819200
    s_cselect_b32 s63, 0, s63
    s_mov_b32 m0, s62
    s_add_u32 s62, s62, 4096
    buffer_load_dwordx4 v16, s[36:39], s63 offen lds
    s_add_u32 s63, s63, 40960
    s_mov_b32 m0, s62
    s_add_u32 s62, s62, 4096
    buffer_load_dwordx4 v16, s[36:39], s63 offen lds
    s_add_u32 s63, s63, 40960
    s_cmp_eq_u32 s63, 819200
    s_cselect_b32 s63, 0, s63
    s_mov_b32 m0, s62
    s_add_u32 s62, s62, 4096
    buffer_load_dwordx4 v16, s[36:39], s63 offen lds
    s_add_u32 s63, s63, 40960
    s_mov_b32 m0, s62
    s_add_u32 s62, s62, 4096
    buffer_load_dwordx4 v16, s[36:39], s63 offen lds
    s_add_u32 s63, s63, 40960
    s_cmp_eq_u32 s63, 819200
    s_cselect_b32 s63, 0, s63
    s_mov_b32 m0, s62
    s_add_u32 s62, s62, 4096
    buffer_load_dwordx4 v16, s[36:39], s63 offen lds
    s_add_u32 s63, s63, 40960
    s_waitcnt vmcnt(9) lgkmcnt(0)
    s_barrier
    s_mov_b32 m0, s62
    s_add_u32 s62, s62, 4096
    buffer_load_dwordx4 v16, s[36:39], s63 offen lds
    s_add_u32 s63, s63, 40960
    s_cmp_eq_u32 s63, 819200
    s_cselect_b32 s63, 0, s63
    s_mov_b32 m0, s62
    s_add_u32 s62, s62, 4096
    buffer_load_dwordx4 v16, s[36:39], s63 offen lds
    s_add_u32 s63, s63, 40960
    s_mov_b32 m0, s62
    s_add_u32 s62, s62, 4096
    buffer_load_dwordx4 v16, s[36:39], s63 offen lds
    s_add_u32 s63, s63, 40960
    s_cmp_eq_u32 s63, 819200
    s_cselect_b32 s63, 0, s63
    s_mov_b32 m0, s62
    s_add_u32 s62, s62, 4096
    buffer_load_dwordx4 v16, s[36:39], s63 offen lds
    s_add_u32 s63, s63, 40960
    s_mov_b32 m0, s62
    s_add_u32 s62, s62, 4096
    buffer_load_dwordx4 v16, s[36:39], s63 offen lds
    s_add_u32 s63, s63, 40960
    s_cmp_eq_u32 s63, 819200
    s_cselect_b32 s63, 0, s63
    s_cmp_eq_u32 s60, 3
    s_cbranch_scc1 pf_11
    s_mul_i32 s67, s53, 6
    s_lshl_b32 s68, s60, 1
    s_add_u32 s67, s67, s68
    s_mul_i32 s67, s67, 24320
    s_add_u32 s67, s67, 1310720
    buffer_load_dword v182, v36, s[24:27], s67 offen sc1
    s_mov_b64 exec, -1
    s_branch pf_12
pf_11:
    v_lshlrev_b32 v4, 7, v0
    s_mov_b64 exec, 7
    buffer_load_dword v182, v4, s[24:27], s57 offen sc1
    s_mov_b64 exec, -1
pf_12:
    s_cmp_lt_u32 s60, 2
    s_cbranch_scc1 LD_s10
    v_subrev_u32 v98, 20480, v16
    s_add_u32 s61, s51, 0
    s_sub_u32 s67, s61, 10
    s_cselect_b32 s61, s61, s67
    s_mul_i32 s61, s61, 81920
    buffer_load_dwordx4 v[100:103], v16, s[36:39], s61 offen
    buffer_load_dwordx4 v[104:107], v98, s[36:39], s61 offen
    s_add_u32 s61, s61, 40960
    buffer_load_dwordx4 v[108:111], v16, s[36:39], s61 offen
    buffer_load_dwordx4 v[112:115], v98, s[36:39], s61 offen
    s_add_u32 s61, s51, 1
    s_sub_u32 s67, s61, 10
    s_cselect_b32 s61, s61, s67
    s_mul_i32 s61, s61, 81920
    buffer_load_dwordx4 v[116:119], v16, s[36:39], s61 offen
    buffer_load_dwordx4 v[120:123], v98, s[36:39], s61 offen
    s_add_u32 s61, s61, 40960
    buffer_load_dwordx4 v[124:127], v16, s[36:39], s61 offen
    buffer_load_dwordx4 v[128:131], v98, s[36:39], s61 offen
    s_add_u32 s61, s51, 2
    s_sub_u32 s67, s61, 10
    s_cselect_b32 s61, s61, s67
    s_mul_i32 s61, s61, 81920
    buffer_load_dwordx4 v[132:135], v16, s[36:39], s61 offen
    buffer_load_dwordx4 v[136:139], v98, s[36:39], s61 offen
    s_add_u32 s61, s61, 40960
    buffer_load_dwordx4 v[140:143], v16, s[36:39], s61 offen
    buffer_load_dwordx4 v[144:147], v98, s[36:39], s61 offen
    s_lshl_b32 s62, s60, 10
    s_add_u32 s62, s62, 10240
    v_lshl_add_u32 v99, v0, 4, s62
    s_barrier
    s_branch AT_67
LD_s10:
    v_mov_b32 v99, v16
    s_branch AT_start
LD_rsp:
    buffer_load_dwordx4 v[20:23], v18, s[24:27], s46 offen sc1
    s_waitcnt vmcnt(0)
    v_cmp_ne_u32 vcc, s54, v22
    s_cbranch_vccz LD_rs
    s_sleep 1
    s_sub_u32 s3, s3, 1
    s_cbranch_scc0 LD_rsp
    s_mov_b32 s3, 0
    s_branch LD_rs
F_start:
    v_and_b32 v0, 63, v0
    s_mov_b32 s3, 0x40000
    s_mov_b32 s47, 0xffff0000
    s_mov_b32 s26, 7340032
    s_mov_b32 s27, 0x00020000
    s_mov_b32 s38, 819200
    s_mov_b32 s39, 0x00020000
    s_mov_b32 s42, 2621440
    s_mov_b32 s43, 0x00020000
    s_and_b32 s49, s2, 7
    s_lshl_b32 s49, s49, 1
    s_add_u32 s49, s49, s56
    s_sub_u32 s49, s49, 30
    s_and_b32 s50, s48, 1
    s_lshr_b32 s51, s48, 1
    s_mul_i32 s52, s48, 6144
    s_mul_i32 s61, s49, 192
    v_mov_b32 v5, 128
    v_add_u32 v1, 0, v0
    v_mul_u32_u24 v2, 171, v1
    v_lshrrev_b32 v2, 11, v2
    v_mul_u32_u24 v3, 12, v2
    v_sub_u32 v3, v1, v3
    v_mul_u32_u24 v2, 3072, v2
    v_lshl_add_u32 v3, v3, 4, s61
    v_lshrrev_b32 v4, 8, v3
    v_cmp_eq_u32 vcc, 9, v4
    s_nop 1
    v_cndmask_b32 v4, 0, v5, vcc
    v_xad_u32 v210, v3, v4, v2
    v_add_u32 v1, 64, v0
    v_mul_u32_u24 v2, 171, v1
    v_lshrrev_b32 v2, 11, v2
    v_mul_u32_u24 v3, 12, v2
    v_sub_u32 v3, v1, v3
    v_mul_u32_u24 v2, 3072, v2
    v_lshl_add_u32 v3, v3, 4, s61
    v_lshrrev_b32 v4, 8, v3
    v_cmp_eq_u32 vcc, 9, v4
    s_nop 1
    v_cndmask_b32 v4, 0, v5, vcc
    v_xad_u32 v211, v3, v4, v2
    v_add_u32 v1, 128, v0
    v_mul_u32_u24 v2, 171, v1
    v_lshrrev_b32 v2, 11, v2
    v_mul_u32_u24 v3, 12, v2
    v_sub_u32 v3, v1, v3
    v_mul_u32_u24 v2, 3072, v2
    v_lshl_add_u32 v3, v3, 4, s61
    v_lshrrev_b32 v4, 8, v3
    v_cmp_eq_u32 vcc, 9, v4
    s_nop 1
    v_cndmask_b32 v4, 0, v5, vcc
    v_xad_u32 v212, v3, v4, v2
    s_mul_i32 s60, s51, 491520
    s_mov_b32 s30, 1966080
    s_mov_b32 s31, 0x00020000
    s_waitcnt lgkmcnt(0)
    s_cmp_eq_u32 s50, 0
    s_cselect_b32 s28, s14, s16
    s_cselect_b32 s29, s15, s17
    s_add_u32 m0, s52, 0
    s_add_u32 s62, s60, 0
    buffer_load_dwordx4 v210, s[28:31], s62 offen lds
    s_add_u32 m0, s52, 1024
    s_add_u32 s62, s60, 0
    buffer_load_dwordx4 v211, s[28:31], s62 offen lds
    s_add_u32 m0, s52, 2048
    s_add_u32 s62, s60, 0
    buffer_load_dwordx4 v212, s[28:31], s62 offen lds
    s_add_u32 m0, s52, 3072
    s_add_u32 s62, s60, 49152
    buffer_load_dwordx4 v210, s[28:31], s62 offen lds
    s_add_u32 m0, s52, 4096
    s_add_u32 s62, s60, 49152
    buffer_load_dwordx4 v211, s[28:31], s62 offen lds
    s_add_u32 m0, s52, 5120
    s_add_u32 s62, s60, 49152
    buffer_load_dwordx4 v212, s[28:31], s62 offen lds
    s_load_dword s54, s[24:25], 0
    s_mov_b32 s4, s12
    s_and_b32 s5, s13, 0xffff
    s_mov_b32 s6, 1280
    s_mov_b32 s7, 0x00020000
    s_mov_b32 s32, s18
    s_and_b32 s33, s19, 0xffff
    s_mov_b32 s34, 1966080
    s_mov_b32 s35, 0x00020000
    s_barrier
    s_add_u32 m0, s52, 49152
    s_add_u32 s62, s60, 98304
    buffer_load_dwordx4 v210, s[28:31], s62 offen lds
    s_add_u32 m0, s52, 50176
    s_add_u32 s62, s60, 98304
    buffer_load_dwordx4 v211, s[28:31], s62 offen lds
    s_add_u32 m0, s52, 51200
    s_add_u32 s62, s60, 98304
    buffer_load_dwordx4 v212, s[28:31], s62 offen lds
    s_add_u32 m0, s52, 52224
    s_add_u32 s62, s60, 147456
    buffer_load_dwordx4 v210, s[28:31], s62 offen lds
    s_add_u32 m0, s52, 53248
    s_add_u32 s62, s60, 147456
    buffer_load_dwordx4 v211, s[28:31], s62 offen lds
    s_add_u32 m0, s52, 54272
    s_add_u32 s62, s60, 147456
    buffer_load_dwordx4 v212, s[28:31], s62 offen lds
    s_mul_i32 s53, s48, 5120
    s_mul_i32 s61, s49, 122880
    s_add_u32 s61, s61, s53
    s_and_b32 s63, s48, 2
    s_lshl_b32 s63, s63, 2
    v_add_u32 v1, 0, v0
    v_mul_u32_u24 v2, 205, v1
    v_lshrrev_b32 v2, 14, v2
    v_lshl_or_b32 v2, v2, 1, s63
    v_xor_b32 v1, v1, v2
    v_lshlrev_b32 v213, 4, v1
    v_add_u32 v1, 64, v0
    v_mul_u32_u24 v2, 205, v1
    v_lshrrev_b32 v2, 14, v2
    v_lshl_or_b32 v2, v2, 1, s63
    v_xor_b32 v1, v1, v2
    v_lshlrev_b32 v214, 4, v1
    v_add_u32 v1, 128, v0
    v_mul_u32_u24 v2, 205, v1
    v_lshrrev_b32 v2, 14, v2
    v_lshl_or_b32 v2, v2, 1, s63
    v_xor_b32 v1, v1, v2
    v_lshlrev_b32 v215, 4, v1
    v_add_u32 v1, 192, v0
    v_mul_u32_u24 v2, 205, v1
    v_lshrrev_b32 v2, 14, v2
    v_lshl_or_b32 v2, v2, 1, s63
    v_xor_b32 v1, v1, v2
    v_lshlrev_b32 v216, 4, v1
    v_add_u32 v1, 256, v0
    v_mul_u32_u24 v2, 205, v1
    v_lshrrev_b32 v2, 14, v2
    v_lshl_or_b32 v2, v2, 1, s63
    v_xor_b32 v1, v1, v2
    v_lshlrev_b32 v217, 4, v1
    v_lshrrev_b32 v2, 4, v0
    v_bfe_u32 v1, v0, 2, 2
    v_lshl_add_u32 v3, v2, 3, v1
    v_and_b32 v4, 3, v0
    v_lshlrev_b32 v4, 3, v4
    v_mul_u32_u24 v5, 192, v3
    s_and_b32 s63, s48, 5
    s_mul_i32 s63, s63, 6144
    s_and_b32 s66, s51, 1
    s_mul_i32 s64, s66, 96
    s_add_u32 s63, s63, s64
    v_add3_u32 v218, v5, v4, s63
    v_and_b32 v6, 1, v2
    v_lshl_or_b32 v6, v6, 2, v1
    v_lshlrev_b32 v6, 5, v6
    v_mul_u32_u24 v3, 1280, v3
    s_mul_i32 s63, s48, 160
    s_add_u32 s64, s63, 0
    v_add_u32 v7, s64, v4
    v_xor_b32 v7, v7, v6
    v_add_u32 v200, v7, v3
    v_add_u32 v205, 98304, v200
    s_add_u32 s64, s63, 32
    v_add_u32 v7, s64, v4
    v_xor_b32 v7, v7, v6
    v_add_u32 v201, v7, v3
    v_add_u32 v206, 98304, v201
    s_add_u32 s64, s63, 64
    v_add_u32 v7, s64, v4
    v_xor_b32 v7, v7, v6
    v_add_u32 v202, v7, v3
    v_add_u32 v207, 98304, v202
    s_add_u32 s64, s63, 96
    v_add_u32 v7, s64, v4
    v_xor_b32 v7, v7, v6
    v_add_u32 v203, v7, v3
    v_add_u32 v208, 98304, v203
    s_add_u32 s64, s63, 128
    v_add_u32 v7, s64, v4
    v_xor_b32 v7, v7, v6
    v_add_u32 v204, v7, v3
    v_add_u32 v209, 98304, v204
    s_waitcnt lgkmcnt(0)
    s_add_u32 s54, s54, 2654435761
    s_mov_b32 s67, 0x3f803f80
    v_mov_b32 v220, s67
    v_mov_b32 v221, s67
    v_mov_b32 v222, s67
    v_mov_b32 v223, s67
    v_mov_b64 v[232:233], 0
    v_mov_b64 v[234:235], 0
    v_mov_b64 v[236:237], 0
    v_mov_b64 v[238:239], 0
    v_mov_b64 v[240:241], 0
    v_mov_b64 v[242:243], 0
    v_lshlrev_b32 v16, 3, v0
    buffer_load_dwordx2 v[10:11], v16, s[4:7], 0 offen offset:0
    buffer_load_dwordx2 v[12:13], v16, s[4:7], 0 offen offset:512
    buffer_load_dwordx2 v[14:15], v16, s[4:7], 0 offen offset:1024
    v_lshlrev_b32 v1, 4, v0
    v_lshlrev_b32 v7, 6, v0
    s_lshl_b32 s15, s49, 11
    s_add_u32 s15, s15, 196608
    s_add_u32 s70, s15, 32768
    s_cmp_eq_u32 s48, 7
    s_cselect_b32 s65, s70, 2.0
    s_mov_b64 exec, 0xffffff
    buffer_load_dword v219, v7, s[24:27], s65 offen sc1
    s_mov_b64 exec, -1
    v_mov_b32 v8, 155648
    v_mov_b32 v224, 0
    v_mov_b32 v225, 0
    v_mov_b32 v226, 0
    v_mov_b32 v227, 0
    ds_write_b128 v8, v[224:227] offset:0
    ds_write_b128 v8, v[224:227] offset:16
    ds_write_b128 v8, v[224:227] offset:32
    ds_write_b128 v8, v[224:227] offset:3648
    ds_write_b128 v8, v[224:227] offset:3664
    ds_write_b128 v8, v[224:227] offset:3776
    ds_write_b128 v8, v[224:227] offset:3792
    s_mul_i32 s65, s48, 1344
    s_add_u32 s45, s65, 16384
    v_lshl_add_u32 v16, v0, 2, s45
    v_and_b32 v19, 15, v0
    v_bfe_u32 v5, v0, 1, 1
    v_mov_b32 v6, 0x44444444
    v_mov_b32 v9, 0xeeeeeeee
    v_cmp_eq_u32 vcc, 1, v5
    s_nop 1
    v_cndmask_b32 v252, v6, v9, vcc
    v_lshlrev_b32 v6, 4, v2
    v_lshl_add_u32 v6, v5, 7, v6
    v_add_u32 v6, v6, v8
    v_bfe_u32 v3, v0, 2, 2
    v_and_b32 v4, 1, v0
    v_lshl_add_u32 v3, v3, 1, v4
    v_mul_u32_u24 v9, 1344, v3
    v_mul_u32_u24 v5, 672, v5
    v_add_u32 v9, v9, v5
    v_lshrrev_b32 v3, 1, v2
    v_mul_u32_u24 v3, 160, v3
    v_and_b32 v4, 1, v2
    v_lshl_add_u32 v3, v4, 4, v3
    s_lshr_b32 s65, s48, 2
    s_mul_i32 s63, s65, 320
    v_add3_u32 v9, v9, v3, s63
    s_lshl1_add_u32 s65, s65, s50
    s_mul_i32 s65, s65, 768
    s_mul_i32 s66, s66, 384
    s_add_u32 s65, s65, s66
    v_lshl_add_u32 v3, v19, 3, s65
    v_add_u32 v230, 155904, v3
    v_mul_u32_u24 v4, 3328, v2
    v_add_u32 v3, v3, v4
    s_mul_i32 s65, s48, 48
    v_add_u32 v4, s65, v0
    v_bfe_u32 v5, v4, 1, 1
    v_lshlrev_b32 v5, 7, v5
    v_and_b32 v17, 1, v4
    v_lshl_add_u32 v5, v17, 1, v5
    v_and_b32 v17, 0xfc, v4
    v_add_u32 v5, v5, v17
    v_lshrrev_b32 v17, 6, v4
    v_lshl_add_u32 v5, v17, 5, v5
    v_add_u32 v5, v5, v8
    v_lshlrev_b32 v4, 3, v4
    v_and_b32 v17, 7, v0
    v_lshlrev_b32 v18, 4, v17
    v_lshl_add_u32 v18, v2, 11, v18
    v_lshrrev_b32 v19, 3, v19
    v_lshl_add_u32 v229, v19, 12, v18
    s_lshl_b32 s8, s48, 13
    s_lshl_b32 s65, s49, 7
    s_add_u32 s8, s8, s65
    s_add_u32 s8, s8, 16384
    s_sub_u32 s44, s48, 2
    s_lshl_b32 s14, s49, 12
    s_lshl_b32 s65, s44, 11
    s_add_u32 s14, s14, s65
    s_add_u32 s14, s14, 16384
    s_lshr_b32 s65, s49, 1
    s_lshl_b32 s65, s65, 6
    s_lshl3_add_u32 s65, s49, s65
    s_and_b32 s66, s44, 1
    s_movk_i32 s19, 0xff
    s_cselect_b32 s18, s19, 0x00ff00ff
    s_mul_i32 s66, s66, 48
    s_add_u32 s65, s65, s66
    v_and_b32 v18, 1, v2
    v_lshrrev_b32 v19, 1, v2
    v_lshl_or_b32 v18, v18, 1, v19
    v_min_u32 v18, 2, v18
    v_lshl_add_u32 v18, v18, 4, v17
    v_add_u32 v18, s65, v18
    v_bfe_u32 v19, v18, 1, 1
    v_mul_u32_u24 v19, 672, v19
    v_and_b32 v17, 1, v18
    v_lshl_add_u32 v19, v17, 1, v19
    v_and_b32 v17, 0xffc, v18
    v_add_u32 v19, v19, v17
    v_lshlrev_b32 v18, 1, v18
    v_mov_b32 v17, v229
    s_sub_u32 s65, s54, 1
    v_mov_b32 v227, s65
    s_mov_b32 exec_hi, 0
    buffer_store_dwordx4 v[224:227], v17, s[24:27], s8 offen sc1
    s_mov_b32 exec_hi, -1
    s_lshr_b32 s68, s48, 1
    s_mul_i32 s68, s68, 3328
    s_lshl2_add_u32 s68, s50, s68
    s_lshr_b32 s16, s49, 2
    s_mul_i32 s16, s16, 61440
    s_add_u32 s16, s16, 262144
    s_mov_b32 s17, 0
    s_mov_b32 s20, 16
    s_and_b32 s9, s49, 1
    s_lshl3_add_u32 s9, s9, s48
    s_cmp_eq_u32 s9, 6
    s_cselect_b32 s9, 0, 2
    v_add_u32 v228, 155904, v4
    s_lshl_b32 s65, s48, 2
    v_add_u32 v231, s65, v8
    s_mov_b64 exec, 0
    s_cmp_eq_u32 s48, 0
    s_cbranch_scc1 HF0_0
    s_cmp_eq_u32 s48, 1
    s_cbranch_scc1 HF1_0
    s_cmp_eq_u32 s48, 2
    s_cbranch_scc1 HF2_0
    s_cmp_eq_u32 s48, 3
    s_cbranch_scc1 HF3_0
    s_cmp_eq_u32 s48, 4
    s_cbranch_scc1 HF4_0
    s_cmp_eq_u32 s48, 5
    s_cbranch_scc1 HF5_0
HF_ret:
    s_mov_b64 exec, -1
    s_add_u32 m0, s52, 98304
    s_add_u32 s62, s60, 196608
    buffer_load_dwordx4 v210, s[28:31], s62 offen lds
    s_add_u32 m0, s52, 99328
    s_add_u32 s62, s60, 196608
    buffer_load_dwordx4 v211, s[28:31], s62 offen lds
    s_add_u32 m0, s52, 100352
    s_add_u32 s62, s60, 196608
    buffer_load_dwordx4 v212, s[28:31], s62 offen lds
    s_add_u32 m0, s52, 101376
    s_add_u32 s62, s60, 245760
    buffer_load_dwordx4 v210, s[28:31], s62 offen lds
    s_add_u32 m0, s52, 102400
    s_add_u32 s62, s60, 245760
    buffer_load_dwordx4 v211, s[28:31], s62 offen lds
    s_add_u32 m0, s52, 103424
    s_add_u32 s62, s60, 245760
    buffer_load_dwordx4 v212, s[28:31], s62 offen lds
    s_waitcnt vmcnt(17)
    s_barrier
    ds_read_b64_tr_b16 v[20:21], v218 offset:0
    ds_read_b64_tr_b16 v[22:23], v218 offset:768
    ds_read_b64_tr_b16 v[24:25], v218 offset:12288
    ds_read_b64_tr_b16 v[26:27], v218 offset:13056
    ds_read_b64_tr_b16 v[28:29], v218 offset:32
    ds_read_b64_tr_b16 v[30:31], v218 offset:800
    ds_read_b64_tr_b16 v[32:33], v218 offset:12320
    ds_read_b64_tr_b16 v[34:35], v218 offset:13088
    ds_read_b64_tr_b16 v[36:37], v218 offset:64
    ds_read_b64_tr_b16 v[38:39], v218 offset:832
    ds_read_b64_tr_b16 v[40:41], v218 offset:12352
    ds_read_b64_tr_b16 v[42:43], v218 offset:13120
    s_waitcnt lgkmcnt(0)
    s_barrier
    s_add_u32 m0, s52, 0
    s_add_u32 s62, s60, 294912
    buffer_load_dwordx4 v210, s[28:31], s62 offen lds
    s_add_u32 m0, s52, 1024
    s_add_u32 s62, s60, 294912
    buffer_load_dwordx4 v211, s[28:31], s62 offen lds
    s_add_u32 m0, s52, 2048
    s_add_u32 s62, s60, 294912
    buffer_load_dwordx4 v212, s[28:31], s62 offen lds
    s_add_u32 m0, s52, 3072
    s_add_u32 s62, s60, 344064
    buffer_load_dwordx4 v210, s[28:31], s62 offen lds
    s_add_u32 m0, s52, 4096
    s_add_u32 s62, s60, 344064
    buffer_load_dwordx4 v211, s[28:31], s62 offen lds
    s_add_u32 m0, s52, 5120
    s_add_u32 s62, s60, 344064
    buffer_load_dwordx4 v212, s[28:31], s62 offen lds
    v_smfmac_f32_16x16x64_bf16 v[232:235], v[220:223], v[20:27], v252
    v_smfmac_f32_16x16x64_bf16 v[236:239], v[220:223], v[28:35], v252
    v_smfmac_f32_16x16x64_bf16 v[240:243], v[220:223], v[36:43], v252
    s_waitcnt vmcnt(17)
    s_barrier
    ds_read_b64_tr_b16 v[44:45], v218 offset:49152
    ds_read_b64_tr_b16 v[46:47], v218 offset:49920
    ds_read_b64_tr_b16 v[48:49], v218 offset:61440
    ds_read_b64_tr_b16 v[50:51], v218 offset:62208
    ds_read_b64_tr_b16 v[52:53], v218 offset:49184
    ds_read_b64_tr_b16 v[54:55], v218 offset:49952
    ds_read_b64_tr_b16 v[56:57], v218 offset:61472
    ds_read_b64_tr_b16 v[58:59], v218 offset:62240
    ds_read_b64_tr_b16 v[60:61], v218 offset:49216
    ds_read_b64_tr_b16 v[62:63], v218 offset:49984
    ds_read_b64_tr_b16 v[64:65], v218 offset:61504
    ds_read_b64_tr_b16 v[66:67], v218 offset:62272
    s_waitcnt lgkmcnt(0)
    s_barrier
    s_add_u32 m0, s52, 49152
    s_add_u32 s62, s60, 393216
    buffer_load_dwordx4 v210, s[28:31], s62 offen lds
    s_add_u32 m0, s52, 50176
    s_add_u32 s62, s60, 393216
    buffer_load_dwordx4 v211, s[28:31], s62 offen lds
    s_add_u32 m0, s52, 51200
    s_add_u32 s62, s60, 393216
    buffer_load_dwordx4 v212, s[28:31], s62 offen lds
    s_add_u32 m0, s52, 52224
    s_add_u32 s62, s60, 442368
    buffer_load_dwordx4 v210, s[28:31], s62 offen lds
    s_add_u32 m0, s52, 53248
    s_add_u32 s62, s60, 442368
    buffer_load_dwordx4 v211, s[28:31], s62 offen lds
    s_add_u32 m0, s52, 54272
    s_add_u32 s62, s60, 442368
    buffer_load_dwordx4 v212, s[28:31], s62 offen lds
    v_smfmac_f32_16x16x64_bf16 v[232:235], v[220:223], v[44:51], v252
    v_smfmac_f32_16x16x64_bf16 v[236:239], v[220:223], v[52:59], v252
    v_smfmac_f32_16x16x64_bf16 v[240:243], v[220:223], v[60:67], v252
    s_waitcnt vmcnt(12)
    s_barrier
    v_add_u32 v229, 98304, v218
    ds_read_b64_tr_b16 v[68:69], v229 offset:0
    ds_read_b64_tr_b16 v[70:71], v229 offset:768
    ds_read_b64_tr_b16 v[72:73], v229 offset:12288
    ds_read_b64_tr_b16 v[74:75], v229 offset:13056
    ds_read_b64_tr_b16 v[76:77], v229 offset:32
    ds_read_b64_tr_b16 v[78:79], v229 offset:800
    ds_read_b64_tr_b16 v[80:81], v229 offset:12320
    ds_read_b64_tr_b16 v[82:83], v229 offset:13088
    ds_read_b64_tr_b16 v[84:85], v229 offset:64
    ds_read_b64_tr_b16 v[86:87], v229 offset:832
    ds_read_b64_tr_b16 v[88:89], v229 offset:12352
    ds_read_b64_tr_b16 v[90:91], v229 offset:13120
    s_waitcnt lgkmcnt(0)
    s_barrier
    s_mul_i32 s62, s49, 3
    s_add_u32 s62, s62, 0
    s_lshr_b32 s63, s62, 2
    s_cmp_eq_u32 s63, 9
    s_cselect_b32 s63, 2, 0
    s_xor_b32 s62, s62, s63
    s_mul_i32 s62, s62, 40960
    s_add_u32 s62, s62, s53
    s_add_u32 m0, s53, 98304
    s_nop 0
    buffer_load_dwordx4 v213, s[32:35], s62 offen lds
    s_add_u32 m0, s53, 99328
    s_nop 0
    buffer_load_dwordx4 v214, s[32:35], s62 offen lds
    s_add_u32 m0, s53, 100352
    s_nop 0
    buffer_load_dwordx4 v215, s[32:35], s62 offen lds
    s_add_u32 m0, s53, 101376
    s_nop 0
    buffer_load_dwordx4 v216, s[32:35], s62 offen lds
    s_add_u32 m0, s53, 102400
    s_nop 0
    buffer_load_dwordx4 v217, s[32:35], s62 offen lds
    v_smfmac_f32_16x16x64_bf16 v[232:235], v[220:223], v[68:75], v252
    v_smfmac_f32_16x16x64_bf16 v[236:239], v[220:223], v[76:83], v252
    v_smfmac_f32_16x16x64_bf16 v[240:243], v[220:223], v[84:91], v252
    v_dot2_f32_bf16 v226, v10, s67, 0
    v_dot2_f32_bf16 v226, v11, s67, v226
    v_dot2_f32_bf16 v226, v12, s67, v226
    v_dot2_f32_bf16 v226, v13, s67, v226
    v_dot2_f32_bf16 v226, v14, s67, v226
    v_dot2_f32_bf16 v226, v15, s67, v226
    s_nop 2
    v_add_f32_dpp v226, v226, v226 row_ror:1 row_mask:0xf bank_mask:0xf
    s_nop 1
    v_add_f32_dpp v226, v226, v226 row_ror:2 row_mask:0xf bank_mask:0xf
    s_nop 1
    v_add_f32_dpp v226, v226, v226 row_ror:4 row_mask:0xf bank_mask:0xf
    s_nop 1
    v_add_f32_dpp v226, v226, v226 row_ror:8 row_mask:0xf bank_mask:0xf
    v_mov_b32 v229, v226
    s_nop 1
    v_permlane32_swap_b32 v226, v229
    v_add_f32 v226, v226, v229
    v_mov_b32 v229, v226
    s_nop 1
    v_permlane16_swap_b32 v226, v229
    v_add_f32 v226, v226, v229
    s_nop 0
    v_readfirstlane_b32 s55, v226
    s_waitcnt vmcnt(11)
    s_barrier
    ds_read_b64_tr_b16 v[92:93], v218 offset:0
    ds_read_b64_tr_b16 v[94:95], v218 offset:768
    ds_read_b64_tr_b16 v[96:97], v218 offset:12288
    ds_read_b64_tr_b16 v[98:99], v218 offset:13056
    ds_read_b64_tr_b16 v[100:101], v218 offset:32
    ds_read_b64_tr_b16 v[102:103], v218 offset:800
    ds_read_b64_tr_b16 v[104:105], v218 offset:12320
    ds_read_b64_tr_b16 v[106:107], v218 offset:13088
    ds_read_b64_tr_b16 v[108:109], v218 offset:64
    ds_read_b64_tr_b16 v[110:111], v218 offset:832
    ds_read_b64_tr_b16 v[112:113], v218 offset:12352
    ds_read_b64_tr_b16 v[114:115], v218 offset:13120
    s_waitcnt lgkmcnt(0)
    s_barrier
    s_mul_i32 s62, s49, 3
    s_add_u32 s62, s62, 1
    s_lshr_b32 s63, s62, 2
    s_cmp_eq_u32 s63, 9
    s_cselect_b32 s63, 2, 0
    s_xor_b32 s62, s62, s63
    s_mul_i32 s62, s62, 40960
    s_add_u32 s62, s62, s53
    s_add_u32 m0, s53, 0
    s_nop 0
    buffer_load_dwordx4 v213, s[32:35], s62 offen lds
    s_add_u32 m0, s53, 1024
    s_nop 0
    buffer_load_dwordx4 v214, s[32:35], s62 offen lds
    s_add_u32 m0, s53, 2048
    s_nop 0
    buffer_load_dwordx4 v215, s[32:35], s62 offen lds
    s_add_u32 m0, s53, 3072
    s_nop 0
    buffer_load_dwordx4 v216, s[32:35], s62 offen lds
    s_add_u32 m0, s53, 4096
    s_nop 0
    buffer_load_dwordx4 v217, s[32:35], s62 offen lds
    v_smfmac_f32_16x16x64_bf16 v[232:235], v[220:223], v[92:99], v252
    v_smfmac_f32_16x16x64_bf16 v[236:239], v[220:223], v[100:107], v252
    v_smfmac_f32_16x16x64_bf16 v[240:243], v[220:223], v[108:115], v252
    s_waitcnt vmcnt(10)
    s_barrier
    ds_read_b64_tr_b16 v[116:117], v218 offset:49152
    ds_read_b64_tr_b16 v[118:119], v218 offset:49920
    ds_read_b64_tr_b16 v[120:121], v218 offset:61440
    ds_read_b64_tr_b16 v[122:123], v218 offset:62208
    ds_read_b64_tr_b16 v[124:125], v218 offset:49184
    ds_read_b64_tr_b16 v[126:127], v218 offset:49952
    ds_read_b64_tr_b16 v[128:129], v218 offset:61472
    ds_read_b64_tr_b16 v[130:131], v218 offset:62240
    ds_read_b64_tr_b16 v[132:133], v218 offset:49216
    ds_read_b64_tr_b16 v[134:135], v218 offset:49984
    ds_read_b64_tr_b16 v[136:137], v218 offset:61504
    ds_read_b64_tr_b16 v[138:139], v218 offset:62272
    s_waitcnt lgkmcnt(0)
    s_barrier
    s_mul_i32 s62, s49, 3
    s_add_u32 s62, s62, 2
    s_lshr_b32 s63, s62, 2
    s_cmp_eq_u32 s63, 9
    s_cselect_b32 s63, 2, 0
    s_xor_b32 s62, s62, s63
    s_mul_i32 s62, s62, 40960
    s_add_u32 s62, s62, s53
    s_add_u32 m0, s53, 49152
    s_nop 0
    buffer_load_dwordx4 v213, s[32:35], s62 offen lds
    s_add_u32 m0, s53, 50176
    s_nop 0
    buffer_load_dwordx4 v214, s[32:35], s62 offen lds
    s_add_u32 m0, s53, 51200
    s_nop 0
    buffer_load_dwordx4 v215, s[32:35], s62 offen lds
    s_add_u32 m0, s53, 52224
    s_nop 0
    buffer_load_dwordx4 v216, s[32:35], s62 offen lds
    s_add_u32 m0, s53, 53248
    s_nop 0
    buffer_load_dwordx4 v217, s[32:35], s62 offen lds
    s_cmp_eq_u32 s48, 0
    s_cselect_b32 s65, s15, 2.0
    s_mov_b64 exec, 0xffffff
    buffer_load_dwordx2 v[224:225], v7, s[24:27], s65 offen sc1
    s_mov_b64 exec, -1
    v_smfmac_f32_16x16x64_bf16 v[232:235], v[220:223], v[116:123], v252
    v_smfmac_f32_16x16x64_bf16 v[236:239], v[220:223], v[124:131], v252
    v_smfmac_f32_16x16x64_bf16 v[240:243], v[220:223], v[132:139], v252
    s_mov_b64 exec, 0xffff
    s_nop 8
    v_pk_add_f32 v[232:233], v[232:233], v[234:235]
    ds_write_b64 v230, v[232:233] offset:0
    v_pk_add_f32 v[236:237], v[236:237], v[238:239]
    ds_write_b64 v230, v[236:237] offset:128
    v_pk_add_f32 v[240:241], v[240:241], v[242:243]
    ds_write_b64 v230, v[240:241] offset:256
    s_mov_b64 exec, -1
    s_waitcnt lgkmcnt(0)
    s_waitcnt vmcnt(6)
    s_barrier
    ds_read2st64_b32 v[232:233], v228 offset0:0 offset1:3
    ds_read2st64_b32 v[234:235], v228 offset0:6 offset1:9
    ds_read_b64_tr_b16 v[140:141], v205 offset:0
    ds_read_b64_tr_b16 v[142:143], v205 offset:5120
    ds_read_b64_tr_b16 v[152:153], v206 offset:0
    ds_read_b64_tr_b16 v[154:155], v206 offset:5120
    ds_read_b64_tr_b16 v[164:165], v207 offset:0
    ds_read_b64_tr_b16 v[166:167], v207 offset:5120
    ds_read_b64_tr_b16 v[176:177], v208 offset:0
    ds_read_b64_tr_b16 v[178:179], v208 offset:5120
    ds_read_b64_tr_b16 v[188:189], v209 offset:0
    ds_read_b64_tr_b16 v[190:191], v209 offset:5120
    ds_read_b64_tr_b16 v[144:145], v200 offset:0
    ds_read_b64_tr_b16 v[146:147], v200 offset:5120
    ds_read_b64_tr_b16 v[156:157], v201 offset:0
    ds_read_b64_tr_b16 v[158:159], v201 offset:5120
    ds_read_b64_tr_b16 v[168:169], v202 offset:0
    ds_read_b64_tr_b16 v[170:171], v202 offset:5120
    ds_read_b64_tr_b16 v[180:181], v203 offset:0
    ds_read_b64_tr_b16 v[182:183], v203 offset:5120
    ds_read_b64_tr_b16 v[192:193], v204 offset:0
    ds_read_b64_tr_b16 v[194:195], v204 offset:5120
    s_waitcnt lgkmcnt(0)
    v_add_f32 v0, v232, v234
    v_add_f32 v2, v233, v235
    s_waitcnt vmcnt(1)
    s_barrier
    ds_read_b64_tr_b16 v[148:149], v200 offset:49152
    ds_read_b64_tr_b16 v[150:151], v200 offset:54272
    ds_read_b64_tr_b16 v[160:161], v201 offset:49152
    ds_read_b64_tr_b16 v[162:163], v201 offset:54272
    ds_read_b64_tr_b16 v[172:173], v202 offset:49152
    ds_read_b64_tr_b16 v[174:175], v202 offset:54272
    ds_read_b64_tr_b16 v[184:185], v203 offset:49152
    ds_read_b64_tr_b16 v[186:187], v203 offset:54272
    ds_read_b64_tr_b16 v[196:197], v204 offset:49152
    ds_read_b64_tr_b16 v[198:199], v204 offset:54272
    s_waitcnt lgkmcnt(0)
F_rdy:
HF0_0:
    s_cbranch_execz HF0_1
    s_cmp_lg_u32 s48, 0
    s_cbranch_scc1 F_wait
    s_mov_b64 exec, 0xffffff
HF0_1:
    s_cbranch_execz HF_ret
    s_branch F_pw
F_poll:
    buffer_load_dwordx2 v[224:225], v7, s[24:27], s15 offen sc1
F_pw:
    s_waitcnt vmcnt(0)
    v_cmp_ne_u32 vcc, s54, v225
    s_cbranch_vccz F_got
    s_sleep 1
    s_sub_u32 s3, s3, 1
    s_cbranch_scc0 F_poll
    s_mov_b32 s3, 0
F_got:
    s_mov_b64 exec, -1
    v_max_u32_dpp v226, v224, v224 row_ror:1 row_mask:0xf bank_mask:0xf
    s_nop 1
    v_max_u32_dpp v226, v226, v226 row_ror:2 row_mask:0xf bank_mask:0xf
    s_nop 1
    v_max_u32_dpp v226, v226, v226 row_ror:4 row_mask:0xf bank_mask:0xf
    s_nop 1
    v_max_u32_dpp v226, v226, v226 row_ror:8 row_mask:0xf bank_mask:0xf
    s_nop 0
    v_readlane_b32 s60, v226, 0
    v_readlane_b32 s62, v226, 16
    s_max_u32 s60, s60, s62
    s_max_u32 s60, s60, 1572865
    s_sub_u32 s60, s60, 1572864
F_thr:
    v_cmp_le_u32 vcc, s60, v224
    s_add_u32 s60, s60, 196608
    s_cbranch_scc1 F_thd
    s_bcnt1_i32_b32 s62, vcc_lo
    s_cmp_gt_u32 s62, 8
    s_cbranch_scc1 F_thr
F_thd:
    v_mbcnt_lo_u32_b32 v226, vcc_lo, 0
    v_cmp_gt_u32 s[62:63], 8, v226
    v_lshl_add_u32 v226, v226, 2, v8
    s_and_b64 exec, vcc, s[62:63]
    ds_write_b32 v226, v224 offset:0
    s_mov_b64 exec, -1
    s_waitcnt lgkmcnt(0)
F_wait:
    s_waitcnt vmcnt(0)
    s_barrier
    ds_read_b32 v224, v231 offset:0
    s_waitcnt lgkmcnt(0)
    v_readfirstlane_b32 s60, v224
F_redo:
    v_mov_b64 v[232:233], 0
    v_mov_b64 v[234:235], 0
    v_mov_b64 v[236:237], 0
    v_mov_b64 v[238:239], 0
    v_mov_b64 v[240:241], 0
    v_mov_b64 v[242:243], 0
HF1_0:
    s_cbranch_execz HF1_1
    s_and_b32 s61, s60, 0xfff
    s_cbranch_scc0 F_b1
    s_lshr_b32 s62, s61, 4
    s_mul_i32 s62, s62, 171
    s_lshr_b32 s62, s62, 10
    s_mul_i32 s62, s62, 2560
    s_add_u32 s62, s62, s16
    s_add_u32 s63, s54, s61
    v_mov_b64 v[228:229], 0
    v_mov_b32 v230, s63
    buffer_load_dwordx3 v[220:222], v1, s[24:27], s62 offen offset:0 sc1
    buffer_load_dwordx3 v[224:226], v1, s[24:27], s62 offen offset:1024 sc1
    s_mov_b32 exec_hi, 0
    buffer_load_dwordx3 v[228:230], v1, s[24:27], s62 offen offset:2048 sc1
    s_mov_b32 exec_hi, -1
    s_branch F_rw
F_row:
    s_mov_b64 exec, s[58:59]
    s_cbranch_execz F_r0
    buffer_load_dwordx3 v[220:222], v1, s[24:27], s62 offen offset:0 sc1
F_r0:
    s_mov_b64 exec, s[64:65]
    s_cbranch_execz F_r1
    buffer_load_dwordx3 v[224:226], v1, s[24:27], s62 offen offset:1024 sc1
F_r1:
    s_mov_b64 exec, s[10:11]
    s_cbranch_execz F_r2
    buffer_load_dwordx3 v[228:230], v1, s[24:27], s62 offen offset:2048 sc1
F_r2:
    s_mov_b64 exec, -1
F_rw:
    s_waitcnt vmcnt(0)
    ds_write2_b32 v16, v220, v221 offset0:0 offset1:168
    ds_write2_b32 v16, v224, v225 offset0:64 offset1:232
    s_mov_b32 exec_hi, 0
    ds_write_b32 v16, v228 offset:512
    ds_write_b32 v16, v229 offset:1184
    s_mov_b32 exec_hi, -1
    v_cmp_ne_u32 s[58:59], s63, v222
    v_cmp_ne_u32 s[64:65], s63, v226
    v_cmp_ne_u32 s[10:11], s63, v230
    s_or_b64 vcc, s[58:59], s[64:65]
    s_or_b64 vcc, vcc, s[10:11]
    s_cbranch_scc0 F_ok
    s_sub_u32 s20, s20, 1
    s_cbranch_scc0 F_row
F_b1:
    s_waitcnt lgkmcnt(0)
    s_barrier
    s_cmp_lg_u32 s9, s17
    s_cbranch_scc1 F_nwb
    buffer_wbl2 sc1
F_nwb:
HF1_1:
    s_cbranch_execz HF_ret
    ds_read_b128 v[200:203], v9 offset:16384
    ds_read_b128 v[204:207], v9 offset:16416
    ds_read_b128 v[208:211], v9 offset:16448
    ds_read_b128 v[212:215], v9 offset:16480
    ds_read_b128 v[216:219], v9 offset:16512
    s_waitcnt lgkmcnt(4)
    v_smfmac_f32_16x16x64_bf16 v[232:235], v[200:203], v[20:27], v252
    v_smfmac_f32_16x16x64_bf16 v[236:239], v[200:203], v[28:35], v252
    v_smfmac_f32_16x16x64_bf16 v[240:243], v[200:203], v[36:43], v252
    s_waitcnt lgkmcnt(3)
    v_smfmac_f32_16x16x64_bf16 v[232:235], v[204:207], v[44:51], v252
    v_smfmac_f32_16x16x64_bf16 v[236:239], v[204:207], v[52:59], v252
    v_smfmac_f32_16x16x64_bf16 v[240:243], v[204:207], v[60:67], v252
    s_waitcnt lgkmcnt(2)
    v_smfmac_f32_16x16x64_bf16 v[232:235], v[208:211], v[68:75], v252
    v_smfmac_f32_16x16x64_bf16 v[236:239], v[208:211], v[76:83], v252
    v_smfmac_f32_16x16x64_bf16 v[240:243], v[208:211], v[84:91], v252
    s_waitcnt lgkmcnt(1)
    v_smfmac_f32_16x16x64_bf16 v[232:235], v[212:215], v[92:99], v252
    v_smfmac_f32_16x16x64_bf16 v[236:239], v[212:215], v[100:107], v252
    v_smfmac_f32_16x16x64_bf16 v[240:243], v[212:215], v[108:115], v252
    s_waitcnt lgkmcnt(0)
    v_smfmac_f32_16x16x64_bf16 v[232:235], v[216:219], v[116:123], v252
    v_smfmac_f32_16x16x64_bf16 v[236:239], v[216:219], v[124:131], v252
    v_smfmac_f32_16x16x64_bf16 v[240:243], v[216:219], v[132:139], v252
    s_nop 8
    s_branch F_pw2
F_ok:
    v_dot2_f32_bf16 v222, v220, s67, 0
    v_dot2_f32_bf16 v223, v220, v220, 0
    v_dot2_f32_bf16 v226, v220, v10, 0
    v_dot2_f32_bf16 v222, v221, s67, v222
    v_dot2_f32_bf16 v223, v221, v221, v223
    v_dot2_f32_bf16 v226, v221, v11, v226
    v_dot2_f32_bf16 v222, v224, s67, v222
    v_dot2_f32_bf16 v223, v224, v224, v223
HF2_0:
    s_cbranch_execz HF2_1
    v_dot2_f32_bf16 v226, v224, v12, v226
    v_dot2_f32_bf16 v222, v225, s67, v222
    v_dot2_f32_bf16 v223, v225, v225, v223
    v_dot2_f32_bf16 v226, v225, v13, v226
    v_dot2_f32_bf16 v222, v228, s67, v222
    v_dot2_f32_bf16 v223, v228, v228, v223
    v_dot2_f32_bf16 v226, v228, v14, v226
    v_dot2_f32_bf16 v222, v229, s67, v222
    v_dot2_f32_bf16 v223, v229, v229, v223
    v_dot2_f32_bf16 v226, v229, v15, v226
    s_waitcnt lgkmcnt(0)
    s_barrier
    s_cmp_lg_u32 s9, s17
    s_cbranch_scc1 F_nwc
    buffer_wbl2 sc1
F_nwc:
    ds_read_b128 v[200:203], v9 offset:16384
    ds_read_b128 v[204:207], v9 offset:16416
    ds_read_b128 v[208:211], v9 offset:16448
    ds_read_b128 v[212:215], v9 offset:16480
    ds_read_b128 v[216:219], v9 offset:16512
    v_mov_b32 v227, v226
    v_permlane32_swap_b32 v222, v223
    s_nop 0
    v_permlane32_swap_b32 v226, v227
    v_add_f32 v222, v222, v223
    v_add_f32 v226, v226, v227
    v_mov_b32 v224, s68
    v_mov_b32 v223, s45
    v_permlane16_swap_b32 v222, v226
    v_add_f32 v222, v222, v226
    s_waitcnt lgkmcnt(4)
    v_smfmac_f32_16x16x64_bf16 v[232:235], v[200:203], v[20:27], v252
    v_add_f32_dpp v222, v222, v222 row_ror:1 row_mask:0xf bank_mask:0xf
    s_nop 1
    v_add_f32_dpp v222, v222, v222 row_ror:2 row_mask:0xf bank_mask:0xf
    v_smfmac_f32_16x16x64_bf16 v[236:239], v[200:203], v[28:35], v252
    s_nop 0
    v_add_f32_dpp v222, v222, v222 row_ror:4 row_mask:0xf bank_mask:0xf
    s_nop 1
    v_add_f32_dpp v222, v222, v222 row_ror:8 row_mask:0xf bank_mask:0xf
    v_smfmac_f32_16x16x64_bf16 v[240:243], v[200:203], v[36:43], v252
HF2_1:
    s_cbranch_execz HF_ret
    v_readlane_b32 s64, v222, 32
    v_readlane_b32 s65, v222, 16
    s_waitcnt lgkmcnt(3)
    v_smfmac_f32_16x16x64_bf16 v[232:235], v[204:207], v[44:51], v252
    v_mov_b32 v220, v222
    v_mov_b32 v221, s64
    v_smfmac_f32_16x16x64_bf16 v[236:239], v[204:207], v[52:59], v252
    v_mul_f32 v220, 0x3acccccd, v220
    v_mul_f32 v221, 0x3acccccd, v221
    v_smfmac_f32_16x16x64_bf16 v[240:243], v[204:207], v[60:67], v252
    v_fma_f32 v221, -v220, v220, v221
    v_max_f32 v221, 0, v221
    s_waitcnt lgkmcnt(2)
    v_smfmac_f32_16x16x64_bf16 v[232:235], v[208:211], v[68:75], v252
    v_cvt_pk_bf16_f32 v221, v221, v221
    v_and_b32 v221, 0xffff0000, v221
    v_smfmac_f32_16x16x64_bf16 v[236:239], v[208:211], v[76:83], v252
    v_add_f32 v221, 0x3727c5ac, v221
    v_cvt_pk_bf16_f32 v221, v221, v221
    v_smfmac_f32_16x16x64_bf16 v[240:243], v[208:211], v[84:91], v252
    v_and_b32 v221, 0xffff0000, v221
    v_sqrt_f32 v221, v221
    s_waitcnt lgkmcnt(1)
    v_smfmac_f32_16x16x64_bf16 v[232:235], v[212:215], v[92:99], v252
    v_cvt_pk_bf16_f32 v220, v220, v220
    v_and_b32 v220, 0xffff0000, v220
    v_smfmac_f32_16x16x64_bf16 v[236:239], v[212:215], v[100:107], v252
    v_cvt_pk_bf16_f32 v221, v221, v221
    v_and_b32 v221, 0xffff0000, v221
    v_smfmac_f32_16x16x64_bf16 v[240:243], v[212:215], v[108:115], v252
    v_rcp_f32 v221, v221
    v_mul_f32 v222, s55, v220
    s_waitcnt lgkmcnt(0)
    v_smfmac_f32_16x16x64_bf16 v[232:235], v[216:219], v[116:123], v252
    v_sub_f32 v222, s65, v222
    v_mul_f32 v222, v222, v221
    v_smfmac_f32_16x16x64_bf16 v[236:239], v[216:219], v[124:131], v252
HF3_0:
    s_cbranch_execz HF3_1
    v_ashrrev_i32 v225, 31, v222
    v_or_b32 v225, 0x80000000, v225
    v_smfmac_f32_16x16x64_bf16 v[240:243], v[216:219], v[132:139], v252
    v_xor_b32 v225, v225, v222
    v_and_b32 v225, 0xfffff000, v225
    v_or_b32 v225, s61, v225
    s_mov_b64 exec, 1
    ds_write2_b32 v224, v220, v221 offset0:0 offset1:2
    ds_write2_b32 v224, v222, v223 offset0:4 offset1:6
    ds_max_u64 v8, v[224:225] offset:32
    s_mov_b64 exec, -1
F_pw2:
    v_pk_add_f32 v[232:233], v[232:233], v[234:235]
    ds_write_b64 v3, v[232:233] offset:256
    v_pk_add_f32 v[236:237], v[236:237], v[238:239]
    ds_write_b64 v3, v[236:237] offset:384
    v_pk_add_f32 v[240:241], v[240:241], v[242:243]
    ds_write_b64 v3, v[240:241] offset:512
    s_cmp_ge_u32 s48, 2
    v_mov_b64 v[244:245], 0
    v_mov_b64 v[246:247], 0
    v_mov_b64 v[248:249], 0
    v_mov_b64 v[250:251], 0
    s_waitcnt lgkmcnt(0)
    s_barrier
    ds_read_b64 v[224:225], v8 offset:32
    v_mov_b64 v[232:233], 0
    v_mov_b64 v[234:235], 0
    v_mov_b64 v[236:237], 0
    v_mov_b64 v[238:239], 0
    v_mov_b64 v[240:241], 0
    v_mov_b64 v[242:243], 0
    s_waitcnt lgkmcnt(0)
    s_cbranch_scc1 F_gu
    v_add_u32 v227, v224, v4
    ds_read2_b32 v[228:229], v224 offset0:0 offset1:2
    ds_read2st64_b32 v[208:209], v227 offset0:1 offset1:4
    ds_read2st64_b32 v[210:211], v227 offset0:7 offset1:10
    s_waitcnt lgkmcnt(1)
    v_fma_f32 v208, -v228, v0, v208
    v_fma_f32 v209, -v228, v2, v209
    s_waitcnt lgkmcnt(0)
    v_add_f32 v208, v208, v210
    v_add_f32 v209, v209, v211
    v_mul_f32 v208, v208, v229
    v_mul_f32 v209, v209, v229
HF3_1:
    s_cbranch_execz HF_ret
    v_cvt_pk_bf16_f32 v209, v208, v209
    v_lshlrev_b32 v208, 16, v209
    v_mul_f32 v210, 0xbfb8aa3b, v208
    v_exp_f32 v210, v210
    v_and_b32 v209, s47, v209
    v_add_f32 v210, 1.0, v210
    v_rcp_f32 v210, v210
    s_mov_b32 exec_hi, 0xffff
    v_mul_f32 v208, v208, v210
    v_cvt_pk_bf16_f32 v208, v208, v208
    v_and_b32 v208, 0xffff0000, v208
    v_mul_f32 v208, v208, v209
    v_cvt_pk_bf16_f32 v208, v208, v208
    ds_write_b16 v5, v208 offset:3584
    s_mov_b64 exec, -1
    s_waitcnt lgkmcnt(0)
F_gu:
    s_barrier
    ds_read_b128 v[200:203], v6 offset:3584
    ds_read_b128 v[204:207], v6 offset:3648
    v_readfirstlane_b32 s61, v225
    v_mov_b32 v220, 0
    s_and_b32 s61, s61, 0xfff
    s_add_u32 s63, s54, s61
    v_mov_b32 v215, s63
    s_waitcnt lgkmcnt(1)
    v_smfmac_f32_16x16x64_bf16 v[232:235], v[200:203], v[140:147], v252
    v_smfmac_f32_16x16x64_bf16 v[236:239], v[200:203], v[152:159], v252
    v_smfmac_f32_16x16x64_bf16 v[240:243], v[200:203], v[164:171], v252
    v_smfmac_f32_16x16x64_bf16 v[244:247], v[200:203], v[176:183], v252
    v_smfmac_f32_16x16x64_bf16 v[248:251], v[200:203], v[188:195], v252
    s_cmp_lg_u32 s48, 7
    s_cbranch_scc1 F_n7
    s_mov_b64 exec, 0xffffff
    buffer_load_dwordx2 v[220:221], v7, s[24:27], s70 offen sc1
    s_mov_b64 exec, -1
F_n7:
    s_waitcnt lgkmcnt(0)
    v_smfmac_f32_16x16x64_bf16 v[232:235], v[204:207], v[144:151], v252
    v_smfmac_f32_16x16x64_bf16 v[236:239], v[204:207], v[156:163], v252
    v_smfmac_f32_16x16x64_bf16 v[240:243], v[204:207], v[168:175], v252
    v_smfmac_f32_16x16x64_bf16 v[244:247], v[204:207], v[180:187], v252
    v_smfmac_f32_16x16x64_bf16 v[248:251], v[204:207], v[192:199], v252
HF4_0:
    s_cbranch_execz HF4_1
    s_nop 7
    v_add_f32 v212, v232, v234
    v_add_f32 v213, v236, v238
    v_add_f32 v214, v240, v242
    s_mov_b32 exec_lo, s47
    v_add_f32 v212, v244, v246
    v_add_f32 v213, v248, v250
    s_mov_b32 exec_lo, -1
    s_mov_b32 exec_hi, 0
    buffer_store_dwordx4 v[212:215], v17, s[24:27], s8 offen sc1
    s_mov_b32 exec_hi, -1
    s_cmp_lt_u32 s44, 2
    s_cbranch_scc0 F_rest
    ds_read2_b32 v[228:229], v224 offset0:0 offset1:2
    ds_read2_b32 v[230:231], v224 offset0:4 offset1:6
    s_lshr_b32 s65, s61, 4
    s_mul_i32 s65, s65, 171
    s_lshr_b32 s65, s65, 10
    s_mul_i32 s64, s65, 2560
    s_add_u32 s64, s64, 131072
    s_mul_i32 s71, s65, 96
    s_sub_u32 s66, s61, s71
    s_lshr_b32 s71, s65, 1
    s_mul_i32 s71, s71, 86
    s_add_u32 s66, s66, s71
    s_sub_u32 s66, s66, 10
    s_lshl_b32 s66, s66, 1
    s_and_b32 s65, s65, 1
    s_add_u32 s66, s66, s65
    s_mul_i32 s66, s66, 1280
    v_lshrrev_b32 v223, 3, v18
    v_lshlrev_b32 v223, 4, v223
    s_waitcnt lgkmcnt(0)
    v_add_u32 v226, v231, v19
    v_and_b32 v226, 0xfffe, v226
    ds_read_u16 v226, v226
    v_cvt_pk_bf16_f32 v231, v230, v230
    v_and_b32 v231, 0xffff0000, v231
    v_mul_f32 v231, 0xbfb8aa3b, v231
    v_exp_f32 v231, v231
    s_nop 0
    v_add_f32 v231, 1.0, v231
    v_rcp_f32 v231, v231
    s_waitcnt lgkmcnt(0)
    v_lshlrev_b32 v226, 16, v226
    v_cvt_pk_bf16_f32 v231, v231, v231
    v_and_b32 v231, 0xffff0000, v231
HF4_1:
    s_cbranch_execz HF_ret
    v_sub_f32 v227, v226, v228
    v_cvt_pk_bf16_f32 v227, v227, v227
    v_and_b32 v227, 0xffff0000, v227
    v_mul_f32 v227, v227, v229
    v_cvt_pk_bf16_f32 v227, v227, v227
    v_and_b32 v227, 0xffff0000, v227
    s_waitcnt vmcnt(0)
F_yp:
    buffer_load_dwordx4 v[200:203], v1, s[24:27], s14 offen sc1
    buffer_load_dwordx4 v[204:207], v1, s[24:27], s14 offen offset:1024 sc1
    s_mov_b64 exec, s[18:19]
    buffer_load_dword v222, v223, s[24:27], s64 offen offset:8 sc1
    s_mov_b64 exec, -1
    s_waitcnt vmcnt(1)
    ds_read_b32 v224, v8 offset:40
    v_cmp_ne_u32 vcc, s63, v203
    v_cmp_ne_u32 s[58:59], s63, v207
    v_add_f32 v200, v200, v204
    v_add_f32 v201, v201, v205
    v_add_f32 v202, v202, v206
    s_or_b64 vcc, vcc, s[58:59]
    s_cbranch_scc1 F_chk
    v_mov_b32 v203, v202
    v_permlane32_swap_b32 v200, v201
    s_nop 0
    v_permlane32_swap_b32 v202, v203
    v_add_f32 v200, v200, v201
    v_add_f32 v202, v202, v203
    s_nop 1
    v_permlane16_swap_b32 v200, v202
    v_add_f32 v200, v200, v202
    s_nop 1
    v_add_f32_dpp v200, v200, v200 row_ror:8 row_mask:0xf bank_mask:0xf
    v_cvt_pk_bf16_f32 v200, v200, v200
    v_and_b32 v200, 0xffff0000, v200
    v_mul_f32 v200, v200, v231
    v_cvt_pk_bf16_f32 v200, v200, v200
    v_and_b32 v200, 0xffff0000, v200
    v_add_f32 v200, v200, v227
    v_cvt_pk_bf16_f32 v200, v200, v200
    v_and_b32 v200, 0xffff0000, v200
    v_add_f32 v200, v200, v226
    v_cvt_pk_bf16_f32 v200, v200, v200
F_vf:
    s_mov_b64 exec, s[18:19]
    s_waitcnt vmcnt(0) lgkmcnt(0)
    v_readfirstlane_b32 s60, v224
    v_cmp_ne_u32 vcc, s63, v222
HF5_0:
    s_cbranch_execz HF5_1
    s_and_b32 s62, s60, 0xfff
    s_cmp_lg_u32 s62, s61
    s_cbranch_scc1 F_vw
    s_cbranch_vccnz F_vl
    buffer_store_short v200, v18, s[40:43], s66 offen
    s_or_b32 s65, s49, s44
    s_cbranch_scc1 L_fin
    s_mov_b64 exec, 1
    v_mov_b32 v9, 0
    v_mov_b32 v10, s54
    buffer_store_dword v10, v9, s[24:27], 0 offen
    s_branch L_fin
F_vw:
    s_cmp_lg_u32 s62, 0
    s_cbranch_scc1 F_vx
    s_cbranch_vccz F_vn
F_vl:
    buffer_load_dword v222, v223, s[24:27], s64 offen offset:8 sc1
F_vn:
    ds_read_b32 v224, v8 offset:40
    s_sub_u32 s3, s3, 1
    s_cbranch_scc0 F_vf
    s_mov_b32 s3, 0
    s_branch L_fin
F_vx:
    s_cmp_eq_u32 s17, 0
    s_cbranch_scc1 F_again
    s_branch L_fin
F_chk:
    s_waitcnt lgkmcnt(0)
    v_readfirstlane_b32 s60, v224
    s_and_b32 s62, s60, 0xfff
    s_cselect_b32 s62, s62, s61
    s_cmp_lg_u32 s62, s61
    s_cbranch_scc1 F_vx
    s_sub_u32 s3, s3, 1
    s_cbranch_scc0 F_yp
    s_mov_b32 s3, 0
    s_branch L_fin
F_rest:
    s_cmp_lg_u32 s17, 0
    s_cbranch_scc1 L_fin
    s_cmp_lg_u32 s48, 7
    s_cbranch_scc1 F_tw
    s_mov_b64 exec, 0xffffff
    s_waitcnt vmcnt(1)
    s_branch F_tc
F_tp:
    buffer_load_dwordx2 v[220:221], v7, s[24:27], s70 offen sc1
    s_waitcnt vmcnt(0)
F_tc:
    v_cmp_ne_u32 vcc, s54, v221
    s_cbranch_vccz F_tg
    s_sub_u32 s3, s3, 1
    s_cbranch_scc0 F_tp
    s_mov_b32 s3, 0
F_tg:
    s_mov_b64 exec, -1
    v_max_u32_dpp v222, v220, v220 row_ror:1 row_mask:0xf bank_mask:0xf
    s_nop 1
    v_max_u32_dpp v222, v222, v222 row_ror:2 row_mask:0xf bank_mask:0xf
    s_nop 1
HF5_1:
    s_cbranch_execz HF_ret
    v_max_u32_dpp v222, v222, v222 row_ror:4 row_mask:0xf bank_mask:0xf
    s_nop 1
    v_max_u32_dpp v222, v222, v222 row_ror:8 row_mask:0xf bank_mask:0xf
    s_nop 0
    v_readlane_b32 s60, v222, 0
    v_readlane_b32 s62, v222, 16
    s_max_u32 s60, s60, s62
    s_and_b32 s62, s60, 0xfff
    s_cselect_b32 s60, s60, 1
    v_mov_b32 v220, s60
    ds_write_b32 v8, v220 offset:40
F_tw:
    ds_read_b32 v224, v8 offset:40
    s_waitcnt lgkmcnt(0)
    v_readfirstlane_b32 s60, v224
    s_and_b32 s62, s60, 0xfff
    s_cbranch_scc1 F_tk
    s_sleep 2
    s_sub_u32 s3, s3, 1
    s_cbranch_scc0 F_tw
    s_mov_b32 s3, 0
    s_branch L_fin
F_tk:
    s_cmp_eq_u32 s62, s61
    s_cbranch_scc1 L_fin
F_again:
    s_mov_b64 exec, -1
    s_waitcnt vmcnt(0)
    s_mov_b32 s17, 1
    s_mov_b32 s16, 131072
    s_mov_b32 s20, 0x40000
    v_mov_b64 v[224:225], 0
    s_cmp_eq_u32 s48, 0
    s_cselect_b32 s60, s60, 0
    s_cbranch_scc0 F_redo
    ds_write_b64 v8, v[224:225] offset:32
    s_branch F_redo
L_last:
.section .rodata,"a"
.p2align 6
.amdhsa_kernel sequential_preLN__sliding_local_dilated__moe_arch_mod__prompt_kernel
  .amdhsa_next_free_vgpr 256
  .amdhsa_next_free_sgpr 102
  .amdhsa_accum_offset 256
  .amdhsa_group_segment_fixed_size 0
  .amdhsa_kernarg_size 88
  .amdhsa_user_sgpr_count 2
  .amdhsa_user_sgpr_kernarg_segment_ptr 1
  .amdhsa_system_sgpr_workgroup_id_x 1
  .amdhsa_float_denorm_mode_32 3
  .amdhsa_float_denorm_mode_16_64 3
.end_amdhsa_kernel
```

```asm
; @launch grid=(256,1,1) block=(512,1,1) lds=163840
.amdgcn_target "amdgcn-amd-amdhsa--gfx950"
.text
.globl sequential_preLN__sliding_local_dilated__moe_arch_mod__prompt_kernel
.p2align 8
.type sequential_preLN__sliding_local_dilated__moe_arch_mod__prompt_kernel,@function
sequential_preLN__sliding_local_dilated__moe_arch_mod__prompt_kernel:
    s_load_dwordx2 s[28:29], s[0:1], 0
    s_load_dwordx2 s[32:33], s[0:1], 8
    v_readfirstlane_b32 s48, v0
    s_load_dwordx2 s[24:25], s[0:1], 80
    s_load_dwordx2 s[36:37], s[0:1], 16
    s_load_dwordx2 s[40:41], s[0:1], 64
    s_load_dwordx8 s[12:19], s[0:1], 32
    s_lshr_b32 s56, s2, 3
    s_lshr_b32 s48, s48, 6
    s_cmp_ge_u32 s2, 240
    s_cbranch_scc1 F_pre
    s_mul_i32 s51, s56, 86
    s_lshr_b32 s51, s51, 8
    s_and_b32 s66, s2, 7
    s_sub_u32 s53, s66, s51
    s_mul_i32 s53, s53, 3
    s_add_u32 s53, s53, s56
    s_lshr_b32 s55, s53, 1
    s_and_b32 s50, s53, 1
    s_mul_i32 s55, s55, 86
    s_sub_u32 s55, s55, 10
    s_mov_b32 s30, 2621440
    s_mov_b32 s31, 0x00020000
    s_sub_u32 s60, s48, 4
    s_cbranch_scc1 C_pre
    s_lshl_b32 s62, s60, 2
    s_and_b32 s62, s62, 4
    v_bfe_u32 v1, v0, 3, 3
    v_bfe_u32 v2, v0, 4, 2
    v_bitop3_b32 v3, v0, 7, s62 bitop3:0x6a
    s_mul_i32 s62, s60, 24
    s_add_u32 s62, s62, s55
    s_lshl1_add_u32 s62, s62, s50
    s_mul_i32 s62, s62, 1280
    v_xor_b32 v4, v3, v2
    v_mul_u32_u24 v5, 2560, v1
    v_lshl_add_u32 v4, v4, 4, s62
    s_movk_i32 s63, 20480
    v_add_u32 v10, v4, v5
    v_bitop3_b32 v6, v1, 2, v3 bitop3:0x6a
    v_xad_u32 v11, v10, 64, s63
    v_add_u32 v12, 40960, v10
    s_mul_i32 s62, s60, 30720
    s_lshl_b32 s63, s51, 7
    s_add_u32 s62, s62, s63
    v_mul_u32_u24 v5, 3840, v1
    v_lshl_add_u32 v6, v6, 4, s62
    s_mov_b32 s71, s51
    v_add_u32 v13, v5, v6
    s_mul_i32 s65, s60, 3072
    v_add_u32 v14, 256, v13
    v_add_u32 v15, 512, v13
    s_mov_b32 s34, 2457600
    s_mov_b32 s35, 0x00020000
    s_mov_b32 s64, s65
    s_add_u32 s70, s65, 110592
    s_mov_b32 s63, 0
    s_waitcnt lgkmcnt(0)
    s_call_b64 s[98:99], LD_issue
    s_branch LD_cont
LD_issue:
    s_cmp_ge_u32 s66, s71
    s_addc_u32 s68, s66, 0
    s_mov_b32 m0, s65
    s_lshl_b32 s67, s68, 7
    buffer_load_dwordx4 v10, s[28:31], s67 offen lds
    s_add_u32 m0, s65, 1024
    s_mul_i32 s68, s68, 245760
    buffer_load_dwordx4 v11, s[28:31], s67 offen lds
    s_add_u32 m0, s65, 2048
    s_add_u32 s69, s68, 122880
    buffer_load_dwordx4 v12, s[28:31], s67 offen lds
    s_add_u32 m0, s65, 12288
    s_and_b32 s61, s63, 15
    s_lshr_b32 s63, s63, 4
    s_add_u32 s66, s66, s61
    buffer_load_dwordx4 v13, s[32:35], s68 offen offset:0 lds
    buffer_load_dwordx4 v14, s[32:35], s68 offen offset:1024 lds
    buffer_load_dwordx4 v15, s[32:35], s68 offen offset:2048 lds
    s_add_u32 m0, s65, 24576
    s_sub_u32 s61, s66, 9
    s_cselect_b32 s66, s66, s61
    buffer_load_dwordx4 v13, s[32:35], s69 offen offset:0 lds
    buffer_load_dwordx4 v14, s[32:35], s69 offen offset:1024 lds
    buffer_load_dwordx4 v15, s[32:35], s69 offen offset:2048 lds
    s_add_u32 s65, s65, 36864
    s_cmp_eq_u32 s65, s70
    s_cselect_b32 s65, s64, s65
    s_setpc_b64 s[98:99]
F_pre:
    s_cmp_ge_u32 s2, 256
    s_cbranch_scc1 L_end
    s_getpc_b64 s[58:59]
P_main:
    v_lshlrev_b32 v2, 7, v0
    v_cmp_gt_u32 vcc, L_last-P_main, v2
    s_nop 1
    v_cndmask_b32 v2, 0, v2, vcc
    global_load_dword v219, v2, s[58:59]
    s_branch F_start
C_pre:
    v_and_b32 v0, 63, v0
    s_mov_b32 s3, 0x40000
    s_mov_b32 s47, 0xffff0000
    s_mov_b32 s26, 7340032
    s_mov_b32 s27, 0x00020000
    s_mov_b32 s38, 819200
    s_mov_b32 s39, 0x00020000
    s_mov_b32 s42, 2621440
    s_mov_b32 s43, 0x00020000
    s_sub_u32 s52, s51, 5
    s_cselect_b32 s52, s51, s52
    v_and_b32 v1, 15, v0
    v_lshrrev_b32 v2, 4, v0
    s_mov_b32 s64, 0x21698350
    s_movk_i32 s65, 0x74
    s_lshl_b32 s62, s51, 2
    s_lshr_b64 s[64:65], s[64:65], s62
    s_and_b32 s64, s64, 15
    s_mul_i32 s60, s64, 12
    s_lshl_b32 s61, s48, 2
    s_add_u32 s60, s60, s61
    v_add_u32 v10, s60, v2
    v_add_u32 v11, s55, v10
    v_cmp_gt_i32 vcc, 0, v11
    v_lshl_add_u32 v11, v11, 1, s50
    v_mul_u32_u24 v11, 1280, v11
    v_lshl_add_u32 v11, v1, 4, v11
    v_cndmask_b32 v11, v11, 2.0, vcc
    s_mov_b32 s34, 1280
    s_mov_b32 s35, 0x00020000
    s_lshl_b32 s62, s53, 1
    s_add_u32 s62, s62, s64
    s_mul_i32 s62, s62, 4
    s_add_u32 s62, s62, s61
    s_sub_u32 s62, s62, 32
    s_cmp_lt_u32 s48, 1
    s_cselect_b32 s62, s62, 640
    s_mul_i32 s63, s64, 24
    s_add_u32 s63, s63, s53
    s_add_u32 s63, s63, 192
    s_cmp_lt_u32 s64, 8
    s_cselect_b32 s65, 3, 0
    s_cselect_b32 s62, s63, s62
    s_cselect_b32 s63, 192, 1
    v_lshlrev_b32 v58, 4, v0
    v_lshlrev_b32 v59, 2, v0
    s_waitcnt lgkmcnt(0)
    s_buffer_load_dword s54, s[24:27], 0
    s_mov_b64 s[32:33], s[12:13]
    s_cmp_lt_u32 s48, s65
    s_cbranch_scc0 A_nors
    buffer_load_dwordx4 v[20:23], v11, s[28:31], 0 offen offset:0
    buffer_load_dwordx4 v[24:27], v11, s[28:31], 0 offen offset:256
    buffer_load_dwordx4 v[28:31], v11, s[28:31], 0 offen offset:512
    buffer_load_dwordx4 v[32:35], v11, s[28:31], 0 offen offset:768
    buffer_load_dwordx4 v[36:39], v11, s[28:31], 0 offen offset:1024
    s_branch A_cons
A_nors:
    s_cmp_lg_u32 s48, 3
    s_cbranch_scc1 A_nowr
    buffer_load_dwordx4 v[48:51], v58, s[32:35], 0 offen
    buffer_load_dword v52, v59, s[32:35], 0 offen offset:1024
A_nowr:
    s_cmp_ge_u32 s62, 640
    s_cbranch_scc1 A_cons
    v_mul_u32_u24 v10, s63, v2
    v_add_u32 v10, s62, v10
    v_lshlrev_b32 v12, 4, v1
    v_mul_u32_u24 v11, 1280, v10
    v_add_u32 v11, v11, v12
    buffer_load_dwordx4 v[76:79], v12, s[32:35], 0 offen offset:0
    buffer_load_dwordx4 v[80:83], v12, s[32:35], 0 offen offset:256
    buffer_load_dwordx4 v[84:87], v12, s[32:35], 0 offen offset:512
    buffer_load_dwordx4 v[88:91], v12, s[32:35], 0 offen offset:768
    buffer_load_dwordx4 v[92:95], v12, s[32:35], 0 offen offset:1024
    buffer_load_dwordx4 v[20:23], v11, s[36:39], 0 offen offset:0
    buffer_load_dwordx4 v[24:27], v11, s[36:39], 0 offen offset:256
    buffer_load_dwordx4 v[28:31], v11, s[36:39], 0 offen offset:512
    buffer_load_dwordx4 v[32:35], v11, s[36:39], 0 offen offset:768
    buffer_load_dwordx4 v[36:39], v11, s[36:39], 0 offen offset:1024
A_cons:
    v_mov_b32 v99, 2.0
    v_lshrrev_b32 v3, 1, v1
    v_xor_b32 v3, v3, v2
    v_lshlrev_b32 v3, 4, v3
    v_lshl_add_u32 v4, v1, 7, v3
    v_xor_b32 v5, 64, v4
    v_cmp_eq_u32 vcc, 0, v1
    v_mov_b32 v3, 159744
    s_nop 0
    v_cndmask_b32 v6, v4, v3, vcc
    v_cndmask_b32 v7, v5, v3, vcc
    v_cndmask_b32 v8, 1, 0, vcc
    v_bfe_u32 v14, v0, 2, 2
    v_and_b32 v15, 3, v0
    v_lshrrev_b32 v16, 1, v14
    v_and_b32 v17, 1, v2
    v_lshl_or_b32 v16, v17, 1, v16
    v_xor_b32 v16, s48, v16
    v_lshlrev_b32 v16, 5, v16
    v_lshl_add_u32 v16, v15, 3, v16
    v_lshl_add_u32 v16, v14, 7, v16
    v_mul_u32_u24 v17, 3072, v2
    v_add_u32 v9, v16, v17
    v_mov_b32 v16, 0x3f803f80
    v_mov_b32 v17, v16
    v_mov_b32 v18, v16
    v_mov_b32 v19, v16
    ds_write_b128 v3, v[16:19]
    v_mov_b64 v[100:101], 0
    v_mov_b64 v[102:103], 0
    v_mov_b64 v[104:105], 0
    v_mov_b64 v[106:107], 0
    v_mov_b64 v[108:109], 0
    v_mov_b64 v[110:111], 0
    v_mov_b64 v[112:113], 0
    v_mov_b64 v[114:115], 0
    v_mov_b64 v[116:117], 0
    v_mov_b64 v[118:119], 0
    v_mov_b64 v[120:121], 0
    v_mov_b64 v[122:123], 0
    v_mov_b64 v[124:125], 0
    v_mov_b64 v[126:127], 0
    v_mov_b64 v[128:129], 0
    v_mov_b64 v[130:131], 0
    v_mov_b64 v[132:133], 0
    v_mov_b64 v[134:135], 0
    v_mov_b64 v[136:137], 0
    v_mov_b64 v[138:139], 0
    v_mov_b64 v[140:141], 0
    v_mov_b64 v[142:143], 0
    v_mov_b64 v[144:145], 0
    v_mov_b64 v[146:147], 0
    v_mov_b64 v[148:149], 0
    v_mov_b64 v[150:151], 0
    v_mov_b64 v[152:153], 0
    v_mov_b64 v[154:155], 0
    v_mov_b64 v[156:157], 0
    v_mov_b64 v[158:159], 0
    v_mov_b64 v[160:161], 0
    v_mov_b64 v[162:163], 0
    v_mov_b64 v[164:165], 0
    v_mov_b64 v[166:167], 0
    v_mov_b64 v[168:169], 0
    v_mov_b64 v[170:171], 0
    s_call_b64 s[98:99], S_late
    s_call_b64 s[98:99], S_late2
    s_call_b64 s[98:99], S_late3
    s_call_b64 s[98:99], S_late4
    s_branch A_c2
S_late:
    v_and_b32 v200, 15, v0
    v_lshrrev_b32 v201, 4, v0
    v_lshlrev_b32 v202, 4, v0
    v_lshlrev_b32 v203, 2, v0
    v_lshrrev_b32 v64, 5, v0
    v_and_b32 v65, 12, v200
    s_lshl_b32 s4, s52, 3
    s_sub_u32 s4, 96768, s4
    s_min_u32 s5, s48, 5
    s_lshl_b32 s6, s5, 4
    v_add_u32 v67, s6, v200
    v_mul_u32_u24 v68, 400, v67
    v_mad_u32_u24 v66, v201, 40, s4
    v_add_u32 v71, v68, v66
    v_subrev_u32 v205, 3072, v71
    v_mul_u32_u24 v72, 5, v201
    v_subrev_u32 v72, s52, v72
    v_mov_b32 v73, 159776
    v_add_u32 v74, 0, v72
    v_cmp_gt_u32 vcc, 16, v74
    v_add_u32 v74, 0, v71
    s_nop 0
    v_cndmask_b32 v204, v73, v74, vcc
    v_add_u32 v74, 1, v72
    v_cmp_gt_u32 vcc, 16, v74
    v_add_u32 v74, 8, v71
    s_nop 0
    v_cndmask_b32 v229, v73, v74, vcc
    v_add_u32 v74, 2, v72
    v_cmp_gt_u32 vcc, 16, v74
    v_add_u32 v74, 16, v71
    s_nop 0
    v_cndmask_b32 v230, v73, v74, vcc
    v_add_u32 v74, 3, v72
    v_cmp_gt_u32 vcc, 16, v74
    v_add_u32 v74, 24, v71
    s_nop 0
    v_cndmask_b32 v231, v73, v74, vcc
    v_add_u32 v74, 4, v72
    v_cmp_gt_u32 vcc, 16, v74
    v_add_u32 v74, 32, v71
    s_nop 0
    v_cndmask_b32 v255, v73, v74, vcc
    v_lshlrev_b32 v208, 3, v67
    v_add_u32 v208, 159808, v208
    v_add_u32 v69, s6, v65
    v_lshlrev_b32 v209, 3, v69
    v_add_u32 v209, 159748, v209
    v_and_b32 v70, 3, v0
    v_cmp_gt_u32 vcc, 1, v70
    v_mov_b32 v73, s47
    s_nop 0
    v_cndmask_b32 v207, 0, v73, vcc
    v_cmp_gt_u32 vcc, 3, v70
    s_nop 1
    v_cndmask_b32 v211, 0, v73, vcc
    v_cmp_gt_u32 vcc, 2, v70
    s_nop 1
    v_cndmask_b32 v211, v211, -1, vcc
    s_setpc_b64 s[98:99]
S_late2:
    s_lshl_b32 s7, s5, 12
    s_add_u32 s7, s7, 135184
    v_lshl_add_u32 v66, v0, 6, s7
    v_lshl_add_u32 v210, v65, 1, v66
    s_add_u32 s13, s6, s55
    v_add_u32 v212, s13, v65
    s_mul_i32 s8, s53, 6
    s_mul_i32 s9, s8, 24320
    s_add_u32 s9, s9, 1310720
    s_mul_i32 s0, s48, 24320
    s_add_u32 s0, s0, s9
    v_lshlrev_b32 v206, 4, v200
    v_lshl_add_u32 v206, v64, 8, v206
    v_xor_b32 v213, 256, v206
    v_lshl_add_u32 v213, v64, 12, v213
    s_cmp_lg_u32 s52, 0
    s_cselect_b32 s20, 0x0000ffff, 0
    s_cmp_lg_u32 s52, 4
    s_cselect_b32 s21, s47, 0
    s_cmp_eq_u32 s48, 0
    s_cselect_b32 s7, 0xff00ff00, -1
    s_and_b32 s20, s20, s7
    s_and_b32 s21, s21, s7
    s_lshl_b32 s7, s51, 11
    s_add_u32 s22, s0, s7
    s_sub_u32 s12, s22, 2048
    s_add_u32 s100, s9, 23040
    s_lshr_b32 s7, s51, 1
    s_mul_i32 s7, s7, 23552
    s_mul_i32 s57, s51, 384
    s_add_u32 s7, s7, s57
    s_add_u32 s7, s7, 23552
    s_add_u32 s57, s7, s9
    s_mul_i32 s7, s48, 10
    s_add_u32 s7, s7, s51
    s_lshl_b32 s7, s7, 2
    s_add_u32 s23, s100, s7
    s_sub_u32 s56, s48, 2
    s_cmp_lt_u32 s48, 6
    s_cselect_b32 s101, 0, 1
    s_cselect_b32 s56, s48, s56
    s_mul_i32 s1, s56, 24320
    s_add_u32 s1, s1, s9
    s_add_u32 s8, s8, s56
    s_mul_i32 s44, s53, 2560
    s_lshl_b32 s7, s51, 8
    s_add_u32 s44, s44, s7
    s_add_u32 s44, s44, 262144
    s_lshl_b32 s45, s53, 6
    s_add_u32 s45, s45, 196608
    s_setpc_b64 s[98:99]
S_late3:
    v_bfe_u32 v68, v0, 2, 2
    v_and_b32 v69, 3, v0
    v_lshl_add_u32 v70, v201, 3, v68
    s_lshl_b32 s7, s48, 4
    s_sub_u32 s7, s7, 16
    v_add_u32 v71, s7, v70
    v_and_b32 v72, 15, v71
    v_max_i32 v71, v71, v72
    v_mul_u32_u24 v71, 400, v71
    v_lshl_add_u32 v71, v69, 3, v71
    v_add_u32 v214, 97024, v71
    v_and_b32 v72, 1, v201
    s_cmp_eq_u32 s48, 0
    s_cselect_b32 s7, 8, 0
    v_cmp_gt_u32 vcc, s7, v200
    s_nop 1
    v_cndmask_b32 v249, v202, 2.0, vcc
    v_lshrrev_b32 v71, 1, v68
    v_lshl_or_b32 v71, v72, 1, v71
    v_lshl_add_u32 v70, v201, 2, v68
    v_lshlrev_b32 v70, 7, v70
    v_lshl_add_u32 v70, v69, 3, v70
    s_mul_i32 s7, s101, 40960
    s_add_u32 s7, s7, 12288
    v_add_u32 v70, s7, v70
    s_mul_i32 s7, s101, 36864
    s_sub_u32 s7, 40960, s7
    v_xor_b32 v73, 0, v71
    v_lshl_add_u32 v216, v73, 5, v70
    v_add_u32 v220, s7, v216
    v_xor_b32 v73, 1, v71
    v_lshl_add_u32 v217, v73, 5, v70
    v_add_u32 v221, s7, v217
    v_xor_b32 v73, 2, v71
    v_lshl_add_u32 v218, v73, 5, v70
    v_add_u32 v222, s7, v218
    v_xor_b32 v73, 3, v71
    v_lshl_add_u32 v219, v73, 5, v70
    v_add_u32 v223, s7, v219
    s_setpc_b64 s[98:99]
S_late4:
    s_lshl_b32 s7, s56, 4
    v_add_u32 v73, s7, v200
    v_cmp_gt_u32 vcc, 10, v73
    v_add_u32 v73, s55, v73
    v_lshl_add_u32 v73, v73, 1, s50
    v_mul_u32_u24 v74, 1280, v73
    s_lshl_b32 s7, s51, 7
    v_lshl_add_u32 v75, v201, 3, s7
    v_add_u32 v74, v74, v75
    v_cndmask_b32 v253, v74, 2.0, vcc
    v_cndmask_b32 v254, v73, -1, vcc
    v_add_u32 v227, 161792, v75
    v_mul_u32_u24 v224, 61440, v201
    v_lshl_add_u32 v224, v200, 4, v224
    s_mov_b32 s7, 161024
    v_lshl_add_u32 v228, v201, 5, s7
    v_lshl_add_u32 v252, v69, 5, s7
    v_lshl_add_u32 v252, v68, 3, v252
    v_mul_u32_u24 v225, 24, v72
    v_add_u32 v225, v225, v253
    v_lshl_add_u32 v226, s8, 4, v200
    s_cmp_eq_u32 s101, 1
    s_cselect_b64 vcc, -1, 0
    v_lshrrev_b32 v73, 1, v200
    v_lshrrev_b32 v74, 1, v201
    v_xor_b32 v73, v73, v74
    v_lshlrev_b32 v73, 4, v73
    v_lshl_add_u32 v73, v72, 3, v73
    v_lshl_add_u32 v73, v200, 7, v73
    v_lshl_add_u32 v250, s56, 11, v73
    v_mov_b32 v251, 160784
    s_add_u32 s7, s52, 5
    s_cmp_lt_u32 s51, 5
    s_cselect_b32 s7, s7, s52
    s_lshl_b32 s7, s7, 11
    s_add_u32 s16, s7, s1
    s_lshl_b32 s7, s51, 11
    s_add_u32 s14, s7, s1
    s_add_u32 s15, s1, 20480
    s_cmp_eq_u32 s101, 1
    s_cselect_b32 s14, s16, s14
    s_cselect_b32 s18, 0x3e0, 62
    s_lshl_b32 s7, s101, 10
    s_add_u32 s16, s16, s7
    s_cmp_lt_u32 s48, 4
    s_cselect_b32 s18, 0x3fe, s18
    s_lshl_b32 s18, s18, s51
    s_lshr_b32 s7, s18, 10
    s_or_b32 s18, s18, s7
    s_and_b32 s18, s18, 0x3ff
    s_mov_b32 s19, 0
    s_mul_i32 s17, s56, 40
    s_add_u32 s17, s17, s100
    s_lshl_b32 s7, s48, 12
    s_add_u32 s7, s7, 135168
    v_lshl_add_u32 v73, v200, 6, s7
    v_lshl_add_u32 v73, v201, 4, v73
    v_add_u32 v74, s52, v201
    s_add_u32 s69, s52, 0
    s_mul_i32 s69, s69, 52
    s_lshr_b32 s69, s69, 8
    v_lshl_add_u32 v172, s69, 10, v73
    s_add_u32 s69, s52, 3
    s_mul_i32 s69, s69, 52
    s_lshr_b32 s69, s69, 8
    v_lshl_add_u32 v173, s69, 10, v73
    s_mul_i32 s69, s69, 5
    s_sub_u32 s69, s69, 0
    v_cmp_le_i32 s[4:5], s69, v74
    s_add_u32 s69, s52, 4
    s_mul_i32 s69, s69, 52
    s_lshr_b32 s69, s69, 8
    v_lshl_add_u32 v174, s69, 10, v73
    s_add_u32 s69, s52, 7
    s_mul_i32 s69, s69, 52
    s_lshr_b32 s69, s69, 8
    v_lshl_add_u32 v175, s69, 10, v73
    s_mul_i32 s69, s69, 5
    s_sub_u32 s69, s69, 4
    v_cmp_le_i32 s[6:7], s69, v74
    s_add_u32 s69, s52, 8
    s_mul_i32 s69, s69, 52
    s_lshr_b32 s69, s69, 8
    v_lshl_add_u32 v176, s69, 10, v73
    s_add_u32 s69, s52, 11
    s_mul_i32 s69, s69, 52
    s_lshr_b32 s69, s69, 8
    v_lshl_add_u32 v177, s69, 10, v73
    s_mul_i32 s69, s69, 5
    s_sub_u32 s69, s69, 8
    v_cmp_le_i32 s[8:9], s69, v74
    s_add_u32 s69, s52, 12
    s_mul_i32 s69, s69, 52
    s_lshr_b32 s69, s69, 8
    v_lshl_add_u32 v178, s69, 10, v73
    s_add_u32 s69, s52, 15
    s_mul_i32 s69, s69, 52
    s_lshr_b32 s69, s69, 8
    v_lshl_add_u32 v179, s69, 10, v73
    s_mul_i32 s69, s69, 5
    s_sub_u32 s69, s69, 12
    v_cmp_le_i32 s[10:11], s69, v74
    s_setpc_b64 s[98:99]
A_c2:
    s_waitcnt lgkmcnt(0)
    s_add_u32 s54, s54, 2654435761
    s_lshl_b32 s63, s53, 11
    s_add_u32 s63, s63, 81920
    v_mov_b32 v42, s54
    v_lshlrev_b32 v10, 4, v10
    s_cmp_lt_u32 s48, s65
    s_cbranch_scc0 A_nos
    s_waitcnt vmcnt(4)
    v_dot2_f32_bf16 v40, v20, v16, 0
    v_dot2_f32_bf16 v41, v20, v20, 0
    v_dot2_f32_bf16 v44, v21, v16, 0
    v_dot2_f32_bf16 v45, v21, v21, 0
    v_dot2_f32_bf16 v40, v22, v16, v40
    v_dot2_f32_bf16 v41, v22, v22, v41
    v_dot2_f32_bf16 v44, v23, v16, v44
    v_dot2_f32_bf16 v45, v23, v23, v45
    s_waitcnt vmcnt(3)
    v_dot2_f32_bf16 v40, v24, v16, v40
    v_dot2_f32_bf16 v41, v24, v24, v41
    v_dot2_f32_bf16 v44, v25, v16, v44
    v_dot2_f32_bf16 v45, v25, v25, v45
    v_dot2_f32_bf16 v40, v26, v16, v40
    v_dot2_f32_bf16 v41, v26, v26, v41
    v_dot2_f32_bf16 v44, v27, v16, v44
    v_dot2_f32_bf16 v45, v27, v27, v45
    s_waitcnt vmcnt(2)
    v_dot2_f32_bf16 v40, v28, v16, v40
    v_dot2_f32_bf16 v41, v28, v28, v41
    v_dot2_f32_bf16 v44, v29, v16, v44
    v_dot2_f32_bf16 v45, v29, v29, v45
    v_dot2_f32_bf16 v40, v30, v16, v40
    v_dot2_f32_bf16 v41, v30, v30, v41
    v_dot2_f32_bf16 v44, v31, v16, v44
    v_dot2_f32_bf16 v45, v31, v31, v45
    s_waitcnt vmcnt(1)
    v_dot2_f32_bf16 v40, v32, v16, v40
    v_dot2_f32_bf16 v41, v32, v32, v41
    v_dot2_f32_bf16 v44, v33, v16, v44
    v_dot2_f32_bf16 v45, v33, v33, v45
    v_dot2_f32_bf16 v40, v34, v16, v40
    v_dot2_f32_bf16 v41, v34, v34, v41
    v_dot2_f32_bf16 v44, v35, v16, v44
    v_dot2_f32_bf16 v45, v35, v35, v45
    s_waitcnt vmcnt(0)
    v_dot2_f32_bf16 v40, v36, v16, v40
    v_dot2_f32_bf16 v41, v36, v36, v41
    v_dot2_f32_bf16 v44, v37, v16, v44
    v_dot2_f32_bf16 v45, v37, v37, v45
    v_dot2_f32_bf16 v40, v38, v16, v40
    v_dot2_f32_bf16 v41, v38, v38, v41
    v_dot2_f32_bf16 v44, v39, v16, v44
    v_dot2_f32_bf16 v45, v39, v39, v45
A_red:
    s_nop 1
    v_add_f32 v40, v40, v44
    v_add_f32 v41, v41, v45
    s_nop 0
    v_add_f32_dpp v40, v40, v40 row_ror:1 row_mask:0xf bank_mask:0xf
    v_add_f32_dpp v41, v41, v41 row_ror:1 row_mask:0xf bank_mask:0xf
    s_nop 0
    v_add_f32_dpp v40, v40, v40 row_ror:2 row_mask:0xf bank_mask:0xf
    v_add_f32_dpp v41, v41, v41 row_ror:2 row_mask:0xf bank_mask:0xf
    s_nop 0
    v_add_f32_dpp v40, v40, v40 row_ror:4 row_mask:0xf bank_mask:0xf
    v_add_f32_dpp v41, v41, v41 row_ror:4 row_mask:0xf bank_mask:0xf
    s_nop 0
    v_add_f32_dpp v40, v40, v40 row_ror:8 row_mask:0xf bank_mask:0xf
    v_add_f32_dpp v41, v41, v41 row_ror:8 row_mask:0xf bank_mask:0xf
    s_cselect_b32 s64, s63, 1245184
    s_cbranch_scc0 A_nln
    v_mul_f32 v40, 0x3acccccd, v40
    v_mul_f32 v41, 0x3acccccd, v41
    v_fma_f32 v41, -v40, v40, v41
    v_max_f32 v41, 0, v41
    v_cvt_pk_bf16_f32 v41, v41, v41
    v_and_b32 v41, 0xffff0000, v41
    v_add_f32 v41, 0x3727c5ac, v41
    v_cvt_pk_bf16_f32 v41, v41, v41
    v_and_b32 v41, 0xffff0000, v41
    v_sqrt_f32 v41, v41
    v_cvt_pk_bf16_f32 v40, v40, v40
    v_and_b32 v40, 0xffff0000, v40
    v_cvt_pk_bf16_f32 v41, v41, v41
    v_and_b32 v41, 0xffff0000, v41
    v_rcp_f32 v41, v41
A_nln:
    s_mov_b32 exec_lo, 0x00010001
    s_mov_b32 exec_hi, 0x00010001
    buffer_store_dwordx3 v[40:42], v10, s[24:27], s64 offen sc1
    s_mov_b64 exec, -1
A_w3:
    s_cmp_lg_u32 s48, 3
    s_cbranch_scc1 A_go
    s_getreg_b32 s61, hwreg(HW_REG_XCC_ID)
    s_lshl_b32 s64, s51, 4
    s_add_u32 s64, s64, 1536
    v_mov_b32 v44, s61
    v_mov_b32 v43, s64
    v_mov_b32 v46, s54
    s_mov_b64 exec, 1
    buffer_store_dwordx3 v[44:46], v43, s[24:27], s63 offen sc1
    s_mov_b64 exec, -1
    v_add_u32 v58, 161792, v58
    v_add_u32 v59, 161792, v59
    s_cmp_lt_u32 s62, 640
    s_cbranch_scc1 A_w3l
    s_waitcnt vmcnt(1)
A_w3l:
    ds_write_b128 v58, v[48:51]
    ds_write_b32 v59, v52 offset:1024
    v_dot2_f32_bf16 v25, v48, v16, 0
    v_dot2_f32_bf16 v25, v49, v16, v25
    v_dot2_f32_bf16 v25, v50, v16, v25
    v_dot2_f32_bf16 v25, v51, v16, v25
    v_dot2_f32_bf16 v25, v52, v16, v25
    s_nop 2
    v_add_f32_dpp v25, v25, v25 row_ror:1 row_mask:0xf bank_mask:0xf
    s_nop 1
    v_add_f32_dpp v25, v25, v25 row_ror:2 row_mask:0xf bank_mask:0xf
    s_nop 1
    v_add_f32_dpp v25, v25, v25 row_ror:4 row_mask:0xf bank_mask:0xf
    s_nop 1
    v_add_f32_dpp v25, v25, v25 row_ror:8 row_mask:0xf bank_mask:0xf
    v_mov_b32 v26, v25
    s_nop 1
    v_permlane32_swap_b32 v25, v26
    v_add_f32 v25, v25, v26
    v_mov_b32 v26, v25
    s_nop 1
    v_permlane16_swap_b32 v25, v26
    v_add_f32 v25, v25, v26
    v_mov_b32 v58, 161792
    ds_write_b32 v58, v25 offset:1280
    s_waitcnt lgkmcnt(0)
    s_branch A_go
A_nos:
    s_cmp_ge_u32 s62, 640
    s_cbranch_scc1 A_w3
    s_waitcnt vmcnt(4)
    v_dot2_f32_bf16 v40, v20, v16, 0
    v_dot2_f32_bf16 v41, v20, v76, 0
    v_dot2_f32_bf16 v44, v21, v16, 0
    v_dot2_f32_bf16 v45, v21, v77, 0
    v_dot2_f32_bf16 v40, v22, v16, v40
    v_dot2_f32_bf16 v41, v22, v78, v41
    v_dot2_f32_bf16 v44, v23, v16, v44
    v_dot2_f32_bf16 v45, v23, v79, v45
    s_waitcnt vmcnt(3)
    v_dot2_f32_bf16 v40, v24, v16, v40
    v_dot2_f32_bf16 v41, v24, v80, v41
    v_dot2_f32_bf16 v44, v25, v16, v44
    v_dot2_f32_bf16 v45, v25, v81, v45
    v_dot2_f32_bf16 v40, v26, v16, v40
    v_dot2_f32_bf16 v41, v26, v82, v41
    v_dot2_f32_bf16 v44, v27, v16, v44
    v_dot2_f32_bf16 v45, v27, v83, v45
    s_waitcnt vmcnt(2)
    v_dot2_f32_bf16 v40, v28, v16, v40
    v_dot2_f32_bf16 v41, v28, v84, v41
    v_dot2_f32_bf16 v44, v29, v16, v44
    v_dot2_f32_bf16 v45, v29, v85, v45
    v_dot2_f32_bf16 v40, v30, v16, v40
    v_dot2_f32_bf16 v41, v30, v86, v41
    v_dot2_f32_bf16 v44, v31, v16, v44
    v_dot2_f32_bf16 v45, v31, v87, v45
    s_waitcnt vmcnt(1)
    v_dot2_f32_bf16 v40, v32, v16, v40
    v_dot2_f32_bf16 v41, v32, v88, v41
    v_dot2_f32_bf16 v44, v33, v16, v44
    v_dot2_f32_bf16 v45, v33, v89, v45
    v_dot2_f32_bf16 v40, v34, v16, v40
    v_dot2_f32_bf16 v41, v34, v90, v41
    v_dot2_f32_bf16 v44, v35, v16, v44
    v_dot2_f32_bf16 v45, v35, v91, v45
    s_waitcnt vmcnt(0)
    v_dot2_f32_bf16 v40, v36, v16, v40
    v_dot2_f32_bf16 v41, v36, v92, v41
    v_dot2_f32_bf16 v44, v37, v16, v44
    v_dot2_f32_bf16 v45, v37, v93, v45
    v_dot2_f32_bf16 v40, v38, v16, v40
    v_dot2_f32_bf16 v41, v38, v94, v41
    v_dot2_f32_bf16 v44, v39, v16, v44
    v_dot2_f32_bf16 v45, v39, v95, v45
    s_branch A_red
A_go:
    v_lshlrev_b32 v18, 3, v1
    v_add_u32 v18, 159808, v18
    v_mul_u32_u24 v3, 400, v1
    v_lshl_add_u32 v3, v2, 3, v3
    s_lshl_b32 s60, s48, 5
    s_add_u32 s60, s60, 96768
    v_add_u32 v3, s60, v3
    v_mov_b32 v17, 160768
    s_mov_b32 s60, 0
    v_add_u32 v14, s60, v9
    v_mad_u32_u24 v10, v8, s60, v6
    v_add_u32 v12, s60, v4
    v_mad_u32_u24 v11, v8, s60, v7
    v_add_u32 v13, s60, v5
    s_mov_b32 s61, 0
    s_barrier
    ds_read_b64_tr_b16 v[44:45], v14 offset:12288
    ds_read_b64_tr_b16 v[46:47], v14 offset:12800
    ds_read_b64_tr_b16 v[48:49], v14 offset:13312
    ds_read_b64_tr_b16 v[50:51], v14 offset:13824
    ds_read_b64_tr_b16 v[52:53], v14 offset:14336
    ds_read_b64_tr_b16 v[54:55], v14 offset:14848
    ds_read_b128 v[20:23], v10
    ds_read_b128 v[24:27], v12 offset:2048
    ds_read_b128 v[28:31], v12 offset:4096
    ds_read_b128 v[32:35], v12 offset:6144
    ds_read_b128 v[36:39], v12 offset:8192
    ds_read_b128 v[40:43], v12 offset:10240
A_loop:
    s_waitcnt lgkmcnt(0)
    v_mfma_f32_16x16x32_bf16 v[100:103], v[44:47], v[20:23], v[100:103]
    ds_read_b64_tr_b16 v[80:81], v14 offset:24576
    v_mfma_f32_16x16x32_bf16 v[104:107], v[48:51], v[20:23], v[104:107]
    ds_read_b64_tr_b16 v[82:83], v14 offset:25088
    v_mfma_f32_16x16x32_bf16 v[108:111], v[52:55], v[20:23], v[108:111]
    ds_read_b64_tr_b16 v[84:85], v14 offset:25600
    v_mfma_f32_16x16x32_bf16 v[120:123], v[52:55], v[24:27], v[120:123]
    ds_read_b64_tr_b16 v[86:87], v14 offset:26112
    v_mfma_f32_16x16x32_bf16 v[116:119], v[48:51], v[24:27], v[116:119]
    ds_read_b64_tr_b16 v[88:89], v14 offset:26624
    v_mfma_f32_16x16x32_bf16 v[112:115], v[44:47], v[24:27], v[112:115]
    ds_read_b64_tr_b16 v[90:91], v14 offset:27136
    v_mfma_f32_16x16x32_bf16 v[124:127], v[44:47], v[28:31], v[124:127]
    ds_read_b128 v[56:59], v11
    v_mfma_f32_16x16x32_bf16 v[128:131], v[48:51], v[28:31], v[128:131]
    ds_read_b128 v[60:63], v13 offset:2048
    v_mfma_f32_16x16x32_bf16 v[132:135], v[52:55], v[28:31], v[132:135]
    ds_read_b128 v[64:67], v13 offset:4096
    v_mfma_f32_16x16x32_bf16 v[144:147], v[52:55], v[32:35], v[144:147]
    ds_read_b128 v[68:71], v13 offset:6144
    v_mfma_f32_16x16x32_bf16 v[140:143], v[48:51], v[32:35], v[140:143]
    ds_read_b128 v[72:75], v13 offset:8192
    v_mfma_f32_16x16x32_bf16 v[136:139], v[44:47], v[32:35], v[136:139]
    ds_read_b128 v[76:79], v13 offset:10240
    v_mfma_f32_16x16x32_bf16 v[148:151], v[44:47], v[36:39], v[148:151]
    s_add_u32 s60, s60, 36864
    v_mfma_f32_16x16x32_bf16 v[152:155], v[48:51], v[36:39], v[152:155]
    s_add_u32 s61, s61, 1
    v_mfma_f32_16x16x32_bf16 v[156:159], v[52:55], v[36:39], v[156:159]
    s_cmp_eq_u32 s60, 110592
    v_mfma_f32_16x16x32_bf16 v[168:171], v[52:55], v[40:43], v[168:171]
    s_cselect_b32 s60, 0, s60
    v_mfma_f32_16x16x32_bf16 v[164:167], v[48:51], v[40:43], v[164:167]
    s_cmp_lt_u32 s61, 9
    v_mfma_f32_16x16x32_bf16 v[160:163], v[44:47], v[40:43], v[160:163]
    s_waitcnt lgkmcnt(0)
    v_mfma_f32_16x16x32_bf16 v[100:103], v[80:83], v[56:59], v[100:103]
    v_add_u32 v14, s60, v9
    v_mfma_f32_16x16x32_bf16 v[104:107], v[84:87], v[56:59], v[104:107]
    v_mad_u32_u24 v10, v8, s60, v6
    v_mfma_f32_16x16x32_bf16 v[108:111], v[88:91], v[56:59], v[108:111]
    v_add_u32 v12, s60, v4
    v_mfma_f32_16x16x32_bf16 v[120:123], v[88:91], v[60:63], v[120:123]
    v_mad_u32_u24 v11, v8, s60, v7
    v_mfma_f32_16x16x32_bf16 v[116:119], v[84:87], v[60:63], v[116:119]
    v_add_u32 v13, s60, v5
    v_mfma_f32_16x16x32_bf16 v[112:115], v[80:83], v[60:63], v[112:115]
    s_barrier
    v_mfma_f32_16x16x32_bf16 v[124:127], v[80:83], v[64:67], v[124:127]
    ds_read_b64_tr_b16 v[44:45], v14 offset:12288
    ds_read_b64_tr_b16 v[46:47], v14 offset:12800
    v_mfma_f32_16x16x32_bf16 v[128:131], v[84:87], v[64:67], v[128:131]
    ds_read_b64_tr_b16 v[48:49], v14 offset:13312
    ds_read_b64_tr_b16 v[50:51], v14 offset:13824
    v_mfma_f32_16x16x32_bf16 v[132:135], v[88:91], v[64:67], v[132:135]
    ds_read_b64_tr_b16 v[52:53], v14 offset:14336
    ds_read_b64_tr_b16 v[54:55], v14 offset:14848
    v_mfma_f32_16x16x32_bf16 v[144:147], v[88:91], v[68:71], v[144:147]
    ds_read_b128 v[20:23], v10
    ds_read_b128 v[24:27], v12 offset:2048
    v_mfma_f32_16x16x32_bf16 v[140:143], v[84:87], v[68:71], v[140:143]
    ds_read_b128 v[28:31], v12 offset:4096
    ds_read_b128 v[32:35], v12 offset:6144
    v_mfma_f32_16x16x32_bf16 v[136:139], v[80:83], v[68:71], v[136:139]
    ds_read_b128 v[36:39], v12 offset:8192
    ds_read_b128 v[40:43], v12 offset:10240
    v_mfma_f32_16x16x32_bf16 v[148:151], v[80:83], v[72:75], v[148:151]
    v_mfma_f32_16x16x32_bf16 v[152:155], v[84:87], v[72:75], v[152:155]
    v_mfma_f32_16x16x32_bf16 v[156:159], v[88:91], v[72:75], v[156:159]
    v_mfma_f32_16x16x32_bf16 v[168:171], v[88:91], v[76:79], v[168:171]
    v_mfma_f32_16x16x32_bf16 v[164:167], v[84:87], v[76:79], v[164:167]
    v_mfma_f32_16x16x32_bf16 v[160:163], v[80:83], v[76:79], v[160:163]
    s_cbranch_scc1 A_loop
A_tail:
    s_waitcnt lgkmcnt(0)
    v_mfma_f32_16x16x32_bf16 v[108:111], v[52:55], v[20:23], v[108:111]
    ds_read_b64_tr_b16 v[80:81], v14 offset:24576
    ds_read_b64_tr_b16 v[82:83], v14 offset:25088
    v_mfma_f32_16x16x32_bf16 v[120:123], v[52:55], v[24:27], v[120:123]
    ds_read_b64_tr_b16 v[84:85], v14 offset:25600
    ds_read_b64_tr_b16 v[86:87], v14 offset:26112
    v_mfma_f32_16x16x32_bf16 v[132:135], v[52:55], v[28:31], v[132:135]
    ds_read_b128 v[56:59], v11
    ds_read_b128 v[60:63], v13 offset:2048
    v_mfma_f32_16x16x32_bf16 v[144:147], v[52:55], v[32:35], v[144:147]
    ds_read_b64 v[184:185], v18 offset:0
    ds_read_b64 v[186:187], v18 offset:128
    v_mfma_f32_16x16x32_bf16 v[156:159], v[52:55], v[36:39], v[156:159]
    ds_read_b128 v[64:67], v13 offset:4096
    ds_read_b128 v[68:71], v13 offset:6144
    v_mfma_f32_16x16x32_bf16 v[168:171], v[52:55], v[40:43], v[168:171]
    ds_read_b128 v[72:75], v13 offset:8192
    ds_read_b128 v[76:79], v13 offset:10240
    v_mfma_f32_16x16x32_bf16 v[100:103], v[44:47], v[20:23], v[100:103]
    ds_read_b64_tr_b16 v[88:89], v14 offset:26624
    ds_read_b64_tr_b16 v[90:91], v14 offset:27136
    v_mfma_f32_16x16x32_bf16 v[104:107], v[48:51], v[20:23], v[104:107]
    ds_read_b64 v[188:189], v18 offset:256
    ds_read_b64 v[190:191], v18 offset:384
    v_mfma_f32_16x16x32_bf16 v[112:115], v[44:47], v[24:27], v[112:115]
    ds_read_b64 v[192:193], v18 offset:512
    ds_read_b64 v[194:195], v18 offset:640
    v_mfma_f32_16x16x32_bf16 v[116:119], v[48:51], v[24:27], v[116:119]
    ds_read_b32 v17, v17
    s_waitcnt lgkmcnt(11)
    v_mfma_f32_16x16x32_bf16 v[100:103], v[80:83], v[56:59], v[100:103]
    ds_read_b32 v16, v208 offset:4
    ds_read2_b32 v[4:5], v209 offset0:0 offset1:2
    v_mfma_f32_16x16x32_bf16 v[104:107], v[84:87], v[56:59], v[104:107]
    ds_read2_b32 v[6:7], v209 offset0:4 offset1:6
    ds_read2_b32 v[8:9], v209 offset0:8 offset1:10
    v_mfma_f32_16x16x32_bf16 v[112:115], v[80:83], v[60:63], v[112:115]
    ds_read2_b32 v[10:11], v209 offset0:12 offset1:14
    ds_read2_b32 v[12:13], v209 offset0:16 offset1:18
    v_mfma_f32_16x16x32_bf16 v[116:119], v[84:87], v[60:63], v[116:119]
    ds_read2_b32 v[14:15], v209 offset0:20 offset1:22
    s_waitcnt lgkmcnt(7)
    v_mfma_f32_16x16x32_bf16 v[124:127], v[44:47], v[28:31], v[124:127]
    v_mov_b32_dpp v20, v100 row_newbcast:0 row_mask:0xf bank_mask:0xf
    v_mov_b32_dpp v21, v101 row_newbcast:0 row_mask:0xf bank_mask:0xf
    v_mov_b32_dpp v22, v102 row_newbcast:0 row_mask:0xf bank_mask:0xf
    v_mfma_f32_16x16x32_bf16 v[128:131], v[48:51], v[28:31], v[128:131]
    v_mov_b32_dpp v23, v103 row_newbcast:0 row_mask:0xf bank_mask:0xf
    v_mov_b32_dpp v24, v104 row_newbcast:0 row_mask:0xf bank_mask:0xf
    v_mov_b32_dpp v25, v105 row_newbcast:0 row_mask:0xf bank_mask:0xf
    v_mfma_f32_16x16x32_bf16 v[124:127], v[80:83], v[64:67], v[124:127]
    v_mov_b32_dpp v26, v106 row_newbcast:0 row_mask:0xf bank_mask:0xf
    v_mov_b32_dpp v27, v107 row_newbcast:0 row_mask:0xf bank_mask:0xf
    v_pk_fma_f32 v[100:101], v[184:185], v[20:21], v[100:101] op_sel_hi:[0,1,1] neg_lo:[1,0,0] neg_hi:[1,0,0]
    v_mfma_f32_16x16x32_bf16 v[128:131], v[84:87], v[64:67], v[128:131]
    v_pk_fma_f32 v[102:103], v[184:185], v[22:23], v[102:103] op_sel_hi:[0,1,1] neg_lo:[1,0,0] neg_hi:[1,0,0]
    v_pk_fma_f32 v[104:105], v[184:185], v[24:25], v[104:105] op_sel_hi:[0,1,1] neg_lo:[1,0,0] neg_hi:[1,0,0]
    v_pk_fma_f32 v[106:107], v[184:185], v[26:27], v[106:107] op_sel_hi:[0,1,1] neg_lo:[1,0,0] neg_hi:[1,0,0]
    v_mfma_f32_16x16x32_bf16 v[136:139], v[44:47], v[32:35], v[136:139]
    v_cvt_pk_bf16_f32 v100, v100, v101
    v_cvt_pk_bf16_f32 v101, v102, v103
    ds_write_b64 v3, v[100:101] offset:0
    v_mfma_f32_16x16x32_bf16 v[140:143], v[48:51], v[32:35], v[140:143]
    v_cvt_pk_bf16_f32 v104, v104, v105
    v_cvt_pk_bf16_f32 v105, v106, v107
    ds_write_b64 v3, v[104:105] offset:128
    v_mfma_f32_16x16x32_bf16 v[136:139], v[80:83], v[68:71], v[136:139]
    v_pk_fma_f32 v[112:113], v[186:187], v[20:21], v[112:113] op_sel_hi:[0,1,1] neg_lo:[1,0,0] neg_hi:[1,0,0]
    v_pk_fma_f32 v[114:115], v[186:187], v[22:23], v[114:115] op_sel_hi:[0,1,1] neg_lo:[1,0,0] neg_hi:[1,0,0]
    v_pk_fma_f32 v[116:117], v[186:187], v[24:25], v[116:117] op_sel_hi:[0,1,1] neg_lo:[1,0,0] neg_hi:[1,0,0]
    v_mfma_f32_16x16x32_bf16 v[140:143], v[84:87], v[68:71], v[140:143]
    v_pk_fma_f32 v[118:119], v[186:187], v[26:27], v[118:119] op_sel_hi:[0,1,1] neg_lo:[1,0,0] neg_hi:[1,0,0]
    v_cvt_pk_bf16_f32 v112, v112, v113
    v_cvt_pk_bf16_f32 v113, v114, v115
    v_mfma_f32_16x16x32_bf16 v[148:151], v[44:47], v[36:39], v[148:151]
    ds_write_b64 v3, v[112:113] offset:6400
    v_cvt_pk_bf16_f32 v116, v116, v117
    v_cvt_pk_bf16_f32 v117, v118, v119
    v_mfma_f32_16x16x32_bf16 v[152:155], v[48:51], v[36:39], v[152:155]
    ds_write_b64 v3, v[116:117] offset:6528
    v_readfirstlane_b32 s49, v17
    s_mov_b32 s60, 0x07060503
    v_mfma_f32_16x16x32_bf16 v[148:151], v[80:83], v[72:75], v[148:151]
    s_mov_b32 s61, 0x07060502
    s_mov_b32 s62, 0x07060501
    s_mov_b32 s63, 0x04000c0c
    v_mfma_f32_16x16x32_bf16 v[152:155], v[84:87], v[72:75], v[152:155]
    v_pk_fma_f32 v[124:125], v[188:189], v[20:21], v[124:125] op_sel_hi:[0,1,1] neg_lo:[1,0,0] neg_hi:[1,0,0]
    v_pk_fma_f32 v[126:127], v[188:189], v[22:23], v[126:127] op_sel_hi:[0,1,1] neg_lo:[1,0,0] neg_hi:[1,0,0]
    v_pk_fma_f32 v[128:129], v[188:189], v[24:25], v[128:129] op_sel_hi:[0,1,1] neg_lo:[1,0,0] neg_hi:[1,0,0]
    v_mfma_f32_16x16x32_bf16 v[160:163], v[44:47], v[40:43], v[160:163]
    v_pk_fma_f32 v[130:131], v[188:189], v[26:27], v[130:131] op_sel_hi:[0,1,1] neg_lo:[1,0,0] neg_hi:[1,0,0]
    v_cvt_pk_bf16_f32 v124, v124, v125
    v_cvt_pk_bf16_f32 v125, v126, v127
    v_mfma_f32_16x16x32_bf16 v[164:167], v[48:51], v[40:43], v[164:167]
    ds_write_b64 v3, v[124:125] offset:12800
    v_cvt_pk_bf16_f32 v128, v128, v129
    v_cvt_pk_bf16_f32 v129, v130, v131
    v_mfma_f32_16x16x32_bf16 v[160:163], v[80:83], v[76:79], v[160:163]
    ds_write_b64 v3, v[128:129] offset:12928
    s_mov_b32 s64, 0x0706000c
    s_mov_b32 s66, 0x11111111
    v_mfma_f32_16x16x32_bf16 v[164:167], v[84:87], v[76:79], v[164:167]
    s_mov_b32 s67, s66
    s_mov_b32 s68, 0x33333333
    v_pk_fma_f32 v[136:137], v[190:191], v[20:21], v[136:137] op_sel_hi:[0,1,1] neg_lo:[1,0,0] neg_hi:[1,0,0]
    v_mfma_f32_16x16x32_bf16 v[108:111], v[88:91], v[56:59], v[108:111]
    v_pk_fma_f32 v[138:139], v[190:191], v[22:23], v[138:139] op_sel_hi:[0,1,1] neg_lo:[1,0,0] neg_hi:[1,0,0]
    v_pk_fma_f32 v[140:141], v[190:191], v[24:25], v[140:141] op_sel_hi:[0,1,1] neg_lo:[1,0,0] neg_hi:[1,0,0]
    v_pk_fma_f32 v[142:143], v[190:191], v[26:27], v[142:143] op_sel_hi:[0,1,1] neg_lo:[1,0,0] neg_hi:[1,0,0]
    v_mfma_f32_16x16x32_bf16 v[120:123], v[88:91], v[60:63], v[120:123]
    v_cvt_pk_bf16_f32 v136, v136, v137
    v_cvt_pk_bf16_f32 v137, v138, v139
    ds_write_b64 v3, v[136:137] offset:19200
    v_mfma_f32_16x16x32_bf16 v[132:135], v[88:91], v[64:67], v[132:135]
    v_cvt_pk_bf16_f32 v140, v140, v141
    v_cvt_pk_bf16_f32 v141, v142, v143
    ds_write_b64 v3, v[140:141] offset:19328
    v_mfma_f32_16x16x32_bf16 v[144:147], v[88:91], v[68:71], v[144:147]
    s_mov_b32 s69, s68
    s_mov_b32 s70, 0x77777777
    s_mov_b32 s71, s70
    v_mfma_f32_16x16x32_bf16 v[156:159], v[88:91], v[72:75], v[156:159]
    v_pk_fma_f32 v[148:149], v[192:193], v[20:21], v[148:149] op_sel_hi:[0,1,1] neg_lo:[1,0,0] neg_hi:[1,0,0]
    v_pk_fma_f32 v[150:151], v[192:193], v[22:23], v[150:151] op_sel_hi:[0,1,1] neg_lo:[1,0,0] neg_hi:[1,0,0]
    v_pk_fma_f32 v[152:153], v[192:193], v[24:25], v[152:153] op_sel_hi:[0,1,1] neg_lo:[1,0,0] neg_hi:[1,0,0]
    v_mfma_f32_16x16x32_bf16 v[168:171], v[88:91], v[76:79], v[168:171]
    v_pk_fma_f32 v[154:155], v[192:193], v[26:27], v[154:155] op_sel_hi:[0,1,1] neg_lo:[1,0,0] neg_hi:[1,0,0]
    v_cvt_pk_bf16_f32 v148, v148, v149
    v_cvt_pk_bf16_f32 v149, v150, v151
    ds_write_b64 v3, v[148:149] offset:25600
    v_cvt_pk_bf16_f32 v152, v152, v153
    v_cvt_pk_bf16_f32 v153, v154, v155
    ds_write_b64 v3, v[152:153] offset:25728
    v_pk_fma_f32 v[160:161], v[194:195], v[20:21], v[160:161] op_sel_hi:[0,1,1] neg_lo:[1,0,0] neg_hi:[1,0,0]
    v_pk_fma_f32 v[162:163], v[194:195], v[22:23], v[162:163] op_sel_hi:[0,1,1] neg_lo:[1,0,0] neg_hi:[1,0,0]
    v_pk_fma_f32 v[164:165], v[194:195], v[24:25], v[164:165] op_sel_hi:[0,1,1] neg_lo:[1,0,0] neg_hi:[1,0,0]
    v_pk_fma_f32 v[166:167], v[194:195], v[26:27], v[166:167] op_sel_hi:[0,1,1] neg_lo:[1,0,0] neg_hi:[1,0,0]
    v_cvt_pk_bf16_f32 v160, v160, v161
    v_cvt_pk_bf16_f32 v161, v162, v163
    ds_write_b64 v3, v[160:161] offset:32000
    v_cvt_pk_bf16_f32 v164, v164, v165
    v_cvt_pk_bf16_f32 v165, v166, v167
    ds_write_b64 v3, v[164:165] offset:32128
    s_setprio 2
    s_branch AT_e2
AT_start:
    s_setprio 3
    ds_read_b32 v16, v208 offset:4
    ds_read2_b32 v[4:5], v209 offset0:0 offset1:2
    ds_read2_b32 v[6:7], v209 offset0:4 offset1:6
    ds_read2_b32 v[8:9], v209 offset0:8 offset1:10
    ds_read2_b32 v[10:11], v209 offset0:12 offset1:14
    ds_read2_b32 v[12:13], v209 offset0:16 offset1:18
    ds_read2_b32 v[14:15], v209 offset0:20 offset1:22
    s_mov_b32 s60, 0x07060503
    s_mov_b32 s61, 0x07060502
    s_mov_b32 s62, 0x07060501
    s_mov_b32 s63, 0x04000c0c
    s_mov_b32 s64, 0x0706000c
    s_mov_b32 s66, 0x11111111
    s_mov_b32 s67, s66
    s_mov_b32 s68, 0x33333333
    s_mov_b32 s69, s68
    s_mov_b32 s70, 0x77777777
    s_mov_b32 s71, s70
    v_mov_b32 v3, 0
AT_e2:
    s_waitcnt lgkmcnt(0)
    s_barrier
    s_branch AT_qk
AT_67:
    s_waitcnt vmcnt(11)
    ds_write_b128 v99, v[100:103] offset:2048
    s_waitcnt vmcnt(10)
    ds_write_b128 v99, v[104:107] offset:0
    s_waitcnt vmcnt(9)
    ds_write_b128 v99, v[108:111] offset:6144
    s_waitcnt vmcnt(8)
    ds_write_b128 v99, v[112:115] offset:4096
    s_waitcnt vmcnt(7)
    ds_write_b128 v99, v[116:119] offset:10240
    s_waitcnt vmcnt(6)
    ds_write_b128 v99, v[120:123] offset:8192
    s_waitcnt vmcnt(5)
    ds_write_b128 v99, v[124:127] offset:14336
    s_waitcnt vmcnt(4)
    ds_write_b128 v99, v[128:131] offset:12288
    s_waitcnt vmcnt(3)
    ds_write_b128 v99, v[132:135] offset:18432
    s_waitcnt vmcnt(2)
    ds_write_b128 v99, v[136:139] offset:16384
    s_waitcnt vmcnt(1)
    ds_write_b128 v99, v[140:143] offset:22528
    s_waitcnt vmcnt(0)
    ds_write_b128 v99, v[144:147] offset:20480
    v_mov_b32 v19, 1
    s_mov_b64 exec, 1
    ds_add_u32 v251, v19
    s_mov_b64 exec, -1
    s_mov_b32 s62, 1
    s_waitcnt vmcnt(0)
    s_branch B_ww
AT_qk:
    ds_read_b64 v[20:21], v204
    ds_read_b64 v[30:31], v205 offset:0
    ds_read_b64 v[40:41], v205 offset:1600
    ds_read_b64 v[50:51], v205 offset:3200
    ds_read_b64 v[22:23], v229
    ds_read_b64 v[32:33], v205 offset:8
    ds_read_b64 v[42:43], v205 offset:1608
    ds_read_b64 v[52:53], v205 offset:3208
    ds_read_b64 v[24:25], v230
    ds_read_b64 v[34:35], v205 offset:16
    ds_read_b64 v[44:45], v205 offset:1616
    ds_read_b64 v[54:55], v205 offset:3216
    ds_read_b64 v[26:27], v231
    ds_read_b64 v[36:37], v205 offset:24
    ds_read_b64 v[46:47], v205 offset:1624
    ds_read_b64 v[56:57], v205 offset:3224
    ds_read_b64 v[28:29], v255
    ds_read_b64 v[38:39], v205 offset:32
    ds_read_b64 v[48:49], v205 offset:1632
    ds_read_b64 v[58:59], v205 offset:3232
    v_cndmask_b32 v13, v13, v5, s[66:67]
    v_cndmask_b32 v14, v14, v6, s[68:69]
    v_cndmask_b32 v15, v15, v7, s[70:71]
    v_mov_b32 v79, s54
    v_mov_b32 v83, s54
    v_mov_b32 v87, s54
    v_mov_b64 v[88:89], 0
    v_mov_b64 v[90:91], 0
    v_mov_b64 v[92:93], 0
    v_mov_b64 v[94:95], 0
    v_mul_f32 v16, 0x3ea52b5c, v16
    v_mul_f32 v148, v16, v8
    v_mul_f32 v149, v16, v9
    v_mul_f32 v150, v16, v10
    v_mul_f32 v151, v16, v11
    v_mul_f32 v152, v16, v12
    v_mul_f32 v153, v16, v13
    v_mul_f32 v154, v16, v14
    v_mul_f32 v155, v16, v15
    s_waitcnt lgkmcnt(15)
    v_mfma_f32_4x4x4_16b_bf16 v[60:63], v[30:31], v[20:21], 0
    v_mfma_f32_4x4x4_16b_bf16 v[64:67], v[40:41], v[20:21], 0
    v_mfma_f32_4x4x4_16b_bf16 v[68:71], v[50:51], v[20:21], 0
    s_waitcnt lgkmcnt(12)
    v_mfma_f32_4x4x4_16b_bf16 v[60:63], v[32:33], v[22:23], v[60:63]
    v_mfma_f32_4x4x4_16b_bf16 v[64:67], v[42:43], v[22:23], v[64:67]
    v_mfma_f32_4x4x4_16b_bf16 v[68:71], v[52:53], v[22:23], v[68:71]
    s_waitcnt lgkmcnt(8)
    v_mfma_f32_4x4x4_16b_bf16 v[60:63], v[34:35], v[24:25], v[60:63]
    v_mfma_f32_4x4x4_16b_bf16 v[64:67], v[44:45], v[24:25], v[64:67]
    v_mfma_f32_4x4x4_16b_bf16 v[68:71], v[54:55], v[24:25], v[68:71]
    s_waitcnt lgkmcnt(4)
    v_mfma_f32_4x4x4_16b_bf16 v[60:63], v[36:37], v[26:27], v[60:63]
    v_mfma_f32_4x4x4_16b_bf16 v[64:67], v[46:47], v[26:27], v[64:67]
    v_mfma_f32_4x4x4_16b_bf16 v[68:71], v[56:57], v[26:27], v[68:71]
    s_waitcnt lgkmcnt(0)
    v_mfma_f32_4x4x4_16b_bf16 v[60:63], v[38:39], v[28:29], v[60:63]
    v_mfma_f32_4x4x4_16b_bf16 v[64:67], v[48:49], v[28:29], v[64:67]
    v_mfma_f32_4x4x4_16b_bf16 v[68:71], v[58:59], v[28:29], v[68:71]
    s_cmp_lt_i32 s13, 8
    s_cbranch_scc1 AT_mask
AT_nomask:
    s_nop 2
    v_cndmask_b32 v69, v69, v61, s[66:67]
    v_cndmask_b32 v70, v70, v62, s[68:69]
    v_cndmask_b32 v71, v71, v63, s[70:71]
    v_pk_mul_f32 v[64:65], v[64:65], v[148:149]
    v_pk_mul_f32 v[66:67], v[66:67], v[150:151]
    v_pk_mul_f32 v[68:69], v[68:69], v[152:153]
    v_pk_mul_f32 v[70:71], v[70:71], v[154:155]
    v_perm_b32 v80, v64, v67, s60
    v_perm_b32 v81, v65, v67, s61
    v_perm_b32 v82, v66, v67, s62
    v_perm_b32 v84, v68, v71, s60
    v_perm_b32 v85, v69, v71, s61
    v_perm_b32 v86, v70, v71, s62
    s_mov_b64 exec, s[20:21]
    s_cmp_eq_u32 s49, 0
    s_cbranch_scc1 sts_1
    buffer_store_dwordx4 v[80:83], v213, s[24:27], s12 offen offset:0
    buffer_store_dwordx4 v[84:87], v213, s[24:27], s12 offen offset:512
std_2:
    s_mov_b64 exec, -1
    s_cmp_ge_u32 s48, 4
    s_cbranch_scc1 AT_vw
    v_mov_b32_dpp v196, v108 row_newbcast:0 row_mask:0xf bank_mask:0xf
    v_mov_b32_dpp v197, v109 row_newbcast:0 row_mask:0xf bank_mask:0xf
    v_mov_b32_dpp v198, v110 row_newbcast:0 row_mask:0xf bank_mask:0xf
    v_mov_b32_dpp v199, v111 row_newbcast:0 row_mask:0xf bank_mask:0xf
    v_pk_fma_f32 v[108:109], v[184:185], v[196:197], v[108:109] op_sel_hi:[0,1,1] neg_lo:[1,0,0] neg_hi:[1,0,0]
    v_pk_fma_f32 v[120:121], v[186:187], v[196:197], v[120:121] op_sel_hi:[0,1,1] neg_lo:[1,0,0] neg_hi:[1,0,0]
    v_pk_fma_f32 v[132:133], v[188:189], v[196:197], v[132:133] op_sel_hi:[0,1,1] neg_lo:[1,0,0] neg_hi:[1,0,0]
    v_pk_fma_f32 v[110:111], v[184:185], v[198:199], v[110:111] op_sel_hi:[0,1,1] neg_lo:[1,0,0] neg_hi:[1,0,0]
    v_pk_fma_f32 v[122:123], v[186:187], v[198:199], v[122:123] op_sel_hi:[0,1,1] neg_lo:[1,0,0] neg_hi:[1,0,0]
    v_pk_fma_f32 v[134:135], v[188:189], v[198:199], v[134:135] op_sel_hi:[0,1,1] neg_lo:[1,0,0] neg_hi:[1,0,0]
    v_cvt_pk_bf16_f32 v108, v108, v109
    v_cvt_pk_bf16_f32 v120, v120, v121
    v_cvt_pk_bf16_f32 v132, v132, v133
    v_cvt_pk_bf16_f32 v109, v110, v111
    v_cvt_pk_bf16_f32 v121, v122, v123
    v_cvt_pk_bf16_f32 v133, v134, v135
    ds_write_b64 v3, v[108:109] offset:256
    ds_write_b64 v3, v[120:121] offset:6656
    ds_write_b64 v3, v[132:133] offset:13056
    v_pk_fma_f32 v[144:145], v[190:191], v[196:197], v[144:145] op_sel_hi:[0,1,1] neg_lo:[1,0,0] neg_hi:[1,0,0]
    v_pk_fma_f32 v[156:157], v[192:193], v[196:197], v[156:157] op_sel_hi:[0,1,1] neg_lo:[1,0,0] neg_hi:[1,0,0]
    v_pk_fma_f32 v[168:169], v[194:195], v[196:197], v[168:169] op_sel_hi:[0,1,1] neg_lo:[1,0,0] neg_hi:[1,0,0]
    v_pk_fma_f32 v[146:147], v[190:191], v[198:199], v[146:147] op_sel_hi:[0,1,1] neg_lo:[1,0,0] neg_hi:[1,0,0]
    v_pk_fma_f32 v[158:159], v[192:193], v[198:199], v[158:159] op_sel_hi:[0,1,1] neg_lo:[1,0,0] neg_hi:[1,0,0]
    v_pk_fma_f32 v[170:171], v[194:195], v[198:199], v[170:171] op_sel_hi:[0,1,1] neg_lo:[1,0,0] neg_hi:[1,0,0]
    v_cvt_pk_bf16_f32 v144, v144, v145
    v_cvt_pk_bf16_f32 v156, v156, v157
    v_cvt_pk_bf16_f32 v168, v168, v169
    v_cvt_pk_bf16_f32 v145, v146, v147
    v_cvt_pk_bf16_f32 v157, v158, v159
    v_cvt_pk_bf16_f32 v169, v170, v171
    ds_write_b64 v3, v[144:145] offset:19456
    ds_write_b64 v3, v[156:157] offset:25856
    ds_write_b64 v3, v[168:169] offset:32256
    v_mov_b32 v19, 1
    s_mov_b64 exec, 1
    ds_add_u32 v251, v19 offset:8
    s_mov_b64 exec, -1
AT_vw:
    v_lshl_add_u32 v17, v201, 3, v251
    ds_read2_b64 v[156:159], v17 offset0:14 offset1:18
    ds_read2_b64 v[160:163], v17 offset0:22 offset1:26
    v_and_b32 v164, 2, v201
    v_lshl_add_u32 v164, v200, 2, v164
    s_lshl_b32 s65, s48, 6
    s_add_u32 s65, s65, s57
    ds_read2_b64 v[240:243], v227 offset0:0 offset1:4
    ds_read2_b64 v[244:247], v227 offset0:8 offset1:12
    ds_read_b64 v[232:233], v250
    v_xor_b32 v4, 32, v250
    ds_read_b64 v[234:235], v4
    v_xor_b32 v5, 64, v250
    ds_read_b64 v[236:237], v5
    v_xor_b32 v6, 96, v250
    ds_read_b64 v[238:239], v6
    s_mov_b64 exec, s[20:21]
AT_poll:
    buffer_load_dwordx4 v[88:91], v206, s[24:27], s22 offen offset:0 sc1
    buffer_load_dwordx4 v[92:95], v206, s[24:27], s22 offen offset:512 sc1
AT_pw:
    s_waitcnt vmcnt(0)
    v_cmp_ne_u32 vcc, s54, v91
    v_cmp_ne_u32 s[58:59], s54, v95
    s_or_b64 vcc, vcc, s[58:59]
    s_cbranch_vccz AT_got
    s_sub_u32 s3, s3, 1
    s_cbranch_scc0 AT_poll
    s_mov_b32 s3, 0
AT_got:
    s_mov_b64 exec, -1
    ds_read_b32 v17, v251 offset:8
    s_cmp_lt_u32 s48, 4
    s_cbranch_scc1 AT_w0
    v_mov_b32 v19, 1
    s_mov_b64 exec, 1
    ds_add_u32 v251, v19
    s_mov_b64 exec, -1
AT_w0:
    v_perm_b32 v91, v88, v89, s63
    v_perm_b32 v95, v92, v93, s63
    v_perm_b32 v91, v91, v90, s64
    v_perm_b32 v95, v95, v94, s64
    v_pk_add_f32 v[64:65], v[64:65], v[88:89]
    v_pk_add_f32 v[68:69], v[68:69], v[92:93]
    v_pk_add_f32 v[66:67], v[66:67], v[90:91]
    v_pk_add_f32 v[70:71], v[70:71], v[94:95]
    v_max3_f32 v18, v64, v65, v66
    v_max3_f32 v19, v67, v68, v69
    v_max3_f32 v18, v18, v70, v71
    v_max_f32 v18, v18, v19
    v_pk_add_f32 v[64:65], v[64:65], v[18:19] op_sel_hi:[1,0] neg_lo:[0,1] neg_hi:[0,1]
    v_pk_add_f32 v[66:67], v[66:67], v[18:19] op_sel_hi:[1,0] neg_lo:[0,1] neg_hi:[0,1]
    v_pk_add_f32 v[68:69], v[68:69], v[18:19] op_sel_hi:[1,0] neg_lo:[0,1] neg_hi:[0,1]
    v_pk_add_f32 v[70:71], v[70:71], v[18:19] op_sel_hi:[1,0] neg_lo:[0,1] neg_hi:[0,1]
AT_vc:
    s_waitcnt lgkmcnt(0)
    v_cmp_ne_u32 vcc, 4, v17
    s_cbranch_vccnz AT_vs
AT_vg:
    ds_read_b64_tr_b16 v[100:101], v214 offset:0
    ds_read_b64_tr_b16 v[102:103], v214 offset:1600
    ds_read_b64_tr_b16 v[104:105], v214 offset:32
    ds_read_b64_tr_b16 v[106:107], v214 offset:1632
    ds_read_b64_tr_b16 v[108:109], v214 offset:64
    ds_read_b64_tr_b16 v[110:111], v214 offset:1664
    ds_read_b64_tr_b16 v[112:113], v214 offset:96
    ds_read_b64_tr_b16 v[114:115], v214 offset:1696
    v_exp_f32 v64, v64
    v_exp_f32 v65, v65
    v_exp_f32 v66, v66
    v_exp_f32 v67, v67
    v_exp_f32 v68, v68
    v_exp_f32 v69, v69
    v_exp_f32 v70, v70
    v_exp_f32 v71, v71
    v_pk_add_f32 v[20:21], v[64:65], v[66:67]
    v_pk_add_f32 v[22:23], v[68:69], v[70:71]
    v_pk_add_f32 v[20:21], v[20:21], v[22:23]
    v_add_f32 v20, v20, v21
    v_rcp_f32 v20, v20
    v_pk_mul_f32 v[64:65], v[64:65], v[8:9]
    v_pk_mul_f32 v[66:67], v[66:67], v[10:11]
    v_pk_mul_f32 v[68:69], v[68:69], v[12:13]
    v_pk_mul_f32 v[70:71], v[70:71], v[14:15]
    v_pk_mul_f32 v[64:65], v[64:65], v[20:21] op_sel_hi:[1,0]
    v_pk_mul_f32 v[66:67], v[66:67], v[20:21] op_sel_hi:[1,0]
    v_pk_mul_f32 v[68:69], v[68:69], v[20:21] op_sel_hi:[1,0]
    v_pk_mul_f32 v[70:71], v[70:71], v[20:21] op_sel_hi:[1,0]
    v_cvt_pk_bf16_f32 v24, v64, v65
    v_cvt_pk_bf16_f32 v25, v66, v67
    v_cvt_pk_bf16_f32 v26, v68, v69
    v_cvt_pk_bf16_f32 v27, v70, v71
    ds_write_b64 v210, v[24:25] offset:8
    v_and_b32 v28, v26, v207
    v_and_b32 v29, v27, v211
    ds_write_b64 v210, v[28:29]
    v_xor_b32 v26, v26, v28
    v_xor_b32 v27, v27, v29
    ds_write_b64 v210, v[26:27] offset:16
    ds_read_b128 v[116:119], v172
    ds_read_b128 v[120:123], v173
    ds_read_b128 v[124:127], v174
    ds_read_b128 v[128:131], v175
    ds_read_b128 v[132:135], v176
    ds_read_b128 v[136:139], v177
    ds_read_b128 v[140:143], v178
    ds_read_b128 v[144:147], v179
    s_cmp_lt_u32 s48, 4
    s_cbranch_scc1 AT_pv
    s_lshl_b32 s58, s48, 2
    s_add_u32 s58, s58, 160760
    v_mov_b32 v18, s58
    v_mov_b32 v19, 1
    ds_write_b32 v18, v19
AT_pv:
    v_mfma_f32_16x16x32_bf16 v[52:55], v[240:243], v[232:235], 0
    v_mfma_f32_16x16x32_bf16 v[52:55], v[244:247], v[236:239], v[52:55]
    s_waitcnt lgkmcnt(6)
    v_mfma_f32_16x16x32_bf16 v[20:23], v[100:103], v[116:119], 0
    v_mfma_f32_16x16x32_bf16 v[24:27], v[100:103], v[120:123], 0
    s_waitcnt lgkmcnt(4)
    v_mfma_f32_16x16x32_bf16 v[28:31], v[104:107], v[124:127], 0
    v_mfma_f32_16x16x32_bf16 v[32:35], v[104:107], v[128:131], 0
    s_waitcnt lgkmcnt(2)
    v_mfma_f32_16x16x32_bf16 v[36:39], v[108:111], v[132:135], 0
    v_mfma_f32_16x16x32_bf16 v[40:43], v[108:111], v[136:139], 0
    s_waitcnt lgkmcnt(0)
    v_mfma_f32_16x16x32_bf16 v[44:47], v[112:115], v[140:143], 0
    v_mfma_f32_16x16x32_bf16 v[48:51], v[112:115], v[144:147], 0
    v_cndmask_b32 v20, v20, v24, s[4:5]
    v_cndmask_b32 v21, v21, v25, s[4:5]
    v_cndmask_b32 v22, v22, v26, s[4:5]
    v_cndmask_b32 v23, v23, v27, s[4:5]
    v_cvt_pk_bf16_f32 v204, v20, v21
    v_cvt_pk_bf16_f32 v205, v22, v23
    v_cndmask_b32 v28, v28, v32, s[6:7]
    v_cndmask_b32 v29, v29, v33, s[6:7]
    v_cndmask_b32 v30, v30, v34, s[6:7]
    v_cndmask_b32 v31, v31, v35, s[6:7]
    v_cvt_pk_bf16_f32 v206, v28, v29
    v_cvt_pk_bf16_f32 v207, v30, v31
    v_cndmask_b32 v36, v36, v40, s[8:9]
    v_cndmask_b32 v37, v37, v41, s[8:9]
    v_cndmask_b32 v38, v38, v42, s[8:9]
    v_cndmask_b32 v39, v39, v43, s[8:9]
    v_cvt_pk_bf16_f32 v208, v36, v37
    v_cvt_pk_bf16_f32 v209, v38, v39
    v_cndmask_b32 v44, v44, v48, s[10:11]
    v_cndmask_b32 v45, v45, v49, s[10:11]
    v_cndmask_b32 v46, v46, v50, s[10:11]
    v_cndmask_b32 v47, v47, v51, s[10:11]
    v_cvt_pk_bf16_f32 v210, v44, v45
    v_cvt_pk_bf16_f32 v211, v46, v47
    s_cmp_eq_u32 s49, 0
    s_cbranch_scc1 sts_3
    buffer_store_dwordx4 v[204:207], v249, s[24:27], s22 offen offset:0
    buffer_store_dwordx4 v[208:211], v249, s[24:27], s22 offen offset:1024
std_4:
    s_mov_b64 exec, s[18:19]
    buffer_load_dword v18, v203, s[24:27], s17 offen sc1
    s_mov_b64 exec, -1
    v_mfma_f32_16x16x32_bf16 v[20:23], v[156:159], v[204:207], v[52:55]
    v_mfma_f32_16x16x32_bf16 v[20:23], v[160:163], v[208:211], v[20:23]
    v_dot2_f32_bf16 v24, v204, v204, 0
    v_dot2_f32_bf16 v24, v205, v205, v24
    v_dot2_f32_bf16 v24, v206, v206, v24
    v_dot2_f32_bf16 v24, v207, v207, v24
    v_dot2_f32_bf16 v24, v208, v208, v24
    v_dot2_f32_bf16 v24, v209, v209, v24
    v_dot2_f32_bf16 v24, v210, v210, v24
    v_dot2_f32_bf16 v24, v211, v211, v24
    s_nop 2
    v_mov_b32 v25, v24
    s_nop 1
    v_permlane32_swap_b32 v24, v25
    v_add_f32 v24, v24, v25
    v_mov_b32 v25, v24
    s_nop 1
    v_permlane16_swap_b32 v24, v25
    s_mov_b32 exec_hi, 0xffff
    s_mov_b32 exec_lo, 0
    v_add_f32 v20, v24, v25
    s_mov_b32 exec_lo, 0xffff
    s_cmp_eq_u32 s49, 0
    s_cbranch_scc1 sts_5
    buffer_store_short_d16_hi v20, v164, s[24:27], s65 offen
std_6:
    s_mov_b64 exec, -1
    ds_read_b32 v19, v251
    ds_read_b32 v248, v251 offset:2288
    v_cmp_gt_u32 vcc, 2048, v254
    s_mov_b64 s[4:5], vcc
    s_waitcnt vmcnt(2)
    s_mov_b64 exec, 1
    s_cmp_eq_u32 s49, 0
    s_cbranch_scc1 sts_7
    buffer_store_dword v79, v203, s[24:27], s23 offen
std_8:
    s_mov_b64 exec, -1
    s_waitcnt vmcnt(2)
    v_cmp_ne_u32 vcc, s54, v18
    s_and_b32 s62, vcc_lo, s18
    s_cbranch_scc1 B_st0
    s_add_u32 s14, s14, 2048
    s_cmp_eq_u32 s14, s15
    s_cselect_b32 s14, s1, s14
    buffer_load_dwordx4 v[168:171], v249, s[24:27], s14 offen offset:0 sc1
    buffer_load_dwordx4 v[172:175], v249, s[24:27], s14 offen offset:1024 sc1
    s_add_u32 s14, s14, 2048
    s_cmp_eq_u32 s14, s15
    s_cselect_b32 s14, s1, s14
    buffer_load_dwordx4 v[176:179], v249, s[24:27], s14 offen offset:0 sc1
    buffer_load_dwordx4 v[180:183], v249, s[24:27], s14 offen offset:1024 sc1
    s_add_u32 s14, s14, 2048
    s_cmp_eq_u32 s14, s15
    s_cselect_b32 s14, s1, s14
    buffer_load_dwordx4 v[212:215], v249, s[24:27], s14 offen offset:0 sc1
    buffer_load_dwordx4 v[12:15], v249, s[24:27], s14 offen offset:1024 sc1
B_st0:
B_start:
    s_branch B_wc
B_ww:
    ds_read_b32 v19, v251
B_wc:
    s_waitcnt lgkmcnt(0)
    v_cmp_ne_u32 vcc, 4, v19
    s_cbranch_vccz B_wd
    s_sleep 1
    s_sub_u32 s3, s3, 1
    s_cbranch_scc0 B_ww
    s_mov_b32 s3, 0
B_wd:
    s_mov_b32 exec_lo, 0x00010001
    s_mov_b32 exec_hi, 0x00010001
    v_mov_b32 v240, 0x3f803f80
    v_mov_b32 v241, 0x3f803f80
    v_mov_b32 v242, 0x3f803f80
    v_mov_b32 v243, 0x3f803f80
    v_mov_b32 v244, 0x3f803f80
    v_mov_b32 v245, 0x3f803f80
    v_mov_b32 v246, 0x3f803f80
    v_mov_b32 v247, 0x3f803f80
    s_mov_b64 exec, -1
    s_setprio 0
    s_cmp_ge_u32 s48, 6
    s_cbranch_scc1 B_r2
    ds_read_b64_tr_b16 v[20:21], v216 offset:0
    ds_read_b64_tr_b16 v[22:23], v216 offset:2048
    ds_read_b64_tr_b16 v[24:25], v217 offset:0
    ds_read_b64_tr_b16 v[26:27], v217 offset:2048
    ds_read_b64_tr_b16 v[28:29], v218 offset:0
    ds_read_b64_tr_b16 v[30:31], v218 offset:2048
    ds_read_b64_tr_b16 v[32:33], v219 offset:0
    ds_read_b64_tr_b16 v[34:35], v219 offset:2048
    ds_read_b64_tr_b16 v[36:37], v216 offset:4096
    ds_read_b64_tr_b16 v[38:39], v216 offset:6144
    ds_read_b64_tr_b16 v[40:41], v217 offset:4096
    ds_read_b64_tr_b16 v[42:43], v217 offset:6144
    ds_read_b64_tr_b16 v[44:45], v218 offset:4096
    ds_read_b64_tr_b16 v[46:47], v218 offset:6144
    ds_read_b64_tr_b16 v[48:49], v219 offset:4096
    ds_read_b64_tr_b16 v[50:51], v219 offset:6144
B_r2:
    ds_read_b64_tr_b16 v[52:53], v216 offset:8192
    ds_read_b64_tr_b16 v[54:55], v216 offset:10240
    ds_read_b64_tr_b16 v[56:57], v217 offset:8192
    ds_read_b64_tr_b16 v[58:59], v217 offset:10240
    ds_read_b64_tr_b16 v[60:61], v218 offset:8192
    ds_read_b64_tr_b16 v[62:63], v218 offset:10240
    ds_read_b64_tr_b16 v[64:65], v219 offset:8192
    ds_read_b64_tr_b16 v[66:67], v219 offset:10240
    ds_read_b64_tr_b16 v[68:69], v216 offset:12288
    ds_read_b64_tr_b16 v[70:71], v216 offset:14336
    ds_read_b64_tr_b16 v[72:73], v217 offset:12288
    ds_read_b64_tr_b16 v[74:75], v217 offset:14336
    ds_read_b64_tr_b16 v[76:77], v218 offset:12288
    ds_read_b64_tr_b16 v[78:79], v218 offset:14336
    ds_read_b64_tr_b16 v[80:81], v219 offset:12288
    ds_read_b64_tr_b16 v[82:83], v219 offset:14336
    s_cmp_eq_u32 s62, 0
    s_cbranch_scc1 B_nap
    s_mov_b64 exec, s[18:19]
    buffer_load_dword v18, v203, s[24:27], s17 offen sc1
    s_mov_b64 exec, -1
B_nap:
    ds_read_b64_tr_b16 v[84:85], v216 offset:16384
    ds_read_b64_tr_b16 v[86:87], v216 offset:18432
    ds_read_b64_tr_b16 v[88:89], v217 offset:16384
    ds_read_b64_tr_b16 v[90:91], v217 offset:18432
    ds_read_b64_tr_b16 v[92:93], v218 offset:16384
    ds_read_b64_tr_b16 v[94:95], v218 offset:18432
    ds_read_b64_tr_b16 v[96:97], v219 offset:16384
    ds_read_b64_tr_b16 v[98:99], v219 offset:18432
    ds_read_b64_tr_b16 v[100:101], v216 offset:20480
    ds_read_b64_tr_b16 v[102:103], v216 offset:22528
    ds_read_b64_tr_b16 v[104:105], v217 offset:20480
    ds_read_b64_tr_b16 v[106:107], v217 offset:22528
    ds_read_b64_tr_b16 v[108:109], v218 offset:20480
    ds_read_b64_tr_b16 v[110:111], v218 offset:22528
    ds_read_b64_tr_b16 v[112:113], v219 offset:20480
    ds_read_b64_tr_b16 v[114:115], v219 offset:22528
    ds_read_b64_tr_b16 v[116:117], v216 offset:24576
    ds_read_b64_tr_b16 v[118:119], v216 offset:26624
    ds_read_b64_tr_b16 v[120:121], v217 offset:24576
    ds_read_b64_tr_b16 v[122:123], v217 offset:26624
    ds_read_b64_tr_b16 v[124:125], v218 offset:24576
    ds_read_b64_tr_b16 v[126:127], v218 offset:26624
    ds_read_b64_tr_b16 v[128:129], v219 offset:24576
    ds_read_b64_tr_b16 v[130:131], v219 offset:26624
    s_cmp_ge_u32 s48, 6
    s_cbranch_scc1 B_no
    v_lshlrev_b32 v184, 16, v232
    v_and_b32 v185, s47, v232
    v_lshlrev_b32 v186, 16, v233
    v_and_b32 v187, s47, v233
    v_lshlrev_b32 v188, 16, v234
    v_and_b32 v189, s47, v234
    v_lshlrev_b32 v190, 16, v235
    v_and_b32 v191, s47, v235
    v_lshlrev_b32 v192, 16, v236
    v_and_b32 v193, s47, v236
    v_lshlrev_b32 v194, 16, v237
    v_and_b32 v195, s47, v237
    v_lshlrev_b32 v196, 16, v238
    v_and_b32 v197, s47, v238
    v_lshlrev_b32 v198, 16, v239
    v_and_b32 v199, s47, v239
    s_waitcnt lgkmcnt(0)
    v_mfma_f32_16x16x32_bf16 v[184:187], v[20:23], v[204:207], v[184:187]
    v_mfma_f32_16x16x32_bf16 v[188:191], v[24:27], v[204:207], v[188:191]
    v_mfma_f32_16x16x32_bf16 v[192:195], v[28:31], v[204:207], v[192:195]
    v_mfma_f32_16x16x32_bf16 v[196:199], v[32:35], v[204:207], v[196:199]
    s_waitcnt lgkmcnt(0)
    v_mfma_f32_16x16x32_bf16 v[184:187], v[36:39], v[208:211], v[184:187]
    v_mfma_f32_16x16x32_bf16 v[188:191], v[40:43], v[208:211], v[188:191]
    v_mfma_f32_16x16x32_bf16 v[192:195], v[44:47], v[208:211], v[192:195]
    v_mfma_f32_16x16x32_bf16 v[196:199], v[48:51], v[208:211], v[196:199]
    s_branch B_n2
B_rds:
    ds_read_b64_tr_b16 v[132:133], v216 offset:28672
    ds_read_b64_tr_b16 v[134:135], v216 offset:30720
    ds_read_b64_tr_b16 v[136:137], v217 offset:28672
    ds_read_b64_tr_b16 v[138:139], v217 offset:30720
    ds_read_b64_tr_b16 v[140:141], v218 offset:28672
    ds_read_b64_tr_b16 v[142:143], v218 offset:30720
    ds_read_b64_tr_b16 v[144:145], v219 offset:28672
    ds_read_b64_tr_b16 v[146:147], v219 offset:30720
    ds_read_b64_tr_b16 v[148:149], v216 offset:32768
    ds_read_b64_tr_b16 v[150:151], v216 offset:34816
    ds_read_b64_tr_b16 v[152:153], v217 offset:32768
    ds_read_b64_tr_b16 v[154:155], v217 offset:34816
    ds_read_b64_tr_b16 v[156:157], v218 offset:32768
    ds_read_b64_tr_b16 v[158:159], v218 offset:34816
    ds_read_b64_tr_b16 v[160:161], v219 offset:32768
    ds_read_b64_tr_b16 v[162:163], v219 offset:34816
    ds_read_b64_tr_b16 v[20:21], v216 offset:36864
    ds_read_b64_tr_b16 v[22:23], v216 offset:38912
    ds_read_b64_tr_b16 v[24:25], v217 offset:36864
    ds_read_b64_tr_b16 v[26:27], v217 offset:38912
    ds_read_b64_tr_b16 v[28:29], v218 offset:36864
    ds_read_b64_tr_b16 v[30:31], v218 offset:38912
    ds_read_b64_tr_b16 v[32:33], v219 offset:36864
    ds_read_b64_tr_b16 v[34:35], v219 offset:38912
    ds_read_b64_tr_b16 v[36:37], v220 offset:0
    ds_read_b64_tr_b16 v[38:39], v220 offset:2048
    ds_read_b64_tr_b16 v[40:41], v221 offset:0
    ds_read_b64_tr_b16 v[42:43], v221 offset:2048
    ds_read_b64_tr_b16 v[44:45], v222 offset:0
    ds_read_b64_tr_b16 v[46:47], v222 offset:2048
    ds_read_b64_tr_b16 v[48:49], v223 offset:0
    ds_read_b64_tr_b16 v[50:51], v223 offset:2048
    s_setpc_b64 s[98:99]
B_no:
    v_mov_b64 v[184:185], 0
    v_mov_b64 v[186:187], 0
    v_mov_b64 v[188:189], 0
    v_mov_b64 v[190:191], 0
    v_mov_b64 v[192:193], 0
    v_mov_b64 v[194:195], 0
    v_mov_b64 v[196:197], 0
    v_mov_b64 v[198:199], 0
    s_call_b64 s[98:99], B_rds
    v_mul_u32_u24 v4, 12, v0
    s_add_u32 s58, s100, 512
    s_add_u32 s59, s100, 24832
    s_add_u32 s60, s100, 49152
    s_add_u32 s12, s100, 73472
    s_add_u32 s13, s100, 97792
    v_and_b32 v5, 31, v0
    v_mul_u32_u24 v5, 3, v5
    s_mul_i32 s64, s53, 96
    s_sub_u32 s65, 1014, s55
    v_mov_b32 v6, 0xfffff000
    v_add_u32 v7, -10, v5
    v_cmp_gt_u32 vcc, s65, v7
    v_add3_u32 v7, v5, s64, 0
    s_nop 0
    v_cndmask_b32 v8, 0, v7, vcc
    v_cndmask_b32 v204, 0, v6, vcc
    v_add_u32 v7, -9, v5
    v_cmp_gt_u32 vcc, s65, v7
    v_add3_u32 v7, v5, s64, 1
    s_nop 0
    v_cndmask_b32 v9, 0, v7, vcc
    v_cndmask_b32 v205, 0, v6, vcc
    v_add_u32 v7, -8, v5
    v_cmp_gt_u32 vcc, s65, v7
    v_add3_u32 v7, v5, s64, 2
    s_nop 0
    v_cndmask_b32 v10, 0, v7, vcc
    v_cndmask_b32 v206, 0, v6, vcc
    v_mov_b32 v7, s54
    v_lshlrev_b32 v11, 11, v200
    s_setprio 2
B_n2:
    s_cmp_eq_u32 s62, 0
    s_cbranch_scc1 B_run
    s_mov_b64 exec, s[18:19]
    s_branch B_pw
B_poll:
    buffer_load_dword v18, v203, s[24:27], s17 offen sc1
B_pw:
    s_waitcnt vmcnt(0)
    v_cmp_ne_u32 vcc, s54, v18
    s_cbranch_vccz B_go
    s_sub_u32 s3, s3, 1
    s_cbranch_scc0 B_poll
    s_mov_b32 s3, 0
B_go:
    s_mov_b64 exec, -1
    s_add_u32 s14, s14, 2048
    s_cmp_eq_u32 s14, s15
    s_cselect_b32 s14, s1, s14
    buffer_load_dwordx4 v[168:171], v249, s[24:27], s14 offen offset:0 sc1
    buffer_load_dwordx4 v[172:175], v249, s[24:27], s14 offen offset:1024 sc1
    s_add_u32 s14, s14, 2048
    s_cmp_eq_u32 s14, s15
    s_cselect_b32 s14, s1, s14
    buffer_load_dwordx4 v[176:179], v249, s[24:27], s14 offen offset:0 sc1
    buffer_load_dwordx4 v[180:183], v249, s[24:27], s14 offen offset:1024 sc1
    s_add_u32 s14, s14, 2048
    s_cmp_eq_u32 s14, s15
    s_cselect_b32 s14, s1, s14
    buffer_load_dwordx4 v[212:215], v249, s[24:27], s14 offen offset:0 sc1
    buffer_load_dwordx4 v[12:15], v249, s[24:27], s14 offen offset:1024 sc1
B_run:
    s_cmp_ge_u32 s48, 6
    s_cbranch_scc1 B_half
    s_call_b64 s[98:99], B_rds
    s_cmp_ge_u32 s48, 4
    s_cbranch_scc1 B_half
    s_setprio 1
    s_waitcnt vmcnt(5) lgkmcnt(15)
    v_mfma_f32_16x16x32_bf16 v[184:187], v[52:55], v[168:171], v[184:187]
    v_mfma_f32_16x16x32_bf16 v[188:191], v[56:59], v[168:171], v[188:191]
    ds_read_b64_tr_b16 v[52:53], v220 offset:4096
    v_mfma_f32_16x16x32_bf16 v[192:195], v[60:63], v[168:171], v[192:195]
    ds_read_b64_tr_b16 v[54:55], v220 offset:6144
    v_mfma_f32_16x16x32_bf16 v[196:199], v[64:67], v[168:171], v[196:199]
    s_add_u32 s14, s14, 2048
    s_cmp_eq_u32 s14, s15
    s_cselect_b32 s14, s1, s14
    buffer_load_dwordx4 v[164:167], v249, s[24:27], s14 offen offset:0 sc1
    ds_read_b64_tr_b16 v[56:57], v221 offset:4096
    s_waitcnt vmcnt(5) lgkmcnt(15)
    v_mfma_f32_16x16x32_bf16 v[184:187], v[68:71], v[172:175], v[184:187]
    ds_read_b64_tr_b16 v[58:59], v221 offset:6144
    ds_read_b64_tr_b16 v[60:61], v222 offset:4096
    v_mfma_f32_16x16x32_bf16 v[188:191], v[72:75], v[172:175], v[188:191]
    ds_read_b64_tr_b16 v[62:63], v222 offset:6144
    v_mfma_f32_16x16x32_bf16 v[192:195], v[76:79], v[172:175], v[192:195]
    ds_read_b64_tr_b16 v[64:65], v223 offset:4096
    v_mfma_f32_16x16x32_bf16 v[196:199], v[80:83], v[172:175], v[196:199]
    buffer_load_dwordx4 v[232:235], v249, s[24:27], s14 offen offset:1024 sc1
    ds_read_b64_tr_b16 v[66:67], v223 offset:6144
    s_waitcnt vmcnt(5) lgkmcnt(15)
    v_mfma_f32_16x16x32_bf16 v[184:187], v[84:87], v[176:179], v[184:187]
    ds_read_b64_tr_b16 v[68:69], v220 offset:8192
    ds_read_b64_tr_b16 v[70:71], v220 offset:10240
    v_mfma_f32_16x16x32_bf16 v[188:191], v[88:91], v[176:179], v[188:191]
    ds_read_b64_tr_b16 v[72:73], v221 offset:8192
    v_mfma_f32_16x16x32_bf16 v[192:195], v[92:95], v[176:179], v[192:195]
    ds_read_b64_tr_b16 v[74:75], v221 offset:10240
    v_mfma_f32_16x16x32_bf16 v[196:199], v[96:99], v[176:179], v[196:199]
    s_mov_b32 s14, s16
    buffer_load_dwordx4 v[236:239], v249, s[24:27], s14 offen offset:0 sc1
    ds_read_b64_tr_b16 v[76:77], v222 offset:8192
    s_waitcnt vmcnt(5) lgkmcnt(15)
    v_mfma_f32_16x16x32_bf16 v[184:187], v[100:103], v[180:183], v[184:187]
    ds_read_b64_tr_b16 v[78:79], v222 offset:10240
    ds_read_b64_tr_b16 v[80:81], v223 offset:8192
    v_mfma_f32_16x16x32_bf16 v[188:191], v[104:107], v[180:183], v[188:191]
    ds_read_b64_tr_b16 v[82:83], v223 offset:10240
    v_mfma_f32_16x16x32_bf16 v[192:195], v[108:111], v[180:183], v[192:195]
    ds_read_b64_tr_b16 v[84:85], v220 offset:12288
    v_mfma_f32_16x16x32_bf16 v[196:199], v[112:115], v[180:183], v[196:199]
    buffer_load_dwordx4 v[168:171], v249, s[24:27], s14 offen offset:1024 sc1
    ds_read_b64_tr_b16 v[86:87], v220 offset:14336
    s_waitcnt vmcnt(5) lgkmcnt(15)
    v_mfma_f32_16x16x32_bf16 v[184:187], v[116:119], v[212:215], v[184:187]
    ds_read_b64_tr_b16 v[88:89], v221 offset:12288
    ds_read_b64_tr_b16 v[90:91], v221 offset:14336
    v_mfma_f32_16x16x32_bf16 v[188:191], v[120:123], v[212:215], v[188:191]
    ds_read_b64_tr_b16 v[92:93], v222 offset:12288
    v_mfma_f32_16x16x32_bf16 v[192:195], v[124:127], v[212:215], v[192:195]
    ds_read_b64_tr_b16 v[94:95], v222 offset:14336
    v_mfma_f32_16x16x32_bf16 v[196:199], v[128:131], v[212:215], v[196:199]
    s_add_u32 s14, s14, 2048
    s_cmp_eq_u32 s14, s15
    s_cselect_b32 s14, s1, s14
    buffer_load_dwordx4 v[172:175], v249, s[24:27], s14 offen offset:0 sc1
    ds_read_b64_tr_b16 v[96:97], v223 offset:12288
    s_waitcnt vmcnt(5) lgkmcnt(15)
    v_mfma_f32_16x16x32_bf16 v[184:187], v[132:135], v[12:15], v[184:187]
    ds_read_b64_tr_b16 v[98:99], v223 offset:14336
    ds_read_b64_tr_b16 v[100:101], v220 offset:16384
    v_mfma_f32_16x16x32_bf16 v[188:191], v[136:139], v[12:15], v[188:191]
    ds_read_b64_tr_b16 v[102:103], v220 offset:18432
    v_mfma_f32_16x16x32_bf16 v[192:195], v[140:143], v[12:15], v[192:195]
    ds_read_b64_tr_b16 v[104:105], v221 offset:16384
    v_mfma_f32_16x16x32_bf16 v[196:199], v[144:147], v[12:15], v[196:199]
    buffer_load_dwordx4 v[176:179], v249, s[24:27], s14 offen offset:1024 sc1
    ds_read_b64_tr_b16 v[106:107], v221 offset:18432
    s_waitcnt vmcnt(5) lgkmcnt(15)
    v_mfma_f32_16x16x32_bf16 v[184:187], v[148:151], v[164:167], v[184:187]
    ds_read_b64_tr_b16 v[108:109], v222 offset:16384
    ds_read_b64_tr_b16 v[110:111], v222 offset:18432
    v_mfma_f32_16x16x32_bf16 v[188:191], v[152:155], v[164:167], v[188:191]
    ds_read_b64_tr_b16 v[112:113], v223 offset:16384
    v_mfma_f32_16x16x32_bf16 v[192:195], v[156:159], v[164:167], v[192:195]
    ds_read_b64_tr_b16 v[114:115], v223 offset:18432
    v_mfma_f32_16x16x32_bf16 v[196:199], v[160:163], v[164:167], v[196:199]
    s_add_u32 s14, s14, 2048
    s_cmp_eq_u32 s14, s15
    s_cselect_b32 s14, s1, s14
    buffer_load_dwordx4 v[180:183], v249, s[24:27], s14 offen offset:0 sc1
    ds_read_b64_tr_b16 v[116:117], v220 offset:20480
    s_waitcnt vmcnt(5) lgkmcnt(15)
    v_mfma_f32_16x16x32_bf16 v[184:187], v[20:23], v[232:235], v[184:187]
    ds_read_b64_tr_b16 v[118:119], v220 offset:22528
    ds_read_b64_tr_b16 v[120:121], v221 offset:20480
    v_mfma_f32_16x16x32_bf16 v[188:191], v[24:27], v[232:235], v[188:191]
    ds_read_b64_tr_b16 v[122:123], v221 offset:22528
    v_mfma_f32_16x16x32_bf16 v[192:195], v[28:31], v[232:235], v[192:195]
    ds_read_b64_tr_b16 v[124:125], v222 offset:20480
    v_mfma_f32_16x16x32_bf16 v[196:199], v[32:35], v[232:235], v[196:199]
    buffer_load_dwordx4 v[212:215], v249, s[24:27], s14 offen offset:1024 sc1
    ds_read_b64_tr_b16 v[126:127], v222 offset:22528
    s_waitcnt vmcnt(5) lgkmcnt(15)
    v_mfma_f32_16x16x32_bf16 v[184:187], v[36:39], v[236:239], v[184:187]
    ds_read_b64_tr_b16 v[128:129], v223 offset:20480
    ds_read_b64_tr_b16 v[130:131], v223 offset:22528
    v_mfma_f32_16x16x32_bf16 v[188:191], v[40:43], v[236:239], v[188:191]
    ds_read_b64_tr_b16 v[132:133], v220 offset:24576
    v_mfma_f32_16x16x32_bf16 v[192:195], v[44:47], v[236:239], v[192:195]
    ds_read_b64_tr_b16 v[134:135], v220 offset:26624
    v_mfma_f32_16x16x32_bf16 v[196:199], v[48:51], v[236:239], v[196:199]
    s_add_u32 s14, s14, 2048
    s_cmp_eq_u32 s14, s15
    s_cselect_b32 s14, s1, s14
    buffer_load_dwordx4 v[12:15], v249, s[24:27], s14 offen offset:0 sc1
    ds_read_b64_tr_b16 v[136:137], v221 offset:24576
    s_waitcnt vmcnt(5) lgkmcnt(15)
    v_mfma_f32_16x16x32_bf16 v[184:187], v[52:55], v[168:171], v[184:187]
    ds_read_b64_tr_b16 v[138:139], v221 offset:26624
    ds_read_b64_tr_b16 v[140:141], v222 offset:24576
    v_mfma_f32_16x16x32_bf16 v[188:191], v[56:59], v[168:171], v[188:191]
    ds_read_b64_tr_b16 v[142:143], v222 offset:26624
    v_mfma_f32_16x16x32_bf16 v[192:195], v[60:63], v[168:171], v[192:195]
    ds_read_b64_tr_b16 v[144:145], v223 offset:24576
    v_mfma_f32_16x16x32_bf16 v[196:199], v[64:67], v[168:171], v[196:199]
    buffer_load_dwordx4 v[164:167], v249, s[24:27], s14 offen offset:1024 sc1
    ds_read_b64_tr_b16 v[146:147], v223 offset:26624
    s_waitcnt vmcnt(5) lgkmcnt(15)
    v_mfma_f32_16x16x32_bf16 v[184:187], v[68:71], v[172:175], v[184:187]
    ds_read_b64_tr_b16 v[148:149], v220 offset:28672
    ds_read_b64_tr_b16 v[150:151], v220 offset:30720
    v_mfma_f32_16x16x32_bf16 v[188:191], v[72:75], v[172:175], v[188:191]
    ds_read_b64_tr_b16 v[152:153], v221 offset:28672
    v_mfma_f32_16x16x32_bf16 v[192:195], v[76:79], v[172:175], v[192:195]
    ds_read_b64_tr_b16 v[154:155], v221 offset:30720
    v_mfma_f32_16x16x32_bf16 v[196:199], v[80:83], v[172:175], v[196:199]
    s_add_u32 s14, s14, 2048
    s_cmp_eq_u32 s14, s15
    s_cselect_b32 s14, s1, s14
    buffer_load_dwordx4 v[232:235], v249, s[24:27], s14 offen offset:0 sc1
    ds_read_b64_tr_b16 v[156:157], v222 offset:28672
    s_waitcnt vmcnt(5) lgkmcnt(15)
    v_mfma_f32_16x16x32_bf16 v[184:187], v[84:87], v[176:179], v[184:187]
    ds_read_b64_tr_b16 v[158:159], v222 offset:30720
    ds_read_b64_tr_b16 v[160:161], v223 offset:28672
    v_mfma_f32_16x16x32_bf16 v[188:191], v[88:91], v[176:179], v[188:191]
    ds_read_b64_tr_b16 v[162:163], v223 offset:30720
    v_mfma_f32_16x16x32_bf16 v[192:195], v[92:95], v[176:179], v[192:195]
    ds_read_b64_tr_b16 v[20:21], v220 offset:32768
    v_mfma_f32_16x16x32_bf16 v[196:199], v[96:99], v[176:179], v[196:199]
    buffer_load_dwordx4 v[236:239], v249, s[24:27], s14 offen offset:1024 sc1
    ds_read_b64_tr_b16 v[22:23], v220 offset:34816
    s_waitcnt vmcnt(5) lgkmcnt(15)
    v_mfma_f32_16x16x32_bf16 v[184:187], v[100:103], v[180:183], v[184:187]
    ds_read_b64_tr_b16 v[24:25], v221 offset:32768
    ds_read_b64_tr_b16 v[26:27], v221 offset:34816
    v_mfma_f32_16x16x32_bf16 v[188:191], v[104:107], v[180:183], v[188:191]
    ds_read_b64_tr_b16 v[28:29], v222 offset:32768
    v_mfma_f32_16x16x32_bf16 v[192:195], v[108:111], v[180:183], v[192:195]
    ds_read_b64_tr_b16 v[30:31], v222 offset:34816
    v_mfma_f32_16x16x32_bf16 v[196:199], v[112:115], v[180:183], v[196:199]
    ds_read_b64_tr_b16 v[32:33], v223 offset:32768
    s_waitcnt vmcnt(4) lgkmcnt(15)
    v_mfma_f32_16x16x32_bf16 v[184:187], v[116:119], v[212:215], v[184:187]
    ds_read_b64_tr_b16 v[34:35], v223 offset:34816
    ds_read_b64_tr_b16 v[36:37], v220 offset:36864
    v_mfma_f32_16x16x32_bf16 v[188:191], v[120:123], v[212:215], v[188:191]
    ds_read_b64_tr_b16 v[38:39], v220 offset:38912
    v_mfma_f32_16x16x32_bf16 v[192:195], v[124:127], v[212:215], v[192:195]
    ds_read_b64_tr_b16 v[40:41], v221 offset:36864
    v_mfma_f32_16x16x32_bf16 v[196:199], v[128:131], v[212:215], v[196:199]
    ds_read_b64_tr_b16 v[42:43], v221 offset:38912
    s_waitcnt vmcnt(3) lgkmcnt(15)
    v_mfma_f32_16x16x32_bf16 v[184:187], v[132:135], v[12:15], v[184:187]
    ds_read_b64_tr_b16 v[44:45], v222 offset:36864
    ds_read_b64_tr_b16 v[46:47], v222 offset:38912
    v_mfma_f32_16x16x32_bf16 v[188:191], v[136:139], v[12:15], v[188:191]
    ds_read_b64_tr_b16 v[48:49], v223 offset:36864
    v_mfma_f32_16x16x32_bf16 v[192:195], v[140:143], v[12:15], v[192:195]
    ds_read_b64_tr_b16 v[50:51], v223 offset:38912
    v_mfma_f32_16x16x32_bf16 v[196:199], v[144:147], v[12:15], v[196:199]
    s_waitcnt vmcnt(2) lgkmcnt(15)
    v_mfma_f32_16x16x32_bf16 v[184:187], v[148:151], v[164:167], v[184:187]
    v_mfma_f32_16x16x32_bf16 v[188:191], v[152:155], v[164:167], v[188:191]
    v_mfma_f32_16x16x32_bf16 v[192:195], v[156:159], v[164:167], v[192:195]
    v_mfma_f32_16x16x32_bf16 v[196:199], v[160:163], v[164:167], v[196:199]
    ds_read_b32 v10, v251 offset:4
    s_waitcnt vmcnt(1) lgkmcnt(9)
    v_mfma_f32_16x16x32_bf16 v[184:187], v[20:23], v[232:235], v[184:187]
    v_mfma_f32_16x16x32_bf16 v[188:191], v[24:27], v[232:235], v[188:191]
    v_mfma_f32_16x16x32_bf16 v[192:195], v[28:31], v[232:235], v[192:195]
    v_mfma_f32_16x16x32_bf16 v[196:199], v[32:35], v[232:235], v[196:199]
    s_waitcnt vmcnt(0) lgkmcnt(1)
    v_mfma_f32_16x16x32_bf16 v[184:187], v[36:39], v[236:239], v[184:187]
    v_mfma_f32_16x16x32_bf16 v[188:191], v[40:43], v[236:239], v[188:191]
    v_mfma_f32_16x16x32_bf16 v[192:195], v[44:47], v[236:239], v[192:195]
    v_mfma_f32_16x16x32_bf16 v[196:199], v[48:51], v[236:239], v[196:199]
    s_branch B_epi
B_half:
    s_add_u32 s14, s14, 2048
    s_cmp_eq_u32 s14, s15
    s_cselect_b32 s14, s1, s14
    buffer_load_dwordx4 v[164:167], v249, s[24:27], s14 offen offset:0 sc1
    buffer_load_dwordx4 v[232:235], v249, s[24:27], s14 offen offset:1024 sc1
    s_mov_b32 s14, s16
    buffer_load_dwordx4 v[236:239], v249, s[24:27], s14 offen offset:0 sc1
    s_cmp_lg_u32 s48, 6
    s_cbranch_scc1 E_end
    s_setprio 3
E_poll:
    s_mov_b32 exec_hi, 0x0fffffff
    buffer_load_dword v17, v203, s[24:27], s100 offen sc1
    s_mov_b32 exec_hi, -1
    buffer_load_dwordx3 v[224:226], v4, s[24:27], s58 offen sc1
    buffer_load_dwordx3 v[228:230], v4, s[24:27], s59 offen sc1
    buffer_load_dwordx3 v[240:242], v4, s[24:27], s60 offen sc1
    buffer_load_dwordx3 v[244:246], v4, s[24:27], s12 offen sc1
    buffer_load_dwordx3 v[208:210], v4, s[24:27], s13 offen sc1
E_chk:
    s_waitcnt vmcnt(5)
    v_cmp_ne_u32 vcc, s54, v17
    s_lshl_b64 vcc, vcc, 4
    s_cbranch_scc0 E_go
    s_sleep 1
    s_sub_u32 s3, s3, 1
    s_cbranch_scc0 E_poll
    s_mov_b32 s3, 0
E_go:
    s_waitcnt vmcnt(4)
    s_waitcnt vmcnt(3)
    v_add_f32 v252, v224, v228
    v_add_f32 v253, v225, v229
    v_add_f32 v254, v226, v230
    v_lshlrev_b32 v224, 16, v224
    v_lshlrev_b32 v225, 16, v225
    v_lshlrev_b32 v226, 16, v226
    v_lshlrev_b32 v228, 16, v228
    v_lshlrev_b32 v229, 16, v229
    v_lshlrev_b32 v230, 16, v230
    v_add_f32 v224, v224, v228
    v_add_f32 v225, v225, v229
    v_add_f32 v226, v226, v230
    s_waitcnt vmcnt(2)
    v_add_f32 v252, v252, v240
    v_add_f32 v253, v253, v241
    v_add_f32 v254, v254, v242
    v_lshlrev_b32 v240, 16, v240
    v_lshlrev_b32 v241, 16, v241
    v_lshlrev_b32 v242, 16, v242
    v_add_f32 v224, v224, v240
    v_add_f32 v225, v225, v241
    v_add_f32 v226, v226, v242
    s_waitcnt vmcnt(1)
    v_add_f32 v252, v252, v244
    v_add_f32 v253, v253, v245
    v_add_f32 v254, v254, v246
    v_lshlrev_b32 v244, 16, v244
    v_lshlrev_b32 v245, 16, v245
    v_lshlrev_b32 v246, 16, v246
    v_add_f32 v224, v224, v244
    v_add_f32 v225, v225, v245
    v_add_f32 v226, v226, v246
    s_waitcnt vmcnt(0)
    v_add_f32 v252, v252, v208
    v_add_f32 v253, v253, v209
    v_add_f32 v254, v254, v210
    v_lshlrev_b32 v208, 16, v208
    v_lshlrev_b32 v209, 16, v209
    v_lshlrev_b32 v210, 16, v210
    v_add_f32 v224, v224, v208
    v_add_f32 v225, v225, v209
    v_add_f32 v226, v226, v210
    v_permlane32_swap_b32 v224, v252
    v_permlane32_swap_b32 v225, v253
    v_permlane32_swap_b32 v226, v254
    v_add_f32 v224, v224, v252
    v_add_f32 v225, v225, v253
    v_add_f32 v226, v226, v254
    v_rsq_f32 v252, v224
    v_rsq_f32 v253, v225
    v_rsq_f32 v254, v226
    v_permlane32_swap_b32 v252, v228
    v_permlane32_swap_b32 v253, v229
    v_permlane32_swap_b32 v254, v230
    v_mul_f32 v224, v224, v228
    v_mul_f32 v225, v225, v229
    v_mul_f32 v226, v226, v230
    v_and_or_b32 v252, v224, v204, v8
    v_and_or_b32 v253, v225, v205, v9
    v_and_or_b32 v254, v226, v206, v10
    v_max3_i32 v6, v252, v253, v254
    s_nop 1
    v_max_i32_dpp v6, v6, v6 row_ror:1 row_mask:0xf bank_mask:0xf
    s_nop 1
    v_max_i32_dpp v6, v6, v6 row_ror:2 row_mask:0xf bank_mask:0xf
    s_nop 1
    v_max_i32_dpp v6, v6, v6 row_ror:4 row_mask:0xf bank_mask:0xf
    s_nop 1
    v_max_i32_dpp v6, v6, v6 row_ror:8 row_mask:0xf bank_mask:0xf
    v_mov_b32 v5, v6
    s_nop 1
    v_permlane16_swap_b32 v6, v5
    s_mov_b64 exec, 0xffff
    s_lshr_b32 s64, 1, s51
    s_bitcmp0_b32 s64, 0
    v_max3_i32 v6, v6, v5, 1
    s_cbranch_scc1 E_np
    buffer_store_dwordx2 v[6:7], v11, s[24:27], s45 offen sc1
E_np:
    ds_write_b32 v251, v6 offset:4
    s_mov_b64 exec, -1
E_end:
    s_waitcnt vmcnt(8) lgkmcnt(15)
    v_mfma_f32_16x16x32_bf16 v[184:187], v[52:55], v[168:171], v[184:187]
    v_mfma_f32_16x16x32_bf16 v[188:191], v[56:59], v[168:171], v[188:191]
    v_mfma_f32_16x16x32_bf16 v[192:195], v[60:63], v[168:171], v[192:195]
    v_mfma_f32_16x16x32_bf16 v[196:199], v[64:67], v[168:171], v[196:199]
    s_waitcnt vmcnt(7) lgkmcnt(15)
    v_mfma_f32_16x16x32_bf16 v[184:187], v[68:71], v[172:175], v[184:187]
    v_mfma_f32_16x16x32_bf16 v[188:191], v[72:75], v[172:175], v[188:191]
    v_mfma_f32_16x16x32_bf16 v[192:195], v[76:79], v[172:175], v[192:195]
    v_mfma_f32_16x16x32_bf16 v[196:199], v[80:83], v[172:175], v[196:199]
    ds_read_b32 v10, v251 offset:4
    s_waitcnt vmcnt(6) lgkmcnt(15)
    v_mfma_f32_16x16x32_bf16 v[184:187], v[84:87], v[176:179], v[184:187]
    v_mfma_f32_16x16x32_bf16 v[188:191], v[88:91], v[176:179], v[188:191]
    v_mfma_f32_16x16x32_bf16 v[192:195], v[92:95], v[176:179], v[192:195]
    v_mfma_f32_16x16x32_bf16 v[196:199], v[96:99], v[176:179], v[196:199]
    s_waitcnt lgkmcnt(0)
    v_and_b32 v9, 0xfff, v10
    s_nop 0
    v_readfirstlane_b32 s64, v9
    s_lshr_b32 s64, s64, 4
    s_mul_i32 s65, s53, 6
    s_add_u32 s65, s65, s56
    s_cmp_lg_u32 s64, s65
    s_cbranch_scc1 B_nb
    s_setprio 3
B_nb:
    s_waitcnt vmcnt(5) lgkmcnt(15)
    v_mfma_f32_16x16x32_bf16 v[184:187], v[100:103], v[180:183], v[184:187]
    v_mfma_f32_16x16x32_bf16 v[188:191], v[104:107], v[180:183], v[188:191]
    v_mfma_f32_16x16x32_bf16 v[192:195], v[108:111], v[180:183], v[192:195]
    v_mfma_f32_16x16x32_bf16 v[196:199], v[112:115], v[180:183], v[196:199]
    s_waitcnt vmcnt(4) lgkmcnt(15)
    v_mfma_f32_16x16x32_bf16 v[184:187], v[116:119], v[212:215], v[184:187]
    v_mfma_f32_16x16x32_bf16 v[188:191], v[120:123], v[212:215], v[188:191]
    v_mfma_f32_16x16x32_bf16 v[192:195], v[124:127], v[212:215], v[192:195]
    v_mfma_f32_16x16x32_bf16 v[196:199], v[128:131], v[212:215], v[196:199]
    s_waitcnt vmcnt(3) lgkmcnt(15)
    v_mfma_f32_16x16x32_bf16 v[184:187], v[132:135], v[12:15], v[184:187]
    v_mfma_f32_16x16x32_bf16 v[188:191], v[136:139], v[12:15], v[188:191]
    v_mfma_f32_16x16x32_bf16 v[192:195], v[140:143], v[12:15], v[192:195]
    v_mfma_f32_16x16x32_bf16 v[196:199], v[144:147], v[12:15], v[196:199]
    s_waitcnt vmcnt(2) lgkmcnt(15)
    v_mfma_f32_16x16x32_bf16 v[184:187], v[148:151], v[164:167], v[184:187]
    v_mfma_f32_16x16x32_bf16 v[188:191], v[152:155], v[164:167], v[188:191]
    v_mfma_f32_16x16x32_bf16 v[192:195], v[156:159], v[164:167], v[192:195]
    v_mfma_f32_16x16x32_bf16 v[196:199], v[160:163], v[164:167], v[196:199]
    s_waitcnt vmcnt(1) lgkmcnt(9)
    v_mfma_f32_16x16x32_bf16 v[184:187], v[20:23], v[232:235], v[184:187]
    v_mfma_f32_16x16x32_bf16 v[188:191], v[24:27], v[232:235], v[188:191]
    v_mfma_f32_16x16x32_bf16 v[192:195], v[28:31], v[232:235], v[192:195]
    v_mfma_f32_16x16x32_bf16 v[196:199], v[32:35], v[232:235], v[196:199]
    s_cmp_eq_u32 s48, 6
    s_cbranch_scc1 B_w6
    s_waitcnt vmcnt(0)
B_w6:
    s_waitcnt lgkmcnt(1)
    v_mfma_f32_16x16x32_bf16 v[184:187], v[36:39], v[236:239], v[184:187]
    v_mfma_f32_16x16x32_bf16 v[188:191], v[40:43], v[236:239], v[188:191]
    v_mfma_f32_16x16x32_bf16 v[192:195], v[44:47], v[236:239], v[192:195]
    v_mfma_f32_16x16x32_bf16 v[196:199], v[48:51], v[236:239], v[196:199]
    s_lshl_b32 s61, s56, 12
    s_add_u32 s61, s61, 135168
    v_add_u32 v16, s61, v202
    s_lshl_b32 s61, s56, 2
    s_add_u32 s61, s61, 160760
    v_mov_b32 v18, s61
    s_cmp_eq_u32 s101, 0
    s_cbranch_scc1 B_rx0
B_pf:
    ds_read_b32 v19, v18
    s_waitcnt lgkmcnt(0)
    v_cmp_eq_u32 vcc, 0, v19
    s_cbranch_vccz B_pg
    s_sleep 1
    s_sub_u32 s3, s3, 1
    s_cbranch_scc0 B_pf
    s_mov_b32 s3, 0
B_pg:
    ds_write_b128 v16, v[184:187] offset:0
    ds_write_b128 v16, v[188:191] offset:1024
    ds_write_b128 v16, v[192:195] offset:2048
    ds_write_b128 v16, v[196:199] offset:3072
    v_mov_b32 v19, 2
    s_waitcnt lgkmcnt(0)
    ds_write_b32 v18, v19
    s_branch L_fin
B_rx0:
B_rx:
    ds_read_b32 v19, v18
    s_waitcnt lgkmcnt(0)
    v_cmp_ne_u32 vcc, 2, v19
    s_cbranch_vccz B_rd
    s_sub_u32 s3, s3, 1
    s_cbranch_scc0 B_rx
    s_mov_b32 s3, 0
B_rd:
    ds_read_b32 v10, v251 offset:4
    ds_read_b128 v[100:103], v16 offset:0
    ds_read_b128 v[104:107], v16 offset:1024
    ds_read_b128 v[108:111], v16 offset:2048
    ds_read_b128 v[112:115], v16 offset:3072
    s_waitcnt lgkmcnt(0)
    v_add_f32 v184, v184, v100
    v_add_f32 v185, v185, v101
    v_add_f32 v186, v186, v102
    v_add_f32 v187, v187, v103
    v_add_f32 v188, v188, v104
    v_add_f32 v189, v189, v105
    v_add_f32 v190, v190, v106
    v_add_f32 v191, v191, v107
    v_add_f32 v192, v192, v108
    v_add_f32 v193, v193, v109
    v_add_f32 v194, v194, v110
    v_add_f32 v195, v195, v111
    v_add_f32 v196, v196, v112
    v_add_f32 v197, v197, v113
    v_add_f32 v198, v198, v114
    v_add_f32 v199, v199, v115
B_epi:
    s_waitcnt lgkmcnt(0)
    v_cmp_eq_u32 vcc, 0, v10
    v_and_b32 v10, 0xfff, v10
    s_cbranch_vccnz B_ew
B_eg:
    v_cmp_eq_u32 s[68:69], v10, v226
    v_add_u32 v10, s54, v10
    v_mov_b32 v16, 0x3f803f80
    v_mov_b32 v15, s54
    s_add_u32 s63, s1, 20480
    s_lshl_b32 s64, s51, 8
    s_add_u32 s64, s64, s63
    v_cvt_pk_bf16_f32 v52, v184, v185
    v_cvt_pk_bf16_f32 v53, v186, v187
    v_cvt_pk_bf16_f32 v54, v188, v189
    v_cvt_pk_bf16_f32 v55, v190, v191
    v_cvt_pk_bf16_f32 v56, v192, v193
    v_cvt_pk_bf16_f32 v57, v194, v195
    v_cvt_pk_bf16_f32 v58, v196, v197
    v_cvt_pk_bf16_f32 v59, v198, v199
    s_cmp_eq_u64 s[68:69], 0
    s_cbranch_scc1 B_np2
    s_mov_b64 exec, s[68:69]
    ds_write_b128 v228, v[52:55] offset:0
    ds_write_b128 v228, v[56:59] offset:16
    s_mov_b64 exec, -1
    ds_read_b64 v[8:9], v252
    s_waitcnt lgkmcnt(0)
    buffer_store_dwordx3 v[8:10], v224, s[24:27], s44 offen sc1
B_np2:
    v_mfma_f32_16x16x32_bf16 v[12:15], v[240:243], v[52:55], 0
    v_mfma_f32_16x16x32_bf16 v[12:15], v[244:247], v[56:59], v[12:15]
    v_dot2_f32_bf16 v16, v52, v52, 0
    v_dot2_f32_bf16 v17, v53, v53, 0
    v_dot2_f32_bf16 v16, v54, v54, v16
    v_dot2_f32_bf16 v17, v55, v55, v17
    v_dot2_f32_bf16 v16, v56, v56, v16
    v_dot2_f32_bf16 v17, v57, v57, v17
    v_dot2_f32_bf16 v16, v58, v58, v16
    v_dot2_f32_bf16 v17, v59, v59, v17
    s_nop 2
    v_add_f32 v16, v16, v17
    v_mov_b32 v17, v16
    s_nop 1
    v_permlane32_swap_b32 v16, v17
    v_add_f32 v16, v16, v17
    v_mov_b32 v17, v16
    v_mov_b32 v15, s54
    s_nop 0
    v_permlane16_swap_b32 v16, v17
    v_add_f32 v13, v16, v17
    s_mov_b64 exec, 0xffff
    s_cmp_eq_u32 s49, 0
    s_cbranch_scc1 sts_9
    buffer_store_dwordx4 v[12:15], v202, s[24:27], s64 offen
std_10:
    s_mov_b64 exec, -1
    v_lshlrev_b32 v36, 16, v52
    v_and_b32 v37, s47, v52
    v_lshlrev_b32 v38, 16, v53
    v_and_b32 v39, s47, v53
    v_lshlrev_b32 v40, 16, v54
    v_and_b32 v41, s47, v54
    v_lshlrev_b32 v42, 16, v55
    v_and_b32 v43, s47, v55
    v_lshlrev_b32 v44, 16, v56
    v_and_b32 v45, s47, v56
    v_lshlrev_b32 v46, 16, v57
    v_and_b32 v47, s47, v57
    v_lshlrev_b32 v48, 16, v58
    v_and_b32 v49, s47, v58
    v_lshlrev_b32 v50, 16, v59
    v_and_b32 v51, s47, v59
    v_mov_b32 v108, 0
    v_mov_b32 v109, 0
    v_mov_b32 v110, 0
    v_mov_b32 v111, s54
    v_mov_b32 v11, s54
    v_mov_b32 v5, 1
    v_lshlrev_b32 v7, 11, v200
    s_add_u32 s45, s45, 32768
    s_sub_u32 s44, s44, 131072
    buffer_load_dwordx4 v[100:103], v202, s[24:27], s63 offen offset:0 sc1
    buffer_load_dwordx4 v[104:107], v202, s[24:27], s63 offen offset:1024 sc1
    s_mov_b32 exec_hi, 0
    buffer_load_dwordx4 v[108:111], v202, s[24:27], s63 offen offset:2048 sc1
    s_mov_b32 exec_hi, -1
    s_branch S_pw
S_poll:
    s_mov_b64 exec, s[58:59]
    s_cbranch_execz S_r0
    buffer_load_dwordx4 v[100:103], v202, s[24:27], s63 offen offset:0 sc1
S_r0:
    s_mov_b64 exec, s[64:65]
    s_cbranch_execz S_r1
    buffer_load_dwordx4 v[104:107], v202, s[24:27], s63 offen offset:1024 sc1
S_r1:
    s_mov_b64 exec, s[66:67]
    s_cbranch_execz S_r2
    buffer_load_dwordx4 v[108:111], v202, s[24:27], s63 offen offset:2048 sc1
S_r2:
    s_mov_b64 exec, -1
S_pw:
    s_waitcnt vmcnt(0)
    v_cmp_ne_u32 s[58:59], s54, v103
    v_cmp_ne_u32 s[64:65], s54, v107
    v_cmp_ne_u32 s[66:67], s54, v111
    s_or_b64 vcc, s[58:59], s[64:65]
    s_or_b64 vcc, vcc, s[66:67]
    s_cbranch_scc0 S_got
    s_sub_u32 s3, s3, 1
    s_cbranch_scc0 S_poll
    s_mov_b32 s3, 0
S_got:
    v_add_f32 v12, v100, v104
    v_add_f32 v13, v101, v105
    v_add_f32 v14, v102, v106
    v_add_f32 v12, v12, v108
    v_add_f32 v13, v13, v109
    v_add_f32 v14, v14, v110
    v_mov_b32 v17, v12
    v_mov_b32 v18, v13
    v_mov_b32 v19, v14
    v_permlane32_swap_b32 v17, v12
    v_permlane32_swap_b32 v18, v13
    v_permlane32_swap_b32 v19, v14
    v_add_f32 v12, v12, v17
    v_add_f32 v13, v13, v18
    v_add_f32 v14, v14, v19
    v_mov_b32 v17, v12
    v_mov_b32 v18, v13
    v_mov_b32 v19, v14
    v_permlane16_swap_b32 v17, v12
    v_permlane16_swap_b32 v18, v13
    v_permlane16_swap_b32 v19, v14
    v_add_f32 v12, v12, v17
    v_add_f32 v13, v13, v18
    v_add_f32 v14, v14, v19
    v_mul_f32 v12, 0x3acccccd, v12
    v_mul_f32 v13, 0x3acccccd, v13
    v_fma_f32 v13, -v12, v12, v13
    v_max_f32 v13, 0, v13
    v_cvt_pk_bf16_f32 v13, v13, v13
    v_and_b32 v13, 0xffff0000, v13
    v_add_f32 v13, 0x3727c5ac, v13
    v_cvt_pk_bf16_f32 v13, v13, v13
    v_and_b32 v13, 0xffff0000, v13
    v_sqrt_f32 v13, v13
    v_cvt_pk_bf16_f32 v12, v12, v12
    v_and_b32 v12, 0xffff0000, v12
    v_cvt_pk_bf16_f32 v13, v13, v13
    v_and_b32 v13, 0xffff0000, v13
    v_rcp_f32 v13, v13
    v_fma_f32 v14, -v12, v248, v14
    v_mul_f32 v14, v14, v13
    v_ashrrev_i32 v6, 31, v14
    v_or_b32 v6, 0x80000000, v6
    v_xor_b32 v6, v6, v14
    v_and_b32 v6, 0xfffff000, v6
    v_or_b32 v6, v6, v226
    s_and_b64 exec, s[4:5], 0xffff
    ds_max_u32 v251, v6 offset:12
    s_lshr_b32 s64, 1, s51
    s_bitcmp0_b32 s64, 0
    s_cbranch_scc1 S_nk
    s_mov_b64 exec, 1
    ds_add_rtn_u32 v5, v251, v5 offset:20
    s_mov_b64 exec, 0xffff
    ds_read_b32 v10, v251 offset:12
    s_waitcnt lgkmcnt(0)
    v_readfirstlane_b32 s64, v5
    s_cmp_lg_u32 s64, 5
    s_cbranch_scc1 S_nk
    buffer_store_dwordx2 v[10:11], v7, s[24:27], s45 offen sc1
S_nk:
    s_mov_b64 exec, -1
    s_and_b64 s[68:69], s[68:69], s[4:5]
    s_cbranch_scc0 S_ne
    s_call_b64 s[98:99], S_ln
    s_mov_b64 exec, s[68:69]
    buffer_store_dwordx4 v[60:63], v225, s[40:43], 0 offen offset:0 sc1
    buffer_store_dwordx4 v[64:67], v225, s[40:43], 0 offen offset:64 sc1
    s_mov_b64 exec, -1
S_ne:
    s_waitcnt lgkmcnt(0)
    s_barrier
    ds_read_b32 v10, v251 offset:12
    s_waitcnt lgkmcnt(0)
S_nc:
    v_cmp_eq_u32 s[60:61], v10, v6
    s_cmp_lg_u64 s[68:69], 0
    s_cbranch_scc1 S_l2
    s_call_b64 s[98:99], S_ln
S_l2:
    s_and_b64 s[60:61], s[60:61], s[4:5]
    s_cbranch_scc0 S_out
    s_andn2_b64 exec, s[60:61], s[68:69]
    s_cbranch_execz S_l3
    buffer_store_dwordx4 v[60:63], v225, s[40:43], 0 offen offset:0 sc1
    buffer_store_dwordx4 v[64:67], v225, s[40:43], 0 offen offset:64 sc1
S_l3:
    s_mov_b64 exec, s[60:61]
    ds_write_b128 v228, v[52:55] offset:0
    ds_write_b128 v228, v[56:59] offset:16
    s_mov_b64 exec, -1
    ds_read_b64 v[8:9], v252
    v_and_b32 v10, 0xfff, v10
    v_add_u32 v10, s54, v10
    s_mov_b64 exec, 0xffff
    s_waitcnt vmcnt(0) lgkmcnt(0)
    buffer_store_dwordx3 v[8:10], v224, s[24:27], s44 offen sc1
S_out:
    s_nor_b64 exec, s[60:61], s[68:69]
    buffer_store_dwordx4 v[60:63], v225, s[40:43], 0 offen offset:0 sc1
    buffer_store_dwordx4 v[64:67], v225, s[40:43], 0 offen offset:64 sc1
    s_mov_b64 exec, -1
    s_branch L_fin
S_ln:
    v_pk_add_f32 v[20:21], v[36:37], v[12:13] op_sel_hi:[1,0] neg_lo:[0,1] neg_hi:[0,1]
    v_pk_add_f32 v[22:23], v[38:39], v[12:13] op_sel_hi:[1,0] neg_lo:[0,1] neg_hi:[0,1]
    v_pk_add_f32 v[24:25], v[40:41], v[12:13] op_sel_hi:[1,0] neg_lo:[0,1] neg_hi:[0,1]
    v_pk_add_f32 v[26:27], v[42:43], v[12:13] op_sel_hi:[1,0] neg_lo:[0,1] neg_hi:[0,1]
    v_pk_add_f32 v[28:29], v[44:45], v[12:13] op_sel_hi:[1,0] neg_lo:[0,1] neg_hi:[0,1]
    v_pk_add_f32 v[30:31], v[46:47], v[12:13] op_sel_hi:[1,0] neg_lo:[0,1] neg_hi:[0,1]
    v_pk_add_f32 v[32:33], v[48:49], v[12:13] op_sel_hi:[1,0] neg_lo:[0,1] neg_hi:[0,1]
    v_pk_add_f32 v[34:35], v[50:51], v[12:13] op_sel_hi:[1,0] neg_lo:[0,1] neg_hi:[0,1]
    v_cvt_pk_bf16_f32 v60, v20, v21
    v_cvt_pk_bf16_f32 v61, v22, v23
    v_cvt_pk_bf16_f32 v62, v24, v25
    v_cvt_pk_bf16_f32 v63, v26, v27
    v_cvt_pk_bf16_f32 v64, v28, v29
    v_cvt_pk_bf16_f32 v65, v30, v31
    v_cvt_pk_bf16_f32 v66, v32, v33
    v_cvt_pk_bf16_f32 v67, v34, v35
    v_lshlrev_b32 v20, 16, v60
    v_and_b32 v21, s47, v60
    v_lshlrev_b32 v22, 16, v61
    v_and_b32 v23, s47, v61
    v_lshlrev_b32 v24, 16, v62
    v_and_b32 v25, s47, v62
    v_lshlrev_b32 v26, 16, v63
    v_and_b32 v27, s47, v63
    v_lshlrev_b32 v28, 16, v64
    v_and_b32 v29, s47, v64
    v_lshlrev_b32 v30, 16, v65
    v_and_b32 v31, s47, v65
    v_lshlrev_b32 v32, 16, v66
    v_and_b32 v33, s47, v66
    v_lshlrev_b32 v34, 16, v67
    v_and_b32 v35, s47, v67
    v_pk_mul_f32 v[20:21], v[20:21], v[12:13] op_sel:[0,1]
    v_pk_mul_f32 v[22:23], v[22:23], v[12:13] op_sel:[0,1]
    v_pk_mul_f32 v[24:25], v[24:25], v[12:13] op_sel:[0,1]
    v_pk_mul_f32 v[26:27], v[26:27], v[12:13] op_sel:[0,1]
    v_pk_mul_f32 v[28:29], v[28:29], v[12:13] op_sel:[0,1]
    v_pk_mul_f32 v[30:31], v[30:31], v[12:13] op_sel:[0,1]
    v_pk_mul_f32 v[32:33], v[32:33], v[12:13] op_sel:[0,1]
    v_pk_mul_f32 v[34:35], v[34:35], v[12:13] op_sel:[0,1]
    v_cvt_pk_bf16_f32 v60, v20, v21
    v_cvt_pk_bf16_f32 v61, v22, v23
    v_cvt_pk_bf16_f32 v62, v24, v25
    v_cvt_pk_bf16_f32 v63, v26, v27
    v_cvt_pk_bf16_f32 v64, v28, v29
    v_cvt_pk_bf16_f32 v65, v30, v31
    v_cvt_pk_bf16_f32 v66, v32, v33
    v_cvt_pk_bf16_f32 v67, v34, v35
    v_lshlrev_b32 v20, 16, v60
    v_and_b32 v21, s47, v60
    v_lshlrev_b32 v22, 16, v61
    v_and_b32 v23, s47, v61
    v_lshlrev_b32 v24, 16, v62
    v_and_b32 v25, s47, v62
    v_lshlrev_b32 v26, 16, v63
    v_and_b32 v27, s47, v63
    v_lshlrev_b32 v28, 16, v64
    v_and_b32 v29, s47, v64
    v_lshlrev_b32 v30, 16, v65
    v_and_b32 v31, s47, v65
    v_lshlrev_b32 v32, 16, v66
    v_and_b32 v33, s47, v66
    v_lshlrev_b32 v34, 16, v67
    v_and_b32 v35, s47, v67
    v_pk_add_f32 v[20:21], v[20:21], v[36:37]
    v_pk_add_f32 v[22:23], v[22:23], v[38:39]
    v_pk_add_f32 v[24:25], v[24:25], v[40:41]
    v_pk_add_f32 v[26:27], v[26:27], v[42:43]
    v_pk_add_f32 v[28:29], v[28:29], v[44:45]
    v_pk_add_f32 v[30:31], v[30:31], v[46:47]
    v_pk_add_f32 v[32:33], v[32:33], v[48:49]
    v_pk_add_f32 v[34:35], v[34:35], v[50:51]
    v_cvt_pk_bf16_f32 v60, v20, v21
    v_cvt_pk_bf16_f32 v61, v22, v23
    v_cvt_pk_bf16_f32 v62, v24, v25
    v_cvt_pk_bf16_f32 v63, v26, v27
    v_cvt_pk_bf16_f32 v64, v28, v29
    v_cvt_pk_bf16_f32 v65, v30, v31
    v_cvt_pk_bf16_f32 v66, v32, v33
    v_cvt_pk_bf16_f32 v67, v34, v35
    v_permlane16_swap_b32 v60, v62
    v_permlane16_swap_b32 v61, v63
    v_permlane16_swap_b32 v64, v66
    v_permlane16_swap_b32 v65, v67
    s_setpc_b64 s[98:99]
L_fin:
L_end:
    s_endpgm
AT_mask:
    v_mov_b32 v17, 0xf149f2ca
    v_cmp_le_i32 vcc, 8, v212
    s_nop 1
    v_cndmask_b32 v60, v17, v60, vcc
    v_cmp_le_i32 vcc, 7, v212
    s_nop 1
    v_cndmask_b32 v61, v17, v61, vcc
    v_cmp_le_i32 vcc, 6, v212
    s_nop 1
    v_cndmask_b32 v62, v17, v62, vcc
    v_cmp_le_i32 vcc, 5, v212
    s_nop 1
    v_cndmask_b32 v63, v17, v63, vcc
    v_cmp_le_i32 vcc, 4, v212
    s_nop 1
    v_cndmask_b32 v64, v17, v64, vcc
    v_cmp_le_i32 vcc, 3, v212
    s_nop 1
    v_cndmask_b32 v65, v17, v65, vcc
    v_cmp_le_i32 vcc, 2, v212
    s_nop 1
    v_cndmask_b32 v66, v17, v66, vcc
    v_cmp_le_i32 vcc, 1, v212
    s_nop 1
    v_cndmask_b32 v67, v17, v67, vcc
    v_cmp_le_i32 vcc, 0, v212
    s_nop 1
    v_cndmask_b32 v68, v17, v68, vcc
    v_cmp_le_i32 vcc, -1, v212
    s_nop 1
    v_cndmask_b32 v69, v17, v69, vcc
    v_cmp_le_i32 vcc, -2, v212
    s_nop 1
    v_cndmask_b32 v70, v17, v70, vcc
    v_cmp_le_i32 vcc, -3, v212
    s_nop 1
    v_cndmask_b32 v71, v17, v71, vcc
    s_branch AT_nomask
sts_1:
    buffer_store_dwordx4 v[80:83], v213, s[24:27], s12 offen offset:0 sc1
    buffer_store_dwordx4 v[84:87], v213, s[24:27], s12 offen offset:512 sc1
    s_branch std_2
AT_vs:
    ds_read_b32 v17, v251 offset:8
    s_sub_u32 s3, s3, 1
    s_cbranch_scc0 AT_vc
    s_mov_b32 s3, 0
    s_branch AT_vg
sts_3:
    buffer_store_dwordx4 v[204:207], v249, s[24:27], s22 offen offset:0 sc1
    buffer_store_dwordx4 v[208:211], v249, s[24:27], s22 offen offset:1024 sc1
    s_branch std_4
sts_5:
    buffer_store_short_d16_hi v20, v164, s[24:27], s65 offen sc1
    s_branch std_6
sts_7:
    buffer_store_dword v79, v203, s[24:27], s23 offen sc1
    s_branch std_8
B_ew:
    s_sleep 1
    ds_read_b32 v10, v251 offset:4
    s_sub_u32 s3, s3, 1
    s_cbranch_scc0 B_epi
    s_mov_b32 s3, 0
    s_waitcnt lgkmcnt(0)
    s_branch B_eg
sts_9:
    buffer_store_dwordx4 v[12:15], v202, s[24:27], s64 offen sc1
    s_branch std_10
LD_cont:
    v_and_b32 v0, 63, v0
    s_mov_b32 s3, 0x40000
    s_mov_b32 s47, 0xffff0000
    s_mov_b32 s26, 7340032
    s_mov_b32 s27, 0x00020000
    s_mov_b32 s38, 819200
    s_mov_b32 s39, 0x00020000
    s_mov_b32 s42, 2621440
    s_mov_b32 s43, 0x00020000
    s_sub_u32 s52, s51, 5
    s_cselect_b32 s52, s51, s52
    s_buffer_load_dword s54, s[24:27], 0
    s_lshr_b32 s61, s2, 3
    s_mul_i32 s62, s61, 57
    s_lshr_b32 s62, s62, 9
    s_mul_i32 s62, s62, 9
    s_sub_u32 s61, s61, s62
    s_cmp_eq_u32 s61, 0
    s_cselect_b32 s63, 0x11112821, s63
    s_cmp_eq_u32 s61, 1
    s_cselect_b32 s63, 0x28471382, s63
    s_cmp_eq_u32 s61, 2
    s_cselect_b32 s63, 0x84737311, s63
    s_cmp_eq_u32 s61, 3
    s_cselect_b32 s63, 0x28471382, s63
    s_cmp_eq_u32 s61, 4
    s_cselect_b32 s63, 0x84737311, s63
    s_cmp_eq_u32 s61, 5
    s_cselect_b32 s63, 0x11112821, s63
    s_cmp_eq_u32 s61, 6
    s_cselect_b32 s63, 0x84737311, s63
    s_cmp_eq_u32 s61, 7
    s_cselect_b32 s63, 0x11112821, s63
    s_cmp_eq_u32 s61, 8
    s_cselect_b32 s63, 0x28471382, s63
    s_and_b32 s61, s63, 15
    s_lshr_b32 s63, s63, 4
    s_add_u32 s66, s66, s61
    s_sub_u32 s61, s66, 9
    s_cselect_b32 s66, s66, s61
    v_lshl_add_u32 v4, s60, 3, v1
    v_mul_u32_u24 v5, 1280, v4
    v_lshlrev_b32 v7, 1, v2
    v_bitop3_b32 v7, v0, 7, v7 bitop3:0x6a
    v_lshl_add_u32 v5, v7, 4, v5
    v_lshl_add_u32 v16, s51, 7, v5
    s_lshl_b32 s46, s53, 11
    s_add_u32 s46, s46, 81920
    s_mul_i32 s62, s60, 24
    v_add_u32 v17, s62, v0
    v_lshlrev_b32 v18, 4, v17
    v_cmp_gt_u32 vcc, 24, v0
    v_add_u32 v19, 72, v0
    v_lshlrev_b32 v19, 4, v19
    v_cndmask_b32 v18, v19, v18, vcc
    s_lshl_b32 s62, s51, 2
    s_add_u32 s62, s62, s60
    s_lshl_b32 s62, s62, 8
    s_sub_u32 s62, s62, s46
    s_add_u32 s62, s62, 1243488
    v_add_u32 v19, s62, v19
    v_cmp_lt_u32 vcc, 33, v0
    s_nop 1
    v_cndmask_b32 v18, v18, v19, vcc
    v_cmp_lt_u32 vcc, 49, v0
    s_nop 1
    v_cndmask_b32 v18, v18, 2.0, vcc
    s_cmp_eq_u32 s60, 0
    s_cselect_b32 s62, 24, 0
    v_cmp_gt_u32 vcc, s62, v0
    s_nop 1
    v_cndmask_b32 v10, v10, 2.0, vcc
    v_mov_b32 v28, 0
    v_mov_b32 v29, 0
    v_mov_b32 v30, 0
    v_mov_b32 v31, 0
    s_lshl_b32 s62, s60, 6
    v_add_u32 v4, s62, v0
    v_lshlrev_b32 v35, 4, v4
    v_add_u32 v35, 135168, v35
    ds_write_b128 v35, v[28:31] offset:0
    ds_write_b128 v35, v[28:31] offset:4096
    ds_write_b128 v35, v[28:31] offset:8192
    ds_write_b128 v35, v[28:31] offset:12288
    ds_write_b128 v35, v[28:31] offset:16384
    ds_write_b128 v35, v[28:31] offset:20480
    v_lshrrev_b32 v5, 1, v4
    v_min_u32 v5, 61, v5
    v_mul_u32_u24 v5, 400, v5
    v_and_b32 v6, 1, v4
    v_lshl_add_u32 v5, v6, 4, v5
    v_add_u32 v5, 110624, v5
    ds_write_b128 v5, v[28:31]
    v_mov_b32 v26, 160768
    ds_write_b64 v26, v[28:29] offset:8
    ds_write_b128 v26, v[28:31] offset:16
    ds_write_b64 v26, v[28:29] offset:32
    v_lshlrev_b32 v17, 3, v17
    v_add_u32 v17, 159808, v17
    s_mov_b32 s62, 160768
    v_writelane_b32 v17, s62, 24
    s_lshl_b32 s62, s60, 5
    s_add_u32 s62, s62, 160828
    v_lshl_add_u32 v25, v0, 1, s62
    s_getreg_b32 s49, hwreg(HW_REG_XCC_ID)
    v_mov_b32 v6, 159776
    ds_write_b64 v6, v[28:29]
    v_and_b32 v4, 31, v0
    v_lshlrev_b32 v5, 7, v4
    s_lshl_b32 s62, s51, 11
    v_add_u32 v6, s62, v5
    s_lshl_b32 s62, s51, 8
    s_add_u32 s62, s62, 17408
    v_add_u32 v7, s62, v5
    v_cmp_lt_u32 vcc, 23, v4
    s_nop 1
    v_cndmask_b32 v6, v6, v7, vcc
    v_and_b32 v7, 128, v5
    v_add_u32 v7, 23040, v7
    v_cmp_lt_u32 vcc, 25, v4
    s_nop 1
    v_cndmask_b32 v6, v6, v7, vcc
    v_lshrrev_b32 v7, 5, v0
    v_mul_u32_u24 v7, 24320, v7
    v_add_u32 v36, v6, v7
    s_mov_b32 vcc_hi, 0xfcff0000
    s_cmp_eq_u32 s60, 0
    s_cselect_b32 vcc_lo, 0xf0ff5555, vcc_hi
    v_cndmask_b32 v36, v36, 2.0, vcc
    s_waitcnt lgkmcnt(0)
    s_add_u32 s54, s54, 2654435761
    s_lshl_b32 s62, s60, 10
    s_add_u32 s62, s62, 36864
    s_call_b64 s[98:99], LD_issue
    s_waitcnt vmcnt(9)
    s_barrier
    s_bitcmp0_b32 s60, 0
    s_cselect_b32 s16, s14, s16
    s_cselect_b32 s17, s15, s17
    s_mov_b64 s[14:15], s[18:19]
    s_and_b32 s17, s17, 0xffff
    s_mov_b32 s18, 1966080
    s_mov_b32 s19, 0x00020000
    s_lshr_b32 s58, s60, 1
    s_lshl1_add_u32 s58, s2, s58
    s_mul_i32 s61, s58, 21846
    s_lshr_b32 s61, s61, 16
    s_mul_i32 s67, s61, 3
    s_sub_u32 s58, s58, s67
    s_mul_i32 s61, s61, 3072
    s_lshl_b32 s58, s58, 10
    s_add_u32 s58, s58, s61
    s_cmp_lt_u32 s61, 73728
    s_cselect_b32 s58, 2.0, s58
    s_buffer_load_dword s59, s[16:19], s58 offset:384
    s_buffer_load_dword s59, s[16:19], s58 offset:448
    s_buffer_load_dword s59, s[16:19], s58 offset:491904
    s_buffer_load_dword s59, s[16:19], s58 offset:491968
    s_call_b64 s[98:99], LD_issue
    s_call_b64 s[98:99], S_late
    s_waitcnt vmcnt(9)
    s_barrier
    s_add_u32 s58, s58, 983040
    s_buffer_load_dword s59, s[16:19], s58 offset:384
    s_buffer_load_dword s59, s[16:19], s58 offset:448
    s_buffer_load_dword s59, s[16:19], s58 offset:491904
    s_buffer_load_dword s59, s[16:19], s58 offset:491968
    s_call_b64 s[98:99], LD_issue
    s_call_b64 s[98:99], S_late2
    s_waitcnt vmcnt(9)
    s_barrier
    buffer_load_dwordx4 v[20:23], v18, s[24:27], s46 offen sc1
    s_call_b64 s[98:99], LD_issue
    s_call_b64 s[98:99], S_late3
    s_call_b64 s[98:99], S_late4
    ds_read_b32 v24, v26 offset:2304
    s_waitcnt vmcnt(9)
    s_barrier
    s_call_b64 s[98:99], LD_issue
    s_waitcnt lgkmcnt(0)
    s_mov_b32 exec_hi, 0x3ffff
    v_cmp_ne_u32 vcc, s54, v22
    s_cbranch_vccnz LD_rsp
LD_rs:
    s_mov_b32 exec_hi, 3
    v_cmp_ne_u32 vcc, s49, v20
    s_lshr_b64 vcc, vcc, 24
    s_cselect_b32 s49, 0, 1
    s_mov_b32 exec_hi, 0
    s_mov_b32 exec_lo, 0x1ffffff
    v_writelane_b32 v20, s49, 24
    ds_write_b64 v17, v[20:21]
    s_mov_b32 exec_hi, 0x3fffc
    s_mov_b32 exec_lo, 0
    v_mul_f32 v24, 0xbacccccd, v24
    v_fmac_f32 v21, v20, v24
    ds_write_b16_d16_hi v25, v21
    s_mov_b64 exec, -1
    s_waitcnt vmcnt(9)
    s_barrier
    s_lshl2_add_u32 s58, s53, s60
    s_mul_i32 s61, s58, 86
    s_lshr_b32 s61, s61, 8
    s_mul_i32 s67, s61, 3
    s_sub_u32 s58, s58, s67
    s_mul_i32 s58, s58, 1280
    s_mul_i32 s61, s61, 7680
    s_add_u32 s58, s58, s61
    s_mul_i32 s61, s51, 245888
    s_add_u32 s58, s58, s61
    s_buffer_load_dword s59, s[32:35], s58 offset:0
    s_buffer_load_dword s59, s[32:35], s58 offset:64
    s_buffer_load_dword s59, s[32:35], s58 offset:3840
    s_buffer_load_dword s59, s[32:35], s58 offset:3904
    s_call_b64 s[98:99], LD_issue
    s_waitcnt vmcnt(9)
    s_barrier
    s_mul_i32 s58, s60, 61440
    s_add_u32 s58, s58, s44
    s_buffer_load_dword s59, s[24:27], s58 offset:0
    s_buffer_load_dword s59, s[24:27], s58 offset:64
    s_buffer_load_dword s59, s[24:27], s58 offset:128
    s_buffer_load_dword s59, s[24:27], s58 offset:192
    s_lshl_b32 s58, s60, 6
    s_add_u32 s58, s58, s44
    s_sub_u32 s58, s58, 131072
    s_buffer_load_dword s59, s[24:27], s58
    s_call_b64 s[98:99], LD_issue
    s_waitcnt vmcnt(9)
    s_barrier
    s_call_b64 s[98:99], LD_issue
    s_waitcnt vmcnt(9)
    s_barrier
    s_mov_b32 s66, s51
    s_movk_i32 s71, 99
    s_call_b64 s[98:99], LD_issue
    s_waitcnt vmcnt(9)
    s_barrier
    s_add_u32 s63, s51, 3
    s_sub_u32 s61, s63, 10
    s_cselect_b32 s63, s63, s61
    s_mul_i32 s63, s63, 81920
    s_mov_b32 m0, s62
    s_add_u32 s62, s62, 4096
    buffer_load_dwordx4 v16, s[36:39], s63 offen lds
    s_add_u32 s63, s63, 40960
    s_mov_b32 m0, s62
    s_add_u32 s62, s62, 4096
    buffer_load_dwordx4 v16, s[36:39], s63 offen lds
    s_add_u32 s63, s63, 40960
    s_cmp_eq_u32 s63, 819200
    s_cselect_b32 s63, 0, s63
    s_mov_b32 m0, s62
    s_add_u32 s62, s62, 4096
    buffer_load_dwordx4 v16, s[36:39], s63 offen lds
    s_add_u32 s63, s63, 40960
    s_mov_b32 m0, s62
    s_add_u32 s62, s62, 4096
    buffer_load_dwordx4 v16, s[36:39], s63 offen lds
    s_add_u32 s63, s63, 40960
    s_cmp_eq_u32 s63, 819200
    s_cselect_b32 s63, 0, s63
    s_mov_b32 m0, s62
    s_add_u32 s62, s62, 4096
    buffer_load_dwordx4 v16, s[36:39], s63 offen lds
    s_add_u32 s63, s63, 40960
    s_mov_b32 m0, s62
    s_add_u32 s62, s62, 4096
    buffer_load_dwordx4 v16, s[36:39], s63 offen lds
    s_add_u32 s63, s63, 40960
    s_cmp_eq_u32 s63, 819200
    s_cselect_b32 s63, 0, s63
    s_mov_b32 m0, s62
    s_add_u32 s62, s62, 4096
    buffer_load_dwordx4 v16, s[36:39], s63 offen lds
    s_add_u32 s63, s63, 40960
    s_mov_b32 m0, s62
    s_add_u32 s62, s62, 4096
    buffer_load_dwordx4 v16, s[36:39], s63 offen lds
    s_add_u32 s63, s63, 40960
    s_cmp_eq_u32 s63, 819200
    s_cselect_b32 s63, 0, s63
    s_mov_b32 m0, s62
    s_add_u32 s62, s62, 4096
    buffer_load_dwordx4 v16, s[36:39], s63 offen lds
    s_add_u32 s63, s63, 40960
    s_waitcnt vmcnt(9) lgkmcnt(0)
    s_barrier
    s_mov_b32 m0, s62
    s_add_u32 s62, s62, 4096
    buffer_load_dwordx4 v16, s[36:39], s63 offen lds
    s_add_u32 s63, s63, 40960
    s_cmp_eq_u32 s63, 819200
    s_cselect_b32 s63, 0, s63
    s_mov_b32 m0, s62
    s_add_u32 s62, s62, 4096
    buffer_load_dwordx4 v16, s[36:39], s63 offen lds
    s_add_u32 s63, s63, 40960
    s_mov_b32 m0, s62
    s_add_u32 s62, s62, 4096
    buffer_load_dwordx4 v16, s[36:39], s63 offen lds
    s_add_u32 s63, s63, 40960
    s_cmp_eq_u32 s63, 819200
    s_cselect_b32 s63, 0, s63
    s_mov_b32 m0, s62
    s_add_u32 s62, s62, 4096
    buffer_load_dwordx4 v16, s[36:39], s63 offen lds
    s_add_u32 s63, s63, 40960
    s_mov_b32 m0, s62
    s_add_u32 s62, s62, 4096
    buffer_load_dwordx4 v16, s[36:39], s63 offen lds
    s_add_u32 s63, s63, 40960
    s_cmp_eq_u32 s63, 819200
    s_cselect_b32 s63, 0, s63
    s_cmp_eq_u32 s60, 3
    s_cbranch_scc1 pf_11
    s_mul_i32 s67, s53, 6
    s_lshl_b32 s68, s60, 1
    s_add_u32 s67, s67, s68
    s_mul_i32 s67, s67, 24320
    s_add_u32 s67, s67, 1310720
    buffer_load_dword v182, v36, s[24:27], s67 offen sc1
    s_mov_b64 exec, -1
    s_branch pf_12
pf_11:
    v_lshlrev_b32 v4, 7, v0
    s_mov_b64 exec, 7
    buffer_load_dword v182, v4, s[24:27], s57 offen sc1
    s_mov_b64 exec, -1
pf_12:
    s_cmp_lt_u32 s60, 2
    s_cbranch_scc1 LD_s10
    v_subrev_u32 v98, 20480, v16
    s_add_u32 s61, s51, 0
    s_sub_u32 s67, s61, 10
    s_cselect_b32 s61, s61, s67
    s_mul_i32 s61, s61, 81920
    buffer_load_dwordx4 v[100:103], v16, s[36:39], s61 offen
    buffer_load_dwordx4 v[104:107], v98, s[36:39], s61 offen
    s_add_u32 s61, s61, 40960
    buffer_load_dwordx4 v[108:111], v16, s[36:39], s61 offen
    buffer_load_dwordx4 v[112:115], v98, s[36:39], s61 offen
    s_add_u32 s61, s51, 1
    s_sub_u32 s67, s61, 10
    s_cselect_b32 s61, s61, s67
    s_mul_i32 s61, s61, 81920
    buffer_load_dwordx4 v[116:119], v16, s[36:39], s61 offen
    buffer_load_dwordx4 v[120:123], v98, s[36:39], s61 offen
    s_add_u32 s61, s61, 40960
    buffer_load_dwordx4 v[124:127], v16, s[36:39], s61 offen
    buffer_load_dwordx4 v[128:131], v98, s[36:39], s61 offen
    s_add_u32 s61, s51, 2
    s_sub_u32 s67, s61, 10
    s_cselect_b32 s61, s61, s67
    s_mul_i32 s61, s61, 81920
    buffer_load_dwordx4 v[132:135], v16, s[36:39], s61 offen
    buffer_load_dwordx4 v[136:139], v98, s[36:39], s61 offen
    s_add_u32 s61, s61, 40960
    buffer_load_dwordx4 v[140:143], v16, s[36:39], s61 offen
    buffer_load_dwordx4 v[144:147], v98, s[36:39], s61 offen
    s_lshl_b32 s62, s60, 10
    s_add_u32 s62, s62, 10240
    v_lshl_add_u32 v99, v0, 4, s62
    s_barrier
    s_branch AT_67
LD_s10:
    v_mov_b32 v99, v16
    s_branch AT_start
LD_rsp:
    buffer_load_dwordx4 v[20:23], v18, s[24:27], s46 offen sc1
    s_waitcnt vmcnt(0)
    v_cmp_ne_u32 vcc, s54, v22
    s_cbranch_vccz LD_rs
    s_sleep 1
    s_sub_u32 s3, s3, 1
    s_cbranch_scc0 LD_rsp
    s_mov_b32 s3, 0
    s_branch LD_rs
F_start:
    v_and_b32 v0, 63, v0
    s_mov_b32 s3, 0x40000
    s_mov_b32 s47, 0xffff0000
    s_mov_b32 s26, 7340032
    s_mov_b32 s27, 0x00020000
    s_mov_b32 s38, 819200
    s_mov_b32 s39, 0x00020000
    s_mov_b32 s42, 2621440
    s_mov_b32 s43, 0x00020000
    s_and_b32 s49, s2, 7
    s_lshl_b32 s49, s49, 1
    s_add_u32 s49, s49, s56
    s_sub_u32 s49, s49, 30
    s_and_b32 s50, s48, 1
    s_lshr_b32 s51, s48, 1
    s_mul_i32 s52, s48, 6144
    s_mul_i32 s61, s49, 192
    v_mov_b32 v5, 128
    v_add_u32 v1, 0, v0
    v_mul_u32_u24 v2, 171, v1
    v_lshrrev_b32 v2, 11, v2
    v_mul_u32_u24 v3, 12, v2
    v_sub_u32 v3, v1, v3
    v_mul_u32_u24 v2, 3072, v2
    v_lshl_add_u32 v3, v3, 4, s61
    v_lshrrev_b32 v4, 8, v3
    v_cmp_eq_u32 vcc, 9, v4
    s_nop 1
    v_cndmask_b32 v4, 0, v5, vcc
    v_xad_u32 v210, v3, v4, v2
    v_add_u32 v1, 64, v0
    v_mul_u32_u24 v2, 171, v1
    v_lshrrev_b32 v2, 11, v2
    v_mul_u32_u24 v3, 12, v2
    v_sub_u32 v3, v1, v3
    v_mul_u32_u24 v2, 3072, v2
    v_lshl_add_u32 v3, v3, 4, s61
    v_lshrrev_b32 v4, 8, v3
    v_cmp_eq_u32 vcc, 9, v4
    s_nop 1
    v_cndmask_b32 v4, 0, v5, vcc
    v_xad_u32 v211, v3, v4, v2
    v_add_u32 v1, 128, v0
    v_mul_u32_u24 v2, 171, v1
    v_lshrrev_b32 v2, 11, v2
    v_mul_u32_u24 v3, 12, v2
    v_sub_u32 v3, v1, v3
    v_mul_u32_u24 v2, 3072, v2
    v_lshl_add_u32 v3, v3, 4, s61
    v_lshrrev_b32 v4, 8, v3
    v_cmp_eq_u32 vcc, 9, v4
    s_nop 1
    v_cndmask_b32 v4, 0, v5, vcc
    v_xad_u32 v212, v3, v4, v2
    s_mul_i32 s60, s51, 491520
    s_mov_b32 s30, 1966080
    s_mov_b32 s31, 0x00020000
    s_waitcnt lgkmcnt(0)
    s_cmp_eq_u32 s50, 0
    s_cselect_b32 s28, s14, s16
    s_cselect_b32 s29, s15, s17
    s_add_u32 m0, s52, 0
    s_add_u32 s62, s60, 0
    buffer_load_dwordx4 v210, s[28:31], s62 offen lds
    s_add_u32 m0, s52, 1024
    s_add_u32 s62, s60, 0
    buffer_load_dwordx4 v211, s[28:31], s62 offen lds
    s_add_u32 m0, s52, 2048
    s_add_u32 s62, s60, 0
    buffer_load_dwordx4 v212, s[28:31], s62 offen lds
    s_add_u32 m0, s52, 3072
    s_add_u32 s62, s60, 49152
    buffer_load_dwordx4 v210, s[28:31], s62 offen lds
    s_add_u32 m0, s52, 4096
    s_add_u32 s62, s60, 49152
    buffer_load_dwordx4 v211, s[28:31], s62 offen lds
    s_add_u32 m0, s52, 5120
    s_add_u32 s62, s60, 49152
    buffer_load_dwordx4 v212, s[28:31], s62 offen lds
    s_load_dword s54, s[24:25], 0
    s_mov_b32 s4, s12
    s_and_b32 s5, s13, 0xffff
    s_mov_b32 s6, 1280
    s_mov_b32 s7, 0x00020000
    s_mov_b32 s32, s18
    s_and_b32 s33, s19, 0xffff
    s_mov_b32 s34, 1966080
    s_mov_b32 s35, 0x00020000
    s_barrier
    s_add_u32 m0, s52, 49152
    s_add_u32 s62, s60, 98304
    buffer_load_dwordx4 v210, s[28:31], s62 offen lds
    s_add_u32 m0, s52, 50176
    s_add_u32 s62, s60, 98304
    buffer_load_dwordx4 v211, s[28:31], s62 offen lds
    s_add_u32 m0, s52, 51200
    s_add_u32 s62, s60, 98304
    buffer_load_dwordx4 v212, s[28:31], s62 offen lds
    s_add_u32 m0, s52, 52224
    s_add_u32 s62, s60, 147456
    buffer_load_dwordx4 v210, s[28:31], s62 offen lds
    s_add_u32 m0, s52, 53248
    s_add_u32 s62, s60, 147456
    buffer_load_dwordx4 v211, s[28:31], s62 offen lds
    s_add_u32 m0, s52, 54272
    s_add_u32 s62, s60, 147456
    buffer_load_dwordx4 v212, s[28:31], s62 offen lds
    s_mul_i32 s53, s48, 5120
    s_mul_i32 s61, s49, 122880
    s_add_u32 s61, s61, s53
    s_and_b32 s63, s48, 2
    s_lshl_b32 s63, s63, 2
    v_add_u32 v1, 0, v0
    v_mul_u32_u24 v2, 205, v1
    v_lshrrev_b32 v2, 14, v2
    v_lshl_or_b32 v2, v2, 1, s63
    v_xor_b32 v1, v1, v2
    v_lshlrev_b32 v213, 4, v1
    v_add_u32 v1, 64, v0
    v_mul_u32_u24 v2, 205, v1
    v_lshrrev_b32 v2, 14, v2
    v_lshl_or_b32 v2, v2, 1, s63
    v_xor_b32 v1, v1, v2
    v_lshlrev_b32 v214, 4, v1
    v_add_u32 v1, 128, v0
    v_mul_u32_u24 v2, 205, v1
    v_lshrrev_b32 v2, 14, v2
    v_lshl_or_b32 v2, v2, 1, s63
    v_xor_b32 v1, v1, v2
    v_lshlrev_b32 v215, 4, v1
    v_add_u32 v1, 192, v0
    v_mul_u32_u24 v2, 205, v1
    v_lshrrev_b32 v2, 14, v2
    v_lshl_or_b32 v2, v2, 1, s63
    v_xor_b32 v1, v1, v2
    v_lshlrev_b32 v216, 4, v1
    v_add_u32 v1, 256, v0
    v_mul_u32_u24 v2, 205, v1
    v_lshrrev_b32 v2, 14, v2
    v_lshl_or_b32 v2, v2, 1, s63
    v_xor_b32 v1, v1, v2
    v_lshlrev_b32 v217, 4, v1
    v_lshrrev_b32 v2, 4, v0
    v_bfe_u32 v1, v0, 2, 2
    v_lshl_add_u32 v3, v2, 3, v1
    v_and_b32 v4, 3, v0
    v_lshlrev_b32 v4, 3, v4
    v_mul_u32_u24 v5, 192, v3
    s_and_b32 s63, s48, 5
    s_mul_i32 s63, s63, 6144
    s_and_b32 s66, s51, 1
    s_mul_i32 s64, s66, 96
    s_add_u32 s63, s63, s64
    v_add3_u32 v218, v5, v4, s63
    v_and_b32 v6, 1, v2
    v_lshl_or_b32 v6, v6, 2, v1
    v_lshlrev_b32 v6, 5, v6
    v_mul_u32_u24 v3, 1280, v3
    s_mul_i32 s63, s48, 160
    s_add_u32 s64, s63, 0
    v_add_u32 v7, s64, v4
    v_xor_b32 v7, v7, v6
    v_add_u32 v200, v7, v3
    v_add_u32 v205, 98304, v200
    s_add_u32 s64, s63, 32
    v_add_u32 v7, s64, v4
    v_xor_b32 v7, v7, v6
    v_add_u32 v201, v7, v3
    v_add_u32 v206, 98304, v201
    s_add_u32 s64, s63, 64
    v_add_u32 v7, s64, v4
    v_xor_b32 v7, v7, v6
    v_add_u32 v202, v7, v3
    v_add_u32 v207, 98304, v202
    s_add_u32 s64, s63, 96
    v_add_u32 v7, s64, v4
    v_xor_b32 v7, v7, v6
    v_add_u32 v203, v7, v3
    v_add_u32 v208, 98304, v203
    s_add_u32 s64, s63, 128
    v_add_u32 v7, s64, v4
    v_xor_b32 v7, v7, v6
    v_add_u32 v204, v7, v3
    v_add_u32 v209, 98304, v204
    s_waitcnt lgkmcnt(0)
    s_add_u32 s54, s54, 2654435761
    s_mov_b32 s67, 0x3f803f80
    v_mov_b32 v220, s67
    v_mov_b32 v221, s67
    v_mov_b32 v222, s67
    v_mov_b32 v223, s67
    v_mov_b64 v[232:233], 0
    v_mov_b64 v[234:235], 0
    v_mov_b64 v[236:237], 0
    v_mov_b64 v[238:239], 0
    v_mov_b64 v[240:241], 0
    v_mov_b64 v[242:243], 0
    v_lshlrev_b32 v16, 3, v0
    buffer_load_dwordx2 v[10:11], v16, s[4:7], 0 offen offset:0
    buffer_load_dwordx2 v[12:13], v16, s[4:7], 0 offen offset:512
    buffer_load_dwordx2 v[14:15], v16, s[4:7], 0 offen offset:1024
    v_lshlrev_b32 v1, 4, v0
    v_lshlrev_b32 v7, 6, v0
    s_lshl_b32 s15, s49, 11
    s_add_u32 s15, s15, 196608
    s_add_u32 s70, s15, 32768
    s_cmp_eq_u32 s48, 7
    s_cselect_b32 s65, s70, 2.0
    s_mov_b64 exec, 0xffffff
    buffer_load_dword v219, v7, s[24:27], s65 offen sc1
    s_mov_b64 exec, -1
    v_mov_b32 v8, 155648
    v_mov_b32 v224, 0
    v_mov_b32 v225, 0
    v_mov_b32 v226, 0
    v_mov_b32 v227, 0
    ds_write_b128 v8, v[224:227] offset:0
    ds_write_b128 v8, v[224:227] offset:16
    ds_write_b128 v8, v[224:227] offset:32
    ds_write_b128 v8, v[224:227] offset:3648
    ds_write_b128 v8, v[224:227] offset:3664
    ds_write_b128 v8, v[224:227] offset:3776
    ds_write_b128 v8, v[224:227] offset:3792
    s_mul_i32 s65, s48, 1344
    s_add_u32 s45, s65, 16384
    v_lshl_add_u32 v16, v0, 2, s45
    v_and_b32 v19, 15, v0
    v_bfe_u32 v5, v0, 1, 1
    v_mov_b32 v6, 0x44444444
    v_mov_b32 v9, 0xeeeeeeee
    v_cmp_eq_u32 vcc, 1, v5
    s_nop 1
    v_cndmask_b32 v252, v6, v9, vcc
    v_lshlrev_b32 v6, 4, v2
    v_lshl_add_u32 v6, v5, 7, v6
    v_add_u32 v6, v6, v8
    v_bfe_u32 v3, v0, 2, 2
    v_and_b32 v4, 1, v0
    v_lshl_add_u32 v3, v3, 1, v4
    v_mul_u32_u24 v9, 1344, v3
    v_mul_u32_u24 v5, 672, v5
    v_add_u32 v9, v9, v5
    v_lshrrev_b32 v3, 1, v2
    v_mul_u32_u24 v3, 160, v3
    v_and_b32 v4, 1, v2
    v_lshl_add_u32 v3, v4, 4, v3
    s_lshr_b32 s65, s48, 2
    s_mul_i32 s63, s65, 320
    v_add3_u32 v9, v9, v3, s63
    s_lshl1_add_u32 s65, s65, s50
    s_mul_i32 s65, s65, 768
    s_mul_i32 s66, s66, 384
    s_add_u32 s65, s65, s66
    v_lshl_add_u32 v3, v19, 3, s65
    v_add_u32 v230, 155904, v3
    v_mul_u32_u24 v4, 3328, v2
    v_add_u32 v3, v3, v4
    s_mul_i32 s65, s48, 48
    v_add_u32 v4, s65, v0
    v_bfe_u32 v5, v4, 1, 1
    v_lshlrev_b32 v5, 7, v5
    v_and_b32 v17, 1, v4
    v_lshl_add_u32 v5, v17, 1, v5
    v_and_b32 v17, 0xfc, v4
    v_add_u32 v5, v5, v17
    v_lshrrev_b32 v17, 6, v4
    v_lshl_add_u32 v5, v17, 5, v5
    v_add_u32 v5, v5, v8
    v_lshlrev_b32 v4, 3, v4
    v_and_b32 v17, 7, v0
    v_lshlrev_b32 v18, 4, v17
    v_lshl_add_u32 v18, v2, 11, v18
    v_lshrrev_b32 v19, 3, v19
    v_lshl_add_u32 v229, v19, 12, v18
    s_lshl_b32 s8, s48, 13
    s_lshl_b32 s65, s49, 7
    s_add_u32 s8, s8, s65
    s_add_u32 s8, s8, 16384
    s_sub_u32 s44, s48, 2
    s_lshl_b32 s14, s49, 12
    s_lshl_b32 s65, s44, 11
    s_add_u32 s14, s14, s65
    s_add_u32 s14, s14, 16384
    s_lshr_b32 s65, s49, 1
    s_lshl_b32 s65, s65, 6
    s_lshl3_add_u32 s65, s49, s65
    s_and_b32 s66, s44, 1
    s_movk_i32 s19, 0xff
    s_cselect_b32 s18, s19, 0x00ff00ff
    s_mul_i32 s66, s66, 48
    s_add_u32 s65, s65, s66
    v_and_b32 v18, 1, v2
    v_lshrrev_b32 v19, 1, v2
    v_lshl_or_b32 v18, v18, 1, v19
    v_min_u32 v18, 2, v18
    v_lshl_add_u32 v18, v18, 4, v17
    v_add_u32 v18, s65, v18
    v_bfe_u32 v19, v18, 1, 1
    v_mul_u32_u24 v19, 672, v19
    v_and_b32 v17, 1, v18
    v_lshl_add_u32 v19, v17, 1, v19
    v_and_b32 v17, 0xffc, v18
    v_add_u32 v19, v19, v17
    v_lshlrev_b32 v18, 1, v18
    v_mov_b32 v17, v229
    s_sub_u32 s65, s54, 1
    v_mov_b32 v227, s65
    s_mov_b32 exec_hi, 0
    buffer_store_dwordx4 v[224:227], v17, s[24:27], s8 offen sc1
    s_mov_b32 exec_hi, -1
    s_lshr_b32 s68, s48, 1
    s_mul_i32 s68, s68, 3328
    s_lshl2_add_u32 s68, s50, s68
    s_lshr_b32 s16, s49, 2
    s_mul_i32 s16, s16, 61440
    s_add_u32 s16, s16, 262144
    s_mov_b32 s17, 0
    s_mov_b32 s20, 16
    s_and_b32 s9, s49, 1
    s_lshl3_add_u32 s9, s9, s48
    s_cmp_eq_u32 s9, 6
    s_cselect_b32 s9, 0, 2
    v_add_u32 v228, 155904, v4
    s_lshl_b32 s65, s48, 2
    v_add_u32 v231, s65, v8
    s_mov_b64 exec, 0
    s_cmp_eq_u32 s48, 0
    s_cbranch_scc1 HF0_0
    s_cmp_eq_u32 s48, 1
    s_cbranch_scc1 HF1_0
    s_cmp_eq_u32 s48, 2
    s_cbranch_scc1 HF2_0
    s_cmp_eq_u32 s48, 3
    s_cbranch_scc1 HF3_0
    s_cmp_eq_u32 s48, 4
    s_cbranch_scc1 HF4_0
    s_cmp_eq_u32 s48, 5
    s_cbranch_scc1 HF5_0
HF_ret:
    s_mov_b64 exec, -1
    s_add_u32 m0, s52, 98304
    s_add_u32 s62, s60, 196608
    buffer_load_dwordx4 v210, s[28:31], s62 offen lds
    s_add_u32 m0, s52, 99328
    s_add_u32 s62, s60, 196608
    buffer_load_dwordx4 v211, s[28:31], s62 offen lds
    s_add_u32 m0, s52, 100352
    s_add_u32 s62, s60, 196608
    buffer_load_dwordx4 v212, s[28:31], s62 offen lds
    s_add_u32 m0, s52, 101376
    s_add_u32 s62, s60, 245760
    buffer_load_dwordx4 v210, s[28:31], s62 offen lds
    s_add_u32 m0, s52, 102400
    s_add_u32 s62, s60, 245760
    buffer_load_dwordx4 v211, s[28:31], s62 offen lds
    s_add_u32 m0, s52, 103424
    s_add_u32 s62, s60, 245760
    buffer_load_dwordx4 v212, s[28:31], s62 offen lds
    s_waitcnt vmcnt(17)
    s_barrier
    ds_read_b64_tr_b16 v[20:21], v218 offset:0
    ds_read_b64_tr_b16 v[22:23], v218 offset:768
    ds_read_b64_tr_b16 v[24:25], v218 offset:12288
    ds_read_b64_tr_b16 v[26:27], v218 offset:13056
    ds_read_b64_tr_b16 v[28:29], v218 offset:32
    ds_read_b64_tr_b16 v[30:31], v218 offset:800
    ds_read_b64_tr_b16 v[32:33], v218 offset:12320
    ds_read_b64_tr_b16 v[34:35], v218 offset:13088
    ds_read_b64_tr_b16 v[36:37], v218 offset:64
    ds_read_b64_tr_b16 v[38:39], v218 offset:832
    ds_read_b64_tr_b16 v[40:41], v218 offset:12352
    ds_read_b64_tr_b16 v[42:43], v218 offset:13120
    s_waitcnt lgkmcnt(0)
    s_barrier
    s_add_u32 m0, s52, 0
    s_add_u32 s62, s60, 294912
    buffer_load_dwordx4 v210, s[28:31], s62 offen lds
    s_add_u32 m0, s52, 1024
    s_add_u32 s62, s60, 294912
    buffer_load_dwordx4 v211, s[28:31], s62 offen lds
    s_add_u32 m0, s52, 2048
    s_add_u32 s62, s60, 294912
    buffer_load_dwordx4 v212, s[28:31], s62 offen lds
    s_add_u32 m0, s52, 3072
    s_add_u32 s62, s60, 344064
    buffer_load_dwordx4 v210, s[28:31], s62 offen lds
    s_add_u32 m0, s52, 4096
    s_add_u32 s62, s60, 344064
    buffer_load_dwordx4 v211, s[28:31], s62 offen lds
    s_add_u32 m0, s52, 5120
    s_add_u32 s62, s60, 344064
    buffer_load_dwordx4 v212, s[28:31], s62 offen lds
    v_smfmac_f32_16x16x64_bf16 v[232:235], v[220:223], v[20:27], v252
    v_smfmac_f32_16x16x64_bf16 v[236:239], v[220:223], v[28:35], v252
    v_smfmac_f32_16x16x64_bf16 v[240:243], v[220:223], v[36:43], v252
    s_waitcnt vmcnt(17)
    s_barrier
    ds_read_b64_tr_b16 v[44:45], v218 offset:49152
    ds_read_b64_tr_b16 v[46:47], v218 offset:49920
    ds_read_b64_tr_b16 v[48:49], v218 offset:61440
    ds_read_b64_tr_b16 v[50:51], v218 offset:62208
    ds_read_b64_tr_b16 v[52:53], v218 offset:49184
    ds_read_b64_tr_b16 v[54:55], v218 offset:49952
    ds_read_b64_tr_b16 v[56:57], v218 offset:61472
    ds_read_b64_tr_b16 v[58:59], v218 offset:62240
    ds_read_b64_tr_b16 v[60:61], v218 offset:49216
    ds_read_b64_tr_b16 v[62:63], v218 offset:49984
    ds_read_b64_tr_b16 v[64:65], v218 offset:61504
    ds_read_b64_tr_b16 v[66:67], v218 offset:62272
    s_waitcnt lgkmcnt(0)
    s_barrier
    s_add_u32 m0, s52, 49152
    s_add_u32 s62, s60, 393216
    buffer_load_dwordx4 v210, s[28:31], s62 offen lds
    s_add_u32 m0, s52, 50176
    s_add_u32 s62, s60, 393216
    buffer_load_dwordx4 v211, s[28:31], s62 offen lds
    s_add_u32 m0, s52, 51200
    s_add_u32 s62, s60, 393216
    buffer_load_dwordx4 v212, s[28:31], s62 offen lds
    s_add_u32 m0, s52, 52224
    s_add_u32 s62, s60, 442368
    buffer_load_dwordx4 v210, s[28:31], s62 offen lds
    s_add_u32 m0, s52, 53248
    s_add_u32 s62, s60, 442368
    buffer_load_dwordx4 v211, s[28:31], s62 offen lds
    s_add_u32 m0, s52, 54272
    s_add_u32 s62, s60, 442368
    buffer_load_dwordx4 v212, s[28:31], s62 offen lds
    v_smfmac_f32_16x16x64_bf16 v[232:235], v[220:223], v[44:51], v252
    v_smfmac_f32_16x16x64_bf16 v[236:239], v[220:223], v[52:59], v252
    v_smfmac_f32_16x16x64_bf16 v[240:243], v[220:223], v[60:67], v252
    s_waitcnt vmcnt(12)
    s_barrier
    v_add_u32 v229, 98304, v218
    ds_read_b64_tr_b16 v[68:69], v229 offset:0
    ds_read_b64_tr_b16 v[70:71], v229 offset:768
    ds_read_b64_tr_b16 v[72:73], v229 offset:12288
    ds_read_b64_tr_b16 v[74:75], v229 offset:13056
    ds_read_b64_tr_b16 v[76:77], v229 offset:32
    ds_read_b64_tr_b16 v[78:79], v229 offset:800
    ds_read_b64_tr_b16 v[80:81], v229 offset:12320
    ds_read_b64_tr_b16 v[82:83], v229 offset:13088
    ds_read_b64_tr_b16 v[84:85], v229 offset:64
    ds_read_b64_tr_b16 v[86:87], v229 offset:832
    ds_read_b64_tr_b16 v[88:89], v229 offset:12352
    ds_read_b64_tr_b16 v[90:91], v229 offset:13120
    s_waitcnt lgkmcnt(0)
    s_barrier
    s_mul_i32 s62, s49, 3
    s_add_u32 s62, s62, 0
    s_lshr_b32 s63, s62, 2
    s_cmp_eq_u32 s63, 9
    s_cselect_b32 s63, 2, 0
    s_xor_b32 s62, s62, s63
    s_mul_i32 s62, s62, 40960
    s_add_u32 s62, s62, s53
    s_add_u32 m0, s53, 98304
    s_nop 0
    buffer_load_dwordx4 v213, s[32:35], s62 offen lds
    s_add_u32 m0, s53, 99328
    s_nop 0
    buffer_load_dwordx4 v214, s[32:35], s62 offen lds
    s_add_u32 m0, s53, 100352
    s_nop 0
    buffer_load_dwordx4 v215, s[32:35], s62 offen lds
    s_add_u32 m0, s53, 101376
    s_nop 0
    buffer_load_dwordx4 v216, s[32:35], s62 offen lds
    s_add_u32 m0, s53, 102400
    s_nop 0
    buffer_load_dwordx4 v217, s[32:35], s62 offen lds
    v_smfmac_f32_16x16x64_bf16 v[232:235], v[220:223], v[68:75], v252
    v_smfmac_f32_16x16x64_bf16 v[236:239], v[220:223], v[76:83], v252
    v_smfmac_f32_16x16x64_bf16 v[240:243], v[220:223], v[84:91], v252
    v_dot2_f32_bf16 v226, v10, s67, 0
    v_dot2_f32_bf16 v226, v11, s67, v226
    v_dot2_f32_bf16 v226, v12, s67, v226
    v_dot2_f32_bf16 v226, v13, s67, v226
    v_dot2_f32_bf16 v226, v14, s67, v226
    v_dot2_f32_bf16 v226, v15, s67, v226
    s_nop 2
    v_add_f32_dpp v226, v226, v226 row_ror:1 row_mask:0xf bank_mask:0xf
    s_nop 1
    v_add_f32_dpp v226, v226, v226 row_ror:2 row_mask:0xf bank_mask:0xf
    s_nop 1
    v_add_f32_dpp v226, v226, v226 row_ror:4 row_mask:0xf bank_mask:0xf
    s_nop 1
    v_add_f32_dpp v226, v226, v226 row_ror:8 row_mask:0xf bank_mask:0xf
    v_mov_b32 v229, v226
    s_nop 1
    v_permlane32_swap_b32 v226, v229
    v_add_f32 v226, v226, v229
    v_mov_b32 v229, v226
    s_nop 1
    v_permlane16_swap_b32 v226, v229
    v_add_f32 v226, v226, v229
    s_nop 0
    v_readfirstlane_b32 s55, v226
    s_waitcnt vmcnt(11)
    s_barrier
    ds_read_b64_tr_b16 v[92:93], v218 offset:0
    ds_read_b64_tr_b16 v[94:95], v218 offset:768
    ds_read_b64_tr_b16 v[96:97], v218 offset:12288
    ds_read_b64_tr_b16 v[98:99], v218 offset:13056
    ds_read_b64_tr_b16 v[100:101], v218 offset:32
    ds_read_b64_tr_b16 v[102:103], v218 offset:800
    ds_read_b64_tr_b16 v[104:105], v218 offset:12320
    ds_read_b64_tr_b16 v[106:107], v218 offset:13088
    ds_read_b64_tr_b16 v[108:109], v218 offset:64
    ds_read_b64_tr_b16 v[110:111], v218 offset:832
    ds_read_b64_tr_b16 v[112:113], v218 offset:12352
    ds_read_b64_tr_b16 v[114:115], v218 offset:13120
    s_waitcnt lgkmcnt(0)
    s_barrier
    s_mul_i32 s62, s49, 3
    s_add_u32 s62, s62, 1
    s_lshr_b32 s63, s62, 2
    s_cmp_eq_u32 s63, 9
    s_cselect_b32 s63, 2, 0
    s_xor_b32 s62, s62, s63
    s_mul_i32 s62, s62, 40960
    s_add_u32 s62, s62, s53
    s_add_u32 m0, s53, 0
    s_nop 0
    buffer_load_dwordx4 v213, s[32:35], s62 offen lds
    s_add_u32 m0, s53, 1024
    s_nop 0
    buffer_load_dwordx4 v214, s[32:35], s62 offen lds
    s_add_u32 m0, s53, 2048
    s_nop 0
    buffer_load_dwordx4 v215, s[32:35], s62 offen lds
    s_add_u32 m0, s53, 3072
    s_nop 0
    buffer_load_dwordx4 v216, s[32:35], s62 offen lds
    s_add_u32 m0, s53, 4096
    s_nop 0
    buffer_load_dwordx4 v217, s[32:35], s62 offen lds
    v_smfmac_f32_16x16x64_bf16 v[232:235], v[220:223], v[92:99], v252
    v_smfmac_f32_16x16x64_bf16 v[236:239], v[220:223], v[100:107], v252
    v_smfmac_f32_16x16x64_bf16 v[240:243], v[220:223], v[108:115], v252
    s_waitcnt vmcnt(10)
    s_barrier
    ds_read_b64_tr_b16 v[116:117], v218 offset:49152
    ds_read_b64_tr_b16 v[118:119], v218 offset:49920
    ds_read_b64_tr_b16 v[120:121], v218 offset:61440
    ds_read_b64_tr_b16 v[122:123], v218 offset:62208
    ds_read_b64_tr_b16 v[124:125], v218 offset:49184
    ds_read_b64_tr_b16 v[126:127], v218 offset:49952
    ds_read_b64_tr_b16 v[128:129], v218 offset:61472
    ds_read_b64_tr_b16 v[130:131], v218 offset:62240
    ds_read_b64_tr_b16 v[132:133], v218 offset:49216
    ds_read_b64_tr_b16 v[134:135], v218 offset:49984
    ds_read_b64_tr_b16 v[136:137], v218 offset:61504
    ds_read_b64_tr_b16 v[138:139], v218 offset:62272
    s_waitcnt lgkmcnt(0)
    s_barrier
    s_mul_i32 s62, s49, 3
    s_add_u32 s62, s62, 2
    s_lshr_b32 s63, s62, 2
    s_cmp_eq_u32 s63, 9
    s_cselect_b32 s63, 2, 0
    s_xor_b32 s62, s62, s63
    s_mul_i32 s62, s62, 40960
    s_add_u32 s62, s62, s53
    s_add_u32 m0, s53, 49152
    s_nop 0
    buffer_load_dwordx4 v213, s[32:35], s62 offen lds
    s_add_u32 m0, s53, 50176
    s_nop 0
    buffer_load_dwordx4 v214, s[32:35], s62 offen lds
    s_add_u32 m0, s53, 51200
    s_nop 0
    buffer_load_dwordx4 v215, s[32:35], s62 offen lds
    s_add_u32 m0, s53, 52224
    s_nop 0
    buffer_load_dwordx4 v216, s[32:35], s62 offen lds
    s_add_u32 m0, s53, 53248
    s_nop 0
    buffer_load_dwordx4 v217, s[32:35], s62 offen lds
    s_cmp_eq_u32 s48, 0
    s_cselect_b32 s65, s15, 2.0
    s_mov_b64 exec, 0xffffff
    buffer_load_dwordx2 v[224:225], v7, s[24:27], s65 offen sc1
    s_mov_b64 exec, -1
    v_smfmac_f32_16x16x64_bf16 v[232:235], v[220:223], v[116:123], v252
    v_smfmac_f32_16x16x64_bf16 v[236:239], v[220:223], v[124:131], v252
    v_smfmac_f32_16x16x64_bf16 v[240:243], v[220:223], v[132:139], v252
    s_mov_b64 exec, 0xffff
    s_nop 8
    v_pk_add_f32 v[232:233], v[232:233], v[234:235]
    ds_write_b64 v230, v[232:233] offset:0
    v_pk_add_f32 v[236:237], v[236:237], v[238:239]
    ds_write_b64 v230, v[236:237] offset:128
    v_pk_add_f32 v[240:241], v[240:241], v[242:243]
    ds_write_b64 v230, v[240:241] offset:256
    s_mov_b64 exec, -1
    s_waitcnt lgkmcnt(0)
    s_waitcnt vmcnt(6)
    s_barrier
    ds_read2st64_b32 v[232:233], v228 offset0:0 offset1:3
    ds_read2st64_b32 v[234:235], v228 offset0:6 offset1:9
    ds_read_b64_tr_b16 v[140:141], v205 offset:0
    ds_read_b64_tr_b16 v[142:143], v205 offset:5120
    ds_read_b64_tr_b16 v[152:153], v206 offset:0
    ds_read_b64_tr_b16 v[154:155], v206 offset:5120
    ds_read_b64_tr_b16 v[164:165], v207 offset:0
    ds_read_b64_tr_b16 v[166:167], v207 offset:5120
    ds_read_b64_tr_b16 v[176:177], v208 offset:0
    ds_read_b64_tr_b16 v[178:179], v208 offset:5120
    ds_read_b64_tr_b16 v[188:189], v209 offset:0
    ds_read_b64_tr_b16 v[190:191], v209 offset:5120
    ds_read_b64_tr_b16 v[144:145], v200 offset:0
    ds_read_b64_tr_b16 v[146:147], v200 offset:5120
    ds_read_b64_tr_b16 v[156:157], v201 offset:0
    ds_read_b64_tr_b16 v[158:159], v201 offset:5120
    ds_read_b64_tr_b16 v[168:169], v202 offset:0
    ds_read_b64_tr_b16 v[170:171], v202 offset:5120
    ds_read_b64_tr_b16 v[180:181], v203 offset:0
    ds_read_b64_tr_b16 v[182:183], v203 offset:5120
    ds_read_b64_tr_b16 v[192:193], v204 offset:0
    ds_read_b64_tr_b16 v[194:195], v204 offset:5120
    s_waitcnt lgkmcnt(0)
    v_add_f32 v0, v232, v234
    v_add_f32 v2, v233, v235
    s_waitcnt vmcnt(1)
    s_barrier
    ds_read_b64_tr_b16 v[148:149], v200 offset:49152
    ds_read_b64_tr_b16 v[150:151], v200 offset:54272
    ds_read_b64_tr_b16 v[160:161], v201 offset:49152
    ds_read_b64_tr_b16 v[162:163], v201 offset:54272
    ds_read_b64_tr_b16 v[172:173], v202 offset:49152
    ds_read_b64_tr_b16 v[174:175], v202 offset:54272
    ds_read_b64_tr_b16 v[184:185], v203 offset:49152
    ds_read_b64_tr_b16 v[186:187], v203 offset:54272
    ds_read_b64_tr_b16 v[196:197], v204 offset:49152
    ds_read_b64_tr_b16 v[198:199], v204 offset:54272
    s_waitcnt lgkmcnt(0)
F_rdy:
HF0_0:
    s_cbranch_execz HF0_1
    s_cmp_lg_u32 s48, 0
    s_cbranch_scc1 F_wait
    s_mov_b64 exec, 0xffffff
    s_branch F_pw
F_poll:
    buffer_load_dwordx2 v[224:225], v7, s[24:27], s15 offen sc1
F_pw:
    s_waitcnt vmcnt(0)
HF0_1:
    s_cbranch_execz HF_ret
    v_cmp_ne_u32 vcc, s54, v225
    s_cbranch_vccz F_got
    s_sleep 1
    s_sub_u32 s3, s3, 1
    s_cbranch_scc0 F_poll
    s_mov_b32 s3, 0
F_got:
    s_mov_b64 exec, -1
    v_max_u32_dpp v226, v224, v224 row_ror:1 row_mask:0xf bank_mask:0xf
    s_nop 1
    v_max_u32_dpp v226, v226, v226 row_ror:2 row_mask:0xf bank_mask:0xf
    s_nop 1
    v_max_u32_dpp v226, v226, v226 row_ror:4 row_mask:0xf bank_mask:0xf
    s_nop 1
    v_max_u32_dpp v226, v226, v226 row_ror:8 row_mask:0xf bank_mask:0xf
    s_nop 0
    v_readlane_b32 s60, v226, 0
    v_readlane_b32 s62, v226, 16
    s_max_u32 s60, s60, s62
    s_max_u32 s60, s60, 1572865
    s_sub_u32 s60, s60, 1572864
F_thr:
    v_cmp_le_u32 vcc, s60, v224
    s_add_u32 s60, s60, 196608
    s_cbranch_scc1 F_thd
    s_bcnt1_i32_b32 s62, vcc_lo
    s_cmp_gt_u32 s62, 8
    s_cbranch_scc1 F_thr
F_thd:
    v_mbcnt_lo_u32_b32 v226, vcc_lo, 0
    v_cmp_gt_u32 s[62:63], 8, v226
    v_lshl_add_u32 v226, v226, 2, v8
    s_and_b64 exec, vcc, s[62:63]
    ds_write_b32 v226, v224 offset:0
    s_mov_b64 exec, -1
    s_waitcnt lgkmcnt(0)
F_wait:
    s_waitcnt vmcnt(0)
    s_barrier
    ds_read_b32 v224, v231 offset:0
    s_waitcnt lgkmcnt(0)
    v_readfirstlane_b32 s60, v224
F_redo:
    v_mov_b64 v[232:233], 0
    v_mov_b64 v[234:235], 0
    v_mov_b64 v[236:237], 0
    v_mov_b64 v[238:239], 0
    v_mov_b64 v[240:241], 0
    v_mov_b64 v[242:243], 0
    s_and_b32 s61, s60, 0xfff
    s_cbranch_scc0 F_b1
    s_lshr_b32 s62, s61, 4
    s_mul_i32 s62, s62, 171
HF1_0:
    s_cbranch_execz HF1_1
    s_lshr_b32 s62, s62, 10
    s_mul_i32 s62, s62, 2560
    s_add_u32 s62, s62, s16
    s_add_u32 s63, s54, s61
    v_mov_b64 v[228:229], 0
    v_mov_b32 v230, s63
    buffer_load_dwordx3 v[220:222], v1, s[24:27], s62 offen offset:0 sc1
    buffer_load_dwordx3 v[224:226], v1, s[24:27], s62 offen offset:1024 sc1
    s_mov_b32 exec_hi, 0
    buffer_load_dwordx3 v[228:230], v1, s[24:27], s62 offen offset:2048 sc1
    s_mov_b32 exec_hi, -1
    s_branch F_rw
F_row:
    s_mov_b64 exec, s[58:59]
    s_cbranch_execz F_r0
    buffer_load_dwordx3 v[220:222], v1, s[24:27], s62 offen offset:0 sc1
F_r0:
    s_mov_b64 exec, s[64:65]
    s_cbranch_execz F_r1
    buffer_load_dwordx3 v[224:226], v1, s[24:27], s62 offen offset:1024 sc1
F_r1:
    s_mov_b64 exec, s[10:11]
    s_cbranch_execz F_r2
    buffer_load_dwordx3 v[228:230], v1, s[24:27], s62 offen offset:2048 sc1
F_r2:
    s_mov_b64 exec, -1
F_rw:
    s_waitcnt vmcnt(0)
    ds_write2_b32 v16, v220, v221 offset0:0 offset1:168
    ds_write2_b32 v16, v224, v225 offset0:64 offset1:232
    s_mov_b32 exec_hi, 0
    ds_write_b32 v16, v228 offset:512
    ds_write_b32 v16, v229 offset:1184
    s_mov_b32 exec_hi, -1
    v_cmp_ne_u32 s[58:59], s63, v222
    v_cmp_ne_u32 s[64:65], s63, v226
    v_cmp_ne_u32 s[10:11], s63, v230
    s_or_b64 vcc, s[58:59], s[64:65]
    s_or_b64 vcc, vcc, s[10:11]
    s_cbranch_scc0 F_ok
    s_sub_u32 s20, s20, 1
    s_cbranch_scc0 F_row
F_b1:
    s_waitcnt lgkmcnt(0)
    s_barrier
    s_cmp_lg_u32 s9, s17
    s_cbranch_scc1 F_nwb
    buffer_wbl2 sc1
F_nwb:
    ds_read_b128 v[200:203], v9 offset:16384
    ds_read_b128 v[204:207], v9 offset:16416
    ds_read_b128 v[208:211], v9 offset:16448
HF1_1:
    s_cbranch_execz HF_ret
    ds_read_b128 v[212:215], v9 offset:16480
    ds_read_b128 v[216:219], v9 offset:16512
    s_waitcnt lgkmcnt(4)
    v_smfmac_f32_16x16x64_bf16 v[232:235], v[200:203], v[20:27], v252
    v_smfmac_f32_16x16x64_bf16 v[236:239], v[200:203], v[28:35], v252
    v_smfmac_f32_16x16x64_bf16 v[240:243], v[200:203], v[36:43], v252
    s_waitcnt lgkmcnt(3)
    v_smfmac_f32_16x16x64_bf16 v[232:235], v[204:207], v[44:51], v252
    v_smfmac_f32_16x16x64_bf16 v[236:239], v[204:207], v[52:59], v252
    v_smfmac_f32_16x16x64_bf16 v[240:243], v[204:207], v[60:67], v252
    s_waitcnt lgkmcnt(2)
    v_smfmac_f32_16x16x64_bf16 v[232:235], v[208:211], v[68:75], v252
    v_smfmac_f32_16x16x64_bf16 v[236:239], v[208:211], v[76:83], v252
    v_smfmac_f32_16x16x64_bf16 v[240:243], v[208:211], v[84:91], v252
    s_waitcnt lgkmcnt(1)
    v_smfmac_f32_16x16x64_bf16 v[232:235], v[212:215], v[92:99], v252
    v_smfmac_f32_16x16x64_bf16 v[236:239], v[212:215], v[100:107], v252
    v_smfmac_f32_16x16x64_bf16 v[240:243], v[212:215], v[108:115], v252
    s_waitcnt lgkmcnt(0)
    v_smfmac_f32_16x16x64_bf16 v[232:235], v[216:219], v[116:123], v252
    v_smfmac_f32_16x16x64_bf16 v[236:239], v[216:219], v[124:131], v252
    v_smfmac_f32_16x16x64_bf16 v[240:243], v[216:219], v[132:139], v252
    s_nop 8
    s_branch F_pw2
F_ok:
    v_dot2_f32_bf16 v222, v220, s67, 0
    v_dot2_f32_bf16 v223, v220, v220, 0
    v_dot2_f32_bf16 v226, v220, v10, 0
    v_dot2_f32_bf16 v222, v221, s67, v222
    v_dot2_f32_bf16 v223, v221, v221, v223
    v_dot2_f32_bf16 v226, v221, v11, v226
    v_dot2_f32_bf16 v222, v224, s67, v222
    v_dot2_f32_bf16 v223, v224, v224, v223
    v_dot2_f32_bf16 v226, v224, v12, v226
    v_dot2_f32_bf16 v222, v225, s67, v222
    v_dot2_f32_bf16 v223, v225, v225, v223
HF2_0:
    s_cbranch_execz HF2_1
    v_dot2_f32_bf16 v226, v225, v13, v226
    v_dot2_f32_bf16 v222, v228, s67, v222
    v_dot2_f32_bf16 v223, v228, v228, v223
    v_dot2_f32_bf16 v226, v228, v14, v226
    v_dot2_f32_bf16 v222, v229, s67, v222
    v_dot2_f32_bf16 v223, v229, v229, v223
    v_dot2_f32_bf16 v226, v229, v15, v226
    s_waitcnt lgkmcnt(0)
    s_barrier
    s_cmp_lg_u32 s9, s17
    s_cbranch_scc1 F_nwc
    buffer_wbl2 sc1
F_nwc:
    ds_read_b128 v[200:203], v9 offset:16384
    ds_read_b128 v[204:207], v9 offset:16416
    ds_read_b128 v[208:211], v9 offset:16448
    ds_read_b128 v[212:215], v9 offset:16480
    ds_read_b128 v[216:219], v9 offset:16512
    v_mov_b32 v227, v226
    v_permlane32_swap_b32 v222, v223
    s_nop 0
    v_permlane32_swap_b32 v226, v227
    v_add_f32 v222, v222, v223
    v_add_f32 v226, v226, v227
    v_mov_b32 v224, s68
    v_mov_b32 v223, s45
    v_permlane16_swap_b32 v222, v226
    v_add_f32 v222, v222, v226
    s_waitcnt lgkmcnt(4)
    v_smfmac_f32_16x16x64_bf16 v[232:235], v[200:203], v[20:27], v252
    v_add_f32_dpp v222, v222, v222 row_ror:1 row_mask:0xf bank_mask:0xf
    s_nop 1
    v_add_f32_dpp v222, v222, v222 row_ror:2 row_mask:0xf bank_mask:0xf
    v_smfmac_f32_16x16x64_bf16 v[236:239], v[200:203], v[28:35], v252
    s_nop 0
    v_add_f32_dpp v222, v222, v222 row_ror:4 row_mask:0xf bank_mask:0xf
    s_nop 1
    v_add_f32_dpp v222, v222, v222 row_ror:8 row_mask:0xf bank_mask:0xf
    v_smfmac_f32_16x16x64_bf16 v[240:243], v[200:203], v[36:43], v252
    v_readlane_b32 s64, v222, 32
    v_readlane_b32 s65, v222, 16
HF2_1:
    s_cbranch_execz HF_ret
    s_waitcnt lgkmcnt(3)
    v_smfmac_f32_16x16x64_bf16 v[232:235], v[204:207], v[44:51], v252
    v_mov_b32 v220, v222
    v_mov_b32 v221, s64
    v_smfmac_f32_16x16x64_bf16 v[236:239], v[204:207], v[52:59], v252
    v_mul_f32 v220, 0x3acccccd, v220
    v_mul_f32 v221, 0x3acccccd, v221
    v_smfmac_f32_16x16x64_bf16 v[240:243], v[204:207], v[60:67], v252
    v_fma_f32 v221, -v220, v220, v221
    v_max_f32 v221, 0, v221
    s_waitcnt lgkmcnt(2)
    v_smfmac_f32_16x16x64_bf16 v[232:235], v[208:211], v[68:75], v252
    v_cvt_pk_bf16_f32 v221, v221, v221
    v_and_b32 v221, 0xffff0000, v221
    v_smfmac_f32_16x16x64_bf16 v[236:239], v[208:211], v[76:83], v252
    v_add_f32 v221, 0x3727c5ac, v221
    v_cvt_pk_bf16_f32 v221, v221, v221
    v_smfmac_f32_16x16x64_bf16 v[240:243], v[208:211], v[84:91], v252
    v_and_b32 v221, 0xffff0000, v221
    v_sqrt_f32 v221, v221
    s_waitcnt lgkmcnt(1)
    v_smfmac_f32_16x16x64_bf16 v[232:235], v[212:215], v[92:99], v252
    v_cvt_pk_bf16_f32 v220, v220, v220
    v_and_b32 v220, 0xffff0000, v220
    v_smfmac_f32_16x16x64_bf16 v[236:239], v[212:215], v[100:107], v252
    v_cvt_pk_bf16_f32 v221, v221, v221
    v_and_b32 v221, 0xffff0000, v221
    v_smfmac_f32_16x16x64_bf16 v[240:243], v[212:215], v[108:115], v252
    v_rcp_f32 v221, v221
    v_mul_f32 v222, s55, v220
    s_waitcnt lgkmcnt(0)
    v_smfmac_f32_16x16x64_bf16 v[232:235], v[216:219], v[116:123], v252
    v_sub_f32 v222, s65, v222
    v_mul_f32 v222, v222, v221
    v_smfmac_f32_16x16x64_bf16 v[236:239], v[216:219], v[124:131], v252
    v_ashrrev_i32 v225, 31, v222
    v_or_b32 v225, 0x80000000, v225
    v_smfmac_f32_16x16x64_bf16 v[240:243], v[216:219], v[132:139], v252
HF3_0:
    s_cbranch_execz HF3_1
    v_xor_b32 v225, v225, v222
    v_and_b32 v225, 0xfffff000, v225
    v_or_b32 v225, s61, v225
    s_mov_b64 exec, 1
    ds_write2_b32 v224, v220, v221 offset0:0 offset1:2
    ds_write2_b32 v224, v222, v223 offset0:4 offset1:6
    ds_max_u64 v8, v[224:225] offset:32
    s_mov_b64 exec, -1
F_pw2:
    v_pk_add_f32 v[232:233], v[232:233], v[234:235]
    ds_write_b64 v3, v[232:233] offset:256
    v_pk_add_f32 v[236:237], v[236:237], v[238:239]
    ds_write_b64 v3, v[236:237] offset:384
    v_pk_add_f32 v[240:241], v[240:241], v[242:243]
    ds_write_b64 v3, v[240:241] offset:512
    s_cmp_ge_u32 s48, 2
    v_mov_b64 v[244:245], 0
    v_mov_b64 v[246:247], 0
    v_mov_b64 v[248:249], 0
    v_mov_b64 v[250:251], 0
    s_waitcnt lgkmcnt(0)
    s_barrier
    ds_read_b64 v[224:225], v8 offset:32
    v_mov_b64 v[232:233], 0
    v_mov_b64 v[234:235], 0
    v_mov_b64 v[236:237], 0
    v_mov_b64 v[238:239], 0
    v_mov_b64 v[240:241], 0
    v_mov_b64 v[242:243], 0
    s_waitcnt lgkmcnt(0)
    s_cbranch_scc1 F_gu
    v_add_u32 v227, v224, v4
    ds_read2_b32 v[228:229], v224 offset0:0 offset1:2
    ds_read2st64_b32 v[208:209], v227 offset0:1 offset1:4
    ds_read2st64_b32 v[210:211], v227 offset0:7 offset1:10
    s_waitcnt lgkmcnt(1)
    v_fma_f32 v208, -v228, v0, v208
    v_fma_f32 v209, -v228, v2, v209
    s_waitcnt lgkmcnt(0)
    v_add_f32 v208, v208, v210
    v_add_f32 v209, v209, v211
    v_mul_f32 v208, v208, v229
    v_mul_f32 v209, v209, v229
    v_cvt_pk_bf16_f32 v209, v208, v209
    v_lshlrev_b32 v208, 16, v209
    v_mul_f32 v210, 0xbfb8aa3b, v208
HF3_1:
    s_cbranch_execz HF_ret
    v_exp_f32 v210, v210
    v_and_b32 v209, s47, v209
    v_add_f32 v210, 1.0, v210
    v_rcp_f32 v210, v210
    s_mov_b32 exec_hi, 0xffff
    v_mul_f32 v208, v208, v210
    v_cvt_pk_bf16_f32 v208, v208, v208
    v_and_b32 v208, 0xffff0000, v208
    v_mul_f32 v208, v208, v209
    v_cvt_pk_bf16_f32 v208, v208, v208
    ds_write_b16 v5, v208 offset:3584
    s_mov_b64 exec, -1
    s_waitcnt lgkmcnt(0)
F_gu:
    s_barrier
    ds_read_b128 v[200:203], v6 offset:3584
    ds_read_b128 v[204:207], v6 offset:3648
    v_readfirstlane_b32 s61, v225
    v_mov_b32 v220, 0
    s_and_b32 s61, s61, 0xfff
    s_add_u32 s63, s54, s61
    v_mov_b32 v215, s63
    s_waitcnt lgkmcnt(1)
    v_smfmac_f32_16x16x64_bf16 v[232:235], v[200:203], v[140:147], v252
    v_smfmac_f32_16x16x64_bf16 v[236:239], v[200:203], v[152:159], v252
    v_smfmac_f32_16x16x64_bf16 v[240:243], v[200:203], v[164:171], v252
    v_smfmac_f32_16x16x64_bf16 v[244:247], v[200:203], v[176:183], v252
    v_smfmac_f32_16x16x64_bf16 v[248:251], v[200:203], v[188:195], v252
    s_cmp_lg_u32 s48, 7
    s_cbranch_scc1 F_n7
    s_mov_b64 exec, 0xffffff
    buffer_load_dwordx2 v[220:221], v7, s[24:27], s70 offen sc1
    s_mov_b64 exec, -1
F_n7:
    s_waitcnt lgkmcnt(0)
    v_smfmac_f32_16x16x64_bf16 v[232:235], v[204:207], v[144:151], v252
    v_smfmac_f32_16x16x64_bf16 v[236:239], v[204:207], v[156:163], v252
    v_smfmac_f32_16x16x64_bf16 v[240:243], v[204:207], v[168:175], v252
    v_smfmac_f32_16x16x64_bf16 v[244:247], v[204:207], v[180:187], v252
    v_smfmac_f32_16x16x64_bf16 v[248:251], v[204:207], v[192:199], v252
    s_nop 7
    v_add_f32 v212, v232, v234
    v_add_f32 v213, v236, v238
    v_add_f32 v214, v240, v242
    s_mov_b32 exec_lo, s47
    v_add_f32 v212, v244, v246
    v_add_f32 v213, v248, v250
    s_mov_b32 exec_lo, -1
HF4_0:
    s_cbranch_execz HF4_1
    s_mov_b32 exec_hi, 0
    buffer_store_dwordx4 v[212:215], v17, s[24:27], s8 offen sc1
    s_mov_b32 exec_hi, -1
    s_cmp_lt_u32 s44, 2
    s_cbranch_scc0 F_rest
    ds_read2_b32 v[228:229], v224 offset0:0 offset1:2
    ds_read2_b32 v[230:231], v224 offset0:4 offset1:6
    s_lshr_b32 s65, s61, 4
    s_mul_i32 s65, s65, 171
    s_lshr_b32 s65, s65, 10
    s_mul_i32 s64, s65, 2560
    s_add_u32 s64, s64, 131072
    s_mul_i32 s71, s65, 96
    s_sub_u32 s66, s61, s71
    s_lshr_b32 s71, s65, 1
    s_mul_i32 s71, s71, 86
    s_add_u32 s66, s66, s71
    s_sub_u32 s66, s66, 10
    s_lshl_b32 s66, s66, 1
    s_and_b32 s65, s65, 1
    s_add_u32 s66, s66, s65
    s_mul_i32 s66, s66, 1280
    v_lshrrev_b32 v223, 3, v18
    v_lshlrev_b32 v223, 4, v223
    s_waitcnt lgkmcnt(0)
    v_add_u32 v226, v231, v19
    v_and_b32 v226, 0xfffe, v226
    ds_read_u16 v226, v226
    v_cvt_pk_bf16_f32 v231, v230, v230
    v_and_b32 v231, 0xffff0000, v231
    v_mul_f32 v231, 0xbfb8aa3b, v231
    v_exp_f32 v231, v231
    s_nop 0
    v_add_f32 v231, 1.0, v231
    v_rcp_f32 v231, v231
    s_waitcnt lgkmcnt(0)
    v_lshlrev_b32 v226, 16, v226
    v_cvt_pk_bf16_f32 v231, v231, v231
    v_and_b32 v231, 0xffff0000, v231
    v_sub_f32 v227, v226, v228
    v_cvt_pk_bf16_f32 v227, v227, v227
    v_and_b32 v227, 0xffff0000, v227
HF4_1:
    s_cbranch_execz HF_ret
    v_mul_f32 v227, v227, v229
    v_cvt_pk_bf16_f32 v227, v227, v227
    v_and_b32 v227, 0xffff0000, v227
    s_waitcnt vmcnt(0)
F_yp:
    buffer_load_dwordx4 v[200:203], v1, s[24:27], s14 offen sc1
    buffer_load_dwordx4 v[204:207], v1, s[24:27], s14 offen offset:1024 sc1
    s_mov_b64 exec, s[18:19]
    buffer_load_dword v222, v223, s[24:27], s64 offen offset:8 sc1
    s_mov_b64 exec, -1
    s_waitcnt vmcnt(1)
    ds_read_b32 v224, v8 offset:40
    v_cmp_ne_u32 vcc, s63, v203
    v_cmp_ne_u32 s[58:59], s63, v207
    v_add_f32 v200, v200, v204
    v_add_f32 v201, v201, v205
    v_add_f32 v202, v202, v206
    s_or_b64 vcc, vcc, s[58:59]
    s_cbranch_scc1 F_chk
    v_mov_b32 v203, v202
    v_permlane32_swap_b32 v200, v201
    s_nop 0
    v_permlane32_swap_b32 v202, v203
    v_add_f32 v200, v200, v201
    v_add_f32 v202, v202, v203
    s_nop 1
    v_permlane16_swap_b32 v200, v202
    v_add_f32 v200, v200, v202
    s_nop 1
    v_add_f32_dpp v200, v200, v200 row_ror:8 row_mask:0xf bank_mask:0xf
    v_cvt_pk_bf16_f32 v200, v200, v200
    v_and_b32 v200, 0xffff0000, v200
    v_mul_f32 v200, v200, v231
    v_cvt_pk_bf16_f32 v200, v200, v200
    v_and_b32 v200, 0xffff0000, v200
    v_add_f32 v200, v200, v227
    v_cvt_pk_bf16_f32 v200, v200, v200
    v_and_b32 v200, 0xffff0000, v200
    v_add_f32 v200, v200, v226
    v_cvt_pk_bf16_f32 v200, v200, v200
F_vf:
    s_mov_b64 exec, s[18:19]
    s_waitcnt vmcnt(0) lgkmcnt(0)
    v_readfirstlane_b32 s60, v224
    v_cmp_ne_u32 vcc, s63, v222
    s_and_b32 s62, s60, 0xfff
    s_cmp_lg_u32 s62, s61
    s_cbranch_scc1 F_vw
    s_cbranch_vccnz F_vl
HF5_0:
    s_cbranch_execz HF5_1
    buffer_store_short v200, v18, s[40:43], s66 offen
    s_or_b32 s65, s49, s44
    s_cbranch_scc1 L_fin
    s_mov_b64 exec, 1
    v_mov_b32 v9, 0
    v_mov_b32 v10, s54
    buffer_store_dword v10, v9, s[24:27], 0 offen
    s_branch L_fin
F_vw:
    s_cmp_lg_u32 s62, 0
    s_cbranch_scc1 F_vx
    s_cbranch_vccz F_vn
F_vl:
    buffer_load_dword v222, v223, s[24:27], s64 offen offset:8 sc1
F_vn:
    ds_read_b32 v224, v8 offset:40
    s_sub_u32 s3, s3, 1
    s_cbranch_scc0 F_vf
    s_mov_b32 s3, 0
    s_branch L_fin
F_vx:
    s_cmp_eq_u32 s17, 0
    s_cbranch_scc1 F_again
    s_branch L_fin
F_chk:
    s_waitcnt lgkmcnt(0)
    v_readfirstlane_b32 s60, v224
    s_and_b32 s62, s60, 0xfff
    s_cselect_b32 s62, s62, s61
    s_cmp_lg_u32 s62, s61
    s_cbranch_scc1 F_vx
    s_sub_u32 s3, s3, 1
    s_cbranch_scc0 F_yp
    s_mov_b32 s3, 0
    s_branch L_fin
F_rest:
    s_cmp_lg_u32 s17, 0
    s_cbranch_scc1 L_fin
    s_cmp_lg_u32 s48, 7
    s_cbranch_scc1 F_tw
    s_mov_b64 exec, 0xffffff
    s_waitcnt vmcnt(1)
    s_branch F_tc
F_tp:
    buffer_load_dwordx2 v[220:221], v7, s[24:27], s70 offen sc1
    s_waitcnt vmcnt(0)
F_tc:
    v_cmp_ne_u32 vcc, s54, v221
    s_cbranch_vccz F_tg
    s_sub_u32 s3, s3, 1
    s_cbranch_scc0 F_tp
    s_mov_b32 s3, 0
F_tg:
    s_mov_b64 exec, -1
    v_max_u32_dpp v222, v220, v220 row_ror:1 row_mask:0xf bank_mask:0xf
    s_nop 1
    v_max_u32_dpp v222, v222, v222 row_ror:2 row_mask:0xf bank_mask:0xf
    s_nop 1
    v_max_u32_dpp v222, v222, v222 row_ror:4 row_mask:0xf bank_mask:0xf
    s_nop 1
    v_max_u32_dpp v222, v222, v222 row_ror:8 row_mask:0xf bank_mask:0xf
HF5_1:
    s_cbranch_execz HF_ret
    s_nop 0
    v_readlane_b32 s60, v222, 0
    v_readlane_b32 s62, v222, 16
    s_max_u32 s60, s60, s62
    s_and_b32 s62, s60, 0xfff
    s_cselect_b32 s60, s60, 1
    v_mov_b32 v220, s60
    ds_write_b32 v8, v220 offset:40
F_tw:
    ds_read_b32 v224, v8 offset:40
    s_waitcnt lgkmcnt(0)
    v_readfirstlane_b32 s60, v224
    s_and_b32 s62, s60, 0xfff
    s_cbranch_scc1 F_tk
    s_sleep 2
    s_sub_u32 s3, s3, 1
    s_cbranch_scc0 F_tw
    s_mov_b32 s3, 0
    s_branch L_fin
F_tk:
    s_cmp_eq_u32 s62, s61
    s_cbranch_scc1 L_fin
F_again:
    s_mov_b64 exec, -1
    s_waitcnt vmcnt(0)
    s_mov_b32 s17, 1
    s_mov_b32 s16, 131072
    s_mov_b32 s20, 0x40000
    v_mov_b64 v[224:225], 0
    s_cmp_eq_u32 s48, 0
    s_cselect_b32 s60, s60, 0
    s_cbranch_scc0 F_redo
    ds_write_b64 v8, v[224:225] offset:32
    s_branch F_redo
L_last:
.section .rodata,"a"
.p2align 6
.amdhsa_kernel sequential_preLN__sliding_local_dilated__moe_arch_mod__prompt_kernel
  .amdhsa_next_free_vgpr 256
  .amdhsa_next_free_sgpr 102
  .amdhsa_accum_offset 256
  .amdhsa_group_segment_fixed_size 0
  .amdhsa_kernarg_size 88
  .amdhsa_user_sgpr_count 2
  .amdhsa_user_sgpr_kernarg_segment_ptr 1
  .amdhsa_system_sgpr_workgroup_id_x 1
  .amdhsa_float_denorm_mode_32 3
  .amdhsa_float_denorm_mode_16_64 3
.end_amdhsa_kernel
```
